```python
import torch

def _softmax(x, axis=-1):
    return torch.softmax(x, dim=axis)
def _gelu(x):
    return torch.nn.functional.gelu(x, approximate="tanh")
def _silu(x):
    return torch.nn.functional.silu(x)
def _sigmoid(x):
    return torch.sigmoid(x)
def _layernorm(x, axis=-1, eps=1e-5):
    m = x.mean(dim=axis, keepdim=True)
    v = x.var(dim=axis, keepdim=True, unbiased=False)
    return (x - m) / torch.sqrt(v + eps)
def _scatter_add(tgt, idx, src, axis=0):
    return tgt.clone().index_add_(axis, idx, src)
def _segment_sum(src, seg, n):
    out = torch.zeros((n,) + src.shape[1:], dtype=src.dtype)
    return out.index_add_(0, seg, src)
def _pad(x, pw):
    flat = tuple(v for pair in reversed(pw) for v in pair)
    return torch.nn.functional.pad(x, flat)

kernel_name = 'recurrent_scan__sliding_block_cached__mixer_s_mlp__prompt'

def setup_inputs():

    _w = (lambda a: (lambda t: t.to(torch.bfloat16) if t.is_floating_point() else t)(torch.as_tensor(a)))
    def _A_setup():
        B, Sq, D = 1, 2048, 576
        Hq, Hkv, Sk, Dh = 32, 16, 2048, 128
        assert Hq % Hkv == 0, (Hq, Hkv)
        return {
            "x": _w((lambda *s: torch.randn(*s, dtype=torch.bfloat16) * 0.05)(B, Sq, D)),
            "k_cache": _w((lambda *s: torch.randn(*s, dtype=torch.bfloat16) * 0.8)(B, Hkv, Sk, Dh)),
            "v_cache": _w((lambda *s: torch.randn(*s, dtype=torch.bfloat16) * 0.8)(B, Hkv, Sk, Dh)),
            "wq": _w((lambda *s: torch.randn(*s, dtype=torch.bfloat16) * 0.8)(D, Hq * Dh) * (D ** -0.5)),
            "wo": _w((lambda *s: torch.randn(*s, dtype=torch.bfloat16) * 0.8)(Hq * Dh, D) * ((Hq * Dh) ** -0.5)),
        }
    _A_in = _A_setup()

    def _B_setup():
        B, S, D, F = 1, 2048, 576, 4608
        return {
            "x":  _w((lambda *s: torch.randn(*s, dtype=torch.bfloat16) * 0.05)(B, S, D)),
            "w1": _w((lambda *s: torch.randn(*s, dtype=torch.bfloat16) * 3.2)(D, D) * (D ** -0.5)),
            "w2": _w((lambda *s: torch.randn(*s, dtype=torch.bfloat16) * 3.2)(D, D) * (D ** -0.5)),
            "w3": _w((lambda *s: torch.randn(*s, dtype=torch.bfloat16) * 3.2)(D, F) * (D ** -0.5)),
            "w4": _w((lambda *s: torch.randn(*s, dtype=torch.bfloat16) * 3.2)(F, D) * (F ** -0.5)),
        }
    _B_in = _B_setup()

    return {
        "A_x": _A_in["x"],
        "A_k_cache": _A_in["k_cache"],
        "A_v_cache": _A_in["v_cache"],
        "A_wq": _A_in["wq"],
        "A_wo": _A_in["wo"],
        "B_x": _B_in["x"],
        "B_w1": _B_in["w1"],
        "B_w2": _B_in["w2"],
        "B_w3": _B_in["w3"],
        "B_w4": _B_in["w4"],
    }

def reference(A_x, A_k_cache, A_v_cache, A_wq, A_wo, B_x, B_w1, B_w2, B_w3, B_w4):
    def _A_ref(x, k_cache, v_cache, wq, wo):
        B, Sq, D = x.shape
        Hq, Dh = 32, 128
        Hkv, Sk = k_cache.shape[1], k_cache.shape[2]
        W = min(4096, max(256, Sk // 4))
        rep = Hq // Hkv
        q = (lambda x, *d: x.permute(*d))((x @ wq).reshape(B, Sq, Hq, Dh), 0, 2, 1, 3)
        k = (lambda x, n, axis: torch.repeat_interleave(x, n, dim=axis))(k_cache[:, :, Sk - W:, :], rep, axis=1)
        v = (lambda x, n, axis: torch.repeat_interleave(x, n, dim=axis))(v_cache[:, :, Sk - W:, :], rep, axis=1)
        scores = torch.einsum("bhqd,bhkd->bhqk", q, k) * (Dh ** -0.5)
        p = _softmax(scores, axis=-1)
        o = torch.einsum("bhqk,bhkd->bhqd", p, v)
        return (lambda x, *d: x.permute(*d))(o, 0, 2, 1, 3).reshape(B, Sq, Hq * Dh) @ wo

    def _B_ref(x, w1, w2, w3, w4):
        B, S, D = x.shape
        h = _gelu(_layernorm(x, axis=-1) @ w1)
        c = D // 4
        g0 = _pad(h[:, :, 0*c:1*c], ((0, 0), (1, 0), (0, 0)))[:, :S, :]
        g1 = _pad(h[:, :, 1*c:2*c], ((0, 0), (0, 1), (0, 0)))[:, 1:, :]
        g2 = _pad(h[:, :, 2*c:3*c], ((0, 0), (2, 0), (0, 0)))[:, :S, :]
        g3 = _pad(h[:, :, 3*c:   ], ((0, 0), (0, 2), (0, 0)))[:, 2:, :]
        hs = torch.concatenate([g0, g1, g2, g3], axis=-1) @ w2
        x1 = x + hs
        h2 = _gelu(_layernorm(x1, axis=-1) @ w3) @ w4
        return x1 + h2

    x = A_x
    xn = _layernorm(x, axis=-1)
    s = _A_ref(xn, A_k_cache, A_v_cache, A_wq, A_wo)
    g = _silu(_B_ref(xn, B_w1, B_w2, B_w3, B_w4))
    return x + s * g
```

```asm
; @launch grid=(256,1,1) block=(256,1,1) lds=163840
.amdgcn_target "amdgcn-amd-amdhsa--gfx950"
.macro Mvvv d,a,b
v_mfma_f32_16x16x32_bf16 v[\d:\d+3], v[\a:\a+3], v[\b:\b+3], v[\d:\d+3]
.endm
.macro Mvva d,a,b
v_mfma_f32_16x16x32_bf16 v[\d:\d+3], v[\a:\a+3], a[\b:\b+3], v[\d:\d+3]
.endm
.macro Mvav d,a,b
v_mfma_f32_16x16x32_bf16 v[\d:\d+3], a[\a:\a+3], v[\b:\b+3], v[\d:\d+3]
.endm
.macro Mvaa d,a,b
v_mfma_f32_16x16x32_bf16 v[\d:\d+3], a[\a:\a+3], a[\b:\b+3], v[\d:\d+3]
.endm
.macro Tv d,r,o
ds_read_b64_tr_b16 v[\d:\d+1], v\r offset:\o
.endm
.macro Mavv d,a,b
v_mfma_f32_16x16x32_bf16 a[\d:\d+3], v[\a:\a+3], v[\b:\b+3], a[\d:\d+3]
.endm
.macro Mava d,a,b
v_mfma_f32_16x16x32_bf16 a[\d:\d+3], v[\a:\a+3], a[\b:\b+3], a[\d:\d+3]
.endm
.macro Maav d,a,b
v_mfma_f32_16x16x32_bf16 a[\d:\d+3], a[\a:\a+3], v[\b:\b+3], a[\d:\d+3]
.endm
.macro Maaa d,a,b
v_mfma_f32_16x16x32_bf16 a[\d:\d+3], a[\a:\a+3], a[\b:\b+3], a[\d:\d+3]
.endm
.macro Ta d,r,o
ds_read_b64_tr_b16 a[\d:\d+1], v\r offset:\o
.endm
.macro CV d,a,b
v_cvt_pk_bf16_f32 v\d, v\a, v\b
.endm
.macro LD v,r,s,o
buffer_load_dwordx4 v\v, s[\r:\r+3], s\s offen offset:\o lds
.endm
.text
.p2align 8
.p2align 12
L_B1:
L_Bmain:
s_add_u32 m0, s83, 0x2000
s_add_u32 s76, s82, 0x100
LD 192,32,76,0
LD 193,32,76,1024
LD 194,32,76,2048
LD 195,32,76,3072
s_add_u32 m0, s83, 0x3000
s_add_u32 s76, s82, 0x180
LD 192,32,76,0
LD 193,32,76,1024
LD 194,32,76,2048
LD 195,32,76,3072
s_mov_b64 exec, 0
s_cmp_eq_u32 s64, 0
s_cbranch_scc1 L_pg0_1
s_cmp_eq_u32 s64, 1
s_cbranch_scc1 L_pg0_2
s_cmp_eq_u32 s64, 2
s_cbranch_scc1 L_pg0_3
s_branch L_pg0_4
L_ret0:
s_mov_b64 exec, -1
s_mov_b64 exec, 0
s_cmp_eq_u32 s64, 0
s_cbranch_scc1 L_pg1_5
s_cmp_eq_u32 s64, 1
s_cbranch_scc1 L_pg1_6
s_cmp_eq_u32 s64, 2
s_cbranch_scc1 L_pg1_7
s_branch L_pg1_8
L_ret1:
s_mov_b64 exec, -1
s_waitcnt vmcnt(15)
ds_read_b128 v[48:51], v196
ds_read_b128 v[52:55], v196 offset:2048
ds_read_b128 v[56:59], v197
ds_read_b128 v[60:63], v197 offset:2048
s_add_u32 m0, s83, 0
s_add_u32 s76, s82, 0x200
s_waitcnt lgkmcnt(0)
LD 192,32,76,0
LD 193,32,76,1024
LD 194,32,76,2048
LD 195,32,76,3072
s_waitcnt vmcnt(15)
ds_read_b128 v[64:67], v196 offset:4096
ds_read_b128 v[68:71], v196 offset:6144
ds_read_b128 v[72:75], v197 offset:4096
ds_read_b128 v[76:79], v197 offset:6144
v_dot2_f32_bf16 v240, v48, s88, v240
v_dot2_f32_bf16 v242, v48, v48, v242
v_dot2_f32_bf16 v241, v52, s88, v241
v_dot2_f32_bf16 v243, v52, v52, v243
v_dot2_f32_bf16 v240, v49, s88, v240
v_dot2_f32_bf16 v242, v49, v49, v242
v_dot2_f32_bf16 v241, v53, s88, v241
v_dot2_f32_bf16 v243, v53, v53, v243
v_dot2_f32_bf16 v240, v50, s88, v240
v_dot2_f32_bf16 v242, v50, v50, v242
v_dot2_f32_bf16 v241, v54, s88, v241
v_dot2_f32_bf16 v243, v54, v54, v243
v_dot2_f32_bf16 v240, v51, s88, v240
v_dot2_f32_bf16 v242, v51, v51, v242
v_dot2_f32_bf16 v241, v55, s88, v241
v_dot2_f32_bf16 v243, v55, v55, v243
v_dot2_f32_bf16 v240, v56, s88, v240
v_dot2_f32_bf16 v242, v56, v56, v242
v_dot2_f32_bf16 v241, v60, s88, v241
v_dot2_f32_bf16 v243, v60, v60, v243
v_dot2_f32_bf16 v240, v57, s88, v240
v_dot2_f32_bf16 v242, v57, v57, v242
v_dot2_f32_bf16 v241, v61, s88, v241
v_dot2_f32_bf16 v243, v61, v61, v243
v_dot2_f32_bf16 v240, v58, s88, v240
v_dot2_f32_bf16 v242, v58, v58, v242
v_dot2_f32_bf16 v241, v62, s88, v241
v_dot2_f32_bf16 v243, v62, v62, v243
v_dot2_f32_bf16 v240, v59, s88, v240
v_dot2_f32_bf16 v242, v59, v59, v242
v_dot2_f32_bf16 v241, v63, s88, v241
v_dot2_f32_bf16 v243, v63, v63, v243
s_cmp_lg_u32 s66, 0
s_cbranch_scc1 L_xt1
v_accvgpr_write_b32 a180, v48
v_accvgpr_write_b32 a181, v49
v_accvgpr_write_b32 a182, v50
v_accvgpr_write_b32 a183, v51
v_accvgpr_write_b32 a184, v52
v_accvgpr_write_b32 a185, v53
v_accvgpr_write_b32 a186, v54
v_accvgpr_write_b32 a187, v55
v_accvgpr_write_b32 a188, v56
v_accvgpr_write_b32 a189, v57
v_accvgpr_write_b32 a190, v58
v_accvgpr_write_b32 a191, v59
v_accvgpr_write_b32 a192, v60
v_accvgpr_write_b32 a193, v61
v_accvgpr_write_b32 a194, v62
v_accvgpr_write_b32 a195, v63
L_xt1:
s_add_u32 m0, s83, 0x1000
s_add_u32 s76, s82, 0x280
s_waitcnt lgkmcnt(0)
LD 192,32,76,0
LD 193,32,76,1024
LD 194,32,76,2048
LD 195,32,76,3072
s_waitcnt vmcnt(12)
ds_read_b128 v[80:83], v196 offset:8192
ds_read_b128 v[84:87], v196 offset:10240
ds_read_b128 v[88:91], v197 offset:8192
ds_read_b128 v[92:95], v197 offset:10240
v_dot2_f32_bf16 v240, v64, s88, v240
v_dot2_f32_bf16 v242, v64, v64, v242
v_dot2_f32_bf16 v241, v68, s88, v241
v_dot2_f32_bf16 v243, v68, v68, v243
v_dot2_f32_bf16 v240, v65, s88, v240
v_dot2_f32_bf16 v242, v65, v65, v242
v_dot2_f32_bf16 v241, v69, s88, v241
v_dot2_f32_bf16 v243, v69, v69, v243
v_dot2_f32_bf16 v240, v66, s88, v240
v_dot2_f32_bf16 v242, v66, v66, v242
v_dot2_f32_bf16 v241, v70, s88, v241
v_dot2_f32_bf16 v243, v70, v70, v243
v_dot2_f32_bf16 v240, v67, s88, v240
v_dot2_f32_bf16 v242, v67, v67, v242
v_dot2_f32_bf16 v241, v71, s88, v241
v_dot2_f32_bf16 v243, v71, v71, v243
v_dot2_f32_bf16 v240, v72, s88, v240
v_dot2_f32_bf16 v242, v72, v72, v242
v_dot2_f32_bf16 v241, v76, s88, v241
v_dot2_f32_bf16 v243, v76, v76, v243
v_dot2_f32_bf16 v240, v73, s88, v240
v_dot2_f32_bf16 v242, v73, v73, v242
v_dot2_f32_bf16 v241, v77, s88, v241
v_dot2_f32_bf16 v243, v77, v77, v243
v_dot2_f32_bf16 v240, v74, s88, v240
v_dot2_f32_bf16 v242, v74, v74, v242
v_dot2_f32_bf16 v241, v78, s88, v241
v_dot2_f32_bf16 v243, v78, v78, v243
v_dot2_f32_bf16 v240, v75, s88, v240
v_dot2_f32_bf16 v242, v75, v75, v242
v_dot2_f32_bf16 v241, v79, s88, v241
v_dot2_f32_bf16 v243, v79, v79, v243
s_cmp_lg_u32 s66, 1
s_cbranch_scc1 L_xt2
v_accvgpr_write_b32 a180, v64
v_accvgpr_write_b32 a181, v65
v_accvgpr_write_b32 a182, v66
v_accvgpr_write_b32 a183, v67
v_accvgpr_write_b32 a184, v68
v_accvgpr_write_b32 a185, v69
v_accvgpr_write_b32 a186, v70
v_accvgpr_write_b32 a187, v71
v_accvgpr_write_b32 a188, v72
v_accvgpr_write_b32 a189, v73
v_accvgpr_write_b32 a190, v74
v_accvgpr_write_b32 a191, v75
v_accvgpr_write_b32 a192, v76
v_accvgpr_write_b32 a193, v77
v_accvgpr_write_b32 a194, v78
v_accvgpr_write_b32 a195, v79
L_xt2:
s_add_u32 m0, s83, 0x2000
s_add_u32 s76, s82, 0x300
s_waitcnt lgkmcnt(0)
LD 192,32,76,0
LD 193,32,76,1024
LD 194,32,76,2048
LD 195,32,76,3072
s_waitcnt vmcnt(12)
ds_read_b128 v[96:99], v196 offset:12288
ds_read_b128 v[100:103], v196 offset:14336
ds_read_b128 v[104:107], v197 offset:12288
ds_read_b128 v[108:111], v197 offset:14336
v_dot2_f32_bf16 v240, v80, s88, v240
v_dot2_f32_bf16 v242, v80, v80, v242
v_dot2_f32_bf16 v241, v84, s88, v241
v_dot2_f32_bf16 v243, v84, v84, v243
v_dot2_f32_bf16 v240, v81, s88, v240
v_dot2_f32_bf16 v242, v81, v81, v242
v_dot2_f32_bf16 v241, v85, s88, v241
v_dot2_f32_bf16 v243, v85, v85, v243
v_dot2_f32_bf16 v240, v82, s88, v240
v_dot2_f32_bf16 v242, v82, v82, v242
v_dot2_f32_bf16 v241, v86, s88, v241
v_dot2_f32_bf16 v243, v86, v86, v243
v_dot2_f32_bf16 v240, v83, s88, v240
v_dot2_f32_bf16 v242, v83, v83, v242
v_dot2_f32_bf16 v241, v87, s88, v241
v_dot2_f32_bf16 v243, v87, v87, v243
v_dot2_f32_bf16 v240, v88, s88, v240
v_dot2_f32_bf16 v242, v88, v88, v242
v_dot2_f32_bf16 v241, v92, s88, v241
v_dot2_f32_bf16 v243, v92, v92, v243
v_dot2_f32_bf16 v240, v89, s88, v240
v_dot2_f32_bf16 v242, v89, v89, v242
v_dot2_f32_bf16 v241, v93, s88, v241
v_dot2_f32_bf16 v243, v93, v93, v243
v_dot2_f32_bf16 v240, v90, s88, v240
v_dot2_f32_bf16 v242, v90, v90, v242
v_dot2_f32_bf16 v241, v94, s88, v241
v_dot2_f32_bf16 v243, v94, v94, v243
v_dot2_f32_bf16 v240, v91, s88, v240
v_dot2_f32_bf16 v242, v91, v91, v242
v_dot2_f32_bf16 v241, v95, s88, v241
v_dot2_f32_bf16 v243, v95, v95, v243
s_cmp_lg_u32 s66, 2
s_cbranch_scc1 L_xt3
v_accvgpr_write_b32 a180, v80
v_accvgpr_write_b32 a181, v81
v_accvgpr_write_b32 a182, v82
v_accvgpr_write_b32 a183, v83
v_accvgpr_write_b32 a184, v84
v_accvgpr_write_b32 a185, v85
v_accvgpr_write_b32 a186, v86
v_accvgpr_write_b32 a187, v87
v_accvgpr_write_b32 a188, v88
v_accvgpr_write_b32 a189, v89
v_accvgpr_write_b32 a190, v90
v_accvgpr_write_b32 a191, v91
v_accvgpr_write_b32 a192, v92
v_accvgpr_write_b32 a193, v93
v_accvgpr_write_b32 a194, v94
v_accvgpr_write_b32 a195, v95
L_xt3:
s_add_u32 m0, s83, 0x3000
s_add_u32 s76, s82, 0x380
s_waitcnt lgkmcnt(0)
LD 192,32,76,0
LD 193,32,76,1024
LD 194,32,76,2048
LD 195,32,76,3072
s_waitcnt vmcnt(12)
ds_read_b128 v[112:115], v196
ds_read_b128 v[116:119], v196 offset:2048
ds_read_b128 v[120:123], v197
ds_read_b128 v[124:127], v197 offset:2048
v_dot2_f32_bf16 v240, v96, s88, v240
v_dot2_f32_bf16 v242, v96, v96, v242
v_dot2_f32_bf16 v241, v100, s88, v241
v_dot2_f32_bf16 v243, v100, v100, v243
v_dot2_f32_bf16 v240, v97, s88, v240
v_dot2_f32_bf16 v242, v97, v97, v242
v_dot2_f32_bf16 v241, v101, s88, v241
v_dot2_f32_bf16 v243, v101, v101, v243
v_dot2_f32_bf16 v240, v98, s88, v240
v_dot2_f32_bf16 v242, v98, v98, v242
v_dot2_f32_bf16 v241, v102, s88, v241
v_dot2_f32_bf16 v243, v102, v102, v243
v_dot2_f32_bf16 v240, v99, s88, v240
v_dot2_f32_bf16 v242, v99, v99, v242
v_dot2_f32_bf16 v241, v103, s88, v241
v_dot2_f32_bf16 v243, v103, v103, v243
v_dot2_f32_bf16 v240, v104, s88, v240
v_dot2_f32_bf16 v242, v104, v104, v242
v_dot2_f32_bf16 v241, v108, s88, v241
v_dot2_f32_bf16 v243, v108, v108, v243
v_dot2_f32_bf16 v240, v105, s88, v240
v_dot2_f32_bf16 v242, v105, v105, v242
v_dot2_f32_bf16 v241, v109, s88, v241
v_dot2_f32_bf16 v243, v109, v109, v243
v_dot2_f32_bf16 v240, v106, s88, v240
v_dot2_f32_bf16 v242, v106, v106, v242
v_dot2_f32_bf16 v241, v110, s88, v241
v_dot2_f32_bf16 v243, v110, v110, v243
v_dot2_f32_bf16 v240, v107, s88, v240
v_dot2_f32_bf16 v242, v107, v107, v242
v_dot2_f32_bf16 v241, v111, s88, v241
v_dot2_f32_bf16 v243, v111, v111, v243
s_cmp_lg_u32 s66, 3
s_cbranch_scc1 L_xt4
v_accvgpr_write_b32 a180, v96
v_accvgpr_write_b32 a181, v97
v_accvgpr_write_b32 a182, v98
v_accvgpr_write_b32 a183, v99
v_accvgpr_write_b32 a184, v100
v_accvgpr_write_b32 a185, v101
v_accvgpr_write_b32 a186, v102
v_accvgpr_write_b32 a187, v103
v_accvgpr_write_b32 a188, v104
v_accvgpr_write_b32 a189, v105
v_accvgpr_write_b32 a190, v106
v_accvgpr_write_b32 a191, v107
v_accvgpr_write_b32 a192, v108
v_accvgpr_write_b32 a193, v109
v_accvgpr_write_b32 a194, v110
v_accvgpr_write_b32 a195, v111
L_xt4:
s_add_u32 m0, s83, 0
s_add_u32 s76, s82, 0x400
s_waitcnt lgkmcnt(0)
LD 192,32,76,0
LD 193,32,76,1024
LD 194,32,76,2048
LD 195,32,76,3072
s_waitcnt vmcnt(12)
ds_read_b128 v[128:131], v196 offset:4096
ds_read_b128 v[132:135], v196 offset:6144
ds_read_b128 v[136:139], v197 offset:4096
ds_read_b128 v[140:143], v197 offset:6144
v_dot2_f32_bf16 v240, v112, s88, v240
v_dot2_f32_bf16 v242, v112, v112, v242
v_dot2_f32_bf16 v241, v116, s88, v241
v_dot2_f32_bf16 v243, v116, v116, v243
v_dot2_f32_bf16 v240, v113, s88, v240
v_dot2_f32_bf16 v242, v113, v113, v242
v_dot2_f32_bf16 v241, v117, s88, v241
v_dot2_f32_bf16 v243, v117, v117, v243
v_dot2_f32_bf16 v240, v114, s88, v240
v_dot2_f32_bf16 v242, v114, v114, v242
v_dot2_f32_bf16 v241, v118, s88, v241
v_dot2_f32_bf16 v243, v118, v118, v243
v_dot2_f32_bf16 v240, v115, s88, v240
v_dot2_f32_bf16 v242, v115, v115, v242
v_dot2_f32_bf16 v241, v119, s88, v241
v_dot2_f32_bf16 v243, v119, v119, v243
v_dot2_f32_bf16 v240, v120, s88, v240
v_dot2_f32_bf16 v242, v120, v120, v242
v_dot2_f32_bf16 v241, v124, s88, v241
v_dot2_f32_bf16 v243, v124, v124, v243
v_dot2_f32_bf16 v240, v121, s88, v240
v_dot2_f32_bf16 v242, v121, v121, v242
v_dot2_f32_bf16 v241, v125, s88, v241
v_dot2_f32_bf16 v243, v125, v125, v243
v_dot2_f32_bf16 v240, v122, s88, v240
v_dot2_f32_bf16 v242, v122, v122, v242
v_dot2_f32_bf16 v241, v126, s88, v241
v_dot2_f32_bf16 v243, v126, v126, v243
v_dot2_f32_bf16 v240, v123, s88, v240
v_dot2_f32_bf16 v242, v123, v123, v242
v_dot2_f32_bf16 v241, v127, s88, v241
v_dot2_f32_bf16 v243, v127, v127, v243
s_cmp_lg_u32 s66, 4
s_cbranch_scc1 L_xt5
v_accvgpr_write_b32 a180, v112
v_accvgpr_write_b32 a181, v113
v_accvgpr_write_b32 a182, v114
v_accvgpr_write_b32 a183, v115
v_accvgpr_write_b32 a184, v116
v_accvgpr_write_b32 a185, v117
v_accvgpr_write_b32 a186, v118
v_accvgpr_write_b32 a187, v119
v_accvgpr_write_b32 a188, v120
v_accvgpr_write_b32 a189, v121
v_accvgpr_write_b32 a190, v122
v_accvgpr_write_b32 a191, v123
v_accvgpr_write_b32 a192, v124
v_accvgpr_write_b32 a193, v125
v_accvgpr_write_b32 a194, v126
v_accvgpr_write_b32 a195, v127
L_xt5:
s_waitcnt vmcnt(8)
ds_read_b128 v[144:147], v196 offset:8192
ds_read_b128 v[148:151], v196 offset:10240
ds_read_b128 v[152:155], v197 offset:8192
ds_read_b128 v[156:159], v197 offset:10240
s_waitcnt lgkmcnt(4)
v_dot2_f32_bf16 v240, v128, s88, v240
v_dot2_f32_bf16 v242, v128, v128, v242
v_dot2_f32_bf16 v241, v132, s88, v241
v_dot2_f32_bf16 v243, v132, v132, v243
v_dot2_f32_bf16 v240, v129, s88, v240
v_dot2_f32_bf16 v242, v129, v129, v242
v_dot2_f32_bf16 v241, v133, s88, v241
v_dot2_f32_bf16 v243, v133, v133, v243
v_dot2_f32_bf16 v240, v130, s88, v240
v_dot2_f32_bf16 v242, v130, v130, v242
v_dot2_f32_bf16 v241, v134, s88, v241
v_dot2_f32_bf16 v243, v134, v134, v243
v_dot2_f32_bf16 v240, v131, s88, v240
v_dot2_f32_bf16 v242, v131, v131, v242
v_dot2_f32_bf16 v241, v135, s88, v241
v_dot2_f32_bf16 v243, v135, v135, v243
v_dot2_f32_bf16 v240, v136, s88, v240
v_dot2_f32_bf16 v242, v136, v136, v242
v_dot2_f32_bf16 v241, v140, s88, v241
v_dot2_f32_bf16 v243, v140, v140, v243
v_dot2_f32_bf16 v240, v137, s88, v240
v_dot2_f32_bf16 v242, v137, v137, v242
v_dot2_f32_bf16 v241, v141, s88, v241
v_dot2_f32_bf16 v243, v141, v141, v243
v_dot2_f32_bf16 v240, v138, s88, v240
v_dot2_f32_bf16 v242, v138, v138, v242
v_dot2_f32_bf16 v241, v142, s88, v241
v_dot2_f32_bf16 v243, v142, v142, v243
v_dot2_f32_bf16 v240, v139, s88, v240
v_dot2_f32_bf16 v242, v139, v139, v242
v_dot2_f32_bf16 v241, v143, s88, v241
v_dot2_f32_bf16 v243, v143, v143, v243
s_cmp_lg_u32 s66, 5
s_cbranch_scc1 L_xt6
v_accvgpr_write_b32 a180, v128
v_accvgpr_write_b32 a181, v129
v_accvgpr_write_b32 a182, v130
v_accvgpr_write_b32 a183, v131
v_accvgpr_write_b32 a184, v132
v_accvgpr_write_b32 a185, v133
v_accvgpr_write_b32 a186, v134
v_accvgpr_write_b32 a187, v135
v_accvgpr_write_b32 a188, v136
v_accvgpr_write_b32 a189, v137
v_accvgpr_write_b32 a190, v138
v_accvgpr_write_b32 a191, v139
v_accvgpr_write_b32 a192, v140
v_accvgpr_write_b32 a193, v141
v_accvgpr_write_b32 a194, v142
v_accvgpr_write_b32 a195, v143
L_xt6:
s_waitcnt vmcnt(4)
ds_read_b128 v[160:163], v196 offset:12288
ds_read_b128 v[164:167], v196 offset:14336
ds_read_b128 v[168:171], v197 offset:12288
ds_read_b128 v[172:175], v197 offset:14336
s_waitcnt lgkmcnt(4)
v_dot2_f32_bf16 v240, v144, s88, v240
s_add_u32 m0, s67, 0
v_dot2_f32_bf16 v242, v144, v144, v242
v_dot2_f32_bf16 v241, v148, s88, v241
v_dot2_f32_bf16 v243, v148, v148, v243
s_add_u32 s76, s28, 0
v_dot2_f32_bf16 v240, v145, s88, v240
v_dot2_f32_bf16 v242, v145, v145, v242
v_dot2_f32_bf16 v241, v149, s88, v241
LD 8,44,76,0
v_dot2_f32_bf16 v243, v149, v149, v243
v_dot2_f32_bf16 v240, v146, s88, v240
v_dot2_f32_bf16 v242, v146, v146, v242
LD 9,44,76,1024
v_dot2_f32_bf16 v241, v150, s88, v241
v_dot2_f32_bf16 v243, v150, v150, v243
v_dot2_f32_bf16 v240, v147, s88, v240
LD 10,44,76,2048
v_dot2_f32_bf16 v242, v147, v147, v242
v_dot2_f32_bf16 v241, v151, s88, v241
v_dot2_f32_bf16 v243, v151, v151, v243
LD 11,44,76,3072
v_dot2_f32_bf16 v240, v152, s88, v240
v_dot2_f32_bf16 v242, v152, v152, v242
v_dot2_f32_bf16 v241, v156, s88, v241
s_add_u32 m0, s67, 0x1000
v_dot2_f32_bf16 v243, v156, v156, v243
v_dot2_f32_bf16 v240, v153, s88, v240
v_dot2_f32_bf16 v242, v153, v153, v242
s_add_u32 s76, s28, 0x9000
v_dot2_f32_bf16 v241, v157, s88, v241
v_dot2_f32_bf16 v243, v157, v157, v243
v_dot2_f32_bf16 v240, v154, s88, v240
LD 8,44,76,0
v_dot2_f32_bf16 v242, v154, v154, v242
v_dot2_f32_bf16 v241, v158, s88, v241
v_dot2_f32_bf16 v243, v158, v158, v243
LD 9,44,76,1024
v_dot2_f32_bf16 v240, v155, s88, v240
v_dot2_f32_bf16 v242, v155, v155, v242
v_dot2_f32_bf16 v241, v159, s88, v241
v_dot2_f32_bf16 v243, v159, v159, v243
s_cmp_lg_u32 s66, 6
s_cbranch_scc1 L_xt7
v_accvgpr_write_b32 a180, v144
v_accvgpr_write_b32 a181, v145
v_accvgpr_write_b32 a182, v146
v_accvgpr_write_b32 a183, v147
v_accvgpr_write_b32 a184, v148
v_accvgpr_write_b32 a185, v149
v_accvgpr_write_b32 a186, v150
v_accvgpr_write_b32 a187, v151
v_accvgpr_write_b32 a188, v152
v_accvgpr_write_b32 a189, v153
v_accvgpr_write_b32 a190, v154
v_accvgpr_write_b32 a191, v155
v_accvgpr_write_b32 a192, v156
v_accvgpr_write_b32 a193, v157
v_accvgpr_write_b32 a194, v158
v_accvgpr_write_b32 a195, v159
L_xt7:
s_waitcnt vmcnt(6)
ds_read_b128 v[176:179], v196
ds_read_b128 v[180:183], v196 offset:2048
ds_read_b128 v[184:187], v197
ds_read_b128 v[188:191], v197 offset:2048
s_waitcnt lgkmcnt(4)
v_dot2_f32_bf16 v240, v160, s88, v240
LD 10,44,76,2048
v_dot2_f32_bf16 v242, v160, v160, v242
v_dot2_f32_bf16 v241, v164, s88, v241
v_dot2_f32_bf16 v243, v164, v164, v243
LD 11,44,76,3072
v_dot2_f32_bf16 v240, v161, s88, v240
v_dot2_f32_bf16 v242, v161, v161, v242
v_dot2_f32_bf16 v241, v165, s88, v241
s_add_u32 m0, s67, 0x2000
v_dot2_f32_bf16 v243, v165, v165, v243
v_dot2_f32_bf16 v240, v162, s88, v240
v_dot2_f32_bf16 v242, v162, v162, v242
s_add_u32 s76, s28, 0x12000
v_dot2_f32_bf16 v241, v166, s88, v241
v_dot2_f32_bf16 v243, v166, v166, v243
v_dot2_f32_bf16 v240, v163, s88, v240
LD 8,44,76,0
v_dot2_f32_bf16 v242, v163, v163, v242
v_dot2_f32_bf16 v241, v167, s88, v241
v_dot2_f32_bf16 v243, v167, v167, v243
s_add_u32 m0, s67, 0x9000
v_dot2_f32_bf16 v240, v168, s88, v240
v_dot2_f32_bf16 v242, v168, v168, v242
v_dot2_f32_bf16 v241, v172, s88, v241
s_add_u32 s76, s28, 0x51000
v_dot2_f32_bf16 v243, v172, v172, v243
v_dot2_f32_bf16 v240, v169, s88, v240
v_dot2_f32_bf16 v242, v169, v169, v242
LD 8,44,76,0
v_dot2_f32_bf16 v241, v173, s88, v241
v_dot2_f32_bf16 v243, v173, v173, v243
v_dot2_f32_bf16 v240, v170, s88, v240
LD 9,44,76,1024
v_dot2_f32_bf16 v242, v170, v170, v242
v_dot2_f32_bf16 v241, v174, s88, v241
v_dot2_f32_bf16 v243, v174, v174, v243
LD 10,44,76,2048
v_dot2_f32_bf16 v240, v171, s88, v240
v_dot2_f32_bf16 v242, v171, v171, v242
v_dot2_f32_bf16 v241, v175, s88, v241
v_dot2_f32_bf16 v243, v175, v175, v243
s_cmp_lg_u32 s66, 7
s_cbranch_scc1 L_xt8
v_accvgpr_write_b32 a180, v160
v_accvgpr_write_b32 a181, v161
v_accvgpr_write_b32 a182, v162
v_accvgpr_write_b32 a183, v163
v_accvgpr_write_b32 a184, v164
v_accvgpr_write_b32 a185, v165
v_accvgpr_write_b32 a186, v166
v_accvgpr_write_b32 a187, v167
v_accvgpr_write_b32 a188, v168
v_accvgpr_write_b32 a189, v169
v_accvgpr_write_b32 a190, v170
v_accvgpr_write_b32 a191, v171
v_accvgpr_write_b32 a192, v172
v_accvgpr_write_b32 a193, v173
v_accvgpr_write_b32 a194, v174
v_accvgpr_write_b32 a195, v175
L_xt8:
s_waitcnt lgkmcnt(0)
s_barrier
v_dot2_f32_bf16 v240, v176, s88, v240
LD 11,44,76,3072
v_dot2_f32_bf16 v242, v176, v176, v242
v_dot2_f32_bf16 v241, v180, s88, v241
s_add_u32 m0, s67, 0xa000
v_dot2_f32_bf16 v243, v180, v180, v243
L_pg0_1:
s_cbranch_execz L_ret0
v_dot2_f32_bf16 v240, v177, s88, v240
s_add_u32 s76, s28, 0x5a000
v_dot2_f32_bf16 v242, v177, v177, v242
v_dot2_f32_bf16 v241, v181, s88, v241
LD 8,44,76,0
v_dot2_f32_bf16 v243, v181, v181, v243
v_dot2_f32_bf16 v240, v178, s88, v240
LD 9,44,76,1024
v_dot2_f32_bf16 v242, v178, v178, v242
v_dot2_f32_bf16 v241, v182, s88, v241
LD 10,44,76,2048
v_dot2_f32_bf16 v243, v182, v182, v243
v_dot2_f32_bf16 v240, v179, s88, v240
LD 11,44,76,3072
v_dot2_f32_bf16 v242, v179, v179, v242
v_dot2_f32_bf16 v241, v183, s88, v241
s_add_u32 m0, s67, 0xb000
v_dot2_f32_bf16 v243, v183, v183, v243
v_dot2_f32_bf16 v240, v184, s88, v240
s_add_u32 s76, s28, 0x63000
v_dot2_f32_bf16 v242, v184, v184, v242
v_dot2_f32_bf16 v241, v188, s88, v241
LD 8,44,76,0
v_dot2_f32_bf16 v243, v188, v188, v243
v_dot2_f32_bf16 v240, v185, s88, v240
v_dot2_f32_bf16 v242, v185, v185, v242
v_dot2_f32_bf16 v241, v189, s88, v241
v_dot2_f32_bf16 v243, v189, v189, v243
v_dot2_f32_bf16 v240, v186, s88, v240
v_dot2_f32_bf16 v242, v186, v186, v242
v_dot2_f32_bf16 v241, v190, s88, v241
v_dot2_f32_bf16 v243, v190, v190, v243
v_dot2_f32_bf16 v240, v187, s88, v240
v_dot2_f32_bf16 v242, v187, v187, v242
v_dot2_f32_bf16 v241, v191, s88, v241
v_dot2_f32_bf16 v243, v191, v191, v243
s_nop 1
v_permlane32_swap_b32 v240, v241
v_add_f32 v240, v240, v241
v_permlane32_swap_b32 v242, v243
v_add_f32 v242, v242, v243
v_mov_b32 v244, v240
s_nop 1
v_permlane16_swap_b32 v240, v244
v_add_f32 v240, v240, v244
v_mov_b32 v245, v242
s_nop 1
v_permlane16_swap_b32 v242, v245
v_add_f32 v242, v242, v245
v_mul_f32 v240, 0xbae38e39, v240
v_mul_f32 v242, 0x3ae38e39, v242
v_fma_f32 v242, -v240, v240, v242
v_max_f32 v242, 0, v242
v_mov_b32 v24, v240
s_add_u32 m0, s67, 0x12000
v_mov_b32 v251, v24
v_mov_b32 v252, v24
s_add_u32 s76, s95, 0x200
s_nop 0
v_permlane32_swap_b32 v251, v252
v_readfirstlane_b32 s84, v255
v_mov_b32 v25, v242
v_mov_b32 v248, v251
v_mov_b32 v249, v251
v_mov_b32 v250, v251
v_mov_b32 v253, v252
v_mov_b32 v254, v252
v_mfma_f32_16x16x32_bf16 v[224:227], a[236:239], v[48:51], v[248:251]
LD 20,36,76,0
v_mov_b32 v255, v252
v_add_f32 v26, 0x3727c5ac, v25
v_mfma_f32_16x16x32_bf16 v[228:231], a[240:243], v[48:51], v[248:251]
s_lshl_b32 s9, s66, 6
v_rcp_f32 v27, v26
v_mfma_f32_16x16x32_bf16 v[232:235], a[236:239], v[52:55], v[252:255]
s_add_u32 s84, s84, 0x9e3779b9
CV 48,224,225
CV 49,226,227
v_mul_f32 v25, v25, v27
v_mfma_f32_16x16x32_bf16 v[236:239], a[240:243], v[52:55], v[252:255]
s_add_u32 s9, s9, s94
CV 50,228,229
CV 51,230,231
v_add_f32 v25, 0x3727c5ac, v25
v_mfma_f32_16x16x32_bf16 v[240:243], a[236:239], v[56:59], v[248:251]
s_cmp_lg_u32 s89, 0
s_cselect_b32 s98, s98, s84
CV 52,232,233
CV 53,234,235
v_mul_f32 v25, v25, v26
v_mov_b32 v47, s98
v_mfma_f32_16x16x32_bf16 v[244:247], a[240:243], v[56:59], v[248:251]
s_lshl_b32 s9, s9, 2
CV 54,236,237
CV 55,238,239
v_mfma_f32_16x16x32_bf16 v[224:227], a[236:239], v[60:63], v[252:255]
LD 21,36,76,1024
CV 56,240,241
CV 57,242,243
v_mfma_f32_16x16x32_bf16 v[228:231], a[240:243], v[60:63], v[252:255]
s_add_u32 s9, s9, 0x300d000
CV 58,244,245
CV 59,246,247
v_sqrt_f32 v25, v25
v_mfma_f32_16x16x32_bf16 v[232:235], a[236:239], v[64:67], v[248:251]
s_lshr_b32 s24, s29, 10
CV 60,224,225
CV 61,226,227
v_mov_b32 v44, v25
v_mfma_f32_16x16x32_bf16 v[236:239], a[240:243], v[64:67], v[248:251]
buffer_store_dword v47, off, s[40:43], s9 sc1
CV 62,228,229
CV 63,230,231
v_mfma_f32_16x16x32_bf16 v[240:243], a[236:239], v[68:71], v[252:255]
s_add_u32 s24, s24, 0
CV 64,232,233
CV 65,234,235
v_mov_b32 v45, v25
v_mfma_f32_16x16x32_bf16 v[244:247], a[240:243], v[68:71], v[252:255]
s_mul_i32 s25, s24, 57
CV 66,236,237
CV 67,238,239
v_mfma_f32_16x16x32_bf16 v[224:227], a[236:239], v[72:75], v[248:251]
LD 22,36,76,2048
CV 68,240,241
CV 69,242,243
v_mfma_f32_16x16x32_bf16 v[228:231], a[240:243], v[72:75], v[248:251]
s_lshr_b32 s25, s25, 9
CV 70,244,245
CV 71,246,247
v_rcp_f32 v25, v25
v_mfma_f32_16x16x32_bf16 v[232:235], a[236:239], v[76:79], v[252:255]
s_lshl_b32 s25, s25, 2
CV 72,224,225
CV 73,226,227
v_mfma_f32_16x16x32_bf16 v[236:239], a[240:243], v[76:79], v[252:255]
s_lshr_b32 s25, 0x4031, s25
CV 74,228,229
CV 75,230,231
v_rsq_f32 v38, v26
v_mfma_f32_16x16x32_bf16 v[240:243], a[236:239], v[80:83], v[248:251]
s_and_b32 s25, s25, 7
CV 76,232,233
CV 77,234,235
v_mul_f32 v26, 0xc0135761, v25
v_mfma_f32_16x16x32_bf16 v[244:247], a[240:243], v[80:83], v[248:251]
s_sub_u32 s25, s25, 2
CV 78,236,237
CV 79,238,239
v_mul_f32 v25, v25, v25
v_mfma_f32_16x16x32_bf16 v[224:227], a[236:239], v[84:87], v[252:255]
s_sub_u32 s5, 32, s25
CV 80,240,241
CV 81,242,243
v_mul_f32 v25, 0x3d372713, v25
v_mfma_f32_16x16x32_bf16 v[228:231], a[240:243], v[84:87], v[252:255]
s_lshl_b32 s78, s25, 4
CV 82,244,245
CV 83,246,247
v_mul_f32 v36, v24, v38
v_mfma_f32_16x16x32_bf16 v[232:235], a[236:239], v[88:91], v[248:251]
LD 23,36,76,3072
CV 84,224,225
CV 85,226,227
v_mfma_f32_16x16x32_bf16 v[236:239], a[240:243], v[88:91], v[248:251]
s_add_u32 m0, s67, 0x13000
s_add_u32 s76, s95, 0x40200
CV 86,228,229
CV 87,230,231
v_mfma_f32_16x16x32_bf16 v[240:243], a[236:239], v[92:95], v[252:255]
s_mul_i32 s77, s100, 0x12000
CV 88,232,233
CV 89,234,235
v_min_u32 v46, 8, v1
v_mfma_f32_16x16x32_bf16 v[244:247], a[240:243], v[92:95], v[252:255]
s_mul_i32 s85, s66, 0x400
CV 90,236,237
CV 91,238,239
v_mul_u32_u24 v46, 0x2000, v46
v_mfma_f32_16x16x32_bf16 v[224:227], a[236:239], v[96:99], v[248:251]
s_add_u32 s77, s77, s85
CV 92,240,241
CV 93,242,243
v_mul_f32 v42, v26, v25
v_mfma_f32_16x16x32_bf16 v[228:231], a[240:243], v[96:99], v[248:251]
s_add_u32 s77, s77, 0x280
CV 94,244,245
CV 95,246,247
v_mov_b32 v40, v26
v_mfma_f32_16x16x32_bf16 v[232:235], a[236:239], v[100:103], v[252:255]
LD 20,36,76,0
CV 96,224,225
CV 97,226,227
v_mfma_f32_16x16x32_bf16 v[236:239], a[240:243], v[100:103], v[252:255]
s_sub_u32 s78, s29, s78
CV 98,228,229
CV 99,230,231
v_mov_b32 v41, v26
v_mfma_f32_16x16x32_bf16 v[240:243], a[236:239], v[104:107], v[248:251]
s_add_u32 s78, s78, 0x480200
CV 100,232,233
CV 101,234,235
v_mul_f32 v38, 0x3e0293ee, v38
v_mfma_f32_16x16x32_bf16 v[244:247], a[240:243], v[104:107], v[248:251]
s_sub_u32 s6, 48, s25
CV 102,236,237
CV 103,238,239
v_mov_b32 v39, v38
v_mfma_f32_16x16x32_bf16 v[224:227], a[236:239], v[108:111], v[252:255]
buffer_load_dword a253, v46, s[36:39], s77 offen
CV 104,240,241
CV 105,242,243
v_mfma_f32_16x16x32_bf16 v[228:231], a[240:243], v[108:111], v[252:255]
s_lshl_b32 s79, s25, 4
CV 106,244,245
CV 107,246,247
v_mov_b32 v37, v36
v_mfma_f32_16x16x32_bf16 v[232:235], a[236:239], v[112:115], v[248:251]
LD 21,36,76,1024
CV 108,224,225
CV 109,226,227
v_mfma_f32_16x16x32_bf16 v[236:239], a[240:243], v[112:115], v[248:251]
s_sub_u32 s79, s29, s79
CV 110,228,229
CV 111,230,231
v_mov_b32 v43, v42
v_mfma_f32_16x16x32_bf16 v[240:243], a[236:239], v[116:119], v[252:255]
s_add_u32 s79, s79, 0x480300
CV 112,232,233
CV 113,234,235
v_mfma_f32_16x16x32_bf16 v[244:247], a[240:243], v[116:119], v[252:255]
s_lshr_b32 s26, s29, 10
CV 114,236,237
CV 115,238,239
v_permlane32_swap_b32 v38, v39
v_mfma_f32_16x16x32_bf16 v[224:227], a[236:239], v[120:123], v[248:251]
s_add_u32 s26, s26, 2
CV 116,240,241
CV 117,242,243
v_mul_f32 v30, 0x40faf233, v38
v_mfma_f32_16x16x32_bf16 v[228:231], a[240:243], v[120:123], v[248:251]
s_mul_i32 s27, s26, 57
CV 118,244,245
CV 119,246,247
v_mfma_f32_16x16x32_bf16 v[232:235], a[236:239], v[124:127], v[252:255]
s_lshr_b32 s27, s27, 9
CV 120,224,225
CV 121,226,227
v_permlane32_swap_b32 v36, v37
v_mfma_f32_16x16x32_bf16 v[236:239], a[240:243], v[124:127], v[252:255]
s_lshl_b32 s27, s27, 2
CV 122,228,229
CV 123,230,231
v_mfma_f32_16x16x32_bf16 v[240:243], a[236:239], v[128:131], v[248:251]
LD 22,36,76,2048
CV 124,232,233
CV 125,234,235
v_mfma_f32_16x16x32_bf16 v[244:247], a[240:243], v[128:131], v[248:251]
s_lshr_b32 s27, 0x4031, s27
CV 126,236,237
CV 127,238,239
v_permlane32_swap_b32 v40, v41
v_mfma_f32_16x16x32_bf16 v[224:227], a[236:239], v[132:135], v[252:255]
s_and_b32 s27, s27, 7
CV 128,240,241
CV 129,242,243
v_mfma_f32_16x16x32_bf16 v[228:231], a[240:243], v[132:135], v[252:255]
s_sub_u32 s27, s27, 2
CV 130,244,245
CV 131,246,247
v_permlane32_swap_b32 v42, v43
v_mfma_f32_16x16x32_bf16 v[232:235], a[236:239], v[136:139], v[248:251]
s_waitcnt vmcnt(18)
s_barrier
CV 132,224,225
CV 133,226,227
v_mfma_f32_16x16x32_bf16 v[236:239], a[240:243], v[136:139], v[248:251]
s_sub_u32 s7, 32, s27
Ta 144,2,0
CV 134,228,229
CV 135,230,231
v_mfma_f32_16x16x32_bf16 v[240:243], a[236:239], v[140:143], v[252:255]
LD 23,36,76,3072
Ta 146,2,2048
s_add_u32 m0, s67, 0x14000
s_add_u32 s76, s95, 0x80200
v_mfma_f32_16x16x32_bf16 v[244:247], a[240:243], v[140:143], v[252:255]
s_lshl_b32 s80, s27, 4
Ta 148,3,0
CV 136,232,233
CV 137,234,235
v_mfma_f32_16x16x32_bf16 v[224:227], a[236:239], v[144:147], v[248:251]
s_sub_u32 s80, s29, s80
Ta 150,3,2048
CV 138,236,237
CV 139,238,239
v_mfma_f32_16x16x32_bf16 v[228:231], a[240:243], v[144:147], v[248:251]
s_add_u32 s80, s80, 0x480a00
Ta 152,4,0
CV 140,240,241
CV 141,242,243
v_mfma_f32_16x16x32_bf16 v[232:235], a[236:239], v[148:151], v[252:255]
s_sub_u32 s4, 48, s27
Ta 154,4,2048
CV 142,244,245
CV 143,246,247
v_mfma_f32_16x16x32_bf16 v[236:239], a[240:243], v[148:151], v[252:255]
s_lshl_b32 s81, s27, 4
Ta 156,5,0
CV 144,224,225
CV 145,226,227
v_mfma_f32_16x16x32_bf16 v[240:243], a[236:239], v[152:155], v[248:251]
LD 20,36,76,0
Ta 158,5,2048
v_mfma_f32_16x16x32_bf16 v[244:247], a[240:243], v[152:155], v[248:251]
s_add_u32 m0, s67, 0x1b000
Ta 160,2,4096
Ta 162,2,6144
CV 146,228,229
v_mfma_f32_16x16x32_bf16 v[224:227], a[236:239], v[156:159], v[252:255]
CV 147,230,231
Ta 164,3,4096
CV 148,232,233
v_mfma_f32_16x16x32_bf16 v[228:231], a[240:243], v[156:159], v[252:255]
CV 149,234,235
Ta 166,3,6144
CV 150,236,237
v_mfma_f32_16x16x32_bf16 v[232:235], a[236:239], v[160:163], v[248:251]
CV 151,238,239
Ta 168,4,4096
CV 152,240,241
v_mfma_f32_16x16x32_bf16 v[236:239], a[240:243], v[160:163], v[248:251]
CV 153,242,243
s_add_u32 s76, s95, 0x240200
Ta 170,4,6144
v_mfma_f32_16x16x32_bf16 v[240:243], a[236:239], v[164:167], v[252:255]
CV 154,244,245
CV 155,246,247
Ta 172,5,4096
v_mfma_f32_16x16x32_bf16 v[244:247], a[240:243], v[164:167], v[252:255]
CV 156,224,225
CV 157,226,227
Ta 174,5,6144
v_mfma_f32_16x16x32_bf16 v[224:227], a[236:239], v[168:171], v[248:251]
CV 158,228,229
CV 159,230,231
Ta 176,2,8192
v_mfma_f32_16x16x32_bf16 v[228:231], a[240:243], v[168:171], v[248:251]
CV 160,232,233
CV 161,234,235
Ta 178,2,10240
v_mfma_f32_16x16x32_bf16 v[232:235], a[236:239], v[172:175], v[252:255]
CV 162,236,237
CV 163,238,239
CV 164,240,241
v_mfma_f32_16x16x32_bf16 v[236:239], a[240:243], v[172:175], v[252:255]
CV 165,242,243
CV 166,244,245
CV 167,246,247
v_mfma_f32_16x16x32_bf16 v[240:243], a[236:239], v[176:179], v[248:251]
s_sub_u32 s81, s29, s81
CV 168,224,225
CV 169,226,227
CV 170,228,229
v_mfma_f32_16x16x32_bf16 v[244:247], a[240:243], v[176:179], v[248:251]
s_add_u32 s81, s81, 0x480b00
CV 171,230,231
CV 172,232,233
CV 173,234,235
v_mfma_f32_16x16x32_bf16 v[224:227], a[236:239], v[180:183], v[252:255]
s_lshl2_add_u32 s10, s66, s99
CV 174,236,237
CV 175,238,239
CV 176,240,241
v_mfma_f32_16x16x32_bf16 v[228:231], a[240:243], v[180:183], v[252:255]
s_add_u32 s10, s10, 0
CV 177,242,243
CV 178,244,245
CV 179,246,247
v_mfma_f32_16x16x32_bf16 v[232:235], a[236:239], v[184:187], v[248:251]
s_lshl2_add_u32 s11, s66, s99
v_permlane32_swap_b32 v44, v45
CV 180,224,225
v_mfma_f32_16x16x32_bf16 v[236:239], a[240:243], v[184:187], v[248:251]
s_add_u32 s11, s11, 0x2000
CV 181,226,227
CV 182,228,229
CV 183,230,231
v_mfma_f32_16x16x32_bf16 v[240:243], a[236:239], v[188:191], v[252:255]
s_lshl2_add_u32 s8, s66, s99
CV 184,232,233
CV 185,234,235
v_mfma_f32_16x16x32_bf16 v[244:247], a[240:243], v[188:191], v[252:255]
s_waitcnt lgkmcnt(0)
s_add_u32 s8, s8, 0x4000
CV 186,236,237
CV 187,238,239
v_mfma_f32_16x16x32_bf16 v[192:195], a[144:147], v[48:51], 0
s_add_u32 s12, s74, 0x400
s_add_u32 s23, s66, 1
CV 188,240,241
CV 189,242,243
v_mfma_f32_16x16x32_bf16 v[200:203], a[144:147], v[52:55], 0
s_and_b32 s23, s23, 7
Ta 144,3,8192
Ta 146,3,10240
v_mfma_f32_16x16x32_bf16 v[196:199], a[148:151], v[48:51], 0
LD 20,36,76,0
CV 190,244,245
CV 191,246,247
v_mfma_f32_16x16x32_bf16 v[204:207], a[148:151], v[52:55], 0
s_lshl_b32 s23, s23, 7
Ta 148,4,8192
Ta 150,4,10240
v_mfma_f32_16x16x32_bf16 v[208:211], a[152:155], v[48:51], 0
s_add_u32 s23, s23, s74
v_accvgpr_read_b32 v24, a180
v_accvgpr_read_b32 v25, a181
v_mfma_f32_16x16x32_bf16 v[216:219], a[152:155], v[52:55], 0
s_add_u32 s16, s66, 0
Ta 152,5,8192
Ta 154,5,10240
v_mfma_f32_16x16x32_bf16 v[212:215], a[156:159], v[48:51], 0
s_mul_i32 s77, s100, 0x2880
v_min_u32 v46, 8, v1
v_accvgpr_read_b32 v26, a182
v_mfma_f32_16x16x32_bf16 v[220:223], a[156:159], v[52:55], 0
s_mul_i32 s85, s66, 0x80
Ta 156,2,12288
Ta 158,2,14336
Mvav 192,160,56
LD 21,36,76,1024
v_mul_u32_u24 v46, 0x480, v46
Mvav 200,160,60
s_add_u32 s77, s77, s85
Ta 160,3,12288
Ta 162,3,14336
Mvav 196,164,56
s_mul_i32 s13, s94, 0x88000
v_permlane16_swap_b32 v24, v26
v_accvgpr_read_b32 v27, a183
Mvav 204,164,60
s_and_b32 s16, s16, 7
Ta 164,4,12288
Ta 166,4,14336
Mvav 208,168,56
buffer_load_dword a255, v46, s[48:51], s77 offen
s_add_u32 s13, s13, 0x800000
Mvav 216,168,60
s_lshl2_add_u32 s9, s66, s99
Ta 168,5,12288
Ta 170,5,14336
Mvav 212,172,56
LD 22,36,76,2048
s_add_u32 s9, s9, 0x6000
Mvav 220,172,60
s_add_u32 s17, s66, 1
Ta 172,2,16384
Ta 174,2,18432
Mvav 192,176,64
s_and_b32 s17, s17, 7
v_permlane16_swap_b32 v25, v27
Mvav 200,176,68
s_waitcnt lgkmcnt(6)
s_lshl_b32 s14, s94, 3
Ta 176,3,16384
Ta 178,3,18432
Mvav 196,144,64
s_add_u32 s14, s14, s66
v_permlane32_swap_b32 v24, v26
Mvav 204,144,68
s_mul_i32 s19, s14, 0x11000
Ta 144,4,16384
Ta 146,4,18432
Mvav 208,148,64
LD 23,36,76,3072
v_accvgpr_write_b32 a180, v24
Mvav 216,148,68
s_add_u32 m0, s67, 0x1c000
Ta 148,5,16384
Ta 150,5,18432
Mvav 212,152,64
s_add_u32 s76, s95, 0x280200
v_permlane32_swap_b32 v25, v27
Mvav 220,152,68
s_add_u32 s19, s19, 0x800000
Ta 152,2,20480
Ta 154,2,22528
Mvav 192,156,72
s_add_u32 s18, s75, 0x4800
v_accvgpr_write_b32 a181, v25
v_lshlrev_b32 v28, 16, v24
Mvav 200,156,76
Ta 156,3,20480
Ta 158,3,22528
Mvav 196,160,72
LD 20,36,76,0
v_lshlrev_b32 v29, 16, v25
v_and_b32 v24, s90, v24
Mvav 204,160,76
s_waitcnt lgkmcnt(6)
Ta 160,4,20480
Ta 162,4,22528
Mvav 208,164,72
v_and_b32 v25, s90, v25
v_fma_f32 v28, v28, v30, v36
Mvav 216,164,76
Ta 164,5,20480
Ta 166,5,22528
Mvav 212,168,72
v_fma_f32 v24, v24, v30, v36
v_fma_f32 v29, v29, v30, v36
Mvav 220,168,76
Ta 168,2,24576
Ta 170,2,26624
Mvav 192,172,80
LD 21,36,76,1024
v_fma_f32 v25, v25, v30, v36
Mvav 200,172,84
Ta 172,3,24576
Ta 174,3,26624
Mvav 196,176,80
CV 24,28,24
CV 25,29,25
v_accvgpr_write_b32 a182, v26
Mvav 204,176,84
Ta 176,4,24576
Ta 178,4,26624
Mvav 208,144,80
v_accvgpr_write_b32 a183, v27
v_lshlrev_b32 v28, 16, v26
Mvav 216,144,84
s_waitcnt lgkmcnt(6)
Ta 144,5,24576
Ta 146,5,26624
Mvav 212,148,80
LD 22,36,76,2048
v_lshlrev_b32 v29, 16, v27
Mvav 220,148,84
Ta 148,2,28672
Ta 150,2,30720
Mvav 192,152,88
v_and_b32 v26, s90, v26
v_and_b32 v27, s90, v27
Mvav 200,152,92
Ta 152,3,28672
Ta 154,3,30720
Mvav 196,156,88
v_fma_f32 v28, v28, v30, v36
v_fma_f32 v26, v26, v30, v36
v_fma_f32 v29, v29, v30, v36
Mvav 204,156,92
Ta 156,4,28672
Ta 158,4,30720
Mvav 208,160,88
LD 23,36,76,3072
v_fma_f32 v27, v27, v30, v36
Mvav 216,160,92
s_add_u32 m0, s67, 0x1d000
Ta 160,5,28672
Ta 162,5,30720
Mvav 212,164,88
s_add_u32 s76, s95, 0x2c0200
CV 26,28,26
CV 27,29,27
Mvav 220,164,92
s_waitcnt lgkmcnt(6)
Ta 164,2,32768
Ta 166,2,34816
Mvav 192,168,96
L_pg0_2:
s_cbranch_execz L_ret0
v_add_u32 v2, 0x9000, v2
v_accvgpr_write_b32 a236, v24
Mvav 200,168,100
Ta 168,3,32768
Ta 170,3,34816
Mvav 196,172,96
LD 20,36,76,0
v_add_u32 v3, 0x9000, v3
v_accvgpr_write_b32 a237, v25
Mvav 204,172,100
s_add_u32 m0, s67, 0
Ta 172,4,32768
Ta 174,4,34816
Mvav 208,176,96
s_add_u32 s76, s95, 0x280
v_add_u32 v4, 0x9000, v4
v_accvgpr_write_b32 a238, v26
Mvav 216,176,100
Ta 176,5,32768
Ta 178,5,34816
Mvav 212,144,96
v_add_u32 v5, 0x9000, v5
v_accvgpr_write_b32 a239, v27
Mvav 220,144,100
v_accvgpr_read_b32 v24, a184
v_accvgpr_read_b32 v25, a185
v_accvgpr_read_b32 v26, a186
Mvav 192,148,104
v_accvgpr_read_b32 v27, a187
v_permlane16_swap_b32 v24, v26
Mvav 200,148,108
s_waitcnt lgkmcnt(4)
v_permlane16_swap_b32 v25, v27
Mvav 196,152,104
v_permlane32_swap_b32 v24, v26
v_permlane32_swap_b32 v25, v27
Mvav 204,152,108
s_waitcnt vmcnt(21) lgkmcnt(0)
s_barrier
v_accvgpr_write_b32 a184, v24
v_accvgpr_write_b32 a185, v25
Mvav 208,156,104
Ta 144,2,0
Ta 146,2,2048
Mvav 216,156,108
Ta 148,3,0
Ta 150,3,2048
Mvav 212,160,104
Ta 152,4,0
Ta 154,4,2048
Mvav 220,160,108
Ta 156,5,0
Ta 158,5,2048
Mvav 192,164,112
Ta 160,2,4096
Ta 162,2,6144
Mvav 200,164,116
Ta 164,3,4096
Ta 166,3,6144
Mvav 196,168,112
v_lshlrev_b32 v28, 16, v24
v_lshlrev_b32 v29, 16, v25
v_mul_f32 v30, 0x40faf233, v39
Mvav 204,168,116
Ta 168,4,4096
Ta 170,4,6144
Mvav 208,172,112
v_and_b32 v24, s90, v24
v_and_b32 v25, s90, v25
Mvav 216,172,116
Ta 172,5,4096
Ta 174,5,6144
Mvav 212,176,112
v_fma_f32 v28, v28, v30, v37
v_fma_f32 v24, v24, v30, v37
Mvav 220,176,116
s_waitcnt lgkmcnt(8)
Ta 176,2,8192
Ta 178,2,10240
Mvav 192,144,120
v_fma_f32 v29, v29, v30, v37
v_fma_f32 v25, v25, v30, v37
Mvav 200,144,124
Ta 144,3,8192
Ta 146,3,10240
Mvav 196,148,120
LD 20,36,76,0
CV 24,28,24
CV 25,29,25
Mvav 204,148,124
Ta 148,4,8192
Ta 150,4,10240
Mvav 208,152,120
v_accvgpr_write_b32 a186, v26
v_accvgpr_write_b32 a187, v27
Mvav 216,152,124
Ta 152,5,8192
Ta 154,5,10240
Mvav 212,156,120
v_lshlrev_b32 v28, 16, v26
v_lshlrev_b32 v29, 16, v27
Mvav 220,156,124
s_waitcnt lgkmcnt(6)
Ta 156,2,12288
Ta 158,2,14336
Mvav 192,160,128
LD 21,36,76,1024
v_and_b32 v26, s90, v26
Mvav 200,160,132
Ta 160,3,12288
Ta 162,3,14336
Mvav 196,164,128
v_and_b32 v27, s90, v27
v_fma_f32 v28, v28, v30, v37
v_fma_f32 v26, v26, v30, v37
Mvav 204,164,132
Ta 164,4,12288
Ta 166,4,14336
Mvav 208,168,128
v_fma_f32 v29, v29, v30, v37
v_fma_f32 v27, v27, v30, v37
Mvav 216,168,132
Ta 168,5,12288
Ta 170,5,14336
Mvav 212,172,128
LD 22,36,76,2048
CV 26,28,26
Mvav 220,172,132
Ta 172,2,16384
Ta 174,2,18432
Mvav 192,176,136
CV 27,29,27
v_accvgpr_write_b32 a240, v24
Mvav 200,176,140
s_waitcnt lgkmcnt(6)
Ta 176,3,16384
Ta 178,3,18432
Mvav 196,144,136
v_accvgpr_write_b32 a241, v25
v_accvgpr_write_b32 a242, v26
v_accvgpr_write_b32 a243, v27
Mvav 204,144,140
Ta 144,4,16384
Ta 146,4,18432
Mvav 208,148,136
LD 23,36,76,3072
v_accvgpr_read_b32 v24, a188
Mvav 216,148,140
s_add_u32 m0, s67, 0x1000
Ta 148,5,16384
Ta 150,5,18432
Mvav 212,152,136
s_add_u32 s76, s95, 0x40280
v_accvgpr_read_b32 v25, a189
v_accvgpr_read_b32 v26, a190
Mvav 220,152,140
Ta 152,2,20480
Ta 154,2,22528
Mvav 192,156,144
v_accvgpr_read_b32 v27, a191
v_permlane16_swap_b32 v24, v26
Mvav 200,156,148
Ta 156,3,20480
Ta 158,3,22528
Mvav 196,160,144
LD 20,36,76,0
v_permlane16_swap_b32 v25, v27
Mvav 204,160,148
s_waitcnt lgkmcnt(6)
Ta 160,4,20480
Ta 162,4,22528
Mvav 208,164,144
v_permlane32_swap_b32 v24, v26
Mvav 216,164,148
Ta 164,5,20480
Ta 166,5,22528
Mvav 212,168,144
v_permlane32_swap_b32 v25, v27
Mvav 220,168,148
Ta 168,2,24576
Ta 170,2,26624
Mvav 192,172,152
LD 21,36,76,1024
v_accvgpr_write_b32 a188, v24
Mvav 200,172,156
Ta 172,3,24576
Ta 174,3,26624
Mvav 196,176,152
v_accvgpr_write_b32 a189, v25
v_lshlrev_b32 v28, 16, v24
v_lshlrev_b32 v29, 16, v25
Mvav 204,176,156
Ta 176,4,24576
Ta 178,4,26624
Mvav 208,144,152
v_mul_f32 v30, 0x40faf233, v38
v_and_b32 v24, s90, v24
Mvav 216,144,156
s_waitcnt lgkmcnt(6)
Ta 144,5,24576
Ta 146,5,26624
Mvav 212,148,152
LD 22,36,76,2048
v_and_b32 v25, s90, v25
Mvav 220,148,156
Ta 148,2,28672
Ta 150,2,30720
Mvav 192,152,160
v_fma_f32 v28, v28, v30, v36
v_fma_f32 v24, v24, v30, v36
Mvav 200,152,164
Ta 152,3,28672
Ta 154,3,30720
Mvav 196,156,160
v_fma_f32 v29, v29, v30, v36
v_fma_f32 v25, v25, v30, v36
CV 24,28,24
Mvav 204,156,164
Ta 156,4,28672
Ta 158,4,30720
Mvav 208,160,160
LD 23,36,76,3072
CV 25,29,25
Mvav 216,160,164
s_add_u32 m0, s67, 0x2000
Ta 160,5,28672
Ta 162,5,30720
Mvav 212,164,160
s_add_u32 s76, s95, 0x80280
v_accvgpr_write_b32 a190, v26
v_accvgpr_write_b32 a191, v27
Mvav 220,164,164
s_waitcnt lgkmcnt(6)
Ta 164,2,32768
Ta 166,2,34816
Mvav 192,168,168
v_lshlrev_b32 v28, 16, v26
v_lshlrev_b32 v29, 16, v27
Mvav 200,168,172
Ta 168,3,32768
Ta 170,3,34816
Mvav 196,172,168
LD 20,36,76,0
v_and_b32 v26, s90, v26
v_and_b32 v27, s90, v27
Mvav 204,172,172
s_add_u32 m0, s67, 0x9000
Ta 172,4,32768
Ta 174,4,34816
Mvav 208,176,168
s_add_u32 s76, s95, 0x240280
v_fma_f32 v28, v28, v30, v36
v_fma_f32 v26, v26, v30, v36
Mvav 216,176,172
Ta 176,5,32768
Ta 178,5,34816
Mvav 212,144,168
v_fma_f32 v29, v29, v30, v36
v_fma_f32 v27, v27, v30, v36
Mvav 220,144,172
CV 26,28,26
CV 27,29,27
v_accvgpr_write_b32 a244, v24
Mvav 192,148,176
v_accvgpr_write_b32 a245, v25
v_accvgpr_write_b32 a246, v26
Mvav 200,148,180
s_waitcnt lgkmcnt(4)
v_accvgpr_write_b32 a247, v27
v_accvgpr_read_b32 v24, a192
Mvav 196,152,176
v_accvgpr_read_b32 v25, a193
v_accvgpr_read_b32 v26, a194
v_accvgpr_read_b32 v27, a195
Mvav 204,152,180
s_waitcnt vmcnt(19) lgkmcnt(0)
s_barrier
v_permlane16_swap_b32 v24, v26
Mvav 208,156,176
v_permlane16_swap_b32 v25, v27
Mvav 216,156,180
v_permlane32_swap_b32 v24, v26
v_permlane32_swap_b32 v25, v27
Mvav 212,160,176
v_accvgpr_write_b32 a192, v24
v_accvgpr_write_b32 a193, v25
Mvav 220,160,180
v_lshlrev_b32 v28, 16, v24
v_lshlrev_b32 v29, 16, v25
v_mul_f32 v30, 0x40faf233, v39
Mvav 192,164,184
v_and_b32 v24, s90, v24
v_and_b32 v25, s90, v25
Mvav 200,164,188
v_fma_f32 v28, v28, v30, v37
v_fma_f32 v24, v24, v30, v37
Mvav 196,168,184
v_fma_f32 v29, v29, v30, v37
v_fma_f32 v25, v25, v30, v37
CV 24,28,24
Mvav 204,168,188
CV 25,29,25
v_accvgpr_write_b32 a194, v26
Mvav 208,172,184
v_accvgpr_write_b32 a195, v27
v_lshlrev_b32 v28, 16, v26
Mvav 216,172,188
v_lshlrev_b32 v29, 16, v27
v_and_b32 v26, s90, v26
v_and_b32 v27, s90, v27
Mvav 212,176,184
v_fma_f32 v28, v28, v30, v37
v_fma_f32 v26, v26, v30, v37
Mvav 220,176,188
v_fma_f32 v29, v29, v30, v37
v_fma_f32 v27, v27, v30, v37
CV 26,28,26
CV 27,29,27
v_pk_mul_f32 v[28:29], v[196:197], v[196:197]
v_accvgpr_write_b32 a248, v24
v_pk_fma_f32 v[28:29], v[28:29], v[42:43], v[40:41] op_sel:[0,0,0] op_sel_hi:[1,0,0]
v_accvgpr_write_b32 a249, v25
v_pk_mul_f32 v[28:29], v[196:197], v[28:29]
v_accvgpr_write_b32 a250, v26
v_accvgpr_write_b32 a251, v27
v_exp_f32 v28, v28
v_exp_f32 v29, v29
v_pk_mul_f32 v[24:25], v[192:193], v[192:193]
v_pk_mul_f32 v[26:27], v[194:195], v[194:195]
v_pk_mul_f32 v[18:19], v[198:199], v[198:199]
v_pk_fma_f32 v[24:25], v[24:25], v[42:43], v[40:41] op_sel:[0,0,0] op_sel_hi:[1,0,0]
v_pk_fma_f32 v[26:27], v[26:27], v[42:43], v[40:41] op_sel:[0,0,0] op_sel_hi:[1,0,0]
v_pk_fma_f32 v[18:19], v[18:19], v[42:43], v[40:41] op_sel:[0,0,0] op_sel_hi:[1,0,0]
v_pk_fma_f32 v[28:29], v[28:29], v[44:45], v[44:45] op_sel:[0,0,0] op_sel_hi:[1,0,0]
v_pk_mul_f32 v[24:25], v[192:193], v[24:25]
v_pk_mul_f32 v[26:27], v[194:195], v[26:27]
v_pk_mul_f32 v[18:19], v[198:199], v[18:19]
v_rcp_f32 v28, v28
v_rcp_f32 v29, v29
v_exp_f32 v24, v24
v_exp_f32 v25, v25
v_exp_f32 v26, v26
v_exp_f32 v27, v27
v_exp_f32 v18, v18
v_exp_f32 v19, v19
v_pk_mul_f32 v[28:29], v[196:197], v[28:29]
v_and_b32 v197, 15, v1
v_pk_fma_f32 v[24:25], v[24:25], v[44:45], v[44:45] op_sel:[0,0,0] op_sel_hi:[1,0,0]
v_pk_fma_f32 v[26:27], v[26:27], v[44:45], v[44:45] op_sel:[0,0,0] op_sel_hi:[1,0,0]
v_pk_fma_f32 v[18:19], v[18:19], v[44:45], v[44:45] op_sel:[0,0,0] op_sel_hi:[1,0,0]
v_add_u32 v196, s5, v197
v_rcp_f32 v24, v24
v_rcp_f32 v25, v25
v_rcp_f32 v26, v26
v_rcp_f32 v27, v27
v_rcp_f32 v18, v18
v_rcp_f32 v19, v19
v_lshrrev_b32 v196, 5, v196
v_pk_mul_f32 v[24:25], v[192:193], v[24:25]
v_pk_mul_f32 v[26:27], v[194:195], v[26:27]
v_pk_mul_f32 v[18:19], v[198:199], v[18:19]
v_mul_u32_u24 v196, 0x8e00, v196
CV 192,24,25
CV 193,26,27
CV 194,28,29
CV 195,18,19
v_add_u32 v196, v196, v6
v_pk_mul_f32 v[26:27], v[204:205], v[204:205]
s_cmp_eq_u32 s24, 8
s_cbranch_scc1 L_hss46
buffer_store_dwordx4 v[192:195], v196, s[40:43], s78 offen sc1
L_hs46:
v_pk_fma_f32 v[26:27], v[26:27], v[42:43], v[40:41] op_sel:[0,1,1] op_sel_hi:[1,1,1]
v_pk_mul_f32 v[16:17], v[200:201], v[200:201]
v_pk_mul_f32 v[26:27], v[204:205], v[26:27]
v_pk_mul_f32 v[24:25], v[202:203], v[202:203]
v_exp_f32 v26, v26
v_exp_f32 v27, v27
v_pk_mul_f32 v[28:29], v[206:207], v[206:207]
v_pk_fma_f32 v[16:17], v[16:17], v[42:43], v[40:41] op_sel:[0,1,1] op_sel_hi:[1,1,1]
v_pk_fma_f32 v[24:25], v[24:25], v[42:43], v[40:41] op_sel:[0,1,1] op_sel_hi:[1,1,1]
v_pk_fma_f32 v[28:29], v[28:29], v[42:43], v[40:41] op_sel:[0,1,1] op_sel_hi:[1,1,1]
v_pk_fma_f32 v[26:27], v[26:27], v[44:45], v[44:45] op_sel:[0,1,1] op_sel_hi:[1,1,1]
v_pk_mul_f32 v[16:17], v[200:201], v[16:17]
v_pk_mul_f32 v[24:25], v[202:203], v[24:25]
v_pk_mul_f32 v[28:29], v[206:207], v[28:29]
v_rcp_f32 v26, v26
v_rcp_f32 v27, v27
v_exp_f32 v16, v16
v_exp_f32 v17, v17
v_exp_f32 v24, v24
v_exp_f32 v25, v25
v_exp_f32 v28, v28
v_exp_f32 v29, v29
v_pk_mul_f32 v[26:27], v[204:205], v[26:27]
v_and_b32 v205, 15, v1
v_pk_fma_f32 v[16:17], v[16:17], v[44:45], v[44:45] op_sel:[0,1,1] op_sel_hi:[1,1,1]
v_pk_fma_f32 v[24:25], v[24:25], v[44:45], v[44:45] op_sel:[0,1,1] op_sel_hi:[1,1,1]
v_pk_fma_f32 v[28:29], v[28:29], v[44:45], v[44:45] op_sel:[0,1,1] op_sel_hi:[1,1,1]
v_add_u32 v204, s6, v205
v_rcp_f32 v16, v16
v_rcp_f32 v17, v17
v_rcp_f32 v24, v24
v_rcp_f32 v25, v25
v_rcp_f32 v28, v28
v_rcp_f32 v29, v29
v_lshrrev_b32 v204, 5, v204
v_pk_mul_f32 v[16:17], v[200:201], v[16:17]
v_pk_mul_f32 v[24:25], v[202:203], v[24:25]
v_pk_mul_f32 v[28:29], v[206:207], v[28:29]
v_mul_u32_u24 v204, 0x8e00, v204
CV 200,16,17
CV 201,24,25
CV 202,26,27
CV 203,28,29
v_add_u32 v204, v204, v6
v_pk_mul_f32 v[24:25], v[212:213], v[212:213]
s_cmp_eq_u32 s24, 8
s_cbranch_scc1 L_hss47
buffer_store_dwordx4 v[200:203], v204, s[40:43], s79 offen sc1
L_hs47:
v_pk_fma_f32 v[24:25], v[24:25], v[42:43], v[40:41] op_sel:[0,0,0] op_sel_hi:[1,0,0]
v_pk_mul_f32 v[18:19], v[208:209], v[208:209]
v_pk_mul_f32 v[24:25], v[212:213], v[24:25]
v_pk_mul_f32 v[16:17], v[210:211], v[210:211]
v_exp_f32 v24, v24
v_exp_f32 v25, v25
v_pk_mul_f32 v[26:27], v[214:215], v[214:215]
v_pk_fma_f32 v[18:19], v[18:19], v[42:43], v[40:41] op_sel:[0,0,0] op_sel_hi:[1,0,0]
v_pk_fma_f32 v[16:17], v[16:17], v[42:43], v[40:41] op_sel:[0,0,0] op_sel_hi:[1,0,0]
v_pk_fma_f32 v[26:27], v[26:27], v[42:43], v[40:41] op_sel:[0,0,0] op_sel_hi:[1,0,0]
v_pk_fma_f32 v[24:25], v[24:25], v[44:45], v[44:45] op_sel:[0,0,0] op_sel_hi:[1,0,0]
v_pk_mul_f32 v[18:19], v[208:209], v[18:19]
v_pk_mul_f32 v[16:17], v[210:211], v[16:17]
v_pk_mul_f32 v[26:27], v[214:215], v[26:27]
v_rcp_f32 v24, v24
v_rcp_f32 v25, v25
v_exp_f32 v18, v18
v_exp_f32 v19, v19
v_exp_f32 v16, v16
v_exp_f32 v17, v17
v_exp_f32 v26, v26
v_exp_f32 v27, v27
v_pk_mul_f32 v[24:25], v[212:213], v[24:25]
v_and_b32 v213, 15, v1
v_pk_fma_f32 v[18:19], v[18:19], v[44:45], v[44:45] op_sel:[0,0,0] op_sel_hi:[1,0,0]
v_pk_fma_f32 v[16:17], v[16:17], v[44:45], v[44:45] op_sel:[0,0,0] op_sel_hi:[1,0,0]
v_pk_fma_f32 v[26:27], v[26:27], v[44:45], v[44:45] op_sel:[0,0,0] op_sel_hi:[1,0,0]
v_add_u32 v212, s7, v213
v_rcp_f32 v18, v18
v_rcp_f32 v19, v19
v_rcp_f32 v16, v16
v_rcp_f32 v17, v17
v_rcp_f32 v26, v26
v_rcp_f32 v27, v27
v_lshrrev_b32 v212, 5, v212
v_pk_mul_f32 v[18:19], v[208:209], v[18:19]
v_pk_mul_f32 v[16:17], v[210:211], v[16:17]
v_pk_mul_f32 v[26:27], v[214:215], v[26:27]
v_mul_u32_u24 v212, 0x8e00, v212
CV 208,18,19
CV 209,16,17
CV 210,24,25
CV 211,26,27
v_add_u32 v212, v212, v6
v_pk_mul_f32 v[16:17], v[220:221], v[220:221]
s_cmp_eq_u32 s26, 26
s_cbranch_scc1 L_hss48
buffer_store_dwordx4 v[208:211], v212, s[40:43], s80 offen sc1
L_hs48:
v_pk_fma_f32 v[16:17], v[16:17], v[42:43], v[40:41] op_sel:[0,1,1] op_sel_hi:[1,1,1]
v_pk_mul_f32 v[28:29], v[216:217], v[216:217]
v_pk_mul_f32 v[16:17], v[220:221], v[16:17]
v_pk_mul_f32 v[18:19], v[218:219], v[218:219]
v_exp_f32 v16, v16
v_exp_f32 v17, v17
v_pk_mul_f32 v[24:25], v[222:223], v[222:223]
v_pk_fma_f32 v[28:29], v[28:29], v[42:43], v[40:41] op_sel:[0,1,1] op_sel_hi:[1,1,1]
v_pk_fma_f32 v[18:19], v[18:19], v[42:43], v[40:41] op_sel:[0,1,1] op_sel_hi:[1,1,1]
v_pk_fma_f32 v[24:25], v[24:25], v[42:43], v[40:41] op_sel:[0,1,1] op_sel_hi:[1,1,1]
v_pk_fma_f32 v[16:17], v[16:17], v[44:45], v[44:45] op_sel:[0,1,1] op_sel_hi:[1,1,1]
v_pk_mul_f32 v[28:29], v[216:217], v[28:29]
v_pk_mul_f32 v[18:19], v[218:219], v[18:19]
v_pk_mul_f32 v[24:25], v[222:223], v[24:25]
v_rcp_f32 v16, v16
v_rcp_f32 v17, v17
v_exp_f32 v28, v28
v_exp_f32 v29, v29
v_exp_f32 v18, v18
v_exp_f32 v19, v19
v_exp_f32 v24, v24
v_exp_f32 v25, v25
v_pk_mul_f32 v[16:17], v[220:221], v[16:17]
v_and_b32 v221, 15, v1
v_pk_fma_f32 v[28:29], v[28:29], v[44:45], v[44:45] op_sel:[0,1,1] op_sel_hi:[1,1,1]
v_pk_fma_f32 v[18:19], v[18:19], v[44:45], v[44:45] op_sel:[0,1,1] op_sel_hi:[1,1,1]
v_pk_fma_f32 v[24:25], v[24:25], v[44:45], v[44:45] op_sel:[0,1,1] op_sel_hi:[1,1,1]
v_add_u32 v220, s4, v221
v_rcp_f32 v28, v28
v_rcp_f32 v29, v29
v_rcp_f32 v18, v18
v_rcp_f32 v19, v19
v_rcp_f32 v24, v24
v_rcp_f32 v25, v25
v_lshrrev_b32 v220, 5, v220
v_pk_mul_f32 v[28:29], v[216:217], v[28:29]
v_pk_mul_f32 v[18:19], v[218:219], v[18:19]
v_pk_mul_f32 v[24:25], v[222:223], v[24:25]
v_mul_u32_u24 v220, 0x8e00, v220
CV 216,28,29
CV 217,18,19
CV 218,16,17
CV 219,24,25
v_add_u32 v220, v220, v6
v_add_u32 v2, 0x9000, v2
s_cmp_eq_u32 s26, 26
s_cbranch_scc1 L_hss49
buffer_store_dwordx4 v[216:219], v220, s[40:43], s81 offen sc1
L_hs49:
Ta 144,2,0
Ta 146,2,2048
s_waitcnt lgkmcnt(0)
Ta 160,2,4096
Ta 162,2,6144
v_add_u32 v3, 0x9000, v3
v_add_u32 v4, 0x9000, v4
v_add_u32 v5, 0x9000, v5
v_lshrrev_b32 v17, 4, v1
v_and_b32 v16, 15, v1
v_min_u32 v17, 2, v17
v_min_u32 v16, 9, v16
v_add_u32 v17, s94, v17
v_lshlrev_b32 v18, 3, v1
v_max_u32 v17, 1, v17
v_mov_b32 v36, v7
v_subrev_u32 v17, 1, v17
v_add_u32 v36, 0x12000, v36
v_min_u32 v17, 63, v17
Ta 148,3,0
Ta 150,3,2048
v_lshlrev_b32 v17, 7, v17
v_lshl_add_u32 v16, v16, 2, v17
v_mfma_f32_16x16x32_bf16 v[224:227], a[144:147], v[48:51], 0
s_mov_b32 s5, 0x489000
Ta 152,4,0
Ta 154,4,2048
v_mfma_f32_16x16x32_bf16 v[232:235], a[144:147], v[52:55], 0
s_waitcnt lgkmcnt(2)
s_add_u32 s78, s101, 0x4000
Ta 156,5,0
Ta 158,5,2048
v_add_u32 v16, 0x3000000, v16
Ta 164,3,4096
Ta 166,3,6144
s_mov_b32 s6, 0x48a000
s_mov_b32 s7, 0x48b000
s_mov_b32 s4, 0x48c000
s_add_u32 s79, s101, 0x5000
s_add_u32 s80, s29, 0x240000
s_lshl_b32 s81, s94, 4
v_mfma_f32_16x16x32_bf16 v[228:231], a[148:151], v[48:51], 0
LD 20,36,76,0
Ta 168,4,4096
v_mfma_f32_16x16x32_bf16 v[236:239], a[148:151], v[52:55], 0
s_waitcnt lgkmcnt(5)
s_add_u32 s81, s81, s66
Ta 170,4,6144
Ta 172,5,4096
s_lshl_b32 s81, s81, 9
v_mfma_f32_16x16x32_bf16 v[240:243], a[152:155], v[48:51], 0
s_add_u32 s81, s81, 0x720000
Ta 174,5,6144
s_mov_b32 s24, 0xc09d30fc
v_mfma_f32_16x16x32_bf16 v[248:251], a[152:155], v[52:55], 0
s_waitcnt lgkmcnt(6)
s_mov_b32 s25, 0x3eeff558
Ta 176,2,8192
v_mfma_f32_16x16x32_bf16 v[244:247], a[156:159], v[48:51], 0
s_mul_i32 s77, s100, 0x12000
Ta 178,2,10240
v_min_u32 v46, 8, v1
v_mfma_f32_16x16x32_bf16 v[252:255], a[156:159], v[52:55], 0
s_mul_i32 s85, s66, 0x400
Ta 144,3,8192
v_mul_u32_u24 v46, 0x2000, v46
Mvav 224,160,56
LD 21,36,76,1024
Ta 146,3,10240
Mvav 232,160,60
s_waitcnt lgkmcnt(8)
s_add_u32 s77, s77, s85
Ta 148,4,8192
s_add_u32 s77, s77, 0x300
Mvav 228,164,56
Ta 150,4,10240
L_pg0_3:
s_cbranch_execz L_ret0
Mvav 236,164,60
s_waitcnt lgkmcnt(8)
Ta 152,5,8192
Mvav 240,168,56
buffer_load_dword a255, v46, s[36:39], s77 offen
Ta 154,5,10240
Mvav 248,168,60
s_waitcnt lgkmcnt(8)
Ta 156,2,12288
Ta 158,2,14336
Mvav 244,172,56
LD 22,36,76,2048
Ta 160,3,12288
Mvav 252,172,60
s_waitcnt lgkmcnt(9)
Ta 162,3,14336
Mvav 224,176,64
Ta 164,4,12288
Mvav 232,176,68
s_waitcnt lgkmcnt(9)
Ta 166,4,14336
Mvav 228,144,64
Ta 168,5,12288
Mvav 236,144,68
s_waitcnt lgkmcnt(9)
Ta 170,5,14336
Mvav 240,148,64
LD 23,36,76,3072
Ta 172,2,16384
Mvav 248,148,68
s_waitcnt lgkmcnt(9)
s_add_u32 m0, s67, 0xa000
s_add_u32 s76, s95, 0x280280
Ta 174,2,18432
Mvav 244,152,64
Ta 176,3,16384
Mvav 252,152,68
s_waitcnt lgkmcnt(9)
Ta 178,3,18432
Mvav 224,156,72
Ta 144,4,16384
Mvav 232,156,76
s_waitcnt lgkmcnt(8)
Ta 146,4,18432
Mvav 228,160,72
LD 20,36,76,0
Ta 148,5,16384
Mvav 236,160,76
s_waitcnt lgkmcnt(8)
Ta 150,5,18432
Ta 152,2,20480
Mvav 240,164,72
s_lshl_b32 s85, s30, 7
Ta 154,2,22528
s_add_u32 s85, s85, 0x4000
Mvav 248,164,76
s_waitcnt lgkmcnt(9)
s_getpc_b64 s[96:97]
Ta 156,3,20480
v_mov_b32 v46, s85
Mvav 244,168,72
global_load_dword a252, v46, s[96:97]
Ta 158,3,22528
Mvav 252,168,76
s_waitcnt lgkmcnt(9)
Ta 160,4,20480
Mvav 224,172,80
LD 21,36,76,1024
Ta 162,4,22528
Mvav 232,172,84
s_waitcnt lgkmcnt(9)
Ta 164,5,20480
Mvav 228,176,80
Ta 166,5,22528
Mvav 236,176,84
s_waitcnt lgkmcnt(9)
Ta 168,2,24576
Mvav 240,144,80
Ta 170,2,26624
Mvav 248,144,84
s_waitcnt lgkmcnt(8)
Ta 172,3,24576
Mvav 244,148,80
LD 22,36,76,2048
Ta 174,3,26624
Mvav 252,148,84
Ta 176,4,24576
Ta 178,4,26624
Mvav 224,152,88
Ta 144,5,24576
Mvav 232,152,92
s_waitcnt lgkmcnt(9)
Ta 146,5,26624
Mvav 228,156,88
Ta 148,2,28672
Mvav 236,156,92
s_waitcnt lgkmcnt(7)
Ta 150,2,30720
Mvav 240,160,88
LD 23,36,76,3072
Ta 152,3,28672
Mvav 248,160,92
s_add_u32 m0, s67, 0xb000
s_add_u32 s76, s95, 0x2c0280
Ta 154,3,30720
Mvav 244,164,88
Ta 156,4,28672
Mvav 252,164,92
Ta 158,4,30720
Mvav 224,168,96
Ta 160,5,28672
Mvav 232,168,100
s_waitcnt lgkmcnt(8)
Ta 162,5,30720
Mvav 228,172,96
LD 20,36,76,0
Ta 164,2,32768
Mvav 236,172,100
s_add_u32 m0, s67, 0x12000
Ta 166,2,34816
Ta 168,3,32768
Mvav 240,176,96
s_add_u32 s76, s28, 0
Ta 170,3,34816
Ta 172,4,32768
Mvav 248,176,100
s_waitcnt lgkmcnt(10)
Ta 174,4,34816
Ta 176,5,32768
Mvav 244,144,96
Ta 178,5,34816
v_add_u32 v2, 0x9000, v2
Mvav 252,144,100
v_add_u32 v3, 0x9000, v3
v_add_u32 v4, 0x9000, v4
Mvav 224,148,104
v_add_u32 v5, 0x9000, v5
Mvav 232,148,108
s_waitcnt lgkmcnt(9)
Mvav 228,152,104
Mvav 236,152,108
Mvav 240,156,104
Mvav 248,156,108
s_waitcnt vmcnt(24) lgkmcnt(0)
s_barrier
Mvav 244,160,104
s_waitcnt vmcnt(11)
buffer_store_dword v47, off, s[40:43], s10 sc1
Ta 144,2,0
Mvav 252,160,108
s_lshl_b32 s10, s94, 3
Ta 146,2,2048
s_add_u32 s10, s10, s17
Mvav 224,164,112
s_lshl_b32 s10, s10, 7
Ta 148,3,0
s_add_u32 s10, s10, 0x3010004
Mvav 232,164,116
Ta 150,3,2048
Mvav 228,168,112
Ta 152,4,0
Ta 154,4,2048
Mvav 236,168,116
Ta 156,5,0
Mvav 240,172,112
Ta 158,5,2048
Mvav 248,172,116
Ta 160,2,4096
Mvav 244,176,112
Ta 162,2,6144
Mvav 252,176,116
s_waitcnt lgkmcnt(8)
Ta 164,3,4096
Mvav 224,144,120
Ta 166,3,6144
Mvav 232,144,124
s_waitcnt lgkmcnt(8)
Ta 168,4,4096
Mvav 228,148,120
LD 8,48,76,0
Ta 170,4,6144
Mvav 236,148,124
s_waitcnt lgkmcnt(8)
Ta 172,5,4096
Mvav 240,152,120
Ta 174,5,6144
Mvav 248,152,124
s_waitcnt lgkmcnt(8)
Ta 176,2,8192
Mvav 244,156,120
s_mul_i32 s77, s100, 0x12000
Ta 178,2,10240
v_min_u32 v46, 8, v1
Mvav 252,156,124
s_waitcnt lgkmcnt(8)
s_mul_i32 s85, s66, 0x400
Ta 144,3,8192
Ta 146,3,10240
Mvav 224,160,128
LD 9,48,76,1024
Ta 148,4,8192
Mvav 232,160,132
s_waitcnt lgkmcnt(9)
s_add_u32 s77, s77, s85
Ta 150,4,10240
v_mul_u32_u24 v46, 0x2000, v46
Mvav 228,164,128
s_add_u32 s77, s77, 0x380
Ta 152,5,8192
Mvav 236,164,132
s_waitcnt lgkmcnt(9)
Ta 154,5,10240
Mvav 240,168,128
buffer_load_dword a255, v46, s[36:39], s77 offen
Ta 156,2,12288
Mvav 248,168,132
s_waitcnt lgkmcnt(9)
Ta 158,2,14336
Mvav 244,172,128
LD 10,48,76,2048
Ta 160,3,12288
Mvav 252,172,132
s_waitcnt lgkmcnt(9)
Ta 162,3,14336
Mvav 224,176,136
Ta 164,4,12288
Mvav 232,176,140
s_waitcnt lgkmcnt(9)
Ta 166,4,14336
Mvav 228,144,136
Ta 168,5,12288
Mvav 236,144,140
s_waitcnt lgkmcnt(8)
Ta 170,5,14336
Mvav 240,148,136
LD 11,48,76,3072
Ta 172,2,16384
Mvav 248,148,140
s_waitcnt lgkmcnt(9)
s_add_u32 m0, s67, 0x13000
s_add_u32 s76, s28, 0x9000
Ta 174,2,18432
Mvav 244,152,136
Ta 176,3,16384
Ta 178,3,18432
Mvav 252,152,140
s_waitcnt lgkmcnt(9)
Ta 144,4,16384
Mvav 224,156,144
Ta 146,4,18432
Mvav 232,156,148
s_waitcnt lgkmcnt(9)
Ta 148,5,16384
Mvav 228,160,144
LD 8,48,76,0
Ta 150,5,18432
Mvav 236,160,148
s_waitcnt lgkmcnt(9)
Ta 152,2,20480
Mvav 240,164,144
Ta 154,2,22528
Mvav 248,164,148
s_waitcnt lgkmcnt(9)
Ta 156,3,20480
Mvav 244,168,144
Ta 158,3,22528
Mvav 252,168,148
s_waitcnt lgkmcnt(8)
Ta 160,4,20480
Mvav 224,172,152
LD 9,48,76,1024
Ta 162,4,22528
Mvav 232,172,156
Ta 164,5,20480
Mvav 228,176,152
Ta 166,5,22528
Mvav 236,176,156
s_waitcnt lgkmcnt(8)
Ta 168,2,24576
Ta 170,2,26624
Mvav 240,144,152
Ta 172,3,24576
Mvav 248,144,156
Ta 174,3,26624
Mvav 244,148,152
LD 10,48,76,2048
Ta 176,4,24576
Mvav 252,148,156
s_waitcnt lgkmcnt(9)
Ta 178,4,26624
Mvav 224,152,160
Ta 144,5,24576
Mvav 232,152,164
Ta 146,5,26624
Mvav 228,156,160
Ta 148,2,28672
Mvav 236,156,164
s_waitcnt lgkmcnt(9)
Ta 150,2,30720
Mvav 240,160,160
LD 11,48,76,3072
Ta 152,3,28672
Mvav 248,160,164
s_add_u32 m0, s67, 0x14000
s_add_u32 s76, s28, 0x12000
Ta 154,3,30720
Mvav 244,164,160
Ta 156,4,28672
Mvav 252,164,164
s_waitcnt lgkmcnt(8)
Ta 158,4,30720
Ta 160,5,28672
Mvav 224,168,168
Ta 162,5,30720
Mvav 232,168,172
s_waitcnt lgkmcnt(7)
Ta 164,2,32768
Mvav 228,172,168
LD 8,48,76,0
Ta 166,2,34816
Mvav 236,172,172
s_add_u32 m0, s67, 0x1b000
Ta 168,3,32768
Ta 170,3,34816
Mvav 240,176,168
s_add_u32 s76, s28, 0x51000
Ta 172,4,32768
Ta 174,4,34816
Mvav 248,176,172
Ta 176,5,32768
Ta 178,5,34816
Mvav 244,144,168
v_add_u32 v2, 0xfffe5000, v2
v_add_u32 v3, 0xfffe5000, v3
Mvav 252,144,172
s_waitcnt lgkmcnt(10)
v_add_u32 v4, 0xfffe5000, v4
v_add_u32 v5, 0xfffe5000, v5
Mvav 224,148,176
buffer_load_dword v17, v16, s[40:43], 0 offen sc1
Mvav 232,148,180
Mvav 228,152,176
Mvav 236,152,180
Mvav 240,156,176
s_waitcnt lgkmcnt(0)
s_barrier
Mvav 248,156,180
Ta 144,2,0
Ta 146,2,2048
Mvav 244,160,176
Ta 148,3,0
Mvav 252,160,180
Ta 150,3,2048
Mvav 224,164,184
Ta 152,4,0
Mvav 232,164,188
Ta 154,4,2048
Mvav 228,168,184
Ta 156,5,0
Mvav 236,168,188
Ta 158,5,2048
Mvav 240,172,184
Ta 160,2,4096
v_mul_f32 v224, v38, v224
Mvav 248,172,188
Ta 162,2,6144
v_mul_f32 v225, v38, v225
Mvav 244,176,184
Ta 164,3,4096
v_mul_f32 v226, v38, v226
Mvav 252,176,188
s_waitcnt lgkmcnt(8)
Ta 166,3,6144
v_mul_f32 v227, v38, v227
v_mfma_f32_16x16x32_bf16 v[192:195], a[144:147], v[48:51], 0
Ta 168,4,4096
v_mul_f32 v228, v38, v228
v_mfma_f32_16x16x32_bf16 v[200:203], a[144:147], v[52:55], 0
s_waitcnt lgkmcnt(8)
Ta 170,4,6144
v_mul_f32 v229, v38, v229
v_mfma_f32_16x16x32_bf16 v[196:199], a[148:151], v[48:51], 0
LD 8,48,76,0
Ta 172,5,4096
v_mfma_f32_16x16x32_bf16 v[204:207], a[148:151], v[52:55], 0
s_waitcnt lgkmcnt(8)
Ta 174,5,6144
Ta 176,2,8192
v_mfma_f32_16x16x32_bf16 v[208:211], a[152:155], v[48:51], 0
Ta 178,2,10240
v_mul_f32 v230, v38, v230
v_mfma_f32_16x16x32_bf16 v[216:219], a[152:155], v[52:55], 0
s_waitcnt lgkmcnt(9)
Ta 144,3,8192
v_mul_f32 v231, v38, v231
v_mfma_f32_16x16x32_bf16 v[212:215], a[156:159], v[48:51], 0
Ta 146,3,10240
CV 224,224,225
v_mfma_f32_16x16x32_bf16 v[220:223], a[156:159], v[52:55], 0
s_waitcnt lgkmcnt(9)
Ta 148,4,8192
CV 225,226,227
Mvav 192,160,56
LD 9,48,76,1024
Ta 150,4,10240
Mvav 200,160,60
s_waitcnt lgkmcnt(9)
Ta 152,5,8192
CV 226,228,229
Mvav 196,164,56
Ta 154,5,10240
CV 227,230,231
Mvav 204,164,60
s_waitcnt lgkmcnt(9)
Ta 156,2,12288
v_mul_f32 v232, v39, v232
Mvav 208,168,56
Ta 158,2,14336
v_mul_f32 v233, v39, v233
Mvav 216,168,60
s_waitcnt lgkmcnt(8)
Ta 160,3,12288
v_mul_f32 v234, v39, v234
Mvav 212,172,56
LD 10,48,76,2048
Ta 162,3,14336
Mvav 220,172,60
Ta 164,4,12288
Ta 166,4,14336
Mvav 192,176,64
Ta 168,5,12288
v_mul_f32 v235, v39, v235
Mvav 200,176,68
s_waitcnt lgkmcnt(9)
Ta 170,5,14336
v_mul_f32 v236, v39, v236
Mvav 196,144,64
Ta 172,2,16384
v_mul_f32 v237, v39, v237
Mvav 204,144,68
s_waitcnt lgkmcnt(7)
Ta 174,2,18432
v_mul_f32 v238, v39, v238
Mvav 208,148,64
LD 11,48,76,3072
Ta 176,3,16384
Mvav 216,148,68
s_add_u32 m0, s67, 0x1c000
s_add_u32 s76, s28, 0x5a000
Ta 178,3,18432
Mvav 212,152,64
Ta 144,4,16384
v_mul_f32 v239, v39, v239
Mvav 220,152,68
Ta 146,4,18432
CV 232,232,233
Mvav 192,156,72
Ta 148,5,16384
CV 233,234,235
Mvav 200,156,76
s_waitcnt lgkmcnt(8)
Ta 150,5,18432
CV 234,236,237
Mvav 196,160,72
LD 8,48,76,0
Ta 152,2,20480
Mvav 204,160,76
Ta 154,2,22528
CV 235,238,239
Mvav 208,164,72
Ta 156,3,20480
v_mul_f32 v240, v38, v240
Mvav 216,164,76
s_waitcnt lgkmcnt(8)
Ta 158,3,22528
v_permlane32_swap_b32 v224, v226
Mvav 212,168,72
Ta 160,4,20480
v_permlane32_swap_b32 v225, v227
Mvav 220,168,76
Ta 162,4,22528
v_permlane16_swap_b32 v224, v226
Mvav 192,172,80
LD 9,48,76,1024
Ta 164,5,20480
Mvav 200,172,84
s_waitcnt lgkmcnt(7)
Ta 166,5,22528
v_permlane16_swap_b32 v225, v227
Mvav 196,176,80
Ta 168,2,24576
v_mul_f32 v241, v38, v241
Mvav 204,176,84
Ta 170,2,26624
v_mul_f32 v242, v38, v242
Mvav 208,144,80
buffer_store_dwordx4 v[224:227], v7, s[40:43], s78 offen sc1
Ta 172,3,24576
Mvav 216,144,84
Ta 174,3,26624
v_mul_f32 v243, v38, v243
Mvav 212,148,80
Ta 176,4,24576
v_mul_f32 v244, v38, v244
Mvav 220,148,84
Ta 178,4,26624
s_waitcnt vmcnt(7)
v_cmp_ne_u32 vcc, s98, v17
s_cbranch_vccnz L_spin50
L_pollok50:
s_waitcnt lgkmcnt(9)
Mvav 192,152,88
Ta 144,5,24576
v_mul_f32 v245, v38, v245
Mvav 200,152,92
buffer_load_dwordx4 a[0:3], v31, s[40:43], s5 offen sc1
Ta 146,5,26624
Mvav 196,156,88
Ta 148,2,28672
v_permlane32_swap_b32 v232, v234
Mvav 204,156,92
s_waitcnt lgkmcnt(8)
Ta 150,2,30720
v_mul_f32 v246, v38, v246
Mvav 208,160,88
Ta 152,3,28672
v_mul_f32 v247, v38, v247
Mvav 216,160,92
LD 10,48,76,2048
Ta 154,3,30720
Mvav 212,164,88
Ta 156,4,28672
CV 240,240,241
Mvav 220,164,92
s_waitcnt lgkmcnt(8)
Ta 158,4,30720
CV 241,242,243
Mvav 192,168,96
Ta 160,5,28672
CV 242,244,245
Mvav 200,168,100
buffer_load_dwordx4 a[4:7], v6, s[40:43], s5 offen offset:256 sc1
Ta 162,5,30720
Mvav 196,172,96
Ta 164,2,32768
CV 243,246,247
Mvav 204,172,100
s_waitcnt lgkmcnt(8)
Ta 166,2,34816
Ta 168,3,32768
Mvav 208,176,96
Ta 170,3,34816
Ta 172,4,32768
Mvav 216,176,100
buffer_load_dwordx4 a[8:11], v31, s[40:43], s5 offen offset:2048 sc1
Ta 174,4,34816
Mvav 212,144,96
Ta 176,5,32768
Ta 178,5,34816
Mvav 220,144,100
s_waitcnt lgkmcnt(10)
v_permlane32_swap_b32 v233, v235
v_add_u32 v2, 0x9000, v2
Mvav 192,148,104
v_permlane16_swap_b32 v232, v234
Mvav 200,148,108
L_pg0_4:
s_cbranch_execz L_ret0
LD 11,48,76,3072
v_add_u32 v3, 0x9000, v3
Mvav 196,152,104
s_add_u32 m0, s67, 0x1d000
s_add_u32 s76, s28, 0x63000
v_add_u32 v4, 0x9000, v4
Mvav 204,152,108
v_permlane16_swap_b32 v233, v235
Mvav 208,156,104
s_waitcnt lgkmcnt(0)
s_barrier
v_permlane32_swap_b32 v240, v242
Mvav 216,156,108
buffer_load_dwordx4 a[12:15], v6, s[40:43], s5 offen offset:2304 sc1
Ta 144,2,0
Mvav 212,160,104
s_mov_b32 s5, 0x48d000
Ta 146,2,2048
v_add_u32 v5, 0x9000, v5
Mvav 220,160,108
Ta 148,3,0
v_mul_f32 v248, v39, v248
Mvav 192,164,112
Ta 150,3,2048
v_mul_f32 v249, v39, v249
Mvav 200,164,116
LD 8,48,76,0
Ta 152,4,0
Mvav 196,168,112
s_add_u32 m0, s67, 0
s_add_u32 s76, s95, 0x300
Ta 154,4,2048
Mvav 204,168,116
Ta 156,5,0
v_mul_f32 v250, v39, v250
Mvav 208,172,112
Ta 158,5,2048
v_mul_f32 v251, v39, v251
Mvav 216,172,116
buffer_load_dwordx4 a[16:19], v31, s[40:43], s6 offen sc1
Ta 160,2,4096
Mvav 212,176,112
Ta 162,2,6144
Ta 164,3,4096
Mvav 220,176,116
s_waitcnt lgkmcnt(9)
Ta 166,3,6144
v_mul_f32 v252, v39, v252
Mvav 192,144,120
s_waitcnt lgkmcnt(8)
Ta 168,4,4096
v_mul_f32 v253, v39, v253
Mvav 200,144,124
buffer_load_dwordx4 a[20:23], v6, s[40:43], s6 offen offset:256 sc1
Ta 170,4,6144
Mvav 196,148,120
Ta 172,5,4096
v_mul_f32 v254, v39, v254
Mvav 204,148,124
s_waitcnt lgkmcnt(9)
Ta 174,5,6144
v_mul_f32 v255, v39, v255
Mvav 208,152,120
s_waitcnt lgkmcnt(8)
Ta 176,2,8192
CV 248,248,249
Mvav 216,152,124
buffer_load_dwordx4 a[24:27], v31, s[40:43], s6 offen offset:2048 sc1
Ta 178,2,10240
Mvav 212,156,120
Ta 144,3,8192
CV 249,250,251
Mvav 220,156,124
s_waitcnt lgkmcnt(8)
Ta 146,3,10240
CV 250,252,253
Mvav 192,160,128
s_waitcnt lgkmcnt(7)
Ta 148,4,8192
CV 251,254,255
Mvav 200,160,132
buffer_load_dwordx4 a[28:31], v6, s[40:43], s6 offen offset:2304 sc1
Ta 150,4,10240
Mvav 196,164,128
s_mov_b32 s6, 0x48e000
Ta 152,5,8192
Ta 154,5,10240
Mvav 204,164,132
s_waitcnt lgkmcnt(9)
Ta 156,2,12288
v_and_b32 v16, 15, v1
Mvav 208,168,128
s_mul_i32 s77, s100, 0x14400
Ta 158,2,14336
v_min_u32 v16, 9, v16
Mvav 216,168,132
s_waitcnt lgkmcnt(9)
buffer_load_dwordx2 a[32:33], v31, s[40:43], s7 offen sc1
Ta 160,3,12288
Mvav 212,172,128
s_waitcnt lgkmcnt(8)
Ta 162,3,14336
v_permlane32_swap_b32 v241, v243
Mvav 220,172,132
buffer_load_dwordx2 a[34:35], v6, s[40:43], s7 offen offset:8 sc1
Ta 164,4,12288
Mvav 192,176,136
s_waitcnt lgkmcnt(8)
Ta 166,4,14336
v_permlane16_swap_b32 v240, v242
Mvav 200,176,140
buffer_load_dwordx2 a[36:37], v6, s[40:43], s7 offen offset:256 sc1
Ta 168,5,12288
Mvav 196,144,136
s_waitcnt lgkmcnt(7)
Ta 170,5,14336
v_permlane16_swap_b32 v241, v243
Mvav 204,144,140
buffer_load_dwordx2 a[38:39], v32, s[40:43], s7 offen offset:8 sc1
Ta 172,2,16384
Mvav 208,148,136
Ta 174,2,18432
v_lshlrev_b32 v17, 7, s94
Mvav 216,148,140
LD 20,36,76,0
Ta 176,3,16384
Mvav 212,152,136
Ta 178,3,18432
v_lshl_add_u32 v16, v16, 2, v17
Mvav 220,152,140
s_waitcnt lgkmcnt(8)
Ta 144,4,16384
Ta 146,4,18432
Mvav 192,156,144
Ta 148,5,16384
v_add_u32 v16, 0x3002000, v16
Mvav 200,156,148
buffer_load_dwordx4 a[40:43], v6, s[40:43], s7 offen offset:2048 sc1
Ta 150,5,18432
Mvav 196,160,144
Ta 152,2,20480
Mvav 204,160,148
s_waitcnt lgkmcnt(9)
Ta 154,2,22528
Mvav 208,164,144
s_lshl_b32 s85, s30, 7
s_getpc_b64 s[96:97]
s_add_u32 s85, s85, 0x4000
Mvav 216,164,148
buffer_store_dwordx4 v[232:235], v7, s[40:43], s78 offen offset:1024 sc1
Ta 156,3,20480
Mvav 212,168,144
s_waitcnt lgkmcnt(7)
Ta 158,3,22528
v_mov_b32 v46, s85
Mvav 220,168,148
s_mul_i32 s85, s66, 0x480
Ta 160,4,20480
s_add_u32 s77, s77, s85
Mvav 192,172,152
Ta 162,4,22528
Mvav 200,172,156
s_waitcnt lgkmcnt(5)
Ta 164,5,20480
Mvav 196,176,152
buffer_load_dwordx4 a[44:47], v32, s[40:43], s7 offen offset:2048 sc1
Ta 166,5,22528
Mvav 204,176,156
s_mov_b32 s7, 0x48f000
Ta 168,2,24576
Mvav 208,144,152
Ta 170,2,26624
Mvav 216,144,156
Ta 172,3,24576
Ta 174,3,26624
Mvav 212,148,152
LD 21,36,76,1024
Ta 176,4,24576
Mvav 220,148,156
s_waitcnt lgkmcnt(9)
Ta 178,4,26624
Mvav 192,152,160
Ta 144,5,24576
Mvav 200,152,164
Ta 146,5,26624
Mvav 196,156,160
buffer_load_dwordx4 a[48:51], v6, s[40:43], s4 offen sc1
Ta 148,2,28672
Mvav 204,156,164
s_waitcnt lgkmcnt(9)
Ta 150,2,30720
v_permlane32_swap_b32 v248, v250
Mvav 208,160,160
Ta 152,3,28672
v_permlane32_swap_b32 v249, v251
Mvav 216,160,164
Ta 154,3,30720
v_permlane16_swap_b32 v248, v250
Mvav 212,164,160
LD 22,36,76,2048
Ta 156,4,28672
Mvav 220,164,164
s_waitcnt lgkmcnt(7)
Ta 158,4,30720
v_permlane16_swap_b32 v249, v251
Mvav 192,168,168
Ta 160,5,28672
Mvav 200,168,172
Ta 162,5,30720
Mvav 196,172,168
buffer_load_dwordx4 a[52:55], v32, s[40:43], s4 offen sc1
Ta 164,2,32768
Mvav 204,172,172
Ta 166,2,34816
Ta 168,3,32768
Mvav 208,176,168
Ta 170,3,34816
Ta 172,4,32768
Mvav 216,176,172
s_waitcnt lgkmcnt(9)
Ta 174,4,34816
Ta 176,5,32768
Mvav 212,144,168
buffer_load_dwordx4 a[56:59], v6, s[40:43], s4 offen offset:2048 sc1
Ta 178,5,34816
Mvav 220,144,172
v_add_u32 v2, 0x9000, v2
v_add_u32 v3, 0x9000, v3
Mvav 192,148,176
v_add_u32 v4, 0x9000, v4
v_add_u32 v5, 0x9000, v5
Mvav 200,148,180
s_waitcnt lgkmcnt(7)
Mvav 196,152,176
LD 23,36,76,3072
Mvav 204,152,180
s_add_u32 m0, s67, 0x1000
s_add_u32 s76, s95, 0x40300
Mvav 208,156,176
Mvav 216,156,180
s_waitcnt lgkmcnt(0)
s_barrier
Mvav 212,160,176
buffer_load_dwordx4 a[60:63], v32, s[40:43], s4 offen offset:2048 sc1
Ta 144,2,0
Mvav 220,160,180
s_mov_b32 s4, 0x490000
Ta 146,2,2048
Ta 148,3,0
Mvav 192,164,184
Ta 150,3,2048
Mvav 200,164,188
Ta 152,4,0
Mvav 196,168,184
LD 20,36,76,0
Ta 154,4,2048
Mvav 204,168,188
Ta 156,5,0
v_mul_f32 v192, v38, v192
Mvav 208,172,184
Ta 158,5,2048
v_mul_f32 v193, v38, v193
Mvav 216,172,188
Ta 160,2,4096
v_mul_f32 v194, v38, v194
Mvav 212,176,184
buffer_load_dwordx4 a[64:67], v6, s[40:43], s5 offen sc1
Ta 162,2,6144
Mvav 220,176,188
s_waitcnt vmcnt(27) lgkmcnt(8)
Ta 164,3,4096
v_mul_f32 v195, v38, v195
v_mfma_f32_16x16x32_bf16 v[224:227], a[144:147], a[0:3], 0
s_waitcnt vmcnt(25)
Ta 166,3,6144
v_mul_f32 v196, v38, v196
v_mfma_f32_16x16x32_bf16 v[232:235], a[144:147], a[4:7], 0
s_waitcnt lgkmcnt(8)
Ta 168,4,4096
v_mul_f32 v197, v38, v197
v_mfma_f32_16x16x32_bf16 v[228:231], a[148:151], a[0:3], 0
buffer_load_dwordx4 a[68:71], v32, s[40:43], s5 offen sc1
Ta 170,4,6144
v_mfma_f32_16x16x32_bf16 v[236:239], a[148:151], a[4:7], 0
s_waitcnt lgkmcnt(8)
buffer_store_dwordx4 v[240:243], v7, s[40:43], s78 offen offset:2048 sc1
Ta 172,5,4096
Ta 174,5,6144
v_mfma_f32_16x16x32_bf16 v[240:243], a[152:155], a[0:3], 0
LD 21,36,76,1024
buffer_load_dwordx4 a[72:75], v33, s[40:43], s5 offen offset:2048 sc1
LD 22,36,76,2048
Ta 176,2,8192
Ta 178,2,10240
Ta 144,3,8192
Ta 146,3,10240
Ta 148,4,8192
buffer_load_dwordx4 a[76:79], v6, s[40:43], s5 offen offset:2304 sc1
s_mov_b32 s5, 0x491000
Ta 150,4,10240
v_mul_f32 v198, v38, v198
v_mul_f32 v199, v38, v199
CV 192,192,193
CV 193,194,195
CV 194,196,197
CV 195,198,199
s_nop 0
v_permlane32_swap_b32 v192, v194
v_permlane32_swap_b32 v193, v195
s_nop 0
v_permlane16_swap_b32 v192, v194
global_load_dword a252, v46, s[96:97]
v_min_u32 v46, 8, v1
v_permlane16_swap_b32 v193, v195
v_mul_u32_u24 v46, 0x2400, v46
buffer_load_dwordx4 a[80:83], v33, s[40:43], s6 offen sc1
v_mul_f32 v200, v39, v200
v_mul_f32 v201, v39, v201
v_mul_f32 v202, v39, v202
v_mul_f32 v203, v39, v203
v_mul_f32 v204, v39, v204
v_mul_f32 v205, v39, v205
v_mul_f32 v206, v39, v206
v_mul_f32 v207, v39, v207
CV 200,200,201
CV 201,202,203
CV 202,204,205
CV 203,206,207
s_nop 0
v_permlane32_swap_b32 v200, v202
buffer_load_dword a255, v46, s[52:55], s77 offen
v_permlane32_swap_b32 v201, v203
v_permlane16_swap_b32 v200, v202
LD 23,36,76,3072
s_add_u32 m0, s67, 0x2000
s_add_u32 s76, s95, 0x80300
v_permlane16_swap_b32 v201, v203
v_mul_f32 v208, v38, v208
v_mul_f32 v209, v38, v209
v_mul_f32 v210, v38, v210
v_mul_f32 v211, v38, v211
v_mul_f32 v212, v38, v212
v_mul_f32 v213, v38, v213
v_mul_f32 v214, v38, v214
v_mul_f32 v215, v38, v215
CV 208,208,209
CV 209,210,211
buffer_load_dwordx4 a[84:87], v6, s[40:43], s6 offen offset:256 sc1
CV 210,212,213
CV 211,214,215
s_nop 0
v_permlane32_swap_b32 v208, v210
v_permlane32_swap_b32 v209, v211
s_nop 0
v_permlane16_swap_b32 v208, v210
v_permlane16_swap_b32 v209, v211
v_mul_f32 v216, v39, v216
v_mul_f32 v217, v39, v217
v_mul_f32 v218, v39, v218
v_mul_f32 v219, v39, v219
LD 20,36,76,0
s_add_u32 m0, s67, 0x9000
s_add_u32 s76, s95, 0x240300
v_mul_f32 v220, v39, v220
v_mul_f32 v221, v39, v221
v_mul_f32 v222, v39, v222
v_mul_f32 v223, v39, v223
CV 216,216,217
CV 217,218,219
CV 218,220,221
CV 219,222,223
s_nop 0
v_permlane32_swap_b32 v216, v218
v_permlane32_swap_b32 v217, v219
buffer_load_dwordx4 a[88:91], v33, s[40:43], s6 offen offset:2048 sc1
v_permlane16_swap_b32 v216, v218
v_permlane16_swap_b32 v217, v219
buffer_load_dwordx4 a[92:95], v6, s[40:43], s6 offen offset:2304 sc1
buffer_load_dwordx4 a[96:99], v33, s[40:43], s7 offen sc1
buffer_store_dwordx4 v[248:251], v7, s[40:43], s78 offen offset:3072 sc1
v_mfma_f32_16x16x32_bf16 v[248:251], a[152:155], a[4:7], 0
s_waitcnt lgkmcnt(0)
s_add_u32 s78, s101, 0x6000
Ta 152,5,8192
v_mfma_f32_16x16x32_bf16 v[244:247], a[156:159], a[0:3], 0
Ta 154,5,10240
v_mfma_f32_16x16x32_bf16 v[252:255], a[156:159], a[4:7], 0
s_waitcnt vmcnt(40)
Ta 156,2,12288
Mvaa 224,160,8
s_waitcnt vmcnt(38)
Ta 158,2,14336
Mvaa 232,160,12
Ta 160,3,12288
Mvaa 228,164,8
Ta 162,3,14336
Mvaa 236,164,12
Ta 164,4,12288
Mvaa 240,168,8
Ta 166,4,14336
Mvaa 248,168,12
Ta 168,5,12288
Mvaa 244,172,8
Ta 170,5,14336
Mvaa 252,172,12
s_waitcnt vmcnt(36)
Ta 172,2,16384
Mvaa 224,176,16
s_waitcnt vmcnt(35)
Ta 174,2,18432
Mvaa 232,176,20
Ta 176,3,16384
Mvaa 228,144,16
Ta 178,3,18432
Mvaa 236,144,20
Ta 144,4,16384
Mvaa 240,148,16
Ta 146,4,18432
Mvaa 248,148,20
s_waitcnt lgkmcnt(8)
Ta 148,5,16384
Mvaa 244,152,16
Ta 150,5,18432
Mvaa 252,152,20
s_waitcnt vmcnt(34)
Ta 152,2,20480
Mvaa 224,156,24
s_waitcnt vmcnt(33)
Ta 154,2,22528
Mvaa 232,156,28
buffer_load_dwordx4 a[100:103], v6, s[40:43], s7 offen offset:256 sc1
Ta 156,3,20480
Mvaa 228,160,24
Ta 158,3,22528
Mvaa 236,160,28
Ta 160,4,20480
Mvaa 240,164,24
s_waitcnt lgkmcnt(7)
Ta 162,4,22528
Mvaa 248,164,28
buffer_load_dwordx2 a[104:105], v33, s[40:43], s7 offen offset:2048 sc1
Ta 164,5,20480
Mvaa 244,168,24
Ta 166,5,22528
Mvaa 252,168,28
s_waitcnt vmcnt(33)
buffer_load_dwordx2 a[106:107], v6, s[40:43], s7 offen offset:2056 sc1
Ta 168,2,24576
Mvaa 224,172,32
s_waitcnt vmcnt(32)
Ta 170,2,26624
Mvaa 232,172,36
buffer_load_dwordx2 a[108:109], v6, s[40:43], s7 offen offset:2304 sc1
Ta 172,3,24576
Mvaa 228,176,32
Ta 174,3,26624
Mvaa 236,176,36
buffer_load_dwordx2 a[110:111], v34, s[40:43], s7 offen offset:2056 sc1
Ta 176,4,24576
Mvaa 240,144,32
s_mov_b32 s7, 0x240000
Ta 178,4,26624
Mvaa 248,144,36
s_waitcnt lgkmcnt(8)
buffer_load_dwordx4 a[112:115], v6, s[40:43], s4 offen sc1
Ta 144,5,24576
Mvaa 244,148,32
Ta 146,5,26624
Mvaa 252,148,36
s_waitcnt vmcnt(33)
Ta 148,2,28672
Mvaa 224,152,40
s_waitcnt vmcnt(31)
Ta 150,2,30720
Mvaa 232,152,44
LD 20,36,76,0
Ta 152,3,28672
Mvaa 228,156,40
Ta 154,3,30720
Mvaa 236,156,44
Ta 156,4,28672
Mvaa 240,160,40
s_waitcnt lgkmcnt(7)
Ta 158,4,30720
Mvaa 248,160,44
buffer_load_dwordx4 a[116:119], v34, s[40:43], s4 offen sc1
Ta 160,5,28672
Ta 162,5,30720
Mvaa 244,164,40
Mvaa 252,164,44
s_waitcnt vmcnt(31)
Ta 164,2,32768
Ta 166,2,34816
v_add_u32 v2, 0x9000, v2
Mvaa 224,168,48
s_waitcnt vmcnt(29)
LD 21,36,76,1024
Mvaa 232,168,52
Ta 168,3,32768
Mvaa 228,172,48
Ta 170,3,34816
v_add_u32 v3, 0x9000, v3
Mvaa 236,172,52
Ta 172,4,32768
Ta 174,4,34816
Mvaa 240,176,48
buffer_load_dwordx4 a[120:123], v6, s[40:43], s4 offen offset:2048 sc1
v_add_u32 v4, 0x9000, v4
Mvaa 248,176,52
s_waitcnt lgkmcnt(6)
Ta 176,5,32768
Ta 178,5,34816
Mvaa 244,144,48
v_add_u32 v5, 0x9000, v5
Mvaa 252,144,52
s_waitcnt vmcnt(30)
Mvaa 224,148,56
s_waitcnt vmcnt(28)
buffer_load_dwordx4 a[124:127], v34, s[40:43], s4 offen offset:2048 sc1
Mvaa 232,148,60
s_mov_b32 s4, 0x241000
Mvaa 228,152,56
Mvaa 236,152,60
Mvaa 240,156,56
LD 22,36,76,2048
s_waitcnt lgkmcnt(0)
s_barrier
Ta 144,2,0
Mvaa 248,156,60
Ta 146,2,2048
Mvaa 244,160,56
Ta 148,3,0
Mvaa 252,160,60
s_waitcnt vmcnt(28)
Ta 150,3,2048
Mvaa 224,164,64
s_waitcnt vmcnt(27)
buffer_load_dwordx4 a[128:131], v6, s[40:43], s5 offen sc1
Ta 152,4,0
Mvaa 232,164,68
Ta 154,4,2048
Mvaa 228,168,64
Ta 156,5,0
Ta 158,5,2048
Mvaa 236,168,68
Ta 160,2,4096
Ta 162,2,6144
Mvaa 240,172,64
LD 23,36,76,3072
Ta 164,3,4096
Mvaa 248,172,68
s_add_u32 m0, s67, 0xa000
s_add_u32 s76, s95, 0x280300
Ta 166,3,6144
Mvaa 244,176,64
Ta 168,4,4096
Ta 170,4,6144
Mvaa 252,176,68
s_waitcnt vmcnt(26) lgkmcnt(10)
Ta 172,5,4096
Ta 174,5,6144
Mvaa 224,144,72
s_waitcnt vmcnt(24)
buffer_load_dwordx4 a[132:135], v34, s[40:43], s5 offen sc1
Ta 176,2,8192
Mvaa 232,144,76
Ta 178,2,10240
Ta 144,3,8192
Mvaa 228,148,72
Ta 146,3,10240
Mvaa 236,148,76
s_waitcnt lgkmcnt(10)
Ta 148,4,8192
Ta 150,4,10240
Mvaa 240,152,72
buffer_load_dwordx4 a[136:139], v6, s[40:43], s5 offen offset:2048 sc1
Mvaa 248,152,76
Ta 152,5,8192
Ta 154,5,10240
L_pg1_5:
s_cbranch_execz L_ret1
Mvaa 244,156,72
Mvaa 252,156,76
s_waitcnt vmcnt(24)
Ta 156,2,12288
Ta 158,2,14336
Mvaa 224,160,80
s_waitcnt vmcnt(21)
LD 20,36,76,0
Mvaa 232,160,84
s_waitcnt lgkmcnt(7)
Ta 160,3,12288
Ta 162,3,14336
Mvaa 228,164,80
Mvaa 236,164,84
Ta 164,4,12288
Ta 166,4,14336
Mvaa 240,168,80
buffer_load_dwordx4 a[140:143], v34, s[40:43], s5 offen offset:2048 sc1
Mvaa 248,168,84
s_lshl_b32 s5, s94, 13
Ta 168,5,12288
Ta 170,5,14336
Mvaa 244,172,80
s_add_u32 s5, s5, 0x720000
Mvaa 252,172,84
s_waitcnt vmcnt(21)
s_add_u32 s6, s5, 0x1000
Ta 172,2,16384
Ta 174,2,18432
Mvaa 224,176,88
s_waitcnt vmcnt(20)
LD 21,36,76,1024
Mvaa 232,176,92
s_waitcnt lgkmcnt(6)
Ta 176,3,16384
Ta 178,3,18432
Mvaa 228,144,88
Mvaa 236,144,92
Ta 144,4,16384
Ta 146,4,18432
Mvaa 240,148,88
LD 22,36,76,2048
Mvaa 248,148,92
Ta 148,5,16384
Ta 150,5,18432
Mvaa 244,152,88
Mvaa 252,152,92
s_waitcnt vmcnt(21)
Ta 152,2,20480
Ta 154,2,22528
Mvaa 224,156,96
s_waitcnt vmcnt(19)
LD 23,36,76,3072
Mvaa 232,156,100
s_add_u32 m0, s67, 0xb000
s_add_u32 s76, s95, 0x2c0300
Ta 156,3,20480
Mvaa 228,160,96
Ta 158,3,22528
Mvaa 236,160,100
s_waitcnt lgkmcnt(7)
Ta 160,4,20480
Ta 162,4,22528
Mvaa 240,164,96
buffer_store_dwordx4 v[192:195], v7, s[40:43], s79 offen sc1
Mvaa 248,164,100
Ta 164,5,20480
Ta 166,5,22528
Mvaa 244,168,96
Mvaa 252,168,100
s_waitcnt vmcnt(19)
Ta 168,2,24576
Ta 170,2,26624
Mvaa 224,172,104
s_waitcnt vmcnt(17)
Mvaa 232,172,108
LD 20,36,76,0
Ta 172,3,24576
Mvaa 228,176,104
s_add_u32 m0, s67, 0x12000
s_add_u32 s76, s95, 0x380
Ta 174,3,26624
Mvaa 236,176,108
s_waitcnt lgkmcnt(7)
Ta 176,4,24576
Ta 178,4,26624
Mvaa 240,144,104
s_mul_i32 s77, s100, 0x14400
v_min_u32 v46, 8, v1
Mvaa 248,144,108
LD 20,36,76,0
Ta 144,5,24576
Mvaa 244,148,104
s_mul_i32 s85, s66, 0x480
Ta 146,5,26624
v_mul_u32_u24 v46, 0x2400, v46
Mvaa 252,148,108
s_waitcnt vmcnt(18)
s_add_u32 s77, s77, s85
Ta 148,2,28672
Ta 150,2,30720
Mvaa 224,152,112
s_waitcnt vmcnt(16)
s_add_u32 s77, s77, 0x80
Mvaa 232,152,116
buffer_store_dwordx4 v[200:203], v7, s[40:43], s79 offen offset:1024 sc1
Ta 152,3,28672
Mvaa 228,156,112
Ta 154,3,30720
Mvaa 236,156,116
s_waitcnt lgkmcnt(8)
Ta 156,4,28672
Ta 158,4,30720
Mvaa 240,160,112
Mvaa 248,160,116
Ta 160,5,28672
Ta 162,5,30720
Mvaa 244,164,112
LD 21,36,76,1024
Mvaa 252,164,116
s_waitcnt vmcnt(16)
Ta 164,2,32768
Ta 166,2,34816
Mvaa 224,168,120
s_waitcnt vmcnt(15)
v_add_u32 v2, 0xfffe5000, v2
Mvaa 232,168,124
Ta 168,3,32768
Ta 170,3,34816
Mvaa 228,172,120
LD 22,36,76,2048
v_add_u32 v3, 0xfffe5000, v3
Mvaa 236,172,124
s_waitcnt lgkmcnt(6)
Ta 172,4,32768
Ta 174,4,34816
Mvaa 240,176,120
v_add_u32 v4, 0xfffe5000, v4
Mvaa 248,176,124
Ta 176,5,32768
Ta 178,5,34816
Mvaa 244,144,120
LD 23,36,76,3072
v_add_u32 v5, 0xfffe5000, v5
Mvaa 252,144,124
s_waitcnt vmcnt(15)
s_add_u32 m0, s67, 0x13000
s_add_u32 s76, s95, 0x40380
Mvaa 224,148,128
s_waitcnt vmcnt(13)
Mvaa 232,148,132
Mvaa 228,152,128
LD 20,36,76,0
Mvaa 236,152,132
Mvaa 240,156,128
s_waitcnt lgkmcnt(0)
s_barrier
Mvaa 248,156,132
Ta 144,2,0
Mvaa 244,160,128
buffer_store_dwordx4 v[208:211], v7, s[40:43], s79 offen offset:2048 sc1
Ta 146,2,2048
Mvaa 252,160,132
s_waitcnt vmcnt(14)
Ta 148,3,0
Mvaa 224,164,136
s_waitcnt vmcnt(12)
Ta 150,3,2048
Mvaa 232,164,140
Ta 152,4,0
Mvaa 228,168,136
Ta 154,4,2048
Mvaa 236,168,140
LD 21,36,76,1024
Ta 156,5,0
Mvaa 240,172,136
Ta 158,5,2048
Mvaa 248,172,140
Ta 160,2,4096
Mvaa 244,176,136
Ta 162,2,6144
Mvaa 252,176,140
LD 22,36,76,2048
Ta 164,3,4096
Mvaa 224,232,236
Ta 166,3,6144
Mvaa 228,228,236
Ta 168,4,4096
Mvaa 232,232,240
Ta 170,4,6144
Mvaa 236,228,240
LD 23,36,76,3072
Ta 172,5,4096
s_add_u32 m0, s67, 0x14000
Mvaa 240,232,244
s_add_u32 s76, s95, 0x80380
Ta 174,5,6144
Mvaa 244,228,244
Ta 176,2,8192
Mvaa 248,232,248
Ta 178,2,10240
Mvaa 252,228,248
LD 20,36,76,0
buffer_store_dwordx4 v[216:219], v7, s[40:43], s79 offen offset:3072 sc1
buffer_load_dword a255, v46, s[52:55], s77 offen
v_pk_mul_f32 v[26:27], v[224:225], v[224:225]
v_pk_add_f32 v[24:25], v[226:227], v[224:225]
CV 224,224,225
v_pk_fma_f32 v[26:27], v[226:227], v[226:227], v[26:27]
CV 225,226,227
CV 226,228,229
CV 227,230,231
v_pk_mul_f32 v[42:43], v[232:233], v[232:233]
buffer_store_dwordx4 v[224:227], v6, s[40:43], s80 offen sc1
v_pk_add_f32 v[40:41], v[234:235], v[232:233]
CV 232,232,233
v_pk_fma_f32 v[42:43], v[234:235], v[234:235], v[42:43]
CV 233,234,235
CV 234,236,237
CV 235,238,239
v_pk_add_f32 v[24:25], v[24:25], v[228:229]
buffer_store_dwordx4 v[232:235], v6, s[40:43], s80 offen offset:256 sc1
v_pk_fma_f32 v[26:27], v[228:229], v[228:229], v[26:27]
v_pk_add_f32 v[24:25], v[24:25], v[230:231]
v_pk_fma_f32 v[26:27], v[230:231], v[230:231], v[26:27]
v_pk_add_f32 v[24:25], v[24:25], v[240:241]
v_pk_fma_f32 v[26:27], v[240:241], v[240:241], v[26:27]
CV 240,240,241
v_pk_add_f32 v[24:25], v[24:25], v[242:243]
v_pk_fma_f32 v[26:27], v[242:243], v[242:243], v[26:27]
CV 241,242,243
CV 242,244,245
CV 243,246,247
v_pk_add_f32 v[40:41], v[40:41], v[236:237]
s_waitcnt lgkmcnt(0)
buffer_store_dwordx4 v[240:243], v6, s[40:43], s80 offen offset:2048 sc1
v_pk_fma_f32 v[42:43], v[236:237], v[236:237], v[42:43]
v_pk_add_f32 v[40:41], v[40:41], v[238:239]
v_pk_fma_f32 v[42:43], v[238:239], v[238:239], v[42:43]
v_pk_add_f32 v[40:41], v[40:41], v[248:249]
v_pk_fma_f32 v[42:43], v[248:249], v[248:249], v[42:43]
CV 248,248,249
v_pk_add_f32 v[40:41], v[40:41], v[250:251]
v_pk_fma_f32 v[42:43], v[250:251], v[250:251], v[42:43]
CV 249,250,251
CV 250,252,253
CV 251,254,255
s_add_u32 m0, s67, 0x1b000
buffer_store_dwordx4 v[248:251], v6, s[40:43], s80 offen offset:2304 sc1
s_add_u32 s76, s95, 0x240380
v_pk_add_f32 v[24:25], v[24:25], v[244:245]
v_pk_add_f32 v[40:41], v[40:41], v[252:253]
v_pk_fma_f32 v[26:27], v[244:245], v[244:245], v[26:27]
v_pk_fma_f32 v[42:43], v[252:253], v[252:253], v[42:43]
v_pk_add_f32 v[24:25], v[24:25], v[246:247]
v_pk_add_f32 v[40:41], v[40:41], v[254:255]
v_pk_fma_f32 v[26:27], v[246:247], v[246:247], v[26:27]
v_pk_fma_f32 v[42:43], v[254:255], v[254:255], v[42:43]
v_add_f32 v24, v24, v25
v_mfma_f32_16x16x32_bf16 v[192:195], a[144:147], v[48:51], 0
s_add_u32 s79, s101, 0x7000
v_add_f32 v40, v40, v41
v_add_f32 v25, v26, v27
v_mfma_f32_16x16x32_bf16 v[200:203], a[144:147], v[52:55], 0
Ta 144,3,8192
v_add_f32 v41, v42, v43
v_mfma_f32_16x16x32_bf16 v[196:199], a[148:151], v[48:51], 0
Ta 146,3,10240
v_permlane32_swap_b32 v24, v40
v_mfma_f32_16x16x32_bf16 v[204:207], a[148:151], v[52:55], 0
Ta 148,4,8192
v_permlane32_swap_b32 v25, v41
v_mfma_f32_16x16x32_bf16 v[208:211], a[152:155], v[48:51], 0
Ta 150,4,10240
v_add_f32 v24, v24, v40
v_mfma_f32_16x16x32_bf16 v[216:219], a[152:155], v[52:55], 0
Ta 152,5,8192
v_add_f32 v25, v25, v41
v_mfma_f32_16x16x32_bf16 v[212:215], a[156:159], v[48:51], 0
Ta 154,5,10240
v_lshlrev_b32 v26, 3, v1
v_mfma_f32_16x16x32_bf16 v[220:223], a[156:159], v[52:55], 0
Ta 156,2,12288
Mvav 192,160,56
Ta 158,2,14336
Mvav 200,160,60
Ta 160,3,12288
Mvav 196,164,56
Ta 162,3,14336
Mvav 204,164,60
Ta 164,4,12288
Mvav 208,168,56
Ta 166,4,14336
Mvav 216,168,60
Ta 168,5,12288
Mvav 212,172,56
buffer_store_dwordx2 v[24:25], v26, s[40:43], s81 offen sc1
Ta 170,5,14336
Mvav 220,172,60
Ta 172,2,16384
Mvav 192,176,64
LD 20,36,76,0
Ta 174,2,18432
Mvav 200,176,68
s_waitcnt lgkmcnt(8)
Ta 176,3,16384
Mvav 196,144,64
Ta 178,3,18432
Mvav 204,144,68
Ta 144,4,16384
Mvav 208,148,64
LD 21,36,76,1024
Ta 146,4,18432
Mvav 216,148,68
Ta 148,5,16384
Mvav 212,152,64
Ta 150,5,18432
Mvav 220,152,68
Ta 152,2,20480
Mvav 192,156,72
LD 22,36,76,2048
Ta 154,2,22528
Mvav 200,156,76
s_waitcnt lgkmcnt(9)
Ta 156,3,20480
Mvav 196,160,72
Ta 158,3,22528
Mvav 204,160,76
Ta 160,4,20480
Mvav 208,164,72
LD 23,36,76,3072
Ta 162,4,22528
s_add_u32 m0, s67, 0x1c000
s_add_u32 s76, s95, 0x280380
Mvav 216,164,76
s_lshl_b32 s85, s30, 7
Ta 164,5,20480
s_add_u32 s85, s85, 0x4000
Mvav 212,168,72
s_getpc_b64 s[96:97]
Ta 166,5,22528
v_mov_b32 v46, s85
Mvav 220,168,76
s_waitcnt lgkmcnt(8)
Ta 168,2,24576
Mvav 192,172,80
LD 20,36,76,0
Ta 170,2,26624
Mvav 200,172,84
Ta 172,3,24576
Mvav 196,176,80
Ta 174,3,26624
Mvav 204,176,84
Ta 176,4,24576
Mvav 208,144,80
LD 21,36,76,1024
Ta 178,4,26624
Mvav 216,144,84
Ta 144,5,24576
Mvav 212,148,80
Ta 146,5,26624
Mvav 220,148,84
s_waitcnt lgkmcnt(8)
Ta 148,2,28672
Mvav 192,152,88
LD 22,36,76,2048
Ta 150,2,30720
Mvav 200,152,92
Ta 152,3,28672
Mvav 196,156,88
Ta 154,3,30720
Mvav 204,156,92
Ta 156,4,28672
Mvav 208,160,88
LD 23,36,76,3072
Ta 158,4,30720
s_add_u32 m0, s67, 0x1d000
Mvav 216,160,92
s_add_u32 s76, s95, 0x2c0380
Ta 160,5,28672
Mvav 212,164,88
Ta 162,5,30720
Mvav 220,164,92
s_waitcnt lgkmcnt(8)
Ta 164,2,32768
Ta 166,2,34816
Mvav 192,168,96
global_load_dword a252, v46, s[96:97]
v_add_u32 v2, 0x9000, v2
Mvav 200,168,100
Ta 168,3,32768
Mvav 196,172,96
LD 20,36,76,0
Ta 170,3,34816
Mvav 204,172,100
s_add_u32 m0, s67, 0
Ta 172,4,32768
Ta 174,4,34816
Mvav 208,176,96
s_add_u32 s76, s73, 0
v_add_u32 v3, 0x9000, v3
v_add_u32 v4, 0x9000, v4
Mvav 216,176,100
Ta 176,5,32768
Ta 178,5,34816
Mvav 212,144,96
v_add_u32 v5, 0x9000, v5
Mvav 220,144,100
s_waitcnt lgkmcnt(8)
Mvav 192,148,104
Mvav 200,148,108
s_waitcnt vmcnt(10)
buffer_store_dword v47, off, s[40:43], s11 sc1
Mvav 196,152,104
s_lshl_b32 s11, s94, 3
Mvav 204,152,108
Mvav 208,156,104
s_waitcnt lgkmcnt(0)
s_barrier
Mvav 216,156,108
Ta 144,2,0
Ta 146,2,2048
Mvav 212,160,104
Ta 148,3,0
Mvav 220,160,108
Ta 150,3,2048
Mvav 192,164,112
Ta 152,4,0
Mvav 200,164,116
Ta 154,4,2048
Mvav 196,168,112
Ta 156,5,0
Mvav 204,168,116
Ta 158,5,2048
Mvav 208,172,112
Ta 160,2,4096
Mvav 216,172,116
Ta 162,2,6144
Mvav 212,176,112
Ta 164,3,4096
Mvav 220,176,116
s_waitcnt lgkmcnt(8)
Ta 166,3,6144
Mvav 192,144,120
Ta 168,4,4096
Mvav 200,144,124
s_waitcnt lgkmcnt(8)
Ta 170,4,6144
Mvav 196,148,120
LD 12,52,76,0
Ta 172,5,4096
Mvav 204,148,124
s_waitcnt lgkmcnt(8)
Ta 174,5,6144
Ta 176,2,8192
Mvav 208,152,120
Ta 178,2,10240
Mvav 216,152,124
s_waitcnt lgkmcnt(9)
Ta 144,3,8192
Mvav 212,156,120
Ta 146,3,10240
Mvav 220,156,124
s_waitcnt lgkmcnt(9)
Ta 148,4,8192
Mvav 192,160,128
LD 13,52,76,1024
Ta 150,4,10240
Mvav 200,160,132
s_waitcnt lgkmcnt(9)
Ta 152,5,8192
Mvav 196,164,128
Ta 154,5,10240
Mvav 204,164,132
s_waitcnt lgkmcnt(9)
Ta 156,2,12288
Mvav 208,168,128
s_mul_i32 s77, s100, 0x14400
Ta 158,2,14336
v_min_u32 v46, 8, v1
Mvav 216,168,132
s_waitcnt lgkmcnt(8)
s_mul_i32 s85, s66, 0x480
Ta 160,3,12288
v_mul_u32_u24 v46, 0x2400, v46
Mvav 212,172,128
LD 14,52,76,2048
Ta 162,3,14336
Mvav 220,172,132
s_add_u32 s77, s77, s85
Ta 164,4,12288
Ta 166,4,14336
Mvav 192,176,136
s_add_u32 s77, s77, 0x100
Ta 168,5,12288
Mvav 200,176,140
s_waitcnt lgkmcnt(9)
Ta 170,5,14336
Mvav 196,144,136
buffer_load_dword a255, v46, s[52:55], s77 offen
Ta 172,2,16384
Mvav 204,144,140
s_waitcnt lgkmcnt(7)
Ta 174,2,18432
Mvav 208,148,136
LD 15,52,76,3072
Ta 176,3,16384
Mvav 216,148,140
s_add_u32 m0, s67, 0x1000
s_add_u32 s76, s73, 0x48000
Ta 178,3,18432
Mvav 212,152,136
Ta 144,4,16384
Mvav 220,152,140
Ta 146,4,18432
Mvav 192,156,144
Ta 148,5,16384
Mvav 200,156,148
s_waitcnt lgkmcnt(8)
Ta 150,5,18432
Mvav 196,160,144
LD 12,52,76,0
Ta 152,2,20480
Mvav 204,160,148
Ta 154,2,22528
Mvav 208,164,144
Ta 156,3,20480
Mvav 216,164,148
s_waitcnt lgkmcnt(9)
Ta 158,3,22528
Mvav 212,168,144
Ta 160,4,20480
Mvav 220,168,148
Ta 162,4,22528
Mvav 192,172,152
LD 13,52,76,1024
Ta 164,5,20480
Mvav 200,172,156
s_waitcnt lgkmcnt(8)
Ta 166,5,22528
Mvav 196,176,152
Ta 168,2,24576
Mvav 204,176,156
Ta 170,2,26624
Mvav 208,144,152
L_pg1_6:
s_cbranch_execz L_ret1
Ta 172,3,24576
Ta 174,3,26624
Mvav 216,144,156
s_waitcnt lgkmcnt(9)
Ta 176,4,24576
Mvav 212,148,152
LD 14,52,76,2048
Ta 178,4,26624
Mvav 220,148,156
Ta 144,5,24576
Mvav 192,152,160
Ta 146,5,26624
Mvav 200,152,164
s_waitcnt lgkmcnt(9)
Ta 148,2,28672
Mvav 196,156,160
Ta 150,2,30720
Mvav 204,156,164
s_waitcnt lgkmcnt(6)
Ta 152,3,28672
Mvav 208,160,160
LD 15,52,76,3072
Ta 154,3,30720
s_add_u32 m0, s67, 0x2000
Mvav 216,160,164
s_add_u32 s76, s73, 0x90000
Ta 156,4,28672
Mvav 212,164,160
Ta 158,4,30720
Mvav 220,164,164
Ta 160,5,28672
Mvav 192,168,168
Ta 162,5,30720
Mvav 200,168,172
s_waitcnt lgkmcnt(6)
Ta 164,2,32768
Mvav 196,172,168
LD 12,52,76,0
Ta 166,2,34816
Mvav 204,172,172
s_add_u32 m0, s67, 0x9000
Ta 168,3,32768
Ta 170,3,34816
Mvav 208,176,168
s_add_u32 s76, s73, 0x288000
Ta 172,4,32768
Ta 174,4,34816
Mvav 216,176,172
Ta 176,5,32768
Ta 178,5,34816
Mvav 212,144,168
v_add_u32 v2, 0x9000, v2
v_add_u32 v3, 0x9000, v3
Mvav 220,144,172
v_add_u32 v4, 0x9000, v4
v_add_u32 v5, 0x9000, v5
Mvav 192,148,176
Mvav 200,148,180
s_waitcnt lgkmcnt(8)
Mvav 196,152,176
Mvav 204,152,180
Mvav 208,156,176
s_waitcnt lgkmcnt(0)
s_barrier
Mvav 216,156,180
Ta 144,2,0
Ta 146,2,2048
Mvav 212,160,176
Ta 148,3,0
Mvav 220,160,180
Ta 150,3,2048
Mvav 192,164,184
Ta 152,4,0
Mvav 200,164,188
Ta 154,4,2048
Mvav 196,168,184
Ta 156,5,0
Mvav 204,168,188
Ta 158,5,2048
Mvav 208,172,184
buffer_load_dword v17, v16, s[40:43], 0 offen sc1
Ta 160,2,4096
Mvav 216,172,188
Ta 162,2,6144
Ta 164,3,4096
Mvav 212,176,184
Ta 166,3,6144
v_mul_f32 v192, v38, v192
Mvav 220,176,188
s_waitcnt lgkmcnt(9)
Ta 168,4,4096
v_mul_f32 v193, v38, v193
v_mfma_f32_16x16x32_bf16 v[224:227], a[144:147], v[48:51], 0
Ta 170,4,6144
v_mul_f32 v194, v38, v194
v_mfma_f32_16x16x32_bf16 v[232:235], a[144:147], v[52:55], 0
s_waitcnt lgkmcnt(9)
Ta 172,5,4096
v_mul_f32 v195, v38, v195
v_mfma_f32_16x16x32_bf16 v[228:231], a[148:151], v[48:51], 0
LD 12,52,76,0
Ta 174,5,6144
v_mfma_f32_16x16x32_bf16 v[236:239], a[148:151], v[52:55], 0
s_waitcnt lgkmcnt(9)
Ta 176,2,8192
v_mul_f32 v196, v38, v196
v_mfma_f32_16x16x32_bf16 v[240:243], a[152:155], v[48:51], 0
Ta 178,2,10240
v_mul_f32 v197, v38, v197
v_mfma_f32_16x16x32_bf16 v[248:251], a[152:155], v[52:55], 0
s_waitcnt lgkmcnt(9)
Ta 144,3,8192
v_mul_f32 v198, v38, v198
v_mfma_f32_16x16x32_bf16 v[244:247], a[156:159], v[48:51], 0
Ta 146,3,10240
v_mul_f32 v199, v38, v199
v_mfma_f32_16x16x32_bf16 v[252:255], a[156:159], v[52:55], 0
s_waitcnt lgkmcnt(8)
Ta 148,4,8192
CV 192,192,193
Mvav 224,160,56
LD 13,52,76,1024
Ta 150,4,10240
Mvav 232,160,60
Ta 152,5,8192
CV 193,194,195
Mvav 228,164,56
Ta 154,5,10240
CV 194,196,197
CV 195,198,199
Mvav 236,164,60
s_waitcnt lgkmcnt(8)
Ta 156,2,12288
v_mul_f32 v200, v39, v200
Mvav 240,168,56
Ta 158,2,14336
v_mul_f32 v201, v39, v201
Mvav 248,168,60
Ta 160,3,12288
v_mul_f32 v202, v39, v202
Mvav 244,172,56
LD 14,52,76,2048
Ta 162,3,14336
Mvav 252,172,60
s_waitcnt lgkmcnt(8)
Ta 164,4,12288
v_mul_f32 v203, v39, v203
Mvav 224,176,64
Ta 166,4,14336
v_mul_f32 v204, v39, v204
Mvav 232,176,68
Ta 168,5,12288
v_mul_f32 v205, v39, v205
Mvav 228,144,64
Ta 170,5,14336
v_mul_f32 v206, v39, v206
Mvav 236,144,68
s_waitcnt lgkmcnt(8)
Ta 172,2,16384
v_mul_f32 v207, v39, v207
Mvav 240,148,64
LD 15,52,76,3072
Ta 174,2,18432
Mvav 248,148,68
s_add_u32 m0, s67, 0xa000
s_add_u32 s76, s73, 0x2d0000
Ta 176,3,16384
Mvav 244,152,64
Ta 178,3,18432
CV 200,200,201
Mvav 252,152,68
s_waitcnt lgkmcnt(8)
Ta 144,4,16384
Ta 146,4,18432
Mvav 224,156,72
Ta 148,5,16384
CV 201,202,203
Mvav 232,156,76
Ta 150,5,18432
CV 202,204,205
Mvav 228,160,72
LD 12,52,76,0
Ta 152,2,20480
Mvav 236,160,76
s_waitcnt lgkmcnt(9)
Ta 154,2,22528
CV 203,206,207
Mvav 240,164,72
Ta 156,3,20480
v_mul_f32 v208, v38, v208
Mvav 248,164,76
Ta 158,3,22528
v_mul_f32 v209, v38, v209
Mvav 244,168,72
Ta 160,4,20480
v_permlane32_swap_b32 v192, v194
Mvav 252,168,76
s_waitcnt lgkmcnt(9)
Ta 162,4,22528
v_permlane32_swap_b32 v193, v195
Mvav 224,172,80
LD 13,52,76,1024
Ta 164,5,20480
Mvav 232,172,84
Ta 166,5,22528
v_permlane16_swap_b32 v192, v194
Mvav 228,176,80
Ta 168,2,24576
v_permlane16_swap_b32 v193, v195
Mvav 236,176,84
s_waitcnt lgkmcnt(7)
Ta 170,2,26624
v_mul_f32 v210, v38, v210
Mvav 240,144,80
buffer_store_dwordx4 v[192:195], v7, s[40:43], s78 offen sc1
Ta 172,3,24576
Mvav 248,144,84
Ta 174,3,26624
Ta 176,4,24576
Mvav 244,148,80
Ta 178,4,26624
v_mul_f32 v211, v38, v211
Mvav 252,148,84
Ta 144,5,24576
v_mul_f32 v212, v38, v212
Mvav 224,152,88
s_waitcnt lgkmcnt(8)
Ta 146,5,26624
v_mul_f32 v213, v38, v213
Mvav 232,152,92
LD 14,52,76,2048
Ta 148,2,28672
Mvav 228,156,88
Ta 150,2,30720
v_mul_f32 v214, v38, v214
Mvav 236,156,92
Ta 152,3,28672
v_mul_f32 v215, v38, v215
Mvav 240,160,88
Ta 154,3,30720
s_waitcnt vmcnt(8)
v_cmp_ne_u32 vcc, s98, v17
s_cbranch_vccnz L_spin51
L_pollok51:
Mvav 248,160,92
s_waitcnt lgkmcnt(9)
buffer_load_dwordx2 a[196:197], v18, s[40:43], s5 offen sc1
Ta 156,4,28672
Mvav 244,164,88
Ta 158,4,30720
CV 208,208,209
Mvav 252,164,92
buffer_load_dwordx2 a[198:199], v18, s[40:43], s5 offen offset:512 sc1
Ta 160,5,28672
Mvav 224,168,96
s_waitcnt lgkmcnt(7)
Ta 162,5,30720
CV 209,210,211
Mvav 232,168,100
buffer_load_dwordx2 a[200:201], v18, s[40:43], s5 offen offset:1024 sc1
Ta 164,2,32768
Mvav 228,172,96
Ta 166,2,34816
Ta 168,3,32768
Mvav 236,172,100
buffer_load_dwordx2 a[202:203], v18, s[40:43], s5 offen offset:1536 sc1
Ta 170,3,34816
Mvav 240,176,96
Ta 172,4,32768
Ta 174,4,34816
Mvav 248,176,100
buffer_load_dwordx2 a[204:205], v18, s[40:43], s5 offen offset:2048 sc1
Ta 176,5,32768
Mvav 244,144,96
s_waitcnt lgkmcnt(9)
Ta 178,5,34816
v_add_u32 v2, 0x9000, v2
Mvav 252,144,100
buffer_load_dwordx2 a[206:207], v18, s[40:43], s5 offen offset:2560 sc1
v_add_u32 v3, 0x9000, v3
Mvav 224,148,104
v_permlane32_swap_b32 v200, v202
Mvav 232,148,108
buffer_load_dwordx2 a[208:209], v18, s[40:43], s5 offen offset:3072 sc1
v_add_u32 v4, 0x9000, v4
Mvav 228,152,104
v_permlane32_swap_b32 v201, v203
Mvav 236,152,108
buffer_load_dwordx2 a[210:211], v18, s[40:43], s5 offen offset:3584 sc1
v_permlane16_swap_b32 v200, v202
Mvav 240,156,104
s_waitcnt lgkmcnt(0)
s_barrier
v_permlane16_swap_b32 v201, v203
Mvav 248,156,108
buffer_load_dwordx2 a[212:213], v18, s[40:43], s6 offen sc1
Ta 144,2,0
Mvav 244,160,104
s_mov_b32 s5, 0x242000
Ta 146,2,2048
v_add_u32 v5, 0x9000, v5
Mvav 252,160,108
buffer_load_dwordx2 a[214:215], v18, s[40:43], s6 offen offset:512 sc1
Ta 148,3,0
Ta 150,3,2048
Mvav 224,164,112
LD 15,52,76,3072
Ta 152,4,0
Mvav 232,164,116
s_add_u32 m0, s67, 0xb000
s_add_u32 s76, s73, 0x318000
Ta 154,4,2048
Mvav 228,168,112
s_mov_b32 s6, 0x243000
Ta 156,5,0
Ta 158,5,2048
Mvav 236,168,116
Ta 160,2,4096
Ta 162,2,6144
Mvav 240,172,112
buffer_load_dwordx4 a[0:3], v6, s[40:43], s7 offen sc1
Ta 164,3,4096
Mvav 248,172,116
Ta 166,3,6144
Ta 168,4,4096
Mvav 244,176,112
Ta 170,4,6144
Ta 172,5,4096
Mvav 252,176,116
s_waitcnt lgkmcnt(11)
Ta 174,5,6144
Ta 176,2,8192
Mvav 224,144,120
LD 12,52,76,0
Ta 178,2,10240
Mvav 232,144,124
s_add_u32 m0, s67, 0x12000
s_add_u32 s76, s73, 0x80
Ta 144,3,8192
Mvav 228,148,120
Ta 146,3,10240
CV 210,212,213
Mvav 236,148,124
s_waitcnt lgkmcnt(10)
Ta 148,4,8192
Ta 150,4,10240
Mvav 240,152,120
buffer_load_dwordx4 a[4:7], v6, s[40:43], s7 offen offset:256 sc1
CV 211,214,215
Mvav 248,152,124
Ta 152,5,8192
Ta 154,5,10240
Mvav 244,156,120
v_permlane32_swap_b32 v208, v210
Mvav 252,156,124
Ta 156,2,12288
Ta 158,2,14336
Mvav 224,160,128
buffer_load_dwordx4 a[8:11], v6, s[40:43], s7 offen offset:2048 sc1
v_mul_f32 v216, v39, v216
Mvav 232,160,132
s_waitcnt lgkmcnt(8)
Ta 160,3,12288
Ta 162,3,14336
Mvav 228,164,128
v_permlane32_swap_b32 v209, v211
Mvav 236,164,132
Ta 164,4,12288
Ta 166,4,14336
Mvav 240,168,128
buffer_load_dwordx4 a[12:15], v6, s[40:43], s7 offen offset:2304 sc1
v_mul_f32 v217, v39, v217
Mvav 248,168,132
s_mov_b32 s7, 0x244000
Ta 168,5,12288
Ta 170,5,14336
Mvav 244,172,128
v_permlane16_swap_b32 v208, v210
Mvav 252,172,132
Ta 172,2,16384
Ta 174,2,18432
Mvav 224,176,136
buffer_load_dwordx4 a[16:19], v6, s[40:43], s4 offen sc1
v_permlane16_swap_b32 v209, v211
Mvav 232,176,140
s_waitcnt lgkmcnt(6)
Ta 176,3,16384
Ta 178,3,18432
Mvav 228,144,136
v_mul_f32 v218, v39, v218
v_mul_f32 v219, v39, v219
v_mul_f32 v220, v39, v220
Mvav 236,144,140
Ta 144,4,16384
LD 12,52,76,0
Mvav 240,148,136
Ta 146,4,18432
v_mul_f32 v221, v39, v221
Mvav 248,148,140
Ta 148,5,16384
Ta 150,5,18432
Mvav 244,152,136
v_mul_f32 v222, v39, v222
v_mul_f32 v223, v39, v223
Mvav 252,152,140
buffer_store_dwordx4 v[200:203], v7, s[40:43], s78 offen offset:1024 sc1
Ta 152,2,20480
Mvav 224,156,144
Ta 154,2,22528
CV 216,216,217
Mvav 232,156,148
Ta 156,3,20480
Ta 158,3,22528
Mvav 228,160,144
CV 217,218,219
CV 218,220,221
Mvav 236,160,148
s_waitcnt lgkmcnt(7)
Ta 160,4,20480
Ta 162,4,22528
Mvav 240,164,144
buffer_load_dwordx4 a[20:23], v6, s[40:43], s4 offen offset:256 sc1
CV 219,222,223
Mvav 248,164,148
s_lshl_b32 s85, s30, 7
Ta 164,5,20480
Ta 166,5,22528
Mvav 244,168,144
s_add_u32 s85, s85, 0x4000
v_permlane32_swap_b32 v216, v218
Mvav 252,168,148
s_getpc_b64 s[96:97]
Ta 168,2,24576
Ta 170,2,26624
Mvav 224,172,152
LD 13,52,76,1024
v_mov_b32 v46, s85
Mvav 232,172,156
Ta 172,3,24576
Ta 174,3,26624
Mvav 228,176,152
v_permlane32_swap_b32 v217, v219
Mvav 236,176,156
s_waitcnt lgkmcnt(6)
Ta 176,4,24576
Ta 178,4,26624
Mvav 240,144,152
buffer_load_dwordx4 a[24:27], v6, s[40:43], s4 offen offset:2048 sc1
v_permlane16_swap_b32 v216, v218
Mvav 248,144,156
Ta 144,5,24576
Ta 146,5,26624
Mvav 244,148,152
v_permlane16_swap_b32 v217, v219
Mvav 252,148,156
Ta 148,2,28672
Ta 150,2,30720
Mvav 224,152,160
LD 14,52,76,2048
s_waitcnt vmcnt(22)
v_accvgpr_read_b32 v24, a196
Mvav 232,152,164
Ta 152,3,28672
Ta 154,3,30720
Mvav 228,156,160
s_waitcnt vmcnt(21)
v_accvgpr_read_b32 v28, a198
s_waitcnt vmcnt(20)
v_accvgpr_read_b32 v26, a200
Mvav 236,156,164
s_waitcnt lgkmcnt(4)
Ta 156,4,28672
Ta 158,4,30720
Mvav 240,160,160
buffer_load_dwordx4 a[28:31], v6, s[40:43], s4 offen offset:2304 sc1
v_add_f32 v24, v24, v28
Mvav 248,160,164
s_mov_b32 s4, 0x245000
Ta 160,5,28672
Ta 162,5,30720
Mvav 244,164,160
v_add_f32 v24, v24, v26
s_waitcnt vmcnt(20)
v_accvgpr_read_b32 v28, a202
Mvav 252,164,164
Ta 164,2,32768
Ta 166,2,34816
Mvav 224,168,168
LD 15,52,76,3072
v_add_f32 v24, v24, v28
Mvav 232,168,172
s_add_u32 m0, s67, 0x13000
s_add_u32 s76, s73, 0x48080
Ta 168,3,32768
Mvav 228,172,168
Ta 170,3,34816
s_waitcnt vmcnt(20)
v_accvgpr_read_b32 v26, a204
Mvav 236,172,172
Ta 172,4,32768
Ta 174,4,34816
Mvav 240,176,168
buffer_load_dwordx4 a[32:35], v6, s[40:43], s5 offen sc1
v_add_f32 v24, v24, v26
Mvav 248,176,172
Ta 176,5,32768
Ta 178,5,34816
Mvav 244,144,168
s_waitcnt vmcnt(20)
v_accvgpr_read_b32 v28, a206
s_waitcnt vmcnt(19)
v_accvgpr_read_b32 v26, a208
Mvav 252,144,172
v_add_f32 v24, v24, v28
s_waitcnt vmcnt(18)
s_waitcnt lgkmcnt(8)
v_accvgpr_read_b32 v28, a210
Mvav 224,148,176
LD 12,52,76,0
v_add_f32 v24, v24, v26
Mvav 232,148,180
v_add_f32 v24, v24, v28
s_waitcnt vmcnt(18)
v_accvgpr_read_b32 v26, a212
Mvav 228,152,176
v_add_f32 v24, v24, v26
s_waitcnt vmcnt(17)
v_accvgpr_read_b32 v28, a214
v_accvgpr_read_b32 v25, a197
Mvav 236,152,180
s_waitcnt lgkmcnt(0)
s_barrier
v_add_f32 v24, v24, v28
v_accvgpr_read_b32 v29, a199
Mvav 240,156,176
buffer_load_dwordx4 a[36:39], v6, s[40:43], s5 offen offset:256 sc1
v_mov_b32 v26, v24
Mvav 248,156,180
s_nop 0
v_permlane16_swap_b32 v24, v26
Mvav 244,160,176
v_add_f32 v24, v24, v26
v_add_f32 v25, v25, v29
Mvav 252,160,180
v_mul_f32 v24, 0xbae38e39, v24
v_accvgpr_read_b32 v27, a201
Mvav 224,164,184
buffer_store_dwordx4 v[208:211], v7, s[40:43], s78 offen offset:2048 sc1
v_mov_b32 v67, v24
Mvav 232,164,188
v_mov_b32 v68, v24
v_add_f32 v25, v25, v27
Mvav 228,168,184
v_permlane32_swap_b32 v67, v68
Mvav 236,168,188
v_mul_f32 v224, v38, v224
v_mul_f32 v225, v38, v225
Mvav 240,172,184
v_mul_f32 v232, v39, v232
v_mul_f32 v233, v39, v233
Mvav 248,172,188
LD 13,52,76,1024
v_mul_f32 v226, v38, v226
Mvav 244,176,184
v_mul_f32 v227, v38, v227
v_mul_f32 v234, v39, v234
Mvav 252,176,188
buffer_load_dwordx4 a[40:43], v6, s[40:43], s5 offen offset:2048 sc1
LD 14,52,76,2048
buffer_load_dwordx4 a[44:47], v6, s[40:43], s5 offen offset:2304 sc1
LD 15,52,76,3072
s_add_u32 m0, s67, 0x14000
buffer_load_dwordx4 a[48:51], v6, s[40:43], s6 offen sc1
s_add_u32 s76, s73, 0x90080
L_pg1_7:
s_cbranch_execz L_ret1
v_mul_f32 v240, v38, v240
v_mul_f32 v241, v38, v241
v_mul_f32 v248, v39, v248
v_mul_f32 v249, v39, v249
v_mul_f32 v235, v39, v235
v_mul_f32 v242, v38, v242
v_mul_f32 v243, v38, v243
v_mul_f32 v250, v39, v250
v_mul_f32 v251, v39, v251
v_mul_f32 v228, v38, v228
v_mul_f32 v229, v38, v229
v_mul_f32 v230, v38, v230
v_mul_f32 v231, v38, v231
LD 12,52,76,0
CV 224,224,225
v_mul_f32 v236, v39, v236
v_mul_f32 v237, v39, v237
v_mul_f32 v238, v39, v238
v_mul_f32 v239, v39, v239
CV 232,232,233
v_mul_f32 v244, v38, v244
v_mul_f32 v245, v38, v245
v_mul_f32 v246, v38, v246
v_mul_f32 v247, v38, v247
CV 240,240,241
v_mul_f32 v252, v39, v252
v_mul_f32 v253, v39, v253
v_mul_f32 v254, v39, v254
v_mul_f32 v255, v39, v255
CV 248,248,249
CV 225,226,227
CV 233,234,235
CV 241,242,243
CV 249,250,251
CV 226,228,229
CV 227,230,231
CV 234,236,237
CV 235,238,239
CV 242,244,245
CV 243,246,247
CV 250,252,253
CV 251,254,255
v_permlane32_swap_b32 v224, v226
v_permlane32_swap_b32 v225, v227
s_waitcnt vmcnt(24)
v_permlane32_swap_b32 v232, v234
v_permlane32_swap_b32 v233, v235
v_permlane32_swap_b32 v240, v242
v_permlane32_swap_b32 v241, v243
v_permlane32_swap_b32 v248, v250
v_permlane32_swap_b32 v249, v251
v_permlane16_swap_b32 v224, v226
v_permlane16_swap_b32 v225, v227
v_permlane16_swap_b32 v232, v234
v_permlane16_swap_b32 v233, v235
v_permlane16_swap_b32 v240, v242
v_permlane16_swap_b32 v241, v243
v_permlane16_swap_b32 v248, v250
v_permlane16_swap_b32 v249, v251
buffer_store_dwordx4 v[216:219], v7, s[40:43], s78 offen offset:3072 sc1
buffer_store_dwordx4 v[224:227], v7, s[40:43], s79 offen sc1
buffer_store_dwordx4 v[232:235], v7, s[40:43], s79 offen offset:1024 sc1
s_add_u32 m0, s67, 0x1b000
s_add_u32 s76, s73, 0x288080
v_mov_b32 v64, v67
v_mov_b32 v65, v67
v_mov_b32 v66, v67
v_mov_b32 v69, v68
v_mov_b32 v70, v68
v_mfma_f32_16x16x32_bf16 v[72:75], a[232:235], a[0:3], v[64:67]
s_mov_b32 s5, 0x246000
v_mov_b32 v71, v68
v_accvgpr_read_b32 v29, a203
v_accvgpr_read_b32 v27, a205
v_mfma_f32_16x16x32_bf16 v[76:79], a[228:231], a[0:3], v[64:67]
s_waitcnt vmcnt(25)
s_mul_i32 s78, s16, 0x11000
v_add_f32 v25, v25, v29
v_accvgpr_read_b32 v29, a207
v_add_f32 v25, v25, v27
v_accvgpr_read_b32 v27, a209
v_mfma_f32_16x16x32_bf16 v[80:83], a[232:235], a[4:7], v[68:71]
s_add_u32 s78, s78, s13
v_add_f32 v25, v25, v29
v_accvgpr_read_b32 v29, a211
v_add_f32 v25, v25, v27
v_accvgpr_read_b32 v27, a213
v_mfma_f32_16x16x32_bf16 v[84:87], a[228:231], a[4:7], v[68:71]
s_waitcnt vmcnt(24)
s_add_u32 s78, s78, 0
v_add_f32 v25, v25, v29
v_accvgpr_read_b32 v29, a215
v_add_f32 v25, v25, v27
v_add_u32 v2, 0xfffe5000, v2
v_mfma_f32_16x16x32_bf16 v[88:91], a[232:235], a[8:11], v[64:67]
s_add_u32 s16, s66, 2
Ta 144,2,0
Ta 146,2,2048
v_add_f32 v25, v25, v29
v_mfma_f32_16x16x32_bf16 v[92:95], a[228:231], a[8:11], v[64:67]
s_waitcnt vmcnt(23)
s_and_b32 s16, s16, 7
Ta 160,2,4096
v_mov_b32 v27, v25
v_add_u32 v3, 0xfffe5000, v3
v_add_u32 v4, 0xfffe5000, v4
v_mfma_f32_16x16x32_bf16 v[96:99], a[232:235], a[12:15], v[68:71]
s_mul_i32 s80, s16, 0x11000
Ta 148,3,0
Ta 150,3,2048
v_permlane16_swap_b32 v25, v27
v_mfma_f32_16x16x32_bf16 v[100:103], a[228:231], a[12:15], v[68:71]
s_waitcnt vmcnt(22)
s_add_u32 s80, s80, s13
Ta 152,4,0
Ta 154,4,2048
v_add_f32 v25, v25, v27
v_mfma_f32_16x16x32_bf16 v[104:107], a[232:235], a[16:19], v[64:67]
s_add_u32 s80, s80, 0x2000
Ta 162,2,6144
v_mul_f32 v25, 0x3ae38e39, v25
v_add_u32 v5, 0xfffe5000, v5
v_mfma_f32_16x16x32_bf16 v[108:111], a[228:231], a[16:19], v[64:67]
s_waitcnt vmcnt(19)
s_add_u32 s11, s11, s16
Ta 156,5,0
Ta 158,5,2048
v_fma_f32 v25, -v24, v24, v25
v_mfma_f32_16x16x32_bf16 v[112:115], a[232:235], a[20:23], v[68:71]
s_lshl_b32 s11, s11, 7
Ta 164,3,4096
v_max_f32 v25, 0, v25
v_lshlrev_b32 v17, 8, s66
v_add_f32 v25, 0x3727c5ac, v25
v_mfma_f32_16x16x32_bf16 v[116:119], a[228:231], a[20:23], v[68:71]
buffer_store_dwordx4 v[240:243], v7, s[40:43], s79 offen offset:2048 sc1
buffer_store_dwordx4 v[248:251], v7, s[40:43], s79 offen offset:3072 sc1
buffer_load_dwordx4 a[52:55], v6, s[40:43], s6 offen offset:256 sc1
global_load_dword a252, v46, s[96:97]
buffer_load_dwordx4 a[56:59], v6, s[40:43], s6 offen offset:2048 sc1
v_rsq_f32 v25, v25
Ta 166,3,6144
Ta 168,4,4096
v_mul_f32 v44, 0x3eeff558, v25
buffer_load_dwordx4 a[60:63], v6, s[40:43], s6 offen offset:2304 sc1
v_mov_b32 v45, v44
s_waitcnt lgkmcnt(2)
Ta 170,4,6144
s_nop 0
v_permlane32_swap_b32 v44, v45
Ta 172,5,4096
Ta 174,5,6144
v_mul_f32 v72, v44, v72
v_mul_f32 v73, v44, v73
v_mul_f32 v74, v44, v74
v_mul_f32 v75, v44, v75
v_mul_f32 v76, v44, v76
v_mul_f32 v77, v44, v77
v_mul_f32 v78, v44, v78
v_mul_f32 v79, v44, v79
buffer_load_dwordx4 a[64:67], v6, s[40:43], s7 offen sc1
CV 72,72,73
CV 74,74,75
CV 76,76,77
CV 78,78,79
v_accvgpr_write_b32 a0, v72
v_accvgpr_write_b32 a1, v74
v_accvgpr_write_b32 a2, v76
v_accvgpr_write_b32 a3, v78
Ta 176,2,8192
v_mul_f32 v80, v45, v80
v_mfma_f32_16x16x32_bf16 v[192:195], a[144:147], a[0:3], 0
v_mul_f32 v81, v45, v81
LD 12,52,76,0
v_mul_f32 v82, v45, v82
v_mul_f32 v83, v45, v83
v_mul_f32 v84, v45, v84
v_mul_f32 v85, v45, v85
v_mul_f32 v86, v45, v86
v_mul_f32 v87, v45, v87
CV 80,80,81
CV 82,82,83
CV 84,84,85
CV 86,86,87
v_accvgpr_write_b32 a4, v80
v_accvgpr_write_b32 a5, v82
v_accvgpr_write_b32 a6, v84
v_accvgpr_write_b32 a7, v86
Ta 178,2,10240
s_mov_b32 s6, 0x247000
v_mfma_f32_16x16x32_bf16 v[200:203], a[144:147], a[4:7], 0
s_mul_i32 s79, s17, 0x11000
Ta 144,3,8192
v_mul_f32 v88, v44, v88
v_mul_f32 v89, v44, v89
v_mul_f32 v90, v44, v90
v_mfma_f32_16x16x32_bf16 v[196:199], a[148:151], a[0:3], 0
s_add_u32 s79, s79, s13
Ta 146,3,10240
v_mul_f32 v91, v44, v91
v_mul_f32 v92, v44, v92
v_mul_f32 v93, v44, v93
v_mfma_f32_16x16x32_bf16 v[204:207], a[148:151], a[4:7], 0
s_add_u32 s79, s79, 0x1000
Ta 148,4,8192
v_mul_f32 v94, v44, v94
v_mul_f32 v95, v44, v95
CV 88,88,89
v_mfma_f32_16x16x32_bf16 v[208:211], a[152:155], a[0:3], 0
s_add_u32 s11, s11, 0x3010008
Ta 150,4,10240
CV 90,90,91
CV 92,92,93
v_mfma_f32_16x16x32_bf16 v[216:219], a[152:155], a[4:7], 0
s_add_u32 s17, s66, 3
Ta 152,5,8192
CV 94,94,95
v_accvgpr_write_b32 a8, v88
v_accvgpr_write_b32 a9, v90
v_mfma_f32_16x16x32_bf16 v[212:215], a[156:159], a[0:3], 0
s_and_b32 s17, s17, 7
Ta 154,5,10240
v_accvgpr_write_b32 a10, v92
v_accvgpr_write_b32 a11, v94
v_mul_f32 v96, v45, v96
v_mfma_f32_16x16x32_bf16 v[220:223], a[156:159], a[4:7], 0
s_waitcnt vmcnt(25)
s_mul_i32 s81, s17, 0x11000
Ta 156,2,12288
v_mul_f32 v97, v45, v97
v_mul_f32 v98, v45, v98
v_mul_f32 v99, v45, v99
v_mfma_f32_16x16x32_bf16 v[72:75], a[232:235], a[24:27], v[64:67]
s_add_u32 s81, s81, s13
Ta 158,2,14336
v_mul_f32 v100, v45, v100
v_mul_f32 v101, v45, v101
v_mul_f32 v102, v45, v102
v_mfma_f32_16x16x32_bf16 v[76:79], a[228:231], a[24:27], v[64:67]
s_waitcnt vmcnt(23)
s_add_u32 s81, s81, 0x3000
v_mul_f32 v103, v45, v103
CV 96,96,97
CV 98,98,99
CV 100,100,101
v_mfma_f32_16x16x32_bf16 v[80:83], a[232:235], a[28:31], v[68:71]
s_add_u32 s16, s66, 4
CV 102,102,103
v_accvgpr_write_b32 a12, v96
v_accvgpr_write_b32 a13, v98
v_accvgpr_write_b32 a14, v100
v_mfma_f32_16x16x32_bf16 v[84:87], a[228:231], a[28:31], v[68:71]
s_and_b32 s16, s16, 7
v_accvgpr_write_b32 a15, v102
v_mul_f32 v104, v44, v104
v_mul_f32 v105, v44, v105
v_mul_f32 v106, v44, v106
Mvaa 192,160,8
buffer_load_dwordx4 a[68:71], v6, s[40:43], s7 offen offset:256 sc1
v_mul_f32 v107, v44, v107
v_mul_f32 v108, v44, v108
Mvaa 200,160,12
s_waitcnt lgkmcnt(1)
Ta 160,3,12288
v_mul_f32 v109, v44, v109
v_mul_f32 v110, v44, v110
v_mul_f32 v111, v44, v111
Mvaa 196,164,8
Ta 162,3,14336
CV 104,104,105
CV 106,106,107
CV 108,108,109
Mvaa 204,164,12
buffer_load_dwordx4 a[72:75], v6, s[40:43], s7 offen offset:2048 sc1
Ta 164,4,12288
CV 110,110,111
Mvaa 208,168,8
Ta 166,4,14336
v_accvgpr_write_b32 a16, v104
v_accvgpr_write_b32 a17, v106
v_accvgpr_write_b32 a18, v108
Mvaa 216,168,12
Ta 168,5,12288
v_accvgpr_write_b32 a19, v110
v_mul_f32 v112, v45, v112
v_mul_f32 v113, v45, v113
Mvaa 212,172,8
LD 13,52,76,1024
Ta 170,5,14336
v_mul_f32 v114, v45, v114
Mvaa 220,172,12
s_waitcnt vmcnt(24)
Ta 172,2,16384
v_mul_f32 v115, v45, v115
v_mul_f32 v116, v45, v116
v_mul_f32 v117, v45, v117
v_mfma_f32_16x16x32_bf16 v[88:91], a[232:235], a[32:35], v[64:67]
Ta 174,2,18432
v_mul_f32 v118, v45, v118
v_mul_f32 v119, v45, v119
v_mfma_f32_16x16x32_bf16 v[92:95], a[228:231], a[32:35], v[64:67]
s_waitcnt vmcnt(22)
buffer_load_dwordx4 a[76:79], v6, s[40:43], s7 offen offset:2304 sc1
CV 112,112,113
CV 114,114,115
CV 116,116,117
v_mfma_f32_16x16x32_bf16 v[96:99], a[232:235], a[36:39], v[68:71]
s_mov_b32 s7, 0x248000
CV 118,118,119
v_accvgpr_write_b32 a20, v112
v_accvgpr_write_b32 a21, v114
v_accvgpr_write_b32 a22, v116
v_mfma_f32_16x16x32_bf16 v[100:103], a[228:231], a[36:39], v[68:71]
v_accvgpr_write_b32 a23, v118
v_mul_f32 v72, v44, v72
v_mul_f32 v73, v44, v73
v_mul_f32 v74, v44, v74
Mvaa 192,176,16
s_waitcnt vmcnt(10)
buffer_store_dword v47, off, s[40:43], s8 sc1
v_mul_f32 v75, v44, v75
v_mul_f32 v76, v44, v76
v_mul_f32 v77, v44, v77
Mvaa 200,176,20
LD 14,52,76,2048
Ta 176,3,16384
v_mul_f32 v78, v44, v78
Mvaa 196,144,16
s_lshl_b32 s8, s94, 3
Ta 178,3,18432
v_mul_f32 v79, v44, v79
CV 72,72,73
CV 74,74,75
Mvaa 204,144,20
s_add_u32 s8, s8, s17
Ta 144,4,16384
CV 76,76,77
CV 78,78,79
v_accvgpr_write_b32 a24, v72
Mvaa 208,148,16
buffer_load_dwordx4 a[80:83], v6, s[40:43], s4 offen sc1
Ta 146,4,18432
Mvaa 216,148,20
s_lshl_b32 s8, s8, 7
Ta 148,5,16384
v_accvgpr_write_b32 a25, v74
v_accvgpr_write_b32 a26, v76
v_accvgpr_write_b32 a27, v78
v_mul_f32 v80, v45, v80
Mvaa 212,152,16
s_add_u32 s8, s8, 0x301000c
Ta 150,5,18432
v_mul_f32 v81, v45, v81
v_mul_f32 v82, v45, v82
v_mul_f32 v83, v45, v83
Mvaa 220,152,20
buffer_load_dwordx4 a[84:87], v6, s[40:43], s4 offen offset:256 sc1
Ta 152,2,20480
v_mul_f32 v84, v45, v84
v_mfma_f32_16x16x32_bf16 v[104:107], a[232:235], a[40:43], v[64:67]
s_add_u32 s17, s66, 5
Ta 154,2,22528
v_mul_f32 v85, v45, v85
v_mul_f32 v86, v45, v86
v_mul_f32 v87, v45, v87
v_mfma_f32_16x16x32_bf16 v[108:111], a[228:231], a[40:43], v[64:67]
s_and_b32 s17, s17, 7
CV 80,80,81
CV 82,82,83
CV 84,84,85
CV 86,86,87
v_mfma_f32_16x16x32_bf16 v[112:115], a[232:235], a[44:47], v[68:71]
LD 15,52,76,3072
v_accvgpr_write_b32 a28, v80
v_accvgpr_write_b32 a29, v82
v_accvgpr_write_b32 a30, v84
v_mfma_f32_16x16x32_bf16 v[116:119], a[228:231], a[44:47], v[68:71]
s_waitcnt lgkmcnt(3)
s_add_u32 m0, s67, 0x1c000
s_add_u32 s76, s73, 0x2d0080
v_accvgpr_write_b32 a31, v86
v_mul_f32 v88, v44, v88
v_mul_f32 v89, v44, v89
Mvaa 192,156,24
v_mul_f32 v90, v44, v90
v_mul_f32 v91, v44, v91
v_mul_f32 v92, v44, v92
Mvaa 200,156,28
buffer_load_dwordx4 a[88:91], v6, s[40:43], s4 offen offset:2048 sc1
Ta 156,3,20480
v_mul_f32 v93, v44, v93
Mvaa 196,160,24
Ta 158,3,22528
v_mul_f32 v94, v44, v94
v_mul_f32 v95, v44, v95
CV 88,88,89
Mvaa 204,160,28
Ta 160,4,20480
CV 90,90,91
CV 92,92,93
CV 94,94,95
Mvaa 208,164,24
buffer_load_dwordx4 a[92:95], v6, s[40:43], s4 offen offset:2304 sc1
Ta 162,4,22528
v_accvgpr_write_b32 a32, v88
Mvaa 216,164,28
s_add_u32 s4, s29, 0x240000
Ta 164,5,20480
v_accvgpr_write_b32 a33, v90
v_accvgpr_write_b32 a34, v92
v_accvgpr_write_b32 a35, v94
Mvaa 212,168,24
Ta 166,5,22528
v_mul_f32 v96, v45, v96
v_mul_f32 v97, v45, v97
v_mul_f32 v98, v45, v98
Mvaa 220,168,28
LD 12,52,76,0
Ta 168,2,24576
v_mul_f32 v99, v45, v99
v_mfma_f32_16x16x32_bf16 v[72:75], a[232:235], a[48:51], v[64:67]
Ta 170,2,26624
v_mul_f32 v100, v45, v100
v_mul_f32 v101, v45, v101
v_mfma_f32_16x16x32_bf16 v[76:79], a[228:231], a[48:51], v[64:67]
s_waitcnt vmcnt(17)
v_mul_f32 v102, v45, v102
v_mul_f32 v103, v45, v103
CV 96,96,97
CV 98,98,99
v_mfma_f32_16x16x32_bf16 v[80:83], a[232:235], a[52:55], v[68:71]
buffer_load_dwordx4 a[96:99], v6, s[40:43], s5 offen sc1
CV 100,100,101
CV 102,102,103
v_accvgpr_write_b32 a36, v96
v_mfma_f32_16x16x32_bf16 v[84:87], a[228:231], a[52:55], v[68:71]
v_accvgpr_write_b32 a37, v98
v_accvgpr_write_b32 a38, v100
v_accvgpr_write_b32 a39, v102
v_mul_f32 v104, v44, v104
Mvaa 192,172,32
v_mul_f32 v105, v44, v105
v_mul_f32 v106, v44, v106
v_mul_f32 v107, v44, v107
v_mul_f32 v108, v44, v108
Mvaa 200,172,36
LD 13,52,76,1024
Ta 172,3,24576
v_mul_f32 v109, v44, v109
Mvaa 196,176,32
Ta 174,3,26624
v_mul_f32 v110, v44, v110
v_mul_f32 v111, v44, v111
CV 104,104,105
Mvaa 204,176,36
Ta 176,4,24576
CV 106,106,107
CV 108,108,109
CV 110,110,111
Mvaa 208,144,32
buffer_load_dwordx4 a[100:103], v6, s[40:43], s5 offen offset:256 sc1
Ta 178,4,26624
Mvaa 216,144,36
s_waitcnt lgkmcnt(4)
Ta 144,5,24576
v_accvgpr_write_b32 a40, v104
v_accvgpr_write_b32 a41, v106
v_accvgpr_write_b32 a42, v108
v_accvgpr_write_b32 a43, v110
Mvaa 212,148,32
Ta 146,5,26624
v_mul_f32 v112, v45, v112
v_mul_f32 v113, v45, v113
v_mul_f32 v114, v45, v114
Mvaa 220,148,36
s_waitcnt vmcnt(18)
buffer_load_dwordx4 a[104:107], v6, s[40:43], s5 offen offset:2048 sc1
Ta 148,2,28672
v_mul_f32 v115, v45, v115
v_mfma_f32_16x16x32_bf16 v[88:91], a[232:235], a[56:59], v[64:67]
Ta 150,2,30720
v_mul_f32 v116, v45, v116
v_mul_f32 v117, v45, v117
v_mul_f32 v118, v45, v118
v_mfma_f32_16x16x32_bf16 v[92:95], a[228:231], a[56:59], v[64:67]
s_waitcnt vmcnt(18)
v_mul_f32 v119, v45, v119
CV 112,112,113
CV 114,114,115
CV 116,116,117
v_mfma_f32_16x16x32_bf16 v[96:99], a[232:235], a[60:63], v[68:71]
LD 14,52,76,2048
CV 118,118,119
v_accvgpr_write_b32 a44, v112
v_accvgpr_write_b32 a45, v114
v_mfma_f32_16x16x32_bf16 v[100:103], a[228:231], a[60:63], v[68:71]
v_accvgpr_write_b32 a46, v116
v_accvgpr_write_b32 a47, v118
v_mul_f32 v72, v44, v72
v_mul_f32 v73, v44, v73
Mvaa 192,152,40
v_mul_f32 v74, v44, v74
v_mul_f32 v75, v44, v75
v_mul_f32 v76, v44, v76
Mvaa 200,152,44
buffer_load_dwordx4 a[108:111], v6, s[40:43], s5 offen offset:2304 sc1
Ta 152,3,28672
v_mul_f32 v77, v44, v77
Mvaa 196,156,40
s_add_u32 s5, s19, 0x1000
Ta 154,3,30720
v_mul_f32 v78, v44, v78
v_mul_f32 v79, v44, v79
CV 72,72,73
Mvaa 204,156,44
Ta 156,4,28672
CV 74,74,75
CV 76,76,77
CV 78,78,79
Mvaa 208,160,40
buffer_load_dwordx4 a[112:115], v6, s[40:43], s6 offen sc1
Ta 158,4,30720
v_accvgpr_write_b32 a48, v72
Mvaa 216,160,44
Ta 160,5,28672
v_accvgpr_write_b32 a49, v74
v_accvgpr_write_b32 a50, v76
v_accvgpr_write_b32 a51, v78
Mvaa 212,164,40
Ta 162,5,30720
v_mul_f32 v80, v45, v80
v_mul_f32 v81, v45, v81
v_mul_f32 v82, v45, v82
Mvaa 220,164,44
s_waitcnt vmcnt(20)
LD 15,52,76,3072
Ta 164,2,32768
s_add_u32 m0, s67, 0x1d000
s_add_u32 s76, s73, 0x318080
v_mfma_f32_16x16x32_bf16 v[104:107], a[232:235], a[64:67], v[64:67]
Ta 166,2,34816
v_mul_f32 v83, v45, v83
v_mul_f32 v84, v45, v84
v_mfma_f32_16x16x32_bf16 v[108:111], a[228:231], a[64:67], v[64:67]
s_waitcnt vmcnt(19)
v_mul_f32 v85, v45, v85
v_mul_f32 v86, v45, v86
v_mul_f32 v87, v45, v87
CV 80,80,81
v_mfma_f32_16x16x32_bf16 v[112:115], a[232:235], a[68:71], v[68:71]
buffer_load_dwordx4 a[116:119], v6, s[40:43], s6 offen offset:256 sc1
CV 82,82,83
CV 84,84,85
CV 86,86,87
v_mfma_f32_16x16x32_bf16 v[116:119], a[228:231], a[68:71], v[68:71]
v_accvgpr_write_b32 a52, v80
v_accvgpr_write_b32 a53, v82
v_accvgpr_write_b32 a54, v84
v_accvgpr_write_b32 a55, v86
Mvaa 192,168,48
s_waitcnt lgkmcnt(1)
v_mul_f32 v88, v44, v88
v_mul_f32 v89, v44, v89
v_mul_f32 v90, v44, v90
v_mul_f32 v91, v44, v91
Mvaa 200,168,52
LD 12,52,76,0
Ta 168,3,32768
v_mul_f32 v92, v44, v92
Mvaa 196,172,48
s_add_u32 m0, s67, 0
Ta 170,3,34816
v_mul_f32 v93, v44, v93
v_mul_f32 v94, v44, v94
v_mul_f32 v95, v44, v95
Mvaa 204,172,52
s_add_u32 s76, s73, 0x100
Ta 172,4,32768
CV 88,88,89
CV 90,90,91
CV 92,92,93
Mvaa 208,176,48
buffer_load_dwordx4 a[120:123], v6, s[40:43], s6 offen offset:2048 sc1
Ta 174,4,34816
Mvaa 216,176,52
Ta 176,5,32768
CV 94,94,95
v_accvgpr_write_b32 a56, v88
v_accvgpr_write_b32 a57, v90
v_accvgpr_write_b32 a58, v92
Mvaa 212,144,48
Ta 178,5,34816
v_accvgpr_write_b32 a59, v94
v_mul_f32 v96, v45, v96
v_mul_f32 v97, v45, v97
Mvaa 220,144,52
s_waitcnt vmcnt(21)
buffer_load_dwordx4 a[124:127], v6, s[40:43], s6 offen offset:2304 sc1
v_mul_f32 v98, v45, v98
v_mul_f32 v99, v45, v99
v_mul_f32 v100, v45, v100
v_mfma_f32_16x16x32_bf16 v[72:75], a[232:235], a[72:75], v[64:67]
s_add_u32 s6, s19, 0x2000
v_mul_f32 v101, v45, v101
v_mul_f32 v102, v45, v102
v_mul_f32 v103, v45, v103
CV 96,96,97
v_mfma_f32_16x16x32_bf16 v[76:79], a[228:231], a[72:75], v[64:67]
s_waitcnt vmcnt(20)
CV 98,98,99
CV 100,100,101
CV 102,102,103
v_accvgpr_write_b32 a60, v96
v_mfma_f32_16x16x32_bf16 v[80:83], a[232:235], a[76:79], v[68:71]
v_accvgpr_write_b32 a61, v98
v_accvgpr_write_b32 a62, v100
v_accvgpr_write_b32 a63, v102
v_lshl_add_u32 v16, v1, 2, v17
v_mfma_f32_16x16x32_bf16 v[84:87], a[228:231], a[76:79], v[68:71]
s_waitcnt lgkmcnt(0)
s_barrier
v_add_u32 v16, 0x300c000, v16
v_mul_f32 v104, v44, v104
v_mul_f32 v105, v44, v105
v_mul_f32 v106, v44, v106
Mvaa 192,148,56
buffer_load_dwordx4 a[128:131], v6, s[40:43], s7 offen sc1
v_mul_f32 v107, v44, v107
v_mul_f32 v108, v44, v108
Mvaa 200,148,60
v_mul_f32 v109, v44, v109
v_mul_f32 v110, v44, v110
L_pg1_8:
s_cbranch_execz L_ret1
v_mul_f32 v111, v44, v111
CV 104,104,105
Mvaa 196,152,56
CV 106,106,107
CV 108,108,109
CV 110,110,111
v_accvgpr_write_b32 a64, v104
Mvaa 204,152,60
v_accvgpr_write_b32 a65, v106
v_accvgpr_write_b32 a66, v108
v_accvgpr_write_b32 a67, v110
v_mul_f32 v112, v45, v112
Mvaa 208,156,56
v_mul_f32 v113, v45, v113
v_mul_f32 v114, v45, v114
v_mul_f32 v115, v45, v115
v_mul_f32 v116, v45, v116
Mvaa 216,156,60
v_mul_f32 v117, v45, v117
v_mul_f32 v118, v45, v118
v_mul_f32 v119, v45, v119
CV 112,112,113
Mvaa 212,160,56
buffer_load_dwordx4 a[132:135], v6, s[40:43], s7 offen offset:256 sc1
CV 114,114,115
CV 116,116,117
CV 118,118,119
Mvaa 220,160,60
s_waitcnt vmcnt(19)
v_accvgpr_write_b32 a68, v112
v_accvgpr_write_b32 a69, v114
v_accvgpr_write_b32 a70, v116
v_accvgpr_write_b32 a71, v118
v_mfma_f32_16x16x32_bf16 v[88:91], a[232:235], a[80:83], v[64:67]
v_add_u32 v2, 0x9000, v2
v_add_u32 v3, 0x9000, v3
v_mul_f32 v72, v44, v72
v_mfma_f32_16x16x32_bf16 v[92:95], a[228:231], a[80:83], v[64:67]
s_waitcnt vmcnt(18)
Ta 144,2,0
v_mul_f32 v73, v44, v73
v_mul_f32 v74, v44, v74
v_mul_f32 v75, v44, v75
v_mfma_f32_16x16x32_bf16 v[96:99], a[232:235], a[84:87], v[68:71]
Ta 146,2,2048
v_mul_f32 v76, v44, v76
v_mul_f32 v77, v44, v77
v_mul_f32 v78, v44, v78
v_mfma_f32_16x16x32_bf16 v[100:103], a[228:231], a[84:87], v[68:71]
Ta 148,3,0
v_mul_f32 v79, v44, v79
v_add_u32 v4, 0x9000, v4
CV 72,72,73
Mvaa 192,164,64
buffer_load_dwordx4 a[136:139], v6, s[40:43], s7 offen offset:2048 sc1
Ta 150,3,2048
CV 74,74,75
Mvaa 200,164,68
Ta 152,4,0
CV 76,76,77
CV 78,78,79
v_accvgpr_write_b32 a72, v72
Mvaa 196,168,64
Ta 154,4,2048
v_accvgpr_write_b32 a73, v74
v_accvgpr_write_b32 a74, v76
v_accvgpr_write_b32 a75, v78
Mvaa 204,168,68
Ta 160,2,4096
v_mul_f32 v80, v45, v80
v_mul_f32 v81, v45, v81
v_mul_f32 v82, v45, v82
Mvaa 208,172,64
Ta 162,2,6144
v_mul_f32 v83, v45, v83
v_mul_f32 v84, v45, v84
Mvaa 216,172,68
s_mov_b64 exec, 0
s_cmp_eq_u32 s64, 0
s_cbranch_scc1 L_pg2_9
s_cmp_eq_u32 s64, 1
s_cbranch_scc1 L_pg2_10
s_cmp_eq_u32 s64, 2
s_cbranch_scc1 L_pg2_11
s_branch L_pg2_12
L_ret2:
s_mov_b64 exec, -1
Ta 164,3,4096
v_mul_f32 v85, v45, v85
v_mul_f32 v86, v45, v86
v_mul_f32 v87, v45, v87
Mvaa 212,176,64
buffer_load_dwordx4 a[140:143], v6, s[40:43], s7 offen offset:2304 sc1
Ta 166,3,6144
CV 80,80,81
Mvaa 220,176,68
s_waitcnt vmcnt(18)
s_add_u32 s7, s19, 0x3000
Ta 168,4,4096
CV 82,82,83
CV 84,84,85
CV 86,86,87
v_mfma_f32_16x16x32_bf16 v[104:107], a[232:235], a[88:91], v[64:67]
Ta 170,4,6144
v_accvgpr_write_b32 a76, v80
v_accvgpr_write_b32 a77, v82
v_accvgpr_write_b32 a78, v84
v_mfma_f32_16x16x32_bf16 v[108:111], a[228:231], a[88:91], v[64:67]
s_waitcnt vmcnt(17)
Ta 176,2,8192
v_accvgpr_write_b32 a79, v86
v_add_u32 v5, 0x9000, v5
v_mul_f32 v88, v44, v88
v_mfma_f32_16x16x32_bf16 v[112:115], a[232:235], a[92:95], v[68:71]
LD 12,52,76,0
Ta 156,5,0
Ta 158,5,2048
v_mfma_f32_16x16x32_bf16 v[116:119], a[228:231], a[92:95], v[68:71]
s_waitcnt lgkmcnt(6)
Ta 172,5,4096
v_mul_f32 v89, v44, v89
v_mul_f32 v90, v44, v90
v_mul_f32 v91, v44, v91
Mvaa 192,144,72
Ta 174,5,6144
v_mul_f32 v92, v44, v92
v_mul_f32 v93, v44, v93
Mvaa 200,144,76
buffer_load_dword v17, v16, s[40:43], 0 offen sc1
Ta 178,2,10240
v_mul_f32 v94, v44, v94
Mvaa 196,148,72
Ta 144,3,8192
v_mul_f32 v95, v44, v95
CV 88,88,89
CV 90,90,91
Mvaa 204,148,76
Ta 146,3,10240
CV 92,92,93
CV 94,94,95
v_accvgpr_write_b32 a80, v88
Mvaa 208,152,72
Ta 148,4,8192
v_accvgpr_write_b32 a81, v90
v_accvgpr_write_b32 a82, v92
v_accvgpr_write_b32 a83, v94
Mvaa 216,152,76
s_waitcnt lgkmcnt(5)
Ta 150,4,10240
v_mul_f32 v96, v45, v96
v_mul_f32 v97, v45, v97
v_mul_f32 v98, v45, v98
Mvaa 212,156,72
Ta 152,5,8192
v_mul_f32 v99, v45, v99
v_mul_f32 v100, v45, v100
v_mul_f32 v101, v45, v101
Mvaa 220,156,76
s_waitcnt vmcnt(17)
Ta 154,5,10240
v_mul_f32 v102, v45, v102
v_mul_f32 v103, v45, v103
CV 96,96,97
v_mfma_f32_16x16x32_bf16 v[72:75], a[232:235], a[96:99], v[64:67]
LD 13,52,76,1024
Ta 156,2,12288
v_mfma_f32_16x16x32_bf16 v[76:79], a[228:231], a[96:99], v[64:67]
s_waitcnt vmcnt(16)
Ta 158,2,14336
CV 98,98,99
CV 100,100,101
CV 102,102,103
v_accvgpr_write_b32 a84, v96
v_mfma_f32_16x16x32_bf16 v[80:83], a[232:235], a[100:103], v[68:71]
v_accvgpr_write_b32 a85, v98
v_accvgpr_write_b32 a86, v100
v_accvgpr_write_b32 a87, v102
v_mul_f32 v104, v44, v104
v_mfma_f32_16x16x32_bf16 v[84:87], a[228:231], a[100:103], v[68:71]
v_mul_f32 v105, v44, v105
v_mul_f32 v106, v44, v106
v_mul_f32 v107, v44, v107
v_mul_f32 v108, v44, v108
Mvaa 192,160,80
v_mul_f32 v109, v44, v109
v_mul_f32 v110, v44, v110
v_mul_f32 v111, v44, v111
CV 104,104,105
Mvaa 200,160,84
Ta 160,3,12288
CV 106,106,107
CV 108,108,109
CV 110,110,111
Mvaa 196,164,80
Ta 162,3,14336
v_accvgpr_write_b32 a88, v104
v_accvgpr_write_b32 a89, v106
v_accvgpr_write_b32 a90, v108
Mvaa 204,164,84
Ta 164,4,12288
v_accvgpr_write_b32 a91, v110
v_mul_f32 v112, v45, v112
v_mul_f32 v113, v45, v113
Mvaa 208,168,80
Ta 166,4,14336
v_mul_f32 v114, v45, v114
v_mul_f32 v115, v45, v115
Mvaa 216,168,84
s_waitcnt lgkmcnt(4)
Ta 168,5,12288
v_mul_f32 v116, v45, v116
v_mul_f32 v117, v45, v117
v_mul_f32 v118, v45, v118
Mvaa 212,172,80
LD 14,52,76,2048
Ta 170,5,14336
v_mul_f32 v119, v45, v119
Mvaa 220,172,84
s_waitcnt vmcnt(16)
Ta 172,2,16384
CV 112,112,113
CV 114,114,115
CV 116,116,117
v_mfma_f32_16x16x32_bf16 v[88:91], a[232:235], a[104:107], v[64:67]
Ta 174,2,18432
CV 118,118,119
v_accvgpr_write_b32 a92, v112
v_accvgpr_write_b32 a93, v114
v_mfma_f32_16x16x32_bf16 v[92:95], a[228:231], a[104:107], v[64:67]
s_waitcnt vmcnt(14)
v_accvgpr_write_b32 a94, v116
v_accvgpr_write_b32 a95, v118
v_mul_f32 v72, v44, v72
v_mul_f32 v73, v44, v73
v_mfma_f32_16x16x32_bf16 v[96:99], a[232:235], a[108:111], v[68:71]
v_mul_f32 v74, v44, v74
v_mul_f32 v75, v44, v75
v_mul_f32 v76, v44, v76
v_mul_f32 v77, v44, v77
v_mfma_f32_16x16x32_bf16 v[100:103], a[228:231], a[108:111], v[68:71]
v_mul_f32 v78, v44, v78
v_mul_f32 v79, v44, v79
CV 72,72,73
CV 74,74,75
Mvaa 192,176,88
s_lshl_b32 s85, s30, 7
CV 76,76,77
CV 78,78,79
v_accvgpr_write_b32 a96, v72
Mvaa 200,176,92
s_add_u32 s85, s85, 0x4000
Ta 176,3,16384
v_accvgpr_write_b32 a97, v74
v_accvgpr_write_b32 a98, v76
v_accvgpr_write_b32 a99, v78
Mvaa 196,144,88
s_getpc_b64 s[96:97]
Ta 178,3,18432
v_mov_b32 v46, s85
v_mul_f32 v80, v45, v80
v_mul_f32 v81, v45, v81
Mvaa 204,144,92
global_load_dword a252, v46, s[96:97]
Ta 144,4,16384
v_mul_f32 v82, v45, v82
Mvaa 208,148,88
LD 15,52,76,3072
Ta 146,4,18432
s_add_u32 m0, s67, 0x1000
s_add_u32 s76, s73, 0x48100
Mvaa 216,148,92
Ta 148,5,16384
v_mul_f32 v83, v45, v83
v_mul_f32 v84, v45, v84
v_mul_f32 v85, v45, v85
Mvaa 212,152,88
Ta 150,5,18432
v_mul_f32 v86, v45, v86
v_mul_f32 v87, v45, v87
CV 80,80,81
Mvaa 220,152,92
s_waitcnt vmcnt(15)
Ta 152,2,20480
CV 82,82,83
CV 84,84,85
CV 86,86,87
v_mfma_f32_16x16x32_bf16 v[104:107], a[232:235], a[112:115], v[64:67]
Ta 154,2,22528
v_accvgpr_write_b32 a100, v80
v_accvgpr_write_b32 a101, v82
v_mfma_f32_16x16x32_bf16 v[108:111], a[228:231], a[112:115], v[64:67]
s_waitcnt vmcnt(13)
v_accvgpr_write_b32 a102, v84
v_accvgpr_write_b32 a103, v86
v_mul_f32 v88, v44, v88
v_mul_f32 v89, v44, v89
v_mfma_f32_16x16x32_bf16 v[112:115], a[232:235], a[116:119], v[68:71]
v_mul_f32 v90, v44, v90
v_mul_f32 v91, v44, v91
v_mul_f32 v92, v44, v92
v_mul_f32 v93, v44, v93
v_mfma_f32_16x16x32_bf16 v[116:119], a[228:231], a[116:119], v[68:71]
v_mul_f32 v94, v44, v94
v_mul_f32 v95, v44, v95
CV 88,88,89
CV 90,90,91
Mvaa 192,156,96
CV 92,92,93
CV 94,94,95
v_accvgpr_write_b32 a104, v88
v_accvgpr_write_b32 a105, v90
Mvaa 200,156,100
s_waitcnt lgkmcnt(1)
Ta 156,3,20480
v_accvgpr_write_b32 a106, v92
v_accvgpr_write_b32 a107, v94
v_mul_f32 v96, v45, v96
Mvaa 196,160,96
LD 12,52,76,0
Ta 158,3,22528
v_mul_f32 v97, v45, v97
Mvaa 204,160,100
Ta 160,4,20480
v_mul_f32 v98, v45, v98
v_mul_f32 v99, v45, v99
v_mul_f32 v100, v45, v100
Mvaa 208,164,96
Ta 162,4,22528
v_mul_f32 v101, v45, v101
v_mul_f32 v102, v45, v102
Mvaa 216,164,100
Ta 164,5,20480
v_mul_f32 v103, v45, v103
CV 96,96,97
CV 98,98,99
Mvaa 212,168,96
Ta 166,5,22528
CV 100,100,101
CV 102,102,103
v_accvgpr_write_b32 a108, v96
Mvaa 220,168,100
s_waitcnt vmcnt(12)
Ta 168,2,24576
v_accvgpr_write_b32 a109, v98
v_accvgpr_write_b32 a110, v100
v_accvgpr_write_b32 a111, v102
v_mfma_f32_16x16x32_bf16 v[72:75], a[232:235], a[120:123], v[64:67]
Ta 170,2,26624
v_mul_f32 v104, v44, v104
s_waitcnt vmcnt(5)
v_cmp_ne_u32 vcc, s98, v17
s_cbranch_vccnz L_spin52
L_pollok52:
v_mfma_f32_16x16x32_bf16 v[76:79], a[228:231], a[120:123], v[64:67]
v_mul_f32 v105, v44, v105
v_mul_f32 v106, v44, v106
v_mul_f32 v107, v44, v107
v_mul_f32 v108, v44, v108
v_mfma_f32_16x16x32_bf16 v[80:83], a[232:235], a[124:127], v[68:71]
v_mul_f32 v109, v44, v109
v_mul_f32 v110, v44, v110
v_mul_f32 v111, v44, v111
CV 104,104,105
v_mfma_f32_16x16x32_bf16 v[84:87], a[228:231], a[124:127], v[68:71]
CV 106,106,107
CV 108,108,109
CV 110,110,111
v_accvgpr_write_b32 a112, v104
Mvaa 192,172,104
LD 13,52,76,1024
v_accvgpr_write_b32 a113, v106
v_accvgpr_write_b32 a114, v108
Mvaa 200,172,108
Ta 172,3,24576
v_accvgpr_write_b32 a115, v110
v_mul_f32 v112, v45, v112
v_mul_f32 v113, v45, v113
Mvaa 196,176,104
Ta 174,3,26624
v_mul_f32 v114, v45, v114
v_mul_f32 v115, v45, v115
v_mul_f32 v116, v45, v116
Mvaa 204,176,108
Ta 176,4,24576
v_mul_f32 v117, v45, v117
v_mul_f32 v118, v45, v118
v_mul_f32 v119, v45, v119
Mvaa 208,144,104
Ta 178,4,26624
CV 112,112,113
CV 114,114,115
CV 116,116,117
Mvaa 216,144,108
Ta 144,5,24576
CV 118,118,119
v_accvgpr_write_b32 a116, v112
v_accvgpr_write_b32 a117, v114
Mvaa 212,148,104
Ta 146,5,26624
v_accvgpr_write_b32 a118, v116
v_accvgpr_write_b32 a119, v118
v_mul_f32 v72, v44, v72
Mvaa 220,148,108
Ta 148,2,28672
v_mul_f32 v73, v44, v73
v_mul_f32 v74, v44, v74
v_mul_f32 v75, v44, v75
v_mfma_f32_16x16x32_bf16 v[88:91], a[232:235], a[128:131], v[64:67]
Ta 150,2,30720
v_mul_f32 v76, v44, v76
v_mul_f32 v77, v44, v77
v_mfma_f32_16x16x32_bf16 v[92:95], a[228:231], a[128:131], v[64:67]
v_mul_f32 v78, v44, v78
v_mul_f32 v79, v44, v79
CV 72,72,73
CV 74,74,75
v_mfma_f32_16x16x32_bf16 v[96:99], a[232:235], a[132:135], v[68:71]
LD 14,52,76,2048
CV 76,76,77
CV 78,78,79
v_accvgpr_write_b32 a120, v72
v_mfma_f32_16x16x32_bf16 v[100:103], a[228:231], a[132:135], v[68:71]
s_waitcnt lgkmcnt(3)
v_accvgpr_write_b32 a121, v74
v_accvgpr_write_b32 a122, v76
v_accvgpr_write_b32 a123, v78
v_mul_f32 v80, v45, v80
Mvaa 192,152,112
v_mul_f32 v81, v45, v81
v_mul_f32 v82, v45, v82
v_mul_f32 v83, v45, v83
v_mul_f32 v84, v45, v84
Mvaa 200,152,116
Ta 152,3,28672
v_mul_f32 v85, v45, v85
v_mul_f32 v86, v45, v86
v_mul_f32 v87, v45, v87
Mvaa 196,156,112
Ta 154,3,30720
CV 80,80,81
CV 82,82,83
CV 84,84,85
Mvaa 204,156,116
Ta 156,4,28672
CV 86,86,87
v_accvgpr_write_b32 a124, v80
v_accvgpr_write_b32 a125, v82
Mvaa 208,160,112
Ta 158,4,30720
v_accvgpr_write_b32 a126, v84
v_accvgpr_write_b32 a127, v86
Mvaa 216,160,116
Ta 160,5,28672
v_mul_f32 v88, v44, v88
v_mul_f32 v89, v44, v89
v_mul_f32 v90, v44, v90
Mvaa 212,164,112
Ta 162,5,30720
v_mul_f32 v91, v44, v91
v_mul_f32 v92, v44, v92
v_mul_f32 v93, v44, v93
Mvaa 220,164,116
Ta 164,2,32768
v_mul_f32 v94, v44, v94
v_mul_f32 v95, v44, v95
CV 88,88,89
v_mfma_f32_16x16x32_bf16 v[104:107], a[232:235], a[136:139], v[64:67]
LD 15,52,76,3072
Ta 166,2,34816
s_add_u32 m0, s67, 0x2000
s_add_u32 s76, s73, 0x90100
v_mfma_f32_16x16x32_bf16 v[108:111], a[228:231], a[136:139], v[64:67]
CV 90,90,91
CV 92,92,93
CV 94,94,95
v_accvgpr_write_b32 a128, v88
v_mfma_f32_16x16x32_bf16 v[112:115], a[232:235], a[140:143], v[68:71]
v_accvgpr_write_b32 a129, v90
v_accvgpr_write_b32 a130, v92
v_accvgpr_write_b32 a131, v94
v_mul_f32 v96, v45, v96
v_mfma_f32_16x16x32_bf16 v[116:119], a[228:231], a[140:143], v[68:71]
v_mul_f32 v97, v45, v97
v_mul_f32 v98, v45, v98
v_mul_f32 v99, v45, v99
v_mul_f32 v100, v45, v100
Mvaa 192,168,120
v_mul_f32 v101, v45, v101
v_mul_f32 v102, v45, v102
v_mul_f32 v103, v45, v103
Mvaa 200,168,124
Ta 168,3,32768
Ta 170,3,34816
CV 96,96,97
Mvaa 196,172,120
CV 98,98,99
CV 100,100,101
CV 102,102,103
v_accvgpr_write_b32 a132, v96
Mvaa 204,172,124
Ta 172,4,32768
Ta 174,4,34816
v_accvgpr_write_b32 a133, v98
Mvaa 208,176,120
v_accvgpr_write_b32 a134, v100
v_accvgpr_write_b32 a135, v102
v_mul_f32 v104, v44, v104
v_mul_f32 v105, v44, v105
Mvaa 216,176,124
s_waitcnt lgkmcnt(4)
Ta 176,5,32768
Ta 178,5,34816
v_mul_f32 v106, v44, v106
Mvaa 212,144,120
LD 12,52,76,0
v_mul_f32 v107, v44, v107
v_mul_f32 v108, v44, v108
v_mul_f32 v109, v44, v109
Mvaa 220,144,124
s_add_u32 m0, s67, 0x9000
v_mul_f32 v110, v44, v110
v_mul_f32 v111, v44, v111
CV 104,104,105
CV 106,106,107
Mvaa 192,148,128
s_add_u32 s76, s73, 0x288100
CV 108,108,109
CV 110,110,111
v_accvgpr_write_b32 a136, v104
Mvaa 200,148,132
v_accvgpr_write_b32 a137, v106
v_accvgpr_write_b32 a138, v108
v_accvgpr_write_b32 a139, v110
v_mul_f32 v112, v45, v112
Mvaa 196,152,128
s_waitcnt lgkmcnt(0)
s_barrier
v_mul_f32 v113, v45, v113
v_mul_f32 v114, v45, v114
v_mul_f32 v115, v45, v115
v_mul_f32 v116, v45, v116
Mvaa 204,152,132
v_mul_f32 v117, v45, v117
v_mul_f32 v118, v45, v118
v_mul_f32 v119, v45, v119
CV 112,112,113
Mvaa 208,156,128
CV 114,114,115
CV 116,116,117
CV 118,118,119
v_accvgpr_write_b32 a140, v112
Mvaa 216,156,132
v_accvgpr_write_b32 a141, v114
v_accvgpr_write_b32 a142, v116
v_accvgpr_write_b32 a143, v118
v_add_u32 v2, 0x9000, v2
Mvaa 212,160,128
Ta 144,2,0
v_add_u32 v3, 0x9000, v3
v_add_u32 v4, 0x9000, v4
v_add_u32 v5, 0x9000, v5
Mvaa 220,160,132
Ta 146,2,2048
v_lshlrev_b32 v17, 8, s66
Mvaa 192,164,136
Ta 148,3,0
Ta 150,3,2048
v_lshl_add_u32 v16, v1, 2, v17
Mvaa 200,164,140
Ta 152,4,0
v_add_u32 v16, 0x300d000, v16
Mvaa 196,168,136
Ta 154,4,2048
v_fma_f32 v20, -v192, v192, s24
v_fma_f32 v21, -v193, v193, s24
v_fma_f32 v22, -v194, v194, s24
v_fma_f32 v23, -v195, v195, s24
v_mul_f32 v20, v192, v20
v_mul_f32 v21, v193, v21
Mvaa 204,168,140
Ta 156,5,0
v_mul_f32 v22, v194, v22
v_mul_f32 v23, v195, v23
v_fma_f32 v28, -v200, v200, s24
Mvaa 208,172,136
Ta 158,5,2048
v_fma_f32 v29, -v201, v201, s24
v_exp_f32 v20, v20
Mvaa 216,172,140
Ta 160,2,4096
v_fma_f32 v30, -v202, v202, s24
v_exp_f32 v21, v21
Mvaa 212,176,136
Ta 162,2,6144
v_fma_f32 v31, -v203, v203, s24
v_exp_f32 v22, v22
Mvaa 220,176,140
s_waitcnt lgkmcnt(5)
Ta 164,3,4096
Ta 166,3,6144
v_mul_f32 v28, v200, v28
v_mfma_f32_16x16x32_bf16 v[224:227], a[144:147], a[0:3], 0
Ta 168,4,4096
v_mul_f32 v29, v201, v29
v_mul_f32 v30, v202, v30
v_mfma_f32_16x16x32_bf16 v[232:235], a[144:147], a[4:7], 0
Ta 170,4,6144
v_mul_f32 v31, v203, v31
v_fma_f32 v20, v20, s25, s25
v_mfma_f32_16x16x32_bf16 v[228:231], a[148:151], a[0:3], 0
LD 12,52,76,0
Ta 172,5,4096
v_mfma_f32_16x16x32_bf16 v[236:239], a[148:151], a[4:7], 0
L_pg2_9:
s_cbranch_execz L_ret2
s_waitcnt lgkmcnt(7)
Ta 174,5,6144
v_fma_f32 v21, v21, s25, s25
v_exp_f32 v23, v23
v_mfma_f32_16x16x32_bf16 v[240:243], a[152:155], a[0:3], 0
Ta 176,2,8192
v_fma_f32 v22, v22, s25, s25
v_fma_f32 v23, v23, s25, s25
v_mfma_f32_16x16x32_bf16 v[248:251], a[152:155], a[4:7], 0
Ta 178,2,10240
v_fma_f32 v24, -v196, v196, s24
v_fma_f32 v25, -v197, v197, s24
v_mfma_f32_16x16x32_bf16 v[244:247], a[156:159], a[0:3], 0
Ta 144,3,8192
v_fma_f32 v26, -v198, v198, s24
v_exp_f32 v28, v28
v_mfma_f32_16x16x32_bf16 v[252:255], a[156:159], a[4:7], 0
s_waitcnt lgkmcnt(6)
Ta 146,3,10240
v_fma_f32 v27, -v199, v199, s24
v_mul_f32 v24, v196, v24
Mvaa 224,160,8
LD 13,52,76,1024
Ta 148,4,8192
Mvaa 232,160,12
Ta 150,4,10240
v_mul_f32 v25, v197, v25
v_exp_f32 v29, v29
Mvaa 228,164,8
Ta 152,5,8192
v_mul_f32 v26, v198, v26
v_mul_f32 v27, v199, v27
Mvaa 236,164,12
s_waitcnt lgkmcnt(6)
Ta 154,5,10240
v_fma_f32 v28, v28, s25, s25
v_fma_f32 v29, v29, s25, s25
Mvaa 240,168,8
Ta 156,2,12288
v_fma_f32 v32, -v204, v204, s24
v_fma_f32 v33, -v205, v205, s24
Mvaa 248,168,12
Ta 158,2,14336
v_fma_f32 v34, -v206, v206, s24
v_exp_f32 v30, v30
Mvaa 244,172,8
LD 14,52,76,2048
Ta 160,3,12288
Mvaa 252,172,12
s_waitcnt lgkmcnt(6)
Ta 162,3,14336
v_fma_f32 v30, v30, s25, s25
v_exp_f32 v31, v31
Mvaa 224,176,16
Ta 164,4,12288
v_fma_f32 v31, v31, s25, s25
v_fma_f32 v35, -v207, v207, s24
Mvaa 232,176,20
Ta 166,4,14336
v_mul_f32 v32, v204, v32
v_mul_f32 v33, v205, v33
Mvaa 228,144,16
Ta 168,5,12288
v_mul_f32 v34, v206, v34
v_mul_f32 v35, v207, v35
Mvaa 236,144,20
s_waitcnt lgkmcnt(6)
Ta 170,5,14336
v_rcp_f32 v20, v20
Mvaa 240,148,16
LD 15,52,76,3072
Ta 172,2,16384
s_add_u32 m0, s67, 0xa000
s_add_u32 s76, s73, 0x2d0100
Mvaa 248,148,20
Ta 174,2,18432
v_mul_f32 v20, v192, v20
Mvaa 244,152,16
Ta 176,3,16384
v_rcp_f32 v21, v21
Mvaa 252,152,20
s_waitcnt lgkmcnt(6)
Ta 178,3,18432
v_mul_f32 v21, v193, v21
v_rcp_f32 v22, v22
Mvaa 224,156,24
Ta 144,4,16384
v_mul_f32 v22, v194, v22
CV 48,20,21
Mvaa 232,156,28
Ta 146,4,18432
v_fma_f32 v20, -v208, v208, s24
v_fma_f32 v21, -v209, v209, s24
Mvaa 228,160,24
LD 12,52,76,0
Ta 148,5,16384
v_mul_f32 v20, v208, v20
Mvaa 236,160,28
s_waitcnt lgkmcnt(6)
Ta 150,5,18432
v_mul_f32 v21, v209, v21
Mvaa 240,164,24
Ta 152,2,20480
v_rcp_f32 v23, v23
Mvaa 248,164,28
Ta 154,2,22528
v_mul_f32 v23, v195, v23
v_exp_f32 v24, v24
Mvaa 244,168,24
Ta 156,3,20480
v_fma_f32 v24, v24, s25, s25
CV 49,22,23
Mvaa 252,168,28
s_waitcnt lgkmcnt(6)
Ta 158,3,22528
v_fma_f32 v22, -v210, v210, s24
v_fma_f32 v23, -v211, v211, s24
Mvaa 224,172,32
LD 13,52,76,1024
Ta 160,4,20480
Mvaa 232,172,36
Ta 162,4,22528
v_mul_f32 v22, v210, v22
v_exp_f32 v25, v25
v_mul_f32 v23, v211, v23
Mvaa 228,176,32
Ta 164,5,20480
v_fma_f32 v25, v25, s25, s25
v_and_b32 v13, 48, v1
Mvaa 236,176,36
s_waitcnt lgkmcnt(6)
Ta 166,5,22528
v_exp_f32 v26, v26
Mvaa 240,144,32
Ta 168,2,24576
v_fma_f32 v26, v26, s25, s25
Mvaa 248,144,36
Ta 170,2,26624
v_exp_f32 v27, v27
Mvaa 244,148,32
LD 14,52,76,2048
Ta 172,3,24576
v_fma_f32 v27, v27, s25, s25
Mvaa 252,148,36
s_waitcnt lgkmcnt(6)
Ta 174,3,26624
v_rcp_f32 v28, v28
Mvaa 224,152,40
Ta 176,4,24576
v_mul_f32 v28, v200, v28
v_rcp_f32 v29, v29
Mvaa 232,152,44
Ta 178,4,26624
v_mul_f32 v29, v201, v29
Mvaa 228,156,40
Ta 144,5,24576
CV 52,28,29
v_rcp_f32 v30, v30
Mvaa 236,156,44
s_waitcnt lgkmcnt(6)
Ta 146,5,26624
v_mul_f32 v30, v202, v30
v_fma_f32 v28, -v216, v216, s24
Mvaa 240,160,40
LD 15,52,76,3072
Ta 148,2,28672
s_add_u32 m0, s67, 0xb000
Mvaa 248,160,44
s_add_u32 s76, s73, 0x318100
Ta 150,2,30720
v_fma_f32 v29, -v217, v217, s24
v_mul_f32 v28, v216, v28
Mvaa 244,164,40
Ta 152,3,28672
v_mul_f32 v29, v217, v29
v_rcp_f32 v31, v31
Mvaa 252,164,44
s_waitcnt lgkmcnt(6)
Ta 154,3,30720
v_mul_f32 v31, v203, v31
Mvaa 224,168,48
Ta 156,4,28672
Ta 158,4,30720
CV 53,30,31
Mvaa 232,168,52
s_waitcnt lgkmcnt(5)
Ta 160,5,28672
Ta 162,5,30720
Mvaa 228,172,48
LD 12,52,76,0
Ta 164,2,32768
Mvaa 236,172,52
s_add_u32 m0, s67, 0x12000
Ta 166,2,34816
Ta 168,3,32768
v_add_u32 v2, 0x9000, v2
Mvaa 240,176,48
s_add_u32 s76, s71, 0x36000
Ta 170,3,34816
Ta 172,4,32768
Mvaa 248,176,52
Ta 174,4,34816
Ta 176,5,32768
v_add_u32 v3, 0x9000, v3
Mvaa 244,144,48
Ta 178,5,34816
v_add_u32 v4, 0x9000, v4
v_add_u32 v5, 0x9000, v5
Mvaa 252,144,52
s_waitcnt lgkmcnt(10)
v_rcp_f32 v24, v24
v_fma_f32 v30, -v218, v218, s24
Mvaa 224,148,56
v_rcp_f32 v25, v25
v_mul_f32 v24, v196, v24
Mvaa 232,148,60
v_rcp_f32 v26, v26
v_mul_f32 v25, v197, v25
Mvaa 228,152,56
v_rcp_f32 v27, v27
v_mul_f32 v26, v198, v26
Mvaa 236,152,60
s_waitcnt lgkmcnt(0)
s_barrier
v_exp_f32 v32, v32
v_exp_f32 v33, v33
Mvaa 240,156,56
Ta 144,2,0
v_mul_f32 v27, v199, v27
v_fma_f32 v32, v32, s25, s25
Mvaa 248,156,60
Ta 146,2,2048
v_fma_f32 v33, v33, s25, s25
v_fma_f32 v31, -v219, v219, s24
Mvaa 244,160,56
Ta 148,3,0
v_mul_f32 v30, v218, v30
v_mul_f32 v31, v219, v31
Mvaa 252,160,60
Ta 150,3,2048
CV 50,24,25
CV 51,26,27
Mvaa 224,164,64
Ta 152,4,0
v_fma_f32 v24, -v212, v212, s24
v_fma_f32 v25, -v213, v213, s24
Mvaa 232,164,68
Ta 154,4,2048
v_fma_f32 v26, -v214, v214, s24
v_fma_f32 v27, -v215, v215, s24
Mvaa 228,168,64
Ta 156,5,0
v_mul_f32 v24, v212, v24
v_exp_f32 v34, v34
Mvaa 236,168,68
Ta 158,5,2048
v_fma_f32 v34, v34, s25, s25
v_mul_f32 v25, v213, v25
Mvaa 240,172,64
Ta 160,2,4096
v_mul_f32 v26, v214, v26
v_mul_f32 v27, v215, v27
Mvaa 248,172,68
Ta 162,2,6144
v_exp_f32 v35, v35
Mvaa 244,176,64
Ta 164,3,4096
v_fma_f32 v35, v35, s25, s25
v_and_b32 v12, 15, v1
Mvaa 252,176,68
s_waitcnt lgkmcnt(6)
Ta 166,3,6144
v_exp_f32 v20, v20
Mvaa 224,144,72
Ta 168,4,4096
v_fma_f32 v20, v20, s25, s25
v_mul_u32_u24 v12, 0x480, v12
Mvaa 232,144,76
Ta 170,4,6144
v_exp_f32 v21, v21
Mvaa 228,148,72
buffer_load_dwordx4 v7, s[40:43], s76 offen sc1 lds
Ta 172,5,4096
v_fma_f32 v21, v21, s25, s25
Mvaa 236,148,76
s_waitcnt lgkmcnt(6)
Ta 174,5,6144
v_exp_f32 v22, v22
Mvaa 240,152,72
Ta 176,2,8192
v_fma_f32 v22, v22, s25, s25
Mvaa 248,152,76
Ta 178,2,10240
v_exp_f32 v23, v23
Mvaa 244,156,72
Ta 144,3,8192
v_fma_f32 v23, v23, s25, s25
v_rcp_f32 v32, v32
Mvaa 252,156,76
s_waitcnt lgkmcnt(6)
Ta 146,3,10240
v_mul_f32 v32, v204, v32
v_rcp_f32 v33, v33
Mvaa 224,160,80
buffer_load_dwordx4 v7, s[40:43], s76 offen offset:1024 sc1 lds
Ta 148,4,8192
Mvaa 232,160,84
Ta 150,4,10240
v_mul_f32 v33, v205, v33
v_rcp_f32 v34, v34
Mvaa 228,164,80
Ta 152,5,8192
v_mul_f32 v34, v206, v34
CV 54,32,33
Mvaa 236,164,84
s_waitcnt lgkmcnt(6)
Ta 154,5,10240
v_fma_f32 v32, -v220, v220, s24
v_fma_f32 v33, -v221, v221, s24
Mvaa 240,168,80
Ta 156,2,12288
v_mul_f32 v32, v220, v32
v_mul_f32 v33, v221, v33
Mvaa 248,168,84
Ta 158,2,14336
v_rcp_f32 v35, v35
Mvaa 244,172,80
buffer_load_dwordx4 v7, s[40:43], s76 offen offset:2048 sc1 lds
Ta 160,3,12288
v_mul_f32 v35, v207, v35
Mvaa 252,172,84
s_waitcnt lgkmcnt(6)
Ta 162,3,14336
CV 55,34,35
v_fma_f32 v34, -v222, v222, s24
Mvaa 224,176,88
Ta 164,4,12288
v_fma_f32 v35, -v223, v223, s24
v_mul_f32 v34, v222, v34
Mvaa 232,176,92
Ta 166,4,14336
v_mul_f32 v35, v223, v35
Mvaa 228,144,88
Ta 168,5,12288
v_exp_f32 v28, v28
Mvaa 236,144,92
s_waitcnt lgkmcnt(6)
Ta 170,5,14336
v_fma_f32 v28, v28, s25, s25
v_exp_f32 v29, v29
Mvaa 240,148,88
buffer_load_dwordx4 v7, s[40:43], s76 offen offset:3072 sc1 lds
Ta 172,2,16384
s_add_u32 m0, s67, 0x13000
Mvaa 248,148,92
s_add_u32 s76, s71, 0x37000
Ta 174,2,18432
v_fma_f32 v29, v29, s25, s25
v_exp_f32 v30, v30
Mvaa 244,152,88
Ta 176,3,16384
v_fma_f32 v30, v30, s25, s25
Mvaa 252,152,92
s_waitcnt lgkmcnt(6)
Ta 178,3,18432
v_exp_f32 v31, v31
Mvaa 224,156,96
Ta 144,4,16384
v_fma_f32 v31, v31, s25, s25
v_rcp_f32 v20, v20
Mvaa 232,156,100
Ta 146,4,18432
v_mul_f32 v20, v208, v20
Mvaa 228,160,96
buffer_load_dwordx4 v7, s[40:43], s76 offen sc1 lds
Ta 148,5,16384
Mvaa 236,160,100
s_waitcnt lgkmcnt(6)
Ta 150,5,18432
v_rcp_f32 v21, v21
v_rcp_f32 v22, v22
v_mul_f32 v21, v209, v21
Mvaa 240,164,96
Ta 152,2,20480
v_mul_f32 v22, v210, v22
CV 56,20,21
Mvaa 248,164,100
Ta 154,2,22528
v_rcp_f32 v23, v23
Mvaa 244,168,96
Ta 156,3,20480
v_mul_f32 v23, v211, v23
Mvaa 252,168,100
s_waitcnt lgkmcnt(6)
Ta 158,3,22528
v_exp_f32 v24, v24
CV 57,22,23
Mvaa 224,172,104
buffer_load_dwordx4 v7, s[40:43], s76 offen offset:1024 sc1 lds
Ta 160,4,20480
Mvaa 232,172,108
Ta 162,4,22528
v_fma_f32 v24, v24, s25, s25
v_exp_f32 v25, v25
Mvaa 228,176,104
Ta 164,5,20480
v_fma_f32 v25, v25, s25, s25
v_exp_f32 v26, v26
Mvaa 236,176,108
s_waitcnt lgkmcnt(6)
Ta 166,5,22528
v_fma_f32 v26, v26, s25, s25
Mvaa 240,144,104
Ta 168,2,24576
v_exp_f32 v27, v27
Mvaa 248,144,108
Ta 170,2,26624
v_fma_f32 v27, v27, s25, s25
v_rcp_f32 v28, v28
Mvaa 244,148,104
buffer_load_dwordx4 v7, s[40:43], s76 offen offset:2048 sc1 lds
Ta 172,3,24576
Mvaa 252,148,108
s_waitcnt lgkmcnt(6)
Ta 174,3,26624
v_mul_f32 v28, v216, v28
v_rcp_f32 v29, v29
Mvaa 224,152,112
Ta 176,4,24576
v_mul_f32 v29, v217, v29
Mvaa 232,152,116
Ta 178,4,26624
v_rcp_f32 v30, v30
v_rcp_f32 v31, v31
Mvaa 228,156,112
Ta 144,5,24576
v_mul_f32 v30, v218, v30
v_mul_f32 v31, v219, v31
Mvaa 236,156,116
s_waitcnt lgkmcnt(6)
Ta 146,5,26624
v_exp_f32 v32, v32
Mvaa 240,160,112
buffer_load_dwordx4 v7, s[40:43], s76 offen offset:3072 sc1 lds
Ta 148,2,28672
s_add_u32 m0, s67, 0x14000
Mvaa 248,160,116
s_add_u32 s76, s71, 0x38000
Ta 150,2,30720
v_fma_f32 v32, v32, s25, s25
CV 60,28,29
Mvaa 244,164,112
Ta 152,3,28672
v_exp_f32 v33, v33
Mvaa 252,164,116
s_waitcnt lgkmcnt(6)
Ta 154,3,30720
v_fma_f32 v33, v33, s25, s25
v_exp_f32 v34, v34
Mvaa 224,168,120
Ta 156,4,28672
Ta 158,4,30720
Mvaa 232,168,124
s_waitcnt lgkmcnt(5)
Ta 160,5,28672
Ta 162,5,30720
Mvaa 228,172,120
buffer_load_dwordx4 v7, s[40:43], s76 offen sc1 lds
Ta 164,2,32768
Mvaa 236,172,124
s_add_u32 m0, s67, 0x1b000
Ta 166,2,34816
Ta 168,3,32768
v_add_u32 v2, 0xfffe5000, v2
Mvaa 240,176,120
s_add_u32 s76, s71, 0x3f000
Ta 170,3,34816
Ta 172,4,32768
Mvaa 248,176,124
Ta 174,4,34816
Ta 176,5,32768
Mvaa 244,144,120
Ta 178,5,34816
v_add_u32 v3, 0xfffe5000, v3
v_add_u32 v4, 0xfffe5000, v4
v_add_u32 v5, 0xfffe5000, v5
Mvaa 252,144,124
s_waitcnt lgkmcnt(10)
v_exp_f32 v35, v35
v_fma_f32 v34, v34, s25, s25
Mvaa 224,148,128
v_rcp_f32 v24, v24
v_fma_f32 v35, v35, s25, s25
Mvaa 232,148,132
v_rcp_f32 v25, v25
v_mul_f32 v24, v212, v24
Mvaa 228,152,128
v_rcp_f32 v26, v26
v_mul_f32 v25, v213, v25
Mvaa 236,152,132
s_waitcnt vmcnt(18) lgkmcnt(0)
s_barrier
v_rcp_f32 v27, v27
v_mul_f32 v26, v214, v26
Mvaa 240,156,128
Ta 144,2,0
v_mul_f32 v27, v215, v27
CV 61,30,31
Mvaa 248,156,132
Ta 146,2,2048
v_rcp_f32 v32, v32
CV 58,24,25
Mvaa 244,160,128
Ta 148,3,0
v_mul_f32 v32, v220, v32
CV 59,26,27
Mvaa 252,160,132
Ta 150,3,2048
v_rcp_f32 v33, v33
Mvaa 224,164,136
Ta 152,4,0
v_mul_f32 v33, v221, v33
Mvaa 232,164,140
Ta 154,4,2048
v_rcp_f32 v34, v34
CV 62,32,33
Mvaa 228,168,136
Ta 156,5,0
v_mul_f32 v34, v222, v34
v_fma_f32 v20, -v224, v224, s24
Mvaa 236,168,140
Ta 158,5,2048
v_rcp_f32 v35, v35
v_fma_f32 v21, -v225, v225, s24
Mvaa 240,172,136
Ta 160,2,4096
v_mul_f32 v35, v223, v35
v_fma_f32 v22, -v226, v226, s24
Mvaa 248,172,140
Ta 162,2,6144
v_fma_f32 v23, -v227, v227, s24
v_mul_f32 v20, v224, v20
Mvaa 244,176,136
Ta 164,3,4096
v_mul_f32 v21, v225, v21
v_mul_f32 v22, v226, v22
Mvaa 252,176,140
s_waitcnt lgkmcnt(6)
Ta 166,3,6144
v_mul_f32 v23, v227, v23
v_fma_f32 v28, -v232, v232, s24
v_mfma_f32_16x16x32_bf16 v[192:195], a[144:147], a[0:3], 0
Ta 168,4,4096
v_fma_f32 v29, -v233, v233, s24
v_fma_f32 v30, -v234, v234, s24
v_mfma_f32_16x16x32_bf16 v[200:203], a[144:147], a[4:7], 0
Ta 170,4,6144
v_fma_f32 v31, -v235, v235, s24
v_mul_f32 v28, v232, v28
v_mfma_f32_16x16x32_bf16 v[196:199], a[148:151], a[0:3], 0
buffer_load_dwordx4 v7, s[40:43], s76 offen sc1 lds
Ta 172,5,4096
v_mul_f32 v29, v233, v29
v_mfma_f32_16x16x32_bf16 v[204:207], a[148:151], a[4:7], 0
s_waitcnt lgkmcnt(6)
Ta 174,5,6144
v_mul_f32 v30, v234, v30
v_mul_f32 v31, v235, v31
v_mfma_f32_16x16x32_bf16 v[208:211], a[152:155], a[0:3], 0
Ta 176,2,8192
v_fma_f32 v24, -v228, v228, s24
v_fma_f32 v25, -v229, v229, s24
v_mfma_f32_16x16x32_bf16 v[216:219], a[152:155], a[4:7], 0
Ta 178,2,10240
v_fma_f32 v26, -v230, v230, s24
v_fma_f32 v27, -v231, v231, s24
v_mfma_f32_16x16x32_bf16 v[212:215], a[156:159], a[0:3], 0
Ta 144,3,8192
v_mul_f32 v24, v228, v24
v_mul_f32 v25, v229, v25
v_mfma_f32_16x16x32_bf16 v[220:223], a[156:159], a[4:7], 0
s_waitcnt lgkmcnt(6)
Ta 146,3,10240
v_mul_f32 v26, v230, v26
v_mul_f32 v27, v231, v27
Mvaa 192,160,8
buffer_load_dwordx4 v7, s[40:43], s76 offen offset:1024 sc1 lds
Ta 148,4,8192
Mvaa 200,160,12
Ta 150,4,10240
CV 63,34,35
v_exp_f32 v20, v20
v_fma_f32 v32, -v236, v236, s24
Mvaa 196,164,8
Ta 152,5,8192
v_fma_f32 v20, v20, s25, s25
L_pg2_10:
s_cbranch_execz L_ret2
v_fma_f32 v33, -v237, v237, s24
Mvaa 204,164,12
s_waitcnt lgkmcnt(6)
Ta 154,5,10240
v_fma_f32 v34, -v238, v238, s24
v_fma_f32 v35, -v239, v239, s24
Mvaa 208,168,8
Ta 156,2,12288
v_mul_f32 v32, v236, v32
v_mul_f32 v33, v237, v33
Mvaa 216,168,12
Ta 158,2,14336
v_mul_f32 v34, v238, v34
v_mul_f32 v35, v239, v35
Mvaa 212,172,8
buffer_load_dwordx4 v7, s[40:43], s76 offen offset:2048 sc1 lds
Ta 160,3,12288
Mvaa 220,172,12
s_waitcnt lgkmcnt(6)
Ta 162,3,14336
v_exp_f32 v21, v21
v_exp_f32 v22, v22
Mvaa 192,176,16
Ta 164,4,12288
v_fma_f32 v21, v21, s25, s25
v_fma_f32 v22, v22, s25, s25
Mvaa 200,176,20
Ta 166,4,14336
v_exp_f32 v23, v23
Mvaa 196,144,16
Ta 168,5,12288
v_fma_f32 v23, v23, s25, s25
Mvaa 204,144,20
s_waitcnt lgkmcnt(6)
Ta 170,5,14336
v_exp_f32 v28, v28
Mvaa 208,148,16
buffer_load_dwordx4 v7, s[40:43], s76 offen offset:3072 sc1 lds
Ta 172,2,16384
s_add_u32 m0, s67, 0x1c000
s_add_u32 s76, s71, 0x40000
Mvaa 216,148,20
Ta 174,2,18432
v_fma_f32 v28, v28, s25, s25
Mvaa 212,152,16
Ta 176,3,16384
v_exp_f32 v29, v29
v_exp_f32 v30, v30
Mvaa 220,152,20
s_waitcnt lgkmcnt(6)
Ta 178,3,18432
v_fma_f32 v29, v29, s25, s25
v_fma_f32 v30, v30, s25, s25
Mvaa 192,156,24
Ta 144,4,16384
v_exp_f32 v31, v31
Mvaa 200,156,28
Ta 146,4,18432
v_fma_f32 v31, v31, s25, s25
Mvaa 196,160,24
buffer_load_dwordx4 v7, s[40:43], s76 offen sc1 lds
Ta 148,5,16384
Mvaa 204,160,28
s_waitcnt lgkmcnt(6)
Ta 150,5,18432
v_rcp_f32 v20, v20
v_rcp_f32 v21, v21
Mvaa 208,164,24
s_lshl_b32 s85, s30, 7
Ta 152,2,20480
v_mul_f32 v20, v224, v20
v_mul_f32 v21, v225, v21
Mvaa 216,164,28
s_add_u32 s85, s85, 0x4000
Ta 154,2,22528
v_mov_b32 v46, s85
v_rcp_f32 v22, v22
Mvaa 212,168,24
s_getpc_b64 s[96:97]
Ta 156,3,20480
v_mul_f32 v22, v226, v22
CV 64,20,21
Mvaa 220,168,28
s_waitcnt lgkmcnt(6)
global_load_dword a252, v46, s[96:97]
Ta 158,3,22528
Mvaa 192,172,32
Ta 160,4,20480
v_fma_f32 v20, -v240, v240, s24
v_rcp_f32 v23, v23
Mvaa 200,172,36
buffer_load_dwordx4 v7, s[40:43], s76 offen offset:1024 sc1 lds
Ta 162,4,22528
Mvaa 196,176,32
Ta 164,5,20480
v_mul_f32 v23, v227, v23
v_exp_f32 v24, v24
Mvaa 204,176,36
s_waitcnt lgkmcnt(6)
Ta 166,5,22528
v_fma_f32 v24, v24, s25, s25
v_exp_f32 v25, v25
Mvaa 208,144,32
Ta 168,2,24576
v_fma_f32 v25, v25, s25, s25
CV 65,22,23
Mvaa 216,144,36
Ta 170,2,26624
v_fma_f32 v21, -v241, v241, s24
v_fma_f32 v22, -v242, v242, s24
Mvaa 212,148,32
buffer_load_dwordx4 v7, s[40:43], s76 offen offset:2048 sc1 lds
Ta 172,3,24576
Mvaa 220,148,36
s_waitcnt lgkmcnt(6)
Ta 174,3,26624
v_fma_f32 v23, -v243, v243, s24
v_exp_f32 v26, v26
Mvaa 192,152,40
Ta 176,4,24576
v_fma_f32 v26, v26, s25, s25
v_mul_f32 v20, v240, v20
Mvaa 200,152,44
Ta 178,4,26624
v_mul_f32 v21, v241, v21
v_mul_f32 v22, v242, v22
Mvaa 196,156,40
Ta 144,5,24576
v_mul_f32 v23, v243, v23
v_exp_f32 v27, v27
Mvaa 204,156,44
s_waitcnt lgkmcnt(6)
Ta 146,5,26624
v_fma_f32 v27, v27, s25, s25
Mvaa 208,160,40
buffer_load_dwordx4 v7, s[40:43], s76 offen offset:3072 sc1 lds
Ta 148,2,28672
s_add_u32 m0, s67, 0x1d000
s_add_u32 s76, s71, 0x41000
Mvaa 216,160,44
Ta 150,2,30720
v_rcp_f32 v28, v28
Mvaa 212,164,40
Ta 152,3,28672
v_mul_f32 v28, v232, v28
Mvaa 220,164,44
s_waitcnt lgkmcnt(6)
Ta 154,3,30720
v_rcp_f32 v29, v29
Mvaa 192,168,48
Ta 156,4,28672
Ta 158,4,30720
v_mul_f32 v29, v233, v29
Mvaa 200,168,52
s_waitcnt lgkmcnt(5)
Ta 160,5,28672
Ta 162,5,30720
CV 68,28,29
Mvaa 196,172,48
buffer_load_dwordx4 v7, s[40:43], s76 offen sc1 lds
Ta 164,2,32768
Mvaa 204,172,52
s_add_u32 m0, s67, 0
Ta 166,2,34816
Ta 168,3,32768
v_add_u32 v2, 0x9000, v2
Mvaa 208,176,48
s_add_u32 s76, s71, 0x48000
Ta 170,3,34816
Ta 172,4,32768
Mvaa 216,176,52
Ta 174,4,34816
Ta 176,5,32768
Mvaa 212,144,48
Ta 178,5,34816
v_add_u32 v3, 0x9000, v3
v_add_u32 v4, 0x9000, v4
Mvaa 220,144,52
s_waitcnt lgkmcnt(10)
v_add_u32 v5, 0x9000, v5
v_fma_f32 v28, -v248, v248, s24
v_rcp_f32 v30, v30
Mvaa 192,148,56
v_rcp_f32 v31, v31
v_mul_f32 v30, v234, v30
Mvaa 200,148,60
v_exp_f32 v32, v32
v_mul_f32 v31, v235, v31
Mvaa 196,152,56
v_exp_f32 v33, v33
v_fma_f32 v32, v32, s25, s25
Mvaa 204,152,60
s_waitcnt vmcnt(19) lgkmcnt(0)
s_barrier
v_exp_f32 v34, v34
v_fma_f32 v33, v33, s25, s25
Mvaa 208,156,56
Ta 144,2,0
v_fma_f32 v34, v34, s25, s25
CV 69,30,31
Mvaa 216,156,60
Ta 146,2,2048
v_fma_f32 v29, -v249, v249, s24
v_fma_f32 v30, -v250, v250, s24
Mvaa 212,160,56
Ta 148,3,0
v_fma_f32 v31, -v251, v251, s24
v_exp_f32 v35, v35
Mvaa 220,160,60
Ta 150,3,2048
v_fma_f32 v35, v35, s25, s25
v_mul_f32 v28, v248, v28
Mvaa 192,164,64
Ta 152,4,0
v_mul_f32 v29, v249, v29
v_mul_f32 v30, v250, v30
Mvaa 200,164,68
Ta 154,4,2048
v_mul_f32 v31, v251, v31
Mvaa 196,168,64
Ta 156,5,0
v_rcp_f32 v24, v24
Mvaa 204,168,68
Ta 158,5,2048
v_mul_f32 v24, v228, v24
v_rcp_f32 v25, v25
Mvaa 208,172,64
Ta 160,2,4096
v_mul_f32 v25, v229, v25
Mvaa 216,172,68
Ta 162,2,6144
CV 66,24,25
v_rcp_f32 v26, v26
v_fma_f32 v24, -v244, v244, s24
Mvaa 212,176,64
Ta 164,3,4096
v_mul_f32 v26, v230, v26
v_fma_f32 v25, -v245, v245, s24
Mvaa 220,176,68
s_waitcnt lgkmcnt(6)
Ta 166,3,6144
v_mul_f32 v24, v244, v24
v_mul_f32 v25, v245, v25
Mvaa 192,144,72
Ta 168,4,4096
v_rcp_f32 v27, v27
Mvaa 200,144,76
Ta 170,4,6144
v_mul_f32 v27, v231, v27
Mvaa 196,148,72
buffer_load_dwordx4 v7, s[40:43], s76 offen sc1 lds
Ta 172,5,4096
CV 67,26,27
Mvaa 204,148,76
s_waitcnt lgkmcnt(6)
Ta 174,5,6144
v_fma_f32 v26, -v246, v246, s24
v_exp_f32 v20, v20
Mvaa 208,152,72
Ta 176,2,8192
v_fma_f32 v20, v20, s25, s25
v_fma_f32 v27, -v247, v247, s24
Mvaa 216,152,76
Ta 178,2,10240
v_mul_f32 v26, v246, v26
v_mul_f32 v27, v247, v27
Mvaa 212,156,72
Ta 144,3,8192
v_exp_f32 v21, v21
Mvaa 220,156,76
s_waitcnt lgkmcnt(6)
Ta 146,3,10240
v_fma_f32 v21, v21, s25, s25
Mvaa 192,160,80
buffer_load_dwordx4 v7, s[40:43], s76 offen offset:1024 sc1 lds
Ta 148,4,8192
Mvaa 200,160,84
Ta 150,4,10240
v_exp_f32 v22, v22
v_exp_f32 v23, v23
Mvaa 196,164,80
Ta 152,5,8192
v_fma_f32 v22, v22, s25, s25
v_rcp_f32 v32, v32
Mvaa 204,164,84
s_waitcnt lgkmcnt(6)
Ta 154,5,10240
v_fma_f32 v23, v23, s25, s25
v_mul_f32 v32, v236, v32
Mvaa 208,168,80
Ta 156,2,12288
v_rcp_f32 v33, v33
Mvaa 216,168,84
Ta 158,2,14336
v_mul_f32 v33, v237, v33
Mvaa 212,172,80
buffer_load_dwordx4 v7, s[40:43], s76 offen offset:2048 sc1 lds
Ta 160,3,12288
CV 70,32,33
Mvaa 220,172,84
s_waitcnt lgkmcnt(6)
Ta 162,3,14336
v_fma_f32 v32, -v252, v252, s24
v_fma_f32 v33, -v253, v253, s24
Mvaa 192,176,88
Ta 164,4,12288
v_mul_f32 v32, v252, v32
v_mul_f32 v33, v253, v33
Mvaa 200,176,92
Ta 166,4,14336
v_rcp_f32 v34, v34
Mvaa 196,144,88
Ta 168,5,12288
v_mul_f32 v34, v238, v34
v_rcp_f32 v35, v35
Mvaa 204,144,92
s_waitcnt lgkmcnt(6)
Ta 170,5,14336
v_mul_f32 v35, v239, v35
Mvaa 208,148,88
buffer_load_dwordx4 v7, s[40:43], s76 offen offset:3072 sc1 lds
Ta 172,2,16384
s_add_u32 m0, s67, 0x1000
s_add_u32 s76, s71, 0x49000
Mvaa 216,148,92
Ta 174,2,18432
CV 71,34,35
v_fma_f32 v34, -v254, v254, s24
Mvaa 212,152,88
Ta 176,3,16384
v_fma_f32 v35, -v255, v255, s24
v_mul_f32 v34, v254, v34
Mvaa 220,152,92
s_waitcnt lgkmcnt(6)
Ta 178,3,18432
v_mul_f32 v35, v255, v35
v_exp_f32 v28, v28
Mvaa 192,156,96
Ta 144,4,16384
v_fma_f32 v28, v28, s25, s25
Mvaa 200,156,100
Ta 146,4,18432
v_exp_f32 v29, v29
Mvaa 196,160,96
buffer_load_dwordx4 v7, s[40:43], s76 offen sc1 lds
Ta 148,5,16384
v_fma_f32 v29, v29, s25, s25
Mvaa 204,160,100
s_waitcnt lgkmcnt(6)
Ta 150,5,18432
v_exp_f32 v30, v30
Mvaa 208,164,96
Ta 152,2,20480
v_fma_f32 v30, v30, s25, s25
Mvaa 216,164,100
Ta 154,2,22528
v_exp_f32 v31, v31
Mvaa 212,168,96
Ta 156,3,20480
v_fma_f32 v31, v31, s25, s25
v_rcp_f32 v20, v20
Mvaa 220,168,100
s_waitcnt lgkmcnt(6)
Ta 158,3,22528
v_mul_f32 v20, v240, v20
v_rcp_f32 v21, v21
Mvaa 192,172,104
buffer_load_dwordx4 v7, s[40:43], s76 offen offset:1024 sc1 lds
Ta 160,4,20480
Mvaa 200,172,108
Ta 162,4,22528
v_mul_f32 v21, v241, v21
v_rcp_f32 v22, v22
Mvaa 196,176,104
Ta 164,5,20480
v_mul_f32 v22, v242, v22
CV 72,20,21
Mvaa 204,176,108
s_waitcnt lgkmcnt(6)
Ta 166,5,22528
v_rcp_f32 v23, v23
Mvaa 208,144,104
Ta 168,2,24576
v_mul_f32 v23, v243, v23
Mvaa 216,144,108
Ta 170,2,26624
v_exp_f32 v24, v24
v_exp_f32 v25, v25
Mvaa 212,148,104
buffer_load_dwordx4 v7, s[40:43], s76 offen offset:2048 sc1 lds
Ta 172,3,24576
Mvaa 220,148,108
s_waitcnt lgkmcnt(6)
Ta 174,3,26624
v_fma_f32 v24, v24, s25, s25
v_exp_f32 v26, v26
Mvaa 192,152,112
Ta 176,4,24576
v_fma_f32 v25, v25, s25, s25
v_fma_f32 v26, v26, s25, s25
Mvaa 200,152,116
Ta 178,4,26624
v_exp_f32 v27, v27
Mvaa 196,156,112
Ta 144,5,24576
v_fma_f32 v27, v27, s25, s25
CV 73,22,23
Mvaa 204,156,116
s_waitcnt lgkmcnt(6)
Ta 146,5,26624
v_rcp_f32 v28, v28
Mvaa 208,160,112
buffer_load_dwordx4 v7, s[40:43], s76 offen offset:3072 sc1 lds
Ta 148,2,28672
s_add_u32 m0, s67, 0x2000
s_add_u32 s76, s71, 0x4a000
Mvaa 216,160,116
Ta 150,2,30720
v_mul_f32 v28, v248, v28
Mvaa 212,164,112
Ta 152,3,28672
v_rcp_f32 v29, v29
Mvaa 220,164,116
s_waitcnt lgkmcnt(6)
Ta 154,3,30720
v_mul_f32 v29, v249, v29
v_rcp_f32 v30, v30
Mvaa 192,168,120
s_mul_i32 s77, s100, 0x480
Ta 156,4,28672
Ta 158,4,30720
Mvaa 200,168,124
s_mul_i32 s85, s66, 0xa2000
Ta 160,5,28672
Ta 162,5,30720
Mvaa 196,172,120
buffer_load_dwordx4 v7, s[40:43], s76 offen sc1 lds
Ta 164,2,32768
Ta 166,2,34816
Mvaa 204,172,124
s_waitcnt lgkmcnt(9)
s_add_u32 m0, s67, 0x9000
Ta 168,3,32768
Ta 170,3,34816
Mvaa 208,176,120
s_add_u32 s76, s71, 0x51000
Ta 172,4,32768
Ta 174,4,34816
Mvaa 216,176,124
s_add_u32 s77, s77, s85
Ta 176,5,32768
Ta 178,5,34816
Mvaa 212,144,120
s_add_u32 s77, s77, 0x90000
v_min_u32 v46, 8, v1
v_mul_f32 v30, v250, v30
v_mul_u32_u24 v46, 0x80, v46
Mvaa 220,144,124
s_waitcnt lgkmcnt(10)
buffer_load_dword a254, v46, s[56:59], s77 offen
v_rcp_f32 v31, v31
Mvaa 192,148,128
v_exp_f32 v32, v32
v_mul_f32 v31, v251, v31
Mvaa 200,148,132
v_exp_f32 v33, v33
v_exp_f32 v34, v34
Mvaa 196,152,128
s_waitcnt vmcnt(20) lgkmcnt(0)
s_barrier
v_exp_f32 v35, v35
v_fma_f32 v32, v32, s25, s25
Mvaa 204,152,132
ds_read_b128 a[144:147], v36
v_fma_f32 v33, v33, s25, s25
v_fma_f32 v34, v34, s25, s25
Mvaa 208,156,128
ds_read_b128 a[148:151], v36 offset:1024
v_fma_f32 v35, v35, s25, s25
CV 76,28,29
Mvaa 216,156,132
ds_read_b128 a[152:155], v36 offset:2048
v_rcp_f32 v24, v24
Mvaa 212,160,128
ds_read_b128 a[156:159], v36 offset:3072
v_mul_f32 v24, v244, v24
CV 77,30,31
Mvaa 220,160,132
ds_read_b128 a[160:163], v36 offset:4096
v_rcp_f32 v25, v25
v_add_u32 v2, 0x9000, v2
Mvaa 192,164,136
v_rcp_f32 v26, v26
v_mul_f32 v25, v245, v25
Mvaa 200,164,140
ds_read_b128 a[164:167], v36 offset:5120
v_mul_f32 v26, v246, v26
CV 74,24,25
Mvaa 196,168,136
v_rcp_f32 v27, v27
v_fma_f32 v20, -v192, v192, s24
Mvaa 204,168,140
ds_read_b128 a[168:171], v36 offset:6144
v_mul_f32 v27, v247, v27
v_fma_f32 v21, -v193, v193, s24
Mvaa 208,172,136
v_rcp_f32 v32, v32
v_fma_f32 v22, -v194, v194, s24
Mvaa 216,172,140
ds_read_b128 a[172:175], v36 offset:7168
v_mul_f32 v32, v252, v32
v_fma_f32 v23, -v195, v195, s24
Mvaa 212,176,136
v_rcp_f32 v33, v33
v_rcp_f32 v34, v34
Mvaa 220,176,140
s_waitcnt lgkmcnt(3)
ds_read_b128 a[176:179], v36 offset:8192
v_mul_f32 v33, v253, v33
v_mul_f32 v34, v254, v34
v_mfma_f32_16x16x32_bf16 v[224:227], a[144:147], a[0:3], 0
v_rcp_f32 v35, v35
v_mfma_f32_16x16x32_bf16 v[232:235], a[144:147], a[4:7], 0
ds_read_b128 a[144:147], v36 offset:9216
v_mul_f32 v35, v255, v35
v_mul_f32 v20, v192, v20
v_mfma_f32_16x16x32_bf16 v[228:231], a[148:151], a[0:3], 0
buffer_load_dwordx4 v7, s[40:43], s76 offen sc1 lds
v_mul_f32 v21, v193, v21
v_mul_f32 v22, v194, v22
v_mfma_f32_16x16x32_bf16 v[236:239], a[148:151], a[4:7], 0
ds_read_b128 a[148:151], v36 offset:10240
v_mul_f32 v23, v195, v23
v_fma_f32 v28, -v200, v200, s24
v_mfma_f32_16x16x32_bf16 v[240:243], a[152:155], a[0:3], 0
v_exp_f32 v20, v20
v_mfma_f32_16x16x32_bf16 v[248:251], a[152:155], a[4:7], 0
ds_read_b128 a[152:155], v36 offset:11264
v_fma_f32 v29, -v201, v201, s24
v_fma_f32 v30, -v202, v202, s24
v_mfma_f32_16x16x32_bf16 v[244:247], a[156:159], a[0:3], 0
v_exp_f32 v21, v21
v_fma_f32 v31, -v203, v203, s24
v_mfma_f32_16x16x32_bf16 v[252:255], a[156:159], a[4:7], 0
ds_read_b128 a[156:159], v36 offset:12288
v_mul_f32 v28, v200, v28
v_mul_f32 v29, v201, v29
Mvaa 224,160,8
buffer_load_dwordx4 v7, s[40:43], s76 offen offset:1024 sc1 lds
v_mul_f32 v30, v202, v30
Mvaa 232,160,12
s_waitcnt lgkmcnt(3)
ds_read_b128 a[160:163], v36 offset:13312
v_mul_f32 v31, v203, v31
v_fma_f32 v20, v20, s25, s25
Mvaa 228,164,8
v_exp_f32 v22, v22
v_fma_f32 v21, v21, s25, s25
Mvaa 236,164,12
ds_read_b128 a[164:167], v36 offset:14336
v_fma_f32 v22, v22, s25, s25
CV 75,26,27
Mvaa 240,168,8
v_exp_f32 v23, v23
Mvaa 248,168,12
ds_read_b128 a[168:171], v36 offset:15360
v_fma_f32 v23, v23, s25, s25
v_fma_f32 v24, -v196, v196, s24
Mvaa 244,172,8
buffer_load_dwordx4 v7, s[40:43], s76 offen offset:2048 sc1 lds
v_fma_f32 v25, -v197, v197, s24
v_fma_f32 v26, -v198, v198, s24
Mvaa 252,172,12
ds_read_b128 a[172:175], v36 offset:16384
v_fma_f32 v27, -v199, v199, s24
v_mul_f32 v24, v196, v24
Mvaa 224,176,16
v_exp_f32 v28, v28
Mvaa 232,176,20
ds_read_b128 a[176:179], v36 offset:17408
v_mul_f32 v25, v197, v25
v_mul_f32 v26, v198, v26
Mvaa 228,144,16
v_exp_f32 v29, v29
v_mul_f32 v27, v199, v27
Mvaa 236,144,20
s_waitcnt lgkmcnt(3)
ds_read_b128 a[144:147], v36 offset:18432
v_fma_f32 v28, v28, s25, s25
v_fma_f32 v29, v29, s25, s25
Mvaa 240,148,16
buffer_load_dwordx4 v7, s[40:43], s76 offen offset:3072 sc1 lds
CV 78,32,33
Mvaa 248,148,20
s_add_u32 m0, s67, 0xa000
s_add_u32 s76, s71, 0x52000
ds_read_b128 a[148:151], v36 offset:19456
CV 79,34,35
L_pg2_11:
s_cbranch_execz L_ret2
Mvaa 244,152,16
v_exp_f32 v30, v30
v_fma_f32 v32, -v204, v204, s24
Mvaa 252,152,20
ds_read_b128 a[152:155], v36 offset:20480
v_fma_f32 v30, v30, s25, s25
v_fma_f32 v33, -v205, v205, s24
Mvaa 224,156,24
v_exp_f32 v31, v31
Mvaa 232,156,28
ds_read_b128 a[156:159], v36 offset:21504
v_fma_f32 v31, v31, s25, s25
v_fma_f32 v34, -v206, v206, s24
Mvaa 228,160,24
buffer_load_dwordx4 v7, s[40:43], s76 offen sc1 lds
v_fma_f32 v35, -v207, v207, s24
v_mul_f32 v32, v204, v32
Mvaa 236,160,28
ds_read_b128 a[160:163], v36 offset:22528
v_mul_f32 v33, v205, v33
v_mul_f32 v34, v206, v34
Mvaa 240,164,24
v_rcp_f32 v20, v20
Mvaa 248,164,28
s_waitcnt lgkmcnt(3)
ds_read_b128 a[164:167], v36 offset:23552
v_mul_f32 v20, v192, v20
v_mul_f32 v35, v207, v35
Mvaa 244,168,24
v_rcp_f32 v21, v21
v_add_u32 v3, 0x9000, v3
Mvaa 252,168,28
ds_read_b128 a[168:171], v36 offset:24576
v_mul_f32 v21, v193, v21
v_add_u32 v4, 0x9000, v4
Mvaa 224,172,32
buffer_load_dwordx4 v7, s[40:43], s76 offen offset:1024 sc1 lds
CV 80,20,21
Mvaa 232,172,36
ds_read_b128 a[172:175], v36 offset:25600
v_fma_f32 v20, -v208, v208, s24
v_fma_f32 v21, -v209, v209, s24
Mvaa 228,176,32
v_rcp_f32 v22, v22
v_mul_f32 v20, v208, v20
Mvaa 236,176,36
ds_read_b128 a[176:179], v36 offset:26624
v_mul_f32 v22, v194, v22
v_mul_f32 v21, v209, v21
Mvaa 240,144,32
v_rcp_f32 v23, v23
Mvaa 248,144,36
ds_read_b128 a[144:147], v36 offset:27648
v_mul_f32 v23, v195, v23
v_add_u32 v5, 0x9000, v5
Mvaa 244,148,32
buffer_load_dwordx4 v7, s[40:43], s76 offen offset:2048 sc1 lds
CV 81,22,23
v_fma_f32 v22, -v210, v210, s24
Mvaa 252,148,36
s_waitcnt lgkmcnt(3)
ds_read_b128 a[148:151], v36 offset:28672
v_fma_f32 v23, -v211, v211, s24
v_mul_f32 v22, v210, v22
Mvaa 224,152,40
v_exp_f32 v24, v24
Mvaa 232,152,44
ds_read_b128 a[152:155], v36 offset:29696
v_fma_f32 v24, v24, s25, s25
v_mul_f32 v23, v211, v23
Mvaa 228,156,40
v_exp_f32 v25, v25
Mvaa 236,156,44
ds_read_b128 a[156:159], v36 offset:30720
v_fma_f32 v25, v25, s25, s25
v_exp_f32 v26, v26
Mvaa 240,160,40
buffer_load_dwordx4 v7, s[40:43], s76 offen offset:3072 sc1 lds
v_fma_f32 v26, v26, s25, s25
Mvaa 248,160,44
s_add_u32 m0, s67, 0xb000
s_add_u32 s76, s71, 0x53000
ds_read_b128 a[160:163], v36 offset:31744
Mvaa 244,164,40
v_exp_f32 v27, v27
v_rcp_f32 v28, v28
Mvaa 252,164,44
s_waitcnt lgkmcnt(2)
ds_read_b128 a[164:167], v36 offset:32768
v_fma_f32 v27, v27, s25, s25
v_mul_f32 v28, v200, v28
Mvaa 224,168,48
s_mul_i32 s77, s100, 0x480
v_min_u32 v46, 8, v1
Mvaa 232,168,52
s_mul_i32 s85, s66, 0xa2000
ds_read_b128 a[168:171], v36 offset:33792
v_mul_u32_u24 v46, 0x80, v46
Mvaa 228,172,48
buffer_load_dwordx4 v7, s[40:43], s76 offen sc1 lds
v_rcp_f32 v29, v29
Mvaa 236,172,52
s_add_u32 m0, s67, 0x12000
ds_read_b128 a[172:175], v36 offset:34816
v_mul_f32 v29, v201, v29
v_rcp_f32 v30, v30
Mvaa 240,176,48
s_add_u32 s76, s71, 0x5a000
v_rcp_f32 v31, v31
Mvaa 248,176,52
s_add_u32 s77, s77, s85
ds_read_b128 a[176:179], v36 offset:35840
v_add_u32 v36, 0x9000, v36
v_mul_f32 v30, v202, v30
Mvaa 244,144,48
buffer_load_dword a254, v46, s[56:59], s77 offen
v_mul_f32 v31, v203, v31
CV 84,28,29
Mvaa 252,144,52
v_exp_f32 v32, v32
CV 85,30,31
Mvaa 224,148,56
v_exp_f32 v33, v33
Mvaa 232,148,60
v_exp_f32 v34, v34
v_fma_f32 v32, v32, s25, s25
Mvaa 228,152,56
v_exp_f32 v35, v35
v_fma_f32 v33, v33, s25, s25
Mvaa 236,152,60
s_waitcnt vmcnt(20) lgkmcnt(0)
s_barrier
v_rcp_f32 v24, v24
v_fma_f32 v34, v34, s25, s25
Mvaa 240,156,56
ds_read_b128 a[144:147], v36
v_fma_f32 v35, v35, s25, s25
Mvaa 248,156,60
ds_read_b128 a[148:151], v36 offset:1024
v_mul_f32 v24, v196, v24
v_fma_f32 v28, -v216, v216, s24
Mvaa 244,160,56
ds_read_b128 a[152:155], v36 offset:2048
v_fma_f32 v29, -v217, v217, s24
v_fma_f32 v30, -v218, v218, s24
Mvaa 252,160,60
ds_read_b128 a[156:159], v36 offset:3072
v_fma_f32 v31, -v219, v219, s24
v_mul_f32 v28, v216, v28
Mvaa 224,164,64
ds_read_b128 a[160:163], v36 offset:4096
v_mul_f32 v29, v217, v29
Mvaa 232,164,68
ds_read_b128 a[164:167], v36 offset:5120
v_mul_f32 v30, v218, v30
v_mul_f32 v31, v219, v31
Mvaa 228,168,64
v_rcp_f32 v25, v25
Mvaa 236,168,68
ds_read_b128 a[168:171], v36 offset:6144
v_mul_f32 v25, v197, v25
v_rcp_f32 v26, v26
Mvaa 240,172,64
v_rcp_f32 v27, v27
Mvaa 248,172,68
ds_read_b128 a[172:175], v36 offset:7168
v_mul_f32 v26, v198, v26
v_mul_f32 v27, v199, v27
Mvaa 244,176,64
v_exp_f32 v20, v20
CV 82,24,25
Mvaa 252,176,68
s_waitcnt lgkmcnt(4)
ds_read_b128 a[176:179], v36 offset:8192
v_fma_f32 v20, v20, s25, s25
CV 83,26,27
Mvaa 224,144,72
v_exp_f32 v21, v21
Mvaa 232,144,76
ds_read_b128 a[144:147], v36 offset:9216
v_fma_f32 v21, v21, s25, s25
v_fma_f32 v24, -v212, v212, s24
Mvaa 228,148,72
buffer_load_dwordx4 v7, s[40:43], s76 offen sc1 lds
v_fma_f32 v25, -v213, v213, s24
v_fma_f32 v26, -v214, v214, s24
Mvaa 236,148,76
ds_read_b128 a[148:151], v36 offset:10240
v_fma_f32 v27, -v215, v215, s24
v_mul_f32 v24, v212, v24
Mvaa 240,152,72
v_exp_f32 v22, v22
Mvaa 248,152,76
ds_read_b128 a[152:155], v36 offset:11264
v_fma_f32 v22, v22, s25, s25
v_mul_f32 v25, v213, v25
Mvaa 244,156,72
v_exp_f32 v23, v23
v_mul_f32 v26, v214, v26
Mvaa 252,156,76
s_waitcnt lgkmcnt(3)
ds_read_b128 a[156:159], v36 offset:12288
v_fma_f32 v23, v23, s25, s25
v_mul_f32 v27, v215, v27
Mvaa 224,160,80
buffer_load_dwordx4 v7, s[40:43], s76 offen offset:1024 sc1 lds
Mvaa 232,160,84
ds_read_b128 a[160:163], v36 offset:13312
v_rcp_f32 v32, v32
Mvaa 228,164,80
v_rcp_f32 v33, v33
v_mul_f32 v32, v204, v32
Mvaa 236,164,84
ds_read_b128 a[164:167], v36 offset:14336
v_mul_f32 v33, v205, v33
Mvaa 240,168,80
v_rcp_f32 v34, v34
CV 86,32,33
Mvaa 248,168,84
ds_read_b128 a[168:171], v36 offset:15360
v_mul_f32 v34, v206, v34
v_fma_f32 v32, -v220, v220, s24
Mvaa 244,172,80
buffer_load_dwordx4 v7, s[40:43], s76 offen offset:2048 sc1 lds
v_fma_f32 v33, -v221, v221, s24
v_mul_f32 v32, v220, v32
Mvaa 252,172,84
ds_read_b128 a[172:175], v36 offset:16384
v_mul_f32 v33, v221, v33
Mvaa 224,176,88
v_rcp_f32 v35, v35
Mvaa 232,176,92
s_waitcnt lgkmcnt(3)
ds_read_b128 a[176:179], v36 offset:17408
v_mul_f32 v35, v207, v35
v_exp_f32 v28, v28
Mvaa 228,144,88
v_exp_f32 v29, v29
v_fma_f32 v28, v28, s25, s25
Mvaa 236,144,92
ds_read_b128 a[144:147], v36 offset:18432
v_fma_f32 v29, v29, s25, s25
CV 87,34,35
Mvaa 240,148,88
buffer_load_dwordx4 v7, s[40:43], s76 offen offset:3072 sc1 lds
v_fma_f32 v34, -v222, v222, s24
Mvaa 248,148,92
s_add_u32 m0, s67, 0x13000
s_add_u32 s76, s71, 0x5b000
ds_read_b128 a[148:151], v36 offset:19456
v_fma_f32 v35, -v223, v223, s24
Mvaa 244,152,88
v_exp_f32 v30, v30
v_mul_f32 v34, v222, v34
Mvaa 252,152,92
ds_read_b128 a[152:155], v36 offset:20480
v_fma_f32 v30, v30, s25, s25
v_mul_f32 v35, v223, v35
Mvaa 224,156,96
v_exp_f32 v31, v31
Mvaa 232,156,100
ds_read_b128 a[156:159], v36 offset:21504
v_fma_f32 v31, v31, s25, s25
Mvaa 228,160,96
buffer_load_dwordx4 v7, s[40:43], s76 offen sc1 lds
v_rcp_f32 v20, v20
Mvaa 236,160,100
s_waitcnt lgkmcnt(3)
ds_read_b128 a[160:163], v36 offset:22528
v_mul_f32 v20, v208, v20
v_rcp_f32 v21, v21
Mvaa 240,164,96
s_lshl_b32 s85, s30, 7
v_rcp_f32 v22, v22
Mvaa 248,164,100
s_add_u32 s85, s85, 0x4000
ds_read_b128 a[164:167], v36 offset:23552
v_mov_b32 v46, s85
v_mul_f32 v21, v209, v21
Mvaa 244,168,96
s_getpc_b64 s[96:97]
v_rcp_f32 v23, v23
v_mul_f32 v22, v210, v22
Mvaa 252,168,100
global_load_dword a252, v46, s[96:97]
ds_read_b128 a[168:171], v36 offset:24576
Mvaa 224,172,104
v_exp_f32 v24, v24
v_mul_f32 v23, v211, v23
Mvaa 232,172,108
buffer_load_dwordx4 v7, s[40:43], s76 offen offset:1024 sc1 lds
ds_read_b128 a[172:175], v36 offset:25600
Mvaa 228,176,104
v_exp_f32 v25, v25
v_exp_f32 v26, v26
Mvaa 236,176,108
ds_read_b128 a[176:179], v36 offset:26624
v_fma_f32 v24, v24, s25, s25
v_fma_f32 v25, v25, s25, s25
Mvaa 240,144,104
v_exp_f32 v27, v27
Mvaa 248,144,108
s_waitcnt lgkmcnt(3)
ds_read_b128 a[144:147], v36 offset:27648
v_fma_f32 v26, v26, s25, s25
v_fma_f32 v27, v27, s25, s25
Mvaa 244,148,104
buffer_load_dwordx4 v7, s[40:43], s76 offen offset:2048 sc1 lds
v_rcp_f32 v28, v28
Mvaa 252,148,108
ds_read_b128 a[148:151], v36 offset:28672
v_mul_f32 v28, v216, v28
CV 88,20,21
Mvaa 224,152,112
v_rcp_f32 v29, v29
Mvaa 232,152,116
ds_read_b128 a[152:155], v36 offset:29696
v_mul_f32 v29, v217, v29
CV 89,22,23
Mvaa 228,156,112
v_rcp_f32 v30, v30
CV 92,28,29
Mvaa 236,156,116
ds_read_b128 a[156:159], v36 offset:30720
v_mul_f32 v30, v218, v30
Mvaa 240,160,112
buffer_load_dwordx4 v7, s[40:43], s76 offen offset:3072 sc1 lds
v_rcp_f32 v31, v31
Mvaa 248,160,116
s_add_u32 m0, s67, 0x14000
s_add_u32 s76, s71, 0x5c000
ds_read_b128 a[160:163], v36 offset:31744
v_mul_f32 v31, v219, v31
Mvaa 244,164,112
v_exp_f32 v32, v32
CV 93,30,31
Mvaa 252,164,116
s_waitcnt lgkmcnt(3)
ds_read_b128 a[164:167], v36 offset:32768
v_fma_f32 v32, v32, s25, s25
Mvaa 224,168,120
s_mul_i32 s77, s100, 0x480
v_min_u32 v46, 8, v1
v_exp_f32 v33, v33
Mvaa 232,168,124
s_mul_i32 s85, s66, 0xa2000
ds_read_b128 a[168:171], v36 offset:33792
v_mul_u32_u24 v46, 0x80, v46
v_fma_f32 v33, v33, s25, s25
Mvaa 228,172,120
buffer_load_dwordx4 v7, s[40:43], s76 offen sc1 lds
v_exp_f32 v34, v34
Mvaa 236,172,124
s_add_u32 m0, s67, 0x1b000
ds_read_b128 a[172:175], v36 offset:34816
v_fma_f32 v34, v34, s25, s25
Mvaa 240,176,120
s_add_u32 s76, s71, 0x63000
v_exp_f32 v35, v35
Mvaa 248,176,124
s_add_u32 s77, s77, s85
ds_read_b128 a[176:179], v36 offset:35840
v_add_u32 v36, 0xfffe5000, v36
v_rcp_f32 v24, v24
Mvaa 244,144,120
s_add_u32 s77, s77, 0x12000
v_rcp_f32 v25, v25
v_fma_f32 v35, v35, s25, s25
Mvaa 252,144,124
buffer_load_dword a254, v46, s[56:59], s77 offen
v_mul_f32 v24, v212, v24
v_mul_f32 v25, v213, v25
Mvaa 224,148,128
v_rcp_f32 v26, v26
Mvaa 232,148,132
s_waitcnt lgkmcnt(2)
v_rcp_f32 v27, v27
v_mul_f32 v26, v214, v26
Mvaa 228,152,128
s_waitcnt vmcnt(22) lgkmcnt(0)
s_barrier
v_rcp_f32 v32, v32
v_mul_f32 v27, v215, v27
Mvaa 236,152,132
ds_read_b128 a[144:147], v36
v_mul_f32 v32, v220, v32
CV 90,24,25
Mvaa 240,156,128
ds_read_b128 a[148:151], v36 offset:1024
CV 91,26,27
Mvaa 248,156,132
ds_read_b128 a[152:155], v36 offset:2048
v_rcp_f32 v33, v33
Mvaa 244,160,128
ds_read_b128 a[156:159], v36 offset:3072
v_mul_f32 v33, v221, v33
Mvaa 252,160,132
ds_read_b128 a[160:163], v36 offset:4096
v_rcp_f32 v34, v34
CV 94,32,33
Mvaa 224,164,136
v_rcp_f32 v35, v35
Mvaa 232,164,140
ds_read_b128 a[164:167], v36 offset:5120
v_mul_f32 v34, v222, v34
v_mul_f32 v35, v223, v35
Mvaa 228,168,136
s_nop 1
v_fma_f32 v20, -v224, v224, s24
Mvaa 236,168,140
ds_read_b128 a[168:171], v36 offset:6144
v_fma_f32 v21, -v225, v225, s24
v_fma_f32 v22, -v226, v226, s24
Mvaa 240,172,136
v_fma_f32 v23, -v227, v227, s24
v_mul_f32 v20, v224, v20
Mvaa 248,172,140
ds_read_b128 a[172:175], v36 offset:7168
v_mul_f32 v21, v225, v21
v_mul_f32 v22, v226, v22
Mvaa 244,176,136
v_exp_f32 v20, v20
v_mul_f32 v23, v227, v23
Mvaa 252,176,140
s_waitcnt lgkmcnt(3)
ds_read_b128 a[176:179], v36 offset:8192
v_fma_f32 v28, -v232, v232, s24
v_fma_f32 v29, -v233, v233, s24
v_mfma_f32_16x16x32_bf16 v[192:195], a[144:147], a[0:3], 0
v_exp_f32 v21, v21
v_mfma_f32_16x16x32_bf16 v[200:203], a[144:147], a[4:7], 0
ds_read_b128 a[144:147], v36 offset:9216
v_fma_f32 v30, -v234, v234, s24
v_fma_f32 v31, -v235, v235, s24
v_mfma_f32_16x16x32_bf16 v[196:199], a[148:151], a[0:3], 0
buffer_load_dwordx4 v7, s[40:43], s76 offen sc1 lds
v_mul_f32 v28, v232, v28
v_mul_f32 v29, v233, v29
v_mfma_f32_16x16x32_bf16 v[204:207], a[148:151], a[4:7], 0
ds_read_b128 a[148:151], v36 offset:10240
v_mul_f32 v30, v234, v30
v_mul_f32 v31, v235, v31
v_mfma_f32_16x16x32_bf16 v[208:211], a[152:155], a[0:3], 0
v_exp_f32 v22, v22
v_mfma_f32_16x16x32_bf16 v[216:219], a[152:155], a[4:7], 0
ds_read_b128 a[152:155], v36 offset:11264
v_fma_f32 v20, v20, s25, s25
v_fma_f32 v21, v21, s25, s25
v_mfma_f32_16x16x32_bf16 v[212:215], a[156:159], a[0:3], 0
v_exp_f32 v23, v23
v_fma_f32 v22, v22, s25, s25
v_mfma_f32_16x16x32_bf16 v[220:223], a[156:159], a[4:7], 0
ds_read_b128 a[156:159], v36 offset:12288
v_fma_f32 v23, v23, s25, s25
v_fma_f32 v24, -v228, v228, s24
Mvaa 192,160,8
buffer_load_dwordx4 v7, s[40:43], s76 offen offset:1024 sc1 lds
v_fma_f32 v25, -v229, v229, s24
Mvaa 200,160,12
s_waitcnt lgkmcnt(3)
ds_read_b128 a[160:163], v36 offset:13312
v_fma_f32 v26, -v230, v230, s24
v_fma_f32 v27, -v231, v231, s24
Mvaa 196,164,8
v_exp_f32 v28, v28
v_mul_f32 v24, v228, v24
Mvaa 204,164,12
ds_read_b128 a[164:167], v36 offset:14336
v_mul_f32 v25, v229, v25
v_mul_f32 v26, v230, v26
Mvaa 208,168,8
v_exp_f32 v29, v29
Mvaa 216,168,12
ds_read_b128 a[168:171], v36 offset:15360
v_mul_f32 v27, v231, v27
v_fma_f32 v28, v28, s25, s25
Mvaa 212,172,8
buffer_load_dwordx4 v7, s[40:43], s76 offen offset:2048 sc1 lds
v_fma_f32 v29, v29, s25, s25
CV 95,34,35
Mvaa 220,172,12
ds_read_b128 a[172:175], v36 offset:16384
v_fma_f32 v32, -v236, v236, s24
v_fma_f32 v33, -v237, v237, s24
Mvaa 192,176,16
v_exp_f32 v30, v30
Mvaa 200,176,20
ds_read_b128 a[176:179], v36 offset:17408
v_fma_f32 v30, v30, s25, s25
v_fma_f32 v34, -v238, v238, s24
Mvaa 196,144,16
v_exp_f32 v31, v31
v_fma_f32 v35, -v239, v239, s24
Mvaa 204,144,20
s_waitcnt lgkmcnt(3)
ds_read_b128 a[144:147], v36 offset:18432
v_fma_f32 v31, v31, s25, s25
v_mul_f32 v32, v236, v32
Mvaa 208,148,16
buffer_load_dwordx4 v7, s[40:43], s76 offen offset:3072 sc1 lds
v_mul_f32 v33, v237, v33
Mvaa 216,148,20
s_add_u32 m0, s67, 0x1c000
s_add_u32 s76, s71, 0x64000
ds_read_b128 a[148:151], v36 offset:19456
v_mul_f32 v34, v238, v34
Mvaa 212,152,16
v_rcp_f32 v20, v20
v_mul_f32 v35, v239, v35
Mvaa 220,152,20
ds_read_b128 a[152:155], v36 offset:20480
v_mul_f32 v20, v224, v20
Mvaa 192,156,24
v_rcp_f32 v21, v21
Mvaa 200,156,28
ds_read_b128 a[156:159], v36 offset:21504
v_mul_f32 v21, v225, v21
v_rcp_f32 v22, v22
Mvaa 196,160,24
buffer_load_dwordx4 v7, s[40:43], s76 offen sc1 lds
v_mul_f32 v22, v226, v22
CV 96,20,21
Mvaa 204,160,28
ds_read_b128 a[160:163], v36 offset:22528
v_fma_f32 v20, -v240, v240, s24
v_fma_f32 v21, -v241, v241, s24
Mvaa 208,164,24
v_rcp_f32 v23, v23
Mvaa 216,164,28
s_waitcnt lgkmcnt(3)
ds_read_b128 a[164:167], v36 offset:23552
v_mul_f32 v23, v227, v23
v_mul_f32 v20, v240, v20
Mvaa 212,168,24
v_exp_f32 v24, v24
CV 97,22,23
Mvaa 220,168,28
ds_read_b128 a[168:171], v36 offset:24576
v_fma_f32 v24, v24, s25, s25
v_fma_f32 v22, -v242, v242, s24
Mvaa 192,172,32
buffer_load_dwordx4 v7, s[40:43], s76 offen offset:1024 sc1 lds
v_fma_f32 v23, -v243, v243, s24
Mvaa 200,172,36
ds_read_b128 a[172:175], v36 offset:25600
v_mul_f32 v21, v241, v21
v_mul_f32 v22, v242, v22
Mvaa 196,176,32
v_exp_f32 v25, v25
v_mul_f32 v23, v243, v23
Mvaa 204,176,36
ds_read_b128 a[176:179], v36 offset:26624
v_fma_f32 v25, v25, s25, s25
Mvaa 208,144,32
v_exp_f32 v26, v26
Mvaa 216,144,36
ds_read_b128 a[144:147], v36 offset:27648
v_fma_f32 v26, v26, s25, s25
v_exp_f32 v27, v27
Mvaa 212,148,32
buffer_load_dwordx4 v7, s[40:43], s76 offen offset:2048 sc1 lds
v_fma_f32 v27, v27, s25, s25
Mvaa 220,148,36
s_waitcnt lgkmcnt(3)
ds_read_b128 a[148:151], v36 offset:28672
v_rcp_f32 v28, v28
Mvaa 192,152,40
v_rcp_f32 v29, v29
v_mul_f32 v28, v232, v28
Mvaa 200,152,44
ds_read_b128 a[152:155], v36 offset:29696
v_mul_f32 v29, v233, v29
Mvaa 196,156,40
v_rcp_f32 v30, v30
v_rcp_f32 v31, v31
Mvaa 204,156,44
ds_read_b128 a[156:159], v36 offset:30720
v_mul_f32 v30, v234, v30
v_mul_f32 v31, v235, v31
Mvaa 208,160,40
buffer_load_dwordx4 v7, s[40:43], s76 offen offset:3072 sc1 lds
CV 100,28,29
Mvaa 216,160,44
s_add_u32 m0, s67, 0x1d000
s_add_u32 s76, s71, 0x65000
ds_read_b128 a[160:163], v36 offset:31744
CV 101,30,31
Mvaa 212,164,40
v_exp_f32 v32, v32
v_fma_f32 v28, -v248, v248, s24
Mvaa 220,164,44
s_waitcnt lgkmcnt(2)
ds_read_b128 a[164:167], v36 offset:32768
v_fma_f32 v32, v32, s25, s25
v_fma_f32 v29, -v249, v249, s24
Mvaa 192,168,48
s_mul_i32 s77, s100, 0x480
v_min_u32 v46, 8, v1
v_fma_f32 v30, -v250, v250, s24
Mvaa 200,168,52
s_mul_i32 s85, s66, 0xa2000
ds_read_b128 a[168:171], v36 offset:33792
v_mul_u32_u24 v46, 0x80, v46
v_fma_f32 v31, -v251, v251, s24
Mvaa 196,172,48
L_pg2_12:
s_cbranch_execz L_ret2
buffer_load_dwordx4 v7, s[40:43], s76 offen sc1 lds
v_mul_f32 v28, v248, v28
v_mul_f32 v29, v249, v29
Mvaa 204,172,52
s_add_u32 m0, s67, 0
ds_read_b128 a[172:175], v36 offset:34816
v_mul_f32 v30, v250, v30
v_mul_f32 v31, v251, v31
Mvaa 208,176,48
s_add_u32 s76, s71, 0x6c000
v_exp_f32 v33, v33
Mvaa 216,176,52
s_add_u32 s77, s77, s85
ds_read_b128 a[176:179], v36 offset:35840
v_add_u32 v36, 0x9000, v36
v_fma_f32 v33, v33, s25, s25
Mvaa 212,144,48
s_add_u32 s77, s77, 0x24000
v_exp_f32 v34, v34
Mvaa 220,144,52
buffer_load_dword a254, v46, s[56:59], s77 offen
v_fma_f32 v34, v34, s25, s25
v_exp_f32 v35, v35
Mvaa 192,148,56
v_rcp_f32 v24, v24
Mvaa 200,148,60
v_rcp_f32 v25, v25
v_fma_f32 v35, v35, s25, s25
Mvaa 196,152,56
v_rcp_f32 v26, v26
v_mul_f32 v24, v228, v24
Mvaa 204,152,60
s_waitcnt vmcnt(22) lgkmcnt(0)
s_barrier
v_rcp_f32 v27, v27
v_mul_f32 v25, v229, v25
Mvaa 208,156,56
ds_read_b128 a[144:147], v36
v_mul_f32 v26, v230, v26
Mvaa 216,156,60
ds_read_b128 a[148:151], v36 offset:1024
v_mul_f32 v27, v231, v27
CV 98,24,25
Mvaa 212,160,56
ds_read_b128 a[152:155], v36 offset:2048
CV 99,26,27
v_fma_f32 v24, -v244, v244, s24
Mvaa 220,160,60
ds_read_b128 a[156:159], v36 offset:3072
v_fma_f32 v25, -v245, v245, s24
v_fma_f32 v26, -v246, v246, s24
Mvaa 192,164,64
ds_read_b128 a[160:163], v36 offset:4096
v_fma_f32 v27, -v247, v247, s24
Mvaa 200,164,68
ds_read_b128 a[164:167], v36 offset:5120
v_mul_f32 v24, v244, v24
v_mul_f32 v25, v245, v25
Mvaa 196,168,64
v_exp_f32 v20, v20
v_mul_f32 v26, v246, v26
Mvaa 204,168,68
ds_read_b128 a[168:171], v36 offset:6144
v_fma_f32 v20, v20, s25, s25
v_mul_f32 v27, v247, v27
Mvaa 208,172,64
v_exp_f32 v21, v21
Mvaa 216,172,68
ds_read_b128 a[172:175], v36 offset:7168
v_fma_f32 v21, v21, s25, s25
Mvaa 212,176,64
v_exp_f32 v22, v22
v_exp_f32 v23, v23
Mvaa 220,176,68
s_waitcnt lgkmcnt(4)
ds_read_b128 a[176:179], v36 offset:8192
v_fma_f32 v22, v22, s25, s25
v_fma_f32 v23, v23, s25, s25
Mvaa 192,144,72
s_mov_b64 exec, 0
s_cmp_eq_u32 s64, 0
s_cbranch_scc1 L_pg3_13
s_cmp_eq_u32 s64, 1
s_cbranch_scc1 L_pg3_14
s_cmp_eq_u32 s64, 2
s_cbranch_scc1 L_pg3_15
s_branch L_pg3_16
L_ret3:
s_mov_b64 exec, -1
v_rcp_f32 v32, v32
Mvaa 200,144,76
ds_read_b128 a[144:147], v36 offset:9216
v_mul_f32 v32, v236, v32
Mvaa 196,148,72
buffer_load_dwordx4 v7, s[40:43], s76 offen sc1 lds
v_rcp_f32 v33, v33
Mvaa 204,148,76
ds_read_b128 a[148:151], v36 offset:10240
v_mul_f32 v33, v237, v33
v_rcp_f32 v34, v34
Mvaa 208,152,72
v_rcp_f32 v35, v35
Mvaa 216,152,76
ds_read_b128 a[152:155], v36 offset:11264
v_mul_f32 v34, v238, v34
v_mul_f32 v35, v239, v35
Mvaa 212,156,72
v_exp_f32 v28, v28
CV 102,32,33
Mvaa 220,156,76
s_waitcnt lgkmcnt(3)
ds_read_b128 a[156:159], v36 offset:12288
v_fma_f32 v28, v28, s25, s25
CV 103,34,35
Mvaa 192,160,80
buffer_load_dwordx4 v7, s[40:43], s76 offen offset:1024 sc1 lds
v_fma_f32 v32, -v252, v252, s24
Mvaa 200,160,84
ds_read_b128 a[160:163], v36 offset:13312
v_fma_f32 v33, -v253, v253, s24
v_fma_f32 v34, -v254, v254, s24
Mvaa 196,164,80
v_exp_f32 v29, v29
v_fma_f32 v35, -v255, v255, s24
Mvaa 204,164,84
ds_read_b128 a[164:167], v36 offset:14336
v_fma_f32 v29, v29, s25, s25
v_mul_f32 v32, v252, v32
Mvaa 208,168,80
v_exp_f32 v30, v30
Mvaa 216,168,84
ds_read_b128 a[168:171], v36 offset:15360
v_fma_f32 v30, v30, s25, s25
v_mul_f32 v33, v253, v33
Mvaa 212,172,80
buffer_load_dwordx4 v7, s[40:43], s76 offen offset:2048 sc1 lds
v_mul_f32 v34, v254, v34
v_mul_f32 v35, v255, v35
Mvaa 220,172,84
ds_read_b128 a[172:175], v36 offset:16384
v_exp_f32 v31, v31
Mvaa 192,176,88
v_rcp_f32 v20, v20
Mvaa 200,176,92
s_waitcnt lgkmcnt(3)
ds_read_b128 a[176:179], v36 offset:17408
v_fma_f32 v31, v31, s25, s25
v_mul_f32 v20, v240, v20
Mvaa 196,144,88
v_rcp_f32 v21, v21
Mvaa 204,144,92
ds_read_b128 a[144:147], v36 offset:18432
v_mul_f32 v21, v241, v21
v_rcp_f32 v22, v22
Mvaa 208,148,88
buffer_load_dwordx4 v7, s[40:43], s76 offen offset:3072 sc1 lds
v_mul_f32 v22, v242, v22
Mvaa 216,148,92
s_add_u32 m0, s67, 0x1000
s_add_u32 s76, s71, 0x6d000
ds_read_b128 a[148:151], v36 offset:19456
CV 104,20,21
Mvaa 212,152,88
v_rcp_f32 v23, v23
Mvaa 220,152,92
ds_read_b128 a[152:155], v36 offset:20480
v_mul_f32 v23, v243, v23
v_exp_f32 v24, v24
Mvaa 192,156,96
v_exp_f32 v25, v25
Mvaa 200,156,100
ds_read_b128 a[156:159], v36 offset:21504
v_fma_f32 v24, v24, s25, s25
v_fma_f32 v25, v25, s25, s25
Mvaa 196,160,96
buffer_load_dwordx4 v7, s[40:43], s76 offen sc1 lds
v_exp_f32 v26, v26
Mvaa 204,160,100
s_waitcnt lgkmcnt(3)
ds_read_b128 a[160:163], v36 offset:22528
v_fma_f32 v26, v26, s25, s25
CV 105,22,23
Mvaa 208,164,96
v_exp_f32 v27, v27
Mvaa 216,164,100
ds_read_b128 a[164:167], v36 offset:23552
v_fma_f32 v27, v27, s25, s25
Mvaa 212,168,96
v_rcp_f32 v28, v28
v_rcp_f32 v29, v29
Mvaa 220,168,100
ds_read_b128 a[168:171], v36 offset:24576
v_mul_f32 v28, v248, v28
v_mul_f32 v29, v249, v29
Mvaa 192,172,104
buffer_load_dwordx4 v7, s[40:43], s76 offen offset:1024 sc1 lds
CV 108,28,29
Mvaa 200,172,108
ds_read_b128 a[172:175], v36 offset:25600
v_rcp_f32 v30, v30
Mvaa 196,176,104
v_rcp_f32 v31, v31
v_mul_f32 v30, v250, v30
Mvaa 204,176,108
ds_read_b128 a[176:179], v36 offset:26624
v_mul_f32 v31, v251, v31
Mvaa 208,144,104
v_exp_f32 v32, v32
CV 109,30,31
Mvaa 216,144,108
s_waitcnt lgkmcnt(3)
ds_read_b128 a[144:147], v36 offset:27648
v_fma_f32 v32, v32, s25, s25
Mvaa 212,148,104
buffer_load_dwordx4 v7, s[40:43], s76 offen offset:2048 sc1 lds
v_exp_f32 v33, v33
Mvaa 220,148,108
ds_read_b128 a[148:151], v36 offset:28672
v_fma_f32 v33, v33, s25, s25
v_exp_f32 v34, v34
Mvaa 192,152,112
v_exp_f32 v35, v35
Mvaa 200,152,116
ds_read_b128 a[152:155], v36 offset:29696
v_fma_f32 v34, v34, s25, s25
v_fma_f32 v35, v35, s25, s25
Mvaa 196,156,112
v_rcp_f32 v24, v24
Mvaa 204,156,116
ds_read_b128 a[156:159], v36 offset:30720
v_mul_f32 v24, v244, v24
v_rcp_f32 v25, v25
Mvaa 208,160,112
buffer_load_dwordx4 v7, s[40:43], s76 offen offset:3072 sc1 lds
v_mul_f32 v25, v245, v25
Mvaa 216,160,116
s_add_u32 m0, s67, 0x2000
s_add_u32 s76, s71, 0x6e000
ds_read_b128 a[160:163], v36 offset:31744
CV 106,24,25
Mvaa 212,164,112
v_rcp_f32 v26, v26
Mvaa 220,164,116
s_waitcnt lgkmcnt(3)
ds_read_b128 a[164:167], v36 offset:32768
v_mul_f32 v26, v246, v26
v_rcp_f32 v27, v27
Mvaa 192,168,120
s_mul_i32 s77, s100, 0x480
v_min_u32 v46, 8, v1
v_mul_f32 v27, v247, v27
Mvaa 200,168,124
s_mul_i32 s85, s66, 0xa2000
ds_read_b128 a[168:171], v36 offset:33792
v_mul_u32_u24 v46, 0x80, v46
CV 107,26,27
Mvaa 196,172,120
buffer_load_dwordx4 v7, s[40:43], s76 offen sc1 lds
v_rcp_f32 v32, v32
Mvaa 204,172,124
s_add_u32 m0, s67, 0x9000
ds_read_b128 a[172:175], v36 offset:34816
v_mul_f32 v32, v252, v32
Mvaa 208,176,120
s_add_u32 s76, s71, 0x75000
v_rcp_f32 v33, v33
Mvaa 216,176,124
s_add_u32 s77, s77, s85
ds_read_b128 a[176:179], v36 offset:35840
v_add_u32 v36, 0x9000, v36
v_rcp_f32 v34, v34
Mvaa 212,144,120
s_add_u32 s77, s77, 0x36000
v_rcp_f32 v35, v35
v_mul_f32 v33, v253, v33
Mvaa 220,144,124
buffer_load_dword a254, v46, s[56:59], s77 offen
v_mul_f32 v34, v254, v34
v_mul_f32 v35, v255, v35
Mvaa 192,148,128
CV 110,32,33
CV 111,34,35
Mvaa 200,148,132
s_waitcnt lgkmcnt(2)
Mvaa 196,152,128
Mvaa 204,152,132
s_waitcnt vmcnt(21) lgkmcnt(0)
s_barrier
Mvaa 208,156,128
ds_read_b128 a[144:147], v36
Mvaa 216,156,132
ds_read_b128 a[148:151], v36 offset:1024
Mvaa 212,160,128
ds_read_b128 a[152:155], v36 offset:2048
Mvaa 220,160,132
ds_read_b128 a[156:159], v36 offset:3072
Mvaa 192,164,136
ds_read_b128 a[160:163], v36 offset:4096
Mvaa 200,164,140
ds_read_b128 a[164:167], v36 offset:5120
Mvaa 196,168,136
s_nop 0
s_nop 2
v_fma_f32 v20, -v192, v192, s24
v_fma_f32 v21, -v193, v193, s24
Mvaa 204,168,140
ds_read_b128 a[168:171], v36 offset:6144
v_fma_f32 v22, -v194, v194, s24
v_fma_f32 v23, -v195, v195, s24
Mvaa 208,172,136
v_mul_f32 v20, v192, v20
v_mul_f32 v21, v193, v21
Mvaa 216,172,140
ds_read_b128 a[172:175], v36 offset:7168
v_mul_f32 v22, v194, v22
v_mul_f32 v23, v195, v23
Mvaa 212,176,136
v_exp_f32 v20, v20
v_fma_f32 v28, -v200, v200, s24
Mvaa 220,176,140
s_waitcnt lgkmcnt(3)
ds_read_b128 a[176:179], v36 offset:8192
v_fma_f32 v29, -v201, v201, s24
v_fma_f32 v30, -v202, v202, s24
v_mfma_f32_16x16x32_bf16 v[224:227], a[144:147], a[0:3], 0
v_exp_f32 v21, v21
v_mfma_f32_16x16x32_bf16 v[232:235], a[144:147], a[4:7], 0
ds_read_b128 a[144:147], v36 offset:9216
v_fma_f32 v31, -v203, v203, s24
v_mul_f32 v28, v200, v28
v_mfma_f32_16x16x32_bf16 v[228:231], a[148:151], a[0:3], 0
buffer_load_dwordx4 v7, s[40:43], s76 offen sc1 lds
v_mul_f32 v29, v201, v29
v_mul_f32 v30, v202, v30
v_mfma_f32_16x16x32_bf16 v[236:239], a[148:151], a[4:7], 0
ds_read_b128 a[148:151], v36 offset:10240
v_mul_f32 v31, v203, v31
v_fma_f32 v20, v20, s25, s25
v_mfma_f32_16x16x32_bf16 v[240:243], a[152:155], a[0:3], 0
v_exp_f32 v22, v22
v_mfma_f32_16x16x32_bf16 v[248:251], a[152:155], a[4:7], 0
ds_read_b128 a[152:155], v36 offset:11264
v_fma_f32 v21, v21, s25, s25
v_fma_f32 v22, v22, s25, s25
v_mfma_f32_16x16x32_bf16 v[244:247], a[156:159], a[0:3], 0
v_exp_f32 v23, v23
v_fma_f32 v24, -v196, v196, s24
v_mfma_f32_16x16x32_bf16 v[252:255], a[156:159], a[4:7], 0
ds_read_b128 a[156:159], v36 offset:12288
v_fma_f32 v23, v23, s25, s25
v_fma_f32 v25, -v197, v197, s24
Mvaa 224,160,8
buffer_load_dwordx4 v7, s[40:43], s76 offen offset:1024 sc1 lds
v_fma_f32 v26, -v198, v198, s24
Mvaa 232,160,12
s_waitcnt lgkmcnt(3)
ds_read_b128 a[160:163], v36 offset:13312
v_fma_f32 v27, -v199, v199, s24
v_mul_f32 v24, v196, v24
Mvaa 228,164,8
v_exp_f32 v28, v28
v_mul_f32 v25, v197, v25
Mvaa 236,164,12
ds_read_b128 a[164:167], v36 offset:14336
v_mul_f32 v26, v198, v26
v_mul_f32 v27, v199, v27
Mvaa 240,168,8
v_exp_f32 v29, v29
Mvaa 248,168,12
ds_read_b128 a[168:171], v36 offset:15360
v_fma_f32 v28, v28, s25, s25
v_fma_f32 v29, v29, s25, s25
Mvaa 244,172,8
buffer_load_dwordx4 v7, s[40:43], s76 offen offset:2048 sc1 lds
v_fma_f32 v32, -v204, v204, s24
v_fma_f32 v33, -v205, v205, s24
Mvaa 252,172,12
ds_read_b128 a[172:175], v36 offset:16384
v_fma_f32 v34, -v206, v206, s24
v_fma_f32 v35, -v207, v207, s24
Mvaa 224,176,16
v_exp_f32 v30, v30
Mvaa 232,176,20
ds_read_b128 a[176:179], v36 offset:17408
v_fma_f32 v30, v30, s25, s25
v_mul_f32 v32, v204, v32
Mvaa 228,144,16
v_exp_f32 v31, v31
v_mul_f32 v33, v205, v33
Mvaa 236,144,20
s_waitcnt lgkmcnt(3)
ds_read_b128 a[144:147], v36 offset:18432
v_fma_f32 v31, v31, s25, s25
v_mul_f32 v34, v206, v34
Mvaa 240,148,16
buffer_load_dwordx4 v7, s[40:43], s76 offen offset:3072 sc1 lds
v_mul_f32 v35, v207, v35
Mvaa 248,148,20
s_add_u32 m0, s67, 0xa000
s_add_u32 s76, s71, 0x76000
ds_read_b128 a[148:151], v36 offset:19456
Mvaa 244,152,16
v_rcp_f32 v20, v20
v_rcp_f32 v21, v21
Mvaa 252,152,20
ds_read_b128 a[152:155], v36 offset:20480
v_mul_f32 v20, v192, v20
v_mul_f32 v21, v193, v21
Mvaa 224,156,24
v_rcp_f32 v22, v22
Mvaa 232,156,28
ds_read_b128 a[156:159], v36 offset:21504
v_mul_f32 v22, v194, v22
CV 112,20,21
Mvaa 228,160,24
buffer_load_dwordx4 v7, s[40:43], s76 offen sc1 lds
v_fma_f32 v20, -v208, v208, s24
v_fma_f32 v21, -v209, v209, s24
Mvaa 236,160,28
s_waitcnt lgkmcnt(2)
ds_read_b128 a[160:163], v36 offset:22528
v_mul_f32 v20, v208, v20
v_mul_f32 v21, v209, v21
Mvaa 240,164,24
s_lshl_b32 s85, s30, 7
v_rcp_f32 v23, v23
Mvaa 248,164,28
s_add_u32 s85, s85, 0x4000
ds_read_b128 a[164:167], v36 offset:23552
v_mov_b32 v46, s85
v_mul_f32 v23, v195, v23
Mvaa 244,168,24
s_getpc_b64 s[96:97]
v_exp_f32 v24, v24
CV 113,22,23
Mvaa 252,168,28
global_load_dword a252, v46, s[96:97]
ds_read_b128 a[168:171], v36 offset:24576
Mvaa 224,172,32
v_exp_f32 v25, v25
v_fma_f32 v24, v24, s25, s25
Mvaa 232,172,36
buffer_load_dwordx4 v7, s[40:43], s76 offen offset:1024 sc1 lds
ds_read_b128 a[172:175], v36 offset:25600
Mvaa 228,176,32
v_exp_f32 v26, v26
v_exp_f32 v27, v27
Mvaa 236,176,36
ds_read_b128 a[176:179], v36 offset:26624
v_fma_f32 v25, v25, s25, s25
v_fma_f32 v26, v26, s25, s25
Mvaa 240,144,32
v_rcp_f32 v28, v28
Mvaa 248,144,36
ds_read_b128 a[144:147], v36 offset:27648
v_fma_f32 v27, v27, s25, s25
v_mul_f32 v28, v200, v28
Mvaa 244,148,32
buffer_load_dwordx4 v7, s[40:43], s76 offen offset:2048 sc1 lds
v_fma_f32 v22, -v210, v210, s24
v_fma_f32 v23, -v211, v211, s24
Mvaa 252,148,36
s_waitcnt lgkmcnt(3)
ds_read_b128 a[148:151], v36 offset:28672
v_mul_f32 v22, v210, v22
v_mul_f32 v23, v211, v23
Mvaa 224,152,40
v_rcp_f32 v29, v29
Mvaa 232,152,44
ds_read_b128 a[152:155], v36 offset:29696
v_mul_f32 v29, v201, v29
Mvaa 228,156,40
v_rcp_f32 v30, v30
v_rcp_f32 v31, v31
Mvaa 236,156,44
ds_read_b128 a[156:159], v36 offset:30720
v_mul_f32 v30, v202, v30
v_mul_f32 v31, v203, v31
Mvaa 240,160,40
buffer_load_dwordx4 v7, s[40:43], s76 offen offset:3072 sc1 lds
CV 116,28,29
Mvaa 248,160,44
s_add_u32 m0, s67, 0xb000
s_add_u32 s76, s71, 0x77000
ds_read_b128 a[160:163], v36 offset:31744
CV 117,30,31
Mvaa 244,164,40
v_exp_f32 v32, v32
v_fma_f32 v28, -v216, v216, s24
Mvaa 252,164,44
s_waitcnt lgkmcnt(2)
ds_read_b128 a[164:167], v36 offset:32768
v_fma_f32 v32, v32, s25, s25
v_fma_f32 v29, -v217, v217, s24
Mvaa 224,168,48
s_mul_i32 s77, s100, 0x480
v_min_u32 v46, 8, v1
v_fma_f32 v30, -v218, v218, s24
Mvaa 232,168,52
s_mul_i32 s85, s66, 0xa2000
ds_read_b128 a[168:171], v36 offset:33792
v_mul_u32_u24 v46, 0x80, v46
v_fma_f32 v31, -v219, v219, s24
Mvaa 228,172,48
buffer_load_dwordx4 v7, s[40:43], s76 offen sc1 lds
v_mul_f32 v28, v216, v28
v_mul_f32 v29, v217, v29
Mvaa 236,172,52
s_add_u32 m0, s67, 0x12000
ds_read_b128 a[172:175], v36 offset:34816
v_mul_f32 v30, v218, v30
v_mul_f32 v31, v219, v31
Mvaa 240,176,48
s_add_u32 s76, s71, 0x7e000
v_exp_f32 v33, v33
Mvaa 248,176,52
s_add_u32 s77, s77, s85
ds_read_b128 a[176:179], v36 offset:35840
v_add_u32 v36, 0x9000, v36
v_fma_f32 v33, v33, s25, s25
Mvaa 244,144,48
s_add_u32 s77, s77, 0x48000
v_exp_f32 v34, v34
Mvaa 252,144,52
buffer_load_dword a254, v46, s[56:59], s77 offen
v_fma_f32 v34, v34, s25, s25
v_exp_f32 v35, v35
Mvaa 224,148,56
v_rcp_f32 v24, v24
Mvaa 232,148,60
v_rcp_f32 v25, v25
v_fma_f32 v35, v35, s25, s25
Mvaa 228,152,56
v_rcp_f32 v26, v26
v_mul_f32 v24, v196, v24
Mvaa 236,152,60
s_waitcnt vmcnt(22) lgkmcnt(0)
s_barrier
v_rcp_f32 v27, v27
v_mul_f32 v25, v197, v25
Mvaa 240,156,56
ds_read_b128 a[144:147], v36
v_mul_f32 v26, v198, v26
Mvaa 248,156,60
ds_read_b128 a[148:151], v36 offset:1024
v_mul_f32 v27, v199, v27
CV 114,24,25
Mvaa 244,160,56
ds_read_b128 a[152:155], v36 offset:2048
CV 115,26,27
v_fma_f32 v24, -v212, v212, s24
Mvaa 252,160,60
ds_read_b128 a[156:159], v36 offset:3072
v_fma_f32 v25, -v213, v213, s24
v_fma_f32 v26, -v214, v214, s24
Mvaa 224,164,64
ds_read_b128 a[160:163], v36 offset:4096
v_fma_f32 v27, -v215, v215, s24
Mvaa 232,164,68
ds_read_b128 a[164:167], v36 offset:5120
v_mul_f32 v24, v212, v24
v_mul_f32 v25, v213, v25
Mvaa 228,168,64
v_exp_f32 v20, v20
v_mul_f32 v26, v214, v26
Mvaa 236,168,68
ds_read_b128 a[168:171], v36 offset:6144
v_fma_f32 v20, v20, s25, s25
v_mul_f32 v27, v215, v27
Mvaa 240,172,64
v_exp_f32 v21, v21
Mvaa 248,172,68
ds_read_b128 a[172:175], v36 offset:7168
v_fma_f32 v21, v21, s25, s25
Mvaa 244,176,64
v_exp_f32 v22, v22
v_exp_f32 v23, v23
Mvaa 252,176,68
s_waitcnt lgkmcnt(4)
ds_read_b128 a[176:179], v36 offset:8192
v_fma_f32 v22, v22, s25, s25
v_fma_f32 v23, v23, s25, s25
Mvaa 224,144,72
v_rcp_f32 v32, v32
Mvaa 232,144,76
ds_read_b128 a[144:147], v36 offset:9216
v_mul_f32 v32, v204, v32
Mvaa 228,148,72
buffer_load_dwordx4 v7, s[40:43], s76 offen sc1 lds
v_rcp_f32 v33, v33
Mvaa 236,148,76
ds_read_b128 a[148:151], v36 offset:10240
v_mul_f32 v33, v205, v33
v_rcp_f32 v34, v34
Mvaa 240,152,72
v_rcp_f32 v35, v35
Mvaa 248,152,76
ds_read_b128 a[152:155], v36 offset:11264
v_mul_f32 v34, v206, v34
v_mul_f32 v35, v207, v35
Mvaa 244,156,72
v_exp_f32 v28, v28
CV 118,32,33
Mvaa 252,156,76
s_waitcnt lgkmcnt(3)
ds_read_b128 a[156:159], v36 offset:12288
v_fma_f32 v28, v28, s25, s25
CV 119,34,35
Mvaa 224,160,80
buffer_load_dwordx4 v7, s[40:43], s76 offen offset:1024 sc1 lds
v_fma_f32 v32, -v220, v220, s24
Mvaa 232,160,84
ds_read_b128 a[160:163], v36 offset:13312
L_pg3_13:
s_cbranch_execz L_ret3
v_fma_f32 v33, -v221, v221, s24
v_fma_f32 v34, -v222, v222, s24
Mvaa 228,164,80
v_exp_f32 v29, v29
v_fma_f32 v35, -v223, v223, s24
Mvaa 236,164,84
ds_read_b128 a[164:167], v36 offset:14336
v_fma_f32 v29, v29, s25, s25
v_mul_f32 v32, v220, v32
Mvaa 240,168,80
v_exp_f32 v30, v30
Mvaa 248,168,84
ds_read_b128 a[168:171], v36 offset:15360
v_fma_f32 v30, v30, s25, s25
v_mul_f32 v33, v221, v33
Mvaa 244,172,80
buffer_load_dwordx4 v7, s[40:43], s76 offen offset:2048 sc1 lds
v_mul_f32 v34, v222, v34
v_mul_f32 v35, v223, v35
Mvaa 252,172,84
ds_read_b128 a[172:175], v36 offset:16384
v_exp_f32 v31, v31
Mvaa 224,176,88
v_rcp_f32 v20, v20
Mvaa 232,176,92
s_waitcnt lgkmcnt(3)
ds_read_b128 a[176:179], v36 offset:17408
v_fma_f32 v31, v31, s25, s25
v_mul_f32 v20, v208, v20
Mvaa 228,144,88
v_rcp_f32 v21, v21
Mvaa 236,144,92
ds_read_b128 a[144:147], v36 offset:18432
v_mul_f32 v21, v209, v21
v_rcp_f32 v22, v22
Mvaa 240,148,88
buffer_load_dwordx4 v7, s[40:43], s76 offen offset:3072 sc1 lds
v_mul_f32 v22, v210, v22
Mvaa 248,148,92
s_add_u32 m0, s67, 0x13000
s_add_u32 s76, s71, 0x7f000
ds_read_b128 a[148:151], v36 offset:19456
CV 120,20,21
Mvaa 244,152,88
v_rcp_f32 v23, v23
Mvaa 252,152,92
ds_read_b128 a[152:155], v36 offset:20480
v_mul_f32 v23, v211, v23
v_exp_f32 v24, v24
Mvaa 224,156,96
v_exp_f32 v25, v25
Mvaa 232,156,100
ds_read_b128 a[156:159], v36 offset:21504
v_fma_f32 v24, v24, s25, s25
v_fma_f32 v25, v25, s25, s25
Mvaa 228,160,96
buffer_load_dwordx4 v7, s[40:43], s76 offen sc1 lds
v_exp_f32 v26, v26
Mvaa 236,160,100
s_waitcnt lgkmcnt(3)
ds_read_b128 a[160:163], v36 offset:22528
v_fma_f32 v26, v26, s25, s25
CV 121,22,23
Mvaa 240,164,96
v_exp_f32 v27, v27
Mvaa 248,164,100
ds_read_b128 a[164:167], v36 offset:23552
v_fma_f32 v27, v27, s25, s25
Mvaa 244,168,96
v_rcp_f32 v28, v28
v_rcp_f32 v29, v29
Mvaa 252,168,100
ds_read_b128 a[168:171], v36 offset:24576
v_mul_f32 v28, v216, v28
v_mul_f32 v29, v217, v29
Mvaa 224,172,104
buffer_load_dwordx4 v7, s[40:43], s76 offen offset:1024 sc1 lds
CV 124,28,29
Mvaa 232,172,108
ds_read_b128 a[172:175], v36 offset:25600
v_rcp_f32 v30, v30
Mvaa 228,176,104
v_rcp_f32 v31, v31
v_mul_f32 v30, v218, v30
Mvaa 236,176,108
ds_read_b128 a[176:179], v36 offset:26624
v_mul_f32 v31, v219, v31
Mvaa 240,144,104
v_exp_f32 v32, v32
CV 125,30,31
Mvaa 248,144,108
s_waitcnt lgkmcnt(3)
ds_read_b128 a[144:147], v36 offset:27648
v_fma_f32 v32, v32, s25, s25
Mvaa 244,148,104
buffer_load_dwordx4 v7, s[40:43], s76 offen offset:2048 sc1 lds
v_exp_f32 v33, v33
Mvaa 252,148,108
ds_read_b128 a[148:151], v36 offset:28672
v_fma_f32 v33, v33, s25, s25
v_exp_f32 v34, v34
Mvaa 224,152,112
v_exp_f32 v35, v35
Mvaa 232,152,116
ds_read_b128 a[152:155], v36 offset:29696
v_fma_f32 v34, v34, s25, s25
v_fma_f32 v35, v35, s25, s25
Mvaa 228,156,112
v_rcp_f32 v24, v24
Mvaa 236,156,116
ds_read_b128 a[156:159], v36 offset:30720
v_mul_f32 v24, v212, v24
v_rcp_f32 v25, v25
Mvaa 240,160,112
buffer_load_dwordx4 v7, s[40:43], s76 offen offset:3072 sc1 lds
v_mul_f32 v25, v213, v25
Mvaa 248,160,116
s_add_u32 m0, s67, 0x14000
s_add_u32 s76, s71, 0x80000
ds_read_b128 a[160:163], v36 offset:31744
CV 122,24,25
Mvaa 244,164,112
v_rcp_f32 v26, v26
Mvaa 252,164,116
s_waitcnt lgkmcnt(3)
ds_read_b128 a[164:167], v36 offset:32768
v_mul_f32 v26, v214, v26
v_rcp_f32 v27, v27
Mvaa 224,168,120
s_mul_i32 s77, s100, 0x480
v_min_u32 v46, 8, v1
v_mul_f32 v27, v215, v27
Mvaa 232,168,124
s_mul_i32 s85, s66, 0xa2000
ds_read_b128 a[168:171], v36 offset:33792
v_mul_u32_u24 v46, 0x80, v46
CV 123,26,27
Mvaa 228,172,120
buffer_load_dwordx4 v7, s[40:43], s76 offen sc1 lds
v_rcp_f32 v32, v32
Mvaa 236,172,124
s_add_u32 m0, s67, 0x1b000
ds_read_b128 a[172:175], v36 offset:34816
v_mul_f32 v32, v220, v32
Mvaa 240,176,120
s_add_u32 s76, s71, 0x87000
v_rcp_f32 v33, v33
Mvaa 248,176,124
s_add_u32 s77, s77, s85
ds_read_b128 a[176:179], v36 offset:35840
v_add_u32 v36, 0xfffe5000, v36
v_rcp_f32 v34, v34
Mvaa 244,144,120
s_add_u32 s77, s77, 0x5a000
v_rcp_f32 v35, v35
v_mul_f32 v33, v221, v33
Mvaa 252,144,124
buffer_load_dword a254, v46, s[56:59], s77 offen
v_mul_f32 v34, v222, v34
v_mul_f32 v35, v223, v35
Mvaa 224,148,128
CV 126,32,33
CV 127,34,35
Mvaa 232,148,132
s_waitcnt lgkmcnt(2)
Mvaa 228,152,128
Mvaa 236,152,132
s_waitcnt vmcnt(22) lgkmcnt(0)
s_barrier
Mvaa 240,156,128
ds_read_b128 a[144:147], v36
Mvaa 248,156,132
ds_read_b128 a[148:151], v36 offset:1024
Mvaa 244,160,128
ds_read_b128 a[152:155], v36 offset:2048
Mvaa 252,160,132
ds_read_b128 a[156:159], v36 offset:3072
Mvaa 224,164,136
ds_read_b128 a[160:163], v36 offset:4096
Mvaa 232,164,140
ds_read_b128 a[164:167], v36 offset:5120
Mvaa 228,168,136
s_nop 0
s_nop 2
v_fma_f32 v20, -v224, v224, s24
v_fma_f32 v21, -v225, v225, s24
Mvaa 236,168,140
ds_read_b128 a[168:171], v36 offset:6144
v_fma_f32 v22, -v226, v226, s24
v_fma_f32 v23, -v227, v227, s24
Mvaa 240,172,136
v_mul_f32 v20, v224, v20
v_mul_f32 v21, v225, v21
Mvaa 248,172,140
ds_read_b128 a[172:175], v36 offset:7168
v_mul_f32 v22, v226, v22
v_mul_f32 v23, v227, v23
Mvaa 244,176,136
v_exp_f32 v20, v20
v_fma_f32 v28, -v232, v232, s24
Mvaa 252,176,140
s_waitcnt lgkmcnt(3)
ds_read_b128 a[176:179], v36 offset:8192
v_fma_f32 v29, -v233, v233, s24
v_fma_f32 v30, -v234, v234, s24
v_mfma_f32_16x16x32_bf16 v[192:195], a[144:147], a[0:3], 0
v_exp_f32 v21, v21
v_mfma_f32_16x16x32_bf16 v[200:203], a[144:147], a[4:7], 0
ds_read_b128 a[144:147], v36 offset:9216
v_fma_f32 v31, -v235, v235, s24
v_mul_f32 v28, v232, v28
v_mfma_f32_16x16x32_bf16 v[196:199], a[148:151], a[0:3], 0
buffer_load_dwordx4 v7, s[40:43], s76 offen sc1 lds
v_mul_f32 v29, v233, v29
v_mul_f32 v30, v234, v30
v_mfma_f32_16x16x32_bf16 v[204:207], a[148:151], a[4:7], 0
ds_read_b128 a[148:151], v36 offset:10240
v_mul_f32 v31, v235, v31
v_fma_f32 v20, v20, s25, s25
v_mfma_f32_16x16x32_bf16 v[208:211], a[152:155], a[0:3], 0
v_exp_f32 v22, v22
v_mfma_f32_16x16x32_bf16 v[216:219], a[152:155], a[4:7], 0
ds_read_b128 a[152:155], v36 offset:11264
v_fma_f32 v21, v21, s25, s25
v_fma_f32 v22, v22, s25, s25
v_mfma_f32_16x16x32_bf16 v[212:215], a[156:159], a[0:3], 0
v_exp_f32 v23, v23
v_fma_f32 v24, -v228, v228, s24
v_mfma_f32_16x16x32_bf16 v[220:223], a[156:159], a[4:7], 0
ds_read_b128 a[156:159], v36 offset:12288
v_fma_f32 v23, v23, s25, s25
v_fma_f32 v25, -v229, v229, s24
Mvaa 192,160,8
buffer_load_dwordx4 v7, s[40:43], s76 offen offset:1024 sc1 lds
v_fma_f32 v26, -v230, v230, s24
Mvaa 200,160,12
s_waitcnt lgkmcnt(3)
ds_read_b128 a[160:163], v36 offset:13312
v_fma_f32 v27, -v231, v231, s24
v_mul_f32 v24, v228, v24
Mvaa 196,164,8
v_exp_f32 v28, v28
v_mul_f32 v25, v229, v25
Mvaa 204,164,12
ds_read_b128 a[164:167], v36 offset:14336
v_mul_f32 v26, v230, v26
v_mul_f32 v27, v231, v27
Mvaa 208,168,8
v_exp_f32 v29, v29
Mvaa 216,168,12
ds_read_b128 a[168:171], v36 offset:15360
v_fma_f32 v28, v28, s25, s25
v_fma_f32 v29, v29, s25, s25
Mvaa 212,172,8
buffer_load_dwordx4 v7, s[40:43], s76 offen offset:2048 sc1 lds
v_fma_f32 v32, -v236, v236, s24
v_fma_f32 v33, -v237, v237, s24
Mvaa 220,172,12
ds_read_b128 a[172:175], v36 offset:16384
v_fma_f32 v34, -v238, v238, s24
v_fma_f32 v35, -v239, v239, s24
Mvaa 192,176,16
v_exp_f32 v30, v30
Mvaa 200,176,20
ds_read_b128 a[176:179], v36 offset:17408
v_fma_f32 v30, v30, s25, s25
v_mul_f32 v32, v236, v32
Mvaa 196,144,16
v_exp_f32 v31, v31
v_mul_f32 v33, v237, v33
Mvaa 204,144,20
s_waitcnt lgkmcnt(3)
ds_read_b128 a[144:147], v36 offset:18432
v_fma_f32 v31, v31, s25, s25
v_mul_f32 v34, v238, v34
Mvaa 208,148,16
buffer_load_dwordx4 v7, s[40:43], s76 offen offset:3072 sc1 lds
v_mul_f32 v35, v239, v35
Mvaa 216,148,20
s_add_u32 m0, s67, 0x1c000
s_add_u32 s76, s71, 0x88000
ds_read_b128 a[148:151], v36 offset:19456
Mvaa 212,152,16
v_rcp_f32 v20, v20
v_rcp_f32 v21, v21
Mvaa 220,152,20
ds_read_b128 a[152:155], v36 offset:20480
v_mul_f32 v20, v224, v20
v_mul_f32 v21, v225, v21
Mvaa 192,156,24
v_rcp_f32 v22, v22
Mvaa 200,156,28
ds_read_b128 a[156:159], v36 offset:21504
v_mul_f32 v22, v226, v22
CV 128,20,21
Mvaa 196,160,24
buffer_load_dwordx4 v7, s[40:43], s76 offen sc1 lds
v_fma_f32 v20, -v240, v240, s24
v_fma_f32 v21, -v241, v241, s24
Mvaa 204,160,28
ds_read_b128 a[160:163], v36 offset:22528
v_mul_f32 v20, v240, v20
v_mul_f32 v21, v241, v21
Mvaa 208,164,24
v_rcp_f32 v23, v23
Mvaa 216,164,28
s_waitcnt lgkmcnt(3)
ds_read_b128 a[164:167], v36 offset:23552
v_mul_f32 v23, v227, v23
Mvaa 212,168,24
v_exp_f32 v24, v24
v_exp_f32 v25, v25
Mvaa 220,168,28
ds_read_b128 a[168:171], v36 offset:24576
v_fma_f32 v24, v24, s25, s25
v_fma_f32 v25, v25, s25, s25
Mvaa 192,172,32
buffer_load_dwordx4 v7, s[40:43], s76 offen offset:1024 sc1 lds
CV 129,22,23
Mvaa 200,172,36
ds_read_b128 a[172:175], v36 offset:25600
v_fma_f32 v22, -v242, v242, s24
v_fma_f32 v23, -v243, v243, s24
Mvaa 196,176,32
v_exp_f32 v26, v26
v_mul_f32 v22, v242, v22
Mvaa 204,176,36
ds_read_b128 a[176:179], v36 offset:26624
v_fma_f32 v26, v26, s25, s25
v_mul_f32 v23, v243, v23
Mvaa 208,144,32
v_exp_f32 v27, v27
Mvaa 216,144,36
ds_read_b128 a[144:147], v36 offset:27648
v_fma_f32 v27, v27, s25, s25
Mvaa 212,148,32
buffer_load_dwordx4 v7, s[40:43], s76 offen offset:2048 sc1 lds
v_rcp_f32 v28, v28
Mvaa 220,148,36
s_waitcnt lgkmcnt(3)
ds_read_b128 a[148:151], v36 offset:28672
v_mul_f32 v28, v232, v28
v_rcp_f32 v29, v29
Mvaa 192,152,40
v_rcp_f32 v30, v30
Mvaa 200,152,44
ds_read_b128 a[152:155], v36 offset:29696
v_mul_f32 v29, v233, v29
v_mul_f32 v30, v234, v30
Mvaa 196,156,40
v_rcp_f32 v31, v31
CV 132,28,29
Mvaa 204,156,44
ds_read_b128 a[156:159], v36 offset:30720
v_mul_f32 v31, v235, v31
v_fma_f32 v28, -v248, v248, s24
Mvaa 208,160,40
buffer_load_dwordx4 v7, s[40:43], s76 offen offset:3072 sc1 lds
CV 133,30,31
Mvaa 216,160,44
s_add_u32 m0, s67, 0x1d000
s_add_u32 s76, s71, 0x89000
ds_read_b128 a[160:163], v36 offset:31744
v_fma_f32 v29, -v249, v249, s24
Mvaa 212,164,40
v_exp_f32 v32, v32
v_fma_f32 v30, -v250, v250, s24
Mvaa 220,164,44
s_waitcnt lgkmcnt(2)
ds_read_b128 a[164:167], v36 offset:32768
v_fma_f32 v32, v32, s25, s25
v_fma_f32 v31, -v251, v251, s24
Mvaa 192,168,48
s_mul_i32 s77, s100, 0x480
v_min_u32 v46, 8, v1
v_mul_f32 v28, v248, v28
Mvaa 200,168,52
s_mul_i32 s85, s66, 0xa2000
ds_read_b128 a[168:171], v36 offset:33792
v_mul_u32_u24 v46, 0x80, v46
v_mul_f32 v29, v249, v29
Mvaa 196,172,48
buffer_load_dwordx4 v7, s[40:43], s76 offen sc1 lds
v_mul_f32 v30, v250, v30
v_mul_f32 v31, v251, v31
Mvaa 204,172,52
s_add_u32 m0, s67, 0
ds_read_b128 a[172:175], v36 offset:34816
v_exp_f32 v33, v33
Mvaa 208,176,48
s_add_u32 s76, s71, 0x90000
v_exp_f32 v34, v34
Mvaa 216,176,52
s_add_u32 s77, s77, s85
ds_read_b128 a[176:179], v36 offset:35840
v_add_u32 v36, 0x9000, v36
v_fma_f32 v33, v33, s25, s25
Mvaa 212,144,48
s_add_u32 s77, s77, 0x6c000
v_exp_f32 v35, v35
v_fma_f32 v34, v34, s25, s25
Mvaa 220,144,52
buffer_load_dword a254, v46, s[56:59], s77 offen
v_fma_f32 v35, v35, s25, s25
Mvaa 192,148,56
v_rcp_f32 v24, v24
Mvaa 200,148,60
v_rcp_f32 v25, v25
v_rcp_f32 v26, v26
Mvaa 196,152,56
v_rcp_f32 v27, v27
v_mul_f32 v24, v228, v24
Mvaa 204,152,60
s_waitcnt vmcnt(21) lgkmcnt(0)
s_barrier
v_exp_f32 v20, v20
v_mul_f32 v25, v229, v25
Mvaa 208,156,56
ds_read_b128 a[144:147], v36
v_mul_f32 v26, v230, v26
Mvaa 216,156,60
ds_read_b128 a[148:151], v36 offset:1024
v_mul_f32 v27, v231, v27
v_fma_f32 v20, v20, s25, s25
Mvaa 212,160,56
ds_read_b128 a[152:155], v36 offset:2048
CV 130,24,25
CV 131,26,27
Mvaa 220,160,60
ds_read_b128 a[156:159], v36 offset:3072
v_fma_f32 v24, -v244, v244, s24
v_fma_f32 v25, -v245, v245, s24
Mvaa 192,164,64
ds_read_b128 a[160:163], v36 offset:4096
v_fma_f32 v26, -v246, v246, s24
Mvaa 200,164,68
ds_read_b128 a[164:167], v36 offset:5120
v_fma_f32 v27, -v247, v247, s24
v_mul_f32 v24, v244, v24
Mvaa 196,168,64
v_exp_f32 v21, v21
v_mul_f32 v25, v245, v25
Mvaa 204,168,68
ds_read_b128 a[168:171], v36 offset:6144
v_fma_f32 v21, v21, s25, s25
v_mul_f32 v26, v246, v26
Mvaa 208,172,64
v_exp_f32 v22, v22
Mvaa 216,172,68
ds_read_b128 a[172:175], v36 offset:7168
v_fma_f32 v22, v22, s25, s25
v_mul_f32 v27, v247, v27
Mvaa 212,176,64
v_exp_f32 v23, v23
Mvaa 220,176,68
s_waitcnt lgkmcnt(4)
ds_read_b128 a[176:179], v36 offset:8192
v_fma_f32 v23, v23, s25, s25
v_rcp_f32 v32, v32
Mvaa 192,144,72
v_rcp_f32 v33, v33
Mvaa 200,144,76
ds_read_b128 a[144:147], v36 offset:9216
v_mul_f32 v32, v236, v32
v_mul_f32 v33, v237, v33
Mvaa 196,148,72
buffer_load_dwordx4 v7, s[40:43], s76 offen sc1 lds
CV 134,32,33
v_fma_f32 v32, -v252, v252, s24
Mvaa 204,148,76
ds_read_b128 a[148:151], v36 offset:10240
v_fma_f32 v33, -v253, v253, s24
v_mul_f32 v32, v252, v32
Mvaa 208,152,72
v_rcp_f32 v34, v34
Mvaa 216,152,76
ds_read_b128 a[152:155], v36 offset:11264
v_mul_f32 v34, v238, v34
v_mul_f32 v33, v253, v33
Mvaa 212,156,72
v_rcp_f32 v35, v35
Mvaa 220,156,76
s_waitcnt lgkmcnt(3)
ds_read_b128 a[156:159], v36 offset:12288
v_mul_f32 v35, v239, v35
v_exp_f32 v28, v28
Mvaa 192,160,80
buffer_load_dwordx4 v7, s[40:43], s76 offen offset:1024 sc1 lds
v_fma_f32 v28, v28, s25, s25
Mvaa 200,160,84
ds_read_b128 a[160:163], v36 offset:13312
CV 135,34,35
v_fma_f32 v34, -v254, v254, s24
Mvaa 196,164,80
v_exp_f32 v29, v29
v_fma_f32 v35, -v255, v255, s24
Mvaa 204,164,84
ds_read_b128 a[164:167], v36 offset:14336
v_fma_f32 v29, v29, s25, s25
v_mul_f32 v34, v254, v34
Mvaa 208,168,80
v_exp_f32 v30, v30
Mvaa 216,168,84
ds_read_b128 a[168:171], v36 offset:15360
v_fma_f32 v30, v30, s25, s25
v_mul_f32 v35, v255, v35
Mvaa 212,172,80
buffer_load_dwordx4 v7, s[40:43], s76 offen offset:2048 sc1 lds
v_exp_f32 v31, v31
Mvaa 220,172,84
ds_read_b128 a[172:175], v36 offset:16384
v_fma_f32 v31, v31, s25, s25
Mvaa 192,176,88
v_rcp_f32 v20, v20
Mvaa 200,176,92
s_waitcnt lgkmcnt(3)
ds_read_b128 a[176:179], v36 offset:17408
v_mul_f32 v20, v240, v20
v_rcp_f32 v21, v21
Mvaa 196,144,88
v_rcp_f32 v22, v22
v_mul_f32 v21, v241, v21
Mvaa 204,144,92
ds_read_b128 a[144:147], v36 offset:18432
v_mul_f32 v22, v242, v22
CV 136,20,21
Mvaa 208,148,88
buffer_load_dwordx4 v7, s[40:43], s76 offen offset:3072 sc1 lds
Mvaa 216,148,92
s_add_u32 m0, s67, 0x1000
s_add_u32 s76, s71, 0x91000
ds_read_b128 a[148:151], v36 offset:19456
Mvaa 212,152,88
v_rcp_f32 v23, v23
v_exp_f32 v24, v24
Mvaa 220,152,92
ds_read_b128 a[152:155], v36 offset:20480
v_mul_f32 v23, v243, v23
v_fma_f32 v24, v24, s25, s25
Mvaa 192,156,96
v_exp_f32 v25, v25
Mvaa 200,156,100
ds_read_b128 a[156:159], v36 offset:21504
v_fma_f32 v25, v25, s25, s25
CV 137,22,23
Mvaa 196,160,96
buffer_load_dwordx4 v7, s[40:43], s76 offen sc1 lds
v_exp_f32 v26, v26
Mvaa 204,160,100
s_waitcnt lgkmcnt(3)
ds_read_b128 a[160:163], v36 offset:22528
v_fma_f32 v26, v26, s25, s25
Mvaa 208,164,96
s_lshl_b32 s85, s30, 7
v_exp_f32 v27, v27
Mvaa 216,164,100
s_add_u32 s85, s85, 0x4000
ds_read_b128 a[164:167], v36 offset:23552
v_mov_b32 v46, s85
v_rcp_f32 v28, v28
Mvaa 212,168,96
s_getpc_b64 s[96:97]
v_rcp_f32 v29, v29
v_fma_f32 v27, v27, s25, s25
Mvaa 220,168,100
global_load_dword a252, v46, s[96:97]
ds_read_b128 a[168:171], v36 offset:24576
Mvaa 192,172,104
v_rcp_f32 v30, v30
v_mul_f32 v28, v248, v28
Mvaa 200,172,108
buffer_load_dwordx4 v7, s[40:43], s76 offen offset:1024 sc1 lds
ds_read_b128 a[172:175], v36 offset:25600
Mvaa 196,176,104
v_rcp_f32 v31, v31
v_mul_f32 v29, v249, v29
v_mul_f32 v30, v250, v30
Mvaa 204,176,108
ds_read_b128 a[176:179], v36 offset:26624
v_mul_f32 v31, v251, v31
CV 140,28,29
Mvaa 208,144,104
v_exp_f32 v32, v32
Mvaa 216,144,108
s_waitcnt lgkmcnt(3)
ds_read_b128 a[144:147], v36 offset:27648
v_fma_f32 v32, v32, s25, s25
CV 141,30,31
Mvaa 212,148,104
buffer_load_dwordx4 v7, s[40:43], s76 offen offset:2048 sc1 lds
v_exp_f32 v33, v33
Mvaa 220,148,108
ds_read_b128 a[148:151], v36 offset:28672
v_fma_f32 v33, v33, s25, s25
Mvaa 192,152,112
v_exp_f32 v34, v34
Mvaa 200,152,116
ds_read_b128 a[152:155], v36 offset:29696
v_fma_f32 v34, v34, s25, s25
v_exp_f32 v35, v35
Mvaa 196,156,112
v_rcp_f32 v24, v24
v_fma_f32 v35, v35, s25, s25
Mvaa 204,156,116
ds_read_b128 a[156:159], v36 offset:30720
v_mul_f32 v24, v244, v24
Mvaa 208,160,112
L_pg3_14:
s_cbranch_execz L_ret3
buffer_load_dwordx4 v7, s[40:43], s76 offen offset:3072 sc1 lds
v_rcp_f32 v25, v25
Mvaa 216,160,116
s_add_u32 m0, s67, 0x2000
s_add_u32 s76, s71, 0x92000
ds_read_b128 a[160:163], v36 offset:31744
v_mul_f32 v25, v245, v25
Mvaa 212,164,112
v_rcp_f32 v26, v26
CV 138,24,25
Mvaa 220,164,116
s_waitcnt lgkmcnt(3)
ds_read_b128 a[164:167], v36 offset:32768
v_mul_f32 v26, v246, v26
Mvaa 192,168,120
s_mul_i32 s77, s100, 0x480
v_min_u32 v46, 8, v1
v_rcp_f32 v27, v27
Mvaa 200,168,124
s_mul_i32 s85, s66, 0xa2000
ds_read_b128 a[168:171], v36 offset:33792
v_mul_u32_u24 v46, 0x80, v46
v_mul_f32 v27, v247, v27
Mvaa 196,172,120
buffer_load_dwordx4 v7, s[40:43], s76 offen sc1 lds
v_rcp_f32 v32, v32
Mvaa 204,172,124
s_add_u32 m0, s67, 0x9000
ds_read_b128 a[172:175], v36 offset:34816
v_mul_f32 v32, v252, v32
CV 139,26,27
Mvaa 208,176,120
s_add_u32 s76, s71, 0x99000
v_rcp_f32 v33, v33
Mvaa 216,176,124
s_add_u32 s77, s77, s85
ds_read_b128 a[176:179], v36 offset:35840
v_add_u32 v36, 0x9000, v36
v_mul_f32 v33, v253, v33
Mvaa 212,144,120
s_add_u32 s77, s77, 0x7e000
v_rcp_f32 v34, v34
CV 142,32,33
Mvaa 220,144,124
buffer_load_dword a254, v46, s[56:59], s77 offen
v_mul_f32 v34, v254, v34
Mvaa 192,148,128
v_rcp_f32 v35, v35
Mvaa 200,148,132
s_waitcnt lgkmcnt(2)
v_mul_f32 v35, v255, v35
Mvaa 196,152,128
CV 143,34,35
Mvaa 204,152,132
s_waitcnt vmcnt(22) lgkmcnt(0)
s_barrier
Mvaa 208,156,128
ds_read_b128 a[144:147], v36
Mvaa 216,156,132
ds_read_b128 a[148:151], v36 offset:1024
Mvaa 212,160,128
ds_read_b128 a[152:155], v36 offset:2048
Mvaa 220,160,132
ds_read_b128 a[156:159], v36 offset:3072
Mvaa 192,164,136
ds_read_b128 a[160:163], v36 offset:4096
Mvaa 200,164,140
ds_read_b128 a[164:167], v36 offset:5120
Mvaa 196,168,136
s_nop 0
s_nop 2
v_fma_f32 v20, -v192, v192, s24
v_fma_f32 v21, -v193, v193, s24
Mvaa 204,168,140
ds_read_b128 a[168:171], v36 offset:6144
v_fma_f32 v22, -v194, v194, s24
v_fma_f32 v23, -v195, v195, s24
Mvaa 208,172,136
v_mul_f32 v20, v192, v20
v_mul_f32 v21, v193, v21
Mvaa 216,172,140
ds_read_b128 a[172:175], v36 offset:7168
v_mul_f32 v22, v194, v22
v_mul_f32 v23, v195, v23
Mvaa 212,176,136
v_exp_f32 v20, v20
v_fma_f32 v28, -v200, v200, s24
Mvaa 220,176,140
s_waitcnt lgkmcnt(3)
ds_read_b128 a[176:179], v36 offset:8192
v_fma_f32 v29, -v201, v201, s24
v_fma_f32 v30, -v202, v202, s24
v_mfma_f32_16x16x32_bf16 v[224:227], a[144:147], a[0:3], 0
v_exp_f32 v21, v21
v_mfma_f32_16x16x32_bf16 v[232:235], a[144:147], a[4:7], 0
ds_read_b128 a[144:147], v36 offset:9216
v_fma_f32 v31, -v203, v203, s24
v_mul_f32 v28, v200, v28
v_mfma_f32_16x16x32_bf16 v[228:231], a[148:151], a[0:3], 0
buffer_load_dwordx4 v7, s[40:43], s76 offen sc1 lds
v_mul_f32 v29, v201, v29
v_mul_f32 v30, v202, v30
v_mfma_f32_16x16x32_bf16 v[236:239], a[148:151], a[4:7], 0
ds_read_b128 a[148:151], v36 offset:10240
v_mul_f32 v31, v203, v31
v_fma_f32 v20, v20, s25, s25
v_mfma_f32_16x16x32_bf16 v[240:243], a[152:155], a[0:3], 0
v_exp_f32 v22, v22
v_mfma_f32_16x16x32_bf16 v[248:251], a[152:155], a[4:7], 0
ds_read_b128 a[152:155], v36 offset:11264
v_fma_f32 v21, v21, s25, s25
v_fma_f32 v22, v22, s25, s25
v_mfma_f32_16x16x32_bf16 v[244:247], a[156:159], a[0:3], 0
v_exp_f32 v23, v23
v_fma_f32 v24, -v196, v196, s24
v_mfma_f32_16x16x32_bf16 v[252:255], a[156:159], a[4:7], 0
ds_read_b128 a[156:159], v36 offset:12288
v_fma_f32 v23, v23, s25, s25
v_fma_f32 v25, -v197, v197, s24
Mvaa 224,160,8
buffer_load_dwordx4 v7, s[40:43], s76 offen offset:1024 sc1 lds
v_fma_f32 v26, -v198, v198, s24
Mvaa 232,160,12
s_waitcnt lgkmcnt(3)
ds_read_b128 a[160:163], v36 offset:13312
v_fma_f32 v27, -v199, v199, s24
v_mul_f32 v24, v196, v24
Mvaa 228,164,8
v_exp_f32 v28, v28
v_mul_f32 v25, v197, v25
Mvaa 236,164,12
ds_read_b128 a[164:167], v36 offset:14336
v_mul_f32 v26, v198, v26
v_mul_f32 v27, v199, v27
Mvaa 240,168,8
v_exp_f32 v29, v29
Mvaa 248,168,12
ds_read_b128 a[168:171], v36 offset:15360
v_fma_f32 v28, v28, s25, s25
v_fma_f32 v29, v29, s25, s25
Mvaa 244,172,8
buffer_load_dwordx4 v7, s[40:43], s76 offen offset:2048 sc1 lds
v_fma_f32 v32, -v204, v204, s24
v_fma_f32 v33, -v205, v205, s24
Mvaa 252,172,12
ds_read_b128 a[172:175], v36 offset:16384
v_fma_f32 v34, -v206, v206, s24
v_fma_f32 v35, -v207, v207, s24
Mvaa 224,176,16
v_exp_f32 v30, v30
Mvaa 232,176,20
ds_read_b128 a[176:179], v36 offset:17408
v_fma_f32 v30, v30, s25, s25
v_mul_f32 v32, v204, v32
Mvaa 228,144,16
v_exp_f32 v31, v31
v_mul_f32 v33, v205, v33
Mvaa 236,144,20
s_waitcnt lgkmcnt(3)
ds_read_b128 a[144:147], v36 offset:18432
v_fma_f32 v31, v31, s25, s25
v_mul_f32 v34, v206, v34
Mvaa 240,148,16
buffer_load_dwordx4 v7, s[40:43], s76 offen offset:3072 sc1 lds
v_mul_f32 v35, v207, v35
Mvaa 248,148,20
s_add_u32 m0, s67, 0xa000
s_add_u32 s76, s71, 0x9a000
ds_read_b128 a[148:151], v36 offset:19456
Mvaa 244,152,16
v_rcp_f32 v20, v20
v_rcp_f32 v21, v21
Mvaa 252,152,20
ds_read_b128 a[152:155], v36 offset:20480
v_mul_f32 v20, v192, v20
v_mul_f32 v21, v193, v21
Mvaa 224,156,24
v_rcp_f32 v22, v22
Mvaa 232,156,28
ds_read_b128 a[156:159], v36 offset:21504
v_mul_f32 v22, v194, v22
CV 144,20,21
Mvaa 228,160,24
buffer_load_dwordx4 v7, s[40:43], s76 offen sc1 lds
v_fma_f32 v20, -v208, v208, s24
v_fma_f32 v21, -v209, v209, s24
Mvaa 236,160,28
ds_read_b128 a[160:163], v36 offset:22528
v_mul_f32 v20, v208, v20
v_mul_f32 v21, v209, v21
Mvaa 240,164,24
v_rcp_f32 v23, v23
Mvaa 248,164,28
s_waitcnt lgkmcnt(3)
ds_read_b128 a[164:167], v36 offset:23552
v_mul_f32 v23, v195, v23
Mvaa 244,168,24
v_exp_f32 v24, v24
v_exp_f32 v25, v25
Mvaa 252,168,28
ds_read_b128 a[168:171], v36 offset:24576
v_fma_f32 v24, v24, s25, s25
v_fma_f32 v25, v25, s25, s25
Mvaa 224,172,32
buffer_load_dwordx4 v7, s[40:43], s76 offen offset:1024 sc1 lds
CV 145,22,23
Mvaa 232,172,36
ds_read_b128 a[172:175], v36 offset:25600
v_fma_f32 v22, -v210, v210, s24
v_fma_f32 v23, -v211, v211, s24
Mvaa 228,176,32
v_exp_f32 v26, v26
v_mul_f32 v22, v210, v22
Mvaa 236,176,36
ds_read_b128 a[176:179], v36 offset:26624
v_fma_f32 v26, v26, s25, s25
v_mul_f32 v23, v211, v23
Mvaa 240,144,32
v_exp_f32 v27, v27
Mvaa 248,144,36
ds_read_b128 a[144:147], v36 offset:27648
v_fma_f32 v27, v27, s25, s25
Mvaa 244,148,32
buffer_load_dwordx4 v7, s[40:43], s76 offen offset:2048 sc1 lds
v_rcp_f32 v28, v28
Mvaa 252,148,36
s_waitcnt lgkmcnt(3)
ds_read_b128 a[148:151], v36 offset:28672
v_mul_f32 v28, v200, v28
v_rcp_f32 v29, v29
Mvaa 224,152,40
v_rcp_f32 v30, v30
Mvaa 232,152,44
ds_read_b128 a[152:155], v36 offset:29696
v_mul_f32 v29, v201, v29
v_mul_f32 v30, v202, v30
Mvaa 228,156,40
v_rcp_f32 v31, v31
CV 148,28,29
Mvaa 236,156,44
ds_read_b128 a[156:159], v36 offset:30720
v_mul_f32 v31, v203, v31
v_fma_f32 v28, -v216, v216, s24
Mvaa 240,160,40
buffer_load_dwordx4 v7, s[40:43], s76 offen offset:3072 sc1 lds
CV 149,30,31
Mvaa 248,160,44
s_add_u32 m0, s67, 0xb000
s_add_u32 s76, s71, 0x9b000
ds_read_b128 a[160:163], v36 offset:31744
v_fma_f32 v29, -v217, v217, s24
Mvaa 244,164,40
v_exp_f32 v32, v32
v_fma_f32 v30, -v218, v218, s24
Mvaa 252,164,44
ds_read_b128 a[164:167], v36 offset:32768
v_fma_f32 v32, v32, s25, s25
v_fma_f32 v31, -v219, v219, s24
Mvaa 224,168,48
v_exp_f32 v33, v33
Mvaa 232,168,52
s_waitcnt lgkmcnt(3)
ds_read_b128 a[168:171], v36 offset:33792
v_fma_f32 v33, v33, s25, s25
v_mul_f32 v28, v216, v28
Mvaa 228,172,48
buffer_load_dwordx4 v7, s[40:43], s76 offen sc1 lds
v_mul_f32 v29, v217, v29
v_mul_f32 v30, v218, v30
Mvaa 236,172,52
s_add_u32 m0, s67, 0x12000
ds_read_b128 a[172:175], v36 offset:34816
v_mul_f32 v31, v219, v31
Mvaa 240,176,48
s_add_u32 s76, s12, 0
v_exp_f32 v34, v34
Mvaa 248,176,52
ds_read_b128 a[176:179], v36 offset:35840
v_add_u32 v36, 0x9000, v36
v_exp_f32 v35, v35
Mvaa 244,144,48
v_rcp_f32 v24, v24
v_fma_f32 v34, v34, s25, s25
Mvaa 252,144,52
v_rcp_f32 v25, v25
v_fma_f32 v35, v35, s25, s25
Mvaa 224,148,56
v_rcp_f32 v26, v26
Mvaa 232,148,60
v_rcp_f32 v27, v27
v_mul_f32 v24, v196, v24
Mvaa 228,152,56
s_waitcnt vmcnt(21) lgkmcnt(0)
s_barrier
v_exp_f32 v20, v20
v_mul_f32 v25, v197, v25
Mvaa 236,152,60
ds_read_b128 a[144:147], v36
v_mul_f32 v26, v198, v26
v_mul_f32 v27, v199, v27
Mvaa 240,156,56
ds_read_b128 a[148:151], v36 offset:1024
v_fma_f32 v20, v20, s25, s25
Mvaa 248,156,60
ds_read_b128 a[152:155], v36 offset:2048
CV 146,24,25
CV 147,26,27
Mvaa 244,160,56
ds_read_b128 a[156:159], v36 offset:3072
v_fma_f32 v24, -v212, v212, s24
v_fma_f32 v25, -v213, v213, s24
Mvaa 252,160,60
ds_read_b128 a[160:163], v36 offset:4096
v_fma_f32 v26, -v214, v214, s24
v_fma_f32 v27, -v215, v215, s24
Mvaa 224,164,64
v_exp_f32 v21, v21
Mvaa 232,164,68
ds_read_b128 a[164:167], v36 offset:5120
v_fma_f32 v21, v21, s25, s25
v_mul_f32 v24, v212, v24
Mvaa 228,168,64
v_exp_f32 v22, v22
v_mul_f32 v25, v213, v25
Mvaa 236,168,68
ds_read_b128 a[168:171], v36 offset:6144
v_fma_f32 v22, v22, s25, s25
v_mul_f32 v26, v214, v26
Mvaa 240,172,64
v_exp_f32 v23, v23
Mvaa 248,172,68
ds_read_b128 a[172:175], v36 offset:7168
v_fma_f32 v23, v23, s25, s25
v_mul_f32 v27, v215, v27
Mvaa 244,176,64
v_rcp_f32 v32, v32
Mvaa 252,176,68
s_waitcnt lgkmcnt(3)
ds_read_b128 a[176:179], v36 offset:8192
v_mul_f32 v32, v204, v32
v_rcp_f32 v33, v33
Mvaa 224,144,72
v_rcp_f32 v34, v34
Mvaa 232,144,76
ds_read_b128 a[144:147], v36 offset:9216
v_mul_f32 v33, v205, v33
v_mul_f32 v34, v206, v34
Mvaa 228,148,72
LD 8,56,76,0
CV 150,32,33
v_fma_f32 v32, -v220, v220, s24
Mvaa 236,148,76
ds_read_b128 a[148:151], v36 offset:10240
v_fma_f32 v33, -v221, v221, s24
v_mul_f32 v32, v220, v32
Mvaa 240,152,72
v_rcp_f32 v35, v35
Mvaa 248,152,76
ds_read_b128 a[152:155], v36 offset:11264
v_mul_f32 v35, v207, v35
v_mul_f32 v33, v221, v33
Mvaa 244,156,72
buffer_load_dword v17, v16, s[40:43], 0 offen sc1
CV 151,34,35
v_fma_f32 v34, -v222, v222, s24
Mvaa 252,156,76
ds_read_b128 a[156:159], v36 offset:12288
v_fma_f32 v35, -v223, v223, s24
v_mul_f32 v34, v222, v34
Mvaa 224,160,80
LD 9,56,76,1024
v_mul_f32 v35, v223, v35
Mvaa 232,160,84
s_waitcnt lgkmcnt(3)
ds_read_b128 a[160:163], v36 offset:13312
v_exp_f32 v28, v28
Mvaa 228,164,80
v_exp_f32 v29, v29
v_fma_f32 v28, v28, s25, s25
Mvaa 236,164,84
ds_read_b128 a[164:167], v36 offset:14336
v_fma_f32 v29, v29, s25, s25
Mvaa 240,168,80
v_exp_f32 v30, v30
Mvaa 248,168,84
ds_read_b128 a[168:171], v36 offset:15360
v_fma_f32 v30, v30, s25, s25
v_exp_f32 v31, v31
Mvaa 244,172,80
LD 10,56,76,2048
v_fma_f32 v31, v31, s25, s25
Mvaa 252,172,84
ds_read_b128 a[172:175], v36 offset:16384
v_rcp_f32 v20, v20
Mvaa 224,176,88
v_rcp_f32 v21, v21
v_mul_f32 v20, v208, v20
Mvaa 232,176,92
ds_read_b128 a[176:179], v36 offset:17408
v_mul_f32 v21, v209, v21
Mvaa 228,144,88
v_rcp_f32 v22, v22
v_rcp_f32 v23, v23
Mvaa 236,144,92
s_waitcnt lgkmcnt(3)
ds_read_b128 a[144:147], v36 offset:18432
v_mul_f32 v22, v210, v22
v_mul_f32 v23, v211, v23
Mvaa 240,148,88
LD 11,56,76,3072
CV 152,20,21
Mvaa 248,148,92
s_add_u32 m0, s67, 0x13000
s_add_u32 s76, s12, 0x9000
ds_read_b128 a[148:151], v36 offset:19456
CV 153,22,23
Mvaa 244,152,88
v_exp_f32 v24, v24
Mvaa 252,152,92
ds_read_b128 a[152:155], v36 offset:20480
v_fma_f32 v24, v24, s25, s25
v_exp_f32 v25, v25
Mvaa 224,156,96
v_exp_f32 v26, v26
Mvaa 232,156,100
ds_read_b128 a[156:159], v36 offset:21504
v_fma_f32 v25, v25, s25, s25
v_fma_f32 v26, v26, s25, s25
Mvaa 228,160,96
LD 8,56,76,0
v_exp_f32 v27, v27
Mvaa 236,160,100
ds_read_b128 a[160:163], v36 offset:22528
v_fma_f32 v27, v27, s25, s25
Mvaa 240,164,96
v_rcp_f32 v28, v28
Mvaa 248,164,100
s_waitcnt lgkmcnt(3)
ds_read_b128 a[164:167], v36 offset:23552
v_mul_f32 v28, v216, v28
v_rcp_f32 v29, v29
Mvaa 244,168,96
v_rcp_f32 v30, v30
v_mul_f32 v29, v217, v29
Mvaa 252,168,100
ds_read_b128 a[168:171], v36 offset:24576
v_mul_f32 v30, v218, v30
CV 156,28,29
Mvaa 224,172,104
LD 9,56,76,1024
Mvaa 232,172,108
ds_read_b128 a[172:175], v36 offset:25600
v_rcp_f32 v31, v31
Mvaa 228,176,104
v_exp_f32 v32, v32
v_mul_f32 v31, v219, v31
Mvaa 236,176,108
ds_read_b128 a[176:179], v36 offset:26624
v_fma_f32 v32, v32, s25, s25
CV 157,30,31
Mvaa 240,144,104
v_exp_f32 v33, v33
Mvaa 248,144,108
ds_read_b128 a[144:147], v36 offset:27648
v_fma_f32 v33, v33, s25, s25
Mvaa 244,148,104
LD 10,56,76,2048
v_exp_f32 v34, v34
Mvaa 252,148,108
s_waitcnt lgkmcnt(3)
ds_read_b128 a[148:151], v36 offset:28672
v_fma_f32 v34, v34, s25, s25
v_exp_f32 v35, v35
Mvaa 224,152,112
v_rcp_f32 v24, v24
Mvaa 232,152,116
ds_read_b128 a[152:155], v36 offset:29696
v_fma_f32 v35, v35, s25, s25
v_mul_f32 v24, v212, v24
Mvaa 228,156,112
v_rcp_f32 v25, v25
Mvaa 236,156,116
ds_read_b128 a[156:159], v36 offset:30720
v_mul_f32 v25, v213, v25
v_rcp_f32 v26, v26
Mvaa 240,160,112
LD 11,56,76,3072
v_mul_f32 v26, v214, v26
Mvaa 248,160,116
s_add_u32 m0, s67, 0x14000
s_add_u32 s76, s12, 0x12000
ds_read_b128 a[160:163], v36 offset:31744
CV 154,24,25
Mvaa 244,164,112
v_rcp_f32 v27, v27
Mvaa 252,164,116
ds_read_b128 a[164:167], v36 offset:32768
v_mul_f32 v27, v215, v27
v_rcp_f32 v32, v32
Mvaa 224,168,120
v_rcp_f32 v33, v33
Mvaa 232,168,124
s_waitcnt lgkmcnt(3)
ds_read_b128 a[168:171], v36 offset:33792
v_mul_f32 v32, v220, v32
v_mul_f32 v33, v221, v33
Mvaa 228,172,120
LD 8,56,76,0
v_rcp_f32 v34, v34
Mvaa 236,172,124
s_add_u32 m0, s67, 0x1b000
ds_read_b128 a[172:175], v36 offset:34816
v_mul_f32 v34, v222, v34
CV 155,26,27
Mvaa 240,176,120
s_add_u32 s76, s12, 0x51000
v_rcp_f32 v35, v35
Mvaa 248,176,124
ds_read_b128 a[176:179], v36 offset:35840
v_add_u32 v36, 0xfffe5000, v36
v_mul_f32 v35, v223, v35
Mvaa 244,144,120
CV 158,32,33
CV 159,34,35
Mvaa 252,144,124
Mvaa 224,148,128
Mvaa 232,148,132
Mvaa 228,152,128
Mvaa 236,152,132
s_waitcnt vmcnt(20) lgkmcnt(0)
s_barrier
Mvaa 240,156,128
ds_read_b128 a[144:147], v36
s_waitcnt vmcnt(8)
v_cmp_ne_u32 vcc, s98, v17
s_cbranch_vccnz L_spin53
L_pollok53:
v_mov_b32 v16, 0
v_lshlrev_b32 v17, 7, s14
Mvaa 248,156,132
ds_read_b128 a[148:151], v36 offset:1024
v_lshl_add_u32 v16, v16, 2, v17
Mvaa 244,160,128
ds_read_b128 a[152:155], v36 offset:2048
v_add_u32 v16, 0x3010004, v16
Mvaa 252,160,132
ds_read_b128 a[156:159], v36 offset:3072
Mvaa 224,164,136
ds_read_b128 a[160:163], v36 offset:4096
Mvaa 232,164,140
ds_read_b128 a[164:167], v36 offset:5120
Mvaa 228,168,136
s_nop 0
s_nop 2
v_fma_f32 v20, -v224, v224, s24
v_fma_f32 v21, -v225, v225, s24
Mvaa 236,168,140
ds_read_b128 a[168:171], v36 offset:6144
v_fma_f32 v22, -v226, v226, s24
v_fma_f32 v23, -v227, v227, s24
Mvaa 240,172,136
v_mul_f32 v20, v224, v20
v_mul_f32 v21, v225, v21
Mvaa 248,172,140
ds_read_b128 a[172:175], v36 offset:7168
v_mul_f32 v22, v226, v22
v_mul_f32 v23, v227, v23
Mvaa 244,176,136
v_exp_f32 v20, v20
v_fma_f32 v28, -v232, v232, s24
Mvaa 252,176,140
s_waitcnt lgkmcnt(3)
ds_read_b128 a[176:179], v36 offset:8192
v_fma_f32 v29, -v233, v233, s24
v_fma_f32 v30, -v234, v234, s24
v_mfma_f32_16x16x32_bf16 v[192:195], a[144:147], a[0:3], 0
v_exp_f32 v21, v21
v_mfma_f32_16x16x32_bf16 v[200:203], a[144:147], a[4:7], 0
ds_read_b128 a[144:147], v36 offset:9216
v_fma_f32 v31, -v235, v235, s24
v_mul_f32 v28, v232, v28
v_mfma_f32_16x16x32_bf16 v[196:199], a[148:151], a[0:3], 0
LD 8,56,76,0
v_mul_f32 v29, v233, v29
v_mul_f32 v30, v234, v30
v_mfma_f32_16x16x32_bf16 v[204:207], a[148:151], a[4:7], 0
ds_read_b128 a[148:151], v36 offset:10240
v_mul_f32 v31, v235, v31
v_fma_f32 v20, v20, s25, s25
v_mfma_f32_16x16x32_bf16 v[208:211], a[152:155], a[0:3], 0
v_exp_f32 v22, v22
v_mfma_f32_16x16x32_bf16 v[216:219], a[152:155], a[4:7], 0
ds_read_b128 a[152:155], v36 offset:11264
v_fma_f32 v21, v21, s25, s25
v_fma_f32 v22, v22, s25, s25
v_mfma_f32_16x16x32_bf16 v[212:215], a[156:159], a[0:3], 0
v_exp_f32 v23, v23
v_fma_f32 v24, -v228, v228, s24
v_mfma_f32_16x16x32_bf16 v[220:223], a[156:159], a[4:7], 0
ds_read_b128 a[156:159], v36 offset:12288
v_fma_f32 v23, v23, s25, s25
v_fma_f32 v25, -v229, v229, s24
Mvaa 192,160,8
LD 9,56,76,1024
v_fma_f32 v26, -v230, v230, s24
Mvaa 200,160,12
L_pg3_15:
s_cbranch_execz L_ret3
s_waitcnt lgkmcnt(3)
ds_read_b128 a[160:163], v36 offset:13312
v_fma_f32 v27, -v231, v231, s24
v_mul_f32 v24, v228, v24
Mvaa 196,164,8
v_exp_f32 v28, v28
v_mul_f32 v25, v229, v25
Mvaa 204,164,12
ds_read_b128 a[164:167], v36 offset:14336
v_mul_f32 v26, v230, v26
v_mul_f32 v27, v231, v27
Mvaa 208,168,8
v_exp_f32 v29, v29
Mvaa 216,168,12
ds_read_b128 a[168:171], v36 offset:15360
v_fma_f32 v28, v28, s25, s25
v_fma_f32 v29, v29, s25, s25
Mvaa 212,172,8
LD 10,56,76,2048
v_fma_f32 v32, -v236, v236, s24
v_fma_f32 v33, -v237, v237, s24
Mvaa 220,172,12
ds_read_b128 a[172:175], v36 offset:16384
v_fma_f32 v34, -v238, v238, s24
v_fma_f32 v35, -v239, v239, s24
Mvaa 192,176,16
v_exp_f32 v30, v30
Mvaa 200,176,20
ds_read_b128 a[176:179], v36 offset:17408
v_fma_f32 v30, v30, s25, s25
v_mul_f32 v32, v236, v32
Mvaa 196,144,16
v_exp_f32 v31, v31
v_mul_f32 v33, v237, v33
Mvaa 204,144,20
s_waitcnt lgkmcnt(3)
ds_read_b128 a[144:147], v36 offset:18432
v_fma_f32 v31, v31, s25, s25
v_mul_f32 v34, v238, v34
Mvaa 208,148,16
LD 11,56,76,3072
v_mul_f32 v35, v239, v35
Mvaa 216,148,20
s_add_u32 m0, s67, 0x1c000
s_add_u32 s76, s12, 0x5a000
ds_read_b128 a[148:151], v36 offset:19456
Mvaa 212,152,16
v_rcp_f32 v20, v20
v_rcp_f32 v21, v21
Mvaa 220,152,20
ds_read_b128 a[152:155], v36 offset:20480
v_mul_f32 v20, v224, v20
v_mul_f32 v21, v225, v21
Mvaa 192,156,24
v_rcp_f32 v22, v22
Mvaa 200,156,28
ds_read_b128 a[156:159], v36 offset:21504
v_mul_f32 v22, v226, v22
CV 160,20,21
Mvaa 196,160,24
LD 8,56,76,0
v_fma_f32 v20, -v240, v240, s24
v_fma_f32 v21, -v241, v241, s24
Mvaa 204,160,28
s_waitcnt lgkmcnt(2)
ds_read_b128 a[160:163], v36 offset:22528
v_mul_f32 v20, v240, v20
v_mul_f32 v21, v241, v21
Mvaa 208,164,24
s_lshl_b32 s85, s30, 7
v_rcp_f32 v23, v23
Mvaa 216,164,28
s_add_u32 s85, s85, 0x4000
ds_read_b128 a[164:167], v36 offset:23552
v_mov_b32 v46, s85
v_mul_f32 v23, v227, v23
Mvaa 212,168,24
s_getpc_b64 s[96:97]
v_exp_f32 v24, v24
CV 161,22,23
Mvaa 220,168,28
global_load_dword a252, v46, s[96:97]
ds_read_b128 a[168:171], v36 offset:24576
Mvaa 192,172,32
v_exp_f32 v25, v25
v_fma_f32 v24, v24, s25, s25
Mvaa 200,172,36
LD 9,56,76,1024
ds_read_b128 a[172:175], v36 offset:25600
Mvaa 196,176,32
v_exp_f32 v26, v26
v_exp_f32 v27, v27
Mvaa 204,176,36
ds_read_b128 a[176:179], v36 offset:26624
v_fma_f32 v25, v25, s25, s25
v_fma_f32 v26, v26, s25, s25
Mvaa 208,144,32
v_rcp_f32 v28, v28
Mvaa 216,144,36
ds_read_b128 a[144:147], v36 offset:27648
v_fma_f32 v27, v27, s25, s25
v_mul_f32 v28, v232, v28
Mvaa 212,148,32
LD 10,56,76,2048
v_fma_f32 v22, -v242, v242, s24
v_fma_f32 v23, -v243, v243, s24
Mvaa 220,148,36
s_waitcnt lgkmcnt(3)
ds_read_b128 a[148:151], v36 offset:28672
v_mul_f32 v22, v242, v22
v_mul_f32 v23, v243, v23
Mvaa 192,152,40
v_rcp_f32 v29, v29
Mvaa 200,152,44
ds_read_b128 a[152:155], v36 offset:29696
v_mul_f32 v29, v233, v29
Mvaa 196,156,40
v_rcp_f32 v30, v30
v_rcp_f32 v31, v31
Mvaa 204,156,44
ds_read_b128 a[156:159], v36 offset:30720
v_mul_f32 v30, v234, v30
v_mul_f32 v31, v235, v31
Mvaa 208,160,40
LD 11,56,76,3072
CV 164,28,29
Mvaa 216,160,44
s_add_u32 m0, s67, 0x1d000
s_add_u32 s76, s12, 0x63000
ds_read_b128 a[160:163], v36 offset:31744
CV 165,30,31
Mvaa 212,164,40
s_add_u32 s12, s66, 2
v_rcp_f32 v24, v24
v_fma_f32 v28, -v248, v248, s24
Mvaa 220,164,44
s_and_b32 s12, s12, 7
ds_read_b128 a[164:167], v36 offset:32768
v_mul_f32 v24, v228, v24
v_fma_f32 v29, -v249, v249, s24
Mvaa 192,168,48
s_lshl_b32 s12, s12, 7
v_rcp_f32 v25, v25
Mvaa 200,168,52
s_waitcnt lgkmcnt(3)
s_add_u32 s12, s12, s74
ds_read_b128 a[168:171], v36 offset:33792
v_mul_f32 v25, v229, v25
v_fma_f32 v30, -v250, v250, s24
Mvaa 196,172,48
LD 8,56,76,0
v_fma_f32 v31, -v251, v251, s24
v_mul_f32 v28, v248, v28
Mvaa 204,172,52
s_add_u32 m0, s67, 0
ds_read_b128 a[172:175], v36 offset:34816
v_mul_f32 v29, v249, v29
v_mul_f32 v30, v250, v30
Mvaa 208,176,48
s_add_u32 s76, s23, 0
v_rcp_f32 v26, v26
Mvaa 216,176,52
ds_read_b128 a[176:179], v36 offset:35840
v_add_u32 v36, 0x9000, v36
v_mul_f32 v26, v230, v26
Mvaa 212,144,48
v_rcp_f32 v27, v27
v_mul_f32 v31, v251, v31
Mvaa 220,144,52
v_exp_f32 v32, v32
v_mul_f32 v27, v231, v27
Mvaa 192,148,56
v_exp_f32 v33, v33
Mvaa 200,148,60
v_exp_f32 v34, v34
v_fma_f32 v32, v32, s25, s25
Mvaa 196,152,56
v_exp_f32 v35, v35
v_fma_f32 v33, v33, s25, s25
Mvaa 204,152,60
s_waitcnt lgkmcnt(0)
s_barrier
v_exp_f32 v20, v20
v_fma_f32 v34, v34, s25, s25
Mvaa 208,156,56
ds_read_b128 a[144:147], v36
v_fma_f32 v35, v35, s25, s25
Mvaa 216,156,60
ds_read_b128 a[148:151], v36 offset:1024
v_fma_f32 v20, v20, s25, s25
CV 162,24,25
Mvaa 212,160,56
ds_read_b128 a[152:155], v36 offset:2048
CV 163,26,27
v_fma_f32 v24, -v244, v244, s24
Mvaa 220,160,60
ds_read_b128 a[156:159], v36 offset:3072
v_fma_f32 v25, -v245, v245, s24
v_fma_f32 v26, -v246, v246, s24
Mvaa 192,164,64
ds_read_b128 a[160:163], v36 offset:4096
v_fma_f32 v27, -v247, v247, s24
Mvaa 200,164,68
ds_read_b128 a[164:167], v36 offset:5120
v_mul_f32 v24, v244, v24
v_mul_f32 v25, v245, v25
Mvaa 196,168,64
v_exp_f32 v21, v21
v_mul_f32 v26, v246, v26
Mvaa 204,168,68
ds_read_b128 a[168:171], v36 offset:6144
v_fma_f32 v21, v21, s25, s25
v_mul_f32 v27, v247, v27
Mvaa 208,172,64
v_exp_f32 v22, v22
Mvaa 216,172,68
ds_read_b128 a[172:175], v36 offset:7168
v_fma_f32 v22, v22, s25, s25
Mvaa 212,176,64
v_exp_f32 v23, v23
v_rcp_f32 v32, v32
Mvaa 220,176,68
s_waitcnt lgkmcnt(4)
ds_read_b128 a[176:179], v36 offset:8192
v_fma_f32 v23, v23, s25, s25
v_mul_f32 v32, v236, v32
Mvaa 192,144,72
v_rcp_f32 v33, v33
Mvaa 200,144,76
ds_read_b128 a[144:147], v36 offset:9216
v_mul_f32 v33, v237, v33
Mvaa 196,148,72
LD 8,56,76,0
CV 166,32,33
v_rcp_f32 v34, v34
Mvaa 204,148,76
ds_read_b128 a[148:151], v36 offset:10240
v_mul_f32 v34, v238, v34
v_fma_f32 v32, -v252, v252, s24
Mvaa 208,152,72
v_rcp_f32 v35, v35
Mvaa 216,152,76
ds_read_b128 a[152:155], v36 offset:11264
v_mul_f32 v35, v239, v35
v_fma_f32 v33, -v253, v253, s24
Mvaa 212,156,72
v_exp_f32 v28, v28
CV 167,34,35
Mvaa 220,156,76
s_waitcnt lgkmcnt(3)
ds_read_b128 a[156:159], v36 offset:12288
v_fma_f32 v28, v28, s25, s25
v_fma_f32 v34, -v254, v254, s24
Mvaa 192,160,80
LD 9,56,76,1024
v_fma_f32 v35, -v255, v255, s24
Mvaa 200,160,84
ds_read_b128 a[160:163], v36 offset:13312
v_mul_f32 v32, v252, v32
v_mul_f32 v33, v253, v33
Mvaa 196,164,80
v_exp_f32 v29, v29
v_mul_f32 v34, v254, v34
Mvaa 204,164,84
ds_read_b128 a[164:167], v36 offset:14336
v_fma_f32 v29, v29, s25, s25
v_mul_f32 v35, v255, v35
Mvaa 208,168,80
v_exp_f32 v30, v30
Mvaa 216,168,84
ds_read_b128 a[168:171], v36 offset:15360
v_fma_f32 v30, v30, s25, s25
Mvaa 212,172,80
LD 10,56,76,2048
v_exp_f32 v31, v31
Mvaa 220,172,84
ds_read_b128 a[172:175], v36 offset:16384
v_fma_f32 v31, v31, s25, s25
v_rcp_f32 v20, v20
Mvaa 192,176,88
v_rcp_f32 v21, v21
Mvaa 200,176,92
s_waitcnt lgkmcnt(3)
ds_read_b128 a[176:179], v36 offset:17408
v_mul_f32 v20, v240, v20
v_mul_f32 v21, v241, v21
Mvaa 196,144,88
v_rcp_f32 v22, v22
CV 168,20,21
Mvaa 204,144,92
ds_read_b128 a[144:147], v36 offset:18432
v_mul_f32 v22, v242, v22
Mvaa 208,148,88
LD 11,56,76,3072
v_rcp_f32 v23, v23
Mvaa 216,148,92
s_add_u32 m0, s67, 0x1000
s_add_u32 s76, s23, 0x9000
ds_read_b128 a[148:151], v36 offset:19456
v_mul_f32 v23, v243, v23
Mvaa 212,152,88
v_exp_f32 v24, v24
CV 169,22,23
Mvaa 220,152,92
ds_read_b128 a[152:155], v36 offset:20480
v_fma_f32 v24, v24, s25, s25
Mvaa 192,156,96
v_exp_f32 v25, v25
Mvaa 200,156,100
ds_read_b128 a[156:159], v36 offset:21504
v_fma_f32 v25, v25, s25, s25
v_exp_f32 v26, v26
Mvaa 196,160,96
LD 8,56,76,0
v_fma_f32 v26, v26, s25, s25
Mvaa 204,160,100
s_waitcnt lgkmcnt(3)
ds_read_b128 a[160:163], v36 offset:22528
v_exp_f32 v27, v27
Mvaa 208,164,96
v_rcp_f32 v28, v28
v_fma_f32 v27, v27, s25, s25
Mvaa 216,164,100
ds_read_b128 a[164:167], v36 offset:23552
v_mul_f32 v28, v248, v28
Mvaa 212,168,96
v_rcp_f32 v29, v29
v_rcp_f32 v30, v30
Mvaa 220,168,100
ds_read_b128 a[168:171], v36 offset:24576
v_mul_f32 v29, v249, v29
v_mul_f32 v30, v250, v30
Mvaa 192,172,104
LD 9,56,76,1024
CV 172,28,29
Mvaa 200,172,108
ds_read_b128 a[172:175], v36 offset:25600
v_rcp_f32 v31, v31
Mvaa 196,176,104
v_rcp_f32 v24, v24
v_mul_f32 v31, v251, v31
Mvaa 204,176,108
ds_read_b128 a[176:179], v36 offset:26624
v_mul_f32 v24, v244, v24
CV 173,30,31
Mvaa 208,144,104
v_rcp_f32 v25, v25
Mvaa 216,144,108
s_waitcnt lgkmcnt(3)
ds_read_b128 a[144:147], v36 offset:27648
v_mul_f32 v25, v245, v25
Mvaa 212,148,104
LD 10,56,76,2048
v_rcp_f32 v26, v26
CV 170,24,25
Mvaa 220,148,108
ds_read_b128 a[148:151], v36 offset:28672
v_mul_f32 v26, v246, v26
Mvaa 192,152,112
v_rcp_f32 v27, v27
Mvaa 200,152,116
ds_read_b128 a[152:155], v36 offset:29696
v_mul_f32 v27, v247, v27
v_exp_f32 v32, v32
Mvaa 196,156,112
v_exp_f32 v33, v33
v_fma_f32 v32, v32, s25, s25
Mvaa 204,156,116
ds_read_b128 a[156:159], v36 offset:30720
v_fma_f32 v33, v33, s25, s25
CV 171,26,27
Mvaa 208,160,112
LD 11,56,76,3072
Mvaa 216,160,116
s_add_u32 m0, s67, 0x2000
s_add_u32 s76, s23, 0x12000
ds_read_b128 a[160:163], v36 offset:31744
Mvaa 212,164,112
v_exp_f32 v34, v34
v_exp_f32 v35, v35
Mvaa 220,164,116
s_waitcnt lgkmcnt(3)
ds_read_b128 a[164:167], v36 offset:32768
v_fma_f32 v34, v34, s25, s25
v_fma_f32 v35, v35, s25, s25
Mvaa 192,168,120
v_rcp_f32 v32, v32
Mvaa 200,168,124
ds_read_b128 a[168:171], v36 offset:33792
v_mul_f32 v32, v252, v32
Mvaa 196,172,120
LD 8,56,76,0
v_rcp_f32 v33, v33
Mvaa 204,172,124
s_add_u32 m0, s67, 0x9000
ds_read_b128 a[172:175], v36 offset:34816
v_mul_f32 v33, v253, v33
v_rcp_f32 v34, v34
Mvaa 208,176,120
s_add_u32 s76, s23, 0x51000
v_rcp_f32 v35, v35
Mvaa 216,176,124
ds_read_b128 a[176:179], v36 offset:35840
v_mul_f32 v34, v254, v34
v_mul_f32 v35, v255, v35
Mvaa 212,144,120
CV 174,32,33
CV 175,34,35
Mvaa 220,144,124
Mvaa 192,148,128
Mvaa 200,148,132
s_waitcnt lgkmcnt(2)
Mvaa 196,152,128
Mvaa 204,152,132
s_waitcnt vmcnt(19) lgkmcnt(0)
s_barrier
Mvaa 208,156,128
Ta 144,2,0
Mvaa 216,156,132
Ta 146,2,2048
Mvaa 212,160,128
Ta 148,3,0
Mvaa 220,160,132
Ta 150,3,2048
Mvaa 192,164,136
Ta 152,4,0
Mvaa 200,164,140
Ta 154,4,2048
Mvaa 196,168,136
Ta 156,5,0
s_nop 2
v_fma_f32 v20, -v192, v192, s24
v_fma_f32 v21, -v193, v193, s24
Mvaa 204,168,140
Ta 158,5,2048
v_fma_f32 v22, -v194, v194, s24
v_fma_f32 v23, -v195, v195, s24
Mvaa 208,172,136
Ta 160,2,4096
v_fma_f32 v24, -v196, v196, s24
Mvaa 216,172,140
Ta 162,2,6144
v_fma_f32 v25, -v197, v197, s24
v_fma_f32 v26, -v198, v198, s24
Mvaa 212,176,136
Ta 164,3,4096
v_fma_f32 v27, -v199, v199, s24
v_mul_f32 v20, v192, v20
Mvaa 220,176,140
s_waitcnt lgkmcnt(6)
Ta 166,3,6144
v_mul_f32 v21, v193, v21
v_mul_f32 v22, v194, v22
v_mfma_f32_16x16x32_bf16 v[224:227], a[144:147], v[48:51], 0
Ta 168,4,4096
v_mul_f32 v23, v195, v23
v_mul_f32 v24, v196, v24
v_mfma_f32_16x16x32_bf16 v[232:235], a[144:147], v[52:55], 0
Ta 170,4,6144
v_mul_f32 v25, v197, v25
v_mul_f32 v26, v198, v26
v_mfma_f32_16x16x32_bf16 v[228:231], a[148:151], v[48:51], 0
LD 8,56,76,0
Ta 172,5,4096
v_mul_f32 v27, v199, v27
v_mfma_f32_16x16x32_bf16 v[236:239], a[148:151], v[52:55], 0
s_waitcnt lgkmcnt(6)
Ta 174,5,6144
v_fma_f32 v28, -v200, v200, s24
v_fma_f32 v29, -v201, v201, s24
v_mfma_f32_16x16x32_bf16 v[240:243], a[152:155], v[48:51], 0
Ta 176,2,8192
v_fma_f32 v30, -v202, v202, s24
v_fma_f32 v31, -v203, v203, s24
v_mfma_f32_16x16x32_bf16 v[248:251], a[152:155], v[52:55], 0
Ta 178,2,10240
v_fma_f32 v32, -v204, v204, s24
v_fma_f32 v33, -v205, v205, s24
v_mfma_f32_16x16x32_bf16 v[244:247], a[156:159], v[48:51], 0
Ta 144,3,8192
v_fma_f32 v34, -v206, v206, s24
v_exp_f32 v20, v20
v_mfma_f32_16x16x32_bf16 v[252:255], a[156:159], v[52:55], 0
s_waitcnt lgkmcnt(6)
Ta 146,3,10240
v_fma_f32 v35, -v207, v207, s24
v_mul_f32 v28, v200, v28
Mvav 224,160,56
LD 9,56,76,1024
Ta 148,4,8192
Mvav 232,160,60
Ta 150,4,10240
v_mul_f32 v29, v201, v29
v_exp_f32 v21, v21
Mvav 228,164,56
Ta 152,5,8192
v_mul_f32 v30, v202, v30
v_exp_f32 v22, v22
Mvav 236,164,60
s_waitcnt lgkmcnt(6)
Ta 154,5,10240
v_mul_f32 v31, v203, v31
v_mul_f32 v32, v204, v32
Mvav 240,168,56
Ta 156,2,12288
v_mul_f32 v33, v205, v33
v_mul_f32 v34, v206, v34
Mvav 248,168,60
Ta 158,2,14336
v_mul_f32 v35, v207, v35
v_exp_f32 v23, v23
Mvav 244,172,56
LD 10,56,76,2048
Ta 160,3,12288
Mvav 252,172,60
s_waitcnt lgkmcnt(6)
Ta 162,3,14336
v_fma_f32 v20, v20, s25, s25
v_exp_f32 v24, v24
Mvav 224,176,64
Ta 164,4,12288
v_fma_f32 v21, v21, s25, s25
v_fma_f32 v22, v22, s25, s25
Mvav 232,176,68
Ta 166,4,14336
v_fma_f32 v23, v23, s25, s25
v_exp_f32 v25, v25
Mvav 228,144,64
Ta 168,5,12288
v_fma_f32 v24, v24, s25, s25
v_fma_f32 v25, v25, s25, s25
Mvav 236,144,68
s_waitcnt lgkmcnt(6)
Ta 170,5,14336
v_exp_f32 v26, v26
Mvav 240,148,64
LD 11,56,76,3072
Ta 172,2,16384
s_add_u32 m0, s67, 0xa000
Mvav 248,148,68
s_add_u32 s76, s23, 0x5a000
Ta 174,2,18432
v_fma_f32 v26, v26, s25, s25
v_exp_f32 v27, v27
Mvav 244,152,64
Ta 176,3,16384
v_fma_f32 v27, v27, s25, s25
Mvav 252,152,68
s_waitcnt lgkmcnt(6)
Ta 178,3,18432
v_exp_f32 v28, v28
Mvav 224,156,72
Ta 144,4,16384
v_fma_f32 v28, v28, s25, s25
v_exp_f32 v29, v29
Mvav 232,156,76
Ta 146,4,18432
v_fma_f32 v29, v29, s25, s25
v_exp_f32 v30, v30
Mvav 228,160,72
LD 8,56,76,0
Ta 148,5,16384
Mvav 236,160,76
s_waitcnt lgkmcnt(6)
Ta 150,5,18432
v_fma_f32 v30, v30, s25, s25
v_exp_f32 v31, v31
Mvav 240,164,72
s_lshl_b32 s85, s30, 7
Ta 152,2,20480
v_fma_f32 v31, v31, s25, s25
v_exp_f32 v32, v32
Mvav 248,164,76
s_add_u32 s85, s85, 0x4000
Ta 154,2,22528
v_mov_b32 v46, s85
v_fma_f32 v32, v32, s25, s25
Mvav 244,168,72
s_getpc_b64 s[96:97]
Ta 156,3,20480
v_exp_f32 v33, v33
Mvav 252,168,76
s_waitcnt lgkmcnt(6)
global_load_dword a252, v46, s[96:97]
Ta 158,3,22528
v_fma_f32 v33, v33, s25, s25
Mvav 224,172,80
LD 9,56,76,1024
Ta 160,4,20480
Mvav 232,172,84
Ta 162,4,22528
v_exp_f32 v34, v34
Mvav 228,176,80
Ta 164,5,20480
v_fma_f32 v34, v34, s25, s25
v_exp_f32 v35, v35
Mvav 236,176,84
s_waitcnt lgkmcnt(6)
Ta 166,5,22528
v_fma_f32 v35, v35, s25, s25
v_rcp_f32 v20, v20
Mvav 240,144,80
Ta 168,2,24576
v_mul_f32 v20, v192, v20
Mvav 248,144,84
Ta 170,2,26624
L_pg3_16:
s_cbranch_execz L_ret3
v_rcp_f32 v21, v21
Mvav 244,148,80
LD 10,56,76,2048
Ta 172,3,24576
v_mul_f32 v21, v193, v21
Mvav 252,148,84
s_waitcnt lgkmcnt(6)
Ta 174,3,26624
CV 176,20,21
v_rcp_f32 v22, v22
Mvav 224,152,88
Ta 176,4,24576
v_mul_f32 v22, v194, v22
v_fma_f32 v20, -v208, v208, s24
Mvav 232,152,92
Ta 178,4,26624
v_fma_f32 v21, -v209, v209, s24
v_mul_f32 v20, v208, v20
Mvav 228,156,88
Ta 144,5,24576
v_mul_f32 v21, v209, v21
v_rcp_f32 v23, v23
Mvav 236,156,92
s_waitcnt lgkmcnt(6)
Ta 146,5,26624
v_mul_f32 v23, v195, v23
Mvav 240,160,88
LD 11,56,76,3072
Ta 148,2,28672
s_add_u32 m0, s67, 0xb000
s_add_u32 s76, s23, 0x63000
Mvav 248,160,92
s_add_u32 s23, s66, 3
Ta 150,2,30720
CV 177,22,23
v_fma_f32 v22, -v210, v210, s24
Mvav 244,164,88
s_and_b32 s23, s23, 7
Ta 152,3,28672
v_fma_f32 v23, -v211, v211, s24
v_rcp_f32 v24, v24
Mvav 252,164,92
s_waitcnt lgkmcnt(6)
s_lshl_b32 s23, s23, 7
Ta 154,3,30720
v_mul_f32 v24, v196, v24
v_mul_f32 v22, v210, v22
Mvav 224,168,96
s_add_u32 s23, s23, s74
Ta 156,4,28672
Ta 158,4,30720
Mvav 232,168,100
s_waitcnt lgkmcnt(5)
Ta 160,5,28672
Ta 162,5,30720
Mvav 228,172,96
LD 8,56,76,0
Ta 164,2,32768
Ta 166,2,34816
Mvav 236,172,100
s_add_u32 m0, s67, 0x12000
Ta 168,3,32768
Ta 170,3,34816
Mvav 240,176,96
s_add_u32 s76, s12, 0
Ta 172,4,32768
Ta 174,4,34816
Mvav 248,176,100
Ta 176,5,32768
Ta 178,5,34816
v_add_u32 v2, 0x9000, v2
Mvav 244,144,96
v_add_u32 v3, 0x9000, v3
v_add_u32 v4, 0x9000, v4
v_add_u32 v5, 0x9000, v5
Mvav 252,144,100
s_mov_b64 exec, 0
s_cmp_eq_u32 s64, 0
s_cbranch_scc1 L_pg4_17
s_cmp_eq_u32 s64, 1
s_cbranch_scc1 L_pg4_18
s_cmp_eq_u32 s64, 2
s_cbranch_scc1 L_pg4_19
s_branch L_pg4_20
L_ret4:
s_mov_b64 exec, -1
s_waitcnt lgkmcnt(10)
v_rcp_f32 v25, v25
v_mul_f32 v23, v211, v23
Mvav 224,148,104
v_rcp_f32 v26, v26
v_mul_f32 v25, v197, v25
Mvav 232,148,108
v_rcp_f32 v27, v27
v_mul_f32 v26, v198, v26
CV 178,24,25
Mvav 228,152,104
s_waitcnt vmcnt(19) lgkmcnt(0)
s_barrier
v_rcp_f32 v28, v28
v_mul_f32 v27, v199, v27
Mvav 236,152,108
Ta 144,2,0
CV 179,26,27
v_mul_f32 v28, v200, v28
Mvav 240,156,104
Ta 146,2,2048
v_fma_f32 v24, -v212, v212, s24
v_fma_f32 v25, -v213, v213, s24
Mvav 248,156,108
Ta 148,3,0
v_fma_f32 v26, -v214, v214, s24
v_rcp_f32 v29, v29
Mvav 244,160,104
Ta 150,3,2048
v_mul_f32 v29, v201, v29
v_fma_f32 v27, -v215, v215, s24
Mvav 252,160,108
Ta 152,4,0
CV 180,28,29
v_mul_f32 v24, v212, v24
Mvav 224,164,112
Ta 154,4,2048
v_mul_f32 v25, v213, v25
v_rcp_f32 v30, v30
Mvav 232,164,116
Ta 156,5,0
v_mul_f32 v30, v202, v30
v_mul_f32 v26, v214, v26
Mvav 228,168,112
Ta 158,5,2048
v_mul_f32 v27, v215, v27
v_fma_f32 v28, -v216, v216, s24
Mvav 236,168,116
Ta 160,2,4096
v_fma_f32 v29, -v217, v217, s24
v_mul_f32 v28, v216, v28
Mvav 240,172,112
Ta 162,2,6144
v_mul_f32 v29, v217, v29
v_rcp_f32 v31, v31
Mvav 248,172,116
Ta 164,3,4096
v_mul_f32 v31, v203, v31
Mvav 244,176,112
Ta 166,3,6144
CV 181,30,31
v_rcp_f32 v32, v32
Mvav 252,176,116
s_waitcnt lgkmcnt(6)
Ta 168,4,4096
v_mul_f32 v32, v204, v32
v_rcp_f32 v33, v33
Mvav 224,144,120
Ta 170,4,6144
v_mul_f32 v33, v205, v33
v_fma_f32 v30, -v218, v218, s24
Mvav 232,144,124
Ta 172,5,4096
CV 182,32,33
v_fma_f32 v31, -v219, v219, s24
Mvav 228,148,120
LD 8,56,76,0
Ta 174,5,6144
Mvav 236,148,124
Ta 176,2,8192
v_fma_f32 v32, -v220, v220, s24
v_rcp_f32 v34, v34
v_fma_f32 v33, -v221, v221, s24
Mvav 240,152,120
Ta 178,2,10240
v_mul_f32 v34, v206, v34
v_mul_f32 v30, v218, v30
Mvav 248,152,124
s_waitcnt lgkmcnt(6)
Ta 144,3,8192
v_mul_f32 v31, v219, v31
v_mul_f32 v32, v220, v32
Mvav 244,156,120
Ta 146,3,10240
v_mul_f32 v33, v221, v33
Mvav 252,156,124
Ta 148,4,8192
v_rcp_f32 v35, v35
v_exp_f32 v20, v20
Mvav 224,160,128
LD 9,56,76,1024
Ta 150,4,10240
Mvav 232,160,132
Ta 152,5,8192
v_mul_f32 v35, v207, v35
v_exp_f32 v21, v21
Mvav 228,164,128
Ta 154,5,10240
CV 183,34,35
v_exp_f32 v22, v22
Mvav 236,164,132
s_waitcnt lgkmcnt(6)
Ta 156,2,12288
v_fma_f32 v34, -v222, v222, s24
v_fma_f32 v35, -v223, v223, s24
Mvav 240,168,128
Ta 158,2,14336
v_mul_f32 v34, v222, v34
v_mul_f32 v35, v223, v35
Mvav 248,168,132
Ta 160,3,12288
v_fma_f32 v20, v20, s25, s25
v_fma_f32 v21, v21, s25, s25
Mvav 244,172,128
LD 10,56,76,2048
Ta 162,3,14336
v_fma_f32 v22, v22, s25, s25
Mvav 252,172,132
Ta 164,4,12288
v_exp_f32 v23, v23
Mvav 224,176,136
Ta 166,4,14336
v_fma_f32 v23, v23, s25, s25
Mvav 232,176,140
s_waitcnt lgkmcnt(6)
Ta 168,5,12288
v_exp_f32 v24, v24
Mvav 228,144,136
Ta 170,5,14336
v_fma_f32 v24, v24, s25, s25
v_exp_f32 v25, v25
Mvav 236,144,140
Ta 172,2,16384
v_fma_f32 v25, v25, s25, s25
v_exp_f32 v26, v26
Mvav 240,148,136
LD 11,56,76,3072
Ta 174,2,18432
s_add_u32 m0, s67, 0x13000
Mvav 248,148,140
s_add_u32 s76, s12, 0x9000
Ta 176,3,16384
v_fma_f32 v26, v26, s25, s25
v_exp_f32 v27, v27
Mvav 244,152,136
Ta 178,3,18432
v_fma_f32 v27, v27, s25, s25
Mvav 252,152,140
s_waitcnt lgkmcnt(6)
Ta 144,4,16384
v_exp_f32 v28, v28
Mvav 224,156,144
Ta 146,4,18432
v_fma_f32 v28, v28, s25, s25
v_exp_f32 v29, v29
Mvav 232,156,148
Ta 148,5,16384
v_fma_f32 v29, v29, s25, s25
v_exp_f32 v30, v30
Mvav 228,160,144
LD 8,56,76,0
Ta 150,5,18432
Mvav 236,160,148
Ta 152,2,20480
v_fma_f32 v30, v30, s25, s25
v_exp_f32 v31, v31
Mvav 240,164,144
Ta 154,2,22528
v_fma_f32 v31, v31, s25, s25
Mvav 248,164,148
s_waitcnt lgkmcnt(6)
Ta 156,3,20480
v_exp_f32 v32, v32
v_exp_f32 v33, v33
Mvav 244,168,144
Ta 158,3,22528
v_fma_f32 v32, v32, s25, s25
v_fma_f32 v33, v33, s25, s25
Mvav 252,168,148
Ta 160,4,20480
v_exp_f32 v34, v34
Mvav 224,172,152
LD 9,56,76,1024
Ta 162,4,22528
v_fma_f32 v34, v34, s25, s25
Mvav 232,172,156
Ta 164,5,20480
v_exp_f32 v35, v35
Mvav 228,176,152
Ta 166,5,22528
v_fma_f32 v35, v35, s25, s25
Mvav 236,176,156
s_waitcnt lgkmcnt(6)
Ta 168,2,24576
v_rcp_f32 v20, v20
Mvav 240,144,152
Ta 170,2,26624
v_mul_f32 v20, v208, v20
v_rcp_f32 v21, v21
Mvav 248,144,156
Ta 172,3,24576
v_mul_f32 v21, v209, v21
v_rcp_f32 v22, v22
Mvav 244,148,152
LD 10,56,76,2048
Ta 174,3,26624
Mvav 252,148,156
Ta 176,4,24576
v_mul_f32 v22, v210, v22
v_rcp_f32 v23, v23
CV 184,20,21
Mvav 224,152,160
Ta 178,4,26624
v_mul_f32 v23, v211, v23
Mvav 232,152,164
s_waitcnt lgkmcnt(6)
Ta 144,5,24576
CV 185,22,23
v_rcp_f32 v24, v24
Mvav 228,156,160
Ta 146,5,26624
v_mul_f32 v24, v212, v24
Mvav 236,156,164
Ta 148,2,28672
v_rcp_f32 v25, v25
v_rcp_f32 v26, v26
Mvav 240,160,160
LD 11,56,76,3072
Ta 150,2,30720
s_add_u32 m0, s67, 0x14000
Mvav 248,160,164
s_add_u32 s76, s12, 0x12000
Ta 152,3,28672
v_mul_f32 v25, v213, v25
v_mul_f32 v26, v214, v26
Mvav 244,164,160
Ta 154,3,30720
CV 186,24,25
Mvav 252,164,164
s_waitcnt lgkmcnt(6)
Ta 156,4,28672
v_rcp_f32 v27, v27
v_rcp_f32 v28, v28
Mvav 224,168,168
Ta 158,4,30720
Ta 160,5,28672
Mvav 232,168,172
Ta 162,5,30720
Ta 164,2,32768
Mvav 228,172,168
LD 8,56,76,0
Ta 166,2,34816
Ta 168,3,32768
Mvav 236,172,172
s_add_u32 m0, s67, 0x1b000
Ta 170,3,34816
Ta 172,4,32768
Mvav 240,176,168
s_add_u32 s76, s12, 0x51000
Ta 174,4,34816
v_mul_f32 v27, v215, v27
v_mul_f32 v28, v216, v28
Mvav 248,176,172
s_waitcnt lgkmcnt(10)
Ta 176,5,32768
Ta 178,5,34816
Mvav 244,144,168
v_rcp_f32 v29, v29
v_rcp_f32 v30, v30
Mvav 252,144,172
v_rcp_f32 v31, v31
CV 187,26,27
Mvav 224,148,176
v_rcp_f32 v32, v32
v_mul_f32 v29, v217, v29
Mvav 232,148,180
v_rcp_f32 v33, v33
v_mul_f32 v30, v218, v30
Mvav 228,152,176
s_waitcnt vmcnt(19) lgkmcnt(0)
s_barrier
v_rcp_f32 v34, v34
v_rcp_f32 v35, v35
Mvav 236,152,180
v_mul_f32 v31, v219, v31
v_mul_f32 v32, v220, v32
v_mul_f32 v33, v221, v33
Mvav 240,156,176
v_mul_f32 v34, v222, v34
v_mul_f32 v35, v223, v35
CV 188,28,29
Mvav 248,156,180
CV 189,30,31
CV 190,32,33
CV 191,34,35
v_add_u32 v2, 0xfffe5000, v2
Mvav 244,160,176
Ta 144,2,0
Ta 146,2,2048
Mvav 252,160,180
Ta 160,2,4096
v_add_u32 v3, 0xfffe5000, v3
v_add_u32 v4, 0xfffe5000, v4
Mvav 224,164,184
Ta 148,3,0
Ta 150,3,2048
Mvav 232,164,188
Ta 152,4,0
Ta 154,4,2048
v_add_u32 v5, 0xfffe5000, v5
Mvav 228,168,184
Ta 156,5,0
Ta 158,5,2048
Mvav 236,168,188
Ta 162,2,6144
CV 224,224,225
CV 225,226,227
Mvav 240,172,184
Ta 164,3,4096
CV 226,228,229
CV 227,230,231
Mvav 248,172,188
buffer_store_dwordx4 v[224:227], v7, s[40:43], s78 offen sc1
Ta 166,3,6144
CV 232,232,233
Mvav 244,176,184
Ta 168,4,4096
CV 233,234,235
CV 234,236,237
Mvav 252,176,188
s_waitcnt lgkmcnt(8)
Ta 170,4,6144
CV 235,238,239
CV 240,240,241
v_mfma_f32_16x16x32_bf16 v[192:195], a[144:147], v[48:51], 0
Ta 172,5,4096
CV 241,242,243
v_mfma_f32_16x16x32_bf16 v[200:203], a[144:147], v[52:55], 0
buffer_store_dwordx4 v[232:235], v7, s[40:43], s78 offen offset:1024 sc1
Ta 174,5,6144
v_mfma_f32_16x16x32_bf16 v[196:199], a[148:151], v[48:51], 0
Ta 176,2,8192
CV 242,244,245
v_mfma_f32_16x16x32_bf16 v[204:207], a[148:151], v[52:55], 0
s_waitcnt lgkmcnt(7)
Ta 178,2,10240
CV 243,246,247
v_mfma_f32_16x16x32_bf16 v[208:211], a[152:155], v[48:51], 0
Ta 144,3,8192
CV 248,248,249
v_mfma_f32_16x16x32_bf16 v[216:219], a[152:155], v[52:55], 0
Ta 146,3,10240
CV 249,250,251
v_mfma_f32_16x16x32_bf16 v[212:215], a[156:159], v[48:51], 0
buffer_store_dwordx4 v[240:243], v7, s[40:43], s78 offen offset:2048 sc1
Ta 148,4,8192
v_mfma_f32_16x16x32_bf16 v[220:223], a[156:159], v[52:55], 0
Ta 150,4,10240
CV 250,252,253
CV 251,254,255
Mvav 192,160,56
Ta 152,5,8192
Mvav 200,160,60
s_waitcnt lgkmcnt(8)
Ta 154,5,10240
Mvav 196,164,56
Ta 156,2,12288
Mvav 204,164,60
buffer_store_dwordx4 v[248:251], v7, s[40:43], s78 offen offset:3072 sc1
Ta 158,2,14336
Mvav 208,168,56
s_mul_i32 s78, s16, 0x11000
Ta 160,3,12288
s_add_u32 s78, s78, s13
Mvav 216,168,60
s_waitcnt lgkmcnt(8)
s_add_u32 s78, s78, 0x4000
Ta 162,3,14336
Mvav 212,172,56
Ta 164,4,12288
Mvav 220,172,60
Ta 166,4,14336
Mvav 192,176,64
LD 8,56,76,0
Ta 168,5,12288
Mvav 200,176,68
s_waitcnt lgkmcnt(8)
Ta 170,5,14336
Mvav 196,144,64
Ta 172,2,16384
Mvav 204,144,68
Ta 174,2,18432
Mvav 208,148,64
LD 9,56,76,1024
Ta 176,3,16384
Mvav 216,148,68
s_waitcnt lgkmcnt(8)
Ta 178,3,18432
Mvav 212,152,64
Ta 144,4,16384
Mvav 220,152,68
Ta 146,4,18432
Mvav 192,156,72
LD 10,56,76,2048
Ta 148,5,16384
Mvav 200,156,76
s_waitcnt lgkmcnt(9)
Ta 150,5,18432
Mvav 196,160,72
Ta 152,2,20480
Mvav 204,160,76
s_waitcnt lgkmcnt(7)
Ta 154,2,22528
Mvav 208,164,72
LD 11,56,76,3072
Ta 156,3,20480
Mvav 216,164,76
s_add_u32 m0, s67, 0x1c000
s_add_u32 s76, s12, 0x5a000
Ta 158,3,22528
Mvav 212,168,72
Ta 160,4,20480
Mvav 220,168,76
Ta 162,4,22528
Mvav 192,172,80
LD 8,56,76,0
Ta 164,5,20480
Mvav 200,172,84
s_waitcnt lgkmcnt(9)
Ta 166,5,22528
Mvav 196,176,80
Ta 168,2,24576
Mvav 204,176,84
Ta 170,2,26624
Mvav 208,144,80
LD 9,56,76,1024
Ta 172,3,24576
Mvav 216,144,84
s_waitcnt lgkmcnt(9)
Ta 174,3,26624
Mvav 212,148,80
Ta 176,4,24576
Mvav 220,148,84
Ta 178,4,26624
Mvav 192,152,88
LD 10,56,76,2048
Ta 144,5,24576
Mvav 200,152,92
s_waitcnt lgkmcnt(9)
Ta 146,5,26624
Mvav 196,156,88
Ta 148,2,28672
Mvav 204,156,92
s_waitcnt lgkmcnt(7)
Ta 150,2,30720
Mvav 208,160,88
LD 11,56,76,3072
Ta 152,3,28672
Mvav 216,160,92
s_add_u32 m0, s67, 0x1d000
s_add_u32 s76, s12, 0x63000
Ta 154,3,30720
Mvav 212,164,88
s_add_u32 s12, s66, 4
Ta 156,4,28672
s_and_b32 s12, s12, 7
Mvav 220,164,92
s_lshl_b32 s12, s12, 7
Ta 158,4,30720
Ta 160,5,28672
Mvav 192,168,96
s_add_u32 s12, s12, s74
Ta 162,5,30720
Mvav 200,168,100
s_waitcnt lgkmcnt(9)
Ta 164,2,32768
Mvav 196,172,96
LD 8,56,76,0
Ta 166,2,34816
Mvav 204,172,100
s_add_u32 m0, s67, 0
Ta 168,3,32768
Ta 170,3,34816
Mvav 208,176,96
s_add_u32 s76, s23, 0
Ta 172,4,32768
Ta 174,4,34816
Mvav 216,176,100
s_waitcnt lgkmcnt(11)
Ta 176,5,32768
L_pg4_17:
s_cbranch_execz L_ret4
Ta 178,5,34816
Mvav 212,144,96
v_add_u32 v2, 0x9000, v2
v_add_u32 v3, 0x9000, v3
Mvav 220,144,100
v_add_u32 v4, 0x9000, v4
v_add_u32 v5, 0x9000, v5
Mvav 192,148,104
buffer_load_dwordx4 a[0:3], v6, s[40:43], s4 offen sc1
Mvav 200,148,108
s_waitcnt lgkmcnt(8)
Mvav 196,152,104
Mvav 204,152,108
Mvav 208,156,104
s_waitcnt vmcnt(23) lgkmcnt(0)
s_barrier
buffer_load_dwordx4 a[32:35], v6, s[40:43], s4 offen offset:256 sc1
Mvav 216,156,108
Ta 144,2,0
Mvav 212,160,104
Ta 146,2,2048
Mvav 220,160,108
Ta 148,3,0
Mvav 192,164,112
buffer_load_dwordx4 a[64:67], v6, s[40:43], s4 offen offset:2048 sc1
Ta 150,3,2048
Mvav 200,164,116
Ta 152,4,0
Mvav 196,168,112
Ta 154,4,2048
Mvav 204,168,116
Ta 156,5,0
Mvav 208,172,112
s_waitcnt vmcnt(12)
buffer_store_dword v47, off, s[40:43], s9 sc1
Ta 158,5,2048
Mvav 216,172,116
s_lshl_b32 s9, s94, 3
Ta 160,2,4096
s_add_u32 s9, s9, s16
Mvav 212,176,112
s_lshl_b32 s9, s9, 7
Ta 162,2,6144
s_add_u32 s9, s9, 0x3010010
Mvav 220,176,116
s_waitcnt lgkmcnt(8)
buffer_load_dwordx4 a[96:99], v6, s[40:43], s4 offen offset:2304 sc1
Ta 164,3,4096
Mvav 192,144,120
s_add_u32 s4, s19, 0x4000
Ta 166,3,6144
s_add_u32 s16, s66, 6
Mvav 200,144,124
s_waitcnt lgkmcnt(8)
s_and_b32 s16, s16, 7
Ta 168,4,4096
Mvav 196,148,120
s_waitcnt lgkmcnt(7)
Ta 170,4,6144
Mvav 204,148,124
LD 8,56,76,0
Ta 172,5,4096
Mvav 208,152,120
Ta 174,5,6144
Mvav 216,152,124
s_waitcnt lgkmcnt(8)
Ta 176,2,8192
Mvav 212,156,120
Ta 178,2,10240
Mvav 220,156,124
s_waitcnt lgkmcnt(8)
Ta 144,3,8192
Mvav 192,160,128
LD 9,56,76,1024
Ta 146,3,10240
Mvav 200,160,132
s_waitcnt lgkmcnt(8)
Ta 148,4,8192
Mvav 196,164,128
Ta 150,4,10240
Mvav 204,164,132
s_waitcnt lgkmcnt(8)
Ta 152,5,8192
Mvav 208,168,128
Ta 154,5,10240
Mvav 216,168,132
s_waitcnt lgkmcnt(8)
Ta 156,2,12288
Mvav 212,172,128
LD 10,56,76,2048
Ta 158,2,14336
Mvav 220,172,132
s_waitcnt lgkmcnt(8)
Ta 160,3,12288
Ta 162,3,14336
Mvav 192,176,136
Ta 164,4,12288
Mvav 200,176,140
s_waitcnt lgkmcnt(9)
Ta 166,4,14336
Mvav 196,144,136
Ta 168,5,12288
Mvav 204,144,140
s_waitcnt lgkmcnt(9)
Ta 170,5,14336
Mvav 208,148,136
LD 11,56,76,3072
Ta 172,2,16384
Mvav 216,148,140
s_waitcnt lgkmcnt(9)
s_add_u32 m0, s67, 0x1000
s_add_u32 s76, s23, 0x9000
Ta 174,2,18432
Mvav 212,152,136
Ta 176,3,16384
Mvav 220,152,140
s_waitcnt lgkmcnt(9)
Ta 178,3,18432
Mvav 192,156,144
Ta 144,4,16384
Mvav 200,156,148
s_waitcnt lgkmcnt(8)
Ta 146,4,18432
Mvav 196,160,144
LD 8,56,76,0
Ta 148,5,16384
Mvav 204,160,148
s_waitcnt lgkmcnt(8)
Ta 150,5,18432
Mvav 208,164,144
Ta 152,2,20480
Mvav 216,164,148
s_waitcnt lgkmcnt(9)
Ta 154,2,22528
Mvav 212,168,144
Ta 156,3,20480
Mvav 220,168,148
s_waitcnt lgkmcnt(8)
Ta 158,3,22528
Mvav 192,172,152
LD 9,56,76,1024
Ta 160,4,20480
Mvav 200,172,156
s_waitcnt lgkmcnt(8)
Ta 162,4,22528
Mvav 196,176,152
Ta 164,5,20480
Mvav 204,176,156
s_waitcnt lgkmcnt(9)
Ta 166,5,22528
Mvav 208,144,152
Ta 168,2,24576
Mvav 216,144,156
s_waitcnt lgkmcnt(8)
Ta 170,2,26624
Mvav 212,148,152
LD 10,56,76,2048
Ta 172,3,24576
Mvav 220,148,156
s_waitcnt lgkmcnt(8)
Ta 174,3,26624
Mvav 192,152,160
Ta 176,4,24576
Mvav 200,152,164
s_waitcnt lgkmcnt(9)
Ta 178,4,26624
Mvav 196,156,160
Ta 144,5,24576
Mvav 204,156,164
s_waitcnt lgkmcnt(8)
Ta 146,5,26624
Mvav 208,160,160
LD 11,56,76,3072
Ta 148,2,28672
Mvav 216,160,164
s_waitcnt lgkmcnt(8)
s_add_u32 m0, s67, 0x2000
s_add_u32 s76, s23, 0x12000
Ta 150,2,30720
Mvav 212,164,160
Ta 152,3,28672
Mvav 220,164,164
s_waitcnt lgkmcnt(9)
Ta 154,3,30720
Mvav 192,168,168
Ta 156,4,28672
Mvav 200,168,172
s_waitcnt lgkmcnt(8)
Ta 158,4,30720
Mvav 196,172,168
LD 8,56,76,0
Ta 160,5,28672
Mvav 204,172,172
s_waitcnt lgkmcnt(8)
s_add_u32 m0, s67, 0x9000
Ta 162,5,30720
Ta 164,2,32768
Mvav 208,176,168
s_add_u32 s76, s23, 0x51000
Ta 166,2,34816
Ta 168,3,32768
Mvav 216,176,172
s_waitcnt lgkmcnt(10)
Ta 170,3,34816
Ta 172,4,32768
Mvav 212,144,168
Ta 174,4,34816
Ta 176,5,32768
Mvav 220,144,172
s_waitcnt lgkmcnt(11)
Ta 178,5,34816
v_add_u32 v2, 0x9000, v2
v_add_u32 v3, 0x9000, v3
Mvav 192,148,176
v_add_u32 v4, 0x9000, v4
v_add_u32 v5, 0x9000, v5
Mvav 200,148,180
Mvav 196,152,176
Mvav 204,152,180
s_waitcnt lgkmcnt(7)
Mvav 208,156,176
Mvav 216,156,180
s_waitcnt lgkmcnt(0)
s_barrier
Mvav 212,160,176
Ta 144,2,0
Mvav 220,160,180
Ta 146,2,2048
Mvav 192,164,184
Ta 148,3,0
Mvav 200,164,188
Ta 150,3,2048
Mvav 196,168,184
Ta 152,4,0
Mvav 204,168,188
Ta 154,4,2048
Mvav 208,172,184
Ta 156,5,0
Mvav 216,172,188
Ta 158,5,2048
Mvav 212,176,184
Ta 160,2,4096
CV 196,196,197
Mvav 220,176,188
s_waitcnt lgkmcnt(7)
Ta 162,2,6144
CV 197,198,199
v_mfma_f32_16x16x32_bf16 v[224:227], a[144:147], v[48:51], 0
Ta 164,3,4096
CV 198,192,193
v_mfma_f32_16x16x32_bf16 v[232:235], a[144:147], v[52:55], 0
s_waitcnt lgkmcnt(7)
Ta 166,3,6144
CV 199,194,195
v_mfma_f32_16x16x32_bf16 v[228:231], a[148:151], v[48:51], 0
buffer_store_dwordx4 v[196:199], v7, s[40:43], s79 offen sc1
Ta 168,4,4096
v_mfma_f32_16x16x32_bf16 v[236:239], a[148:151], v[52:55], 0
s_waitcnt lgkmcnt(7)
Ta 170,4,6144
CV 204,204,205
v_mfma_f32_16x16x32_bf16 v[240:243], a[152:155], v[48:51], 0
Ta 172,5,4096
CV 205,206,207
v_mfma_f32_16x16x32_bf16 v[248:251], a[152:155], v[52:55], 0
s_waitcnt lgkmcnt(7)
Ta 174,5,6144
CV 206,200,201
v_mfma_f32_16x16x32_bf16 v[244:247], a[156:159], v[48:51], 0
s_waitcnt lgkmcnt(6)
Ta 176,2,8192
CV 207,202,203
v_mfma_f32_16x16x32_bf16 v[252:255], a[156:159], v[52:55], 0
buffer_store_dwordx4 v[204:207], v7, s[40:43], s79 offen offset:1024 sc1
Ta 178,2,10240
Mvav 224,160,56
Ta 144,3,8192
CV 212,212,213
Mvav 232,160,60
s_waitcnt lgkmcnt(7)
Ta 146,3,10240
CV 213,214,215
Mvav 228,164,56
Ta 148,4,8192
CV 214,208,209
Mvav 236,164,60
s_waitcnt lgkmcnt(7)
Ta 150,4,10240
CV 215,210,211
Mvav 240,168,56
buffer_store_dwordx4 v[212:215], v7, s[40:43], s79 offen offset:2048 sc1
Ta 152,5,8192
Mvav 248,168,60
s_waitcnt lgkmcnt(7)
Ta 154,5,10240
CV 220,220,221
Mvav 244,172,56
Ta 156,2,12288
CV 221,222,223
Mvav 252,172,60
s_waitcnt lgkmcnt(7)
Ta 158,2,14336
CV 222,216,217
Mvav 224,176,64
s_waitcnt lgkmcnt(6)
Ta 160,3,12288
CV 223,218,219
Mvav 232,176,68
buffer_store_dwordx4 v[220:223], v7, s[40:43], s79 offen offset:3072 sc1
Ta 162,3,14336
Mvav 228,144,64
s_mul_i32 s79, s17, 0x11000
Ta 164,4,12288
s_add_u32 s79, s79, s13
Mvav 236,144,68
s_waitcnt lgkmcnt(7)
s_add_u32 s79, s79, 0x5000
Ta 166,4,14336
Mvav 240,148,64
Ta 168,5,12288
Mvav 248,148,68
s_waitcnt lgkmcnt(7)
Ta 170,5,14336
Mvav 244,152,64
LD 8,56,76,0
Ta 172,2,16384
Mvav 252,152,68
s_waitcnt lgkmcnt(7)
Ta 174,2,18432
Ta 176,3,16384
Mvav 224,156,72
Ta 178,3,18432
Mvav 232,156,76
s_waitcnt lgkmcnt(8)
Ta 144,4,16384
Mvav 228,160,72
LD 9,56,76,1024
Ta 146,4,18432
Mvav 236,160,76
s_waitcnt lgkmcnt(8)
Ta 148,5,16384
Mvav 240,164,72
s_lshl_b32 s85, s30, 7
Ta 150,5,18432
s_add_u32 s85, s85, 0x4000
Mvav 248,164,76
s_waitcnt lgkmcnt(8)
s_getpc_b64 s[96:97]
Ta 152,2,20480
v_mov_b32 v46, s85
Mvav 244,168,72
LD 10,56,76,2048
Ta 154,2,22528
Mvav 252,168,76
s_waitcnt lgkmcnt(8)
Ta 156,3,20480
Mvav 224,172,80
Ta 158,3,22528
Mvav 232,172,84
s_waitcnt lgkmcnt(8)
Ta 160,4,20480
Mvav 228,176,80
LD 11,56,76,3072
Ta 162,4,22528
Mvav 236,176,84
s_waitcnt lgkmcnt(8)
s_add_u32 m0, s67, 0xa000
s_add_u32 s76, s23, 0x5a000
Ta 164,5,20480
Mvav 240,144,80
Ta 166,5,22528
Mvav 248,144,84
s_waitcnt lgkmcnt(8)
Ta 168,2,24576
Mvav 244,148,80
LD 8,56,76,0
Ta 170,2,26624
Mvav 252,148,84
s_waitcnt lgkmcnt(8)
Ta 172,3,24576
Mvav 224,152,88
Ta 174,3,26624
Mvav 232,152,92
s_waitcnt lgkmcnt(8)
Ta 176,4,24576
Mvav 228,156,88
LD 9,56,76,1024
Ta 178,4,26624
Mvav 236,156,92
s_waitcnt lgkmcnt(8)
Ta 144,5,24576
Mvav 240,160,88
Ta 146,5,26624
Mvav 248,160,92
s_waitcnt lgkmcnt(8)
Ta 148,2,28672
Mvav 244,164,88
LD 10,56,76,2048
Ta 150,2,30720
Mvav 252,164,92
s_waitcnt lgkmcnt(8)
Ta 152,3,28672
Mvav 224,168,96
Ta 154,3,30720
Mvav 232,168,100
s_waitcnt lgkmcnt(8)
Ta 156,4,28672
Mvav 228,172,96
LD 11,56,76,3072
Ta 158,4,30720
Mvav 236,172,100
s_waitcnt lgkmcnt(8)
s_add_u32 m0, s67, 0xb000
s_add_u32 s76, s23, 0x63000
Ta 160,5,28672
Mvav 240,176,96
s_add_u32 s23, s66, 5
Ta 162,5,30720
Ta 164,2,32768
Mvav 248,176,100
s_waitcnt lgkmcnt(9)
s_and_b32 s23, s23, 7
Ta 166,2,34816
Ta 168,3,32768
Mvav 244,144,96
LD 8,56,76,0
Ta 170,3,34816
Mvav 252,144,100
s_waitcnt lgkmcnt(10)
s_add_u32 m0, s67, 0x12000
Ta 172,4,32768
Ta 174,4,34816
Mvav 224,148,104
s_add_u32 s76, s12, 0
Ta 176,5,32768
Ta 178,5,34816
Mvav 232,148,108
s_waitcnt lgkmcnt(11)
s_lshl_b32 s23, s23, 7
v_add_u32 v2, 0x9000, v2
v_add_u32 v3, 0x9000, v3
Mvav 228,152,104
global_load_dword a252, v46, s[96:97]
v_add_u32 v4, 0x9000, v4
Mvav 236,152,108
s_waitcnt lgkmcnt(10)
s_add_u32 s23, s23, s74
v_add_u32 v5, 0x9000, v5
Mvav 240,156,104
Mvav 248,156,108
s_waitcnt lgkmcnt(7)
Mvav 244,160,104
Mvav 252,160,108
s_waitcnt vmcnt(28) lgkmcnt(0)
s_barrier
Mvav 224,164,112
Ta 144,2,0
Ta 146,2,2048
Mvav 232,164,116
Ta 148,3,0
Mvav 228,168,112
Ta 150,3,2048
Mvav 236,168,116
Ta 152,4,0
Mvav 240,172,112
Ta 154,4,2048
Mvav 248,172,116
Ta 156,5,0
Mvav 244,176,112
Ta 158,5,2048
Mvav 252,176,116
s_waitcnt lgkmcnt(6)
Ta 160,2,4096
Mvav 224,144,120
s_waitcnt vmcnt(10)
buffer_store_dword v47, off, s[40:43], s10 sc1
Ta 162,2,6144
Mvav 232,144,124
s_waitcnt lgkmcnt(6)
s_lshl_b32 s10, s94, 3
Ta 164,3,4096
s_add_u32 s10, s10, s17
Mvav 228,148,120
LD 8,56,76,0
Ta 166,3,6144
Mvav 236,148,124
s_waitcnt lgkmcnt(6)
s_lshl_b32 s10, s10, 7
Ta 168,4,4096
s_add_u32 s10, s10, 0x3010014
Mvav 240,152,120
s_add_u32 s17, s66, 7
Ta 170,4,6144
s_and_b32 s17, s17, 7
Mvav 248,152,124
s_waitcnt lgkmcnt(6)
Ta 172,5,4096
Mvav 244,156,120
Ta 174,5,6144
Mvav 252,156,124
s_waitcnt lgkmcnt(6)
Ta 176,2,8192
Mvav 224,160,128
LD 9,56,76,1024
Ta 178,2,10240
Mvav 232,160,132
s_waitcnt lgkmcnt(6)
Ta 144,3,8192
Mvav 228,164,128
Ta 146,3,10240
Mvav 236,164,132
s_waitcnt lgkmcnt(6)
Ta 148,4,8192
Mvav 240,168,128
Ta 150,4,10240
Mvav 248,168,132
s_waitcnt lgkmcnt(6)
Ta 152,5,8192
Mvav 244,172,128
LD 10,56,76,2048
Ta 154,5,10240
Mvav 252,172,132
s_waitcnt lgkmcnt(6)
Ta 156,2,12288
Mvav 224,176,136
Ta 158,2,14336
Mvav 232,176,140
s_waitcnt lgkmcnt(6)
Ta 160,3,12288
Mvav 228,144,136
Ta 162,3,14336
Mvav 236,144,140
s_waitcnt lgkmcnt(6)
Ta 164,4,12288
Mvav 240,148,136
LD 11,56,76,3072
Ta 166,4,14336
Mvav 248,148,140
s_waitcnt lgkmcnt(6)
s_add_u32 m0, s67, 0x13000
s_add_u32 s76, s12, 0x9000
Ta 168,5,12288
Mvav 244,152,136
Ta 170,5,14336
Mvav 252,152,140
s_waitcnt lgkmcnt(6)
Ta 172,2,16384
Mvav 224,156,144
Ta 174,2,18432
Mvav 232,156,148
s_waitcnt lgkmcnt(6)
Ta 176,3,16384
Mvav 228,160,144
LD 8,56,76,0
Ta 178,3,18432
Mvav 236,160,148
s_waitcnt lgkmcnt(6)
Ta 144,4,16384
Mvav 240,164,144
Ta 146,4,18432
Mvav 248,164,148
s_waitcnt lgkmcnt(6)
Ta 148,5,16384
Mvav 244,168,144
Ta 150,5,18432
L_pg4_18:
s_cbranch_execz L_ret4
Mvav 252,168,148
s_waitcnt lgkmcnt(6)
Ta 152,2,20480
Ta 154,2,22528
Mvav 224,172,152
LD 9,56,76,1024
Ta 156,3,20480
Mvav 232,172,156
s_waitcnt lgkmcnt(7)
Ta 158,3,22528
Mvav 228,176,152
Ta 160,4,20480
Mvav 236,176,156
s_waitcnt lgkmcnt(7)
Ta 162,4,22528
Mvav 240,144,152
Ta 164,5,20480
Mvav 248,144,156
s_waitcnt lgkmcnt(7)
Ta 166,5,22528
Mvav 244,148,152
LD 10,56,76,2048
Ta 168,2,24576
Mvav 252,148,156
s_waitcnt lgkmcnt(7)
Ta 170,2,26624
Mvav 224,152,160
Ta 172,3,24576
Mvav 232,152,164
s_waitcnt lgkmcnt(7)
Ta 174,3,26624
Mvav 228,156,160
Ta 176,4,24576
Mvav 236,156,164
s_waitcnt lgkmcnt(7)
Ta 178,4,26624
Mvav 240,160,160
LD 11,56,76,3072
Ta 144,5,24576
Mvav 248,160,164
s_waitcnt lgkmcnt(7)
s_add_u32 m0, s67, 0x14000
s_add_u32 s76, s12, 0x12000
Ta 146,5,26624
Mvav 244,164,160
Ta 148,2,28672
Mvav 252,164,164
s_waitcnt lgkmcnt(7)
Ta 150,2,30720
Mvav 224,168,168
Ta 152,3,28672
Mvav 232,168,172
s_waitcnt lgkmcnt(7)
Ta 154,3,30720
Mvav 228,172,168
LD 8,56,76,0
Ta 156,4,28672
Mvav 236,172,172
s_waitcnt lgkmcnt(7)
s_add_u32 m0, s67, 0x1b000
Ta 158,4,30720
Ta 160,5,28672
Mvav 240,176,168
s_add_u32 s76, s12, 0x51000
Ta 162,5,30720
Ta 164,2,32768
Mvav 248,176,172
s_waitcnt lgkmcnt(9)
Ta 166,2,34816
Ta 168,3,32768
Mvav 244,144,168
Ta 170,3,34816
Ta 172,4,32768
Mvav 252,144,172
s_waitcnt lgkmcnt(11)
Ta 174,4,34816
Ta 176,5,32768
Mvav 224,148,176
Ta 178,5,34816
v_add_u32 v2, 0xfffe5000, v2
Mvav 232,148,180
s_waitcnt lgkmcnt(12)
v_add_u32 v3, 0xfffe5000, v3
v_add_u32 v4, 0xfffe5000, v4
Mvav 228,152,176
v_add_u32 v5, 0xfffe5000, v5
Mvav 236,152,180
s_waitcnt lgkmcnt(9)
Mvav 240,156,176
Mvav 248,156,180
s_waitcnt lgkmcnt(7)
Mvav 244,160,176
Mvav 252,160,180
s_waitcnt lgkmcnt(0)
s_barrier
Mvav 224,164,184
Ta 144,2,0
Mvav 232,164,188
Ta 146,2,2048
Mvav 228,168,184
Ta 148,3,0
Mvav 236,168,188
Ta 150,3,2048
Mvav 240,172,184
Ta 152,4,0
CV 224,224,225
Mvav 248,172,188
Ta 154,4,2048
CV 225,226,227
Mvav 244,176,184
Ta 156,5,0
CV 226,228,229
Mvav 252,176,188
s_waitcnt lgkmcnt(5)
Ta 158,5,2048
Ta 160,2,4096
CV 227,230,231
v_mfma_f32_16x16x32_bf16 v[192:195], a[144:147], v[48:51], 0
buffer_store_dwordx4 v[224:227], v7, s[40:43], s80 offen sc1
Ta 162,2,6144
v_mfma_f32_16x16x32_bf16 v[200:203], a[144:147], v[52:55], 0
s_waitcnt lgkmcnt(6)
Ta 164,3,4096
CV 232,232,233
v_mfma_f32_16x16x32_bf16 v[196:199], a[148:151], v[48:51], 0
Ta 166,3,6144
CV 233,234,235
v_mfma_f32_16x16x32_bf16 v[204:207], a[148:151], v[52:55], 0
s_waitcnt lgkmcnt(6)
Ta 168,4,4096
CV 234,236,237
v_mfma_f32_16x16x32_bf16 v[208:211], a[152:155], v[48:51], 0
s_waitcnt lgkmcnt(5)
Ta 170,4,6144
CV 235,238,239
v_mfma_f32_16x16x32_bf16 v[216:219], a[152:155], v[52:55], 0
buffer_store_dwordx4 v[232:235], v7, s[40:43], s80 offen offset:1024 sc1
Ta 172,5,4096
v_mfma_f32_16x16x32_bf16 v[212:215], a[156:159], v[48:51], 0
Ta 174,5,6144
CV 240,240,241
v_mfma_f32_16x16x32_bf16 v[220:223], a[156:159], v[52:55], 0
s_waitcnt lgkmcnt(6)
Ta 176,2,8192
CV 241,242,243
Mvav 192,160,56
Ta 178,2,10240
CV 242,244,245
Mvav 200,160,60
s_waitcnt lgkmcnt(6)
Ta 144,3,8192
CV 243,246,247
Mvav 196,164,56
buffer_store_dwordx4 v[240:243], v7, s[40:43], s80 offen offset:2048 sc1
Ta 146,3,10240
Mvav 204,164,60
s_waitcnt lgkmcnt(6)
Ta 148,4,8192
CV 248,248,249
Mvav 208,168,56
Ta 150,4,10240
CV 249,250,251
Mvav 216,168,60
s_waitcnt lgkmcnt(6)
Ta 152,5,8192
CV 250,252,253
Mvav 212,172,56
s_waitcnt lgkmcnt(5)
Ta 154,5,10240
CV 251,254,255
Mvav 220,172,60
buffer_store_dwordx4 v[248:251], v7, s[40:43], s80 offen offset:3072 sc1
Ta 156,2,12288
Mvav 192,176,64
s_mul_i32 s80, s16, 0x11000
Ta 158,2,14336
s_add_u32 s80, s80, s13
Mvav 200,176,68
s_waitcnt lgkmcnt(6)
s_add_u32 s80, s80, 0x6000
Ta 160,3,12288
Mvav 196,144,64
Ta 162,3,14336
Mvav 204,144,68
s_waitcnt lgkmcnt(6)
Ta 164,4,12288
Mvav 208,148,64
LD 8,56,76,0
Ta 166,4,14336
Mvav 216,148,68
s_waitcnt lgkmcnt(6)
Ta 168,5,12288
Mvav 212,152,64
Ta 170,5,14336
Mvav 220,152,68
s_waitcnt lgkmcnt(6)
Ta 172,2,16384
Mvav 192,156,72
LD 9,56,76,1024
Ta 174,2,18432
Mvav 200,156,76
s_waitcnt lgkmcnt(6)
Ta 176,3,16384
Mvav 196,160,72
Ta 178,3,18432
Mvav 204,160,76
s_waitcnt lgkmcnt(6)
Ta 144,4,16384
Mvav 208,164,72
LD 10,56,76,2048
Ta 146,4,18432
Mvav 216,164,76
s_waitcnt lgkmcnt(6)
Ta 148,5,16384
Mvav 212,168,72
Ta 150,5,18432
Mvav 220,168,76
s_waitcnt lgkmcnt(6)
Ta 152,2,20480
Mvav 192,172,80
LD 11,56,76,3072
Ta 154,2,22528
Mvav 200,172,84
s_waitcnt lgkmcnt(6)
s_add_u32 m0, s67, 0x1c000
s_add_u32 s76, s12, 0x5a000
Ta 156,3,20480
Mvav 196,176,80
Ta 158,3,22528
Mvav 204,176,84
s_waitcnt lgkmcnt(6)
Ta 160,4,20480
Mvav 208,144,80
LD 8,56,76,0
Ta 162,4,22528
Mvav 216,144,84
s_waitcnt lgkmcnt(6)
Ta 164,5,20480
Mvav 212,148,80
Ta 166,5,22528
Mvav 220,148,84
s_waitcnt lgkmcnt(6)
Ta 168,2,24576
Ta 170,2,26624
Mvav 192,152,88
LD 9,56,76,1024
Ta 172,3,24576
Mvav 200,152,92
s_waitcnt lgkmcnt(7)
Ta 174,3,26624
Mvav 196,156,88
Ta 176,4,24576
Mvav 204,156,92
s_waitcnt lgkmcnt(7)
Ta 178,4,26624
Mvav 208,160,88
LD 10,56,76,2048
Ta 144,5,24576
Mvav 216,160,92
s_waitcnt lgkmcnt(7)
Ta 146,5,26624
Mvav 212,164,88
Ta 148,2,28672
Mvav 220,164,92
s_waitcnt lgkmcnt(7)
Ta 150,2,30720
Mvav 192,168,96
LD 11,56,76,3072
Ta 152,3,28672
Mvav 200,168,100
s_waitcnt lgkmcnt(7)
s_add_u32 m0, s67, 0x1d000
s_add_u32 s76, s12, 0x63000
Ta 154,3,30720
Mvav 196,172,96
s_add_u32 s12, s66, 6
Ta 156,4,28672
s_and_b32 s12, s12, 7
Mvav 204,172,100
s_waitcnt lgkmcnt(7)
s_lshl_b32 s12, s12, 7
Ta 158,4,30720
Ta 160,5,28672
Mvav 208,176,96
LD 8,56,76,0
Ta 162,5,30720
Mvav 216,176,100
s_waitcnt lgkmcnt(8)
s_add_u32 m0, s67, 0
Ta 164,2,32768
Ta 166,2,34816
Mvav 212,144,96
s_add_u32 s76, s23, 0
Ta 168,3,32768
Ta 170,3,34816
Mvav 220,144,100
s_waitcnt lgkmcnt(10)
s_add_u32 s12, s12, s74
Ta 172,4,32768
Ta 174,4,34816
Mvav 192,148,104
Ta 176,5,32768
Ta 178,5,34816
Mvav 200,148,108
s_waitcnt lgkmcnt(12)
v_add_u32 v2, 0x9000, v2
v_add_u32 v3, 0x9000, v3
Mvav 196,152,104
v_add_u32 v4, 0x9000, v4
v_add_u32 v5, 0x9000, v5
Mvav 204,152,108
s_waitcnt lgkmcnt(9)
Mvav 208,156,104
buffer_load_dword v17, v16, s[40:43], 0 offen sc1
Mvav 216,156,108
s_waitcnt lgkmcnt(7)
Mvav 212,160,104
Mvav 220,160,108
s_waitcnt vmcnt(25) lgkmcnt(0)
s_barrier
Mvav 192,164,112
Ta 144,2,0
Ta 146,2,2048
Mvav 200,164,116
Ta 148,3,0
Mvav 196,168,112
Ta 150,3,2048
Mvav 204,168,116
Ta 152,4,0
Mvav 208,172,112
Ta 154,4,2048
Mvav 216,172,116
Ta 156,5,0
Mvav 212,176,112
s_waitcnt vmcnt(10)
buffer_store_dword v47, off, s[40:43], s11 sc1
Ta 158,5,2048
Mvav 220,176,116
s_waitcnt lgkmcnt(6)
s_lshl_b32 s11, s94, 3
Ta 160,2,4096
s_add_u32 s11, s11, s16
Mvav 192,144,120
s_lshl_b32 s11, s11, 7
Ta 162,2,6144
s_add_u32 s11, s11, 0x3010018
Mvav 200,144,124
s_waitcnt lgkmcnt(6)
Ta 164,3,4096
Mvav 196,148,120
LD 8,56,76,0
Ta 166,3,6144
Mvav 204,148,124
s_waitcnt lgkmcnt(6)
Ta 168,4,4096
Mvav 208,152,120
Ta 170,4,6144
Mvav 216,152,124
s_waitcnt lgkmcnt(6)
Ta 172,5,4096
Mvav 212,156,120
Ta 174,5,6144
Mvav 220,156,124
s_waitcnt lgkmcnt(6)
Ta 176,2,8192
Ta 178,2,10240
Mvav 192,160,128
LD 9,56,76,1024
Ta 144,3,8192
Mvav 200,160,132
s_waitcnt lgkmcnt(7)
Ta 146,3,10240
Mvav 196,164,128
Ta 148,4,8192
Mvav 204,164,132
s_waitcnt lgkmcnt(7)
Ta 150,4,10240
Mvav 208,168,128
Ta 152,5,8192
Mvav 216,168,132
s_waitcnt lgkmcnt(7)
Ta 154,5,10240
Mvav 212,172,128
LD 10,56,76,2048
Ta 156,2,12288
Mvav 220,172,132
s_waitcnt lgkmcnt(7)
Ta 158,2,14336
Mvav 192,176,136
Ta 160,3,12288
Mvav 200,176,140
s_waitcnt lgkmcnt(7)
Ta 162,3,14336
Mvav 196,144,136
Ta 164,4,12288
Mvav 204,144,140
s_waitcnt lgkmcnt(7)
Ta 166,4,14336
Mvav 208,148,136
LD 11,56,76,3072
Ta 168,5,12288
Mvav 216,148,140
s_waitcnt lgkmcnt(7)
s_add_u32 m0, s67, 0x1000
s_add_u32 s76, s23, 0x9000
Ta 170,5,14336
Mvav 212,152,136
Ta 172,2,16384
Mvav 220,152,140
s_waitcnt lgkmcnt(7)
Ta 174,2,18432
Mvav 192,156,144
Ta 176,3,16384
Mvav 200,156,148
s_waitcnt lgkmcnt(7)
Ta 178,3,18432
Mvav 196,160,144
LD 8,56,76,0
Ta 144,4,16384
Mvav 204,160,148
s_waitcnt lgkmcnt(7)
Ta 146,4,18432
Mvav 208,164,144
Ta 148,5,16384
Mvav 216,164,148
s_waitcnt lgkmcnt(7)
Ta 150,5,18432
Mvav 212,168,144
Ta 152,2,20480
Mvav 220,168,148
s_waitcnt lgkmcnt(7)
Ta 154,2,22528
Mvav 192,172,152
LD 9,56,76,1024
Ta 156,3,20480
Mvav 200,172,156
s_waitcnt lgkmcnt(7)
Ta 158,3,22528
Mvav 196,176,152
Ta 160,4,20480
Mvav 204,176,156
s_waitcnt lgkmcnt(7)
Ta 162,4,22528
Mvav 208,144,152
Ta 164,5,20480
Mvav 216,144,156
s_waitcnt lgkmcnt(7)
Ta 166,5,22528
Mvav 212,148,152
LD 10,56,76,2048
Ta 168,2,24576
Mvav 220,148,156
Ta 170,2,26624
s_waitcnt vmcnt(8)
v_cmp_ne_u32 vcc, s98, v17
s_cbranch_vccnz L_spin54
L_pollok54:
s_waitcnt lgkmcnt(8)
Mvav 192,152,160
Ta 172,3,24576
v_mov_b32 v16, 0
Mvav 200,152,164
s_waitcnt lgkmcnt(7)
Ta 174,3,26624
v_lshlrev_b32 v17, 7, s14
Mvav 196,156,160
buffer_load_dwordx4 a[4:7], v7, s[40:43], s5 offen sc1
Ta 176,4,24576
Mvav 204,156,164
s_waitcnt lgkmcnt(7)
Ta 178,4,26624
v_lshl_add_u32 v16, v16, 2, v17
Mvav 208,160,160
Ta 144,5,24576
v_add_u32 v16, 0x3010008, v16
Mvav 216,160,164
s_waitcnt lgkmcnt(7)
Ta 146,5,26624
Mvav 212,164,160
buffer_load_dwordx4 a[36:39], v7, s[40:43], s5 offen offset:1024 sc1
Ta 148,2,28672
Mvav 220,164,164
s_waitcnt lgkmcnt(7)
Ta 150,2,30720
Ta 152,3,28672
Mvav 192,168,168
Ta 154,3,30720
Mvav 200,168,172
s_waitcnt lgkmcnt(8)
Ta 156,4,28672
Mvav 196,172,168
buffer_load_dwordx4 a[68:71], v7, s[40:43], s5 offen offset:2048 sc1
Ta 158,4,30720
Mvav 204,172,172
s_waitcnt lgkmcnt(8)
Ta 160,5,28672
Ta 162,5,30720
Mvav 208,176,168
Ta 164,2,32768
Ta 166,2,34816
Mvav 216,176,172
s_waitcnt lgkmcnt(10)
Ta 168,3,32768
Ta 170,3,34816
Mvav 212,144,168
buffer_load_dwordx4 a[100:103], v7, s[40:43], s5 offen offset:3072 sc1
Ta 172,4,32768
Mvav 220,144,172
s_waitcnt lgkmcnt(10)
s_add_u32 s5, s19, 0x5000
Ta 174,4,34816
Ta 176,5,32768
Mvav 192,148,176
Ta 178,5,34816
v_add_u32 v2, 0x9000, v2
Mvav 200,148,180
s_waitcnt lgkmcnt(11)
v_add_u32 v3, 0x9000, v3
v_add_u32 v4, 0x9000, v4
Mvav 196,152,176
LD 11,56,76,3072
v_add_u32 v5, 0x9000, v5
Mvav 204,152,180
s_waitcnt lgkmcnt(9)
s_add_u32 m0, s67, 0x2000
s_add_u32 s76, s23, 0x12000
Mvav 208,156,176
Mvav 216,156,180
s_waitcnt lgkmcnt(6)
Mvav 212,160,176
LD 8,56,76,0
s_waitcnt lgkmcnt(0)
s_barrier
Mvav 220,160,180
s_add_u32 m0, s67, 0x9000
s_add_u32 s76, s23, 0x51000
Ta 144,2,0
Mvav 192,164,184
Ta 146,2,2048
Mvav 200,164,188
Ta 148,3,0
Mvav 196,168,184
Ta 150,3,2048
Mvav 204,168,188
Ta 152,4,0
Mvav 208,172,184
Ta 154,4,2048
Mvav 216,172,188
Ta 156,5,0
Mvav 212,176,184
Ta 158,5,2048
CV 196,196,197
Mvav 220,176,188
s_waitcnt lgkmcnt(6)
Ta 160,2,4096
CV 197,198,199
v_mfma_f32_16x16x32_bf16 v[224:227], a[144:147], v[48:51], 0
Ta 162,2,6144
CV 198,192,193
v_mfma_f32_16x16x32_bf16 v[232:235], a[144:147], v[52:55], 0
s_waitcnt lgkmcnt(6)
Ta 164,3,4096
CV 199,194,195
v_mfma_f32_16x16x32_bf16 v[228:231], a[148:151], v[48:51], 0
L_pg4_19:
s_cbranch_execz L_ret4
buffer_store_dwordx4 v[196:199], v7, s[40:43], s81 offen sc1
Ta 166,3,6144
v_mfma_f32_16x16x32_bf16 v[236:239], a[148:151], v[52:55], 0
s_waitcnt lgkmcnt(6)
Ta 168,4,4096
CV 204,204,205
v_mfma_f32_16x16x32_bf16 v[240:243], a[152:155], v[48:51], 0
Ta 170,4,6144
CV 205,206,207
v_mfma_f32_16x16x32_bf16 v[248:251], a[152:155], v[52:55], 0
s_waitcnt lgkmcnt(6)
Ta 172,5,4096
CV 206,200,201
v_mfma_f32_16x16x32_bf16 v[244:247], a[156:159], v[48:51], 0
s_waitcnt lgkmcnt(5)
Ta 174,5,6144
CV 207,202,203
v_mfma_f32_16x16x32_bf16 v[252:255], a[156:159], v[52:55], 0
buffer_store_dwordx4 v[204:207], v7, s[40:43], s81 offen offset:1024 sc1
Ta 176,2,8192
Mvav 224,160,56
Ta 178,2,10240
CV 212,212,213
Mvav 232,160,60
s_waitcnt lgkmcnt(6)
Ta 144,3,8192
CV 213,214,215
Mvav 228,164,56
Ta 146,3,10240
CV 214,208,209
Mvav 236,164,60
s_waitcnt lgkmcnt(6)
Ta 148,4,8192
CV 215,210,211
Mvav 240,168,56
buffer_store_dwordx4 v[212:215], v7, s[40:43], s81 offen offset:2048 sc1
Ta 150,4,10240
Mvav 248,168,60
s_waitcnt lgkmcnt(6)
Ta 152,5,8192
CV 220,220,221
Mvav 244,172,56
Ta 154,5,10240
CV 221,222,223
Mvav 252,172,60
s_waitcnt lgkmcnt(6)
Ta 156,2,12288
Ta 158,2,14336
Mvav 224,176,64
s_waitcnt lgkmcnt(6)
Ta 160,3,12288
CV 222,216,217
Mvav 232,176,68
LD 8,56,76,0
Ta 162,3,14336
Mvav 228,144,64
Ta 164,4,12288
CV 223,218,219
Mvav 236,144,68
s_waitcnt lgkmcnt(7)
Ta 166,4,14336
Mvav 240,148,64
s_waitcnt lgkmcnt(6)
Ta 168,5,12288
Mvav 248,148,68
buffer_store_dwordx4 v[220:223], v7, s[40:43], s81 offen offset:3072 sc1
Ta 170,5,14336
Mvav 244,152,64
s_mul_i32 s81, s17, 0x11000
Ta 172,2,16384
s_add_u32 s81, s81, s13
Mvav 252,152,68
s_waitcnt lgkmcnt(7)
s_add_u32 s81, s81, 0x7000
Ta 174,2,18432
Mvav 224,156,72
Ta 176,3,16384
Mvav 232,156,76
s_waitcnt lgkmcnt(7)
Ta 178,3,18432
Mvav 228,160,72
LD 9,56,76,1024
Ta 144,4,16384
Mvav 236,160,76
s_waitcnt lgkmcnt(7)
Ta 146,4,18432
Mvav 240,164,72
s_lshl_b32 s85, s30, 7
Ta 148,5,16384
s_add_u32 s85, s85, 0x4000
Mvav 248,164,76
s_waitcnt lgkmcnt(7)
s_getpc_b64 s[96:97]
Ta 150,5,18432
v_mov_b32 v46, s85
Mvav 244,168,72
LD 10,56,76,2048
Ta 152,2,20480
Mvav 252,168,76
s_waitcnt lgkmcnt(7)
Ta 154,2,22528
Mvav 224,172,80
Ta 156,3,20480
Mvav 232,172,84
s_waitcnt lgkmcnt(7)
Ta 158,3,22528
Mvav 228,176,80
LD 11,56,76,3072
Ta 160,4,20480
Mvav 236,176,84
s_waitcnt lgkmcnt(7)
s_add_u32 m0, s67, 0xa000
s_add_u32 s76, s23, 0x5a000
Ta 162,4,22528
Mvav 240,144,80
Ta 164,5,20480
Mvav 248,144,84
s_waitcnt lgkmcnt(7)
Ta 166,5,22528
Mvav 244,148,80
LD 8,56,76,0
Ta 168,2,24576
Mvav 252,148,84
s_waitcnt lgkmcnt(7)
Ta 170,2,26624
Mvav 224,152,88
Ta 172,3,24576
Mvav 232,152,92
s_waitcnt lgkmcnt(7)
Ta 174,3,26624
Mvav 228,156,88
LD 9,56,76,1024
Ta 176,4,24576
Mvav 236,156,92
s_waitcnt lgkmcnt(7)
Ta 178,4,26624
Mvav 240,160,88
Ta 144,5,24576
Mvav 248,160,92
s_waitcnt lgkmcnt(7)
Ta 146,5,26624
Mvav 244,164,88
LD 10,56,76,2048
Ta 148,2,28672
Mvav 252,164,92
s_waitcnt lgkmcnt(7)
Ta 150,2,30720
Mvav 224,168,96
Ta 152,3,28672
Mvav 232,168,100
s_waitcnt lgkmcnt(7)
Ta 154,3,30720
Mvav 228,172,96
LD 11,56,76,3072
Ta 156,4,28672
Mvav 236,172,100
s_waitcnt lgkmcnt(7)
s_add_u32 m0, s67, 0xb000
s_add_u32 s76, s23, 0x63000
Ta 158,4,30720
Mvav 240,176,96
s_add_u32 s23, s66, 7
Ta 160,5,28672
Ta 162,5,30720
Mvav 248,176,100
s_waitcnt lgkmcnt(8)
s_and_b32 s23, s23, 7
Ta 164,2,32768
Ta 166,2,34816
Mvav 244,144,96
LD 8,56,76,0
Ta 168,3,32768
Mvav 252,144,100
s_waitcnt lgkmcnt(9)
s_add_u32 m0, s67, 0x12000
Ta 170,3,34816
Ta 172,4,32768
Mvav 224,148,104
s_add_u32 s76, s12, 0
Ta 174,4,34816
Ta 176,5,32768
Mvav 232,148,108
s_waitcnt lgkmcnt(11)
s_lshl_b32 s23, s23, 7
Ta 178,5,34816
v_add_u32 v2, 0x9000, v2
Mvav 228,152,104
global_load_dword a252, v46, s[96:97]
v_add_u32 v3, 0x9000, v3
Mvav 236,152,108
s_waitcnt lgkmcnt(10)
s_add_u32 s23, s23, s74
v_add_u32 v4, 0x9000, v4
v_add_u32 v5, 0x9000, v5
Mvav 240,156,104
buffer_load_dword v17, v16, s[40:43], 0 offen sc1
Mvav 248,156,108
s_waitcnt lgkmcnt(8)
Mvav 244,160,104
Mvav 252,160,108
s_waitcnt lgkmcnt(5)
Mvav 224,164,112
s_waitcnt lgkmcnt(0)
s_barrier
Mvav 232,164,116
Ta 144,2,0
Ta 146,2,2048
Mvav 228,168,112
Ta 148,3,0
Ta 150,3,2048
Mvav 236,168,116
Ta 152,4,0
Mvav 240,172,112
Ta 154,4,2048
Mvav 248,172,116
Ta 156,5,0
Mvav 244,176,112
Ta 158,5,2048
Mvav 252,176,116
s_waitcnt lgkmcnt(6)
Ta 160,2,4096
Ta 162,2,6144
Mvav 224,144,120
Ta 164,3,4096
Mvav 232,144,124
s_waitcnt lgkmcnt(7)
Ta 166,3,6144
Mvav 228,148,120
LD 8,56,76,0
Ta 168,4,4096
Mvav 236,148,124
s_waitcnt lgkmcnt(7)
Ta 170,4,6144
Mvav 240,152,120
Ta 172,5,4096
Mvav 248,152,124
s_waitcnt lgkmcnt(7)
Ta 174,5,6144
Mvav 244,156,120
s_waitcnt vmcnt(11)
buffer_store_dword v47, off, s[40:43], s8 sc1
Ta 176,2,8192
Mvav 252,156,124
s_waitcnt lgkmcnt(7)
s_lshl_b32 s8, s94, 3
Ta 178,2,10240
s_add_u32 s8, s8, s17
Mvav 224,160,128
LD 9,56,76,1024
Ta 144,3,8192
Mvav 232,160,132
s_waitcnt lgkmcnt(7)
s_lshl_b32 s8, s8, 7
Ta 146,3,10240
s_add_u32 s8, s8, 0x301001c
Mvav 228,164,128
Ta 148,4,8192
Mvav 236,164,132
s_waitcnt lgkmcnt(7)
Ta 150,4,10240
Mvav 240,168,128
Ta 152,5,8192
Mvav 248,168,132
s_waitcnt lgkmcnt(7)
Ta 154,5,10240
Mvav 244,172,128
LD 10,56,76,2048
Ta 156,2,12288
Mvav 252,172,132
s_waitcnt lgkmcnt(7)
Ta 158,2,14336
Mvav 224,176,136
Ta 160,3,12288
Mvav 232,176,140
s_waitcnt lgkmcnt(7)
Ta 162,3,14336
Mvav 228,144,136
Ta 164,4,12288
Mvav 236,144,140
s_waitcnt lgkmcnt(7)
Ta 166,4,14336
Mvav 240,148,136
LD 11,56,76,3072
Ta 168,5,12288
Mvav 248,148,140
s_waitcnt lgkmcnt(7)
s_add_u32 m0, s67, 0x13000
s_add_u32 s76, s12, 0x9000
Ta 170,5,14336
Mvav 244,152,136
Ta 172,2,16384
Mvav 252,152,140
s_waitcnt lgkmcnt(7)
Ta 174,2,18432
Ta 176,3,16384
Mvav 224,156,144
Ta 178,3,18432
Mvav 232,156,148
s_waitcnt lgkmcnt(8)
Ta 144,4,16384
Mvav 228,160,144
LD 8,56,76,0
Ta 146,4,18432
Mvav 236,160,148
s_waitcnt lgkmcnt(8)
Ta 148,5,16384
Mvav 240,164,144
Ta 150,5,18432
Mvav 248,164,148
s_waitcnt lgkmcnt(8)
Ta 152,2,20480
Mvav 244,168,144
Ta 154,2,22528
Mvav 252,168,148
s_waitcnt lgkmcnt(8)
Ta 156,3,20480
Mvav 224,172,152
LD 9,56,76,1024
Ta 158,3,22528
Mvav 232,172,156
s_waitcnt lgkmcnt(8)
Ta 160,4,20480
Mvav 228,176,152
Ta 162,4,22528
Mvav 236,176,156
s_waitcnt lgkmcnt(8)
Ta 164,5,20480
Mvav 240,144,152
Ta 166,5,22528
Mvav 248,144,156
Ta 168,2,24576
s_waitcnt vmcnt(7)
v_cmp_ne_u32 vcc, s98, v17
s_cbranch_vccnz L_spin55
L_pollok55:
s_waitcnt lgkmcnt(9)
Mvav 244,148,152
LD 10,56,76,2048
Ta 170,2,26624
Mvav 252,148,156
s_waitcnt lgkmcnt(8)
Ta 172,3,24576
v_mov_b32 v16, 0
Mvav 224,152,160
Ta 174,3,26624
v_lshlrev_b32 v17, 7, s14
Mvav 232,152,164
s_waitcnt lgkmcnt(8)
Ta 176,4,24576
v_lshl_add_u32 v16, v16, 2, v17
Mvav 228,156,160
buffer_load_dwordx4 a[8:11], v7, s[40:43], s6 offen sc1
Ta 178,4,26624
Mvav 236,156,164
s_waitcnt lgkmcnt(8)
Ta 144,5,24576
v_add_u32 v16, 0x301000c, v16
Mvav 240,160,160
Ta 146,5,26624
Mvav 248,160,164
s_waitcnt lgkmcnt(8)
Ta 148,2,28672
Mvav 244,164,160
buffer_load_dwordx4 a[40:43], v7, s[40:43], s6 offen offset:1024 sc1
Ta 150,2,30720
Mvav 252,164,164
s_waitcnt lgkmcnt(8)
Ta 152,3,28672
Mvav 224,168,168
Ta 154,3,30720
Mvav 232,168,172
s_waitcnt lgkmcnt(8)
Ta 156,4,28672
Mvav 228,172,168
buffer_load_dwordx4 a[72:75], v7, s[40:43], s6 offen offset:2048 sc1
Ta 158,4,30720
Mvav 236,172,172
s_waitcnt lgkmcnt(8)
Ta 160,5,28672
Ta 162,5,30720
Mvav 240,176,168
Ta 164,2,32768
Ta 166,2,34816
Mvav 248,176,172
s_waitcnt lgkmcnt(10)
Ta 168,3,32768
Ta 170,3,34816
Mvav 244,144,168
buffer_load_dwordx4 a[104:107], v7, s[40:43], s6 offen offset:3072 sc1
Ta 172,4,32768
Mvav 252,144,172
s_waitcnt lgkmcnt(10)
s_add_u32 s6, s19, 0xe000
Ta 174,4,34816
Ta 176,5,32768
Mvav 224,148,176
Ta 178,5,34816
v_add_u32 v2, 0xfffe5000, v2
Mvav 232,148,180
s_waitcnt lgkmcnt(11)
v_add_u32 v3, 0xfffe5000, v3
v_add_u32 v4, 0xfffe5000, v4
Mvav 228,152,176
LD 11,56,76,3072
v_add_u32 v5, 0xfffe5000, v5
Mvav 236,152,180
s_waitcnt lgkmcnt(9)
s_add_u32 m0, s67, 0x14000
s_add_u32 s76, s12, 0x12000
Mvav 240,156,176
Mvav 248,156,180
s_waitcnt lgkmcnt(6)
Mvav 244,160,176
LD 8,56,76,0
s_waitcnt lgkmcnt(0)
s_barrier
Mvav 252,160,180
s_add_u32 m0, s67, 0x1b000
s_add_u32 s76, s12, 0x51000
Ta 144,2,0
Mvav 224,164,184
Ta 146,2,2048
Ta 148,3,0
Mvav 232,164,188
Ta 150,3,2048
Mvav 228,168,184
Ta 152,4,0
Mvav 236,168,188
Ta 154,4,2048
CV 224,224,225
Mvav 240,172,184
Ta 156,5,0
CV 225,226,227
Mvav 248,172,188
Ta 158,5,2048
CV 226,228,229
Mvav 244,176,184
s_waitcnt lgkmcnt(6)
Ta 160,2,4096
CV 227,230,231
Mvav 252,176,188
buffer_store_dwordx4 v[224:227], v7, s[40:43], s78 offen sc1
Ta 162,2,6144
v_mfma_f32_16x16x32_bf16 v[192:195], a[144:147], v[48:51], 0
Ta 164,3,4096
CV 232,232,233
v_mfma_f32_16x16x32_bf16 v[200:203], a[144:147], v[52:55], 0
s_waitcnt lgkmcnt(7)
Ta 166,3,6144
CV 233,234,235
v_mfma_f32_16x16x32_bf16 v[196:199], a[148:151], v[48:51], 0
Ta 168,4,4096
CV 234,236,237
v_mfma_f32_16x16x32_bf16 v[204:207], a[148:151], v[52:55], 0
s_waitcnt lgkmcnt(7)
Ta 170,4,6144
CV 235,238,239
v_mfma_f32_16x16x32_bf16 v[208:211], a[152:155], v[48:51], 0
buffer_store_dwordx4 v[232:235], v7, s[40:43], s78 offen offset:1024 sc1
Ta 172,5,4096
v_mfma_f32_16x16x32_bf16 v[216:219], a[152:155], v[52:55], 0
s_waitcnt lgkmcnt(7)
Ta 174,5,6144
CV 240,240,241
v_mfma_f32_16x16x32_bf16 v[212:215], a[156:159], v[48:51], 0
Ta 176,2,8192
CV 241,242,243
v_mfma_f32_16x16x32_bf16 v[220:223], a[156:159], v[52:55], 0
s_waitcnt lgkmcnt(7)
Ta 178,2,10240
CV 242,244,245
Mvav 192,160,56
s_waitcnt lgkmcnt(6)
Ta 144,3,8192
CV 243,246,247
Mvav 200,160,60
buffer_store_dwordx4 v[240:243], v7, s[40:43], s78 offen offset:2048 sc1
Ta 146,3,10240
Mvav 196,164,56
Ta 148,4,8192
CV 248,248,249
Mvav 204,164,60
s_waitcnt lgkmcnt(7)
Ta 150,4,10240
CV 249,250,251
Mvav 208,168,56
Ta 152,5,8192
CV 250,252,253
Mvav 216,168,60
s_waitcnt lgkmcnt(7)
Ta 154,5,10240
CV 251,254,255
Mvav 212,172,56
buffer_store_dwordx4 v[248:251], v7, s[40:43], s78 offen offset:3072 sc1
Ta 156,2,12288
Mvav 220,172,60
s_waitcnt lgkmcnt(7)
Ta 158,2,14336
Mvav 192,176,64
Ta 160,3,12288
Mvav 200,176,68
s_waitcnt lgkmcnt(7)
Ta 162,3,14336
Mvav 196,144,64
s_waitcnt lgkmcnt(6)
Ta 164,4,12288
Mvav 204,144,68
LD 8,56,76,0
Ta 166,4,14336
Mvav 208,148,64
Ta 168,5,12288
Mvav 216,148,68
s_waitcnt lgkmcnt(7)
Ta 170,5,14336
Mvav 212,152,64
s_waitcnt lgkmcnt(6)
Ta 172,2,16384
Mvav 220,152,68
LD 9,56,76,1024
Ta 174,2,18432
Mvav 192,156,72
Ta 176,3,16384
Mvav 200,156,76
s_waitcnt lgkmcnt(7)
Ta 178,3,18432
Mvav 196,160,72
s_waitcnt lgkmcnt(6)
Ta 144,4,16384
Mvav 204,160,76
LD 10,56,76,2048
Ta 146,4,18432
Mvav 208,164,72
Ta 148,5,16384
Mvav 216,164,76
s_waitcnt lgkmcnt(7)
Ta 150,5,18432
Mvav 212,168,72
s_waitcnt lgkmcnt(6)
Ta 152,2,20480
Mvav 220,168,76
LD 11,56,76,3072
Ta 154,2,22528
s_add_u32 m0, s67, 0x1c000
Mvav 192,172,80
s_add_u32 s76, s12, 0x5a000
Ta 156,3,20480
Mvav 200,172,84
s_waitcnt lgkmcnt(7)
Ta 158,3,22528
Mvav 196,176,80
s_waitcnt lgkmcnt(6)
Ta 160,4,20480
Mvav 204,176,84
LD 8,56,76,0
Ta 162,4,22528
Mvav 208,144,80
Ta 164,5,20480
Mvav 216,144,84
s_waitcnt lgkmcnt(7)
Ta 166,5,22528
Mvav 212,148,80
s_waitcnt lgkmcnt(6)
Ta 168,2,24576
Mvav 220,148,84
LD 9,56,76,1024
L_pg4_20:
s_cbranch_execz L_ret4
Ta 170,2,26624
Mvav 192,152,88
Ta 172,3,24576
Mvav 200,152,92
s_waitcnt lgkmcnt(7)
Ta 174,3,26624
Mvav 196,156,88
s_waitcnt lgkmcnt(6)
Ta 176,4,24576
Mvav 204,156,92
LD 10,56,76,2048
Ta 178,4,26624
Mvav 208,160,88
Ta 144,5,24576
Mvav 216,160,92
s_waitcnt lgkmcnt(7)
Ta 146,5,26624
Mvav 212,164,88
s_waitcnt lgkmcnt(6)
Ta 148,2,28672
Mvav 220,164,92
LD 11,56,76,3072
Ta 150,2,30720
Mvav 192,168,96
s_add_u32 m0, s67, 0x1d000
s_add_u32 s76, s12, 0x63000
Ta 152,3,28672
Mvav 200,168,100
s_waitcnt lgkmcnt(7)
s_add_u32 s12, s66, 8
Ta 154,3,30720
s_and_b32 s12, s12, 7
Mvav 196,172,96
s_lshl_b32 s12, s12, 7
Ta 156,4,28672
s_add_u32 s12, s12, s74
Mvav 204,172,100
s_waitcnt lgkmcnt(7)
LD 8,56,76,0
Ta 158,4,30720
Mvav 208,176,96
s_add_u32 m0, s67, 0
Ta 160,5,28672
Ta 162,5,30720
Mvav 216,176,100
s_waitcnt lgkmcnt(8)
s_add_u32 s76, s23, 0
Ta 164,2,32768
Ta 166,2,34816
Mvav 212,144,96
Ta 168,3,32768
Ta 170,3,34816
Mvav 220,144,100
s_waitcnt lgkmcnt(10)
Ta 172,4,32768
Ta 174,4,34816
Mvav 192,148,104
Ta 176,5,32768
Ta 178,5,34816
Mvav 200,148,108
s_waitcnt lgkmcnt(12)
v_add_u32 v2, 0x9000, v2
v_add_u32 v3, 0x9000, v3
Mvav 196,152,104
v_add_u32 v4, 0x9000, v4
v_add_u32 v5, 0x9000, v5
Mvav 204,152,108
s_waitcnt lgkmcnt(10)
Mvav 208,156,104
buffer_load_dword v17, v16, s[40:43], 0 offen sc1
Mvav 216,156,108
s_mov_b64 exec, 0
s_cmp_eq_u32 s64, 0
s_cbranch_scc1 L_pg5_21
s_cmp_eq_u32 s64, 1
s_cbranch_scc1 L_pg5_22
s_cmp_eq_u32 s64, 2
s_cbranch_scc1 L_pg5_23
s_branch L_ret5
L_ret5:
s_mov_b64 exec, -1
s_waitcnt lgkmcnt(7)
Mvav 212,160,104
Mvav 220,160,108
s_waitcnt lgkmcnt(0)
s_barrier
Mvav 192,164,112
Ta 144,2,0
Mvav 200,164,116
Ta 146,2,2048
Mvav 196,168,112
Ta 148,3,0
Mvav 204,168,116
Ta 150,3,2048
Mvav 208,172,112
Ta 152,4,0
Mvav 216,172,116
s_waitcnt vmcnt(10)
buffer_store_dword v47, off, s[40:43], s9 sc1
Ta 154,4,2048
Mvav 212,176,112
s_mov_b32 s9, 0x300f000
Ta 156,5,0
Mvav 220,176,116
s_waitcnt lgkmcnt(5)
Ta 158,5,2048
Ta 160,2,4096
Mvav 192,144,120
Ta 162,2,6144
Mvav 200,144,124
s_waitcnt lgkmcnt(6)
Ta 164,3,4096
Mvav 196,148,120
LD 8,56,76,0
Ta 166,3,6144
Mvav 204,148,124
s_waitcnt lgkmcnt(6)
Ta 168,4,4096
Ta 170,4,6144
Mvav 208,152,120
Ta 172,5,4096
Mvav 216,152,124
s_waitcnt lgkmcnt(7)
Ta 174,5,6144
Mvav 212,156,120
Ta 176,2,8192
Mvav 220,156,124
s_waitcnt lgkmcnt(7)
Ta 178,2,10240
Mvav 192,160,128
LD 9,56,76,1024
Ta 144,3,8192
Mvav 200,160,132
s_waitcnt lgkmcnt(7)
Ta 146,3,10240
Mvav 196,164,128
Ta 148,4,8192
Mvav 204,164,132
s_waitcnt lgkmcnt(7)
Ta 150,4,10240
Mvav 208,168,128
Ta 152,5,8192
Mvav 216,168,132
s_waitcnt lgkmcnt(7)
Ta 154,5,10240
Mvav 212,172,128
LD 10,56,76,2048
Ta 156,2,12288
Mvav 220,172,132
s_waitcnt lgkmcnt(7)
Ta 158,2,14336
Mvav 192,176,136
Ta 160,3,12288
Mvav 200,176,140
s_waitcnt lgkmcnt(7)
Ta 162,3,14336
Mvav 196,144,136
Ta 164,4,12288
Mvav 204,144,140
s_waitcnt lgkmcnt(7)
Ta 166,4,14336
Mvav 208,148,136
LD 11,56,76,3072
Ta 168,5,12288
Mvav 216,148,140
s_waitcnt lgkmcnt(7)
s_add_u32 m0, s67, 0x1000
s_add_u32 s76, s23, 0x9000
Ta 170,5,14336
Mvav 212,152,136
Ta 172,2,16384
Mvav 220,152,140
s_waitcnt lgkmcnt(7)
Ta 174,2,18432
Mvav 192,156,144
Ta 176,3,16384
Mvav 200,156,148
s_waitcnt lgkmcnt(7)
Ta 178,3,18432
Mvav 196,160,144
LD 8,56,76,0
Ta 144,4,16384
Mvav 204,160,148
s_waitcnt lgkmcnt(7)
Ta 146,4,18432
Mvav 208,164,144
Ta 148,5,16384
Mvav 216,164,148
s_waitcnt lgkmcnt(7)
Ta 150,5,18432
Mvav 212,168,144
Ta 152,2,20480
Mvav 220,168,148
s_waitcnt lgkmcnt(7)
Ta 154,2,22528
Mvav 192,172,152
LD 9,56,76,1024
Ta 156,3,20480
Mvav 200,172,156
s_waitcnt lgkmcnt(7)
Ta 158,3,22528
Mvav 196,176,152
Ta 160,4,20480
Mvav 204,176,156
s_waitcnt lgkmcnt(7)
Ta 162,4,22528
Mvav 208,144,152
Ta 164,5,20480
Mvav 216,144,156
Ta 166,5,22528
s_waitcnt vmcnt(7)
v_cmp_ne_u32 vcc, s98, v17
s_cbranch_vccnz L_spin56
L_pollok56:
s_waitcnt lgkmcnt(8)
Mvav 212,148,152
LD 10,56,76,2048
Ta 168,2,24576
Mvav 220,148,156
s_waitcnt lgkmcnt(7)
Ta 170,2,26624
Ta 172,3,24576
Mvav 192,152,160
Ta 174,3,26624
v_mov_b32 v16, 0
Mvav 200,152,164
s_waitcnt lgkmcnt(8)
Ta 176,4,24576
v_lshlrev_b32 v17, 7, s14
Mvav 196,156,160
buffer_load_dwordx4 a[12:15], v7, s[40:43], s7 offen sc1
Ta 178,4,26624
Mvav 204,156,164
s_waitcnt lgkmcnt(8)
Ta 144,5,24576
v_lshl_add_u32 v16, v16, 2, v17
Mvav 208,160,160
Ta 146,5,26624
v_add_u32 v16, 0x3010010, v16
Mvav 216,160,164
s_waitcnt lgkmcnt(8)
Ta 148,2,28672
Mvav 212,164,160
buffer_load_dwordx4 a[44:47], v7, s[40:43], s7 offen offset:1024 sc1
Ta 150,2,30720
Mvav 220,164,164
s_waitcnt lgkmcnt(8)
Ta 152,3,28672
Mvav 192,168,168
Ta 154,3,30720
Mvav 200,168,172
s_waitcnt lgkmcnt(8)
Ta 156,4,28672
Mvav 196,172,168
buffer_load_dwordx4 a[76:79], v7, s[40:43], s7 offen offset:2048 sc1
Ta 158,4,30720
Mvav 204,172,172
s_waitcnt lgkmcnt(8)
Ta 160,5,28672
Ta 162,5,30720
Mvav 208,176,168
Ta 164,2,32768
Ta 166,2,34816
Mvav 216,176,172
s_waitcnt lgkmcnt(10)
Ta 168,3,32768
Ta 170,3,34816
Mvav 212,144,168
buffer_load_dwordx4 a[108:111], v7, s[40:43], s7 offen offset:3072 sc1
Ta 172,4,32768
Mvav 220,144,172
s_waitcnt lgkmcnt(10)
s_add_u32 s7, s19, 0x6000
Ta 174,4,34816
Ta 176,5,32768
Mvav 192,148,176
Ta 178,5,34816
v_add_u32 v2, 0x9000, v2
Mvav 200,148,180
s_waitcnt lgkmcnt(11)
v_add_u32 v3, 0x9000, v3
v_add_u32 v4, 0x9000, v4
Mvav 196,152,176
LD 11,56,76,3072
v_add_u32 v5, 0x9000, v5
Mvav 204,152,180
s_waitcnt lgkmcnt(9)
s_add_u32 m0, s67, 0x2000
s_add_u32 s76, s23, 0x12000
Mvav 208,156,176
Mvav 216,156,180
s_waitcnt lgkmcnt(6)
Mvav 212,160,176
LD 8,56,76,0
s_waitcnt lgkmcnt(0)
s_barrier
Mvav 220,160,180
s_add_u32 m0, s67, 0x9000
s_add_u32 s76, s23, 0x51000
Ta 144,2,0
Mvav 192,164,184
Ta 146,2,2048
Mvav 200,164,188
Ta 148,3,0
Mvav 196,168,184
Ta 150,3,2048
Mvav 204,168,188
Ta 152,4,0
Mvav 208,172,184
Ta 154,4,2048
Mvav 216,172,188
Ta 156,5,0
Mvav 212,176,184
Ta 158,5,2048
CV 196,196,197
Mvav 220,176,188
s_waitcnt lgkmcnt(6)
Ta 160,2,4096
CV 197,198,199
v_mfma_f32_16x16x32_bf16 v[224:227], a[144:147], v[48:51], 0
Ta 162,2,6144
CV 198,192,193
v_mfma_f32_16x16x32_bf16 v[232:235], a[144:147], v[52:55], 0
s_waitcnt lgkmcnt(6)
Ta 164,3,4096
CV 199,194,195
v_mfma_f32_16x16x32_bf16 v[228:231], a[148:151], v[48:51], 0
buffer_store_dwordx4 v[196:199], v7, s[40:43], s79 offen sc1
Ta 166,3,6144
v_mfma_f32_16x16x32_bf16 v[236:239], a[148:151], v[52:55], 0
s_waitcnt lgkmcnt(6)
Ta 168,4,4096
CV 204,204,205
v_mfma_f32_16x16x32_bf16 v[240:243], a[152:155], v[48:51], 0
Ta 170,4,6144
CV 205,206,207
v_mfma_f32_16x16x32_bf16 v[248:251], a[152:155], v[52:55], 0
s_waitcnt lgkmcnt(6)
Ta 172,5,4096
CV 206,200,201
v_mfma_f32_16x16x32_bf16 v[244:247], a[156:159], v[48:51], 0
s_waitcnt lgkmcnt(5)
Ta 174,5,6144
CV 207,202,203
v_mfma_f32_16x16x32_bf16 v[252:255], a[156:159], v[52:55], 0
buffer_store_dwordx4 v[204:207], v7, s[40:43], s79 offen offset:1024 sc1
Ta 176,2,8192
Mvav 224,160,56
Ta 178,2,10240
Ta 144,3,8192
Mvav 232,160,60
s_waitcnt lgkmcnt(7)
Ta 146,3,10240
CV 212,212,213
Mvav 228,164,56
Ta 148,4,8192
CV 213,214,215
Mvav 236,164,60
s_waitcnt lgkmcnt(7)
Ta 150,4,10240
CV 214,208,209
Mvav 240,168,56
LD 8,56,76,0
Ta 152,5,8192
Mvav 248,168,60
s_waitcnt lgkmcnt(7)
Ta 154,5,10240
CV 215,210,211
Mvav 244,172,56
Ta 156,2,12288
CV 220,220,221
Mvav 252,172,60
s_waitcnt lgkmcnt(7)
Ta 158,2,14336
CV 221,222,223
Mvav 224,176,64
buffer_store_dwordx4 v[212:215], v7, s[40:43], s79 offen offset:2048 sc1
Ta 160,3,12288
Mvav 232,176,68
s_waitcnt lgkmcnt(7)
Ta 162,3,14336
CV 222,216,217
Mvav 228,144,64
Ta 164,4,12288
CV 223,218,219
Mvav 236,144,68
s_waitcnt lgkmcnt(7)
Ta 166,4,14336
Mvav 240,148,64
s_waitcnt lgkmcnt(6)
Ta 168,5,12288
Mvav 248,148,68
buffer_store_dwordx4 v[220:223], v7, s[40:43], s79 offen offset:3072 sc1
Ta 170,5,14336
Mvav 244,152,64
Ta 172,2,16384
Mvav 252,152,68
s_waitcnt lgkmcnt(7)
Ta 174,2,18432
Mvav 224,156,72
Ta 176,3,16384
Mvav 232,156,76
s_waitcnt lgkmcnt(7)
Ta 178,3,18432
Mvav 228,160,72
LD 9,56,76,1024
Ta 144,4,16384
Mvav 236,160,76
s_waitcnt lgkmcnt(7)
Ta 146,4,18432
Mvav 240,164,72
s_lshl_b32 s85, s30, 7
Ta 148,5,16384
s_add_u32 s85, s85, 0x4000
Mvav 248,164,76
s_waitcnt lgkmcnt(7)
s_getpc_b64 s[96:97]
Ta 150,5,18432
v_mov_b32 v46, s85
Mvav 244,168,72
LD 10,56,76,2048
Ta 152,2,20480
Mvav 252,168,76
s_waitcnt lgkmcnt(7)
Ta 154,2,22528
Mvav 224,172,80
Ta 156,3,20480
Mvav 232,172,84
s_waitcnt lgkmcnt(7)
Ta 158,3,22528
Mvav 228,176,80
LD 11,56,76,3072
Ta 160,4,20480
Mvav 236,176,84
s_waitcnt lgkmcnt(7)
s_add_u32 m0, s67, 0xa000
s_add_u32 s76, s23, 0x5a000
Ta 162,4,22528
Mvav 240,144,80
Ta 164,5,20480
Mvav 248,144,84
s_waitcnt lgkmcnt(7)
Ta 166,5,22528
Mvav 244,148,80
LD 8,56,76,0
Ta 168,2,24576
Mvav 252,148,84
s_waitcnt lgkmcnt(7)
Ta 170,2,26624
Mvav 224,152,88
Ta 172,3,24576
Mvav 232,152,92
s_waitcnt lgkmcnt(7)
Ta 174,3,26624
Mvav 228,156,88
LD 9,56,76,1024
Ta 176,4,24576
Mvav 236,156,92
s_waitcnt lgkmcnt(7)
Ta 178,4,26624
Mvav 240,160,88
Ta 144,5,24576
Mvav 248,160,92
s_waitcnt lgkmcnt(7)
Ta 146,5,26624
Mvav 244,164,88
LD 10,56,76,2048
Ta 148,2,28672
Mvav 252,164,92
s_waitcnt lgkmcnt(7)
Ta 150,2,30720
Ta 152,3,28672
Mvav 224,168,96
Ta 154,3,30720
Mvav 232,168,100
s_waitcnt lgkmcnt(8)
Ta 156,4,28672
Mvav 228,172,96
LD 11,56,76,3072
Ta 158,4,30720
Mvav 236,172,100
s_waitcnt lgkmcnt(8)
s_add_u32 m0, s67, 0xb000
s_add_u32 s76, s23, 0x63000
Ta 160,5,28672
Mvav 240,176,96
Ta 162,5,30720
Ta 164,2,32768
Mvav 248,176,100
s_waitcnt lgkmcnt(9)
Ta 166,2,34816
Ta 168,3,32768
Mvav 244,144,96
LD 8,56,76,0
Ta 170,3,34816
Mvav 252,144,100
s_waitcnt lgkmcnt(10)
s_add_u32 m0, s67, 0x12000
Ta 172,4,32768
Ta 174,4,34816
Mvav 224,148,104
s_add_u32 s76, s12, 0
Ta 176,5,32768
Ta 178,5,34816
Mvav 232,148,108
s_waitcnt lgkmcnt(11)
v_add_u32 v2, 0x9000, v2
v_add_u32 v3, 0x9000, v3
Mvav 228,152,104
global_load_dword a252, v46, s[96:97]
v_add_u32 v4, 0x9000, v4
Mvav 236,152,108
s_waitcnt lgkmcnt(10)
v_add_u32 v5, 0x9000, v5
Mvav 240,156,104
buffer_load_dword v17, v16, s[40:43], 0 offen sc1
Mvav 248,156,108
s_waitcnt lgkmcnt(7)
Mvav 244,160,104
Mvav 252,160,108
s_waitcnt lgkmcnt(0)
s_barrier
Mvav 224,164,112
Ta 144,2,0
Ta 146,2,2048
Mvav 232,164,116
Ta 148,3,0
Mvav 228,168,112
Ta 150,3,2048
Mvav 236,168,116
Ta 152,4,0
Mvav 240,172,112
Ta 154,4,2048
Mvav 248,172,116
Ta 156,5,0
Mvav 244,176,112
Ta 158,5,2048
Mvav 252,176,116
s_waitcnt lgkmcnt(6)
Ta 160,2,4096
Mvav 224,144,120
Ta 162,2,6144
Mvav 232,144,124
s_waitcnt lgkmcnt(6)
Ta 164,3,4096
Mvav 228,148,120
LD 8,56,76,0
Ta 166,3,6144
Mvav 236,148,124
s_waitcnt lgkmcnt(6)
Ta 168,4,4096
Mvav 240,152,120
Ta 170,4,6144
Mvav 248,152,124
s_waitcnt lgkmcnt(6)
Ta 172,5,4096
Mvav 244,156,120
s_waitcnt vmcnt(11)
buffer_store_dword v47, off, s[40:43], s10 sc1
Ta 174,5,6144
Mvav 252,156,124
s_waitcnt lgkmcnt(6)
Ta 176,2,8192
Mvav 224,160,128
LD 9,56,76,1024
Ta 178,2,10240
Mvav 232,160,132
s_waitcnt lgkmcnt(6)
Ta 144,3,8192
L_pg5_21:
s_cbranch_execz L_ret5
Mvav 228,164,128
Ta 146,3,10240
Mvav 236,164,132
s_waitcnt lgkmcnt(6)
Ta 148,4,8192
Mvav 240,168,128
Ta 150,4,10240
Mvav 248,168,132
s_waitcnt lgkmcnt(6)
Ta 152,5,8192
Mvav 244,172,128
LD 10,56,76,2048
Ta 154,5,10240
Mvav 252,172,132
s_waitcnt lgkmcnt(6)
Ta 156,2,12288
Ta 158,2,14336
Mvav 224,176,136
Ta 160,3,12288
Mvav 232,176,140
s_waitcnt lgkmcnt(7)
Ta 162,3,14336
Mvav 228,144,136
Ta 164,4,12288
Mvav 236,144,140
s_waitcnt lgkmcnt(7)
Ta 166,4,14336
Mvav 240,148,136
LD 11,56,76,3072
Ta 168,5,12288
Mvav 248,148,140
s_waitcnt lgkmcnt(7)
s_add_u32 m0, s67, 0x13000
s_add_u32 s76, s12, 0x9000
Ta 170,5,14336
Mvav 244,152,136
Ta 172,2,16384
Mvav 252,152,140
s_waitcnt lgkmcnt(7)
Ta 174,2,18432
Mvav 224,156,144
Ta 176,3,16384
Mvav 232,156,148
s_waitcnt lgkmcnt(7)
Ta 178,3,18432
Mvav 228,160,144
LD 8,56,76,0
Ta 144,4,16384
Mvav 236,160,148
s_waitcnt lgkmcnt(7)
Ta 146,4,18432
Mvav 240,164,144
Ta 148,5,16384
Mvav 248,164,148
s_waitcnt lgkmcnt(7)
Ta 150,5,18432
Mvav 244,168,144
Ta 152,2,20480
Mvav 252,168,148
s_waitcnt lgkmcnt(7)
Ta 154,2,22528
Mvav 224,172,152
LD 9,56,76,1024
Ta 156,3,20480
Mvav 232,172,156
s_waitcnt lgkmcnt(7)
Ta 158,3,22528
Mvav 228,176,152
Ta 160,4,20480
Mvav 236,176,156
s_waitcnt lgkmcnt(7)
Ta 162,4,22528
Mvav 240,144,152
Ta 164,5,20480
Mvav 248,144,156
s_waitcnt lgkmcnt(7)
Ta 166,5,22528
Mvav 244,148,152
LD 10,56,76,2048
Ta 168,2,24576
Mvav 252,148,156
Ta 170,2,26624
s_waitcnt vmcnt(8)
v_cmp_ne_u32 vcc, s98, v17
s_cbranch_vccnz L_spin57
L_pollok57:
s_waitcnt lgkmcnt(8)
Mvav 224,152,160
Ta 172,3,24576
v_and_b32 v16, 1, v1
Mvav 232,152,164
s_waitcnt lgkmcnt(7)
Ta 174,3,26624
v_mul_u32_u24 v16, 9, v16
Mvav 228,156,160
buffer_load_dwordx4 a[16:19], v7, s[40:43], s4 offen sc1
Ta 176,4,24576
Mvav 236,156,164
s_waitcnt lgkmcnt(7)
Ta 178,4,26624
v_lshlrev_b32 v17, 7, s14
Mvav 240,160,160
Ta 144,5,24576
v_lshl_add_u32 v16, v16, 2, v17
Mvav 248,160,164
s_waitcnt lgkmcnt(7)
Ta 146,5,26624
v_add_u32 v16, 0x3010014, v16
Mvav 244,164,160
buffer_load_dwordx4 a[48:51], v7, s[40:43], s4 offen offset:1024 sc1
Ta 148,2,28672
Mvav 252,164,164
s_waitcnt lgkmcnt(7)
Ta 150,2,30720
Mvav 224,168,168
Ta 152,3,28672
Mvav 232,168,172
s_waitcnt lgkmcnt(7)
Ta 154,3,30720
Mvav 228,172,168
buffer_load_dwordx4 a[80:83], v7, s[40:43], s4 offen offset:2048 sc1
Ta 156,4,28672
Mvav 236,172,172
s_waitcnt lgkmcnt(7)
Ta 158,4,30720
Ta 160,5,28672
Mvav 240,176,168
Ta 162,5,30720
Ta 164,2,32768
Mvav 248,176,172
s_waitcnt lgkmcnt(9)
Ta 166,2,34816
Ta 168,3,32768
Mvav 244,144,168
buffer_load_dwordx4 a[112:115], v7, s[40:43], s4 offen offset:3072 sc1
Ta 170,3,34816
Mvav 252,144,172
s_waitcnt lgkmcnt(10)
s_add_u32 s4, s19, 0xf000
Ta 172,4,32768
Ta 174,4,34816
Mvav 224,148,176
Ta 176,5,32768
Ta 178,5,34816
Mvav 232,148,180
s_waitcnt lgkmcnt(12)
v_add_u32 v2, 0xfffe5000, v2
v_add_u32 v3, 0xfffe5000, v3
Mvav 228,152,176
LD 11,56,76,3072
v_add_u32 v4, 0xfffe5000, v4
Mvav 236,152,180
s_waitcnt lgkmcnt(9)
s_add_u32 m0, s67, 0x14000
s_add_u32 s76, s12, 0x12000
v_add_u32 v5, 0xfffe5000, v5
Mvav 240,156,176
Mvav 248,156,180
s_waitcnt lgkmcnt(7)
Mvav 244,160,176
LD 8,56,76,0
s_waitcnt lgkmcnt(0)
s_barrier
Mvav 252,160,180
s_add_u32 m0, s67, 0x1b000
s_add_u32 s76, s12, 0x51000
Ta 144,2,0
Mvav 224,164,184
Ta 146,2,2048
Mvav 232,164,188
Ta 148,3,0
Mvav 228,168,184
Ta 150,3,2048
Mvav 236,168,188
Ta 152,4,0
Mvav 240,172,184
Ta 154,4,2048
CV 224,224,225
Mvav 248,172,188
Ta 156,5,0
CV 225,226,227
Mvav 244,176,184
Ta 158,5,2048
CV 226,228,229
Mvav 252,176,188
s_waitcnt lgkmcnt(6)
Ta 160,2,4096
CV 227,230,231
v_mfma_f32_16x16x32_bf16 v[192:195], a[144:147], v[48:51], 0
buffer_store_dwordx4 v[224:227], v7, s[40:43], s80 offen sc1
Ta 162,2,6144
v_mfma_f32_16x16x32_bf16 v[200:203], a[144:147], v[52:55], 0
s_waitcnt lgkmcnt(6)
Ta 164,3,4096
CV 232,232,233
v_mfma_f32_16x16x32_bf16 v[196:199], a[148:151], v[48:51], 0
Ta 166,3,6144
CV 233,234,235
v_mfma_f32_16x16x32_bf16 v[204:207], a[148:151], v[52:55], 0
s_waitcnt lgkmcnt(6)
Ta 168,4,4096
CV 234,236,237
v_mfma_f32_16x16x32_bf16 v[208:211], a[152:155], v[48:51], 0
s_waitcnt lgkmcnt(5)
Ta 170,4,6144
CV 235,238,239
v_mfma_f32_16x16x32_bf16 v[216:219], a[152:155], v[52:55], 0
buffer_store_dwordx4 v[232:235], v7, s[40:43], s80 offen offset:1024 sc1
Ta 172,5,4096
v_mfma_f32_16x16x32_bf16 v[212:215], a[156:159], v[48:51], 0
Ta 174,5,6144
CV 240,240,241
v_mfma_f32_16x16x32_bf16 v[220:223], a[156:159], v[52:55], 0
s_waitcnt lgkmcnt(6)
Ta 176,2,8192
CV 241,242,243
Mvav 192,160,56
Ta 178,2,10240
CV 242,244,245
Mvav 200,160,60
s_waitcnt lgkmcnt(6)
Ta 144,3,8192
CV 243,246,247
Mvav 196,164,56
buffer_store_dwordx4 v[240:243], v7, s[40:43], s80 offen offset:2048 sc1
Ta 146,3,10240
Mvav 204,164,60
s_waitcnt lgkmcnt(6)
Ta 148,4,8192
CV 248,248,249
Mvav 208,168,56
Ta 150,4,10240
CV 249,250,251
Mvav 216,168,60
s_waitcnt lgkmcnt(6)
Ta 152,5,8192
CV 250,252,253
Mvav 212,172,56
s_waitcnt lgkmcnt(5)
Ta 154,5,10240
CV 251,254,255
Mvav 220,172,60
buffer_store_dwordx4 v[248:251], v7, s[40:43], s80 offen offset:3072 sc1
Ta 156,2,12288
Mvav 192,176,64
Ta 158,2,14336
Mvav 200,176,68
s_waitcnt lgkmcnt(6)
Ta 160,3,12288
Mvav 196,144,64
Ta 162,3,14336
Mvav 204,144,68
s_waitcnt lgkmcnt(6)
Ta 164,4,12288
Mvav 208,148,64
LD 8,56,76,0
Ta 166,4,14336
Mvav 216,148,68
s_waitcnt lgkmcnt(6)
Ta 168,5,12288
Mvav 212,152,64
Ta 170,5,14336
Mvav 220,152,68
s_waitcnt lgkmcnt(6)
Ta 172,2,16384
Ta 174,2,18432
Mvav 192,156,72
LD 9,56,76,1024
Ta 176,3,16384
Mvav 200,156,76
s_waitcnt lgkmcnt(7)
Ta 178,3,18432
Mvav 196,160,72
Ta 144,4,16384
Mvav 204,160,76
s_waitcnt lgkmcnt(7)
Ta 146,4,18432
Mvav 208,164,72
LD 10,56,76,2048
Ta 148,5,16384
Mvav 216,164,76
s_waitcnt lgkmcnt(7)
Ta 150,5,18432
Mvav 212,168,72
Ta 152,2,20480
Mvav 220,168,76
s_waitcnt lgkmcnt(7)
Ta 154,2,22528
Mvav 192,172,80
LD 11,56,76,3072
Ta 156,3,20480
Mvav 200,172,84
s_waitcnt lgkmcnt(7)
s_add_u32 m0, s67, 0x1c000
s_add_u32 s76, s12, 0x5a000
Ta 158,3,22528
Mvav 196,176,80
Ta 160,4,20480
Mvav 204,176,84
s_waitcnt lgkmcnt(7)
Ta 162,4,22528
Mvav 208,144,80
LD 8,56,76,0
Ta 164,5,20480
Mvav 216,144,84
s_waitcnt lgkmcnt(7)
Ta 166,5,22528
Mvav 212,148,80
Ta 168,2,24576
Mvav 220,148,84
s_waitcnt lgkmcnt(7)
Ta 170,2,26624
Mvav 192,152,88
LD 9,56,76,1024
Ta 172,3,24576
Mvav 200,152,92
s_waitcnt lgkmcnt(7)
Ta 174,3,26624
Mvav 196,156,88
Ta 176,4,24576
Mvav 204,156,92
s_waitcnt lgkmcnt(7)
Ta 178,4,26624
Mvav 208,160,88
LD 10,56,76,2048
Ta 144,5,24576
Mvav 216,160,92
s_waitcnt lgkmcnt(7)
Ta 146,5,26624
Mvav 212,164,88
Ta 148,2,28672
Mvav 220,164,92
s_waitcnt lgkmcnt(7)
Ta 150,2,30720
Mvav 192,168,96
LD 11,56,76,3072
Ta 152,3,28672
Mvav 200,168,100
s_waitcnt lgkmcnt(7)
s_add_u32 m0, s67, 0x1d000
s_add_u32 s76, s12, 0x63000
Ta 154,3,30720
Mvav 196,172,96
Ta 156,4,28672
Mvav 204,172,100
s_waitcnt lgkmcnt(7)
Ta 158,4,30720
Mvav 208,176,96
LD 8,56,76,0
Ta 160,5,28672
Mvav 216,176,100
s_waitcnt lgkmcnt(7)
Ta 162,5,30720
Mvav 212,144,96
Ta 164,2,32768
Mvav 220,144,100
s_waitcnt lgkmcnt(7)
Ta 166,2,34816
v_add_u32 v2, 0x9000, v2
Mvav 192,148,104
Ta 168,3,32768
Mvav 200,148,108
s_waitcnt lgkmcnt(7)
Ta 170,3,34816
v_add_u32 v3, 0x9000, v3
Mvav 196,152,104
Ta 172,4,32768
Ta 174,4,34816
Mvav 204,152,108
s_waitcnt lgkmcnt(8)
Ta 176,5,32768
Ta 178,5,34816
Mvav 208,156,104
buffer_load_dword v17, v16, s[40:43], 0 offen sc1
v_add_u32 v4, 0x9000, v4
Mvav 216,156,108
s_waitcnt lgkmcnt(8)
v_add_u32 v5, 0x9000, v5
Mvav 212,160,104
Mvav 220,160,108
s_waitcnt lgkmcnt(6)
Mvav 192,164,112
Mvav 200,164,116
s_waitcnt lgkmcnt(4)
Mvav 196,168,112
s_waitcnt lgkmcnt(0)
s_barrier
Mvav 204,168,116
Ta 144,2,0
Ta 146,2,2048
Mvav 208,172,112
Ta 148,3,0
Ta 150,3,2048
Mvav 216,172,116
Ta 152,4,0
Ta 154,4,2048
Mvav 212,176,112
s_waitcnt vmcnt(10)
buffer_store_dword v47, off, s[40:43], s11 sc1
Ta 156,5,0
Mvav 220,176,116
s_waitcnt lgkmcnt(5)
Ta 158,5,2048
Ta 160,2,4096
Ta 162,2,6144
Ta 164,3,4096
Mvav 192,144,120
Ta 166,3,6144
Mvav 200,144,124
s_waitcnt lgkmcnt(8)
Ta 168,4,4096
Mvav 196,148,120
Ta 170,4,6144
Mvav 204,148,124
s_waitcnt lgkmcnt(8)
Ta 172,5,4096
Mvav 208,152,120
Ta 174,5,6144
Mvav 216,152,124
s_waitcnt lgkmcnt(8)
Ta 176,2,8192
Mvav 212,156,120
Ta 178,2,10240
Mvav 220,156,124
s_waitcnt lgkmcnt(8)
Ta 144,3,8192
Mvav 192,160,128
Ta 146,3,10240
Mvav 200,160,132
s_waitcnt lgkmcnt(8)
Ta 148,4,8192
Mvav 196,164,128
Ta 150,4,10240
Mvav 204,164,132
s_waitcnt lgkmcnt(8)
Ta 152,5,8192
Mvav 208,168,128
Ta 154,5,10240
Mvav 216,168,132
s_waitcnt lgkmcnt(8)
Ta 156,2,12288
Mvav 212,172,128
Ta 158,2,14336
Mvav 220,172,132
s_waitcnt lgkmcnt(8)
Ta 160,3,12288
Mvav 192,176,136
Ta 162,3,14336
Mvav 200,176,140
s_waitcnt lgkmcnt(8)
Ta 164,4,12288
Mvav 196,144,136
Ta 166,4,14336
Mvav 204,144,140
s_waitcnt lgkmcnt(8)
Ta 168,5,12288
Mvav 208,148,136
Ta 170,5,14336
Mvav 216,148,140
s_waitcnt lgkmcnt(8)
Ta 172,2,16384
Mvav 212,152,136
Ta 174,2,18432
Mvav 220,152,140
s_waitcnt lgkmcnt(8)
Ta 176,3,16384
Mvav 192,156,144
Ta 178,3,18432
Mvav 200,156,148
s_waitcnt lgkmcnt(8)
Ta 144,4,16384
Mvav 196,160,144
Ta 146,4,18432
Mvav 204,160,148
s_waitcnt lgkmcnt(8)
Ta 148,5,16384
Mvav 208,164,144
Ta 150,5,18432
Mvav 216,164,148
s_waitcnt lgkmcnt(8)
Ta 152,2,20480
Mvav 212,168,144
Ta 154,2,22528
Mvav 220,168,148
s_waitcnt lgkmcnt(8)
Ta 156,3,20480
Ta 158,3,22528
Mvav 192,172,152
Ta 160,4,20480
Mvav 200,172,156
s_waitcnt lgkmcnt(9)
Ta 162,4,22528
Mvav 196,176,152
Ta 164,5,20480
Mvav 204,176,156
Ta 166,5,22528
s_waitcnt vmcnt(1)
v_cmp_ne_u32 vcc, s98, v17
s_cbranch_vccnz L_spin58
L_pollok58:
s_waitcnt lgkmcnt(10)
Mvav 208,144,152
Ta 168,2,24576
v_and_b32 v16, 1, v1
Mvav 216,144,156
s_waitcnt lgkmcnt(9)
Ta 170,2,26624
v_mul_u32_u24 v16, 9, v16
Mvav 212,148,152
Ta 172,3,24576
v_lshlrev_b32 v17, 7, s14
Mvav 220,148,156
s_waitcnt lgkmcnt(9)
Ta 174,3,26624
v_lshl_add_u32 v16, v16, 2, v17
Mvav 192,152,160
buffer_load_dwordx4 a[20:23], v7, s[40:43], s5 offen sc1
Ta 176,4,24576
Mvav 200,152,164
s_waitcnt lgkmcnt(8)
Ta 178,4,26624
v_add_u32 v16, 0x3010018, v16
Mvav 196,156,160
Ta 144,5,24576
Mvav 204,156,164
s_waitcnt lgkmcnt(8)
Ta 146,5,26624
Mvav 208,160,160
buffer_load_dwordx4 a[52:55], v7, s[40:43], s5 offen offset:1024 sc1
Ta 148,2,28672
Mvav 216,160,164
s_waitcnt lgkmcnt(8)
Ta 150,2,30720
Mvav 212,164,160
Ta 152,3,28672
Mvav 220,164,164
s_waitcnt lgkmcnt(8)
Ta 154,3,30720
Mvav 192,168,168
buffer_load_dwordx4 a[84:87], v7, s[40:43], s5 offen offset:2048 sc1
Ta 156,4,28672
Mvav 200,168,172
s_waitcnt lgkmcnt(9)
Ta 158,4,30720
Mvav 196,172,168
Ta 160,5,28672
Mvav 204,172,172
s_waitcnt lgkmcnt(8)
Ta 162,5,30720
Mvav 208,176,168
buffer_load_dwordx4 a[116:119], v7, s[40:43], s5 offen offset:3072 sc1
Ta 164,2,32768
Mvav 216,176,172
s_waitcnt lgkmcnt(9)
s_mul_i32 s5, s94, 0x9000
Ta 166,2,34816
v_add_u32 v2, 0x9000, v2
Mvav 212,144,168
Ta 168,3,32768
v_add3_u32 v12, v12, v13, s5
Mvav 220,144,172
s_waitcnt lgkmcnt(8)
Ta 170,3,34816
v_add_u32 v3, 0x9000, v3
Mvav 192,148,176
buffer_load_dwordx4 a[128:131], v7, s[40:43], s6 offen sc1
L_pg5_22:
s_cbranch_execz L_ret5
Ta 172,4,32768
Mvav 200,148,180
s_waitcnt lgkmcnt(9)
Ta 174,4,34816
v_add_u32 v4, 0x9000, v4
Mvav 196,152,176
Ta 176,5,32768
Ta 178,5,34816
Mvav 204,152,180
s_waitcnt lgkmcnt(9)
v_add_u32 v5, 0x9000, v5
Mvav 208,156,176
buffer_load_dwordx4 a[136:139], v7, s[40:43], s6 offen offset:1024 sc1
Mvav 216,156,180
s_waitcnt lgkmcnt(7)
Mvav 212,160,176
Mvav 220,160,180
s_waitcnt lgkmcnt(5)
Mvav 192,164,184
buffer_load_dwordx4 a[236:239], v7, s[40:43], s6 offen offset:2048 sc1
s_waitcnt lgkmcnt(0)
s_barrier
Mvav 200,164,188
Ta 144,2,0
Ta 146,2,2048
Mvav 196,168,184
Ta 148,3,0
Mvav 204,168,188
Ta 150,3,2048
Mvav 208,172,184
buffer_load_dwordx4 a[244:247], v7, s[40:43], s6 offen offset:3072 sc1
Ta 152,4,0
Mvav 216,172,188
s_add_u32 s6, s19, 0x7000
Ta 154,4,2048
CV 196,196,197
Mvav 212,176,184
Ta 156,5,0
CV 197,198,199
Mvav 220,176,188
s_waitcnt lgkmcnt(5)
Ta 158,5,2048
Ta 160,2,4096
CV 198,192,193
v_mfma_f32_16x16x32_bf16 v[224:227], a[144:147], v[48:51], 0
s_waitcnt lgkmcnt(5)
Ta 162,2,6144
CV 199,194,195
v_mfma_f32_16x16x32_bf16 v[232:235], a[144:147], v[52:55], 0
buffer_store_dwordx4 v[196:199], v7, s[40:43], s81 offen sc1
Ta 164,3,4096
v_mfma_f32_16x16x32_bf16 v[228:231], a[148:151], v[48:51], 0
Ta 166,3,6144
CV 204,204,205
v_mfma_f32_16x16x32_bf16 v[236:239], a[148:151], v[52:55], 0
s_waitcnt lgkmcnt(6)
Ta 168,4,4096
CV 205,206,207
v_mfma_f32_16x16x32_bf16 v[240:243], a[152:155], v[48:51], 0
Ta 170,4,6144
CV 206,200,201
v_mfma_f32_16x16x32_bf16 v[248:251], a[152:155], v[52:55], 0
s_waitcnt lgkmcnt(6)
Ta 172,5,4096
CV 207,202,203
v_mfma_f32_16x16x32_bf16 v[244:247], a[156:159], v[48:51], 0
buffer_store_dwordx4 v[204:207], v7, s[40:43], s81 offen offset:1024 sc1
Ta 174,5,6144
v_mfma_f32_16x16x32_bf16 v[252:255], a[156:159], v[52:55], 0
s_waitcnt lgkmcnt(6)
Ta 176,2,8192
CV 212,212,213
Mvav 224,160,56
Ta 178,2,10240
CV 213,214,215
Mvav 232,160,60
s_waitcnt lgkmcnt(6)
Ta 144,3,8192
CV 214,208,209
Mvav 228,164,56
s_waitcnt lgkmcnt(5)
Ta 146,3,10240
CV 215,210,211
Mvav 236,164,60
buffer_store_dwordx4 v[212:215], v7, s[40:43], s81 offen offset:2048 sc1
Ta 148,4,8192
Mvav 240,168,56
Ta 150,4,10240
CV 220,220,221
Mvav 248,168,60
s_waitcnt lgkmcnt(6)
Ta 152,5,8192
CV 221,222,223
Mvav 244,172,56
Ta 154,5,10240
CV 222,216,217
Mvav 252,172,60
s_waitcnt lgkmcnt(6)
Ta 156,2,12288
CV 223,218,219
Mvav 224,176,64
buffer_store_dwordx4 v[220:223], v7, s[40:43], s81 offen offset:3072 sc1
Ta 158,2,14336
Mvav 232,176,68
s_waitcnt lgkmcnt(6)
Ta 160,3,12288
v_accvgpr_read_b32 v48, a180
Mvav 228,144,64
Ta 162,3,14336
v_accvgpr_read_b32 v52, a184
Mvav 236,144,68
s_waitcnt lgkmcnt(6)
Ta 164,4,12288
v_accvgpr_read_b32 v56, a188
Mvav 240,148,64
Ta 166,4,14336
v_accvgpr_read_b32 v60, a192
Mvav 248,148,68
s_waitcnt lgkmcnt(6)
Ta 168,5,12288
v_accvgpr_read_b32 v49, a181
Mvav 244,152,64
Ta 170,5,14336
v_accvgpr_read_b32 v53, a185
Mvav 252,152,68
s_waitcnt lgkmcnt(6)
Ta 172,2,16384
v_accvgpr_read_b32 v57, a189
Mvav 224,156,72
Ta 174,2,18432
v_accvgpr_read_b32 v61, a193
Mvav 232,156,76
s_waitcnt lgkmcnt(6)
Ta 176,3,16384
v_accvgpr_read_b32 v50, a182
Mvav 228,160,72
Ta 178,3,18432
v_accvgpr_read_b32 v51, a183
Mvav 236,160,76
s_waitcnt lgkmcnt(6)
Ta 144,4,16384
v_accvgpr_read_b32 v54, a186
Mvav 240,164,72
buffer_load_dword v17, v16, s[40:43], 0 offen sc1
Ta 146,4,18432
Mvav 248,164,76
s_waitcnt lgkmcnt(6)
Ta 148,5,16384
v_accvgpr_read_b32 v55, a187
Mvav 244,168,72
Ta 150,5,18432
v_accvgpr_read_b32 v58, a190
Mvav 252,168,76
s_waitcnt lgkmcnt(6)
Ta 152,2,20480
v_accvgpr_read_b32 v59, a191
Mvav 224,172,80
Ta 154,2,22528
v_accvgpr_read_b32 v62, a194
Mvav 232,172,84
s_waitcnt lgkmcnt(6)
Ta 156,3,20480
v_accvgpr_read_b32 v63, a195
Mvav 228,176,80
Ta 158,3,22528
v_lshlrev_b32 v64, 16, v48
Mvav 236,176,84
s_waitcnt lgkmcnt(6)
Ta 160,4,20480
v_and_b32 v65, s90, v48
Mvav 240,144,80
Ta 162,4,22528
v_lshlrev_b32 v72, 16, v52
Mvav 248,144,84
s_waitcnt lgkmcnt(6)
Ta 164,5,20480
v_and_b32 v73, s90, v52
Mvav 244,148,80
Ta 166,5,22528
v_lshlrev_b32 v80, 16, v56
Mvav 252,148,84
s_waitcnt lgkmcnt(6)
Ta 168,2,24576
Ta 170,2,26624
Mvav 224,152,88
Ta 172,3,24576
v_and_b32 v81, s90, v56
Mvav 232,152,92
s_waitcnt lgkmcnt(7)
Ta 174,3,26624
v_lshlrev_b32 v66, 16, v49
Mvav 228,156,88
Ta 176,4,24576
v_and_b32 v67, s90, v49
Mvav 236,156,92
s_waitcnt lgkmcnt(7)
Ta 178,4,26624
v_lshlrev_b32 v74, 16, v53
Mvav 240,160,88
Ta 144,5,24576
v_and_b32 v75, s90, v53
Mvav 248,160,92
s_waitcnt lgkmcnt(7)
Ta 146,5,26624
v_lshlrev_b32 v82, 16, v57
Mvav 244,164,88
Ta 148,2,28672
v_lshlrev_b32 v88, 16, v60
Mvav 252,164,92
s_waitcnt lgkmcnt(7)
Ta 150,2,30720
v_and_b32 v89, s90, v60
Mvav 224,168,96
Ta 152,3,28672
v_and_b32 v83, s90, v57
Mvav 232,168,100
s_waitcnt lgkmcnt(7)
Ta 154,3,30720
v_lshlrev_b32 v90, 16, v61
Mvav 228,172,96
Ta 156,4,28672
v_and_b32 v91, s90, v61
Mvav 236,172,100
s_waitcnt lgkmcnt(7)
Ta 158,4,30720
v_lshlrev_b32 v68, 16, v50
Mvav 240,176,96
Ta 160,5,28672
v_and_b32 v69, s90, v50
Mvav 248,176,100
s_waitcnt lgkmcnt(7)
Ta 162,5,30720
v_lshlrev_b32 v70, 16, v51
Mvav 244,144,96
Ta 164,2,32768
v_and_b32 v71, s90, v51
Mvav 252,144,100
s_waitcnt lgkmcnt(7)
Ta 166,2,34816
v_add_u32 v2, 0x9000, v2
Mvav 224,148,104
Ta 168,3,32768
v_lshlrev_b32 v76, 16, v54
Mvav 232,148,108
s_waitcnt lgkmcnt(7)
Ta 170,3,34816
v_add_u32 v3, 0x9000, v3
Mvav 228,152,104
Ta 172,4,32768
Ta 174,4,34816
Mvav 236,152,108
s_waitcnt lgkmcnt(8)
Ta 176,5,32768
Ta 178,5,34816
Mvav 240,156,104
v_add_u32 v4, 0x9000, v4
v_add_u32 v5, 0x9000, v5
Mvav 248,156,108
s_waitcnt lgkmcnt(8)
v_and_b32 v77, s90, v54
v_lshlrev_b32 v78, 16, v55
Mvav 244,160,104
v_and_b32 v79, s90, v55
v_lshlrev_b32 v84, 16, v58
Mvav 252,160,108
s_waitcnt lgkmcnt(6)
v_and_b32 v85, s90, v58
v_lshlrev_b32 v86, 16, v59
Mvav 224,164,112
v_and_b32 v87, s90, v59
v_lshlrev_b32 v92, 16, v62
Mvav 232,164,116
s_waitcnt lgkmcnt(4)
v_and_b32 v93, s90, v62
v_lshlrev_b32 v94, 16, v63
Mvav 228,168,112
s_waitcnt lgkmcnt(0)
s_barrier
v_and_b32 v95, s90, v63
Mvav 236,168,116
Ta 144,2,0
Ta 146,2,2048
Mvav 240,172,112
Ta 148,3,0
Ta 150,3,2048
Mvav 248,172,116
Ta 152,4,0
Ta 154,4,2048
Mvav 244,176,112
Ta 156,5,0
Ta 158,5,2048
Mvav 252,176,116
s_waitcnt vmcnt(1)
s_waitcnt lgkmcnt(6)
buffer_store_dword v47, off, s[40:43], s8 sc1
Ta 160,2,4096
Ta 162,2,6144
Ta 164,3,4096
Ta 166,3,6144
Mvav 224,144,120
Ta 168,4,4096
Mvav 232,144,124
s_waitcnt lgkmcnt(9)
Ta 170,4,6144
Mvav 228,148,120
Ta 172,5,4096
Mvav 236,148,124
Ta 174,5,6144
s_waitcnt vmcnt(1)
v_cmp_ne_u32 vcc, s98, v17
s_cbranch_vccnz L_spin59
L_pollok59:
s_waitcnt lgkmcnt(10)
Mvav 240,152,120
Ta 176,2,8192
v_and_b32 v16, 1, v1
Mvav 248,152,124
s_waitcnt lgkmcnt(9)
Ta 178,2,10240
v_mul_u32_u24 v16, 9, v16
Mvav 244,156,120
Ta 144,3,8192
v_lshlrev_b32 v17, 7, s14
Mvav 252,156,124
s_waitcnt lgkmcnt(8)
Ta 146,3,10240
Ta 148,4,8192
Mvav 224,160,128
buffer_load_dwordx4 a[24:27], v7, s[40:43], s7 offen sc1
Ta 150,4,10240
Mvav 232,160,132
s_waitcnt lgkmcnt(9)
Ta 152,5,8192
v_lshl_add_u32 v16, v16, 2, v17
Mvav 228,164,128
Ta 154,5,10240
v_add_u32 v16, 0x301001c, v16
Mvav 236,164,132
s_waitcnt lgkmcnt(9)
Ta 156,2,12288
Mvav 240,168,128
buffer_load_dwordx4 a[56:59], v7, s[40:43], s7 offen offset:1024 sc1
Ta 158,2,14336
Mvav 248,168,132
s_waitcnt lgkmcnt(9)
Ta 160,3,12288
Mvav 244,172,128
Ta 162,3,14336
Mvav 252,172,132
s_waitcnt lgkmcnt(9)
Ta 164,4,12288
Mvav 224,176,136
buffer_load_dwordx4 a[88:91], v7, s[40:43], s7 offen offset:2048 sc1
Ta 166,4,14336
Mvav 232,176,140
s_waitcnt lgkmcnt(9)
Ta 168,5,12288
Mvav 228,144,136
Ta 170,5,14336
Mvav 236,144,140
s_waitcnt lgkmcnt(8)
Ta 172,2,16384
Mvav 240,148,136
buffer_load_dwordx4 a[120:123], v7, s[40:43], s7 offen offset:3072 sc1
Ta 174,2,18432
Mvav 248,148,140
s_add_u32 s7, s19, 0x10000
Ta 176,3,16384
Mvav 244,152,136
Ta 178,3,18432
Mvav 252,152,140
s_waitcnt lgkmcnt(8)
Ta 144,4,16384
Mvav 224,156,144
buffer_load_dwordx4 a[132:135], v7, s[40:43], s4 offen sc1
Ta 146,4,18432
Mvav 232,156,148
Ta 148,5,16384
Mvav 228,160,144
Ta 150,5,18432
Mvav 236,160,148
s_waitcnt lgkmcnt(8)
Ta 152,2,20480
Mvav 240,164,144
buffer_load_dwordx4 a[140:143], v7, s[40:43], s4 offen offset:1024 sc1
Ta 154,2,22528
Mvav 248,164,148
Ta 156,3,20480
Mvav 244,168,144
Ta 158,3,22528
Mvav 252,168,148
s_waitcnt lgkmcnt(8)
Ta 160,4,20480
Mvav 224,172,152
buffer_load_dword v17, v16, s[40:43], 0 offen sc1
Ta 162,4,22528
Mvav 232,172,156
Ta 164,5,20480
Mvav 228,176,152
buffer_load_dwordx4 a[240:243], v7, s[40:43], s4 offen offset:2048 sc1
Ta 166,5,22528
Mvav 236,176,156
s_waitcnt lgkmcnt(8)
Ta 168,2,24576
Mvav 240,144,152
Ta 170,2,26624
Mvav 248,144,156
Ta 172,3,24576
Mvav 244,148,152
buffer_load_dwordx4 a[248:251], v7, s[40:43], s4 offen offset:3072 sc1
Ta 174,3,26624
Mvav 252,148,156
s_waitcnt lgkmcnt(8)
Ta 176,4,24576
Mvav 224,152,160
Ta 178,4,26624
Mvav 232,152,164
Ta 144,5,24576
Mvav 228,156,160
Ta 146,5,26624
Mvav 236,156,164
s_waitcnt lgkmcnt(9)
Ta 148,2,28672
Mvav 240,160,160
Ta 150,2,30720
Mvav 248,160,164
s_waitcnt lgkmcnt(8)
Ta 152,3,28672
Mvav 244,164,160
Ta 154,3,30720
Mvav 252,164,164
Ta 156,4,28672
Ta 158,4,30720
Mvav 224,168,168
Ta 160,5,28672
Mvav 232,168,172
s_waitcnt lgkmcnt(9)
Ta 162,5,30720
Mvav 228,172,168
Ta 164,2,32768
Mvav 236,172,172
Ta 166,2,34816
Mvav 240,176,168
Ta 168,3,32768
Mvav 248,176,172
s_waitcnt lgkmcnt(9)
Ta 170,3,34816
Mvav 244,144,168
Ta 172,4,32768
Mvav 252,144,172
Ta 174,4,34816
Mvav 224,148,176
Ta 176,5,32768
Mvav 232,148,180
s_waitcnt lgkmcnt(8)
Ta 178,5,34816
Mvav 228,152,176
Mvav 236,152,180
Mvav 240,156,176
Mvav 248,156,180
s_waitcnt lgkmcnt(5)
Mvav 244,160,176
Mvav 252,160,180
Mvav 224,164,184
Mvav 232,164,188
s_waitcnt lgkmcnt(1)
Mvav 228,168,184
Mvav 236,168,188
Mvav 240,172,184
Mvav 248,172,188
s_waitcnt lgkmcnt(0)
Mvav 244,176,184
Mvav 252,176,188
Mvaa 224,232,0
Mvaa 232,232,32
Mvaa 240,232,64
Mvaa 248,232,96
Mvaa 228,230,2
s_waitcnt vmcnt(2)
v_cmp_ne_u32 vcc, s98, v17
s_cbranch_vccnz L_spin60
L_pollok60:
Mvaa 236,230,34
buffer_load_dwordx4 a[28:31], v7, s[40:43], s6 offen sc1
Mvaa 244,230,66
Mvaa 252,230,98
Mvaa 224,230,6
Mvaa 232,230,38
buffer_load_dwordx4 a[60:63], v7, s[40:43], s6 offen offset:1024 sc1
Mvaa 240,230,70
Mvaa 248,230,102
Mvaa 228,230,10
Mvaa 236,230,42
buffer_load_dwordx4 a[92:95], v7, s[40:43], s6 offen offset:2048 sc1
Mvaa 244,230,74
Mvaa 252,230,106
Mvaa 224,230,14
Mvaa 232,230,46
buffer_load_dwordx4 a[124:127], v7, s[40:43], s6 offen offset:3072 sc1
Mvaa 240,230,78
Mvaa 248,230,110
Mvaa 228,230,18
Mvaa 236,230,50
buffer_load_dwordx4 v[120:123], v7, s[40:43], s7 offen sc1
Mvaa 244,230,82
Mvaa 252,230,114
Mvaa 224,230,22
Mvaa 232,230,54
buffer_load_dwordx4 v[124:127], v7, s[40:43], s7 offen offset:1024 sc1
Mvaa 240,230,86
Mvaa 248,230,118
v_mfma_f32_16x16x32_bf16 a[196:199], a[232:235], a[128:131], 0
v_mfma_f32_16x16x32_bf16 a[204:207], a[232:235], a[136:139], 0
buffer_load_dwordx4 v[128:131], v7, s[40:43], s7 offen offset:2048 sc1
v_mfma_f32_16x16x32_bf16 a[212:215], a[232:235], a[236:239], 0
v_mfma_f32_16x16x32_bf16 a[220:223], a[232:235], a[244:247], 0
v_mfma_f32_16x16x32_bf16 a[200:203], a[230:233], a[130:133], 0
v_mfma_f32_16x16x32_bf16 a[208:211], a[230:233], a[138:141], 0
s_waitcnt vmcnt(8)
buffer_load_dwordx4 v[132:135], v7, s[40:43], s7 offen offset:3072 sc1
v_mfma_f32_16x16x32_bf16 a[216:219], a[230:233], a[238:241], 0
s_waitcnt vmcnt(8)
v_mfma_f32_16x16x32_bf16 a[224:227], a[230:233], a[246:249], 0
Maaa 196,228,132
Maaa 204,228,140
Maaa 212,228,240
Maaa 220,228,248
s_waitcnt vmcnt(7)
Mvaa 228,230,26
s_waitcnt vmcnt(6)
s_nop 0
Mvaa 236,230,58
s_waitcnt vmcnt(5)
s_nop 5
v_mul_f32 v100, 0xbfb8aa3b, v228
v_mul_f32 v101, 0xbfb8aa3b, v229
v_mul_f32 v102, 0xbfb8aa3b, v230
v_mul_f32 v103, 0xbfb8aa3b, v231
v_exp_f32 v100, v100
v_exp_f32 v101, v101
Mvaa 244,230,90
s_waitcnt vmcnt(4)
v_exp_f32 v102, v102
v_exp_f32 v103, v103
v_mul_f32 v108, 0xbfb8aa3b, v236
v_mul_f32 v109, 0xbfb8aa3b, v237
v_mul_f32 v110, 0xbfb8aa3b, v238
v_mul_f32 v111, 0xbfb8aa3b, v239
v_exp_f32 v108, v108
s_nop 0
v_mul_f32 v116, 0xbfb8aa3b, v244
v_mul_f32 v117, 0xbfb8aa3b, v245
v_mul_f32 v118, 0xbfb8aa3b, v246
Mvaa 252,230,122
v_exp_f32 v109, v109
Mvaa 224,228,28
v_exp_f32 v110, v110
Mvaa 232,228,60
v_exp_f32 v111, v111
Mvaa 240,228,92
v_exp_f32 v116, v116
Mvaa 248,228,124
s_waitcnt vmcnt(3)
v_exp_f32 v117, v117
Maav 196,232,120
s_waitcnt vmcnt(2)
v_exp_f32 v118, v118
v_mul_f32 v96, 0xbfb8aa3b, v224
v_mul_f32 v97, 0xbfb8aa3b, v225
v_mul_f32 v98, 0xbfb8aa3b, v226
v_mul_f32 v99, 0xbfb8aa3b, v227
v_exp_f32 v96, v96
v_exp_f32 v97, v97
Maav 204,232,124
s_waitcnt vmcnt(1)
v_exp_f32 v98, v98
v_exp_f32 v99, v99
v_mul_f32 v104, 0xbfb8aa3b, v232
v_mul_f32 v105, 0xbfb8aa3b, v233
v_mul_f32 v112, 0xbfb8aa3b, v240
L_pg5_23:
s_cbranch_execz L_ret5
v_mul_f32 v113, 0xbfb8aa3b, v241
v_mul_f32 v106, 0xbfb8aa3b, v234
v_mul_f32 v107, 0xbfb8aa3b, v235
v_mul_f32 v114, 0xbfb8aa3b, v242
v_mul_f32 v115, 0xbfb8aa3b, v243
v_exp_f32 v104, v104
Maav 212,232,128
s_waitcnt vmcnt(0)
v_exp_f32 v105, v105
v_exp_f32 v112, v112
v_exp_f32 v113, v113
v_mul_f32 v119, 0xbfb8aa3b, v247
v_exp_f32 v106, v106
v_exp_f32 v107, v107
v_exp_f32 v114, v114
v_accvgpr_read_b32 v144, a196
Maav 220,232,132
v_exp_f32 v115, v115
Maav 200,228,120
v_exp_f32 v119, v119
Maav 208,228,124
v_accvgpr_read_b32 v145, a197
v_accvgpr_read_b32 v152, a204
Maav 216,228,128
s_nop 0
v_accvgpr_read_b32 v168, a220
Maav 224,228,132
v_accvgpr_read_b32 v153, a205
v_accvgpr_read_b32 v160, a212
v_accvgpr_read_b32 v161, a213
v_accvgpr_read_b32 v169, a221
v_pk_add_f32 v[96:97], v[96:97], 1.0 op_sel_hi:[1,0]
v_pk_add_f32 v[98:99], v[98:99], 1.0 op_sel_hi:[1,0]
v_rcp_f32 v96, v96
v_rcp_f32 v97, v97
v_pk_add_f32 v[100:101], v[100:101], 1.0 op_sel_hi:[1,0]
v_pk_add_f32 v[102:103], v[102:103], 1.0 op_sel_hi:[1,0]
v_rcp_f32 v98, v98
v_rcp_f32 v99, v99
v_rcp_f32 v100, v100
v_rcp_f32 v101, v101
v_rcp_f32 v102, v102
v_rcp_f32 v103, v103
v_pk_mul_f32 v[224:225], v[224:225], v[96:97]
v_pk_mul_f32 v[226:227], v[226:227], v[98:99]
v_mul_f32 v96, 0xbfb8aa3b, v248
v_mul_f32 v97, 0xbfb8aa3b, v249
v_pk_mul_f32 v[228:229], v[228:229], v[100:101]
v_pk_mul_f32 v[230:231], v[230:231], v[102:103]
v_mul_f32 v98, 0xbfb8aa3b, v250
v_mul_f32 v99, 0xbfb8aa3b, v251
v_exp_f32 v96, v96
v_exp_f32 v97, v97
v_mul_f32 v100, 0xbfb8aa3b, v252
v_mul_f32 v101, 0xbfb8aa3b, v253
v_mul_f32 v102, 0xbfb8aa3b, v254
v_mul_f32 v103, 0xbfb8aa3b, v255
v_exp_f32 v98, v98
v_exp_f32 v99, v99
v_exp_f32 v100, v100
v_exp_f32 v101, v101
v_exp_f32 v102, v102
v_exp_f32 v103, v103
v_pk_add_f32 v[104:105], v[104:105], 1.0 op_sel_hi:[1,0]
v_pk_add_f32 v[112:113], v[112:113], 1.0 op_sel_hi:[1,0]
v_pk_add_f32 v[96:97], v[96:97], 1.0 op_sel_hi:[1,0]
v_pk_add_f32 v[106:107], v[106:107], 1.0 op_sel_hi:[1,0]
v_pk_add_f32 v[114:115], v[114:115], 1.0 op_sel_hi:[1,0]
v_pk_add_f32 v[98:99], v[98:99], 1.0 op_sel_hi:[1,0]
v_rcp_f32 v104, v104
v_rcp_f32 v105, v105
v_pk_add_f32 v[108:109], v[108:109], 1.0 op_sel_hi:[1,0]
v_pk_add_f32 v[110:111], v[110:111], 1.0 op_sel_hi:[1,0]
v_rcp_f32 v112, v112
v_rcp_f32 v113, v113
v_pk_add_f32 v[116:117], v[116:117], 1.0 op_sel_hi:[1,0]
v_pk_add_f32 v[118:119], v[118:119], 1.0 op_sel_hi:[1,0]
v_rcp_f32 v96, v96
v_rcp_f32 v97, v97
v_pk_add_f32 v[100:101], v[100:101], 1.0 op_sel_hi:[1,0]
v_pk_add_f32 v[102:103], v[102:103], 1.0 op_sel_hi:[1,0]
v_rcp_f32 v106, v106
v_rcp_f32 v107, v107
v_rcp_f32 v114, v114
v_rcp_f32 v115, v115
v_rcp_f32 v98, v98
v_rcp_f32 v99, v99
v_rcp_f32 v108, v108
v_rcp_f32 v109, v109
v_rcp_f32 v110, v110
v_rcp_f32 v111, v111
v_rcp_f32 v116, v116
v_rcp_f32 v117, v117
v_rcp_f32 v118, v118
v_rcp_f32 v119, v119
v_rcp_f32 v100, v100
v_rcp_f32 v101, v101
v_rcp_f32 v102, v102
v_rcp_f32 v103, v103
v_pk_mul_f32 v[232:233], v[232:233], v[104:105]
v_pk_mul_f32 v[240:241], v[240:241], v[112:113]
v_pk_mul_f32 v[248:249], v[248:249], v[96:97]
v_pk_mul_f32 v[234:235], v[234:235], v[106:107]
v_pk_mul_f32 v[242:243], v[242:243], v[114:115]
v_pk_mul_f32 v[250:251], v[250:251], v[98:99]
v_accvgpr_read_b32 v146, a198
v_accvgpr_read_b32 v147, a199
v_accvgpr_read_b32 v154, a206
v_accvgpr_read_b32 v155, a207
v_accvgpr_read_b32 v162, a214
v_accvgpr_read_b32 v163, a215
v_accvgpr_read_b32 v170, a222
v_accvgpr_read_b32 v171, a223
v_pk_mul_f32 v[236:237], v[236:237], v[108:109]
v_pk_mul_f32 v[238:239], v[238:239], v[110:111]
v_pk_mul_f32 v[244:245], v[244:245], v[116:117]
v_pk_mul_f32 v[246:247], v[246:247], v[118:119]
v_pk_mul_f32 v[252:253], v[252:253], v[100:101]
v_pk_mul_f32 v[254:255], v[254:255], v[102:103]
v_accvgpr_read_b32 v148, a200
v_accvgpr_read_b32 v149, a201
v_accvgpr_read_b32 v150, a202
v_accvgpr_read_b32 v151, a203
v_accvgpr_read_b32 v156, a208
v_accvgpr_read_b32 v157, a209
v_accvgpr_read_b32 v158, a210
v_accvgpr_read_b32 v159, a211
v_accvgpr_read_b32 v164, a216
v_accvgpr_read_b32 v165, a217
v_accvgpr_read_b32 v166, a218
v_accvgpr_read_b32 v167, a219
v_accvgpr_read_b32 v172, a224
v_accvgpr_read_b32 v173, a225
v_accvgpr_read_b32 v174, a226
v_accvgpr_read_b32 v175, a227
v_pk_fma_f32 v[224:225], v[224:225], v[144:145], v[64:65]
v_pk_fma_f32 v[240:241], v[240:241], v[160:161], v[80:81]
v_pk_fma_f32 v[232:233], v[232:233], v[152:153], v[72:73]
v_pk_fma_f32 v[248:249], v[248:249], v[168:169], v[88:89]
v_pk_fma_f32 v[226:227], v[226:227], v[146:147], v[66:67]
v_pk_fma_f32 v[242:243], v[242:243], v[162:163], v[82:83]
v_pk_fma_f32 v[234:235], v[234:235], v[154:155], v[74:75]
v_pk_fma_f32 v[250:251], v[250:251], v[170:171], v[90:91]
v_pk_fma_f32 v[228:229], v[228:229], v[148:149], v[68:69]
v_pk_fma_f32 v[230:231], v[230:231], v[150:151], v[70:71]
CV 224,224,225
v_pk_fma_f32 v[244:245], v[244:245], v[164:165], v[84:85]
v_pk_fma_f32 v[246:247], v[246:247], v[166:167], v[86:87]
CV 240,240,241
v_pk_fma_f32 v[236:237], v[236:237], v[156:157], v[76:77]
v_pk_fma_f32 v[238:239], v[238:239], v[158:159], v[78:79]
CV 232,232,233
v_pk_fma_f32 v[252:253], v[252:253], v[172:173], v[92:93]
v_pk_fma_f32 v[254:255], v[254:255], v[174:175], v[94:95]
CV 248,248,249
CV 225,226,227
CV 241,242,243
CV 233,234,235
CV 249,250,251
CV 226,228,229
CV 227,230,231
CV 242,244,245
CV 243,246,247
CV 234,236,237
CV 235,238,239
CV 250,252,253
CV 251,254,255
v_permlane32_swap_b32 v224, v226
v_permlane32_swap_b32 v225, v227
v_permlane32_swap_b32 v240, v242
v_permlane32_swap_b32 v241, v243
v_permlane32_swap_b32 v232, v234
v_permlane32_swap_b32 v233, v235
v_permlane32_swap_b32 v248, v250
v_permlane32_swap_b32 v249, v251
v_permlane16_swap_b32 v224, v226
v_permlane16_swap_b32 v225, v227
v_permlane16_swap_b32 v240, v242
v_permlane16_swap_b32 v241, v243
v_permlane16_swap_b32 v232, v234
v_permlane16_swap_b32 v233, v235
v_permlane16_swap_b32 v248, v250
v_permlane16_swap_b32 v249, v251
buffer_store_dwordx4 v[224:227], v12, s[60:63], s75 offen sc1
buffer_store_dwordx4 v[240:243], v12, s[60:63], s75 offen offset:64 sc1
buffer_store_dwordx4 v[232:235], v12, s[60:63], s18 offen sc1
buffer_store_dwordx4 v[248:251], v12, s[60:63], s18 offen offset:64 sc1
s_cmp_lg_u32 s14, 0
s_cbranch_scc1 L_epdone
buffer_store_dword v47, off, s[40:43], s9 sc1
L_epdone:
s_endpgm
L_hss46:
buffer_store_dwordx2 v[192:193], v196, s[40:43], s78 offen sc1
s_add_u32 s5, s25, 32
v_add_u32 v197, s5, v197
v_lshrrev_b32 v197, 5, v197
v_mul_u32_u24 v197, 36352, v197
v_add_u32 v197, v197, v6
s_lshl_b32 s5, s25, 5
s_add_u32 s5, s78, s5
buffer_store_dwordx2 v[194:195], v197, s[40:43], s5 offen offset:8 sc1
s_branch L_hs46
L_hss47:
buffer_store_dwordx2 v[200:201], v204, s[40:43], s79 offen sc1
s_add_u32 s6, s25, 48
v_add_u32 v205, s6, v205
v_lshrrev_b32 v205, 5, v205
v_mul_u32_u24 v205, 36352, v205
v_add_u32 v205, v205, v6
s_lshl_b32 s6, s25, 5
s_add_u32 s6, s79, s6
buffer_store_dwordx2 v[202:203], v205, s[40:43], s6 offen offset:8 sc1
s_branch L_hs47
L_hss48:
buffer_store_dwordx2 v[208:209], v212, s[40:43], s80 offen sc1
s_add_u32 s7, s27, 32
v_add_u32 v213, s7, v213
v_lshrrev_b32 v213, 5, v213
v_mul_u32_u24 v213, 36352, v213
v_add_u32 v213, v213, v6
s_lshl_b32 s7, s27, 5
s_add_u32 s7, s80, s7
buffer_store_dwordx2 v[210:211], v213, s[40:43], s7 offen offset:8 sc1
s_branch L_hs48
L_hss49:
buffer_store_dwordx2 v[216:217], v220, s[40:43], s81 offen sc1
s_add_u32 s4, s27, 48
v_add_u32 v221, s4, v221
v_lshrrev_b32 v221, 5, v221
v_mul_u32_u24 v221, 36352, v221
v_add_u32 v221, v221, v6
s_lshl_b32 s4, s27, 5
s_add_u32 s4, s81, s4
buffer_store_dwordx2 v[218:219], v221, s[40:43], s4 offen offset:8 sc1
s_branch L_hs49
L_spin50:
s_mov_b32 s91, 0x8000
L_spinl50:
s_sleep 2
buffer_load_dword v17, v16, s[40:43], 0 offen sc1
s_waitcnt vmcnt(0)
v_cmp_ne_u32 vcc, s98, v17
s_cbranch_vccz L_pollok50
s_sub_u32 s91, s91, 1
s_cmp_lg_u32 s91, 0
s_cbranch_scc1 L_spinl50
s_branch L_pollok50
L_spin51:
s_mov_b32 s91, 0x8000
L_spinl51:
s_sleep 2
buffer_load_dword v17, v16, s[40:43], 0 offen sc1
s_waitcnt vmcnt(0)
v_cmp_ne_u32 vcc, s98, v17
s_cbranch_vccz L_pollok51
s_sub_u32 s91, s91, 1
s_cmp_lg_u32 s91, 0
s_cbranch_scc1 L_spinl51
s_branch L_pollok51
L_spin52:
s_mov_b32 s91, 0x8000
L_spinl52:
s_sleep 2
buffer_load_dword v17, v16, s[40:43], 0 offen sc1
s_waitcnt vmcnt(0)
v_cmp_ne_u32 vcc, s98, v17
s_cbranch_vccz L_pollok52
s_sub_u32 s91, s91, 1
s_cmp_lg_u32 s91, 0
s_cbranch_scc1 L_spinl52
s_branch L_pollok52
L_spin53:
s_mov_b32 s91, 0x8000
L_spinl53:
s_sleep 2
buffer_load_dword v17, v16, s[40:43], 0 offen sc1
s_waitcnt vmcnt(0)
v_cmp_ne_u32 vcc, s98, v17
s_cbranch_vccz L_pollok53
s_sub_u32 s91, s91, 1
s_cmp_lg_u32 s91, 0
s_cbranch_scc1 L_spinl53
s_branch L_pollok53
L_spin54:
s_mov_b32 s91, 0x8000
L_spinl54:
s_sleep 2
buffer_load_dword v17, v16, s[40:43], 0 offen sc1
s_waitcnt vmcnt(0)
v_cmp_ne_u32 vcc, s98, v17
s_cbranch_vccz L_pollok54
s_sub_u32 s91, s91, 1
s_cmp_lg_u32 s91, 0
s_cbranch_scc1 L_spinl54
s_branch L_pollok54
L_spin55:
s_mov_b32 s91, 0x8000
L_spinl55:
s_sleep 2
buffer_load_dword v17, v16, s[40:43], 0 offen sc1
s_waitcnt vmcnt(0)
v_cmp_ne_u32 vcc, s98, v17
s_cbranch_vccz L_pollok55
s_sub_u32 s91, s91, 1
s_cmp_lg_u32 s91, 0
s_cbranch_scc1 L_spinl55
s_branch L_pollok55
L_spin56:
s_mov_b32 s91, 0x8000
L_spinl56:
s_sleep 2
buffer_load_dword v17, v16, s[40:43], 0 offen sc1
s_waitcnt vmcnt(0)
v_cmp_ne_u32 vcc, s98, v17
s_cbranch_vccz L_pollok56
s_sub_u32 s91, s91, 1
s_cmp_lg_u32 s91, 0
s_cbranch_scc1 L_spinl56
s_branch L_pollok56
L_spin57:
s_mov_b32 s91, 0x8000
L_spinl57:
s_sleep 2
buffer_load_dword v17, v16, s[40:43], 0 offen sc1
s_waitcnt vmcnt(0)
v_cmp_ne_u32 vcc, s98, v17
s_cbranch_vccz L_pollok57
s_sub_u32 s91, s91, 1
s_cmp_lg_u32 s91, 0
s_cbranch_scc1 L_spinl57
s_branch L_pollok57
L_spin58:
s_mov_b32 s91, 0x8000
L_spinl58:
s_sleep 2
buffer_load_dword v17, v16, s[40:43], 0 offen sc1
s_waitcnt vmcnt(0)
v_cmp_ne_u32 vcc, s98, v17
s_cbranch_vccz L_pollok58
s_sub_u32 s91, s91, 1
s_cmp_lg_u32 s91, 0
s_cbranch_scc1 L_spinl58
s_branch L_pollok58
L_spin59:
s_mov_b32 s91, 0x8000
L_spinl59:
s_sleep 2
buffer_load_dword v17, v16, s[40:43], 0 offen sc1
s_waitcnt vmcnt(0)
v_cmp_ne_u32 vcc, s98, v17
s_cbranch_vccz L_pollok59
s_sub_u32 s91, s91, 1
s_cmp_lg_u32 s91, 0
s_cbranch_scc1 L_spinl59
s_branch L_pollok59
L_spin60:
s_mov_b32 s91, 0x8000
L_spinl60:
s_sleep 2
buffer_load_dword v17, v16, s[40:43], 0 offen sc1
s_waitcnt vmcnt(0)
v_cmp_ne_u32 vcc, s98, v17
s_cbranch_vccz L_pollok60
s_sub_u32 s91, s91, 1
s_cmp_lg_u32 s91, 0
s_cbranch_scc1 L_spinl60
s_branch L_pollok60
.globl recurrent_scan__sliding_block_cached__mixer_s_mlp__prompt_kernel
.p2align 12
.type recurrent_scan__sliding_block_cached__mixer_s_mlp__prompt_kernel,@function
recurrent_scan__sliding_block_cached__mixer_s_mlp__prompt_kernel:
s_getpc_b64 s[96:97]
L_pc:
s_bfe_u32 s82, s2, 0x50003
s_lshl_b32 s82, s82, 13
s_sub_u32 s96, s96, L_pc-L_B1
s_subb_u32 s97, s97, 0
v_lshl_add_u32 v47, v0, 5, s82
global_load_dword v203, v47, s[96:97]
s_mov_b32 s89, 0
s_mov_b32 s98, 0
v_mov_b32 v7, v0
L_restart:
s_load_dwordx2 s[32:33], s[0:1], 0
s_load_dwordx16 s[4:19], s[0:1], 0
s_load_dwordx8 s[20:27], s[0:1], 64
s_load_dwordx2 s[28:29], s[0:1], 96
s_cmpk_ge_u32 s2, 256
s_cbranch_scc1 L_exit
s_mov_b32 s34, 0x240000
s_mov_b32 s35, 0x20000
v_lshrrev_b32 v46, 6, v7
v_and_b32 v1, 63, v7
v_readfirstlane_b32 s64, v46
v_min_u32 v46, 0x47, v7
v_lshlrev_b32 v46, 7, v46
s_mul_i32 s77, s2, 0x2400
s_waitcnt lgkmcnt(0)
buffer_load_dword v202, v46, s[32:35], s77 offen
s_bfe_u32 s82, s2, 0x40003
s_lshl_b32 s30, s82, 2
s_add_u32 s30, s30, s64
s_and_b32 s83, s2, 7
s_lshr_b32 s65, s83, 2
s_lshl_b32 s65, s65, 3
s_and_b32 s84, s82, 7
s_add_u32 s65, s65, s84
s_lshr_b32 s66, s82, 3
s_lshl_b32 s66, s66, 2
s_and_b32 s83, s83, 3
s_add_u32 s66, s66, s83
s_lshl_b32 s94, s65, 2
s_add_u32 s94, s94, s64
s_cmp_lt_u32 s2, 128
s_cselect_b32 s83, 4, 0
s_and_b32 s87, s66, 5
s_cmp_lg_u32 s87, s83
s_cselect_b32 s87, 1, 0
s_and_b32 s83, s66, 1
s_cmp_lt_u32 s2, 128
s_cselect_b32 s83, 1, s83
s_mul_i32 s83, s83, 0x12000
s_lshl_b32 s82, s64, 14
s_add_u32 s83, s83, s82
s_mul_i32 s82, s94, 0x9000
v_lshrrev_b32 v47, 4, v1
v_and_b32 v192, 7, v1
v_xor_b32 v192, v192, v47
v_lshrrev_b32 v47, 3, v1
v_mul_u32_u24 v47, 0x480, v47
v_lshl_add_u32 v192, v192, 4, v47
v_xor_b32 v193, 64, v192
v_add_u32 v194, 0x4000, v192
v_add_u32 v195, 0x6000, v193
v_add_u32 v193, 0x2000, v193
s_add_u32 m0, s83, 0
s_add_u32 s76, s82, 0
LD 192,32,76,0
LD 193,32,76,1024
LD 194,32,76,2048
LD 195,32,76,3072
s_add_u32 m0, s83, 0x1000
s_add_u32 s76, s82, 0x80
LD 192,32,76,0
LD 193,32,76,1024
LD 194,32,76,2048
LD 195,32,76,3072
s_mul_i32 s67, s64, 0x2400
s_lshl_b32 s68, s64, 13
s_lshl_b32 s69, s64, 12
s_and_b32 s100, s94, 63
s_mov_b32 s86, 0x3f80
s_mov_b32 s88, 0x3f803f80
s_mov_b32 s90, 0xffff0000
s_lshl_b32 s99, s94, 7
s_add_u32 s99, s99, 0x3000000
s_lshl_b32 s101, s94, 3
s_add_u32 s101, s101, s66
s_lshl_b32 s101, s101, 15
s_add_u32 s101, s101, 0x3100000
s_mov_b32 s40, s28
s_mov_b32 s41, s29
s_mov_b32 s42, 0x10000000
s_mov_b32 s43, 0x20000
s_mov_b32 s36, s10
s_mov_b32 s37, s11
s_mov_b32 s38, 0x480000
s_mov_b32 s39, 0x20000
s_cmp_ge_u32 s2, 128
s_cbranch_scc1 L_roleA
L_roleB:
s_mov_b32 s44, s16
s_mov_b32 s45, s17
s_mov_b32 s46, 0xa2000
s_mov_b32 s47, 0x20000
v_min_u32 v46, 8, v1
v_mul_u32_u24 v46, 0x480, v46
s_mul_i32 s77, s100, 0x2880
s_mul_i32 s85, s66, 0x80
s_add_u32 s77, s77, s85
buffer_load_dword v206, v46, s[44:47], s77 offen
v_min_u32 v46, 8, v1
v_mul_u32_u24 v46, 0x2000, v46
s_mul_i32 s77, s100, 0x12000
s_mul_i32 s85, s66, 0x400
s_add_u32 s77, s77, s85
s_add_u32 s77, s77, 0x200
buffer_load_dword v207, v46, s[36:39], s77 offen
s_mov_b32 s85, 0x300f000
buffer_load_dword v255, off, s[40:43], s85 sc1
s_mov_b32 s48, s18
s_mov_b32 s49, s19
s_mov_b32 s50, 0xa2000
s_mov_b32 s51, 0x20000
s_mov_b32 s52, s20
s_mov_b32 s53, s21
s_mov_b32 s54, 0x510000
s_mov_b32 s55, 0x20000
s_mov_b32 s56, s22
s_mov_b32 s57, s23
s_mov_b32 s58, 0x510000
s_mov_b32 s59, 0x20000
s_mov_b32 s60, s24
s_mov_b32 s61, s25
s_mov_b32 s62, 0x240000
s_mov_b32 s63, 0x20000
v_lshrrev_b32 v200, 4, v1
v_and_b32 v201, 15, v1
v_lshrrev_b32 v2, 2, v1
v_lshlrev_b32 v2, 7, v2
v_bfe_u32 v46, v1, 3, 2
v_lshl_add_u32 v2, v46, 5, v2
v_and_b32 v46, 3, v1
v_lshl_add_u32 v2, v46, 3, v2
v_xor_b32 v3, 32, v2
v_xor_b32 v4, 64, v2
v_xor_b32 v5, 0x60, v2
v_lshlrev_b32 v7, 4, v1
v_lshlrev_b32 v46, 9, v200
v_lshl_add_u32 v6, v201, 4, v46
v_add_u32 v6, s82, v6
s_lshl_b32 s84, s94, 5
v_mov_b32 v38, 0x40000000
v_add3_u32 v47, v201, s84, -1
v_cmp_gt_u32 vcc, 0x800, v47
v_add_u32 v31, 0, v6
s_nop 0
v_cndmask_b32 v31, v38, v31, vcc
v_add3_u32 v47, v201, s84, 17
v_cmp_gt_u32 vcc, 0x800, v47
v_add_u32 v32, 0x100, v6
s_nop 0
v_cndmask_b32 v32, v38, v32, vcc
v_add3_u32 v47, v201, s84, -2
v_cmp_gt_u32 vcc, 0x800, v47
v_add_u32 v33, 0, v6
s_nop 0
v_cndmask_b32 v33, v38, v33, vcc
v_add3_u32 v47, v201, s84, 18
v_cmp_gt_u32 vcc, 0x800, v47
v_add_u32 v34, 0x100, v6
s_nop 0
v_cndmask_b32 v34, v38, v34, vcc
v_lshrrev_b32 v47, 1, v201
v_xor_b32 v47, v47, v200
v_lshlrev_b32 v46, 7, v201
v_lshl_add_u32 v196, v47, 4, v46
v_add_u32 v196, s83, v196
v_xor_b32 v197, 64, v196
v_mov_b32 v240, 0
v_mov_b32 v241, 0
v_mov_b32 v242, 0
v_mov_b32 v243, 0
v_lshrrev_b32 v46, 3, v1
v_and_b32 v47, 6, v46
v_and_b32 v12, 7, v1
v_xor_b32 v12, v12, v47
v_mul_u32_u24 v46, 0x2400, v46
v_lshl_add_u32 v12, v12, 4, v46
v_add_u32 v13, 0x11c00, v12
v_add_u32 v14, 0x23800, v12
v_add_u32 v15, 0x35400, v12
v_lshrrev_b32 v46, 3, v1
v_and_b32 v47, 6, v46
v_and_b32 v20, 7, v1
v_xor_b32 v20, v20, v47
v_mul_u32_u24 v46, 0x2000, v46
v_lshl_add_u32 v20, v20, 4, v46
v_add_u32 v21, 0xfc00, v20
v_add_u32 v22, 0x1f800, v20
v_add_u32 v23, 0x2f400, v20
v_lshrrev_b32 v46, 3, v1
v_and_b32 v47, 6, v46
v_and_b32 v8, 7, v1
v_xor_b32 v8, v8, v47
v_mul_u32_u24 v46, 0x480, v46
v_lshl_add_u32 v8, v8, 4, v46
v_add_u32 v9, 0x2000, v8
v_add_u32 v10, 0x4000, v8
v_add_u32 v11, 0x6000, v8
s_mul_i32 s95, s64, 0x90000
s_lshl_b32 s84, s66, 10
s_add_u32 s95, s95, s84
s_lshl_b32 s75, s66, 7
s_lshl_b32 s29, s66, 12
s_mul_i32 s28, s64, 0x14400
s_mul_i32 s74, s66, 0xa2000
s_add_u32 s74, s74, s28
s_add_u32 s28, s28, s75
s_mul_i32 s73, s64, 0xa2000
s_mul_i32 s84, s66, 0x480
s_add_u32 s73, s73, s84
s_mul_i32 s71, s66, 0xa2000
s_add_u32 s71, s71, s67
s_add_u32 s71, s71, 0x4400000
s_mul_i32 s70, s64, 0x14400
s_add_u32 s70, s70, 0x400
s_bfe_u32 s31, s66, 0x10001
s_lshl_b32 s72, s31, 11
s_add_u32 s72, s72, 0x8000
s_add_u32 s31, s31, 8
v_and_b32 v208, 15, v1
v_lshrrev_b32 v210, 4, v1
v_lshlrev_b32 v210, 3, v210
v_sub_u32 v208, v208, v210
v_and_b32 v210, 1, v208
v_lshlrev_b32 v210, 4, v210
v_lshlrev_b32 v209, v210, s86
v_ashrrev_i32 v208, 1, v208
v_cmp_eq_u32 vcc, 0, v208
s_nop 1
v_cndmask_b32 v210, 0, v209, vcc
v_accvgpr_write_b32 a236, v210
v_cmp_eq_u32 vcc, 1, v208
s_nop 1
v_cndmask_b32 v210, 0, v209, vcc
v_accvgpr_write_b32 a237, v210
v_cmp_eq_u32 vcc, 2, v208
s_nop 1
v_cndmask_b32 v210, 0, v209, vcc
v_accvgpr_write_b32 a238, v210
v_cmp_eq_u32 vcc, 3, v208
s_nop 1
v_cndmask_b32 v210, 0, v209, vcc
v_accvgpr_write_b32 a239, v210
v_cmp_eq_u32 vcc, -8, v208
s_nop 1
v_cndmask_b32 v210, 0, v209, vcc
v_accvgpr_write_b32 a240, v210
v_cmp_eq_u32 vcc, -7, v208
s_nop 1
v_cndmask_b32 v210, 0, v209, vcc
v_accvgpr_write_b32 a241, v210
v_cmp_eq_u32 vcc, -6, v208
s_nop 1
v_cndmask_b32 v210, 0, v209, vcc
v_accvgpr_write_b32 a242, v210
v_cmp_eq_u32 vcc, -5, v208
s_nop 1
v_cndmask_b32 v210, 0, v209, vcc
v_accvgpr_write_b32 a243, v210
v_and_b32 v208, 15, v1
v_lshrrev_b32 v210, 4, v1
v_lshlrev_b32 v210, 2, v210
v_sub_u32 v208, v208, v210
v_and_b32 v210, 1, v208
v_lshlrev_b32 v210, 4, v210
v_lshlrev_b32 v209, v210, s86
v_ashrrev_i32 v208, 1, v208
v_accvgpr_write_b32 a228, 0
v_accvgpr_write_b32 a229, 0
v_cmp_eq_u32 vcc, 0, v208
s_nop 1
v_cndmask_b32 v210, 0, v209, vcc
v_accvgpr_write_b32 a230, v210
v_cmp_eq_u32 vcc, 1, v208
s_nop 1
v_cndmask_b32 v210, 0, v209, vcc
v_accvgpr_write_b32 a231, v210
v_cmp_eq_u32 vcc, 0, v208
s_nop 1
v_cndmask_b32 v210, 0, v209, vcc
v_accvgpr_write_b32 a232, v210
v_cmp_eq_u32 vcc, 1, v208
s_nop 1
v_cndmask_b32 v210, 0, v209, vcc
v_accvgpr_write_b32 a233, v210
v_accvgpr_write_b32 a234, 0
v_accvgpr_write_b32 a235, 0
s_cmp_lg_u32 s87, 0
s_cbranch_scc1 L_B1
s_branch L_B0
L_exit:
s_endpgm
L_roleA:
v_min_u32 v46, 8, v1
v_mul_u32_u24 v46, 0x2000, v46
s_mul_i32 s77, s100, 0x12000
s_mul_i32 s85, s66, 0x400
s_add_u32 s77, s77, s85
buffer_load_dword v206, v46, s[36:39], s77 offen
v_min_u32 v46, 8, v1
v_mul_u32_u24 v46, 0x2000, v46
s_mul_i32 s77, s100, 0x12000
s_mul_i32 s85, s66, 0x400
s_add_u32 s77, s77, s85
s_add_u32 s77, s77, 0x80
buffer_load_dword v207, v46, s[36:39], s77 offen
s_mov_b32 s85, 0x300f000
buffer_load_dword v255, off, s[40:43], s85 sc1
s_mov_b32 s44, s6
s_mov_b32 s45, s7
s_mov_b32 s46, 0x800000
s_mov_b32 s47, 0x20000
s_mov_b32 s48, s8
s_mov_b32 s49, s9
s_mov_b32 s50, 0x800000
s_mov_b32 s51, 0x20000
s_mov_b32 s52, s12
s_mov_b32 s53, s13
s_mov_b32 s54, 0x480000
s_mov_b32 s55, 0x20000
s_mov_b32 s56, s16
s_mov_b32 s57, s17
s_mov_b32 s58, 0xa2000
s_mov_b32 s59, 0x20000
s_mov_b32 s60, s24
s_mov_b32 s61, s25
s_mov_b32 s62, 0x240000
s_mov_b32 s63, 0x20000
s_mov_b32 s24, s20
s_mov_b32 s25, s21
s_mov_b32 s26, 0x510000
s_mov_b32 s27, 0x20000
v_lshrrev_b32 v200, 4, v1
v_and_b32 v201, 15, v1
v_lshrrev_b32 v2, 2, v1
v_lshlrev_b32 v2, 7, v2
v_bfe_u32 v46, v1, 3, 2
v_lshl_add_u32 v2, v46, 5, v2
v_and_b32 v46, 3, v1
v_lshl_add_u32 v2, v46, 3, v2
v_xor_b32 v3, 32, v2
v_xor_b32 v4, 64, v2
v_xor_b32 v5, 0x60, v2
v_lshlrev_b32 v7, 4, v1
v_lshlrev_b32 v46, 9, v200
v_lshl_add_u32 v6, v201, 4, v46
v_add_u32 v6, s82, v6
s_lshl_b32 s84, s94, 5
v_mov_b32 v38, 0x40000000
v_add3_u32 v47, v201, s84, -1
v_cmp_gt_u32 vcc, 0x800, v47
v_add_u32 v31, 0, v6
s_nop 0
v_cndmask_b32 v31, v38, v31, vcc
v_add3_u32 v47, v201, s84, 17
v_cmp_gt_u32 vcc, 0x800, v47
v_add_u32 v32, 0x100, v6
s_nop 0
v_cndmask_b32 v32, v38, v32, vcc
v_add3_u32 v47, v201, s84, -2
v_cmp_gt_u32 vcc, 0x800, v47
v_add_u32 v33, 0, v6
s_nop 0
v_cndmask_b32 v33, v38, v33, vcc
v_add3_u32 v47, v201, s84, 18
v_cmp_gt_u32 vcc, 0x800, v47
v_add_u32 v34, 0x100, v6
s_nop 0
v_cndmask_b32 v34, v38, v34, vcc
v_lshrrev_b32 v47, 1, v201
v_xor_b32 v47, v47, v200
v_lshlrev_b32 v46, 7, v201
v_lshl_add_u32 v196, v47, 4, v46
v_add_u32 v196, s83, v196
v_xor_b32 v197, 64, v196
v_mov_b32 v240, 0
v_mov_b32 v241, 0
v_mov_b32 v242, 0
v_mov_b32 v243, 0
v_lshrrev_b32 v46, 3, v1
v_and_b32 v47, 6, v46
v_and_b32 v20, 7, v1
v_xor_b32 v20, v20, v47
v_mul_u32_u24 v46, 0x2000, v46
v_lshl_add_u32 v20, v20, 4, v46
v_add_u32 v21, 0xfc00, v20
v_add_u32 v22, 0x1f800, v20
v_add_u32 v23, 0x2f400, v20
v_lshrrev_b32 v46, 3, v1
v_and_b32 v47, 6, v46
v_and_b32 v8, 7, v1
v_xor_b32 v8, v8, v47
v_mul_u32_u24 v46, 0x480, v46
v_lshl_add_u32 v8, v8, 4, v46
v_add_u32 v9, 0x2000, v8
v_add_u32 v10, 0x4000, v8
v_add_u32 v11, 0x6000, v8
v_lshrrev_b32 v46, 3, v1
v_and_b32 v47, 6, v46
v_and_b32 v16, 7, v1
v_xor_b32 v16, v16, v47
v_mul_u32_u24 v46, 0x100, v46
v_lshl_add_u32 v16, v16, 4, v46
v_add_u32 v17, 0x400, v16
v_add_u32 v18, 0x800, v16
v_add_u32 v19, 0xc00, v16
s_mul_i32 s95, s64, 0x90000
s_lshl_b32 s84, s66, 10
s_add_u32 s95, s95, s84
s_mul_i32 s70, s64, 0x14400
s_add_u32 s70, s70, 0x400
s_bfe_u32 s31, s66, 0x10001
s_lshl_b32 s72, s31, 11
s_add_u32 s72, s72, 0x8000
s_add_u32 s31, s31, 8
s_mov_b64 s[28:29], s[22:23]
s_lshl_b32 s73, s66, 20
s_add_u32 s71, s73, s69
s_lshr_b32 s84, s64, 1
s_lshl_b32 s84, s84, 13
s_add_u32 s73, s73, s84
s_and_b32 s84, s64, 1
s_lshl_b32 s84, s84, 7
s_add_u32 s73, s73, s84
s_mul_i32 s74, s66, 0x90000
s_mul_i32 s84, s64, 0x12000
s_add_u32 s74, s74, s84
v_lshrrev_b32 v46, 4, v1
v_and_b32 v12, 15, v1
v_xor_b32 v12, v12, v46
v_lshlrev_b32 v46, 8, v46
v_lshl_add_u32 v12, v12, 4, v46
v_xor_b32 v13, 64, v12
v_xor_b32 v14, 0x80, v12
v_xor_b32 v15, 0xc0, v12
v_and_b32 v208, 15, v1
v_lshrrev_b32 v210, 4, v1
v_lshlrev_b32 v210, 3, v210
v_sub_u32 v208, v208, v210
v_and_b32 v210, 1, v208
v_lshlrev_b32 v210, 4, v210
v_lshlrev_b32 v209, v210, s86
v_ashrrev_i32 v208, 1, v208
v_cmp_eq_u32 vcc, 0, v208
s_nop 1
v_cndmask_b32 v210, 0, v209, vcc
v_accvgpr_write_b32 a248, v210
v_cmp_eq_u32 vcc, 1, v208
s_nop 1
v_cndmask_b32 v210, 0, v209, vcc
v_accvgpr_write_b32 a249, v210
v_cmp_eq_u32 vcc, 2, v208
s_nop 1
v_cndmask_b32 v210, 0, v209, vcc
v_accvgpr_write_b32 a250, v210
v_cmp_eq_u32 vcc, 3, v208
s_nop 1
v_cndmask_b32 v210, 0, v209, vcc
v_accvgpr_write_b32 a251, v210
v_cmp_eq_u32 vcc, -8, v208
s_nop 1
v_cndmask_b32 v210, 0, v209, vcc
v_accvgpr_write_b32 a252, v210
v_cmp_eq_u32 vcc, -7, v208
s_nop 1
v_cndmask_b32 v210, 0, v209, vcc
v_accvgpr_write_b32 a253, v210
v_cmp_eq_u32 vcc, -6, v208
s_nop 1
v_cndmask_b32 v210, 0, v209, vcc
v_accvgpr_write_b32 a254, v210
v_cmp_eq_u32 vcc, -5, v208
s_nop 1
v_cndmask_b32 v210, 0, v209, vcc
v_accvgpr_write_b32 a255, v210
s_bitcmp1_b32 s66, 0
s_cbranch_scc1 L_A1
s_cmp_gt_u32 s66, 3
s_cbranch_scc1 L_A2
s_branch L_A0
.p2align 12
L_B0:
s_branch L_Bmain
L_endB:
.p2align 12
L_A2:
s_add_u32 m0, s83, 0x2000
s_add_u32 s76, s82, 0x100
LD 192,32,76,0
LD 193,32,76,1024
LD 194,32,76,2048
LD 195,32,76,3072
s_add_u32 m0, s83, 0x3000
s_add_u32 s76, s82, 0x180
LD 192,32,76,0
LD 193,32,76,1024
LD 194,32,76,2048
LD 195,32,76,3072
s_mov_b64 exec, 0
s_cmp_eq_u32 s64, 0
s_cbranch_scc1 L_pg6_1
s_cmp_eq_u32 s64, 1
s_cbranch_scc1 L_pg6_2
s_cmp_eq_u32 s64, 2
s_cbranch_scc1 L_pg6_3
s_branch L_pg6_4
L_ret6:
s_mov_b64 exec, -1
s_mov_b64 exec, 0
s_cmp_eq_u32 s64, 0
s_cbranch_scc1 L_pg7_5
s_cmp_eq_u32 s64, 1
s_cbranch_scc1 L_pg7_6
s_cmp_eq_u32 s64, 2
s_cbranch_scc1 L_ret7
s_branch L_ret7
L_ret7:
s_mov_b64 exec, -1
s_waitcnt vmcnt(15)
ds_read_b128 v[48:51], v196
ds_read_b128 v[52:55], v196 offset:2048
ds_read_b128 v[56:59], v197
ds_read_b128 v[60:63], v197 offset:2048
s_add_u32 m0, s83, 0
s_add_u32 s76, s82, 0x200
s_waitcnt lgkmcnt(0)
LD 192,32,76,0
LD 193,32,76,1024
LD 194,32,76,2048
LD 195,32,76,3072
s_waitcnt vmcnt(15)
ds_read_b128 v[64:67], v196 offset:4096
ds_read_b128 v[68:71], v196 offset:6144
ds_read_b128 v[72:75], v197 offset:4096
ds_read_b128 v[76:79], v197 offset:6144
v_dot2_f32_bf16 v240, v48, s88, v240
v_dot2_f32_bf16 v242, v48, v48, v242
v_dot2_f32_bf16 v241, v52, s88, v241
v_dot2_f32_bf16 v243, v52, v52, v243
v_dot2_f32_bf16 v240, v49, s88, v240
v_dot2_f32_bf16 v242, v49, v49, v242
v_dot2_f32_bf16 v241, v53, s88, v241
v_dot2_f32_bf16 v243, v53, v53, v243
v_dot2_f32_bf16 v240, v50, s88, v240
v_dot2_f32_bf16 v242, v50, v50, v242
v_dot2_f32_bf16 v241, v54, s88, v241
v_dot2_f32_bf16 v243, v54, v54, v243
v_dot2_f32_bf16 v240, v51, s88, v240
v_dot2_f32_bf16 v242, v51, v51, v242
v_dot2_f32_bf16 v241, v55, s88, v241
v_dot2_f32_bf16 v243, v55, v55, v243
v_dot2_f32_bf16 v240, v56, s88, v240
v_dot2_f32_bf16 v242, v56, v56, v242
v_dot2_f32_bf16 v241, v60, s88, v241
v_dot2_f32_bf16 v243, v60, v60, v243
v_dot2_f32_bf16 v240, v57, s88, v240
v_dot2_f32_bf16 v242, v57, v57, v242
v_dot2_f32_bf16 v241, v61, s88, v241
v_dot2_f32_bf16 v243, v61, v61, v243
v_dot2_f32_bf16 v240, v58, s88, v240
v_dot2_f32_bf16 v242, v58, v58, v242
v_dot2_f32_bf16 v241, v62, s88, v241
v_dot2_f32_bf16 v243, v62, v62, v243
v_dot2_f32_bf16 v240, v59, s88, v240
v_dot2_f32_bf16 v242, v59, v59, v242
v_dot2_f32_bf16 v241, v63, s88, v241
v_dot2_f32_bf16 v243, v63, v63, v243
s_add_u32 m0, s83, 0x1000
s_add_u32 s76, s82, 0x280
s_waitcnt lgkmcnt(0)
LD 192,32,76,0
LD 193,32,76,1024
LD 194,32,76,2048
LD 195,32,76,3072
s_waitcnt vmcnt(12)
ds_read_b128 v[80:83], v196 offset:8192
ds_read_b128 v[84:87], v196 offset:10240
ds_read_b128 v[88:91], v197 offset:8192
ds_read_b128 v[92:95], v197 offset:10240
v_dot2_f32_bf16 v240, v64, s88, v240
v_dot2_f32_bf16 v242, v64, v64, v242
v_dot2_f32_bf16 v241, v68, s88, v241
v_dot2_f32_bf16 v243, v68, v68, v243
v_dot2_f32_bf16 v240, v65, s88, v240
v_dot2_f32_bf16 v242, v65, v65, v242
v_dot2_f32_bf16 v241, v69, s88, v241
v_dot2_f32_bf16 v243, v69, v69, v243
v_dot2_f32_bf16 v240, v66, s88, v240
v_dot2_f32_bf16 v242, v66, v66, v242
v_dot2_f32_bf16 v241, v70, s88, v241
v_dot2_f32_bf16 v243, v70, v70, v243
v_dot2_f32_bf16 v240, v67, s88, v240
v_dot2_f32_bf16 v242, v67, v67, v242
v_dot2_f32_bf16 v241, v71, s88, v241
v_dot2_f32_bf16 v243, v71, v71, v243
v_dot2_f32_bf16 v240, v72, s88, v240
v_dot2_f32_bf16 v242, v72, v72, v242
v_dot2_f32_bf16 v241, v76, s88, v241
v_dot2_f32_bf16 v243, v76, v76, v243
v_dot2_f32_bf16 v240, v73, s88, v240
v_dot2_f32_bf16 v242, v73, v73, v242
v_dot2_f32_bf16 v241, v77, s88, v241
v_dot2_f32_bf16 v243, v77, v77, v243
v_dot2_f32_bf16 v240, v74, s88, v240
v_dot2_f32_bf16 v242, v74, v74, v242
v_dot2_f32_bf16 v241, v78, s88, v241
v_dot2_f32_bf16 v243, v78, v78, v243
v_dot2_f32_bf16 v240, v75, s88, v240
v_dot2_f32_bf16 v242, v75, v75, v242
v_dot2_f32_bf16 v241, v79, s88, v241
v_dot2_f32_bf16 v243, v79, v79, v243
s_add_u32 m0, s83, 0x2000
s_add_u32 s76, s82, 0x300
s_waitcnt lgkmcnt(0)
LD 192,32,76,0
LD 193,32,76,1024
LD 194,32,76,2048
LD 195,32,76,3072
s_waitcnt vmcnt(12)
ds_read_b128 v[96:99], v196 offset:12288
ds_read_b128 v[100:103], v196 offset:14336
ds_read_b128 v[104:107], v197 offset:12288
ds_read_b128 v[108:111], v197 offset:14336
v_dot2_f32_bf16 v240, v80, s88, v240
v_dot2_f32_bf16 v242, v80, v80, v242
v_dot2_f32_bf16 v241, v84, s88, v241
v_dot2_f32_bf16 v243, v84, v84, v243
v_dot2_f32_bf16 v240, v81, s88, v240
v_dot2_f32_bf16 v242, v81, v81, v242
v_dot2_f32_bf16 v241, v85, s88, v241
v_dot2_f32_bf16 v243, v85, v85, v243
v_dot2_f32_bf16 v240, v82, s88, v240
v_dot2_f32_bf16 v242, v82, v82, v242
v_dot2_f32_bf16 v241, v86, s88, v241
v_dot2_f32_bf16 v243, v86, v86, v243
v_dot2_f32_bf16 v240, v83, s88, v240
v_dot2_f32_bf16 v242, v83, v83, v242
v_dot2_f32_bf16 v241, v87, s88, v241
v_dot2_f32_bf16 v243, v87, v87, v243
v_dot2_f32_bf16 v240, v88, s88, v240
v_dot2_f32_bf16 v242, v88, v88, v242
v_dot2_f32_bf16 v241, v92, s88, v241
v_dot2_f32_bf16 v243, v92, v92, v243
v_dot2_f32_bf16 v240, v89, s88, v240
v_dot2_f32_bf16 v242, v89, v89, v242
v_dot2_f32_bf16 v241, v93, s88, v241
v_dot2_f32_bf16 v243, v93, v93, v243
v_dot2_f32_bf16 v240, v90, s88, v240
v_dot2_f32_bf16 v242, v90, v90, v242
v_dot2_f32_bf16 v241, v94, s88, v241
v_dot2_f32_bf16 v243, v94, v94, v243
v_dot2_f32_bf16 v240, v91, s88, v240
v_dot2_f32_bf16 v242, v91, v91, v242
v_dot2_f32_bf16 v241, v95, s88, v241
v_dot2_f32_bf16 v243, v95, v95, v243
s_add_u32 m0, s83, 0x3000
s_add_u32 s76, s82, 0x380
s_waitcnt lgkmcnt(0)
LD 192,32,76,0
LD 193,32,76,1024
LD 194,32,76,2048
LD 195,32,76,3072
s_waitcnt vmcnt(12)
ds_read_b128 v[112:115], v196
ds_read_b128 v[116:119], v196 offset:2048
ds_read_b128 v[120:123], v197
ds_read_b128 v[124:127], v197 offset:2048
v_dot2_f32_bf16 v240, v96, s88, v240
v_dot2_f32_bf16 v242, v96, v96, v242
v_dot2_f32_bf16 v241, v100, s88, v241
v_dot2_f32_bf16 v243, v100, v100, v243
v_dot2_f32_bf16 v240, v97, s88, v240
v_dot2_f32_bf16 v242, v97, v97, v242
v_dot2_f32_bf16 v241, v101, s88, v241
v_dot2_f32_bf16 v243, v101, v101, v243
v_dot2_f32_bf16 v240, v98, s88, v240
v_dot2_f32_bf16 v242, v98, v98, v242
v_dot2_f32_bf16 v241, v102, s88, v241
v_dot2_f32_bf16 v243, v102, v102, v243
v_dot2_f32_bf16 v240, v99, s88, v240
v_dot2_f32_bf16 v242, v99, v99, v242
v_dot2_f32_bf16 v241, v103, s88, v241
v_dot2_f32_bf16 v243, v103, v103, v243
v_dot2_f32_bf16 v240, v104, s88, v240
v_dot2_f32_bf16 v242, v104, v104, v242
v_dot2_f32_bf16 v241, v108, s88, v241
v_dot2_f32_bf16 v243, v108, v108, v243
v_dot2_f32_bf16 v240, v105, s88, v240
v_dot2_f32_bf16 v242, v105, v105, v242
v_dot2_f32_bf16 v241, v109, s88, v241
v_dot2_f32_bf16 v243, v109, v109, v243
v_dot2_f32_bf16 v240, v106, s88, v240
v_dot2_f32_bf16 v242, v106, v106, v242
v_dot2_f32_bf16 v241, v110, s88, v241
v_dot2_f32_bf16 v243, v110, v110, v243
v_dot2_f32_bf16 v240, v107, s88, v240
v_dot2_f32_bf16 v242, v107, v107, v242
v_dot2_f32_bf16 v241, v111, s88, v241
v_dot2_f32_bf16 v243, v111, v111, v243
s_add_u32 m0, s83, 0
s_add_u32 s76, s82, 0x400
s_waitcnt lgkmcnt(0)
LD 192,32,76,0
LD 193,32,76,1024
LD 194,32,76,2048
LD 195,32,76,3072
s_waitcnt vmcnt(12)
ds_read_b128 v[128:131], v196 offset:4096
ds_read_b128 v[132:135], v196 offset:6144
ds_read_b128 v[136:139], v197 offset:4096
ds_read_b128 v[140:143], v197 offset:6144
v_dot2_f32_bf16 v240, v112, s88, v240
v_dot2_f32_bf16 v242, v112, v112, v242
v_dot2_f32_bf16 v241, v116, s88, v241
v_dot2_f32_bf16 v243, v116, v116, v243
v_dot2_f32_bf16 v240, v113, s88, v240
v_dot2_f32_bf16 v242, v113, v113, v242
v_dot2_f32_bf16 v241, v117, s88, v241
v_dot2_f32_bf16 v243, v117, v117, v243
v_dot2_f32_bf16 v240, v114, s88, v240
v_dot2_f32_bf16 v242, v114, v114, v242
v_dot2_f32_bf16 v241, v118, s88, v241
v_dot2_f32_bf16 v243, v118, v118, v243
v_dot2_f32_bf16 v240, v115, s88, v240
v_dot2_f32_bf16 v242, v115, v115, v242
v_dot2_f32_bf16 v241, v119, s88, v241
v_dot2_f32_bf16 v243, v119, v119, v243
v_dot2_f32_bf16 v240, v120, s88, v240
v_dot2_f32_bf16 v242, v120, v120, v242
v_dot2_f32_bf16 v241, v124, s88, v241
v_dot2_f32_bf16 v243, v124, v124, v243
v_dot2_f32_bf16 v240, v121, s88, v240
v_dot2_f32_bf16 v242, v121, v121, v242
v_dot2_f32_bf16 v241, v125, s88, v241
v_dot2_f32_bf16 v243, v125, v125, v243
v_dot2_f32_bf16 v240, v122, s88, v240
v_dot2_f32_bf16 v242, v122, v122, v242
v_dot2_f32_bf16 v241, v126, s88, v241
v_dot2_f32_bf16 v243, v126, v126, v243
v_dot2_f32_bf16 v240, v123, s88, v240
v_dot2_f32_bf16 v242, v123, v123, v242
v_dot2_f32_bf16 v241, v127, s88, v241
v_dot2_f32_bf16 v243, v127, v127, v243
s_waitcnt vmcnt(8)
ds_read_b128 v[144:147], v196 offset:8192
ds_read_b128 v[148:151], v196 offset:10240
ds_read_b128 v[152:155], v197 offset:8192
ds_read_b128 v[156:159], v197 offset:10240
s_waitcnt lgkmcnt(5)
v_dot2_f32_bf16 v240, v128, s88, v240
v_dot2_f32_bf16 v242, v128, v128, v242
v_dot2_f32_bf16 v241, v132, s88, v241
v_dot2_f32_bf16 v243, v132, v132, v243
v_dot2_f32_bf16 v240, v129, s88, v240
v_dot2_f32_bf16 v242, v129, v129, v242
v_dot2_f32_bf16 v241, v133, s88, v241
v_dot2_f32_bf16 v243, v133, v133, v243
v_dot2_f32_bf16 v240, v130, s88, v240
v_dot2_f32_bf16 v242, v130, v130, v242
v_dot2_f32_bf16 v241, v134, s88, v241
v_dot2_f32_bf16 v243, v134, v134, v243
v_dot2_f32_bf16 v240, v131, s88, v240
v_dot2_f32_bf16 v242, v131, v131, v242
v_dot2_f32_bf16 v241, v135, s88, v241
v_dot2_f32_bf16 v243, v135, v135, v243
v_dot2_f32_bf16 v240, v136, s88, v240
v_dot2_f32_bf16 v242, v136, v136, v242
s_waitcnt lgkmcnt(4)
v_dot2_f32_bf16 v241, v140, s88, v241
v_dot2_f32_bf16 v243, v140, v140, v243
v_dot2_f32_bf16 v240, v137, s88, v240
v_dot2_f32_bf16 v242, v137, v137, v242
v_dot2_f32_bf16 v241, v141, s88, v241
v_dot2_f32_bf16 v243, v141, v141, v243
v_dot2_f32_bf16 v240, v138, s88, v240
v_dot2_f32_bf16 v242, v138, v138, v242
v_dot2_f32_bf16 v241, v142, s88, v241
v_dot2_f32_bf16 v243, v142, v142, v243
v_dot2_f32_bf16 v240, v139, s88, v240
v_dot2_f32_bf16 v242, v139, v139, v242
v_dot2_f32_bf16 v241, v143, s88, v241
v_dot2_f32_bf16 v243, v143, v143, v243
s_waitcnt vmcnt(4)
ds_read_b128 v[160:163], v196 offset:12288
ds_read_b128 v[164:167], v196 offset:14336
ds_read_b128 v[168:171], v197 offset:12288
ds_read_b128 v[172:175], v197 offset:14336
s_waitcnt lgkmcnt(5)
v_dot2_f32_bf16 v240, v144, s88, v240
s_add_u32 m0, s67, 0x12000
v_dot2_f32_bf16 v242, v144, v144, v242
v_dot2_f32_bf16 v241, v148, s88, v241
s_add_u32 s76, s95, 0
v_dot2_f32_bf16 v243, v148, v148, v243
v_dot2_f32_bf16 v240, v145, s88, v240
LD 20,36,76,0
v_dot2_f32_bf16 v242, v145, v145, v242
v_dot2_f32_bf16 v241, v149, s88, v241
LD 21,36,76,1024
v_dot2_f32_bf16 v243, v149, v149, v243
v_dot2_f32_bf16 v240, v146, s88, v240
LD 22,36,76,2048
v_dot2_f32_bf16 v242, v146, v146, v242
v_dot2_f32_bf16 v241, v150, s88, v241
LD 23,36,76,3072
v_dot2_f32_bf16 v243, v150, v150, v243
v_dot2_f32_bf16 v240, v147, s88, v240
s_add_u32 m0, s67, 0x13000
v_dot2_f32_bf16 v242, v147, v147, v242
v_dot2_f32_bf16 v241, v151, s88, v241
s_add_u32 s76, s95, 0x40000
v_dot2_f32_bf16 v243, v151, v151, v243
v_dot2_f32_bf16 v240, v152, s88, v240
LD 20,36,76,0
v_dot2_f32_bf16 v242, v152, v152, v242
s_waitcnt lgkmcnt(4)
v_dot2_f32_bf16 v241, v156, s88, v241
LD 21,36,76,1024
v_dot2_f32_bf16 v243, v156, v156, v243
v_dot2_f32_bf16 v240, v153, s88, v240
v_dot2_f32_bf16 v242, v153, v153, v242
v_dot2_f32_bf16 v241, v157, s88, v241
v_dot2_f32_bf16 v243, v157, v157, v243
v_dot2_f32_bf16 v240, v154, s88, v240
v_dot2_f32_bf16 v242, v154, v154, v242
v_dot2_f32_bf16 v241, v158, s88, v241
v_dot2_f32_bf16 v243, v158, v158, v243
v_dot2_f32_bf16 v240, v155, s88, v240
v_dot2_f32_bf16 v242, v155, v155, v242
v_dot2_f32_bf16 v241, v159, s88, v241
v_dot2_f32_bf16 v243, v159, v159, v243
s_waitcnt vmcnt(6)
ds_read_b128 v[176:179], v196
ds_read_b128 v[180:183], v196 offset:2048
ds_read_b128 v[184:187], v197
ds_read_b128 v[188:191], v197 offset:2048
s_waitcnt lgkmcnt(4)
v_dot2_f32_bf16 v240, v160, s88, v240
LD 22,36,76,2048
v_dot2_f32_bf16 v242, v160, v160, v242
v_dot2_f32_bf16 v241, v164, s88, v241
LD 23,36,76,3072
v_dot2_f32_bf16 v243, v164, v164, v243
v_dot2_f32_bf16 v240, v161, s88, v240
s_add_u32 m0, s67, 0x14000
v_dot2_f32_bf16 v242, v161, v161, v242
v_dot2_f32_bf16 v241, v165, s88, v241
s_add_u32 s76, s95, 0x80000
v_dot2_f32_bf16 v243, v165, v165, v243
v_dot2_f32_bf16 v240, v162, s88, v240
LD 20,36,76,0
v_dot2_f32_bf16 v242, v162, v162, v242
v_dot2_f32_bf16 v241, v166, s88, v241
s_add_u32 m0, s67, 0x1b000
v_dot2_f32_bf16 v243, v166, v166, v243
v_dot2_f32_bf16 v240, v163, s88, v240
s_add_u32 s76, s95, 0x240000
v_dot2_f32_bf16 v242, v163, v163, v242
v_dot2_f32_bf16 v241, v167, s88, v241
LD 20,36,76,0
v_dot2_f32_bf16 v243, v167, v167, v243
v_dot2_f32_bf16 v240, v168, s88, v240
LD 21,36,76,1024
v_dot2_f32_bf16 v242, v168, v168, v242
v_dot2_f32_bf16 v241, v172, s88, v241
LD 22,36,76,2048
v_dot2_f32_bf16 v243, v172, v172, v243
v_dot2_f32_bf16 v240, v169, s88, v240
v_dot2_f32_bf16 v242, v169, v169, v242
v_dot2_f32_bf16 v241, v173, s88, v241
v_dot2_f32_bf16 v243, v173, v173, v243
v_dot2_f32_bf16 v240, v170, s88, v240
v_dot2_f32_bf16 v242, v170, v170, v242
v_dot2_f32_bf16 v241, v174, s88, v241
v_dot2_f32_bf16 v243, v174, v174, v243
v_dot2_f32_bf16 v240, v171, s88, v240
v_dot2_f32_bf16 v242, v171, v171, v242
v_dot2_f32_bf16 v241, v175, s88, v241
v_dot2_f32_bf16 v243, v175, v175, v243
s_waitcnt lgkmcnt(0)
s_barrier
v_dot2_f32_bf16 v240, v176, s88, v240
LD 23,36,76,3072
v_dot2_f32_bf16 v242, v176, v176, v242
v_dot2_f32_bf16 v241, v180, s88, v241
s_add_u32 m0, s67, 0x1c000
v_dot2_f32_bf16 v243, v180, v180, v243
v_dot2_f32_bf16 v240, v177, s88, v240
s_add_u32 s76, s95, 0x280000
v_dot2_f32_bf16 v242, v177, v177, v242
v_dot2_f32_bf16 v241, v181, s88, v241
LD 20,36,76,0
v_dot2_f32_bf16 v243, v181, v181, v243
v_dot2_f32_bf16 v240, v178, s88, v240
LD 21,36,76,1024
v_dot2_f32_bf16 v242, v178, v178, v242
v_dot2_f32_bf16 v241, v182, s88, v241
LD 22,36,76,2048
v_dot2_f32_bf16 v243, v182, v182, v243
v_dot2_f32_bf16 v240, v179, s88, v240
LD 23,36,76,3072
v_dot2_f32_bf16 v242, v179, v179, v242
v_dot2_f32_bf16 v241, v183, s88, v241
s_add_u32 m0, s67, 0x1d000
v_dot2_f32_bf16 v243, v183, v183, v243
v_dot2_f32_bf16 v240, v184, s88, v240
s_add_u32 s76, s95, 0x2c0000
v_dot2_f32_bf16 v242, v184, v184, v242
v_dot2_f32_bf16 v241, v188, s88, v241
LD 20,36,76,0
v_dot2_f32_bf16 v243, v188, v188, v243
v_dot2_f32_bf16 v240, v185, s88, v240
v_dot2_f32_bf16 v242, v185, v185, v242
v_dot2_f32_bf16 v241, v189, s88, v241
v_dot2_f32_bf16 v243, v189, v189, v243
v_dot2_f32_bf16 v240, v186, s88, v240
v_dot2_f32_bf16 v242, v186, v186, v242
v_dot2_f32_bf16 v241, v190, s88, v241
v_dot2_f32_bf16 v243, v190, v190, v243
v_dot2_f32_bf16 v240, v187, s88, v240
v_dot2_f32_bf16 v242, v187, v187, v242
v_dot2_f32_bf16 v241, v191, s88, v241
v_dot2_f32_bf16 v243, v191, v191, v243
s_nop 1
v_permlane32_swap_b32 v240, v241
v_add_f32 v240, v240, v241
v_permlane32_swap_b32 v242, v243
v_add_f32 v242, v242, v243
v_mov_b32 v244, v240
s_nop 1
v_permlane16_swap_b32 v240, v244
v_add_f32 v240, v240, v244
v_mov_b32 v245, v242
s_nop 1
v_permlane16_swap_b32 v242, v245
v_add_f32 v242, v242, v245
v_mul_f32 v240, 0xbae38e39, v240
v_mul_f32 v242, 0x3ae38e39, v242
v_fma_f32 v242, -v240, v240, v242
v_max_f32 v242, 0, v242
v_mov_b32 v24, v240
s_add_u32 m0, s67, 0
v_mov_b32 v219, v24
v_mov_b32 v220, v24
s_add_u32 s76, s95, 0x80
s_nop 0
v_permlane32_swap_b32 v219, v220
v_add_u32 v2, 0x12000, v2
v_add_u32 v3, 0x12000, v3
v_mov_b32 v216, v219
v_mov_b32 v217, v219
v_mov_b32 v218, v219
v_mov_b32 v221, v220
v_mov_b32 v222, v220
v_mfma_f32_16x16x32_bf16 v[192:195], a[248:251], v[48:51], v[216:219]
LD 20,36,76,0
v_mov_b32 v223, v220
v_add_u32 v4, 0x12000, v4
v_mfma_f32_16x16x32_bf16 v[196:199], a[252:255], v[48:51], v[216:219]
s_mov_b64 s[56:57], s[18:19]
v_add_u32 v5, 0x12000, v5
v_mov_b32 v25, v242
v_readfirstlane_b32 s84, v255
v_mfma_f32_16x16x32_bf16 v[200:203], a[248:251], v[52:55], v[220:223]
s_nop 2
s_add_u32 s84, s84, 0x9e3779b9
CV 48,192,193
CV 49,194,195
v_add_f32 v26, 0x3727c5ac, v25
v_mfma_f32_16x16x32_bf16 v[204:207], a[252:255], v[52:55], v[220:223]
s_cmp_lg_u32 s89, 0
s_cselect_b32 s98, s98, s84
CV 50,196,197
CV 51,198,199
v_lshrrev_b32 v29, 4, v1
v_mfma_f32_16x16x32_bf16 v[208:211], a[248:251], v[56:59], v[216:219]
s_mov_b32 s5, 0x489000
CV 52,200,201
CV 53,202,203
v_min_u32 v29, 2, v29
v_mfma_f32_16x16x32_bf16 v[212:215], a[252:255], v[56:59], v[216:219]
s_mov_b32 s6, 0x48a000
CV 54,204,205
CV 55,206,207
v_add_u32 v29, s94, v29
v_mfma_f32_16x16x32_bf16 v[192:195], a[248:251], v[60:63], v[220:223]
LD 21,36,76,1024
CV 56,208,209
CV 57,210,211
v_mfma_f32_16x16x32_bf16 v[196:199], a[252:255], v[60:63], v[220:223]
s_mov_b32 s7, 0x48b000
CV 58,212,213
CV 59,214,215
v_max_u32 v29, 1, v29
v_mfma_f32_16x16x32_bf16 v[200:203], a[248:251], v[64:67], v[216:219]
s_mov_b32 s4, 0x48c000
CV 60,192,193
CV 61,194,195
v_subrev_u32 v29, 1, v29
v_mfma_f32_16x16x32_bf16 v[204:207], a[252:255], v[64:67], v[216:219]
s_and_b32 s20, s66, 2
CV 62,196,197
CV 63,198,199
v_and_b32 v28, 15, v1
v_mfma_f32_16x16x32_bf16 v[208:211], a[248:251], v[68:71], v[220:223]
s_lshl_b32 s20, s20, 5
CV 64,200,201
CV 65,202,203
v_min_u32 v29, 63, v29
v_mfma_f32_16x16x32_bf16 v[212:215], a[252:255], v[68:71], v[220:223]
s_bitcmp1_b32 s66, 1
s_cselect_b64 s[22:23], -1, 0
CV 66,204,205
CV 67,206,207
v_min_u32 v28, 9, v28
v_mfma_f32_16x16x32_bf16 v[192:195], a[248:251], v[72:75], v[216:219]
LD 22,36,76,2048
CV 68,208,209
CV 69,210,211
v_mfma_f32_16x16x32_bf16 v[196:199], a[252:255], v[72:75], v[216:219]
s_lshl_b32 s79, s94, 4
CV 70,212,213
CV 71,214,215
v_lshlrev_b32 v29, 7, v29
v_mfma_f32_16x16x32_bf16 v[200:203], a[248:251], v[76:79], v[220:223]
s_add_u32 s79, s79, s31
CV 72,192,193
CV 73,194,195
v_lshl_add_u32 v28, v28, 2, v29
v_mfma_f32_16x16x32_bf16 v[204:207], a[252:255], v[76:79], v[220:223]
s_lshl_b32 s79, s79, 9
CV 74,196,197
CV 75,198,199
v_add_u32 v28, 0x3000000, v28
v_mfma_f32_16x16x32_bf16 v[208:211], a[248:251], v[80:83], v[216:219]
s_add_u32 s78, s72, 0x240000
CV 76,200,201
CV 77,202,203
v_mov_b32 v25, 0xff800000
v_mfma_f32_16x16x32_bf16 v[212:215], a[252:255], v[80:83], v[216:219]
s_add_u32 s79, s79, 0x720000
CV 78,204,205
CV 79,206,207
v_mov_b32 v27, 0xff800000
v_mfma_f32_16x16x32_bf16 v[192:195], a[248:251], v[84:87], v[220:223]
L_pg6_1:
s_cbranch_execz L_ret6
s_lshl2_add_u32 s9, s31, s99
CV 80,208,209
CV 81,210,211
v_mov_b32 v47, s98
v_mfma_f32_16x16x32_bf16 v[196:199], a[252:255], v[84:87], v[220:223]
s_add_u32 s9, s9, 0x2000
CV 82,212,213
CV 83,214,215
v_mov_b32 v40, s88
v_mfma_f32_16x16x32_bf16 v[200:203], a[248:251], v[88:91], v[216:219]
LD 23,36,76,3072
CV 84,192,193
CV 85,194,195
v_mfma_f32_16x16x32_bf16 v[204:207], a[252:255], v[88:91], v[216:219]
s_add_u32 m0, s67, 0x1000
s_add_u32 s76, s95, 0x40080
CV 86,196,197
CV 87,198,199
v_mfma_f32_16x16x32_bf16 v[208:211], a[248:251], v[92:95], v[220:223]
s_mul_i32 s77, s100, 0x12000
CV 88,200,201
CV 89,202,203
v_min_u32 v46, 8, v1
v_mfma_f32_16x16x32_bf16 v[212:215], a[252:255], v[92:95], v[220:223]
s_mul_i32 s85, s66, 0x400
CV 90,204,205
CV 91,206,207
v_mul_u32_u24 v46, 0x2000, v46
v_mfma_f32_16x16x32_bf16 v[192:195], a[248:251], v[96:99], v[216:219]
s_add_u32 s77, s77, s85
CV 92,208,209
CV 93,210,211
v_mov_b32 v41, s88
v_mfma_f32_16x16x32_bf16 v[196:199], a[252:255], v[96:99], v[216:219]
s_add_u32 s77, s77, 0x100
CV 94,212,213
CV 95,214,215
v_mov_b32 v42, s88
v_mfma_f32_16x16x32_bf16 v[200:203], a[248:251], v[100:103], v[220:223]
LD 20,36,76,0
CV 96,192,193
CV 97,194,195
v_mfma_f32_16x16x32_bf16 v[204:207], a[252:255], v[100:103], v[220:223]
s_lshl_b32 s10, s66, 6
CV 98,196,197
CV 99,198,199
v_mov_b32 v43, s88
v_mfma_f32_16x16x32_bf16 v[208:211], a[248:251], v[104:107], v[216:219]
s_add_u32 s10, s10, s94
CV 100,200,201
CV 101,202,203
v_mov_b32 v30, 0xff800000
v_mfma_f32_16x16x32_bf16 v[212:215], a[252:255], v[104:107], v[216:219]
s_lshl_b32 s10, s10, 2
CV 102,204,205
CV 103,206,207
v_mfma_f32_16x16x32_bf16 v[192:195], a[248:251], v[108:111], v[220:223]
buffer_load_dword v35, v46, s[36:39], s77 offen
CV 104,208,209
CV 105,210,211
v_mfma_f32_16x16x32_bf16 v[196:199], a[252:255], v[108:111], v[220:223]
s_add_u32 s10, s10, 0x300c000
CV 106,212,213
CV 107,214,215
v_rsq_f32 v38, v26
v_mfma_f32_16x16x32_bf16 v[200:203], a[248:251], v[112:115], v[216:219]
LD 21,36,76,1024
CV 108,192,193
CV 109,194,195
v_mfma_f32_16x16x32_bf16 v[204:207], a[252:255], v[112:115], v[216:219]
s_add_u32 s12, s74, 0x400
CV 110,196,197
CV 111,198,199
v_mul_f32 v36, v24, v38
v_mfma_f32_16x16x32_bf16 v[208:211], a[248:251], v[116:119], v[220:223]
s_lshl_b32 s11, s64, 8
CV 112,200,201
CV 113,202,203
v_mul_f32 v38, 0x3e0293ee, v38
v_mfma_f32_16x16x32_bf16 v[212:215], a[252:255], v[116:119], v[220:223]
s_add_u32 s11, s11, 0x24000
CV 114,204,205
CV 115,206,207
v_mov_b32 v39, v38
v_mfma_f32_16x16x32_bf16 v[192:195], a[248:251], v[120:123], v[216:219]
s_add_u32 s16, s66, 0
CV 116,208,209
CV 117,210,211
v_mov_b32 v24, 0xff800000
v_mfma_f32_16x16x32_bf16 v[196:199], a[252:255], v[120:123], v[216:219]
s_mul_i32 s13, s94, 0x88000
CV 118,212,213
CV 119,214,215
v_mov_b32 v26, 0xff800000
v_mfma_f32_16x16x32_bf16 v[200:203], a[248:251], v[124:127], v[220:223]
s_and_b32 s16, s16, 7
CV 120,192,193
CV 121,194,195
v_mov_b32 v37, v36
v_mfma_f32_16x16x32_bf16 v[204:207], a[252:255], v[124:127], v[220:223]
s_add_u32 s13, s13, 0x800000
CV 122,196,197
CV 123,198,199
v_mfma_f32_16x16x32_bf16 v[208:211], a[248:251], v[128:131], v[216:219]
LD 22,36,76,2048
CV 124,200,201
CV 125,202,203
v_mfma_f32_16x16x32_bf16 v[212:215], a[252:255], v[128:131], v[216:219]
s_add_u32 s17, s66, 1
CV 126,204,205
CV 127,206,207
v_permlane32_swap_b32 v38, v39
v_mfma_f32_16x16x32_bf16 v[192:195], a[248:251], v[132:135], v[220:223]
s_and_b32 s17, s17, 7
CV 128,208,209
CV 129,210,211
v_mul_f32 v44, 0x40faf233, v38
v_mfma_f32_16x16x32_bf16 v[196:199], a[252:255], v[132:135], v[220:223]
s_lshl2_add_u32 s8, s66, s99
CV 130,212,213
CV 131,214,215
v_mul_f32 v45, 0x40faf233, v39
v_mfma_f32_16x16x32_bf16 v[200:203], a[248:251], v[136:139], v[216:219]
s_waitcnt vmcnt(17)
s_barrier
CV 132,192,193
CV 133,194,195
v_mfma_f32_16x16x32_bf16 v[204:207], a[252:255], v[136:139], v[216:219]
s_add_u32 s8, s8, 0x6020
Ta 128,2,0
CV 134,196,197
CV 135,198,199
v_mfma_f32_16x16x32_bf16 v[208:211], a[248:251], v[140:143], v[220:223]
LD 23,36,76,3072
Ta 130,2,2048
s_add_u32 m0, s67, 0x2000
s_add_u32 s76, s95, 0x80080
v_mfma_f32_16x16x32_bf16 v[212:215], a[252:255], v[140:143], v[220:223]
Ta 132,3,0
CV 136,200,201
CV 137,202,203
v_mfma_f32_16x16x32_bf16 v[192:195], a[248:251], v[144:147], v[216:219]
Ta 134,3,2048
CV 138,204,205
CV 139,206,207
v_mfma_f32_16x16x32_bf16 v[196:199], a[252:255], v[144:147], v[216:219]
Ta 136,4,0
CV 140,208,209
CV 141,210,211
v_mfma_f32_16x16x32_bf16 v[200:203], a[248:251], v[148:151], v[220:223]
Ta 138,4,2048
CV 142,212,213
CV 143,214,215
v_mfma_f32_16x16x32_bf16 v[204:207], a[252:255], v[148:151], v[220:223]
Ta 140,5,0
CV 144,192,193
CV 145,194,195
v_mfma_f32_16x16x32_bf16 v[208:211], a[248:251], v[152:155], v[216:219]
LD 20,36,76,0
Ta 142,5,2048
v_mfma_f32_16x16x32_bf16 v[212:215], a[252:255], v[152:155], v[216:219]
s_add_u32 m0, s67, 0x9000
Ta 144,2,4096
CV 146,196,197
CV 147,198,199
CV 148,200,201
v_mfma_f32_16x16x32_bf16 v[192:195], a[248:251], v[156:159], v[220:223]
s_add_u32 s76, s95, 0x240080
Ta 146,2,6144
CV 149,202,203
CV 150,204,205
v_mfma_f32_16x16x32_bf16 v[196:199], a[252:255], v[156:159], v[220:223]
Ta 148,3,4096
CV 151,206,207
CV 152,208,209
v_mfma_f32_16x16x32_bf16 v[200:203], a[248:251], v[160:163], v[216:219]
Ta 150,3,6144
CV 153,210,211
CV 154,212,213
v_mfma_f32_16x16x32_bf16 v[204:207], a[252:255], v[160:163], v[216:219]
Ta 152,4,4096
CV 155,214,215
CV 156,192,193
v_mfma_f32_16x16x32_bf16 v[208:211], a[248:251], v[164:167], v[220:223]
Ta 154,4,6144
CV 157,194,195
CV 158,196,197
v_mfma_f32_16x16x32_bf16 v[212:215], a[252:255], v[164:167], v[220:223]
Ta 156,5,4096
CV 159,198,199
CV 160,200,201
v_mfma_f32_16x16x32_bf16 v[192:195], a[248:251], v[168:171], v[216:219]
Ta 158,5,6144
CV 161,202,203
CV 162,204,205
v_mfma_f32_16x16x32_bf16 v[196:199], a[252:255], v[168:171], v[216:219]
Ta 160,2,8192
CV 163,206,207
CV 164,208,209
v_mfma_f32_16x16x32_bf16 v[200:203], a[248:251], v[172:175], v[220:223]
Ta 162,2,10240
CV 165,210,211
CV 166,212,213
v_mfma_f32_16x16x32_bf16 v[204:207], a[252:255], v[172:175], v[220:223]
Ta 164,3,8192
CV 167,214,215
CV 168,192,193
v_mfma_f32_16x16x32_bf16 v[208:211], a[248:251], v[176:179], v[216:219]
Ta 166,3,10240
CV 169,194,195
CV 170,196,197
v_mfma_f32_16x16x32_bf16 v[212:215], a[252:255], v[176:179], v[216:219]
CV 171,198,199
CV 172,200,201
CV 173,202,203
v_mfma_f32_16x16x32_bf16 v[192:195], a[248:251], v[180:183], v[220:223]
CV 174,204,205
CV 175,206,207
CV 176,208,209
v_mfma_f32_16x16x32_bf16 v[196:199], a[252:255], v[180:183], v[220:223]
CV 177,210,211
CV 178,212,213
CV 179,214,215
v_mfma_f32_16x16x32_bf16 v[200:203], a[248:251], v[184:187], v[216:219]
CV 180,192,193
CV 181,194,195
v_mfma_f32_16x16x32_bf16 v[204:207], a[252:255], v[184:187], v[216:219]
s_nop 0
CV 182,196,197
CV 183,198,199
v_mfma_f32_16x16x32_bf16 v[208:211], a[248:251], v[188:191], v[220:223]
s_nop 0
CV 184,200,201
CV 185,202,203
v_mfma_f32_16x16x32_bf16 v[212:215], a[252:255], v[188:191], v[220:223]
s_waitcnt lgkmcnt(0)
CV 186,204,205
CV 187,206,207
v_permlane32_swap_b32 v36, v37
v_mfma_f32_16x16x32_bf16 v[224:227], a[128:131], v[48:51], 0
CV 188,208,209
CV 189,210,211
v_mfma_f32_16x16x32_bf16 v[232:235], a[128:131], v[52:55], 0
Ta 128,4,8192
CV 190,212,213
v_mfma_f32_16x16x32_bf16 v[228:231], a[132:135], v[48:51], 0
LD 20,36,76,0
Ta 130,4,10240
v_mfma_f32_16x16x32_bf16 v[236:239], a[132:135], v[52:55], 0
Ta 132,5,8192
CV 191,214,215
v_mfma_f32_16x16x32_bf16 v[240:243], a[136:139], v[48:51], 0
Ta 134,5,10240
v_mfma_f32_16x16x32_bf16 v[248:251], a[136:139], v[52:55], 0
Ta 136,2,12288
v_mfma_f32_16x16x32_bf16 v[244:247], a[140:143], v[48:51], 0
s_mul_i32 s77, s100, 0x12000
Ta 138,2,14336
v_min_u32 v46, 8, v1
v_mfma_f32_16x16x32_bf16 v[252:255], a[140:143], v[52:55], 0
s_mul_i32 s85, s66, 0x400
Ta 140,3,12288
v_mul_u32_u24 v46, 0x2000, v46
Mvav 224,144,56
LD 21,36,76,1024
Ta 142,3,14336
Mvav 232,144,60
s_add_u32 s77, s77, s85
Ta 144,4,12288
s_add_u32 s77, s77, 0x180
Mvav 228,148,56
Ta 146,4,14336
Mvav 236,148,60
Ta 148,5,12288
Mvav 240,152,56
buffer_load_dword v35, v46, s[36:39], s77 offen
Ta 150,5,14336
Mvav 248,152,60
Ta 152,2,16384
Mvav 244,156,56
LD 22,36,76,2048
Ta 154,2,18432
Mvav 252,156,60
Ta 156,3,16384
Mvav 224,160,64
Ta 158,3,18432
Mvav 232,160,68
Ta 160,4,16384
Mvav 228,164,64
Ta 162,4,18432
Mvav 236,164,68
s_waitcnt lgkmcnt(8)
Ta 164,5,16384
Mvav 240,128,64
LD 23,36,76,3072
Ta 166,5,18432
Mvav 248,128,68
s_add_u32 m0, s67, 0xa000
s_add_u32 s76, s95, 0x280080
Ta 128,2,20480
Mvav 244,132,64
Ta 130,2,22528
Mvav 252,132,68
Ta 132,3,20480
Mvav 224,136,72
Ta 134,3,22528
Mvav 232,136,76
Ta 136,4,20480
Mvav 228,140,72
LD 20,36,76,0
Ta 138,4,22528
Mvav 236,140,76
Ta 140,5,20480
Mvav 240,144,72
Ta 142,5,22528
Mvav 248,144,76
s_waitcnt lgkmcnt(9)
Ta 144,2,24576
Mvav 244,148,72
Ta 146,2,26624
Mvav 252,148,76
Ta 148,3,24576
Mvav 224,152,80
LD 21,36,76,1024
Ta 150,3,26624
Mvav 232,152,84
Ta 152,4,24576
Mvav 228,156,80
Ta 154,4,26624
Mvav 236,156,84
Ta 156,5,24576
Mvav 240,160,80
Ta 158,5,26624
Mvav 248,160,84
s_waitcnt lgkmcnt(8)
Ta 160,2,28672
Mvav 244,164,80
LD 22,36,76,2048
Ta 162,2,30720
Mvav 252,164,84
Ta 164,3,28672
Mvav 224,128,88
Ta 166,3,30720
Mvav 232,128,92
Ta 128,4,28672
Mvav 228,132,88
Ta 130,4,30720
Mvav 236,132,92
Ta 132,5,28672
Mvav 240,136,88
LD 23,36,76,3072
Ta 134,5,30720
Mvav 248,136,92
s_add_u32 m0, s67, 0xb000
s_add_u32 s76, s95, 0x2c0080
Ta 136,2,32768
Mvav 244,140,88
Ta 138,2,34816
v_add_u32 v2, 0x9000, v2
Mvav 252,140,92
s_waitcnt lgkmcnt(9)
Ta 140,3,32768
Mvav 224,144,96
Ta 142,3,34816
v_add_u32 v3, 0x9000, v3
Mvav 232,144,100
Ta 144,4,32768
Mvav 228,148,96
LD 20,36,76,0
Ta 146,4,34816
Mvav 236,148,100
s_add_u32 m0, s67, 0x12000
Ta 148,5,32768
Ta 150,5,34816
Mvav 240,152,96
s_add_u32 s76, s95, 0x100
v_add_u32 v4, 0x9000, v4
v_add_u32 v5, 0x9000, v5
Mvav 248,152,100
Mvav 244,156,96
Mvav 252,156,100
s_waitcnt lgkmcnt(6)
Mvav 224,160,104
Mvav 232,160,108
Mvav 228,164,104
s_waitcnt vmcnt(20) lgkmcnt(0)
s_barrier
Mvav 236,164,108
Ta 152,2,0
Mvav 240,128,104
Ta 154,2,2048
Mvav 248,128,108
Ta 156,3,0
Mvav 244,132,104
Ta 158,3,2048
Mvav 252,132,108
Ta 160,4,0
Mvav 224,136,112
Ta 162,4,2048
Mvav 232,136,116
Ta 164,5,0
Mvav 228,140,112
Ta 166,5,2048
Mvav 236,140,116
Ta 128,2,4096
Mvav 240,144,112
Ta 130,2,6144
Mvav 248,144,116
Ta 132,3,4096
Mvav 244,148,112
Ta 134,3,6144
Mvav 252,148,116
s_waitcnt lgkmcnt(8)
Ta 136,4,4096
Mvav 224,152,120
Ta 138,4,6144
Mvav 232,152,124
Ta 140,5,4096
Mvav 228,156,120
LD 20,36,76,0
Ta 142,5,6144
Mvav 236,156,124
s_waitcnt lgkmcnt(8)
Ta 144,2,8192
Mvav 240,160,120
Ta 146,2,10240
Mvav 248,160,124
s_waitcnt lgkmcnt(6)
Ta 148,3,8192
Mvav 244,164,120
s_mul_i32 s77, s100, 0x2880
Ta 150,3,10240
v_min_u32 v46, 8, v1
Mvav 252,164,124
s_add_u32 s77, s77, 0x400
Ta 152,4,8192
v_mul_u32_u24 v46, 0x480, v46
Mvav 224,128,128
LD 21,36,76,1024
Ta 154,4,10240
Mvav 232,128,132
Ta 156,5,8192
Mvav 228,132,128
Ta 158,5,10240
Mvav 236,132,132
s_waitcnt lgkmcnt(9)
Ta 160,2,12288
Mvav 240,136,128
buffer_load_dword v35, v46, s[56:59], s77 offen
Ta 162,2,14336
Mvav 248,136,132
s_waitcnt lgkmcnt(8)
Ta 164,3,12288
Mvav 244,140,128
LD 22,36,76,2048
Ta 166,3,14336
Mvav 252,140,132
Ta 128,4,12288
Mvav 224,144,136
Ta 130,4,14336
Mvav 232,144,140
s_waitcnt lgkmcnt(9)
Ta 132,5,12288
Mvav 228,148,136
Ta 134,5,14336
Mvav 236,148,140
s_waitcnt lgkmcnt(8)
Ta 136,2,16384
Mvav 240,152,136
LD 23,36,76,3072
Ta 138,2,18432
Mvav 248,152,140
s_add_u32 m0, s67, 0x13000
s_add_u32 s76, s95, 0x40100
Ta 140,3,16384
Mvav 244,156,136
Ta 142,3,18432
Mvav 252,156,140
s_waitcnt lgkmcnt(9)
Ta 144,4,16384
Mvav 224,160,144
Ta 146,4,18432
Mvav 232,160,148
s_waitcnt lgkmcnt(8)
Ta 148,5,16384
Mvav 228,164,144
LD 20,36,76,0
Ta 150,5,18432
Mvav 236,164,148
Ta 152,2,20480
Mvav 240,128,144
Ta 154,2,22528
Mvav 248,128,148
s_waitcnt lgkmcnt(9)
Ta 156,3,20480
Mvav 244,132,144
Ta 158,3,22528
Mvav 252,132,148
s_waitcnt lgkmcnt(8)
Ta 160,4,20480
Mvav 224,136,152
LD 21,36,76,1024
Ta 162,4,22528
Mvav 232,136,156
Ta 164,5,20480
Mvav 228,140,152
Ta 166,5,22528
Mvav 236,140,156
s_waitcnt lgkmcnt(9)
Ta 128,2,24576
Mvav 240,144,152
Ta 130,2,26624
Mvav 248,144,156
s_waitcnt lgkmcnt(8)
Ta 132,3,24576
Mvav 244,148,152
LD 22,36,76,2048
Ta 134,3,26624
Mvav 252,148,156
Ta 136,4,24576
Mvav 224,152,160
Ta 138,4,26624
Mvav 232,152,164
s_waitcnt lgkmcnt(9)
Ta 140,5,24576
Mvav 228,156,160
Ta 142,5,26624
Mvav 236,156,164
s_waitcnt lgkmcnt(8)
Ta 144,2,28672
Mvav 240,160,160
LD 23,36,76,3072
Ta 146,2,30720
Mvav 248,160,164
s_add_u32 m0, s67, 0x14000
s_add_u32 s76, s95, 0x80100
Ta 148,3,28672
Mvav 244,164,160
L_pg6_2:
s_cbranch_execz L_ret6
Ta 150,3,30720
Mvav 252,164,164
s_waitcnt lgkmcnt(9)
Ta 152,4,28672
Mvav 224,128,168
s_and_b32 s85, s30, 31
Ta 154,4,30720
v_and_b32 v46, 32, v1
Mvav 232,128,172
s_waitcnt lgkmcnt(8)
s_lshl_b32 s85, s85, 8
Ta 156,5,28672
v_lshl_add_u32 v46, v46, 2, s85
Mvav 228,132,168
LD 20,36,76,0
Ta 158,5,30720
Mvav 236,132,172
s_add_u32 m0, s67, 0x1b000
Ta 160,2,32768
Ta 162,2,34816
Mvav 240,136,168
s_add_u32 s76, s95, 0x240100
Ta 164,3,32768
Ta 166,3,34816
Mvav 248,136,172
s_waitcnt lgkmcnt(10)
s_getpc_b64 s[96:97]
L_ca0_2:
s_add_u32 s96, s96, L_ca0_2+16384-L_ca0_2
s_addc_u32 s97, s97, 0
Ta 128,4,32768
Ta 130,4,34816
Mvav 244,140,168
global_load_dword v35, v46, s[96:97]
Ta 132,5,32768
Mvav 252,140,172
Ta 134,5,34816
v_add_u32 v2, 0xfffe5000, v2
Mvav 224,144,176
v_add_u32 v3, 0xfffe5000, v3
v_add_u32 v4, 0xfffe5000, v4
Mvav 232,144,180
s_waitcnt lgkmcnt(10)
v_add_u32 v5, 0xfffe5000, v5
Mvav 228,148,176
Mvav 236,148,180
Mvav 240,152,176
Mvav 248,152,180
s_waitcnt lgkmcnt(4)
Mvav 244,156,176
s_waitcnt vmcnt(21) lgkmcnt(0)
s_barrier
Mvav 252,156,180
Ta 136,2,0
Mvav 224,160,184
Ta 138,2,2048
Mvav 232,160,188
Ta 140,3,0
Mvav 228,164,184
Ta 142,3,2048
Mvav 236,164,188
Ta 144,4,0
Mvav 240,128,184
Ta 146,4,2048
v_mul_f32 v224, v38, v224
Mvav 248,128,188
Ta 148,5,0
v_mul_f32 v225, v38, v225
Mvav 244,132,184
Ta 150,5,2048
v_mul_f32 v226, v38, v226
Mvav 252,132,188
s_waitcnt lgkmcnt(6)
Ta 152,2,4096
v_mul_f32 v227, v38, v227
v_mfma_f32_16x16x32_bf16 v[192:195], a[136:139], v[48:51], 0
Ta 154,2,6144
v_mul_f32 v228, v38, v228
v_mfma_f32_16x16x32_bf16 v[200:203], a[136:139], v[52:55], 0
s_waitcnt lgkmcnt(6)
Ta 156,3,4096
v_mul_f32 v229, v38, v229
v_mfma_f32_16x16x32_bf16 v[196:199], a[140:143], v[48:51], 0
LD 20,36,76,0
Ta 158,3,6144
v_mfma_f32_16x16x32_bf16 v[204:207], a[140:143], v[52:55], 0
s_waitcnt lgkmcnt(6)
Ta 160,4,4096
v_mul_f32 v230, v38, v230
v_mfma_f32_16x16x32_bf16 v[208:211], a[144:147], v[48:51], 0
Ta 162,4,6144
v_mul_f32 v231, v38, v231
v_mfma_f32_16x16x32_bf16 v[216:219], a[144:147], v[52:55], 0
s_waitcnt lgkmcnt(6)
Ta 164,5,4096
CV 224,224,225
v_mfma_f32_16x16x32_bf16 v[212:215], a[148:151], v[48:51], 0
s_mul_i32 s77, s100, 0x400
Ta 166,5,6144
v_min_u32 v46, 7, v1
v_mfma_f32_16x16x32_bf16 v[220:223], a[148:151], v[52:55], 0
s_waitcnt lgkmcnt(6)
s_mul_i32 s85, s66, 0x100000
Ta 128,2,8192
v_mul_u32_u24 v46, 0x80, v46
Mvav 192,152,56
LD 21,36,76,1024
Ta 130,2,10240
Mvav 200,152,60
s_waitcnt lgkmcnt(6)
s_add_u32 s77, s77, s85
Ta 132,3,8192
CV 225,226,227
Mvav 196,156,56
s_add_u32 s77, s77, 0x60000
Ta 134,3,10240
CV 226,228,229
Mvav 204,156,60
s_waitcnt lgkmcnt(6)
Ta 136,4,8192
CV 227,230,231
Mvav 208,160,56
buffer_load_dword v35, v46, s[44:47], s77 offen
Ta 138,4,10240
Mvav 216,160,60
s_waitcnt lgkmcnt(6)
Ta 140,5,8192
Ta 142,5,10240
Mvav 212,164,56
LD 22,36,76,2048
Ta 144,2,12288
Mvav 220,164,60
s_waitcnt lgkmcnt(7)
Ta 146,2,14336
v_mul_f32 v232, v39, v232
Mvav 192,128,64
Ta 148,3,12288
v_mul_f32 v233, v39, v233
Mvav 200,128,68
s_waitcnt lgkmcnt(7)
Ta 150,3,14336
v_mul_f32 v234, v39, v234
Mvav 196,132,64
Ta 152,4,12288
v_mul_f32 v235, v39, v235
Mvav 204,132,68
s_waitcnt lgkmcnt(7)
Ta 154,4,14336
v_mul_f32 v236, v39, v236
Mvav 208,136,64
LD 23,36,76,3072
Ta 156,5,12288
Mvav 216,136,68
s_waitcnt lgkmcnt(7)
s_add_u32 m0, s67, 0x1c000
s_add_u32 s76, s95, 0x280100
Ta 158,5,14336
Mvav 212,140,64
Ta 160,2,16384
v_mul_f32 v237, v39, v237
Mvav 220,140,68
s_waitcnt lgkmcnt(7)
Ta 162,2,18432
v_mul_f32 v238, v39, v238
Mvav 192,144,72
Ta 164,3,16384
v_mul_f32 v239, v39, v239
Mvav 200,144,76
s_waitcnt lgkmcnt(7)
Ta 166,3,18432
CV 232,232,233
Mvav 196,148,72
LD 20,36,76,0
Ta 128,4,16384
Mvav 204,148,76
s_waitcnt lgkmcnt(7)
Ta 130,4,18432
Ta 132,5,16384
Mvav 208,152,72
Ta 134,5,18432
CV 233,234,235
Mvav 216,152,76
s_waitcnt lgkmcnt(8)
Ta 136,2,20480
CV 234,236,237
Mvav 212,156,72
Ta 138,2,22528
CV 235,238,239
Mvav 220,156,76
s_waitcnt lgkmcnt(8)
Ta 140,3,20480
v_mul_f32 v240, v38, v240
Mvav 192,160,80
LD 21,36,76,1024
Ta 142,3,22528
Mvav 200,160,84
s_waitcnt lgkmcnt(8)
Ta 144,4,20480
v_mul_f32 v241, v38, v241
Mvav 196,164,80
Ta 146,4,22528
v_mul_f32 v242, v38, v242
Mvav 204,164,84
s_waitcnt lgkmcnt(8)
Ta 148,5,20480
v_mul_f32 v243, v38, v243
Mvav 208,128,80
Ta 150,5,22528
v_mul_f32 v244, v38, v244
Mvav 216,128,84
s_waitcnt lgkmcnt(8)
Ta 152,2,24576
v_mul_f32 v245, v38, v245
Mvav 212,132,80
LD 22,36,76,2048
Ta 154,2,26624
Mvav 220,132,84
s_waitcnt lgkmcnt(8)
Ta 156,3,24576
Ta 158,3,26624
Mvav 192,136,88
Ta 160,4,24576
v_mul_f32 v246, v38, v246
Mvav 200,136,92
s_waitcnt lgkmcnt(9)
Ta 162,4,26624
v_mul_f32 v247, v38, v247
Mvav 196,140,88
Ta 164,5,24576
CV 240,240,241
Mvav 204,140,92
s_waitcnt lgkmcnt(9)
Ta 166,5,26624
CV 241,242,243
Mvav 208,144,88
LD 23,36,76,3072
Ta 128,2,28672
Mvav 216,144,92
s_waitcnt lgkmcnt(9)
s_add_u32 m0, s67, 0x1d000
s_add_u32 s76, s95, 0x2c0100
Ta 130,2,30720
Mvav 212,148,88
Ta 132,3,28672
CV 242,244,245
Mvav 220,148,92
s_waitcnt lgkmcnt(9)
Ta 134,3,30720
CV 243,246,247
Mvav 192,152,96
Ta 136,4,28672
v_mul_f32 v248, v39, v248
Mvav 200,152,100
s_waitcnt lgkmcnt(8)
Ta 138,4,30720
v_mul_f32 v249, v39, v249
Mvav 196,156,96
LD 20,36,76,0
Ta 140,5,28672
Mvav 204,156,100
s_waitcnt lgkmcnt(8)
s_add_u32 m0, s67, 0
Ta 142,5,30720
Ta 144,2,32768
Mvav 208,160,96
s_add_u32 s76, s95, 0x180
Ta 146,2,34816
Ta 148,3,32768
Mvav 216,160,100
s_waitcnt lgkmcnt(10)
Ta 150,3,34816
Ta 152,4,32768
Mvav 212,164,96
Ta 154,4,34816
Ta 156,5,32768
Mvav 220,164,100
s_waitcnt lgkmcnt(11)
Ta 158,5,34816
v_add_u32 v2, 0x9000, v2
Mvav 192,128,104
v_add_u32 v3, 0x9000, v3
v_add_u32 v4, 0x9000, v4
Mvav 200,128,108
v_add_u32 v5, 0x9000, v5
v_mul_f32 v250, v39, v250
Mvav 196,132,104
v_permlane32_swap_b32 v224, v226
Mvav 204,132,108
s_waitcnt lgkmcnt(8)
v_permlane32_swap_b32 v225, v227
Mvav 208,136,104
v_permlane16_swap_b32 v224, v226
Mvav 216,136,108
v_permlane16_swap_b32 v225, v227
Mvav 212,140,104
s_waitcnt vmcnt(21) lgkmcnt(0)
s_barrier
v_permlane32_swap_b32 v232, v234
Mvav 220,140,108
Ta 160,2,0
v_accvgpr_write_b32 a0, v224
Mvav 192,144,112
Ta 162,2,2048
v_accvgpr_write_b32 a1, v225
Mvav 200,144,116
Ta 164,3,0
v_accvgpr_write_b32 a2, v226
Mvav 196,148,112
Ta 166,3,2048
Ta 128,4,0
Mvav 204,148,116
Ta 130,4,2048
v_accvgpr_write_b32 a3, v227
Mvav 208,152,112
Ta 132,5,0
v_mul_f32 v251, v39, v251
Mvav 216,152,116
Ta 134,5,2048
v_mul_f32 v252, v39, v252
Mvav 212,156,112
Ta 136,2,4096
v_mul_f32 v253, v39, v253
Mvav 220,156,116
s_waitcnt lgkmcnt(7)
Ta 138,2,6144
v_mul_f32 v254, v39, v254
Mvav 192,160,120
Ta 140,3,4096
v_mul_f32 v255, v39, v255
Mvav 200,160,124
s_waitcnt lgkmcnt(7)
Ta 142,3,6144
CV 248,248,249
Mvav 196,164,120
LD 20,36,76,0
Ta 144,4,4096
Mvav 204,164,124
s_waitcnt lgkmcnt(7)
Ta 146,4,6144
CV 249,250,251
Mvav 208,128,120
Ta 148,5,4096
CV 250,252,253
Mvav 216,128,124
s_waitcnt lgkmcnt(7)
Ta 150,5,6144
CV 251,254,255
Mvav 212,132,120
s_mul_i32 s77, s100, 0x400
Ta 152,2,8192
v_min_u32 v46, 7, v1
Mvav 220,132,124
s_waitcnt lgkmcnt(7)
s_mul_i32 s85, s66, 0x100000
Ta 154,2,10240
Ta 156,3,8192
Mvav 192,136,128
LD 21,36,76,1024
Ta 158,3,10240
Mvav 200,136,132
s_waitcnt lgkmcnt(8)
s_add_u32 s77, s77, s85
Ta 160,4,8192
v_mul_u32_u24 v46, 0x80, v46
Mvav 196,140,128
s_add_u32 s77, s77, 0x60000
Ta 162,4,10240
Mvav 204,140,132
s_waitcnt lgkmcnt(8)
Ta 164,5,8192
Mvav 208,144,128
buffer_load_dword v35, v46, s[48:51], s77 offen
Ta 166,5,10240
Mvav 216,144,132
s_waitcnt lgkmcnt(8)
Ta 128,2,12288
Mvav 212,148,128
LD 22,36,76,2048
Ta 130,2,14336
Mvav 220,148,132
s_waitcnt lgkmcnt(8)
Ta 132,3,12288
Mvav 192,152,136
Ta 134,3,14336
Mvav 200,152,140
s_waitcnt lgkmcnt(8)
Ta 136,4,12288
Mvav 196,156,136
Ta 138,4,14336
Mvav 204,156,140
s_waitcnt lgkmcnt(8)
Ta 140,5,12288
Mvav 208,160,136
LD 23,36,76,3072
Ta 142,5,14336
Mvav 216,160,140
s_waitcnt lgkmcnt(8)
s_add_u32 m0, s67, 0x1000
s_add_u32 s76, s95, 0x40180
Ta 144,2,16384
Mvav 212,164,136
Ta 146,2,18432
Ta 148,3,16384
Mvav 220,164,140
s_waitcnt lgkmcnt(9)
Ta 150,3,18432
Mvav 192,128,144
Ta 152,4,16384
Mvav 200,128,148
s_waitcnt lgkmcnt(9)
Ta 154,4,18432
Mvav 196,132,144
LD 20,36,76,0
Ta 156,5,16384
Mvav 204,132,148
s_waitcnt lgkmcnt(9)
Ta 158,5,18432
Mvav 208,136,144
Ta 160,2,20480
Mvav 216,136,148
s_waitcnt lgkmcnt(9)
Ta 162,2,22528
Mvav 212,140,144
Ta 164,3,20480
Mvav 220,140,148
s_waitcnt lgkmcnt(8)
Ta 166,3,22528
Mvav 192,144,152
LD 21,36,76,1024
Ta 128,4,20480
Mvav 200,144,156
s_waitcnt lgkmcnt(8)
Ta 130,4,22528
Mvav 196,148,152
Ta 132,5,20480
Ta 134,5,22528
Mvav 204,148,156
s_waitcnt lgkmcnt(9)
Ta 136,2,24576
Mvav 208,152,152
Ta 138,2,26624
Mvav 216,152,156
s_waitcnt lgkmcnt(9)
Ta 140,3,24576
Mvav 212,156,152
LD 22,36,76,2048
Ta 142,3,26624
Mvav 220,156,156
s_waitcnt lgkmcnt(9)
Ta 144,4,24576
Mvav 192,160,160
Ta 146,4,26624
Mvav 200,160,164
s_waitcnt lgkmcnt(9)
Ta 148,5,24576
Mvav 196,164,160
Ta 150,5,26624
Mvav 204,164,164
s_waitcnt lgkmcnt(8)
Ta 152,2,28672
Mvav 208,128,160
LD 23,36,76,3072
Ta 154,2,30720
Mvav 216,128,164
s_add_u32 m0, s67, 0x2000
s_add_u32 s76, s95, 0x80180
Ta 156,3,28672
Mvav 212,132,160
Ta 158,3,30720
Mvav 220,132,164
s_waitcnt lgkmcnt(8)
Ta 160,4,28672
Ta 162,4,30720
Mvav 192,136,168
Ta 164,5,28672
Mvav 200,136,172
s_waitcnt lgkmcnt(7)
Ta 166,5,30720
Mvav 196,140,168
LD 20,36,76,0
Ta 128,2,32768
Mvav 204,140,172
s_add_u32 m0, s67, 0x9000
Ta 130,2,34816
Ta 132,3,32768
Mvav 208,144,168
s_add_u32 s76, s95, 0x240180
Ta 134,3,34816
Ta 136,4,32768
Mvav 216,144,172
Ta 138,4,34816
Ta 140,5,32768
Mvav 212,148,168
Ta 142,5,34816
v_add_u32 v2, 0x9000, v2
Mvav 220,148,172
s_waitcnt lgkmcnt(11)
v_permlane32_swap_b32 v233, v235
Mvav 192,152,176
v_permlane16_swap_b32 v232, v234
Mvav 200,152,180
v_permlane16_swap_b32 v233, v235
Mvav 196,156,176
v_permlane32_swap_b32 v240, v242
Mvav 204,156,180
s_waitcnt lgkmcnt(7)
v_permlane32_swap_b32 v241, v243
Mvav 208,160,176
v_permlane16_swap_b32 v240, v242
Mvav 216,160,180
s_waitcnt vmcnt(21) lgkmcnt(0)
s_barrier
v_permlane16_swap_b32 v241, v243
v_add_u32 v3, 0x9000, v3
Mvav 212,164,176
Ta 144,2,0
v_add_u32 v4, 0x9000, v4
Mvav 220,164,180
Ta 146,2,2048
v_add_u32 v5, 0x9000, v5
Mvav 192,128,184
Ta 148,3,0
v_accvgpr_write_b32 a4, v232
Mvav 200,128,188
Ta 150,3,2048
v_accvgpr_write_b32 a5, v233
Mvav 196,132,184
Ta 152,4,0
v_accvgpr_write_b32 a6, v234
Mvav 204,132,188
Ta 154,4,2048
v_accvgpr_write_b32 a7, v235
Mvav 208,136,184
Ta 156,5,0
v_accvgpr_write_b32 a8, v240
Mvav 216,136,188
Ta 158,5,2048
v_accvgpr_write_b32 a9, v241
Mvav 212,140,184
Ta 160,2,4096
v_accvgpr_write_b32 a10, v242
Mvav 220,140,188
s_waitcnt lgkmcnt(7)
Ta 162,2,6144
v_accvgpr_write_b32 a11, v243
v_mfma_f32_16x16x32_bf16 v[224:227], a[144:147], v[48:51], 0
Ta 164,3,4096
v_mul_f32 v192, v38, v192
v_mfma_f32_16x16x32_bf16 v[232:235], a[144:147], v[52:55], 0
s_waitcnt lgkmcnt(7)
Ta 166,3,6144
v_mul_f32 v193, v38, v193
v_mfma_f32_16x16x32_bf16 v[228:231], a[148:151], v[48:51], 0
LD 20,36,76,0
Ta 128,4,4096
v_permlane32_swap_b32 v248, v250
v_mfma_f32_16x16x32_bf16 v[236:239], a[148:151], v[52:55], 0
s_waitcnt lgkmcnt(7)
Ta 130,4,6144
v_permlane32_swap_b32 v249, v251
v_mfma_f32_16x16x32_bf16 v[240:243], a[152:155], v[48:51], 0
v_permlane16_swap_b32 v248, v250
v_permlane16_swap_b32 v249, v251
v_accvgpr_write_b32 a12, v248
v_accvgpr_write_b32 a14, v250
v_accvgpr_write_b32 a13, v249
v_accvgpr_write_b32 a15, v251
v_mfma_f32_16x16x32_bf16 v[248:251], a[152:155], v[52:55], 0
s_waitcnt lgkmcnt(5)
Ta 132,5,4096
v_mul_f32 v194, v38, v194
v_mfma_f32_16x16x32_bf16 v[244:247], a[156:159], v[48:51], 0
s_mul_i32 s77, s100, 0x400
Ta 134,5,6144
v_min_u32 v46, 7, v1
v_mfma_f32_16x16x32_bf16 v[252:255], a[156:159], v[52:55], 0
s_waitcnt lgkmcnt(5)
s_mul_i32 s85, s66, 0x100000
Ta 136,2,8192
v_mul_u32_u24 v46, 0x80, v46
L_pg6_3:
s_cbranch_execz L_ret6
Mvav 224,160,56
LD 21,36,76,1024
Ta 138,2,10240
Mvav 232,160,60
s_waitcnt lgkmcnt(5)
s_add_u32 s77, s77, s85
Ta 140,3,8192
v_mul_f32 v195, v38, v195
Mvav 228,164,56
s_add_u32 s77, s77, 0x70000
Ta 142,3,10240
v_mul_f32 v196, v38, v196
Mvav 236,164,60
s_waitcnt lgkmcnt(6)
Ta 144,4,8192
v_mul_f32 v197, v38, v197
Mvav 240,128,56
buffer_load_dword v35, v46, s[44:47], s77 offen
Ta 146,4,10240
Mvav 248,128,60
s_waitcnt lgkmcnt(6)
Ta 148,5,8192
v_mul_f32 v198, v38, v198
Mvav 244,132,56
LD 22,36,76,2048
Ta 150,5,10240
Mvav 252,132,60
s_waitcnt lgkmcnt(6)
Ta 152,2,12288
Ta 154,2,14336
Mvav 224,136,64
Ta 156,3,12288
v_mul_f32 v199, v38, v199
Mvav 232,136,68
s_waitcnt lgkmcnt(7)
Ta 158,3,14336
CV 192,192,193
Mvav 228,140,64
Ta 160,4,12288
CV 193,194,195
Mvav 236,140,68
s_waitcnt lgkmcnt(7)
Ta 162,4,14336
CV 194,196,197
Mvav 240,144,64
LD 23,36,76,3072
Ta 164,5,12288
Mvav 248,144,68
s_waitcnt lgkmcnt(7)
s_add_u32 m0, s67, 0xa000
s_add_u32 s76, s95, 0x280180
Ta 166,5,14336
Mvav 244,148,64
Ta 128,2,16384
CV 195,198,199
Mvav 252,148,68
s_waitcnt lgkmcnt(7)
Ta 130,2,18432
v_mul_f32 v200, v39, v200
Mvav 224,152,72
Ta 132,3,16384
v_mul_f32 v201, v39, v201
Mvav 232,152,76
s_waitcnt lgkmcnt(7)
Ta 134,3,18432
v_mul_f32 v202, v39, v202
Mvav 228,156,72
LD 20,36,76,0
Ta 136,4,16384
Mvav 236,156,76
s_waitcnt lgkmcnt(7)
Ta 138,4,18432
v_mul_f32 v203, v39, v203
Mvav 240,160,72
Ta 140,5,16384
v_mul_f32 v204, v39, v204
Mvav 248,160,76
s_waitcnt lgkmcnt(7)
Ta 142,5,18432
Ta 144,2,20480
Mvav 244,164,72
Ta 146,2,22528
v_mul_f32 v205, v39, v205
Mvav 252,164,76
s_waitcnt lgkmcnt(8)
Ta 148,3,20480
v_mul_f32 v206, v39, v206
Mvav 224,128,80
LD 21,36,76,1024
Ta 150,3,22528
Mvav 232,128,84
s_waitcnt lgkmcnt(8)
Ta 152,4,20480
v_mul_f32 v207, v39, v207
Mvav 228,132,80
Ta 154,4,22528
CV 200,200,201
Mvav 236,132,84
s_waitcnt lgkmcnt(8)
Ta 156,5,20480
CV 201,202,203
Mvav 240,136,80
Ta 158,5,22528
CV 202,204,205
Mvav 248,136,84
s_waitcnt lgkmcnt(8)
Ta 160,2,24576
CV 203,206,207
Mvav 244,140,80
LD 22,36,76,2048
Ta 162,2,26624
Mvav 252,140,84
s_waitcnt lgkmcnt(8)
Ta 164,3,24576
v_mul_f32 v208, v38, v208
Mvav 224,144,88
s_and_b32 s85, s30, 31
Ta 166,3,26624
v_and_b32 v46, 32, v1
Mvav 232,144,92
s_waitcnt lgkmcnt(8)
s_lshl_b32 s85, s85, 8
Ta 128,4,24576
v_lshl_add_u32 v46, v46, 2, s85
Mvav 228,148,88
s_getpc_b64 s[96:97]
L_ca1_2:
s_add_u32 s96, s96, L_Amain+0-L_ca1_2
s_addc_u32 s97, s97, 0
Ta 130,4,26624
Ta 132,5,24576
Mvav 236,148,92
s_waitcnt lgkmcnt(9)
global_load_dword v35, v46, s[96:97]
Ta 134,5,26624
Mvav 240,152,88
s_waitcnt lgkmcnt(8)
Ta 136,2,28672
v_mul_f32 v209, v38, v209
Mvav 248,152,92
LD 23,36,76,3072
Ta 138,2,30720
Mvav 244,156,88
s_add_u32 m0, s67, 0xb000
s_add_u32 s76, s95, 0x2c0180
Ta 140,3,28672
Mvav 252,156,92
s_waitcnt lgkmcnt(9)
Ta 142,3,30720
v_mul_f32 v210, v38, v210
Mvav 224,160,96
Ta 144,4,28672
v_mul_f32 v211, v38, v211
Mvav 232,160,100
s_waitcnt lgkmcnt(9)
Ta 146,4,30720
v_mul_f32 v212, v38, v212
Mvav 228,164,96
LD 20,36,76,0
Ta 148,5,28672
Mvav 236,164,100
s_waitcnt lgkmcnt(8)
s_add_u32 m0, s67, 0x12000
Ta 150,5,30720
Ta 152,2,32768
Mvav 240,128,96
s_add_u32 s76, s70, 0
Ta 154,2,34816
Ta 156,3,32768
Mvav 248,128,100
s_waitcnt lgkmcnt(10)
Ta 158,3,34816
Ta 160,4,32768
Mvav 244,132,96
Ta 162,4,34816
Ta 164,5,32768
Mvav 252,132,100
s_waitcnt lgkmcnt(11)
Ta 166,5,34816
v_add_u32 v2, 0x9000, v2
v_add_u32 v3, 0x9000, v3
Mvav 224,136,104
v_add_u32 v4, 0x9000, v4
v_add_u32 v5, 0x9000, v5
Mvav 232,136,108
v_permlane32_swap_b32 v192, v194
Mvav 228,140,104
v_permlane32_swap_b32 v193, v195
Mvav 236,140,108
s_waitcnt lgkmcnt(7)
v_permlane16_swap_b32 v192, v194
Mvav 240,144,104
v_permlane16_swap_b32 v193, v195
Mvav 248,144,108
s_waitcnt vmcnt(21) lgkmcnt(0)
s_barrier
v_permlane32_swap_b32 v200, v202
Mvav 244,148,104
Ta 128,2,0
v_accvgpr_write_b32 a16, v192
Mvav 252,148,108
Ta 130,2,2048
v_accvgpr_write_b32 a17, v193
Mvav 224,152,112
Ta 132,3,0
v_accvgpr_write_b32 a18, v194
Mvav 232,152,116
Ta 134,3,2048
v_accvgpr_write_b32 a19, v195
Mvav 228,156,112
Ta 136,4,0
v_mul_f32 v213, v38, v213
Mvav 236,156,116
Ta 138,4,2048
v_mul_f32 v214, v38, v214
Mvav 240,160,112
Ta 140,5,0
v_mul_f32 v215, v38, v215
Mvav 248,160,116
Ta 142,5,2048
Ta 144,2,4096
Mvav 244,164,112
Ta 146,2,6144
CV 208,208,209
Mvav 252,164,116
s_waitcnt lgkmcnt(8)
Ta 148,3,4096
CV 209,210,211
Mvav 224,128,120
buffer_load_dword v29, v28, s[40:43], 0 offen sc1
Ta 150,3,6144
Mvav 232,128,124
s_waitcnt lgkmcnt(8)
Ta 152,4,4096
CV 210,212,213
Mvav 228,132,120
LD 8,56,76,0
Ta 154,4,6144
Mvav 236,132,124
s_waitcnt lgkmcnt(8)
Ta 156,5,4096
CV 211,214,215
Mvav 240,136,120
Ta 158,5,6144
v_mul_f32 v216, v39, v216
Mvav 248,136,124
s_waitcnt lgkmcnt(8)
Ta 160,2,8192
v_mul_f32 v217, v39, v217
Mvav 244,140,120
s_mul_i32 s77, s100, 0x400
Ta 162,2,10240
v_min_u32 v46, 7, v1
Mvav 252,140,124
s_waitcnt lgkmcnt(8)
s_mul_i32 s85, s66, 0x100000
Ta 164,3,8192
v_mul_u32_u24 v46, 0x80, v46
Mvav 224,144,128
LD 9,56,76,1024
Ta 166,3,10240
Mvav 232,144,132
s_waitcnt lgkmcnt(8)
s_add_u32 s77, s77, s85
Ta 128,4,8192
v_mul_f32 v218, v39, v218
Mvav 228,148,128
s_add_u32 s77, s77, 0x70000
Ta 130,4,10240
Ta 132,5,8192
Mvav 236,148,132
s_waitcnt lgkmcnt(9)
Ta 134,5,10240
v_mul_f32 v219, v39, v219
Mvav 240,152,128
buffer_load_dword v35, v46, s[48:51], s77 offen
Ta 136,2,12288
Mvav 248,152,132
s_waitcnt lgkmcnt(9)
Ta 138,2,14336
v_mul_f32 v220, v39, v220
Mvav 244,156,128
LD 10,56,76,2048
Ta 140,3,12288
Mvav 252,156,132
s_waitcnt lgkmcnt(9)
Ta 142,3,14336
v_mul_f32 v221, v39, v221
Mvav 224,160,136
Ta 144,4,12288
v_mul_f32 v222, v39, v222
Mvav 232,160,140
s_waitcnt lgkmcnt(9)
Ta 146,4,14336
v_mul_f32 v223, v39, v223
Mvav 228,164,136
Ta 148,5,12288
CV 216,216,217
Mvav 236,164,140
s_waitcnt lgkmcnt(8)
Ta 150,5,14336
CV 217,218,219
Mvav 240,128,136
LD 11,56,76,3072
Ta 152,2,16384
Mvav 248,128,140
s_waitcnt lgkmcnt(9)
s_add_u32 m0, s67, 0x13000
s_add_u32 s76, s70, 0x9000
Ta 154,2,18432
Mvav 244,132,136
Ta 156,3,16384
CV 218,220,221
Mvav 252,132,140
s_waitcnt lgkmcnt(8)
Ta 158,3,18432
Ta 160,4,16384
Mvav 224,136,144
Ta 162,4,18432
CV 219,222,223
Mvav 232,136,148
s_waitcnt lgkmcnt(9)
Ta 164,5,16384
v_and_b32 v20, 15, v1
Mvav 228,140,144
LD 8,56,76,0
Ta 166,5,18432
Mvav 236,140,148
s_waitcnt lgkmcnt(9)
Ta 128,2,20480
v_lshrrev_b32 v21, 4, v1
Mvav 240,144,144
Ta 130,2,22528
v_xor_b32 v21, v21, v20
Mvav 248,144,148
s_waitcnt lgkmcnt(9)
Ta 132,3,20480
v_lshlrev_b32 v20, 8, v20
Mvav 244,148,144
Ta 134,3,22528
v_lshl_add_u32 v20, v21, 4, v20
Mvav 252,148,148
s_waitcnt lgkmcnt(9)
Ta 136,4,20480
v_xor_b32 v21, 64, v20
Mvav 224,152,152
LD 9,56,76,1024
Ta 138,4,22528
Mvav 232,152,156
s_waitcnt lgkmcnt(8)
Ta 140,5,20480
v_xor_b32 v22, 0x80, v20
Mvav 228,156,152
Ta 142,5,22528
v_xor_b32 v23, 0xc0, v20
Mvav 236,156,156
Ta 144,2,24576
Mvav 240,160,152
Ta 146,2,26624
Mvav 248,160,156
s_waitcnt lgkmcnt(8)
Ta 148,3,24576
Ta 150,3,26624
Mvav 244,164,152
LD 10,56,76,2048
Ta 152,4,24576
Mvav 252,164,156
Ta 154,4,26624
Mvav 224,128,160
Ta 156,5,24576
Mvav 232,128,164
s_waitcnt lgkmcnt(9)
Ta 158,5,26624
Mvav 228,132,160
Ta 160,2,28672
Mvav 236,132,164
s_waitcnt lgkmcnt(7)
Ta 162,2,30720
Mvav 240,136,160
LD 11,56,76,3072
Ta 164,3,28672
Mvav 248,136,164
s_add_u32 m0, s67, 0x14000
s_add_u32 s76, s70, 0x12000
Ta 166,3,30720
Mvav 244,140,160
Ta 128,4,28672
Mvav 252,140,164
Ta 130,4,30720
Mvav 224,144,168
Ta 132,5,28672
Mvav 232,144,172
s_waitcnt lgkmcnt(8)
Ta 134,5,30720
Mvav 228,148,168
LD 8,56,76,0
Ta 136,2,32768
Mvav 236,148,172
s_add_u32 m0, s67, 0x1b000
Ta 138,2,34816
Ta 140,3,32768
Mvav 240,152,168
s_add_u32 s76, s70, 0x51000
Ta 142,3,34816
Ta 144,4,32768
Mvav 248,152,172
s_waitcnt lgkmcnt(10)
Ta 146,4,34816
Ta 148,5,32768
Mvav 244,156,168
Ta 150,5,34816
v_add_u32 v2, 0xfffe5000, v2
Mvav 252,156,172
s_waitcnt vmcnt(10)
v_cmp_ne_u32 vcc, s98, v29
s_cbranch_vccnz L_spin3_2
L_pollok3_2:
Mvav 224,160,176
buffer_load_dwordx4 a[64:67], v31, s[40:43], s5 offen sc1
v_add_u32 v3, 0xfffe5000, v3
Mvav 232,160,180
s_waitcnt lgkmcnt(9)
v_permlane32_swap_b32 v201, v203
Mvav 228,164,176
v_permlane16_swap_b32 v200, v202
Mvav 236,164,180
v_permlane16_swap_b32 v201, v203
Mvav 240,128,176
buffer_load_dwordx4 a[68:71], v6, s[40:43], s5 offen offset:256 sc1
s_waitcnt lgkmcnt(0)
s_barrier
Mvav 248,128,180
Ta 152,2,0
v_add_u32 v4, 0xfffe5000, v4
Mvav 244,132,176
Ta 154,2,2048
v_add_u32 v5, 0xfffe5000, v5
Mvav 252,132,180
Ta 156,3,0
Ta 158,3,2048
Mvav 224,136,184
buffer_load_dwordx4 a[72:75], v31, s[40:43], s5 offen offset:2048 sc1
Ta 160,4,0
Mvav 232,136,188
Ta 162,4,2048
v_accvgpr_write_b32 a20, v200
Mvav 228,140,184
Ta 164,5,0
v_accvgpr_write_b32 a21, v201
Mvav 236,140,188
Ta 166,5,2048
v_accvgpr_write_b32 a22, v202
Mvav 240,144,184
buffer_load_dwordx4 a[76:79], v6, s[40:43], s5 offen offset:2304 sc1
Ta 128,2,4096
Mvav 248,144,188
s_mov_b32 s5, 0x48d000
Ta 130,2,6144
v_accvgpr_write_b32 a23, v203
Mvav 244,148,184
Ta 132,3,4096
v_mul_f32 v224, v38, v224
Mvav 252,148,188
s_waitcnt lgkmcnt(9)
Ta 134,3,6144
v_mul_f32 v248, v39, v248
v_mfma_f32_16x16x32_bf16 v[192:195], a[152:155], v[48:51], 0
Ta 136,4,4096
v_mul_f32 v249, v39, v249
v_mfma_f32_16x16x32_bf16 v[200:203], a[152:155], v[52:55], 0
s_waitcnt lgkmcnt(8)
Ta 138,4,6144
v_permlane32_swap_b32 v208, v210
v_mfma_f32_16x16x32_bf16 v[196:199], a[156:159], v[48:51], 0
LD 8,56,76,0
Ta 140,5,4096
v_mfma_f32_16x16x32_bf16 v[204:207], a[156:159], v[52:55], 0
s_waitcnt lgkmcnt(5)
buffer_load_dwordx4 a[80:83], v31, s[40:43], s6 offen sc1
v_permlane32_swap_b32 v209, v211
v_permlane16_swap_b32 v208, v210
s_nop 0
v_permlane16_swap_b32 v209, v211
v_permlane32_swap_b32 v216, v218
v_permlane32_swap_b32 v217, v219
v_accvgpr_write_b32 a24, v208
v_accvgpr_write_b32 a25, v209
v_accvgpr_write_b32 a26, v210
v_accvgpr_write_b32 a27, v211
v_mfma_f32_16x16x32_bf16 v[208:211], a[160:163], v[48:51], 0
v_permlane16_swap_b32 v216, v218
v_permlane16_swap_b32 v217, v219
v_accvgpr_write_b32 a28, v216
v_accvgpr_write_b32 a30, v218
v_accvgpr_write_b32 a29, v217
v_accvgpr_write_b32 a31, v219
v_mfma_f32_16x16x32_bf16 v[216:219], a[160:163], v[52:55], 0
Ta 142,5,6144
Ta 144,2,8192
v_mfma_f32_16x16x32_bf16 v[212:215], a[164:167], v[48:51], 0
Ta 146,2,10240
v_mul_f32 v250, v39, v250
v_mfma_f32_16x16x32_bf16 v[220:223], a[164:167], v[52:55], 0
Ta 148,3,8192
v_mul_f32 v251, v39, v251
Mvav 192,128,56
LD 9,56,76,1024
Ta 150,3,10240
Mvav 200,128,60
s_waitcnt lgkmcnt(5)
Ta 152,4,8192
v_mul_f32 v254, v39, v254
Mvav 196,132,56
Ta 154,4,10240
v_mul_f32 v255, v39, v255
Mvav 204,132,60
Ta 156,5,8192
CV 248,248,249
Mvav 208,136,56
buffer_load_dwordx4 a[84:87], v6, s[40:43], s6 offen offset:256 sc1
Ta 158,5,10240
Mvav 216,136,60
s_waitcnt lgkmcnt(8)
Ta 160,2,12288
CV 249,250,251
Mvav 212,140,56
Ta 162,2,14336
CV 251,254,255
Mvav 220,140,60
s_waitcnt lgkmcnt(8)
Ta 164,3,12288
v_mul_f32 v225, v38, v225
Mvav 192,144,64
LD 10,56,76,2048
Ta 166,3,14336
Mvav 200,144,68
s_waitcnt lgkmcnt(8)
Ta 128,4,12288
v_mul_f32 v226, v38, v226
Mvav 196,148,64
Ta 130,4,14336
Ta 132,5,12288
Mvav 204,148,68
s_waitcnt lgkmcnt(9)
Ta 134,5,14336
v_mul_f32 v227, v38, v227
Mvav 208,152,64
buffer_load_dwordx4 a[88:91], v31, s[40:43], s6 offen offset:2048 sc1
Ta 136,2,16384
Mvav 216,152,68
s_waitcnt lgkmcnt(9)
Ta 138,2,18432
v_mul_f32 v228, v38, v228
Mvav 212,156,64
Ta 140,3,16384
v_mul_f32 v229, v38, v229
Mvav 220,156,68
s_waitcnt lgkmcnt(9)
Ta 142,3,18432
v_mul_f32 v230, v38, v230
Mvav 192,160,72
LD 11,56,76,3072
Ta 144,4,16384
Mvav 200,160,76
s_waitcnt lgkmcnt(9)
s_add_u32 m0, s67, 0x1c000
s_add_u32 s76, s70, 0x5a000
Ta 146,4,18432
Mvav 196,164,72
Ta 148,5,16384
v_mul_f32 v231, v38, v231
Mvav 204,164,76
s_waitcnt lgkmcnt(8)
Ta 150,5,18432
CV 224,224,225
Mvav 208,128,72
buffer_load_dwordx4 a[92:95], v6, s[40:43], s6 offen offset:2304 sc1
Ta 152,2,20480
Mvav 216,128,76
s_waitcnt lgkmcnt(9)
s_mov_b32 s6, 0x48e000
Ta 154,2,22528
CV 225,226,227
Mvav 212,132,72
Ta 156,3,20480
L_pg6_4:
s_cbranch_execz L_ret6
CV 226,228,229
Mvav 220,132,76
s_waitcnt lgkmcnt(8)
Ta 158,3,22528
Ta 160,4,20480
Mvav 192,136,80
buffer_load_dwordx2 a[96:97], v31, s[40:43], s7 offen sc1
Ta 162,4,22528
Mvav 200,136,84
s_waitcnt lgkmcnt(9)
Ta 164,5,20480
CV 227,230,231
Mvav 196,140,80
LD 8,56,76,0
Ta 166,5,22528
Mvav 204,140,84
s_waitcnt lgkmcnt(9)
Ta 128,2,24576
v_mul_f32 v232, v39, v232
Mvav 208,144,80
Ta 130,2,26624
v_mul_f32 v233, v39, v233
Mvav 216,144,84
s_waitcnt lgkmcnt(9)
Ta 132,3,24576
v_mul_f32 v234, v39, v234
Mvav 212,148,80
buffer_load_dwordx2 a[98:99], v6, s[40:43], s7 offen offset:8 sc1
Ta 134,3,26624
Mvav 220,148,84
s_waitcnt lgkmcnt(9)
Ta 136,4,24576
v_mul_f32 v235, v39, v235
Mvav 192,152,88
buffer_load_dwordx2 a[100:101], v6, s[40:43], s7 offen offset:256 sc1
Ta 138,4,26624
Mvav 200,152,92
s_waitcnt lgkmcnt(9)
s_and_b32 s85, s30, 31
Ta 140,5,24576
v_and_b32 v46, 32, v1
Mvav 196,156,88
LD 9,56,76,1024
Ta 142,5,26624
Mvav 204,156,92
s_waitcnt lgkmcnt(9)
s_lshl_b32 s85, s85, 8
Ta 144,2,28672
v_lshl_add_u32 v46, v46, 2, s85
Mvav 208,160,88
s_getpc_b64 s[96:97]
L_ca2_2:
s_add_u32 s96, s96, L_Amain+8192-L_ca2_2
s_addc_u32 s97, s97, 0
Ta 146,2,30720
v_mul_f32 v236, v39, v236
Mvav 216,160,92
s_waitcnt lgkmcnt(8)
Ta 148,3,28672
Ta 150,3,30720
Mvav 212,164,88
buffer_load_dwordx2 a[102:103], v32, s[40:43], s7 offen offset:8 sc1
Ta 152,4,28672
Mvav 220,164,92
Ta 154,4,30720
v_mul_f32 v237, v39, v237
Mvav 192,128,96
LD 10,56,76,2048
Ta 156,5,28672
Mvav 200,128,100
s_waitcnt lgkmcnt(9)
Ta 158,5,30720
v_mul_f32 v238, v39, v238
Mvav 196,132,96
Ta 160,2,32768
v_mul_f32 v239, v39, v239
Mvav 204,132,100
Ta 162,2,34816
Ta 164,3,32768
Mvav 208,136,96
buffer_load_dwordx4 a[104:107], v6, s[40:43], s7 offen offset:2048 sc1
Ta 166,3,34816
Mvav 216,136,100
s_waitcnt lgkmcnt(10)
Ta 128,4,32768
Ta 130,4,34816
Mvav 212,140,96
Ta 132,5,32768
Ta 134,5,34816
Mvav 220,140,100
s_waitcnt lgkmcnt(9)
v_add_u32 v2, 0x9000, v2
v_add_u32 v3, 0x9000, v3
Mvav 192,144,104
LD 11,56,76,3072
v_add_u32 v4, 0x9000, v4
Mvav 200,144,108
s_add_u32 m0, s67, 0x1d000
s_add_u32 s76, s70, 0x63000
v_add_u32 v5, 0x9000, v5
Mvav 196,148,104
v_permlane32_swap_b32 v224, v226
CV 232,232,233
Mvav 204,148,108
v_permlane32_swap_b32 v225, v227
Mvav 208,152,104
buffer_load_dwordx4 a[108:111], v32, s[40:43], s7 offen offset:2048 sc1
s_waitcnt lgkmcnt(0)
s_barrier
Mvav 216,152,108
s_mov_b32 s7, 0x48f000
Ta 136,2,0
CV 233,234,235
Mvav 212,156,104
Ta 138,2,2048
CV 234,236,237
Mvav 220,156,108
Ta 140,3,0
CV 235,238,239
Mvav 192,160,112
LD 8,56,76,0
Ta 142,3,2048
Mvav 200,160,116
s_add_u32 m0, s69, 0
s_add_u32 s76, s71, 0x60000
Ta 144,4,0
Mvav 196,164,112
Ta 146,4,2048
v_mul_f32 v240, v38, v240
Mvav 204,164,116
Ta 148,5,0
v_mul_f32 v241, v38, v241
Mvav 208,128,112
buffer_load_dwordx4 a[112:115], v6, s[40:43], s4 offen sc1
Ta 150,5,2048
Mvav 216,128,116
Ta 152,2,4096
v_mul_f32 v242, v38, v242
Mvav 212,132,112
Ta 154,2,6144
v_mul_f32 v243, v38, v243
Mvav 220,132,116
s_waitcnt lgkmcnt(8)
Ta 156,3,4096
Ta 158,3,6144
Mvav 192,136,120
buffer_load_dwordx4 a[116:119], v32, s[40:43], s4 offen sc1
Ta 160,4,4096
Mvav 200,136,124
s_waitcnt lgkmcnt(9)
Ta 162,4,6144
v_mul_f32 v244, v38, v244
Mvav 196,140,120
Ta 164,5,4096
v_mul_f32 v245, v38, v245
Mvav 204,140,124
s_waitcnt lgkmcnt(9)
Ta 166,5,6144
v_mul_f32 v246, v38, v246
Mvav 208,144,120
buffer_load_dwordx4 a[120:123], v6, s[40:43], s4 offen offset:2048 sc1
Ta 128,2,8192
Mvav 216,144,124
s_waitcnt lgkmcnt(9)
Ta 130,2,10240
v_mul_f32 v247, v38, v247
Mvav 212,148,120
Ta 132,3,8192
CV 240,240,241
Mvav 220,148,124
s_waitcnt lgkmcnt(9)
Ta 134,3,10240
v_mul_f32 v252, v39, v252
Mvav 192,152,128
global_load_dword v35, v46, s[96:97]
Ta 136,4,8192
Mvav 200,152,132
s_waitcnt lgkmcnt(9)
Ta 138,4,10240
v_mul_f32 v253, v39, v253
Mvav 196,156,128
buffer_load_dwordx4 a[124:127], v32, s[40:43], s4 offen offset:2048 sc1
Ta 140,5,8192
Mvav 204,156,132
s_waitcnt lgkmcnt(8)
s_mov_b32 s4, 0x490000
Ta 142,5,10240
CV 241,242,243
Mvav 208,160,128
Ta 144,2,12288
CV 242,244,245
Mvav 216,160,132
s_waitcnt lgkmcnt(8)
Ta 146,2,14336
Ta 148,3,12288
Mvav 212,164,128
LD 12,44,76,0
Ta 150,3,14336
Mvav 220,164,132
s_waitcnt lgkmcnt(9)
Ta 152,4,12288
v_cndmask_b32 v130, v177, v185, s[22:23]
Mvav 192,128,136
Ta 154,4,14336
v_cndmask_b32 v128, v176, v184, s[22:23]
Mvav 200,128,140
s_waitcnt lgkmcnt(9)
Ta 156,5,12288
v_lshlrev_b32 v131, 16, v130
Mvav 196,132,136
buffer_load_dwordx4 a[168:171], v6, s[40:43], s5 offen sc1
Ta 158,5,14336
Mvav 204,132,140
s_waitcnt lgkmcnt(9)
Ta 160,2,16384
v_and_b32 v130, s90, v130
Mvav 208,136,136
Ta 162,2,18432
v_lshlrev_b32 v129, 16, v128
Mvav 216,136,140
s_waitcnt lgkmcnt(9)
Ta 164,3,16384
v_cndmask_b32 v132, v178, v186, s[22:23]
Mvav 212,140,136
buffer_load_dwordx4 a[172:175], v32, s[40:43], s5 offen sc1
Ta 166,3,18432
Mvav 220,140,140
s_waitcnt lgkmcnt(9)
Ta 128,4,16384
v_and_b32 v128, s90, v128
Mvav 192,144,144
Ta 130,4,18432
v_lshlrev_b32 v133, 16, v132
Mvav 200,144,148
s_waitcnt lgkmcnt(8)
Ta 132,5,16384
v_and_b32 v132, s90, v132
Mvav 196,148,144
LD 13,44,76,1024
Ta 134,5,18432
Mvav 204,148,148
Ta 136,2,20480
Ta 138,2,22528
Mvav 208,152,144
Ta 140,3,20480
CV 243,246,247
Mvav 216,152,148
s_waitcnt lgkmcnt(9)
Ta 142,3,22528
CV 250,252,253
Mvav 212,156,144
buffer_load_dwordx4 a[176:179], v33, s[40:43], s5 offen offset:2048 sc1
Ta 144,4,20480
Mvav 220,156,148
Ta 146,4,22528
v_and_b32 v8, 7, v1
Mvav 192,160,152
Ta 148,5,20480
v_mov_b32 v28, 0xff800000
Mvav 200,160,156
s_waitcnt lgkmcnt(9)
Ta 150,5,22528
v_mov_b32 v29, 0xff800000
Mvav 196,164,152
buffer_load_dwordx4 a[180:183], v6, s[40:43], s5 offen offset:2304 sc1
Ta 152,2,24576
Mvav 204,164,156
s_mov_b32 s5, 0x491000
Ta 154,2,26624
v_mov_b32 v31, 0xff800000
Mvav 208,128,152
Ta 156,3,24576
Mvav 216,128,156
s_waitcnt lgkmcnt(8)
Ta 158,3,26624
Mvav 212,132,152
buffer_load_dwordx4 a[184:187], v33, s[40:43], s6 offen sc1
Ta 160,4,24576
Mvav 220,132,156
Ta 162,4,26624
v_permlane16_swap_b32 v224, v226
Mvav 192,136,160
Ta 164,5,24576
v_accvgpr_write_b32 a32, v224
Mvav 200,136,164
s_waitcnt lgkmcnt(8)
Ta 166,5,26624
v_accvgpr_write_b32 a34, v226
Mvav 196,140,160
LD 14,44,76,2048
Ta 128,2,28672
Mvav 204,140,164
Ta 130,2,30720
Mvav 208,144,160
Ta 132,3,28672
Mvav 216,144,164
s_waitcnt lgkmcnt(8)
Ta 134,3,30720
Mvav 212,148,160
buffer_load_dwordx4 a[188:191], v6, s[40:43], s6 offen offset:256 sc1
Ta 136,4,28672
Mvav 220,148,164
Ta 138,4,30720
Mvav 192,152,168
Ta 140,5,28672
Mvav 200,152,172
s_waitcnt lgkmcnt(8)
Ta 142,5,30720
Mvav 196,156,168
buffer_load_dwordx4 a[192:195], v33, s[40:43], s6 offen offset:2048 sc1
Ta 144,2,32768
Mvav 204,156,172
Ta 146,2,34816
Ta 148,3,32768
Mvav 208,160,168
Ta 150,3,34816
Ta 152,4,32768
Mvav 216,160,172
s_waitcnt lgkmcnt(10)
Ta 154,4,34816
Ta 156,5,32768
Mvav 212,164,168
LD 15,44,76,3072
Ta 158,5,34816
Mvav 220,164,172
s_add_u32 m0, s69, 0x9000
v_permlane16_swap_b32 v225, v227
Mvav 192,128,176
s_add_u32 s76, s71, 0x64000
v_permlane32_swap_b32 v232, v234
Mvav 200,128,180
s_waitcnt lgkmcnt(9)
v_permlane32_swap_b32 v233, v235
Mvav 196,132,176
buffer_load_dwordx4 a[196:199], v6, s[40:43], s6 offen offset:2304 sc1
v_add_u32 v2, 0x9000, v2
Mvav 204,132,180
s_add_u32 s6, s101, 0x5000
v_permlane16_swap_b32 v232, v234
Mvav 208,136,176
v_permlane16_swap_b32 v233, v235
Mvav 216,136,180
s_waitcnt vmcnt(40) lgkmcnt(0)
s_barrier
v_xor_b32 v254, s20, v2
v_add_u32 v3, 0x9000, v3
Mvav 212,140,176
buffer_load_dwordx4 a[200:203], v33, s[40:43], s7 offen sc1
Ta 160,254,0
Mvav 220,140,180
Ta 162,254,2048
v_xor_b32 v255, s20, v3
Mvav 192,144,184
Ta 164,255,0
v_accvgpr_write_b32 a33, v225
Mvav 200,144,188
Ta 166,255,2048
v_accvgpr_write_b32 a35, v227
Mvav 196,148,184
buffer_load_dwordx4 a[204:207], v6, s[40:43], s7 offen offset:256 sc1
Ta 128,254,4096
Mvav 204,148,188
Ta 130,254,6144
Ta 132,255,4096
Mvav 208,152,184
Ta 134,255,6144
v_accvgpr_write_b32 a36, v232
Mvav 216,152,188
Ta 136,254,8192
v_accvgpr_write_b32 a37, v233
Mvav 212,156,184
buffer_load_dwordx2 a[208:209], v33, s[40:43], s7 offen offset:2048 sc1
Ta 138,254,10240
Mvav 220,156,188
s_waitcnt vmcnt(42) lgkmcnt(8)
Ta 140,255,8192
v_accvgpr_write_b32 a38, v234
v_mfma_f32_16x16x32_bf16 v[224:227], a[160:163], a[64:67], 0
s_waitcnt vmcnt(41)
buffer_load_dwordx2 a[210:211], v6, s[40:43], s7 offen offset:2056 sc1
buffer_load_dwordx2 a[212:213], v6, s[40:43], s7 offen offset:2304 sc1
buffer_load_dwordx2 a[214:215], v34, s[40:43], s7 offen offset:2056 sc1
v_accvgpr_write_b32 a39, v235
v_mfma_f32_16x16x32_bf16 v[232:235], a[160:163], a[68:71], 0
s_waitcnt lgkmcnt(7)
s_add_u32 s7, s101, 0x6000
Ta 142,255,10240
v_add_u32 v2, 0x9000, v2
v_mfma_f32_16x16x32_bf16 v[228:231], a[164:167], a[64:67], 0
Ta 144,254,12288
v_add_u32 v3, 0x9000, v3
v_mfma_f32_16x16x32_bf16 v[236:239], a[164:167], a[68:71], 0
s_waitcnt vmcnt(43) lgkmcnt(6)
Ta 146,254,14336
v_mul_f32 v192, v38, v192
Mvaa 224,128,72
s_waitcnt vmcnt(42)
buffer_load_dwordx4 a[216:219], v6, s[40:43], s4 offen sc1
Ta 148,255,12288
Mvaa 232,128,76
s_waitcnt lgkmcnt(6)
Ta 150,255,14336
v_mul_f32 v193, v38, v193
Mvaa 228,132,72
Ta 152,254,16384
v_mul_f32 v200, v39, v200
Mvaa 236,132,76
s_waitcnt vmcnt(41) lgkmcnt(6)
Ta 154,254,18432
Ta 156,255,16384
Mvaa 224,136,80
s_waitcnt vmcnt(39)
LD 12,44,76,0
Ta 158,255,18432
Mvaa 232,136,84
s_waitcnt lgkmcnt(8)
Ta 160,254,20480
v_mul_f32 v201, v39, v201
Mvaa 228,140,80
Ta 162,254,22528
v_mul_f32 v208, v38, v208
Mvaa 236,140,84
s_waitcnt vmcnt(38) lgkmcnt(8)
Ta 164,255,20480
v_mul_f32 v209, v38, v209
Mvaa 224,144,88
s_waitcnt vmcnt(36)
LD 13,44,76,1024
Ta 166,255,22528
Mvaa 232,144,92
s_waitcnt lgkmcnt(8)
Ta 128,254,24576
v_mul_f32 v216, v39, v216
Mvaa 228,148,88
Ta 130,254,26624
v_mul_f32 v217, v39, v217
Mvaa 236,148,92
s_waitcnt vmcnt(34) lgkmcnt(8)
Ta 132,255,24576
Ta 134,255,26624
Mvaa 224,152,96
s_waitcnt vmcnt(31)
buffer_load_dwordx4 a[220:223], v34, s[40:43], s4 offen sc1
Ta 136,254,28672
Mvaa 232,152,100
s_waitcnt lgkmcnt(9)
Ta 138,254,30720
Ta 140,255,28672
Mvaa 228,156,96
Ta 142,255,30720
Ta 144,254,32768
Mvaa 236,156,100
s_waitcnt vmcnt(30) lgkmcnt(10)
Ta 146,254,34816
Ta 148,255,32768
Mvaa 224,160,104
s_waitcnt vmcnt(28)
LD 14,44,76,2048
Ta 150,255,34816
Mvaa 232,160,108
s_waitcnt lgkmcnt(11)
v_xor_b32 v254, s20, v2
v_xor_b32 v255, s20, v3
v_mul_f32 v194, v38, v194
Mvaa 228,164,104
v_permlane32_swap_b32 v240, v242
Mvaa 236,164,108
s_waitcnt vmcnt(27) lgkmcnt(8)
v_permlane32_swap_b32 v241, v243
Mvaa 224,128,112
s_waitcnt vmcnt(26)
buffer_load_dwordx4 a[224:227], v6, s[40:43], s4 offen offset:2048 sc1
v_mul_f32 v195, v38, v195
Mvaa 232,128,116
v_permlane32_swap_b32 v248, v250
Mvaa 228,132,112
v_permlane32_swap_b32 v249, v251
Mvaa 236,132,116
s_waitcnt lgkmcnt(0)
s_barrier
s_waitcnt vmcnt(26)
v_permlane16_swap_b32 v240, v242
Mvaa 224,136,120
s_waitcnt vmcnt(24)
LD 15,44,76,3072
Ta 152,254,0
Mvaa 232,136,124
s_add_u32 m0, s69, 0xd000
s_add_u32 s76, s73, 0x60000
Ta 154,254,2048
Mvaa 228,140,120
Ta 156,255,0
Ta 158,255,2048
Mvaa 236,140,124
s_waitcnt vmcnt(23)
Ta 160,254,4096
Ta 162,254,6144
Mvaa 224,144,168
s_waitcnt vmcnt(22)
LD 16,48,76,0
Ta 164,255,4096
Mvaa 232,144,172
Ta 166,255,6144
Ta 128,254,8192
Mvaa 228,148,168
Ta 130,254,10240
Ta 132,255,8192
Mvaa 236,148,172
s_waitcnt vmcnt(21) lgkmcnt(9)
Ta 134,255,10240
Ta 136,254,12288
Mvaa 224,152,176
s_waitcnt vmcnt(20)
buffer_load_dwordx4 a[228:231], v34, s[40:43], s4 offen offset:2048 sc1
Ta 138,254,14336
Mvaa 232,152,180
s_waitcnt lgkmcnt(10)
s_add_u32 s4, s101, 0x7000
Ta 140,255,12288
Ta 142,255,14336
Mvaa 228,156,176
Ta 144,254,16384
Ta 146,254,18432
Mvaa 236,156,180
s_waitcnt vmcnt(20) lgkmcnt(12)
Ta 148,255,16384
Ta 150,255,18432
Mvaa 224,160,184
s_waitcnt vmcnt(18)
LD 17,48,76,1024
Ta 152,254,20480
Mvaa 232,160,188
s_waitcnt lgkmcnt(12)
s_and_b32 s85, s30, 31
Ta 154,254,22528
Ta 156,255,20480
Mvaa 228,164,184
s_lshl_b32 s85, s85, 8
Ta 158,255,22528
Ta 160,254,24576
Mvaa 236,164,188
s_waitcnt vmcnt(18) lgkmcnt(12)
s_getpc_b64 s[96:97]
L_ca4_2:
s_add_u32 s96, s96, L_Amain+16384-L_ca4_2
s_addc_u32 s97, s97, 0
Ta 162,254,26624
Ta 164,255,24576
Mvaa 224,128,192
s_waitcnt vmcnt(16)
buffer_load_dwordx4 a[232:235], v6, s[40:43], s5 offen sc1
Ta 166,255,26624
Mvaa 232,128,196
Ta 128,254,28672
Ta 130,254,30720
Mvaa 228,132,192
v_and_b32 v46, 32, v1
v_mul_f32 v202, v39, v202
Mvaa 236,132,196
s_waitcnt vmcnt(16) lgkmcnt(10)
Ta 132,255,28672
Ta 134,255,30720
Mvaa 224,136,200
s_waitcnt vmcnt(15)
buffer_load_dwordx4 a[236:239], v34, s[40:43], s5 offen sc1
v_lshl_add_u32 v46, v46, 2, s85
Mvaa 232,136,204
Ta 136,254,32768
Ta 138,254,34816
Mvaa 228,140,200
v_permlane16_swap_b32 v241, v243
Mvaa 236,140,204
s_waitcnt vmcnt(14)
Ta 140,255,32768
Ta 142,255,34816
Mvaa 224,144,208
s_waitcnt vmcnt(12)
LD 18,48,76,2048
v_mul_f32 v203, v39, v203
Mvaa 232,144,212
v_permlane16_swap_b32 v248, v250
Mvaa 228,148,208
v_permlane16_swap_b32 v249, v251
Mvaa 236,148,212
s_waitcnt vmcnt(12) lgkmcnt(6)
v_mul_f32 v210, v38, v210
L_pg7_5:
s_cbranch_execz L_ret7
v_mul_f32 v211, v38, v211
Mvaa 224,152,216
s_waitcnt vmcnt(9)
buffer_load_dwordx4 a[240:243], v6, s[40:43], s5 offen offset:2048 sc1
v_mul_f32 v218, v39, v218
Mvaa 232,152,220
v_mul_f32 v219, v39, v219
v_mul_f32 v196, v38, v196
Mvaa 228,156,216
s_waitcnt lgkmcnt(0)
s_barrier
v_mul_f32 v197, v38, v197
v_mul_f32 v198, v38, v198
Mvaa 236,156,220
s_waitcnt vmcnt(8)
ds_read_b128 a[144:147], v20 offset:4096
v_mul_f32 v199, v38, v199
Mvaa 224,160,224
buffer_load_dwordx4 a[244:247], v34, s[40:43], s5 offen offset:2048 sc1
ds_read_b128 a[148:151], v21 offset:4096
CV 192,192,193
v_mul_f32 v204, v39, v204
v_mul_f32 v205, v39, v205
v_mul_f32 v206, v39, v206
v_mul_f32 v207, v39, v207
CV 200,200,201
v_mul_f32 v212, v38, v212
v_mul_f32 v213, v38, v213
v_mul_f32 v214, v38, v214
v_mul_f32 v215, v38, v215
CV 208,208,209
s_waitcnt vmcnt(6)
v_mul_f32 v220, v39, v220
v_mul_f32 v221, v39, v221
v_mul_f32 v222, v39, v222
v_mul_f32 v223, v39, v223
CV 216,216,217
CV 193,194,195
CV 201,202,203
CV 209,210,211
CV 217,218,219
CV 194,196,197
CV 195,198,199
CV 202,204,205
CV 203,206,207
CV 210,212,213
CV 211,214,215
CV 218,220,221
CV 219,222,223
v_permlane32_swap_b32 v192, v194
v_permlane32_swap_b32 v193, v195
v_permlane32_swap_b32 v200, v202
v_permlane32_swap_b32 v201, v203
v_permlane32_swap_b32 v208, v210
v_permlane32_swap_b32 v209, v211
v_accvgpr_write_b32 a40, v240
Mvaa 232,160,228
LD 19,48,76,3072
ds_read_b128 a[152:155], v22 offset:4096
s_add_u32 m0, s69, 0x12000
Mvaa 228,164,224
s_add_u32 s76, s71, 0x68000
ds_read_b128 a[156:159], v23 offset:4096
v_accvgpr_write_b32 a41, v241
Mvaa 236,164,228
s_waitcnt vmcnt(5)
s_add_u32 s5, s101, 0x4000
ds_read_b128 a[160:163], v20 offset:8192
v_accvgpr_write_b32 a42, v242
v_permlane32_swap_b32 v216, v218
v_permlane32_swap_b32 v217, v219
v_permlane16_swap_b32 v192, v194
v_permlane16_swap_b32 v193, v195
v_permlane16_swap_b32 v200, v202
v_permlane16_swap_b32 v201, v203
v_permlane16_swap_b32 v208, v210
v_permlane16_swap_b32 v209, v211
v_permlane16_swap_b32 v216, v218
v_permlane16_swap_b32 v217, v219
v_accvgpr_write_b32 a43, v243
v_accvgpr_write_b32 a44, v248
v_accvgpr_write_b32 a45, v249
v_accvgpr_write_b32 a46, v250
v_accvgpr_write_b32 a47, v251
Mvaa 224,128,232
s_waitcnt vmcnt(4)
LD 12,44,76,0
ds_read_b128 a[164:167], v21 offset:8192
v_accvgpr_write_b32 a48, v192
v_accvgpr_write_b32 a49, v193
v_accvgpr_write_b32 a50, v194
v_accvgpr_write_b32 a51, v195
v_accvgpr_write_b32 a52, v200
v_accvgpr_write_b32 a53, v201
v_accvgpr_write_b32 a54, v202
v_accvgpr_write_b32 a55, v203
v_accvgpr_write_b32 a56, v208
v_accvgpr_write_b32 a57, v209
v_accvgpr_write_b32 a58, v210
v_accvgpr_write_b32 a59, v211
v_accvgpr_write_b32 a60, v216
Mvaa 232,128,236
LD 13,44,76,1024
ds_read_b128 a[128:131], v20
Mvaa 228,132,232
ds_read_b128 a[168:171], v22 offset:8192
v_accvgpr_write_b32 a61, v217
Mvaa 236,132,236
ds_read_b128 a[132:135], v21
v_accvgpr_write_b32 a62, v218
v_accvgpr_write_b32 a63, v219
v_lshrrev_b32 v172, 3, v1
s_nop 0
s_cmp_lg_u32 s89, 0
s_cbranch_scc1 L_max0_2
L_maxr0_2:
s_waitcnt vmcnt(4)
v_and_b32 v173, 6, v172
v_mul_u32_u24 v172, 0x2400, v172
v_xor_b32 v8, v8, v173
v_add_u32 v2, 0xfffe5000, v2
v_lshl_add_u32 v8, v8, 4, v172
v_add_u32 v2, 0x9000, v2
v_add_u32 v9, 0x11c00, v8
v_add_u32 v10, 0x23800, v8
v_add_u32 v11, 0x35400, v8
v_add_u32 v3, 0xfffe5000, v3
v_add_u32 v4, 0x9000, v4
v_add_u32 v3, 0x9000, v3
v_add_u32 v4, 0x9000, v4
v_add_u32 v5, 0x9000, v5
v_add_u32 v4, 0xfffe5000, v4
v_add_u32 v5, 0x9000, v5
v_add_u32 v4, 0x9000, v4
v_add_u32 v5, 0xfffe5000, v5
Mvaa 224,136,240
s_waitcnt vmcnt(3)
LD 14,44,76,2048
ds_read_b128 a[172:175], v23 offset:8192
v_add_u32 v5, 0x9000, v5
v_lshrrev_b32 v172, 3, v1
v_mov_b32 v174, 0
v_and_b32 v173, 6, v172
v_mul_u32_u24 v172, 0x480, v172
v_and_b32 v175, 48, v1
v_fma_f32 v227, v130, v44, v227
v_cndmask_b32 v130, v180, v188, s[22:23]
v_fma_f32 v225, v128, v44, v225
v_fma_f32 v226, v131, v44, v226
v_cndmask_b32 v128, v179, v187, s[22:23]
Mvaa 232,136,244
LD 15,44,76,3072
ds_read_b128 a[136:139], v22
Mvaa 228,140,240
s_add_u32 m0, s69, 0x16000
s_add_u32 s76, s73, 0x64000
v_lshlrev_b32 v131, 16, v130
Mvaa 236,140,244
s_waitcnt lgkmcnt(2)
ds_read_b128 a[140:143], v23
v_fma_f32 v224, v129, v44, v224
v_mfma_f32_16x16x32_bf16 v[48:51], a[128:131], a[0:3], 0
v_lshlrev_b32 v129, 16, v128
v_fma_f32 v229, v132, v44, v229
v_mfma_f32_16x16x32_bf16 v[56:59], a[128:131], a[4:7], 0
LD 16,48,76,0
v_fma_f32 v232, v131, v45, v232
v_mfma_f32_16x16x32_bf16 v[64:67], a[128:131], a[32:35], 0
v_and_b32 v130, s90, v130
v_cndmask_b32 v132, v181, v189, s[22:23]
v_mfma_f32_16x16x32_bf16 v[72:75], a[128:131], a[36:39], 0
ds_read_b128 a[128:131], v20 offset:12288
v_fma_f32 v228, v133, v44, v228
Mvaa 48,132,8
v_and_b32 v128, s90, v128
v_mov_b32 v136, v224
Mvaa 56,132,12
LD 17,48,76,1024
v_fma_f32 v233, v130, v45, v233
Mvaa 64,132,40
v_mov_b32 v138, v232
v_lshlrev_b32 v133, 16, v132
Mvaa 72,132,44
s_waitcnt lgkmcnt(2)
ds_read_b128 a[132:135], v21 offset:12288
v_mul_f32 v137, v224, v224
Mvaa 48,136,16
v_fma_f32 v231, v128, v44, v231
v_mul_f32 v139, v232, v232
Mvaa 56,136,20
LD 18,48,76,2048
v_add_f32 v136, v136, v225
Mvaa 64,136,48
v_add_f32 v138, v138, v233
v_fma_f32 v234, v133, v45, v234
Mvaa 72,136,52
s_waitcnt lgkmcnt(2)
ds_read_b128 a[136:139], v22 offset:12288
v_and_b32 v132, s90, v132
Mvaa 48,140,24
v_cndmask_b32 v128, v182, v190, s[22:23]
v_fmac_f32 v137, v225, v225
Mvaa 56,140,28
LD 19,48,76,3072
v_fma_f32 v230, v129, v44, v230
Mvaa 64,140,56
s_add_u32 m0, s69, 0x1b000
s_add_u32 s76, s71, 0x6c000
v_fmac_f32 v139, v233, v233
Mvaa 72,140,60
ds_read_b128 a[140:143], v23 offset:12288
v_add_f32 v136, v136, v226
v_mfma_f32_16x16x32_bf16 v[52:55], a[144:147], a[0:3], 0
v_fma_f32 v235, v132, v45, v235
v_add_f32 v138, v138, v234
v_mfma_f32_16x16x32_bf16 v[60:63], a[144:147], a[4:7], 0
global_load_dword v35, v46, s[96:97]
v_lshlrev_b32 v129, 16, v128
v_mfma_f32_16x16x32_bf16 v[68:71], a[144:147], a[32:35], 0
v_fmac_f32 v137, v226, v226
v_fmac_f32 v139, v234, v234
v_mfma_f32_16x16x32_bf16 v[76:79], a[144:147], a[36:39], 0
LD 12,44,76,0
v_add_f32 v136, v136, v227
Mvaa 52,148,8
v_add_f32 v138, v138, v235
v_fma_f32 v236, v129, v45, v236
Mvaa 60,148,12
v_and_b32 v128, s90, v128
v_cndmask_b32 v130, v183, v191, s[22:23]
Mvaa 68,148,40
s_waitcnt vmcnt(10) lgkmcnt(0)
s_barrier
v_fmac_f32 v137, v227, v227
v_fmac_f32 v139, v235, v235
Mvaa 76,148,44
LD 13,44,76,1024
v_add_f32 v136, v136, v228
Mvaa 52,152,16
s_add_u32 s23, s66, 1
v_fma_f32 v237, v128, v45, v237
v_add_f32 v138, v138, v236
Mvaa 60,152,20
s_and_b32 s23, s23, 7
v_lshlrev_b32 v131, 16, v130
v_fmac_f32 v137, v228, v228
Mvaa 68,152,48
s_lshl_b32 s23, s23, 7
v_fmac_f32 v139, v236, v236
v_add_f32 v136, v136, v229
Mvaa 76,152,52
LD 14,44,76,2048
v_add_f32 v138, v138, v237
Mvaa 52,156,24
s_add_u32 s23, s23, s74
v_fma_f32 v238, v131, v45, v238
v_and_b32 v130, s90, v130
Mvaa 60,156,28
v_fmac_f32 v137, v229, v229
v_fmac_f32 v139, v237, v237
Mvaa 68,156,56
v_add_f32 v136, v136, v230
v_fma_f32 v239, v130, v45, v239
Mvaa 76,156,60
v_add_f32 v138, v138, v238
v_fmac_f32 v137, v230, v230
v_fmac_f32 v139, v238, v238
v_add_f32 v136, v136, v231
v_add_f32 v138, v138, v239
v_fmac_f32 v137, v231, v231
v_fmac_f32 v139, v239, v239
v_permlane32_swap_b32 v136, v138
s_nop 0
v_permlane32_swap_b32 v137, v139
CV 224,224,225
CV 232,232,233
v_add_f32 v136, v136, v138
CV 225,226,227
CV 233,234,235
v_add_f32 v137, v137, v139
CV 226,228,229
CV 227,230,231
CV 234,236,237
CV 235,238,239
v_lshlrev_b32 v138, 3, v1
buffer_store_dwordx4 v[224:227], v6, s[40:43], s78 offen sc1
buffer_store_dwordx4 v[232:235], v6, s[40:43], s78 offen offset:256 sc1
buffer_store_dwordx2 v[136:137], v138, s[40:43], s79 offen sc1
LD 15,44,76,3072
s_add_u32 m0, s69, 0x1f000
s_add_u32 s76, s73, 0x68000
v_max3_f32 v168, v48, v49, v24
LD 16,48,76,0
v_max3_f32 v169, v56, v57, v25
LD 17,48,76,1024
v_max3_f32 v168, v168, v50, v51
v_max3_f32 v169, v169, v58, v59
v_max3_f32 v168, v168, v52, v53
v_max3_f32 v169, v169, v60, v61
v_max3_f32 v168, v168, v54, v55
v_max3_f32 v169, v169, v62, v63
v_max3_f32 v170, v64, v65, v26
v_max3_f32 v171, v72, v73, v27
v_permlane32_swap_b32 v168, v169
v_max3_f32 v170, v170, v66, v67
v_max3_f32 v171, v171, v74, v75
v_max_f32 v168, v168, v169
v_max3_f32 v170, v170, v68, v69
v_max3_f32 v171, v171, v76, v77
v_mov_b32 v169, v168
v_max3_f32 v170, v170, v70, v71
v_max3_f32 v171, v171, v78, v79
v_permlane16_swap_b32 v168, v169
s_nop 0
v_permlane32_swap_b32 v170, v171
v_max_f32 v168, v168, v169
v_add_u32 v20, 0x9000, v20
v_max_f32 v170, v170, v171
v_mov_b32 v169, v168
v_mov_b32 v171, v170
s_nop 0
v_permlane32_swap_b32 v168, v169
v_permlane16_swap_b32 v170, v171
v_sub_f32 v144, 0, v168
v_sub_f32 v145, 0, v168
v_sub_f32 v146, 0, v168
v_sub_f32 v147, 0, v168
ds_read_b128 a[144:147], v20
v_max_f32 v170, v170, v171
v_mfma_f32_16x16x32_bf16 v[80:83], a[160:163], a[0:3], v[144:147]
v_mov_b32 v171, v170
v_sub_f32 v148, 0, v169
v_sub_f32 v149, 0, v169
v_sub_f32 v150, 0, v169
v_sub_f32 v151, 0, v169
v_permlane32_swap_b32 v170, v171
s_nop 0
v_mfma_f32_16x16x32_bf16 v[88:91], a[160:163], a[4:7], v[148:151]
v_sub_f32 v152, 0, v170
v_sub_f32 v153, 0, v170
v_sub_f32 v154, 0, v170
v_sub_f32 v155, 0, v170
v_sub_f32 v156, 0, v171
v_sub_f32 v157, 0, v171
v_mfma_f32_16x16x32_bf16 v[96:99], a[160:163], a[32:35], v[152:155]
v_sub_f32 v158, 0, v171
v_sub_f32 v159, 0, v171
v_add_u32 v21, 0x9000, v21
v_sub_f32 v48, v48, v168
v_mfma_f32_16x16x32_bf16 v[104:107], a[160:163], a[36:39], v[156:159]
s_mul_i32 s78, s16, 0x11000
ds_read_b128 a[148:151], v21
v_sub_f32 v49, v49, v168
Mvaa 80,164,8
s_add_u32 s78, s78, s13
ds_read_b128 a[160:163], v20 offset:4096
v_sub_f32 v50, v50, v168
Mvaa 88,164,12
s_add_u32 s78, s78, 0x8000
v_exp_f32 v48, v48
Mvaa 96,164,40
s_mul_i32 s79, s17, 0x11000
v_exp_f32 v49, v49
Mvaa 104,164,44
LD 18,48,76,2048
ds_read_b128 a[164:167], v21 offset:4096
Mvaa 80,168,16
s_add_u32 s79, s79, s13
v_exp_f32 v50, v50
Mvaa 88,168,20
s_add_u32 s79, s79, 0x9000
v_sub_f32 v51, v51, v168
v_sub_f32 v56, v56, v169
Mvaa 96,168,48
s_add_u32 s21, s94, 54
v_exp_f32 v51, v51
Mvaa 104,168,52
LD 19,48,76,3072
v_sub_f32 v57, v57, v169
Mvaa 80,172,24
s_min_u32 s21, s21, 0xa1
v_exp_f32 v56, v56
Mvaa 88,172,28
s_mul_i32 s22, s21, 0xe39
v_exp_f32 v57, v57
Mvaa 96,172,56
s_lshr_b32 s22, s22, 16
v_sub_f32 v58, v58, v169
v_sub_f32 v59, v59, v169
Mvaa 104,172,60
s_mul_i32 s22, s22, 0xffaf0080
s_mul_i32 s15, s21, 0x48000
s_add_u32 s22, s22, s15
v_mfma_f32_16x16x32_bf16 v[84:87], a[128:131], a[0:3], v[144:147]
s_mul_i32 s15, s66, 0x480
s_add_u32 m0, s69, 0x24000
s_add_u32 s22, s22, s15
v_mfma_f32_16x16x32_bf16 v[92:95], a[128:131], a[4:7], v[148:151]
s_mov_b32 s76, s22
v_exp_f32 v58, v58
v_mfma_f32_16x16x32_bf16 v[100:103], a[128:131], a[32:35], v[152:155]
s_lshl_b32 s14, s21, 12
v_exp_f32 v59, v59
v_mfma_f32_16x16x32_bf16 v[108:111], a[128:131], a[36:39], v[156:159]
s_mul_i32 s15, s66, 0xa2000
Ta 128,2,16384
CV 112,48,49
Mvaa 84,132,8
s_add_u32 s14, s14, s15
Ta 130,2,18432
CV 113,50,51
Mvaa 92,132,12
s_add_u32 s14, s14, 0x4400000
v_sub_f32 v64, v64, v170
v_sub_f32 v65, v65, v170
Mvaa 100,132,40
s_add_u32 s16, s66, 2
v_exp_f32 v64, v64
Mvaa 108,132,44
s_and_b32 s16, s16, 7
Ta 132,3,16384
v_sub_f32 v66, v66, v170
Mvaa 84,136,16
s_mul_i32 s80, s16, 0x11000
Ta 134,3,18432
v_sub_f32 v67, v67, v170
Mvaa 92,136,20
s_add_u32 s80, s80, s13
v_exp_f32 v65, v65
Mvaa 100,136,48
s_add_u32 s80, s80, 0xa000
v_exp_f32 v66, v66
Mvaa 108,136,52
Ta 136,4,16384
v_add_u32 v22, 0x9000, v22
Mvaa 84,140,24
s_waitcnt vmcnt(5)
buffer_store_dword v47, off, s[40:43], s9 sc1
ds_read_b128 a[152:155], v22
Mvaa 92,140,28
s_add_u32 s9, s69, 0x1b000
ds_read_b128 a[168:171], v22 offset:4096
CV 116,56,57
Mvaa 100,140,56
Ta 138,4,18432
CV 117,58,59
Mvaa 108,140,60
s_waitcnt lgkmcnt(6)
Ta 140,5,16384
v_sub_f32 v72, v72, v171
v_mfma_f32_16x16x32_bf16 v[48:51], a[144:147], a[0:3], v[144:147]
Ta 142,5,18432
v_exp_f32 v67, v67
v_mfma_f32_16x16x32_bf16 v[56:59], a[144:147], a[4:7], v[148:151]
v_sub_f32 v73, v73, v171
v_sub_f32 v74, v74, v171
v_sub_f32 v75, v75, v171
CV 120,64,65
CV 121,66,67
v_mfma_f32_16x16x32_bf16 v[64:67], a[144:147], a[32:35], v[152:155]
LD 8,24,76,0
LD 9,24,76,1024
LD 10,24,76,2048
LD 11,24,76,3072
s_add_u32 m0, s69, 0
s_add_u32 s76, s71, 0x70000
v_exp_f32 v72, v72
LD 12,44,76,0
v_exp_f32 v73, v73
v_exp_f32 v74, v74
v_exp_f32 v75, v75
CV 124,72,73
v_add_u32 v23, 0x9000, v23
CV 125,74,75
v_mfma_f32_16x16x32_bf16 v[72:75], a[144:147], a[36:39], v[156:159]
ds_read_b128 a[156:159], v23
v_sub_f32 v52, v52, v168
Mvaa 48,148,8
ds_read_b128 a[172:175], v23 offset:4096
v_sub_f32 v53, v53, v168
Mvaa 56,148,12
Ta 144,2,20480
v_sub_f32 v54, v54, v168
Mvaa 64,148,40
Ta 146,2,22528
v_sub_f32 v55, v55, v168
Mvaa 72,148,44
s_waitcnt lgkmcnt(4)
Ta 148,3,20480
v_sub_f32 v60, v60, v169
Mvaa 48,152,16
Ta 150,3,22528
v_sub_f32 v61, v61, v169
Mvaa 56,152,20
v_exp_f32 v52, v52
Mvaa 64,152,48
v_exp_f32 v53, v53
Mvaa 72,152,52
s_waitcnt lgkmcnt(5)
Ta 152,4,20480
v_sub_f32 v62, v62, v169
Mvaa 48,156,24
Ta 154,4,22528
v_sub_f32 v63, v63, v169
Mvaa 56,156,28
v_exp_f32 v54, v54
Mvaa 64,156,56
v_exp_f32 v55, v55
Mvaa 72,156,60
LD 13,44,76,1024
CV 114,52,53
CV 115,54,55
v_mfma_f32_16x16x32_bf16 v[52:55], a[160:163], a[0:3], v[144:147]
v_exp_f32 v60, v60
v_exp_f32 v61, v61
v_exp_f32 v62, v62
v_exp_f32 v63, v63
v_sub_f32 v68, v68, v170
v_sub_f32 v69, v69, v170
v_sub_f32 v70, v70, v170
v_sub_f32 v71, v71, v170
CV 118,60,61
CV 119,62,63
v_mfma_f32_16x16x32_bf16 v[60:63], a[160:163], a[4:7], v[148:151]
v_exp_f32 v68, v68
v_exp_f32 v69, v69
v_exp_f32 v70, v70
v_exp_f32 v71, v71
v_sub_f32 v76, v76, v171
v_sub_f32 v77, v77, v171
v_sub_f32 v78, v78, v171
v_sub_f32 v79, v79, v171
CV 122,68,69
CV 123,70,71
v_mfma_f32_16x16x32_bf16 v[68:71], a[160:163], a[32:35], v[152:155]
v_exp_f32 v76, v76
v_exp_f32 v77, v77
v_exp_f32 v78, v78
v_exp_f32 v79, v79
CV 126,76,77
Ta 156,5,20480
CV 127,78,79
v_mfma_f32_16x16x32_bf16 v[76:79], a[160:163], a[36:39], v[156:159]
Ta 158,5,22528
v_add_u32 v36, s9, v2
Mvaa 52,164,8
ds_read_b128 a[160:163], v20 offset:8192
v_add_u32 v37, s9, v3
Mvaa 60,164,12
v_exp_f32 v80, v80
Mvaa 68,164,40
v_exp_f32 v81, v81
Mvaa 76,164,44
ds_read_b128 a[164:167], v21 offset:8192
CV 128,80,81
Mvaa 52,168,16
v_exp_f32 v82, v82
Mvaa 60,168,20
v_exp_f32 v83, v83
Mvaa 68,168,48
v_exp_f32 v88, v88
Mvaa 76,168,52
s_waitcnt lgkmcnt(3)
ds_read_b128 a[168:171], v22 offset:8192
CV 129,82,83
Mvaa 52,172,24
LD 14,44,76,2048
v_add_u32 v38, s9, v4
Mvaa 60,172,28
s_lshl_b32 s85, s30, 7
v_exp_f32 v89, v89
Mvaa 68,172,56
s_add_u32 s85, s85, 0x4000
v_exp_f32 v90, v90
Mvaa 76,172,60
s_getpc_b64 s[96:97]
ds_read_b128 a[172:175], v23 offset:8192
v_mov_b32 v46, s85
v_mfma_f32_16x16x32_bf16 a[240:243], v[40:43], v[112:115], 0
global_load_dword v35, v46, s[96:97]
CV 132,88,89
v_mfma_f32_16x16x32_bf16 a[244:247], v[40:43], v[116:119], 0
v_exp_f32 v91, v91
v_mfma_f32_16x16x32_bf16 a[248:251], v[40:43], v[120:123], 0
v_exp_f32 v96, v96
v_mfma_f32_16x16x32_bf16 a[252:255], v[40:43], v[124:127], 0
v_exp_f32 v97, v97
v_mfma_f32_16x16x32_bf16 v[176:179], a[128:131], v[112:115], 0
v_exp_f32 v98, v98
v_mfma_f32_16x16x32_bf16 v[184:187], a[128:131], v[116:119], 0
v_exp_f32 v99, v99
v_mfma_f32_16x16x32_bf16 a[176:179], a[128:131], v[120:123], 0
v_exp_f32 v104, v104
v_mfma_f32_16x16x32_bf16 a[184:187], a[128:131], v[124:127], 0
ds_read_b128 a[128:131], v20 offset:12288
CV 133,90,91
v_mfma_f32_16x16x32_bf16 v[180:183], a[132:135], v[112:115], 0
v_exp_f32 v105, v105
v_mfma_f32_16x16x32_bf16 v[188:191], a[132:135], v[116:119], 0
v_exp_f32 v106, v106
v_mfma_f32_16x16x32_bf16 a[180:183], a[132:135], v[120:123], 0
LD 15,44,76,3072
CV 136,96,97
v_mfma_f32_16x16x32_bf16 a[188:191], a[132:135], v[124:127], 0
s_add_u32 m0, s69, 0x4000
s_add_u32 s76, s73, 0x6c000
ds_read_b128 a[132:135], v21 offset:12288
v_mfma_f32_16x16x32_bf16 v[192:195], a[136:139], v[112:115], 0
v_exp_f32 v107, v107
v_mfma_f32_16x16x32_bf16 v[200:203], a[136:139], v[116:119], 0
v_exp_f32 v84, v84
v_mfma_f32_16x16x32_bf16 a[192:195], a[136:139], v[120:123], 0
v_exp_f32 v85, v85
v_mfma_f32_16x16x32_bf16 a[200:203], a[136:139], v[124:127], 0
ds_read_b128 a[136:139], v22 offset:12288
CV 137,98,99
v_mfma_f32_16x16x32_bf16 v[196:199], a[140:143], v[112:115], 0
v_exp_f32 v86, v86
v_mfma_f32_16x16x32_bf16 v[204:207], a[140:143], v[116:119], 0
v_exp_f32 v87, v87
v_mfma_f32_16x16x32_bf16 a[196:199], a[140:143], v[120:123], 0
v_exp_f32 v92, v92
v_mfma_f32_16x16x32_bf16 a[204:207], a[140:143], v[124:127], 0
ds_read_b128 a[140:143], v23 offset:12288
CV 140,104,105
v_mfma_f32_16x16x32_bf16 v[208:211], a[144:147], v[112:115], 0
v_exp_f32 v93, v93
v_mfma_f32_16x16x32_bf16 v[216:219], a[144:147], v[116:119], 0
v_exp_f32 v94, v94
v_mfma_f32_16x16x32_bf16 a[208:211], a[144:147], v[120:123], 0
v_exp_f32 v95, v95
v_mfma_f32_16x16x32_bf16 a[216:219], a[144:147], v[124:127], 0
Ta 144,2,24576
CV 141,106,107
v_mfma_f32_16x16x32_bf16 v[212:215], a[148:151], v[112:115], 0
LD 16,48,76,0
Ta 146,2,26624
v_mfma_f32_16x16x32_bf16 v[220:223], a[148:151], v[116:119], 0
v_exp_f32 v100, v100
v_mfma_f32_16x16x32_bf16 a[212:215], a[148:151], v[120:123], 0
v_exp_f32 v101, v101
v_mfma_f32_16x16x32_bf16 a[220:223], a[148:151], v[124:127], 0
L_pg7_6:
s_cbranch_execz L_ret7
Ta 148,3,24576
CV 130,84,85
v_mfma_f32_16x16x32_bf16 v[224:227], a[152:155], v[112:115], 0
Ta 150,3,26624
CV 131,86,87
v_mfma_f32_16x16x32_bf16 v[232:235], a[152:155], v[116:119], 0
v_exp_f32 v102, v102
v_mfma_f32_16x16x32_bf16 a[224:227], a[152:155], v[120:123], 0
v_exp_f32 v103, v103
v_mfma_f32_16x16x32_bf16 a[232:235], a[152:155], v[124:127], 0
s_waitcnt lgkmcnt(4)
Ta 152,4,24576
CV 134,92,93
v_mfma_f32_16x16x32_bf16 v[228:231], a[156:159], v[112:115], 0
Ta 154,4,26624
CV 135,94,95
v_mfma_f32_16x16x32_bf16 v[236:239], a[156:159], v[116:119], 0
v_exp_f32 v108, v108
v_mfma_f32_16x16x32_bf16 a[228:231], a[156:159], v[120:123], 0
v_exp_f32 v109, v109
v_mfma_f32_16x16x32_bf16 a[236:239], a[156:159], v[124:127], 0
Ta 156,5,24576
CV 138,100,101
v_mfma_f32_16x16x32_bf16 v[80:83], a[160:163], a[0:3], v[144:147]
Ta 158,5,26624
CV 139,102,103
v_mfma_f32_16x16x32_bf16 v[88:91], a[160:163], a[4:7], v[148:151]
v_exp_f32 v110, v110
v_mfma_f32_16x16x32_bf16 v[96:99], a[160:163], a[32:35], v[152:155]
LD 17,48,76,1024
CV 142,108,109
v_mfma_f32_16x16x32_bf16 v[104:107], a[160:163], a[36:39], v[156:159]
Ta 160,2,28672
v_add_u32 v39, s9, v5
Mvaa 80,164,8
s_lshl_b32 s9, s94, 3
Ta 162,2,30720
v_add_u32 v20, 0x9000, v20
Mvaa 88,164,12
s_add_u32 s9, s9, s17
v_exp_f32 v111, v111
Mvaa 96,164,40
s_lshl_b32 s9, s9, 7
CV 143,110,111
v_add_u32 v21, 0x9000, v21
Mvaa 104,164,44
s_add_u32 s9, s9, 0x3010024
Ta 164,3,28672
v_add_u32 v22, 0x9000, v22
Mvaa 80,168,16
s_add_u32 s17, s66, 3
Ta 166,3,30720
v_add_u32 v23, 0x9000, v23
Mvaa 88,168,20
s_and_b32 s17, s17, 7
v_exp_f32 v48, v48
Mvaa 96,168,48
s_mul_i32 s81, s17, 0x11000
v_exp_f32 v49, v49
Mvaa 104,168,52
s_add_u32 s81, s81, s13
Ta 168,4,28672
CV 112,48,49
Mvaa 80,172,24
s_add_u32 s81, s81, 0xb000
Ta 170,4,30720
v_add_u32 v2, 0x9000, v2
Mvaa 88,172,28
v_exp_f32 v50, v50
Mvaa 96,172,56
v_exp_f32 v51, v51
Mvaa 104,172,60
Ta 172,5,28672
CV 113,50,51
v_mfma_f32_16x16x32_bf16 v[84:87], a[128:131], a[0:3], v[144:147]
LD 18,48,76,2048
Ta 174,5,30720
v_mfma_f32_16x16x32_bf16 v[92:95], a[128:131], a[4:7], v[148:151]
v_exp_f32 v56, v56
v_mfma_f32_16x16x32_bf16 v[100:103], a[128:131], a[32:35], v[152:155]
v_exp_f32 v57, v57
v_mfma_f32_16x16x32_bf16 v[108:111], a[128:131], a[36:39], v[156:159]
v_exp_f32 v58, v58
Mvaa 84,132,8
v_exp_f32 v59, v59
Mvaa 92,132,12
v_exp_f32 v64, v64
Mvaa 100,132,40
s_waitcnt vmcnt(8)
Tv 240,36,0
CV 116,56,57
Mvaa 108,132,44
s_waitcnt lgkmcnt(1)
s_barrier
Tv 242,36,2048
CV 117,58,59
Mvaa 84,136,16
Tv 244,37,0
v_add_u32 v3, 0x9000, v3
Mvaa 92,136,20
Tv 246,37,2048
v_add_u32 v4, 0x9000, v4
Mvaa 100,136,48
Tv 248,38,0
Tv 250,38,2048
Mvaa 108,136,52
Tv 252,39,0
Tv 254,39,2048
Mvaa 84,140,24
ds_read_b128 a[128:131], v20
v_add_u32 v5, 0x9000, v5
Mvaa 92,140,28
ds_read_b128 a[132:135], v21
Mvaa 100,140,56
LD 19,48,76,3072
ds_read_b128 a[136:139], v22
Mvaa 108,140,60
ds_read_b128 a[140:143], v23
Mavv 240,40,128
v_exp_f32 v65, v65
Mavv 244,40,132
v_exp_f32 v66, v66
Mavv 248,40,136
s_waitcnt lgkmcnt(8)
buffer_store_dwordx4 v[240:243], v7, s[40:43], s14 offen sc1
CV 120,64,65
Mavv 252,40,140
v_exp_f32 v67, v67
Mvav 176,144,128
v_exp_f32 v72, v72
Mvav 184,144,132
v_exp_f32 v73, v73
Maav 176,144,136
v_exp_f32 v74, v74
Maav 184,144,140
buffer_store_dwordx4 v[244:247], v7, s[40:43], s14 offen offset:1024 sc1
ds_read_b128 a[144:147], v20 offset:4096
Mvav 180,148,128
v_exp_f32 v75, v75
Mvav 188,148,132
v_exp_f32 v52, v52
Maav 180,148,136
v_exp_f32 v53, v53
Maav 188,148,140
ds_read_b128 a[148:151], v21 offset:4096
CV 121,66,67
Mvav 192,152,128
s_waitcnt lgkmcnt(2)
buffer_store_dwordx4 v[248:251], v7, s[40:43], s14 offen offset:2048 sc1
CV 124,72,73
Mvav 200,152,132
v_exp_f32 v54, v54
Maav 192,152,136
s_add_u32 s21, s94, 0x76
v_exp_f32 v55, v55
Maav 200,152,140
s_min_u32 s21, s21, 0xa1
ds_read_b128 a[152:155], v22 offset:4096
CV 125,74,75
Mvav 196,156,128
s_mul_i32 s22, s21, 0xe39
v_exp_f32 v60, v60
Mvav 204,156,132
buffer_store_dwordx4 v[252:255], v7, s[40:43], s14 offen offset:3072 sc1
CV 114,52,53
Maav 196,156,136
s_lshr_b32 s22, s22, 16
v_exp_f32 v61, v61
Maav 204,156,140
s_mul_i32 s22, s22, 0xffaf0080
s_mul_i32 s15, s21, 0x48000
s_add_u32 s22, s22, s15
Mvav 208,160,128
s_mul_i32 s15, s66, 0x480
s_add_u32 m0, s69, 0x24000
s_add_u32 s22, s22, s15
Mvav 216,160,132
s_mov_b32 s76, s22
ds_read_b128 a[156:159], v23 offset:4096
CV 115,54,55
Maav 208,160,136
s_lshl_b32 s14, s21, 12
v_exp_f32 v62, v62
Maav 216,160,140
s_mul_i32 s15, s66, 0xa2000
Ta 160,2,16384
CV 118,60,61
Mvav 212,164,128
s_add_u32 s14, s14, s15
Ta 162,2,18432
s_add_u32 s14, s14, 0x4400000
Mvav 220,164,132
s_and_b32 s15, s66, 3
v_exp_f32 v63, v63
Maav 212,164,136
s_lshl_b32 s20, s15, 10
v_exp_f32 v68, v68
Maav 220,164,140
s_add_u32 s20, s20, s13
Ta 164,3,16384
CV 119,62,63
Mvav 224,168,128
s_add_u32 s20, s20, 0x8000
Ta 166,3,18432
s_lshl_b32 s21, s15, 10
Mvav 232,168,132
s_add_u32 s21, s21, s13
v_exp_f32 v69, v69
Maav 224,168,136
s_add_u32 s21, s21, 0x19000
v_exp_f32 v70, v70
Maav 232,168,140
s_and_b32 s22, s66, 1
Ta 168,4,16384
CV 122,68,69
Mvav 228,172,128
s_mul_i32 s18, s22, 0x4800
Ta 170,4,18432
s_lshl_b32 s22, s22, 8
Mvav 236,172,132
v_exp_f32 v71, v71
Maav 228,172,136
v_exp_f32 v76, v76
Maav 236,172,140
Ta 172,5,16384
CV 123,70,71
v_mfma_f32_16x16x32_bf16 v[48:51], a[128:131], a[0:3], v[144:147]
Ta 174,5,18432
v_mfma_f32_16x16x32_bf16 v[56:59], a[128:131], a[4:7], v[148:151]
v_exp_f32 v77, v77
v_mfma_f32_16x16x32_bf16 v[64:67], a[128:131], a[32:35], v[152:155]
LD 8,24,76,0
CV 126,76,77
v_mfma_f32_16x16x32_bf16 v[72:75], a[128:131], a[36:39], v[156:159]
Ta 128,2,20480
v_and_b32 v8, 7, v1
Mvaa 48,132,8
Ta 130,2,22528
v_xor_b32 v8, v8, v173
Mvaa 56,132,12
v_exp_f32 v78, v78
Mvaa 64,132,40
LD 9,24,76,1024
v_lshl_add_u32 v8, v8, 4, v172
Mvaa 72,132,44
Ta 132,3,20480
v_mov_b32 v172, s66
Mvaa 48,136,16
Ta 134,3,22528
v_lshlrev_b32 v173, 7, s94
Mvaa 56,136,20
v_exp_f32 v79, v79
Mvaa 64,136,48
LD 10,24,76,2048
CV 127,78,79
Mvaa 72,136,52
Ta 136,4,20480
v_lshl_add_u32 v172, v172, 2, v173
Mvaa 48,140,24
Ta 138,4,22528
v_add_u32 v172, 0x3004000, v172
Mvaa 56,140,28
s_waitcnt lgkmcnt(4)
v_exp_f32 v80, v80
Mvaa 64,140,56
LD 11,24,76,3072
v_add_u32 v9, 0x2000, v8
Mvaa 72,140,60
s_add_u32 m0, s69, 0x9000
s_add_u32 s76, s71, 0x74000
Ta 140,5,20480
v_mfma_f32_16x16x32_bf16 v[52:55], a[144:147], a[0:3], v[144:147]
Ta 142,5,22528
v_add_u32 v10, 0x4000, v8
v_mfma_f32_16x16x32_bf16 v[60:63], a[144:147], a[4:7], v[148:151]
v_exp_f32 v81, v81
v_mfma_f32_16x16x32_bf16 v[68:71], a[144:147], a[32:35], v[152:155]
LD 12,44,76,0
CV 128,80,81
v_mfma_f32_16x16x32_bf16 v[76:79], a[144:147], a[36:39], v[156:159]
ds_read_b128 a[144:147], v20 offset:8192
v_add_u32 v11, 0x6000, v8
Mvaa 52,148,8
v_exp_f32 v82, v82
Mvaa 60,148,12
v_exp_f32 v83, v83
Mvaa 68,148,40
LD 13,44,76,1024
CV 129,82,83
Mvaa 76,148,44
ds_read_b128 a[148:151], v21 offset:8192
Mvaa 52,152,16
v_exp_f32 v88, v88
Mvaa 60,152,20
v_exp_f32 v89, v89
Mvaa 68,152,48
v_exp_f32 v90, v90
Mvaa 76,152,52
ds_read_b128 a[152:155], v22 offset:8192
CV 132,88,89
Mvaa 52,156,24
LD 14,44,76,2048
Mvaa 60,156,28
v_exp_f32 v91, v91
Mvaa 68,156,56
v_exp_f32 v96, v96
Mvaa 76,156,60
ds_read_b128 a[156:159], v23 offset:8192
CV 133,90,91
Mavv 240,40,112
v_exp_f32 v97, v97
Mavv 244,40,116
v_exp_f32 v98, v98
Mavv 248,40,120
v_exp_f32 v99, v99
Mavv 252,40,124
v_exp_f32 v104, v104
Mvav 176,160,112
v_exp_f32 v105, v105
Mvav 184,160,116
v_exp_f32 v106, v106
Maav 176,160,120
v_exp_f32 v107, v107
Maav 184,160,124
ds_read_b128 a[160:163], v20 offset:12288
CV 136,96,97
Mvav 180,164,112
v_exp_f32 v84, v84
Mvav 188,164,116
v_exp_f32 v85, v85
Maav 180,164,120
LD 15,44,76,3072
CV 137,98,99
Maav 188,164,124
s_add_u32 m0, s69, 0xd000
s_add_u32 s76, s73, 0x70000
ds_read_b128 a[164:167], v21 offset:12288
Mvav 192,168,112
v_exp_f32 v86, v86
Mvav 200,168,116
v_exp_f32 v87, v87
Maav 192,168,120
v_exp_f32 v92, v92
Maav 200,168,124
ds_read_b128 a[168:171], v22 offset:12288
CV 140,104,105
Mvav 196,172,112
v_exp_f32 v93, v93
Mvav 204,172,116
v_exp_f32 v94, v94
Maav 196,172,120
v_exp_f32 v95, v95
Maav 204,172,124
ds_read_b128 a[172:175], v23 offset:12288
CV 141,106,107
Mvav 208,128,112
v_exp_f32 v100, v100
Mvav 216,128,116
v_exp_f32 v101, v101
Maav 208,128,120
v_exp_f32 v102, v102
Maav 216,128,124
s_waitcnt lgkmcnt(2)
Ta 128,2,24576
CV 130,84,85
Mvav 212,132,112
LD 16,48,76,0
Ta 130,2,26624
Mvav 220,132,116
v_exp_f32 v103, v103
Maav 212,132,120
v_exp_f32 v108, v108
Maav 220,132,124
Ta 132,3,24576
CV 131,86,87
Mvav 224,136,112
Ta 134,3,26624
CV 134,92,93
Mvav 232,136,116
v_exp_f32 v109, v109
Maav 224,136,120
v_exp_f32 v110, v110
Maav 232,136,124
Ta 136,4,24576
CV 135,94,95
Mvav 228,140,112
Ta 138,4,26624
CV 138,100,101
Mvav 236,140,116
v_exp_f32 v111, v111
Maav 228,140,120
CV 139,102,103
CV 142,108,109
Maav 236,140,124
Ta 140,5,24576
CV 143,110,111
v_mfma_f32_16x16x32_bf16 v[80:83], a[144:147], a[0:3], v[144:147]
Ta 142,5,26624
v_add_u32 v20, 0x9000, v20
v_mfma_f32_16x16x32_bf16 v[88:91], a[144:147], a[4:7], v[148:151]
v_exp_f32 v48, v48
v_mfma_f32_16x16x32_bf16 v[96:99], a[144:147], a[32:35], v[152:155]
LD 17,48,76,1024
v_add_u32 v21, 0x9000, v21
v_mfma_f32_16x16x32_bf16 v[104:107], a[144:147], a[36:39], v[156:159]
Ta 144,2,28672
v_add_u32 v22, 0x9000, v22
Mvaa 80,148,8
Ta 146,2,30720
v_add_u32 v23, 0x9000, v23
Mvaa 88,148,12
v_exp_f32 v49, v49
Mvaa 96,148,40
v_exp_f32 v50, v50
Mvaa 104,148,44
Ta 148,3,28672
CV 112,48,49
Mvaa 80,152,16
Ta 150,3,30720
v_add_u32 v2, 0x9000, v2
Mvaa 88,152,20
v_exp_f32 v51, v51
Mvaa 96,152,48
v_exp_f32 v56, v56
Mvaa 104,152,52
Ta 152,4,28672
CV 113,50,51
Mvaa 80,156,24
Ta 154,4,30720
v_add_u32 v3, 0x9000, v3
Mvaa 88,156,28
v_exp_f32 v57, v57
Mvaa 96,156,56
v_exp_f32 v58, v58
Mvaa 104,156,60
s_branch L_Amain
.p2align 12
L_A0:
s_add_u32 m0, s83, 0x2000
s_add_u32 s76, s82, 0x100
LD 192,32,76,0
LD 193,32,76,1024
LD 194,32,76,2048
LD 195,32,76,3072
s_add_u32 m0, s83, 0x3000
s_add_u32 s76, s82, 0x180
LD 192,32,76,0
LD 193,32,76,1024
LD 194,32,76,2048
LD 195,32,76,3072
s_mov_b64 exec, 0
s_cmp_eq_u32 s64, 0
s_cbranch_scc1 L_pg8_1
s_cmp_eq_u32 s64, 1
s_cbranch_scc1 L_pg8_2
s_cmp_eq_u32 s64, 2
s_cbranch_scc1 L_pg8_3
s_branch L_pg8_4
L_ret8:
s_mov_b64 exec, -1
s_mov_b64 exec, 0
s_cmp_eq_u32 s64, 0
s_cbranch_scc1 L_pg9_5
s_cmp_eq_u32 s64, 1
s_cbranch_scc1 L_pg9_6
s_cmp_eq_u32 s64, 2
s_cbranch_scc1 L_ret9
s_branch L_ret9
L_ret9:
s_mov_b64 exec, -1
v_min_u32 v46, 8, v1
v_mul_u32_u24 v46, 0x480, v46
s_mul_i32 s77, s100, 0x2880
s_add_u32 s77, s77, 0x400
buffer_load_dword v204, v46, s[56:59], s77 offen
s_waitcnt vmcnt(16)
ds_read_b128 v[48:51], v196
ds_read_b128 v[52:55], v196 offset:2048
ds_read_b128 v[56:59], v197
ds_read_b128 v[60:63], v197 offset:2048
s_add_u32 m0, s83, 0
s_add_u32 s76, s82, 0x200
s_waitcnt lgkmcnt(0)
LD 192,32,76,0
LD 193,32,76,1024
LD 194,32,76,2048
LD 195,32,76,3072
s_waitcnt vmcnt(16)
ds_read_b128 v[64:67], v196 offset:4096
ds_read_b128 v[68:71], v196 offset:6144
ds_read_b128 v[72:75], v197 offset:4096
ds_read_b128 v[76:79], v197 offset:6144
v_dot2_f32_bf16 v240, v48, s88, v240
v_dot2_f32_bf16 v242, v48, v48, v242
v_dot2_f32_bf16 v241, v52, s88, v241
v_dot2_f32_bf16 v243, v52, v52, v243
v_dot2_f32_bf16 v240, v49, s88, v240
v_dot2_f32_bf16 v242, v49, v49, v242
v_dot2_f32_bf16 v241, v53, s88, v241
v_dot2_f32_bf16 v243, v53, v53, v243
v_dot2_f32_bf16 v240, v50, s88, v240
v_dot2_f32_bf16 v242, v50, v50, v242
v_dot2_f32_bf16 v241, v54, s88, v241
v_dot2_f32_bf16 v243, v54, v54, v243
v_dot2_f32_bf16 v240, v51, s88, v240
v_dot2_f32_bf16 v242, v51, v51, v242
v_dot2_f32_bf16 v241, v55, s88, v241
v_dot2_f32_bf16 v243, v55, v55, v243
v_dot2_f32_bf16 v240, v56, s88, v240
v_dot2_f32_bf16 v242, v56, v56, v242
v_dot2_f32_bf16 v241, v60, s88, v241
v_dot2_f32_bf16 v243, v60, v60, v243
v_dot2_f32_bf16 v240, v57, s88, v240
v_dot2_f32_bf16 v242, v57, v57, v242
v_dot2_f32_bf16 v241, v61, s88, v241
v_dot2_f32_bf16 v243, v61, v61, v243
v_dot2_f32_bf16 v240, v58, s88, v240
v_dot2_f32_bf16 v242, v58, v58, v242
v_dot2_f32_bf16 v241, v62, s88, v241
v_dot2_f32_bf16 v243, v62, v62, v243
v_dot2_f32_bf16 v240, v59, s88, v240
v_dot2_f32_bf16 v242, v59, v59, v242
v_dot2_f32_bf16 v241, v63, s88, v241
v_dot2_f32_bf16 v243, v63, v63, v243
s_add_u32 m0, s83, 0x1000
s_add_u32 s76, s82, 0x280
s_waitcnt lgkmcnt(0)
LD 192,32,76,0
LD 193,32,76,1024
LD 194,32,76,2048
LD 195,32,76,3072
s_waitcnt vmcnt(13)
ds_read_b128 v[80:83], v196 offset:8192
ds_read_b128 v[84:87], v196 offset:10240
ds_read_b128 v[88:91], v197 offset:8192
ds_read_b128 v[92:95], v197 offset:10240
v_dot2_f32_bf16 v240, v64, s88, v240
v_dot2_f32_bf16 v242, v64, v64, v242
v_dot2_f32_bf16 v241, v68, s88, v241
v_dot2_f32_bf16 v243, v68, v68, v243
v_dot2_f32_bf16 v240, v65, s88, v240
v_dot2_f32_bf16 v242, v65, v65, v242
v_dot2_f32_bf16 v241, v69, s88, v241
v_dot2_f32_bf16 v243, v69, v69, v243
v_dot2_f32_bf16 v240, v66, s88, v240
v_dot2_f32_bf16 v242, v66, v66, v242
v_dot2_f32_bf16 v241, v70, s88, v241
v_dot2_f32_bf16 v243, v70, v70, v243
v_dot2_f32_bf16 v240, v67, s88, v240
v_dot2_f32_bf16 v242, v67, v67, v242
v_dot2_f32_bf16 v241, v71, s88, v241
v_dot2_f32_bf16 v243, v71, v71, v243
v_dot2_f32_bf16 v240, v72, s88, v240
v_dot2_f32_bf16 v242, v72, v72, v242
v_dot2_f32_bf16 v241, v76, s88, v241
v_dot2_f32_bf16 v243, v76, v76, v243
v_dot2_f32_bf16 v240, v73, s88, v240
v_dot2_f32_bf16 v242, v73, v73, v242
v_dot2_f32_bf16 v241, v77, s88, v241
v_dot2_f32_bf16 v243, v77, v77, v243
v_dot2_f32_bf16 v240, v74, s88, v240
v_dot2_f32_bf16 v242, v74, v74, v242
v_dot2_f32_bf16 v241, v78, s88, v241
v_dot2_f32_bf16 v243, v78, v78, v243
v_dot2_f32_bf16 v240, v75, s88, v240
v_dot2_f32_bf16 v242, v75, v75, v242
v_dot2_f32_bf16 v241, v79, s88, v241
v_dot2_f32_bf16 v243, v79, v79, v243
s_add_u32 m0, s83, 0x2000
s_add_u32 s76, s82, 0x300
s_waitcnt lgkmcnt(0)
LD 192,32,76,0
LD 193,32,76,1024
LD 194,32,76,2048
LD 195,32,76,3072
s_waitcnt vmcnt(13)
ds_read_b128 v[96:99], v196 offset:12288
ds_read_b128 v[100:103], v196 offset:14336
ds_read_b128 v[104:107], v197 offset:12288
ds_read_b128 v[108:111], v197 offset:14336
v_dot2_f32_bf16 v240, v80, s88, v240
v_dot2_f32_bf16 v242, v80, v80, v242
v_dot2_f32_bf16 v241, v84, s88, v241
v_dot2_f32_bf16 v243, v84, v84, v243
v_dot2_f32_bf16 v240, v81, s88, v240
v_dot2_f32_bf16 v242, v81, v81, v242
v_dot2_f32_bf16 v241, v85, s88, v241
v_dot2_f32_bf16 v243, v85, v85, v243
v_dot2_f32_bf16 v240, v82, s88, v240
v_dot2_f32_bf16 v242, v82, v82, v242
v_dot2_f32_bf16 v241, v86, s88, v241
v_dot2_f32_bf16 v243, v86, v86, v243
v_dot2_f32_bf16 v240, v83, s88, v240
v_dot2_f32_bf16 v242, v83, v83, v242
v_dot2_f32_bf16 v241, v87, s88, v241
v_dot2_f32_bf16 v243, v87, v87, v243
v_dot2_f32_bf16 v240, v88, s88, v240
v_dot2_f32_bf16 v242, v88, v88, v242
v_dot2_f32_bf16 v241, v92, s88, v241
v_dot2_f32_bf16 v243, v92, v92, v243
v_dot2_f32_bf16 v240, v89, s88, v240
v_dot2_f32_bf16 v242, v89, v89, v242
v_dot2_f32_bf16 v241, v93, s88, v241
v_dot2_f32_bf16 v243, v93, v93, v243
v_dot2_f32_bf16 v240, v90, s88, v240
v_dot2_f32_bf16 v242, v90, v90, v242
v_dot2_f32_bf16 v241, v94, s88, v241
v_dot2_f32_bf16 v243, v94, v94, v243
v_dot2_f32_bf16 v240, v91, s88, v240
v_dot2_f32_bf16 v242, v91, v91, v242
v_dot2_f32_bf16 v241, v95, s88, v241
v_dot2_f32_bf16 v243, v95, v95, v243
s_add_u32 m0, s83, 0x3000
s_add_u32 s76, s82, 0x380
s_waitcnt lgkmcnt(0)
LD 192,32,76,0
LD 193,32,76,1024
LD 194,32,76,2048
LD 195,32,76,3072
s_waitcnt vmcnt(12)
ds_read_b128 v[112:115], v196
ds_read_b128 v[116:119], v196 offset:2048
ds_read_b128 v[120:123], v197
ds_read_b128 v[124:127], v197 offset:2048
v_dot2_f32_bf16 v240, v96, s88, v240
v_dot2_f32_bf16 v242, v96, v96, v242
v_dot2_f32_bf16 v241, v100, s88, v241
v_dot2_f32_bf16 v243, v100, v100, v243
v_dot2_f32_bf16 v240, v97, s88, v240
v_dot2_f32_bf16 v242, v97, v97, v242
v_dot2_f32_bf16 v241, v101, s88, v241
v_dot2_f32_bf16 v243, v101, v101, v243
v_dot2_f32_bf16 v240, v98, s88, v240
v_dot2_f32_bf16 v242, v98, v98, v242
v_dot2_f32_bf16 v241, v102, s88, v241
v_dot2_f32_bf16 v243, v102, v102, v243
v_dot2_f32_bf16 v240, v99, s88, v240
v_dot2_f32_bf16 v242, v99, v99, v242
v_dot2_f32_bf16 v241, v103, s88, v241
v_dot2_f32_bf16 v243, v103, v103, v243
v_dot2_f32_bf16 v240, v104, s88, v240
v_dot2_f32_bf16 v242, v104, v104, v242
v_dot2_f32_bf16 v241, v108, s88, v241
v_dot2_f32_bf16 v243, v108, v108, v243
v_dot2_f32_bf16 v240, v105, s88, v240
v_dot2_f32_bf16 v242, v105, v105, v242
v_dot2_f32_bf16 v241, v109, s88, v241
v_dot2_f32_bf16 v243, v109, v109, v243
v_dot2_f32_bf16 v240, v106, s88, v240
v_dot2_f32_bf16 v242, v106, v106, v242
v_dot2_f32_bf16 v241, v110, s88, v241
v_dot2_f32_bf16 v243, v110, v110, v243
v_dot2_f32_bf16 v240, v107, s88, v240
v_dot2_f32_bf16 v242, v107, v107, v242
v_dot2_f32_bf16 v241, v111, s88, v241
v_dot2_f32_bf16 v243, v111, v111, v243
s_add_u32 m0, s83, 0
s_add_u32 s76, s82, 0x400
s_waitcnt lgkmcnt(0)
LD 192,32,76,0
LD 193,32,76,1024
LD 194,32,76,2048
LD 195,32,76,3072
s_waitcnt vmcnt(12)
ds_read_b128 v[128:131], v196 offset:4096
ds_read_b128 v[132:135], v196 offset:6144
ds_read_b128 v[136:139], v197 offset:4096
ds_read_b128 v[140:143], v197 offset:6144
v_dot2_f32_bf16 v240, v112, s88, v240
v_dot2_f32_bf16 v242, v112, v112, v242
v_dot2_f32_bf16 v241, v116, s88, v241
v_dot2_f32_bf16 v243, v116, v116, v243
v_dot2_f32_bf16 v240, v113, s88, v240
v_dot2_f32_bf16 v242, v113, v113, v242
v_dot2_f32_bf16 v241, v117, s88, v241
v_dot2_f32_bf16 v243, v117, v117, v243
v_dot2_f32_bf16 v240, v114, s88, v240
v_dot2_f32_bf16 v242, v114, v114, v242
v_dot2_f32_bf16 v241, v118, s88, v241
v_dot2_f32_bf16 v243, v118, v118, v243
v_dot2_f32_bf16 v240, v115, s88, v240
v_dot2_f32_bf16 v242, v115, v115, v242
v_dot2_f32_bf16 v241, v119, s88, v241
v_dot2_f32_bf16 v243, v119, v119, v243
v_dot2_f32_bf16 v240, v120, s88, v240
v_dot2_f32_bf16 v242, v120, v120, v242
v_dot2_f32_bf16 v241, v124, s88, v241
v_dot2_f32_bf16 v243, v124, v124, v243
v_dot2_f32_bf16 v240, v121, s88, v240
v_dot2_f32_bf16 v242, v121, v121, v242
v_dot2_f32_bf16 v241, v125, s88, v241
v_dot2_f32_bf16 v243, v125, v125, v243
v_dot2_f32_bf16 v240, v122, s88, v240
v_dot2_f32_bf16 v242, v122, v122, v242
v_dot2_f32_bf16 v241, v126, s88, v241
v_dot2_f32_bf16 v243, v126, v126, v243
v_dot2_f32_bf16 v240, v123, s88, v240
v_dot2_f32_bf16 v242, v123, v123, v242
v_dot2_f32_bf16 v241, v127, s88, v241
v_dot2_f32_bf16 v243, v127, v127, v243
s_waitcnt vmcnt(8)
ds_read_b128 v[144:147], v196 offset:8192
ds_read_b128 v[148:151], v196 offset:10240
ds_read_b128 v[152:155], v197 offset:8192
ds_read_b128 v[156:159], v197 offset:10240
s_waitcnt lgkmcnt(5)
v_dot2_f32_bf16 v240, v128, s88, v240
v_dot2_f32_bf16 v242, v128, v128, v242
v_dot2_f32_bf16 v241, v132, s88, v241
v_dot2_f32_bf16 v243, v132, v132, v243
v_dot2_f32_bf16 v240, v129, s88, v240
v_dot2_f32_bf16 v242, v129, v129, v242
v_dot2_f32_bf16 v241, v133, s88, v241
v_dot2_f32_bf16 v243, v133, v133, v243
v_dot2_f32_bf16 v240, v130, s88, v240
v_dot2_f32_bf16 v242, v130, v130, v242
v_dot2_f32_bf16 v241, v134, s88, v241
v_dot2_f32_bf16 v243, v134, v134, v243
v_dot2_f32_bf16 v240, v131, s88, v240
v_dot2_f32_bf16 v242, v131, v131, v242
v_dot2_f32_bf16 v241, v135, s88, v241
v_dot2_f32_bf16 v243, v135, v135, v243
v_dot2_f32_bf16 v240, v136, s88, v240
v_dot2_f32_bf16 v242, v136, v136, v242
s_waitcnt lgkmcnt(4)
v_dot2_f32_bf16 v241, v140, s88, v241
v_dot2_f32_bf16 v243, v140, v140, v243
v_dot2_f32_bf16 v240, v137, s88, v240
v_dot2_f32_bf16 v242, v137, v137, v242
v_dot2_f32_bf16 v241, v141, s88, v241
v_dot2_f32_bf16 v243, v141, v141, v243
v_dot2_f32_bf16 v240, v138, s88, v240
v_dot2_f32_bf16 v242, v138, v138, v242
v_dot2_f32_bf16 v241, v142, s88, v241
v_dot2_f32_bf16 v243, v142, v142, v243
v_dot2_f32_bf16 v240, v139, s88, v240
v_dot2_f32_bf16 v242, v139, v139, v242
v_dot2_f32_bf16 v241, v143, s88, v241
v_dot2_f32_bf16 v243, v143, v143, v243
s_waitcnt vmcnt(4)
ds_read_b128 v[160:163], v196 offset:12288
ds_read_b128 v[164:167], v196 offset:14336
ds_read_b128 v[168:171], v197 offset:12288
ds_read_b128 v[172:175], v197 offset:14336
s_waitcnt lgkmcnt(5)
v_dot2_f32_bf16 v240, v144, s88, v240
s_add_u32 m0, s67, 0x12000
v_dot2_f32_bf16 v242, v144, v144, v242
v_dot2_f32_bf16 v241, v148, s88, v241
s_add_u32 s76, s70, 0
v_dot2_f32_bf16 v243, v148, v148, v243
v_dot2_f32_bf16 v240, v145, s88, v240
LD 8,56,76,0
v_dot2_f32_bf16 v242, v145, v145, v242
v_dot2_f32_bf16 v241, v149, s88, v241
LD 9,56,76,1024
v_dot2_f32_bf16 v243, v149, v149, v243
v_dot2_f32_bf16 v240, v146, s88, v240
LD 10,56,76,2048
v_dot2_f32_bf16 v242, v146, v146, v242
v_dot2_f32_bf16 v241, v150, s88, v241
LD 11,56,76,3072
v_dot2_f32_bf16 v243, v150, v150, v243
v_dot2_f32_bf16 v240, v147, s88, v240
s_add_u32 m0, s67, 0x13000
v_dot2_f32_bf16 v242, v147, v147, v242
v_dot2_f32_bf16 v241, v151, s88, v241
s_add_u32 s76, s70, 0x9000
v_dot2_f32_bf16 v243, v151, v151, v243
v_dot2_f32_bf16 v240, v152, s88, v240
LD 8,56,76,0
v_dot2_f32_bf16 v242, v152, v152, v242
s_waitcnt lgkmcnt(4)
v_dot2_f32_bf16 v241, v156, s88, v241
LD 9,56,76,1024
v_dot2_f32_bf16 v243, v156, v156, v243
v_dot2_f32_bf16 v240, v153, s88, v240
v_dot2_f32_bf16 v242, v153, v153, v242
v_dot2_f32_bf16 v241, v157, s88, v241
v_dot2_f32_bf16 v243, v157, v157, v243
v_dot2_f32_bf16 v240, v154, s88, v240
v_dot2_f32_bf16 v242, v154, v154, v242
v_dot2_f32_bf16 v241, v158, s88, v241
v_dot2_f32_bf16 v243, v158, v158, v243
v_dot2_f32_bf16 v240, v155, s88, v240
v_dot2_f32_bf16 v242, v155, v155, v242
v_dot2_f32_bf16 v241, v159, s88, v241
v_dot2_f32_bf16 v243, v159, v159, v243
s_waitcnt vmcnt(6)
ds_read_b128 v[176:179], v196
ds_read_b128 v[180:183], v196 offset:2048
ds_read_b128 v[184:187], v197
ds_read_b128 v[188:191], v197 offset:2048
s_waitcnt lgkmcnt(4)
v_dot2_f32_bf16 v240, v160, s88, v240
LD 10,56,76,2048
v_dot2_f32_bf16 v242, v160, v160, v242
v_dot2_f32_bf16 v241, v164, s88, v241
LD 11,56,76,3072
v_dot2_f32_bf16 v243, v164, v164, v243
v_dot2_f32_bf16 v240, v161, s88, v240
s_add_u32 m0, s67, 0x14000
v_dot2_f32_bf16 v242, v161, v161, v242
v_dot2_f32_bf16 v241, v165, s88, v241
s_add_u32 s76, s70, 0x12000
v_dot2_f32_bf16 v243, v165, v165, v243
v_dot2_f32_bf16 v240, v162, s88, v240
LD 8,56,76,0
v_dot2_f32_bf16 v242, v162, v162, v242
v_dot2_f32_bf16 v241, v166, s88, v241
s_add_u32 m0, s67, 0x1b000
v_dot2_f32_bf16 v243, v166, v166, v243
v_dot2_f32_bf16 v240, v163, s88, v240
s_add_u32 s76, s70, 0x51000
v_dot2_f32_bf16 v242, v163, v163, v242
v_dot2_f32_bf16 v241, v167, s88, v241
LD 8,56,76,0
v_dot2_f32_bf16 v243, v167, v167, v243
v_dot2_f32_bf16 v240, v168, s88, v240
LD 9,56,76,1024
v_dot2_f32_bf16 v242, v168, v168, v242
v_dot2_f32_bf16 v241, v172, s88, v241
LD 10,56,76,2048
v_dot2_f32_bf16 v243, v172, v172, v243
v_dot2_f32_bf16 v240, v169, s88, v240
v_dot2_f32_bf16 v242, v169, v169, v242
v_dot2_f32_bf16 v241, v173, s88, v241
v_dot2_f32_bf16 v243, v173, v173, v243
v_dot2_f32_bf16 v240, v170, s88, v240
v_dot2_f32_bf16 v242, v170, v170, v242
v_dot2_f32_bf16 v241, v174, s88, v241
v_dot2_f32_bf16 v243, v174, v174, v243
v_dot2_f32_bf16 v240, v171, s88, v240
v_dot2_f32_bf16 v242, v171, v171, v242
v_dot2_f32_bf16 v241, v175, s88, v241
v_dot2_f32_bf16 v243, v175, v175, v243
s_waitcnt lgkmcnt(0)
s_barrier
v_dot2_f32_bf16 v240, v176, s88, v240
LD 11,56,76,3072
v_dot2_f32_bf16 v242, v176, v176, v242
v_dot2_f32_bf16 v241, v180, s88, v241
s_add_u32 m0, s67, 0x1c000
v_dot2_f32_bf16 v243, v180, v180, v243
v_dot2_f32_bf16 v240, v177, s88, v240
s_add_u32 s76, s70, 0x5a000
v_dot2_f32_bf16 v242, v177, v177, v242
v_dot2_f32_bf16 v241, v181, s88, v241
LD 8,56,76,0
v_dot2_f32_bf16 v243, v181, v181, v243
v_dot2_f32_bf16 v240, v178, s88, v240
LD 9,56,76,1024
v_dot2_f32_bf16 v242, v178, v178, v242
v_dot2_f32_bf16 v241, v182, s88, v241
LD 10,56,76,2048
v_dot2_f32_bf16 v243, v182, v182, v243
v_dot2_f32_bf16 v240, v179, s88, v240
LD 11,56,76,3072
v_dot2_f32_bf16 v242, v179, v179, v242
v_dot2_f32_bf16 v241, v183, s88, v241
s_add_u32 m0, s67, 0x1d000
v_dot2_f32_bf16 v243, v183, v183, v243
v_dot2_f32_bf16 v240, v184, s88, v240
s_add_u32 s76, s70, 0x63000
v_dot2_f32_bf16 v242, v184, v184, v242
v_dot2_f32_bf16 v241, v188, s88, v241
LD 8,56,76,0
v_dot2_f32_bf16 v243, v188, v188, v243
v_dot2_f32_bf16 v240, v185, s88, v240
v_dot2_f32_bf16 v242, v185, v185, v242
v_dot2_f32_bf16 v241, v189, s88, v241
v_dot2_f32_bf16 v243, v189, v189, v243
v_dot2_f32_bf16 v240, v186, s88, v240
v_dot2_f32_bf16 v242, v186, v186, v242
v_dot2_f32_bf16 v241, v190, s88, v241
v_dot2_f32_bf16 v243, v190, v190, v243
v_dot2_f32_bf16 v240, v187, s88, v240
v_dot2_f32_bf16 v242, v187, v187, v242
v_dot2_f32_bf16 v241, v191, s88, v241
v_dot2_f32_bf16 v243, v191, v191, v243
s_nop 1
v_permlane32_swap_b32 v240, v241
v_add_f32 v240, v240, v241
v_permlane32_swap_b32 v242, v243
v_add_f32 v242, v242, v243
v_mov_b32 v244, v240
s_nop 1
v_permlane16_swap_b32 v240, v244
v_add_f32 v240, v240, v244
v_mov_b32 v245, v242
s_nop 1
v_permlane16_swap_b32 v242, v245
v_add_f32 v242, v242, v245
v_mul_f32 v240, 0xbae38e39, v240
v_mul_f32 v242, 0x3ae38e39, v242
v_fma_f32 v242, -v240, v240, v242
v_max_f32 v242, 0, v242
v_mov_b32 v24, v240
s_add_u32 m0, s67, 0
v_mov_b32 v219, v24
v_mov_b32 v220, v24
s_add_u32 s76, s95, 0
s_nop 0
v_permlane32_swap_b32 v219, v220
v_add_u32 v2, 0x12000, v2
s_and_b32 s20, s66, 2
v_mov_b32 v216, v219
v_mov_b32 v217, v219
v_mov_b32 v218, v219
v_mov_b32 v221, v220
v_mov_b32 v222, v220
v_mfma_f32_16x16x32_bf16 v[192:195], a[248:251], v[48:51], v[216:219]
LD 20,36,76,0
v_mov_b32 v223, v220
v_add_u32 v3, 0x12000, v3
v_mfma_f32_16x16x32_bf16 v[196:199], a[252:255], v[48:51], v[216:219]
s_lshl_b32 s20, s20, 5
v_readfirstlane_b32 s84, v255
v_xor_b32 v254, s20, v2
v_xor_b32 v255, s20, v3
v_mfma_f32_16x16x32_bf16 v[200:203], a[248:251], v[52:55], v[220:223]
s_lshr_b32 s16, s72, 10
CV 48,192,193
CV 49,194,195
v_add_u32 v2, 0x9000, v2
v_mfma_f32_16x16x32_bf16 v[204:207], a[252:255], v[52:55], v[220:223]
s_add_u32 s16, s16, 0
CV 50,196,197
CV 51,198,199
v_add_u32 v3, 0x9000, v3
v_mfma_f32_16x16x32_bf16 v[208:211], a[248:251], v[56:59], v[216:219]
s_mul_i32 s17, s16, 57
CV 52,200,201
CV 53,202,203
v_add_u32 v4, 0x12000, v4
v_mfma_f32_16x16x32_bf16 v[212:215], a[252:255], v[56:59], v[216:219]
s_lshr_b32 s17, s17, 9
CV 54,204,205
CV 55,206,207
v_add_u32 v4, 0x9000, v4
v_mfma_f32_16x16x32_bf16 v[192:195], a[248:251], v[60:63], v[220:223]
LD 21,36,76,1024
CV 56,208,209
CV 57,210,211
v_mfma_f32_16x16x32_bf16 v[196:199], a[252:255], v[60:63], v[220:223]
s_lshl_b32 s17, s17, 2
CV 58,212,213
CV 59,214,215
v_add_u32 v4, 0xfffe5000, v4
v_mfma_f32_16x16x32_bf16 v[200:203], a[248:251], v[64:67], v[216:219]
s_lshr_b32 s17, 0x4031, s17
CV 60,192,193
CV 61,194,195
v_add_u32 v5, 0x12000, v5
v_mfma_f32_16x16x32_bf16 v[204:207], a[252:255], v[64:67], v[216:219]
s_and_b32 s17, s17, 7
CV 62,196,197
CV 63,198,199
v_add_u32 v5, 0x9000, v5
v_mfma_f32_16x16x32_bf16 v[208:211], a[248:251], v[68:71], v[220:223]
s_sub_u32 s17, s17, 2
CV 64,200,201
CV 65,202,203
v_add_u32 v5, 0xfffe5000, v5
v_mfma_f32_16x16x32_bf16 v[212:215], a[252:255], v[68:71], v[220:223]
s_sub_u32 s5, 32, s17
CV 66,204,205
CV 67,206,207
v_mov_b32 v25, v242
v_mfma_f32_16x16x32_bf16 v[192:195], a[248:251], v[72:75], v[216:219]
LD 22,36,76,2048
CV 68,208,209
CV 69,210,211
v_mfma_f32_16x16x32_bf16 v[196:199], a[252:255], v[72:75], v[216:219]
s_sub_u32 s6, 48, s17
CV 70,212,213
CV 71,214,215
v_add_f32 v26, 0x3727c5ac, v25
v_mfma_f32_16x16x32_bf16 v[200:203], a[248:251], v[76:79], v[220:223]
s_lshl_b32 s78, s17, 4
CV 72,192,193
CV 73,194,195
v_and_b32 v8, 7, v1
v_mfma_f32_16x16x32_bf16 v[204:207], a[252:255], v[76:79], v[220:223]
s_lshl_b32 s79, s17, 4
CV 74,196,197
CV 75,198,199
v_mfma_f32_16x16x32_bf16 v[208:211], a[248:251], v[80:83], v[216:219]
s_sub_u32 s78, s72, s78
CV 76,200,201
CV 77,202,203
v_rcp_f32 v27, v26
v_mfma_f32_16x16x32_bf16 v[212:215], a[252:255], v[80:83], v[216:219]
s_sub_u32 s79, s72, s79
CV 78,204,205
CV 79,206,207
v_mul_f32 v25, v25, v27
v_mfma_f32_16x16x32_bf16 v[192:195], a[248:251], v[84:87], v[220:223]
L_pg8_1:
s_cbranch_execz L_ret8
s_add_u32 s78, s78, 0x480200
CV 80,208,209
CV 81,210,211
v_add_f32 v25, 0x3727c5ac, v25
v_mfma_f32_16x16x32_bf16 v[196:199], a[252:255], v[84:87], v[220:223]
s_add_u32 s79, s79, 0x480300
CV 82,212,213
CV 83,214,215
v_mul_f32 v25, v25, v26
v_mfma_f32_16x16x32_bf16 v[200:203], a[248:251], v[88:91], v[216:219]
LD 23,36,76,3072
CV 84,192,193
CV 85,194,195
v_mfma_f32_16x16x32_bf16 v[204:207], a[252:255], v[88:91], v[216:219]
s_add_u32 m0, s67, 0x1000
s_add_u32 s76, s95, 0x40000
CV 86,196,197
CV 87,198,199
v_mfma_f32_16x16x32_bf16 v[208:211], a[248:251], v[92:95], v[220:223]
s_add_u32 s84, s84, 0x9e3779b9
CV 88,200,201
CV 89,202,203
v_mfma_f32_16x16x32_bf16 v[212:215], a[252:255], v[92:95], v[220:223]
s_cmp_lg_u32 s89, 0
s_cselect_b32 s98, s98, s84
CV 90,204,205
CV 91,206,207
v_sqrt_f32 v25, v25
v_mfma_f32_16x16x32_bf16 v[192:195], a[248:251], v[96:99], v[216:219]
s_lshl2_add_u32 s9, s31, s99
CV 92,208,209
CV 93,210,211
v_mov_b32 v44, v25
v_mfma_f32_16x16x32_bf16 v[196:199], a[252:255], v[96:99], v[216:219]
s_add_u32 s9, s9, 0
CV 94,212,213
CV 95,214,215
v_mov_b32 v45, v25
v_mfma_f32_16x16x32_bf16 v[200:203], a[248:251], v[100:103], v[220:223]
LD 20,36,76,0
CV 96,192,193
CV 97,194,195
v_mfma_f32_16x16x32_bf16 v[204:207], a[252:255], v[100:103], v[220:223]
s_lshl_b32 s10, s66, 6
CV 98,196,197
CV 99,198,199
v_mov_b32 v47, s98
v_mfma_f32_16x16x32_bf16 v[208:211], a[248:251], v[104:107], v[216:219]
s_add_u32 s10, s10, s94
CV 100,200,201
CV 101,202,203
v_mfma_f32_16x16x32_bf16 v[212:215], a[252:255], v[104:107], v[216:219]
s_lshl_b32 s10, s10, 2
CV 102,204,205
CV 103,206,207
v_rcp_f32 v25, v25
v_mfma_f32_16x16x32_bf16 v[192:195], a[248:251], v[108:111], v[220:223]
s_add_u32 s10, s10, 0x300c000
CV 104,208,209
CV 105,210,211
v_mfma_f32_16x16x32_bf16 v[196:199], a[252:255], v[108:111], v[220:223]
s_add_u32 s7, s101, 0x6000
CV 106,212,213
CV 107,214,215
v_rsq_f32 v38, v26
v_mfma_f32_16x16x32_bf16 v[200:203], a[248:251], v[112:115], v[216:219]
LD 21,36,76,1024
CV 108,192,193
CV 109,194,195
v_mfma_f32_16x16x32_bf16 v[204:207], a[252:255], v[112:115], v[216:219]
s_add_u32 s4, s101, 0x7000
CV 110,196,197
CV 111,198,199
v_mul_f32 v26, 0xc0135761, v25
v_mfma_f32_16x16x32_bf16 v[208:211], a[248:251], v[116:119], v[220:223]
s_add_u32 s12, s74, 0x400
CV 112,200,201
CV 113,202,203
v_mul_f32 v25, v25, v25
v_mfma_f32_16x16x32_bf16 v[212:215], a[252:255], v[116:119], v[220:223]
s_add_u32 s23, s66, 1
CV 114,204,205
CV 115,206,207
v_mul_f32 v25, 0x3d372713, v25
v_mfma_f32_16x16x32_bf16 v[192:195], a[248:251], v[120:123], v[216:219]
s_and_b32 s23, s23, 7
CV 116,208,209
CV 117,210,211
v_mul_f32 v42, v26, v25
v_mfma_f32_16x16x32_bf16 v[196:199], a[252:255], v[120:123], v[216:219]
s_lshl_b32 s23, s23, 7
CV 118,212,213
CV 119,214,215
v_mov_b32 v40, v26
v_mfma_f32_16x16x32_bf16 v[200:203], a[248:251], v[124:127], v[220:223]
s_add_u32 s23, s23, s74
CV 120,192,193
CV 121,194,195
v_mov_b32 v41, v26
v_mfma_f32_16x16x32_bf16 v[204:207], a[252:255], v[124:127], v[220:223]
s_lshl_b32 s11, s64, 8
CV 122,196,197
CV 123,198,199
v_mov_b32 v43, v42
v_mfma_f32_16x16x32_bf16 v[208:211], a[248:251], v[128:131], v[216:219]
LD 22,36,76,2048
CV 124,200,201
CV 125,202,203
v_mfma_f32_16x16x32_bf16 v[212:215], a[252:255], v[128:131], v[216:219]
s_add_u32 s11, s11, 0x24000
CV 126,204,205
CV 127,206,207
v_mul_f32 v36, v24, v38
v_mfma_f32_16x16x32_bf16 v[192:195], a[248:251], v[132:135], v[220:223]
s_mul_i32 s13, s94, 0x88000
CV 128,208,209
CV 129,210,211
v_mul_f32 v38, 0x3e0293ee, v38
v_mfma_f32_16x16x32_bf16 v[196:199], a[252:255], v[132:135], v[220:223]
s_add_u32 s13, s13, 0x800000
CV 130,212,213
CV 131,214,215
v_mov_b32 v39, v38
v_mfma_f32_16x16x32_bf16 v[200:203], a[248:251], v[136:139], v[216:219]
s_waitcnt vmcnt(16)
s_barrier
CV 132,192,193
CV 133,194,195
v_mov_b32 v37, v36
v_mfma_f32_16x16x32_bf16 v[204:207], a[252:255], v[136:139], v[216:219]
s_lshl2_add_u32 s8, s66, s99
Ta 128,254,0
CV 134,196,197
CV 135,198,199
v_mfma_f32_16x16x32_bf16 v[208:211], a[248:251], v[140:143], v[220:223]
LD 23,36,76,3072
Ta 130,254,2048
s_add_u32 m0, s67, 0x2000
v_mfma_f32_16x16x32_bf16 v[212:215], a[252:255], v[140:143], v[220:223]
s_add_u32 s76, s95, 0x80000
Ta 132,255,0
CV 136,200,201
CV 137,202,203
v_mfma_f32_16x16x32_bf16 v[192:195], a[248:251], v[144:147], v[216:219]
s_add_u32 s8, s8, 0x6020
Ta 134,255,2048
CV 138,204,205
CV 139,206,207
v_mfma_f32_16x16x32_bf16 v[196:199], a[252:255], v[144:147], v[216:219]
s_mov_b64 s[56:57], s[18:19]
Ta 136,254,4096
CV 140,208,209
CV 141,210,211
v_mfma_f32_16x16x32_bf16 v[200:203], a[248:251], v[148:151], v[220:223]
Ta 138,254,6144
CV 142,212,213
CV 143,214,215
v_mfma_f32_16x16x32_bf16 v[204:207], a[252:255], v[148:151], v[220:223]
Ta 140,255,4096
CV 144,192,193
CV 145,194,195
v_mfma_f32_16x16x32_bf16 v[208:211], a[248:251], v[152:155], v[216:219]
LD 20,36,76,0
Ta 142,255,6144
v_mfma_f32_16x16x32_bf16 v[212:215], a[252:255], v[152:155], v[216:219]
s_add_u32 m0, s67, 0x9000
Ta 144,254,8192
CV 146,196,197
CV 147,198,199
CV 148,200,201
v_mfma_f32_16x16x32_bf16 v[192:195], a[248:251], v[156:159], v[220:223]
s_add_u32 s76, s95, 0x240000
Ta 146,254,10240
CV 149,202,203
CV 150,204,205
v_mfma_f32_16x16x32_bf16 v[196:199], a[252:255], v[156:159], v[220:223]
Ta 148,255,8192
CV 151,206,207
CV 152,208,209
v_mfma_f32_16x16x32_bf16 v[200:203], a[248:251], v[160:163], v[216:219]
Ta 150,255,10240
CV 153,210,211
CV 154,212,213
v_mfma_f32_16x16x32_bf16 v[204:207], a[252:255], v[160:163], v[216:219]
Ta 152,254,12288
CV 155,214,215
CV 156,192,193
v_mfma_f32_16x16x32_bf16 v[208:211], a[248:251], v[164:167], v[220:223]
Ta 154,254,14336
CV 157,194,195
CV 158,196,197
v_mfma_f32_16x16x32_bf16 v[212:215], a[252:255], v[164:167], v[220:223]
Ta 156,255,12288
CV 159,198,199
CV 160,200,201
v_mfma_f32_16x16x32_bf16 v[192:195], a[248:251], v[168:171], v[216:219]
Ta 158,255,14336
CV 161,202,203
CV 162,204,205
v_mfma_f32_16x16x32_bf16 v[196:199], a[252:255], v[168:171], v[216:219]
Ta 160,254,16384
CV 163,206,207
CV 164,208,209
v_mfma_f32_16x16x32_bf16 v[200:203], a[248:251], v[172:175], v[220:223]
Ta 162,254,18432
CV 165,210,211
CV 166,212,213
v_mfma_f32_16x16x32_bf16 v[204:207], a[252:255], v[172:175], v[220:223]
Ta 164,255,16384
CV 167,214,215
CV 168,192,193
v_mfma_f32_16x16x32_bf16 v[208:211], a[248:251], v[176:179], v[216:219]
Ta 166,255,18432
CV 169,194,195
CV 170,196,197
v_mfma_f32_16x16x32_bf16 v[212:215], a[252:255], v[176:179], v[216:219]
CV 171,198,199
CV 172,200,201
CV 173,202,203
v_mfma_f32_16x16x32_bf16 v[192:195], a[248:251], v[180:183], v[220:223]
CV 174,204,205
CV 175,206,207
CV 176,208,209
v_mfma_f32_16x16x32_bf16 v[196:199], a[252:255], v[180:183], v[220:223]
CV 177,210,211
CV 178,212,213
CV 179,214,215
v_mfma_f32_16x16x32_bf16 v[200:203], a[248:251], v[184:187], v[216:219]
CV 180,192,193
CV 181,194,195
v_mfma_f32_16x16x32_bf16 v[204:207], a[252:255], v[184:187], v[216:219]
s_nop 0
CV 182,196,197
CV 183,198,199
v_mfma_f32_16x16x32_bf16 v[208:211], a[248:251], v[188:191], v[220:223]
s_nop 0
CV 184,200,201
CV 185,202,203
v_mfma_f32_16x16x32_bf16 v[212:215], a[252:255], v[188:191], v[220:223]
s_waitcnt lgkmcnt(0)
CV 186,204,205
CV 187,206,207
v_permlane32_swap_b32 v40, v41
v_mfma_f32_16x16x32_bf16 v[224:227], a[128:131], v[48:51], 0
CV 188,208,209
CV 189,210,211
v_mfma_f32_16x16x32_bf16 v[232:235], a[128:131], v[52:55], 0
Ta 128,254,20480
CV 190,212,213
v_mfma_f32_16x16x32_bf16 v[228:231], a[132:135], v[48:51], 0
LD 20,36,76,0
Ta 130,254,22528
v_mfma_f32_16x16x32_bf16 v[236:239], a[132:135], v[52:55], 0
Ta 132,255,20480
CV 191,214,215
Mvav 224,136,56
Ta 134,255,22528
Mvav 232,136,60
Ta 136,254,24576
Mvav 228,140,56
LD 21,36,76,1024
Ta 138,254,26624
Mvav 236,140,60
s_mul_i32 s77, s100, 0x12000
Ta 140,255,24576
v_min_u32 v46, 8, v1
Mvav 224,144,64
s_mul_i32 s85, s66, 0x400
Ta 142,255,26624
v_mul_u32_u24 v46, 0x2000, v46
Mvav 232,144,68
s_add_u32 s77, s77, s85
Ta 144,254,28672
s_add_u32 s77, s77, 0x100
Mvav 228,148,64
LD 22,36,76,2048
Ta 146,254,30720
Mvav 236,148,68
Ta 148,255,28672
Mvav 224,152,72
Ta 150,255,30720
Mvav 232,152,76
Ta 152,254,32768
Mvav 228,156,72
LD 23,36,76,3072
Ta 154,254,34816
Mvav 236,156,76
s_add_u32 m0, s67, 0xa000
s_add_u32 s76, s95, 0x280000
Ta 156,255,32768
Mvav 224,160,80
Ta 158,255,34816
v_xor_b32 v254, s20, v2
Mvav 232,160,84
v_xor_b32 v255, s20, v3
v_add_u32 v2, 0xfffe5000, v2
Mvav 228,164,80
LD 20,36,76,0
v_add_u32 v3, 0xfffe5000, v3
Mvav 236,164,84
s_waitcnt lgkmcnt(7)
v_permlane32_swap_b32 v42, v43
Mvav 224,128,88
v_permlane32_swap_b32 v44, v45
Mvav 232,128,92
v_permlane32_swap_b32 v38, v39
Mvav 228,132,88
LD 21,36,76,1024
s_waitcnt vmcnt(15) lgkmcnt(0)
s_barrier
Mvav 236,132,92
Ta 160,254,0
Mvav 224,136,96
Ta 162,254,2048
Mvav 232,136,100
Ta 164,255,0
Mvav 228,140,96
LD 22,36,76,2048
Ta 166,255,2048
Mvav 236,140,100
Ta 128,254,4096
Mvav 224,144,104
Ta 130,254,6144
Mvav 232,144,108
Ta 132,255,4096
Mvav 228,148,104
LD 23,36,76,3072
Ta 134,255,6144
Mvav 236,148,108
s_add_u32 m0, s67, 0xb000
s_add_u32 s76, s95, 0x2c0000
Ta 136,254,8192
Mvav 224,152,112
Ta 138,254,10240
Mvav 232,152,116
s_waitcnt lgkmcnt(7)
Ta 140,255,8192
Mvav 228,156,112
LD 20,36,76,0
Ta 142,255,10240
Mvav 236,156,116
s_add_u32 m0, s67, 0x12000
s_add_u32 s76, s95, 0x80
Ta 144,254,12288
Mvav 224,160,120
Ta 146,254,14336
Mvav 232,160,124
s_waitcnt lgkmcnt(8)
Ta 148,255,12288
Mvav 228,164,120
buffer_load_dword v35, v46, s[36:39], s77 offen
Ta 150,255,14336
Mvav 236,164,124
Ta 152,254,16384
Mvav 224,128,128
LD 20,36,76,0
Ta 154,254,18432
Mvav 232,128,132
s_waitcnt lgkmcnt(8)
Ta 156,255,16384
Mvav 228,132,128
s_mul_i32 s77, s100, 0x12000
Ta 158,255,18432
v_min_u32 v46, 8, v1
Mvav 236,132,132
s_mul_i32 s85, s66, 0x400
Ta 160,254,20480
v_mul_u32_u24 v46, 0x2000, v46
Mvav 224,136,136
LD 21,36,76,1024
Ta 162,254,22528
Mvav 232,136,140
s_waitcnt lgkmcnt(8)
s_add_u32 s77, s77, s85
Ta 164,255,20480
s_add_u32 s77, s77, 0x180
Mvav 228,140,136
Ta 166,255,22528
Mvav 236,140,140
Ta 128,254,24576
Mvav 224,144,144
LD 22,36,76,2048
Ta 130,254,26624
Mvav 232,144,148
s_waitcnt lgkmcnt(9)
Ta 132,255,24576
Mvav 228,148,144
Ta 134,255,26624
Mvav 236,148,148
s_waitcnt lgkmcnt(8)
Ta 136,254,28672
Ta 138,254,30720
Mvav 224,152,152
LD 23,36,76,3072
Ta 140,255,28672
Mvav 232,152,156
s_add_u32 m0, s67, 0x13000
s_add_u32 s76, s95, 0x40080
Ta 142,255,30720
Mvav 228,156,152
Ta 144,254,32768
Ta 146,254,34816
Mvav 236,156,156
s_waitcnt lgkmcnt(10)
Ta 148,255,32768
Ta 150,255,34816
Mvav 224,160,160
LD 20,36,76,0
Mvav 232,160,164
v_permlane32_swap_b32 v36, v37
Mvav 228,164,160
Mvav 236,164,164
s_waitcnt lgkmcnt(8)
Mvav 224,128,168
LD 21,36,76,1024
Mvav 232,128,172
Mvav 228,132,168
s_waitcnt vmcnt(16) lgkmcnt(0)
s_barrier
Mvav 236,132,172
Ta 152,2,0
Mvav 224,136,176
LD 22,36,76,2048
Ta 154,2,2048
Mvav 232,136,180
Ta 156,3,0
Mvav 228,140,176
Ta 158,3,2048
Mvav 236,140,180
Ta 160,4,0
Mvav 224,144,184
LD 23,36,76,3072
Ta 162,4,2048
Mvav 232,144,188
s_add_u32 m0, s67, 0x14000
s_add_u32 s76, s95, 0x80080
Ta 164,5,0
Mvav 228,148,184
Ta 166,5,2048
v_mul_f32 v26, v226, v226
Mvav 236,148,188
s_waitcnt lgkmcnt(6)
Ta 128,2,4096
v_mul_f32 v27, v227, v227
v_mfma_f32_16x16x32_bf16 v[192:195], a[152:155], v[48:51], 0
LD 20,36,76,0
Ta 130,2,6144
v_mfma_f32_16x16x32_bf16 v[200:203], a[152:155], v[52:55], 0
s_waitcnt lgkmcnt(6)
s_add_u32 m0, s67, 0x1b000
s_add_u32 s76, s95, 0x240080
Ta 132,3,4096
v_mul_f32 v25, v225, v225
v_mfma_f32_16x16x32_bf16 v[196:199], a[156:159], v[48:51], 0
Ta 134,3,6144
Ta 136,4,4096
v_mfma_f32_16x16x32_bf16 v[204:207], a[156:159], v[52:55], 0
s_waitcnt lgkmcnt(7)
Ta 138,4,6144
Ta 140,5,4096
v_mfma_f32_16x16x32_bf16 v[208:211], a[160:163], v[48:51], 0
buffer_load_dword v35, v46, s[36:39], s77 offen
Ta 142,5,6144
v_mfma_f32_16x16x32_bf16 v[216:219], a[160:163], v[52:55], 0
s_waitcnt lgkmcnt(8)
Ta 144,2,8192
Ta 146,2,10240
v_mfma_f32_16x16x32_bf16 v[212:215], a[164:167], v[48:51], 0
LD 20,36,76,0
Ta 148,3,8192
v_mfma_f32_16x16x32_bf16 v[220:223], a[164:167], v[52:55], 0
s_waitcnt lgkmcnt(9)
s_mul_i32 s77, s100, 0x400
Ta 150,3,10240
v_fma_f32 v26, v26, v42, v40
v_fma_f32 v27, v27, v42, v40
v_fma_f32 v25, v25, v42, v40
Mvav 192,128,56
Ta 152,4,8192
v_mul_f32 v26, v226, v26
Mvav 200,128,60
s_waitcnt lgkmcnt(9)
Ta 154,4,10240
v_mul_f32 v27, v227, v27
v_mul_f32 v25, v225, v25
Mvav 196,132,56
LD 21,36,76,1024
Ta 156,5,8192
Mvav 204,132,60
s_waitcnt lgkmcnt(8)
Ta 158,5,10240
v_mul_f32 v24, v224, v224
v_exp_f32 v26, v26
Mvav 208,136,56
s_and_b32 s85, s30, 31
Ta 160,2,12288
v_and_b32 v46, 32, v1
Mvav 216,136,60
s_waitcnt lgkmcnt(7)
s_lshl_b32 s85, s85, 8
Ta 162,2,14336
v_lshl_add_u32 v46, v46, 2, s85
v_mul_f32 v28, v228, v228
Mvav 212,140,56
LD 22,36,76,2048
Ta 164,3,12288
Mvav 220,140,60
s_getpc_b64 s[96:97]
L_ca0_0:
s_add_u32 s96, s96, L_ca0_0+16384-L_ca0_0
s_addc_u32 s97, s97, 0
Ta 166,3,14336
v_mul_f32 v29, v229, v229
v_exp_f32 v27, v27
Mvav 192,144,64
s_mul_i32 s85, s66, 0x100000
Ta 128,4,12288
v_fma_f32 v24, v24, v42, v40
Mvav 200,144,68
s_waitcnt lgkmcnt(7)
s_add_u32 s77, s77, s85
Ta 130,4,14336
s_add_u32 s77, s77, 0x60000
global_load_dword v35, v46, s[96:97]
Mvav 196,148,64
Ta 132,5,12288
Ta 134,5,14336
Mvav 204,148,68
s_waitcnt lgkmcnt(6)
Ta 136,2,16384
v_min_u32 v46, 7, v1
v_fma_f32 v28, v28, v42, v40
Mvav 208,152,64
LD 23,36,76,3072
Ta 138,2,18432
Mvav 216,152,68
s_add_u32 m0, s67, 0x1c000
s_add_u32 s76, s95, 0x280080
Ta 140,3,16384
v_mul_u32_u24 v46, 0x80, v46
Mvav 212,156,64
Ta 142,3,18432
v_fma_f32 v29, v29, v42, v40
v_fma_f32 v26, v26, v44, v44
Mvav 220,156,68
Ta 144,4,16384
v_fma_f32 v27, v27, v44, v44
v_mul_f32 v24, v224, v24
Mvav 192,160,72
buffer_load_dword v35, v46, s[44:47], s77 offen
Ta 146,4,18432
Mvav 200,160,76
s_waitcnt lgkmcnt(8)
Ta 148,5,16384
v_mul_f32 v28, v228, v28
v_mul_f32 v29, v229, v29
Mvav 196,164,72
LD 20,36,76,0
L_pg8_2:
s_cbranch_execz L_ret8
Ta 150,5,18432
Mvav 204,164,76
Ta 152,2,20480
v_mul_f32 v30, v230, v230
v_exp_f32 v25, v25
Mvav 208,128,72
Ta 154,2,22528
v_fma_f32 v25, v25, v44, v44
Mvav 216,128,76
s_waitcnt lgkmcnt(7)
Ta 156,3,20480
v_mul_f32 v31, v231, v231
v_mul_f32 v32, v232, v232
Mvav 212,132,72
Ta 158,3,22528
v_mul_f32 v33, v233, v233
v_fma_f32 v30, v30, v42, v40
Mvav 220,132,76
Ta 160,4,20480
v_fma_f32 v31, v31, v42, v40
v_fma_f32 v32, v32, v43, v41
Mvav 192,136,80
LD 21,36,76,1024
Ta 162,4,22528
Mvav 200,136,84
s_waitcnt lgkmcnt(7)
Ta 164,5,20480
v_fma_f32 v33, v33, v43, v41
v_mul_f32 v30, v230, v30
Mvav 196,140,80
Ta 166,5,22528
v_mul_f32 v31, v231, v31
v_mul_f32 v32, v232, v32
Mvav 204,140,84
Ta 128,2,24576
v_mul_f32 v33, v233, v33
v_mov_b32 v40, s88
Mvav 208,144,80
Ta 130,2,26624
v_mov_b32 v42, s88
Mvav 216,144,84
s_waitcnt lgkmcnt(7)
Ta 132,3,24576
v_rcp_f32 v26, v26
Mvav 212,148,80
LD 22,36,76,2048
Ta 134,3,26624
Mvav 220,148,84
Ta 136,4,24576
v_rcp_f32 v27, v27
v_mul_f32 v26, v226, v26
Mvav 192,152,88
Ta 138,4,26624
v_rcp_f32 v25, v25
Mvav 200,152,92
s_waitcnt lgkmcnt(7)
Ta 140,5,24576
v_exp_f32 v24, v24
Mvav 196,156,88
Ta 142,5,26624
v_exp_f32 v28, v28
Mvav 204,156,92
s_waitcnt lgkmcnt(5)
Ta 144,2,28672
v_exp_f32 v29, v29
Mvav 208,160,88
LD 23,36,76,3072
Ta 146,2,30720
Mvav 216,160,92
s_add_u32 m0, s67, 0x1d000
s_add_u32 s76, s95, 0x2c0080
Ta 148,3,28672
v_mul_f32 v27, v227, v27
Mvav 212,164,88
Ta 150,3,30720
v_mul_f32 v25, v225, v25
v_fma_f32 v24, v24, v44, v44
Mvav 220,164,92
Ta 152,4,28672
Ta 154,4,30720
Mvav 192,128,96
Ta 156,5,28672
v_fma_f32 v28, v28, v44, v44
Mvav 200,128,100
s_waitcnt lgkmcnt(8)
Ta 158,5,30720
Ta 160,2,32768
Mvav 196,132,96
LD 20,36,76,0
Ta 162,2,34816
v_fma_f32 v29, v29, v44, v44
Mvav 204,132,100
s_add_u32 m0, s67, 0
Ta 164,3,32768
Ta 166,3,34816
Mvav 208,136,96
s_add_u32 s76, s95, 0x100
Ta 128,4,32768
Ta 130,4,34816
Mvav 216,136,100
s_waitcnt lgkmcnt(10)
Ta 132,5,32768
Ta 134,5,34816
Mvav 212,140,96
CV 225,26,27
v_mul_f32 v27, v237, v237
v_rcp_f32 v24, v24
Mvav 220,140,100
v_rcp_f32 v28, v28
v_rcp_f32 v29, v29
Mvav 192,144,104
v_mul_f32 v26, v236, v236
v_fma_f32 v27, v27, v43, v41
Mvav 200,144,108
v_mul_f32 v24, v224, v24
v_mul_f32 v28, v228, v28
v_mul_f32 v29, v229, v29
Mvav 196,148,104
s_waitcnt vmcnt(22) lgkmcnt(0)
s_barrier
v_fma_f32 v26, v26, v43, v41
v_mul_f32 v27, v237, v27
CV 224,24,25
Mvav 204,148,108
CV 226,28,29
v_mul_f32 v26, v236, v26
v_exp_f32 v27, v27
Mvav 208,152,104
v_mul_f32 v24, v234, v234
v_mul_f32 v25, v235, v235
Mvav 216,152,108
v_mul_f32 v28, v238, v238
v_mul_f32 v29, v239, v239
v_exp_f32 v26, v26
Mvav 212,156,104
v_fma_f32 v24, v24, v43, v41
v_fma_f32 v25, v25, v43, v41
v_fma_f32 v28, v28, v43, v41
Mvav 220,156,108
v_fma_f32 v29, v29, v43, v41
v_fma_f32 v27, v27, v45, v45
v_mul_f32 v24, v234, v24
Mvav 192,160,112
v_mul_f32 v25, v235, v25
v_mul_f32 v28, v238, v28
Mvav 200,160,116
v_mul_f32 v29, v239, v29
v_fma_f32 v26, v26, v45, v45
v_rcp_f32 v27, v27
Mvav 196,164,112
v_exp_f32 v30, v30
v_exp_f32 v31, v31
Mvav 204,164,116
v_exp_f32 v32, v32
v_exp_f32 v33, v33
Mvav 208,128,112
v_exp_f32 v24, v24
Mvav 216,128,116
v_exp_f32 v25, v25
v_exp_f32 v28, v28
Mvav 212,132,112
v_exp_f32 v29, v29
v_rcp_f32 v26, v26
Mvav 220,132,116
v_mul_f32 v27, v237, v27
v_and_b32 v229, 15, v1
v_and_b32 v237, 15, v1
v_fma_f32 v30, v30, v44, v44
v_fma_f32 v31, v31, v44, v44
v_fma_f32 v32, v32, v45, v45
v_fma_f32 v33, v33, v45, v45
v_fma_f32 v24, v24, v45, v45
v_fma_f32 v25, v25, v45, v45
v_fma_f32 v28, v28, v45, v45
v_fma_f32 v29, v29, v45, v45
v_mul_f32 v26, v236, v26
v_add_u32 v228, s5, v229
v_add_u32 v236, s6, v237
v_rcp_f32 v30, v30
v_rcp_f32 v31, v31
v_rcp_f32 v32, v32
v_rcp_f32 v33, v33
v_rcp_f32 v24, v24
v_rcp_f32 v25, v25
v_rcp_f32 v28, v28
v_rcp_f32 v29, v29
v_lshrrev_b32 v228, 5, v228
v_lshrrev_b32 v236, 5, v236
v_mul_f32 v30, v230, v30
v_mul_f32 v31, v231, v31
v_mul_f32 v32, v232, v32
v_mul_f32 v33, v233, v33
v_mul_f32 v24, v234, v24
v_mul_f32 v25, v235, v25
v_mul_f32 v28, v238, v28
v_mul_f32 v29, v239, v29
v_mul_u32_u24 v228, 0x8e00, v228
v_mul_u32_u24 v236, 0x8e00, v236
CV 227,30,31
CV 232,32,33
CV 233,24,25
CV 234,26,27
CV 235,28,29
v_add_u32 v228, v228, v6
v_add_u32 v236, v236, v6
s_cmp_eq_u32 s16, 8
s_cbranch_scc1 L_hss1_0
buffer_store_dwordx4 v[224:227], v228, s[40:43], s78 offen sc1
L_hs1_0:
s_cmp_eq_u32 s16, 8
s_cbranch_scc1 L_hss2_0
buffer_store_dwordx4 v[232:235], v236, s[40:43], s79 offen sc1
L_hs2_0:
v_add_u32 v2, 0x9000, v2
v_add_u32 v3, 0x9000, v3
Ta 136,2,0
Ta 138,2,2048
s_waitcnt lgkmcnt(0)
Ta 140,3,0
Ta 142,3,2048
v_add_u32 v4, 0x9000, v4
v_add_u32 v5, 0x9000, v5
v_mov_b32 v24, 0xff800000
v_mov_b32 v25, 0xff800000
v_mov_b32 v26, 0xff800000
v_mov_b32 v27, 0xff800000
v_mov_b32 v41, s88
v_mov_b32 v43, s88
v_mov_b32 v28, 0xff800000
v_mov_b32 v29, 0xff800000
v_mov_b32 v30, 0xff800000
v_mov_b32 v31, 0xff800000
Ta 144,4,0
Ta 146,4,2048
s_add_u32 s5, s101, 0x4000
s_add_u32 s6, s101, 0x5000
s_add_u32 s16, s66, 0
s_and_b32 s16, s16, 7
s_mul_i32 s78, s16, 0x11000
s_add_u32 s78, s78, s13
s_add_u32 s78, s78, 0x8000
Mvav 192,136,120
s_add_u32 s17, s66, 1
Ta 148,5,0
Ta 150,5,2048
Mvav 200,136,124
s_waitcnt lgkmcnt(4)
s_and_b32 s17, s17, 7
Ta 152,2,4096
Ta 154,2,6144
Mvav 196,140,120
LD 20,36,76,0
Ta 156,3,4096
Mvav 204,140,124
s_waitcnt lgkmcnt(5)
s_mul_i32 s79, s17, 0x11000
Ta 158,3,6144
Ta 160,4,4096
Mvav 208,144,120
s_add_u32 s79, s79, s13
Ta 162,4,6144
Ta 164,5,4096
Mvav 216,144,124
s_waitcnt lgkmcnt(7)
s_add_u32 s79, s79, 0x9000
Ta 166,5,6144
Ta 128,2,8192
s_add_u32 s16, s66, 2
s_and_b32 s16, s16, 7
Mvav 212,148,120
s_mul_i32 s77, s100, 0x400
Ta 130,2,10240
Ta 132,3,8192
Mvav 220,148,124
s_waitcnt lgkmcnt(9)
s_mul_i32 s85, s66, 0x100000
Ta 134,3,10240
v_min_u32 v46, 7, v1
Mvav 192,152,128
LD 21,36,76,1024
Ta 136,4,8192
Mvav 200,152,132
s_waitcnt lgkmcnt(9)
s_add_u32 s77, s77, s85
Ta 138,4,10240
v_mul_u32_u24 v46, 0x80, v46
Mvav 196,156,128
s_add_u32 s77, s77, 0x60000
Ta 140,5,8192
Ta 142,5,10240
Mvav 204,156,132
s_waitcnt lgkmcnt(10)
s_mul_i32 s80, s16, 0x11000
Ta 144,2,12288
s_add_u32 s80, s80, s13
Mvav 208,160,128
buffer_load_dword v35, v46, s[48:51], s77 offen
Ta 146,2,14336
Mvav 216,160,132
s_waitcnt lgkmcnt(9)
s_add_u32 s80, s80, 0xa000
Ta 148,3,12288
Mvav 212,164,128
LD 22,36,76,2048
Ta 150,3,14336
Mvav 220,164,132
s_waitcnt lgkmcnt(9)
Ta 152,4,12288
Mvav 192,128,136
Ta 154,4,14336
Mvav 200,128,140
s_waitcnt lgkmcnt(9)
Ta 156,5,12288
Mvav 196,132,136
Ta 158,5,14336
Mvav 204,132,140
s_waitcnt lgkmcnt(8)
Ta 160,2,16384
Mvav 208,136,136
LD 23,36,76,3072
Ta 162,2,18432
s_add_u32 m0, s67, 0x1000
s_add_u32 s76, s95, 0x40100
Mvav 216,136,140
Ta 164,3,16384
Mvav 212,140,136
Ta 166,3,18432
Mvav 220,140,140
s_waitcnt lgkmcnt(8)
Ta 128,4,16384
Mvav 192,144,144
Ta 130,4,18432
Mvav 200,144,148
Ta 132,5,16384
Mvav 196,148,144
LD 20,36,76,0
Ta 134,5,18432
Mvav 204,148,148
s_waitcnt lgkmcnt(8)
Ta 136,2,20480
Mvav 208,152,144
Ta 138,2,22528
Mvav 216,152,148
Ta 140,3,20480
Mvav 212,156,144
Ta 142,3,22528
Mvav 220,156,148
s_waitcnt lgkmcnt(8)
Ta 144,4,20480
Mvav 192,160,152
LD 21,36,76,1024
Ta 146,4,22528
Mvav 200,160,156
Ta 148,5,20480
Mvav 196,164,152
Ta 150,5,22528
Mvav 204,164,156
s_waitcnt lgkmcnt(9)
Ta 152,2,24576
Mvav 208,128,152
Ta 154,2,26624
Mvav 216,128,156
s_waitcnt lgkmcnt(8)
Ta 156,3,24576
Mvav 212,132,152
LD 22,36,76,2048
Ta 158,3,26624
Mvav 220,132,156
Ta 160,4,24576
Mvav 192,136,160
Ta 162,4,26624
Mvav 200,136,164
s_waitcnt lgkmcnt(9)
Ta 164,5,24576
Mvav 196,140,160
Ta 166,5,26624
Mvav 204,140,164
s_waitcnt lgkmcnt(8)
Ta 128,2,28672
Mvav 208,144,160
LD 23,36,76,3072
Ta 130,2,30720
s_add_u32 m0, s67, 0x2000
s_add_u32 s76, s95, 0x80100
Mvav 216,144,164
Ta 132,3,28672
Mvav 212,148,160
Ta 134,3,30720
Mvav 220,148,164
s_waitcnt lgkmcnt(8)
Ta 136,4,28672
Ta 138,4,30720
Mvav 192,152,168
Ta 140,5,28672
Ta 142,5,30720
Mvav 200,152,172
s_waitcnt lgkmcnt(6)
Ta 144,2,32768
Ta 146,2,34816
v_add_u32 v2, 0x9000, v2
Mvav 196,156,168
LD 20,36,76,0
Ta 148,3,32768
Ta 150,3,34816
Mvav 204,156,172
s_add_u32 m0, s67, 0x9000
Ta 152,4,32768
Ta 154,4,34816
Mvav 208,160,168
s_add_u32 s76, s95, 0x240100
Ta 156,5,32768
Ta 158,5,34816
Mvav 216,160,172
v_add_u32 v3, 0x9000, v3
v_add_u32 v4, 0x9000, v4
v_add_u32 v5, 0x9000, v5
Mvav 212,164,168
Mvav 220,164,172
Mvav 192,128,176
Mvav 200,128,180
s_waitcnt lgkmcnt(6)
Mvav 196,132,176
s_waitcnt vmcnt(24) lgkmcnt(0)
s_barrier
Mvav 204,132,180
Ta 160,2,0
Mvav 208,136,176
Ta 162,2,2048
Mvav 216,136,180
s_waitcnt vmcnt(10)
buffer_store_dword v47, off, s[40:43], s9 sc1
Ta 164,3,0
Mvav 212,140,176
s_add_u32 s9, s69, 0x1b000
Ta 166,3,2048
Mvav 220,140,180
Ta 128,4,0
Mvav 192,144,184
Ta 130,4,2048
Mvav 200,144,188
Ta 132,5,0
Mvav 196,148,184
Ta 134,5,2048
s_nop 2
v_mul_f32 v192, v38, v192
v_mul_f32 v193, v38, v193
Mvav 204,148,188
Ta 136,2,4096
Ta 138,2,6144
Mvav 208,152,184
Ta 140,3,4096
v_mul_f32 v194, v38, v194
Mvav 216,152,188
Ta 142,3,6144
v_mul_f32 v195, v38, v195
v_mul_f32 v196, v38, v196
Mvav 212,156,184
Ta 144,4,4096
v_mul_f32 v197, v38, v197
v_mul_f32 v198, v38, v198
Mvav 220,156,188
s_waitcnt lgkmcnt(7)
Ta 146,4,6144
v_mul_f32 v199, v38, v199
CV 192,192,193
v_mfma_f32_16x16x32_bf16 v[224:227], a[160:163], v[48:51], 0
Ta 148,5,4096
CV 193,194,195
v_mfma_f32_16x16x32_bf16 v[232:235], a[160:163], v[52:55], 0
Ta 150,5,6144
CV 194,196,197
v_mfma_f32_16x16x32_bf16 v[228:231], a[164:167], v[48:51], 0
LD 20,36,76,0
Ta 152,2,8192
v_mfma_f32_16x16x32_bf16 v[236:239], a[164:167], v[52:55], 0
Ta 154,2,10240
CV 195,198,199
v_mfma_f32_16x16x32_bf16 v[240:243], a[128:131], v[48:51], 0
Ta 156,3,8192
v_mul_f32 v200, v39, v200
v_mfma_f32_16x16x32_bf16 v[248:251], a[128:131], v[52:55], 0
s_waitcnt lgkmcnt(8)
Ta 158,3,10240
v_mul_f32 v201, v39, v201
v_mfma_f32_16x16x32_bf16 v[244:247], a[132:135], v[48:51], 0
s_mul_i32 s77, s100, 0x400
Ta 160,4,8192
v_min_u32 v46, 7, v1
v_mfma_f32_16x16x32_bf16 v[252:255], a[132:135], v[52:55], 0
s_mul_i32 s85, s66, 0x100000
Ta 162,4,10240
v_mul_u32_u24 v46, 0x80, v46
Mvav 224,136,56
LD 21,36,76,1024
Ta 164,5,8192
Mvav 232,136,60
s_waitcnt lgkmcnt(8)
s_add_u32 s77, s77, s85
Ta 166,5,10240
v_mul_f32 v202, v39, v202
Mvav 228,140,56
s_add_u32 s77, s77, 0x70000
Ta 128,2,12288
v_mul_f32 v203, v39, v203
Mvav 236,140,60
Ta 130,2,14336
v_mul_f32 v204, v39, v204
Mvav 240,144,56
buffer_load_dword v35, v46, s[44:47], s77 offen
Ta 132,3,12288
Mvav 248,144,60
s_waitcnt lgkmcnt(8)
Ta 134,3,14336
v_mul_f32 v205, v39, v205
v_mul_f32 v206, v39, v206
Mvav 244,148,56
LD 22,36,76,2048
Ta 136,4,12288
Mvav 252,148,60
Ta 138,4,14336
v_mul_f32 v207, v39, v207
Mvav 224,152,64
Ta 140,5,12288
CV 200,200,201
Mvav 232,152,68
s_waitcnt lgkmcnt(8)
Ta 142,5,14336
CV 201,202,203
Mvav 228,156,64
Ta 144,2,16384
CV 202,204,205
Mvav 236,156,68
s_waitcnt lgkmcnt(6)
Ta 146,2,18432
CV 203,206,207
Mvav 240,160,64
LD 23,36,76,3072
Ta 148,3,16384
Mvav 248,160,68
s_add_u32 m0, s67, 0xa000
s_add_u32 s76, s95, 0x280100
Ta 150,3,18432
Mvav 244,164,64
Ta 152,4,16384
v_mul_f32 v208, v38, v208
Mvav 252,164,68
Ta 154,4,18432
v_mul_f32 v209, v38, v209
Mvav 224,128,72
Ta 156,5,16384
v_mul_f32 v210, v38, v210
Mvav 232,128,76
s_waitcnt lgkmcnt(8)
Ta 158,5,18432
v_mul_f32 v211, v38, v211
Mvav 228,132,72
LD 20,36,76,0
Ta 160,2,20480
Mvav 236,132,76
Ta 162,2,22528
v_mul_f32 v212, v38, v212
v_mul_f32 v213, v38, v213
Mvav 240,136,72
Ta 164,3,20480
v_mul_f32 v214, v38, v214
Mvav 248,136,76
s_waitcnt lgkmcnt(8)
Ta 166,3,22528
v_mul_f32 v215, v38, v215
Mvav 244,140,72
Ta 128,4,20480
CV 208,208,209
Mvav 252,140,76
Ta 130,4,22528
CV 209,210,211
Mvav 224,144,80
LD 21,36,76,1024
Ta 132,5,20480
Mvav 232,144,84
s_waitcnt lgkmcnt(8)
Ta 134,5,22528
CV 210,212,213
Mvav 228,148,80
Ta 136,2,24576
CV 211,214,215
Mvav 236,148,84
Ta 138,2,26624
v_mul_f32 v216, v39, v216
Mvav 240,152,80
Ta 140,3,24576
v_mul_f32 v217, v39, v217
Mvav 248,152,84
s_waitcnt lgkmcnt(8)
Ta 142,3,26624
v_mul_f32 v218, v39, v218
Mvav 244,156,80
LD 22,36,76,2048
L_pg8_3:
s_cbranch_execz L_ret8
Ta 144,4,24576
Mvav 252,156,84
s_waitcnt lgkmcnt(6)
Ta 146,4,26624
v_mul_f32 v219, v39, v219
v_mul_f32 v220, v39, v220
Mvav 224,160,88
s_and_b32 s85, s30, 31
Ta 148,5,24576
v_and_b32 v46, 32, v1
Mvav 232,160,92
s_lshl_b32 s85, s85, 8
Ta 150,5,26624
v_lshl_add_u32 v46, v46, 2, s85
Mvav 228,164,88
s_getpc_b64 s[96:97]
L_ca3_0:
s_add_u32 s96, s96, L_Amain+0-L_ca3_0
s_addc_u32 s97, s97, 0
Ta 152,2,28672
v_mul_f32 v221, v39, v221
Mvav 236,164,92
global_load_dword v35, v46, s[96:97]
Ta 154,2,30720
Mvav 240,128,88
s_waitcnt lgkmcnt(7)
Ta 156,3,28672
v_mul_f32 v222, v39, v222
Mvav 248,128,92
LD 23,36,76,3072
Ta 158,3,30720
Mvav 244,132,88
s_add_u32 m0, s67, 0xb000
s_add_u32 s76, s95, 0x2c0100
Ta 160,4,28672
Mvav 252,132,92
Ta 162,4,30720
v_mul_f32 v223, v39, v223
Mvav 224,136,96
Ta 164,5,28672
CV 216,216,217
Mvav 232,136,100
s_waitcnt lgkmcnt(8)
Ta 166,5,30720
CV 217,218,219
Mvav 228,140,96
LD 20,36,76,0
Ta 128,2,32768
Mvav 236,140,100
s_add_u32 m0, s67, 0x12000
Ta 130,2,34816
Ta 132,3,32768
Mvav 240,144,96
s_add_u32 s76, s95, 0x180
Ta 134,3,34816
Ta 136,4,32768
Mvav 248,144,100
s_waitcnt lgkmcnt(10)
Ta 138,4,34816
Ta 140,5,32768
Mvav 244,148,96
Ta 142,5,34816
v_add_u32 v2, 0x9000, v2
Mvav 252,148,100
v_add_u32 v3, 0x9000, v3
v_add_u32 v4, 0x9000, v4
Mvav 224,152,104
v_add_u32 v5, 0x9000, v5
CV 218,220,221
Mvav 232,152,108
s_waitcnt lgkmcnt(9)
v_permlane32_swap_b32 v192, v194
Mvav 228,156,104
v_permlane32_swap_b32 v193, v195
Mvav 236,156,108
v_permlane16_swap_b32 v192, v194
Mvav 240,160,104
v_permlane16_swap_b32 v193, v195
Mvav 248,160,108
s_waitcnt lgkmcnt(0)
s_barrier
v_permlane32_swap_b32 v200, v202
Mvav 244,164,104
Ta 144,2,0
v_accvgpr_write_b32 a0, v192
Mvav 252,164,108
Ta 146,2,2048
v_accvgpr_write_b32 a1, v193
Mvav 224,128,112
Ta 148,3,0
v_accvgpr_write_b32 a2, v194
Mvav 232,128,116
Ta 150,3,2048
v_accvgpr_write_b32 a3, v195
Mvav 228,132,112
Ta 152,4,0
Ta 154,4,2048
Mvav 236,132,116
Ta 156,5,0
CV 219,222,223
Mvav 240,136,112
Ta 158,5,2048
Mvav 248,136,116
Ta 160,2,4096
Mvav 244,140,112
Ta 162,2,6144
Mvav 252,140,116
s_waitcnt lgkmcnt(8)
Ta 164,3,4096
Mvav 224,144,120
Ta 166,3,6144
Mvav 232,144,124
s_waitcnt lgkmcnt(8)
Ta 128,4,4096
Mvav 228,148,120
LD 20,36,76,0
Ta 130,4,6144
Mvav 236,148,124
s_waitcnt lgkmcnt(8)
Ta 132,5,4096
Mvav 240,152,120
Ta 134,5,6144
Mvav 248,152,124
s_waitcnt lgkmcnt(8)
Ta 136,2,8192
Mvav 244,156,120
s_mul_i32 s77, s100, 0x400
Ta 138,2,10240
v_min_u32 v46, 7, v1
Mvav 252,156,124
s_waitcnt lgkmcnt(8)
s_mul_i32 s85, s66, 0x100000
Ta 140,3,8192
Ta 142,3,10240
Mvav 224,160,128
LD 21,36,76,1024
Ta 144,4,8192
Mvav 232,160,132
s_waitcnt lgkmcnt(9)
s_add_u32 s77, s77, s85
Ta 146,4,10240
v_mul_u32_u24 v46, 0x80, v46
Mvav 228,164,128
s_add_u32 s77, s77, 0x70000
Ta 148,5,8192
Mvav 236,164,132
s_waitcnt lgkmcnt(9)
Ta 150,5,10240
Mvav 240,128,128
buffer_load_dword v35, v46, s[48:51], s77 offen
Ta 152,2,12288
Mvav 248,128,132
s_waitcnt lgkmcnt(9)
Ta 154,2,14336
Mvav 244,132,128
LD 22,36,76,2048
Ta 156,3,12288
Mvav 252,132,132
s_waitcnt lgkmcnt(9)
Ta 158,3,14336
Mvav 224,136,136
Ta 160,4,12288
Mvav 232,136,140
s_waitcnt lgkmcnt(9)
Ta 162,4,14336
Mvav 228,140,136
Ta 164,5,12288
Mvav 236,140,140
s_waitcnt lgkmcnt(8)
Ta 166,5,14336
Mvav 240,144,136
LD 23,36,76,3072
Ta 128,2,16384
Mvav 248,144,140
s_waitcnt lgkmcnt(9)
s_add_u32 m0, s67, 0x13000
s_add_u32 s76, s95, 0x40180
Ta 130,2,18432
Mvav 244,148,136
Ta 132,3,16384
Ta 134,3,18432
Mvav 252,148,140
s_waitcnt lgkmcnt(9)
Ta 136,4,16384
Mvav 224,152,144
Ta 138,4,18432
Mvav 232,152,148
s_waitcnt lgkmcnt(9)
Ta 140,5,16384
Mvav 228,156,144
LD 20,36,76,0
Ta 142,5,18432
Mvav 236,156,148
s_waitcnt lgkmcnt(9)
Ta 144,2,20480
Mvav 240,160,144
Ta 146,2,22528
Mvav 248,160,148
s_waitcnt lgkmcnt(9)
Ta 148,3,20480
Mvav 244,164,144
Ta 150,3,22528
Mvav 252,164,148
s_waitcnt lgkmcnt(8)
Ta 152,4,20480
Mvav 224,128,152
LD 21,36,76,1024
Ta 154,4,22528
Mvav 232,128,156
Ta 156,5,20480
Mvav 228,132,152
Ta 158,5,22528
v_permlane32_swap_b32 v201, v203
Mvav 236,132,156
s_waitcnt lgkmcnt(8)
Ta 160,2,24576
Mvav 240,136,152
Ta 162,2,26624
Mvav 248,136,156
Ta 164,3,24576
Mvav 244,140,152
LD 22,36,76,2048
Ta 166,3,26624
Mvav 252,140,156
s_waitcnt lgkmcnt(8)
Ta 128,4,24576
Mvav 224,144,160
Ta 130,4,26624
Mvav 232,144,164
Ta 132,5,24576
Mvav 228,148,160
Ta 134,5,26624
Mvav 236,148,164
s_waitcnt lgkmcnt(8)
Ta 136,2,28672
Mvav 240,152,160
LD 23,36,76,3072
Ta 138,2,30720
Mvav 248,152,164
s_add_u32 m0, s67, 0x14000
s_add_u32 s76, s95, 0x80180
Ta 140,3,28672
Mvav 244,156,160
Ta 142,3,30720
Mvav 252,156,164
s_waitcnt lgkmcnt(8)
Ta 144,4,28672
Ta 146,4,30720
Mvav 224,160,168
Ta 148,5,28672
Mvav 232,160,172
s_waitcnt lgkmcnt(7)
Ta 150,5,30720
Mvav 228,164,168
LD 20,36,76,0
Ta 152,2,32768
Mvav 236,164,172
s_add_u32 m0, s67, 0x1b000
Ta 154,2,34816
Ta 156,3,32768
Mvav 240,128,168
s_add_u32 s76, s95, 0x240180
Ta 158,3,34816
Ta 160,4,32768
Mvav 248,128,172
Ta 162,4,34816
Ta 164,5,32768
Mvav 244,132,168
Ta 166,5,34816
v_add_u32 v2, 0xfffe5000, v2
Mvav 252,132,172
s_waitcnt lgkmcnt(11)
v_permlane16_swap_b32 v200, v202
Mvav 224,136,176
v_permlane16_swap_b32 v201, v203
Mvav 232,136,180
v_permlane32_swap_b32 v208, v210
Mvav 228,140,176
v_permlane32_swap_b32 v209, v211
Mvav 236,140,180
s_waitcnt lgkmcnt(7)
v_permlane16_swap_b32 v208, v210
Mvav 240,144,176
v_permlane16_swap_b32 v209, v211
Mvav 248,144,180
s_waitcnt vmcnt(22) lgkmcnt(0)
s_barrier
v_permlane32_swap_b32 v216, v218
v_add_u32 v3, 0xfffe5000, v3
Mvav 244,148,176
Ta 128,2,0
v_add_u32 v4, 0xfffe5000, v4
Mvav 252,148,180
Ta 130,2,2048
v_add_u32 v5, 0xfffe5000, v5
Mvav 224,152,184
Ta 132,3,0
v_accvgpr_write_b32 a4, v200
Mvav 232,152,188
Ta 134,3,2048
v_accvgpr_write_b32 a5, v201
Mvav 228,156,184
Ta 136,4,0
v_accvgpr_write_b32 a6, v202
Mvav 236,156,188
Ta 138,4,2048
v_accvgpr_write_b32 a7, v203
Mvav 240,160,184
Ta 140,5,0
v_accvgpr_write_b32 a8, v208
Mvav 248,160,188
Ta 142,5,2048
v_accvgpr_write_b32 a9, v209
Mvav 244,164,184
Ta 144,2,4096
v_accvgpr_write_b32 a10, v210
Mvav 252,164,188
s_waitcnt lgkmcnt(7)
Ta 146,2,6144
v_accvgpr_write_b32 a11, v211
v_mfma_f32_16x16x32_bf16 v[192:195], a[128:131], v[48:51], 0
Ta 148,3,4096
v_mul_f32 v224, v38, v224
v_mfma_f32_16x16x32_bf16 v[200:203], a[128:131], v[52:55], 0
s_waitcnt lgkmcnt(7)
Ta 150,3,6144
v_mul_f32 v225, v38, v225
v_mfma_f32_16x16x32_bf16 v[196:199], a[132:135], v[48:51], 0
LD 20,36,76,0
Ta 152,4,4096
v_permlane32_swap_b32 v217, v219
v_mfma_f32_16x16x32_bf16 v[204:207], a[132:135], v[52:55], 0
s_waitcnt lgkmcnt(7)
Ta 154,4,6144
v_permlane16_swap_b32 v216, v218
v_mfma_f32_16x16x32_bf16 v[208:211], a[136:139], v[48:51], 0
v_permlane16_swap_b32 v217, v219
v_accvgpr_write_b32 a12, v216
v_accvgpr_write_b32 a14, v218
v_accvgpr_write_b32 a13, v217
v_accvgpr_write_b32 a15, v219
v_mfma_f32_16x16x32_bf16 v[216:219], a[136:139], v[52:55], 0
s_waitcnt lgkmcnt(5)
Ta 156,5,4096
v_mul_f32 v226, v38, v226
v_mfma_f32_16x16x32_bf16 v[212:215], a[140:143], v[48:51], 0
Ta 158,5,6144
v_mul_f32 v227, v38, v227
v_mfma_f32_16x16x32_bf16 v[220:223], a[140:143], v[52:55], 0
s_waitcnt lgkmcnt(5)
Ta 160,2,8192
v_mul_f32 v228, v38, v228
Mvav 192,144,56
LD 21,36,76,1024
Ta 162,2,10240
Mvav 200,144,60
s_waitcnt lgkmcnt(6)
Ta 164,3,8192
v_mul_f32 v229, v38, v229
Mvav 196,148,56
Ta 166,3,10240
v_mul_f32 v230, v38, v230
Mvav 204,148,60
s_waitcnt lgkmcnt(6)
Ta 128,4,8192
v_mul_f32 v231, v38, v231
Mvav 208,152,56
Ta 130,4,10240
CV 224,224,225
Mvav 216,152,60
s_waitcnt lgkmcnt(6)
Ta 132,5,8192
CV 225,226,227
Mvav 212,156,56
LD 22,36,76,2048
Ta 134,5,10240
Mvav 220,156,60
s_waitcnt lgkmcnt(6)
Ta 136,2,12288
Ta 138,2,14336
Mvav 192,160,64
Ta 140,3,12288
CV 226,228,229
Mvav 200,160,68
s_waitcnt lgkmcnt(7)
Ta 142,3,14336
CV 227,230,231
Mvav 196,164,64
Ta 144,4,12288
v_mul_f32 v232, v39, v232
Mvav 204,164,68
s_waitcnt lgkmcnt(7)
Ta 146,4,14336
v_mul_f32 v233, v39, v233
Mvav 208,128,64
LD 23,36,76,3072
Ta 148,5,12288
Mvav 216,128,68
s_waitcnt lgkmcnt(7)
s_add_u32 m0, s67, 0x1c000
s_add_u32 s76, s95, 0x280180
Ta 150,5,14336
Mvav 212,132,64
Ta 152,2,16384
v_mul_f32 v234, v39, v234
Mvav 220,132,68
s_waitcnt lgkmcnt(7)
Ta 154,2,18432
v_mul_f32 v235, v39, v235
Mvav 192,136,72
Ta 156,3,16384
v_mul_f32 v236, v39, v236
Mvav 200,136,76
s_waitcnt lgkmcnt(7)
Ta 158,3,18432
v_mul_f32 v237, v39, v237
Mvav 196,140,72
LD 20,36,76,0
Ta 160,4,16384
Mvav 204,140,76
s_waitcnt lgkmcnt(7)
Ta 162,4,18432
v_mul_f32 v238, v39, v238
Mvav 208,144,72
Ta 164,5,16384
v_mul_f32 v239, v39, v239
Mvav 216,144,76
s_waitcnt lgkmcnt(7)
Ta 166,5,18432
Ta 128,2,20480
Mvav 212,148,72
Ta 130,2,22528
CV 232,232,233
Mvav 220,148,76
s_waitcnt lgkmcnt(8)
Ta 132,3,20480
CV 233,234,235
Mvav 192,152,80
LD 21,36,76,1024
Ta 134,3,22528
Mvav 200,152,84
s_waitcnt lgkmcnt(8)
Ta 136,4,20480
CV 234,236,237
Mvav 196,156,80
Ta 138,4,22528
CV 235,238,239
Mvav 204,156,84
s_waitcnt lgkmcnt(8)
Ta 140,5,20480
v_mul_f32 v240, v38, v240
Mvav 208,160,80
Ta 142,5,22528
v_mul_f32 v241, v38, v241
Mvav 216,160,84
s_waitcnt lgkmcnt(8)
Ta 144,2,24576
v_mul_f32 v242, v38, v242
Mvav 212,164,80
LD 22,36,76,2048
Ta 146,2,26624
Mvav 220,164,84
s_waitcnt lgkmcnt(8)
Ta 148,3,24576
v_mul_f32 v243, v38, v243
Mvav 192,128,88
s_and_b32 s85, s30, 31
Ta 150,3,26624
v_and_b32 v46, 32, v1
Mvav 200,128,92
s_waitcnt lgkmcnt(8)
s_lshl_b32 s85, s85, 8
Ta 152,4,24576
v_lshl_add_u32 v46, v46, 2, s85
Mvav 196,132,88
s_getpc_b64 s[96:97]
L_ca4_0:
s_add_u32 s96, s96, L_Amain+8192-L_ca4_0
s_addc_u32 s97, s97, 0
Ta 154,4,26624
Ta 156,5,24576
Mvav 204,132,92
s_waitcnt lgkmcnt(9)
global_load_dword v35, v46, s[96:97]
Ta 158,5,26624
Mvav 208,136,88
s_waitcnt lgkmcnt(8)
Ta 160,2,28672
v_mul_f32 v244, v38, v244
Mvav 216,136,92
LD 23,36,76,3072
Ta 162,2,30720
Mvav 212,140,88
s_add_u32 m0, s67, 0x1d000
s_add_u32 s76, s95, 0x2c0180
Ta 164,3,28672
Mvav 220,140,92
s_waitcnt lgkmcnt(9)
Ta 166,3,30720
v_mul_f32 v245, v38, v245
Mvav 192,144,96
Ta 128,4,28672
v_mul_f32 v246, v38, v246
Mvav 200,144,100
s_waitcnt lgkmcnt(9)
Ta 130,4,30720
v_mul_f32 v247, v38, v247
Mvav 196,148,96
LD 20,36,76,0
Ta 132,5,28672
Mvav 204,148,100
s_waitcnt lgkmcnt(8)
s_add_u32 m0, s69, 0
Ta 134,5,30720
Ta 136,2,32768
Mvav 208,152,96
s_add_u32 s76, s71, 0x60000
Ta 138,2,34816
Ta 140,3,32768
Mvav 216,152,100
s_waitcnt lgkmcnt(10)
Ta 142,3,34816
Ta 144,4,32768
Mvav 212,156,96
Ta 146,4,34816
Ta 148,5,32768
Mvav 220,156,100
s_waitcnt lgkmcnt(11)
Ta 150,5,34816
v_add_u32 v2, 0x9000, v2
v_add_u32 v3, 0x9000, v3
Mvav 192,160,104
v_add_u32 v4, 0x9000, v4
v_add_u32 v5, 0x9000, v5
Mvav 200,160,108
v_permlane32_swap_b32 v224, v226
Mvav 196,164,104
v_permlane32_swap_b32 v225, v227
Mvav 204,164,108
s_waitcnt lgkmcnt(7)
v_permlane16_swap_b32 v224, v226
Mvav 208,128,104
v_permlane16_swap_b32 v225, v227
Mvav 216,128,108
s_waitcnt vmcnt(20) lgkmcnt(0)
s_barrier
v_permlane32_swap_b32 v232, v234
Mvav 212,132,104
Ta 152,2,0
v_accvgpr_write_b32 a16, v224
Mvav 220,132,108
Ta 154,2,2048
v_accvgpr_write_b32 a17, v225
Mvav 192,136,112
Ta 156,3,0
v_accvgpr_write_b32 a18, v226
Mvav 200,136,116
Ta 158,3,2048
v_accvgpr_write_b32 a19, v227
Mvav 196,140,112
Ta 160,4,0
CV 240,240,241
Mvav 204,140,116
Ta 162,4,2048
CV 241,242,243
Mvav 208,144,112
Ta 164,5,0
CV 242,244,245
Mvav 216,144,116
Ta 166,5,2048
Ta 128,2,4096
Mvav 212,148,112
Ta 130,2,6144
CV 243,246,247
Mvav 220,148,116
s_waitcnt lgkmcnt(8)
Ta 132,3,4096
v_mul_f32 v248, v39, v248
L_pg8_4:
s_cbranch_execz L_ret8
Mvav 192,152,120
Ta 134,3,6144
v_mul_f32 v249, v39, v249
Mvav 200,152,124
s_waitcnt lgkmcnt(8)
Ta 136,4,4096
v_mul_f32 v250, v39, v250
Mvav 196,156,120
LD 12,44,76,0
Ta 138,4,6144
Mvav 204,156,124
s_waitcnt lgkmcnt(8)
Ta 140,5,4096
v_mul_f32 v251, v39, v251
Mvav 208,160,120
Ta 142,5,6144
v_mul_f32 v252, v39, v252
Mvav 216,160,124
s_waitcnt lgkmcnt(8)
Ta 144,2,8192
v_mul_f32 v253, v39, v253
Mvav 212,164,120
Ta 146,2,10240
v_mul_f32 v254, v39, v254
Mvav 220,164,124
s_waitcnt lgkmcnt(8)
Ta 148,3,8192
v_mul_f32 v255, v39, v255
Mvav 192,128,128
Ta 150,3,10240
CV 248,248,249
Mvav 200,128,132
s_waitcnt lgkmcnt(8)
Ta 152,4,8192
CV 249,250,251
Mvav 196,132,128
Ta 154,4,10240
Ta 156,5,8192
Mvav 204,132,132
s_waitcnt lgkmcnt(9)
Ta 158,5,10240
CV 250,252,253
Mvav 208,136,128
Ta 160,2,12288
CV 251,254,255
Mvav 216,136,132
s_waitcnt lgkmcnt(9)
Ta 162,2,14336
v_and_b32 v20, 15, v1
Mvav 212,140,128
LD 13,44,76,1024
Ta 164,3,12288
Mvav 220,140,132
s_waitcnt lgkmcnt(9)
Ta 166,3,14336
v_lshrrev_b32 v21, 4, v1
Mvav 192,144,136
Ta 128,4,12288
v_xor_b32 v21, v21, v20
Mvav 200,144,140
s_waitcnt lgkmcnt(9)
Ta 130,4,14336
v_lshlrev_b32 v20, 8, v20
Mvav 196,148,136
Ta 132,5,12288
v_lshl_add_u32 v20, v21, 4, v20
Mvav 204,148,140
s_waitcnt lgkmcnt(8)
Ta 134,5,14336
v_xor_b32 v21, 64, v20
Mvav 208,152,136
Ta 136,2,16384
v_xor_b32 v22, 0x80, v20
Mvav 216,152,140
s_waitcnt lgkmcnt(8)
Ta 138,2,18432
v_xor_b32 v23, 0xc0, v20
Mvav 212,156,136
Ta 140,3,16384
Mvav 220,156,140
s_waitcnt lgkmcnt(8)
Ta 142,3,18432
Ta 144,4,16384
Mvav 192,160,144
Ta 146,4,18432
Mvav 200,160,148
s_waitcnt lgkmcnt(9)
Ta 148,5,16384
Mvav 196,164,144
Ta 150,5,18432
Mvav 204,164,148
s_waitcnt lgkmcnt(9)
Ta 152,2,20480
Mvav 208,128,144
LD 14,44,76,2048
Ta 154,2,22528
Mvav 216,128,148
s_waitcnt lgkmcnt(9)
Ta 156,3,20480
Mvav 212,132,144
Ta 158,3,22528
Mvav 220,132,148
s_waitcnt lgkmcnt(9)
Ta 160,4,20480
Mvav 192,136,152
Ta 162,4,22528
Mvav 200,136,156
s_waitcnt lgkmcnt(8)
Ta 164,5,20480
Mvav 196,140,152
Ta 166,5,22528
Mvav 204,140,156
Ta 128,2,24576
Mvav 208,144,152
Ta 130,2,26624
Mvav 216,144,156
s_waitcnt lgkmcnt(8)
Ta 132,3,24576
Ta 134,3,26624
Mvav 212,148,152
Ta 136,4,24576
Mvav 220,148,156
Ta 138,4,26624
Mvav 192,152,160
Ta 140,5,24576
Mvav 200,152,164
s_waitcnt lgkmcnt(9)
Ta 142,5,26624
Mvav 196,156,160
LD 15,44,76,3072
Ta 144,2,28672
Mvav 204,156,164
s_add_u32 m0, s69, 0x9000
Ta 146,2,30720
s_add_u32 s76, s71, 0x64000
Mvav 208,160,160
Ta 148,3,28672
Mvav 216,160,164
s_waitcnt lgkmcnt(9)
Ta 150,3,30720
Mvav 212,164,160
Ta 152,4,28672
Mvav 220,164,164
Ta 154,4,30720
Mvav 192,128,168
Ta 156,5,28672
Mvav 200,128,172
s_waitcnt lgkmcnt(8)
Ta 158,5,30720
Mvav 196,132,168
Ta 160,2,32768
Ta 162,2,34816
Mvav 204,132,172
Ta 164,3,32768
Ta 166,3,34816
Mvav 208,136,168
Ta 128,4,32768
Ta 130,4,34816
Mvav 216,136,172
s_waitcnt lgkmcnt(10)
Ta 132,5,32768
Ta 134,5,34816
Mvav 212,140,168
v_permlane32_swap_b32 v233, v235
Mvav 220,140,172
v_permlane16_swap_b32 v232, v234
Mvav 192,144,176
v_permlane16_swap_b32 v233, v235
Mvav 200,144,180
v_permlane32_swap_b32 v240, v242
Mvav 196,148,176
v_permlane32_swap_b32 v241, v243
Mvav 204,148,180
s_waitcnt lgkmcnt(6)
v_permlane16_swap_b32 v240, v242
Mvav 208,152,176
s_waitcnt vmcnt(14) lgkmcnt(0)
s_barrier
v_permlane16_swap_b32 v241, v243
Mvav 216,152,180
v_permlane32_swap_b32 v248, v250
Mvav 212,156,176
v_permlane32_swap_b32 v249, v251
Mvav 220,156,180
v_permlane16_swap_b32 v248, v250
v_add_u32 v2, 0x9000, v2
Mvav 192,160,184
Ta 136,2,0
Ta 138,2,2048
Mvav 200,160,188
Ta 152,2,4096
v_add_u32 v3, 0x9000, v3
Mvav 196,164,184
Ta 140,3,0
Ta 142,3,2048
Mvav 204,164,188
Ta 154,2,6144
v_add_u32 v4, 0x9000, v4
Mvav 208,128,184
Ta 144,4,0
Ta 146,4,2048
Mvav 216,128,188
Ta 156,3,4096
v_add_u32 v5, 0x9000, v5
Mvav 212,132,184
Ta 148,5,0
v_accvgpr_write_b32 a20, v232
Mvav 220,132,188
s_waitcnt lgkmcnt(8)
Ta 150,5,2048
v_accvgpr_write_b32 a21, v233
v_mfma_f32_16x16x32_bf16 v[224:227], a[136:139], v[48:51], 0
v_accvgpr_write_b32 a22, v234
v_accvgpr_write_b32 a23, v235
v_mfma_f32_16x16x32_bf16 v[232:235], a[136:139], v[52:55], 0
s_waitcnt lgkmcnt(6)
Ta 158,3,6144
v_accvgpr_write_b32 a24, v240
v_mfma_f32_16x16x32_bf16 v[228:231], a[140:143], v[48:51], 0
LD 12,44,76,0
Ta 160,4,4096
v_mfma_f32_16x16x32_bf16 v[236:239], a[140:143], v[52:55], 0
s_waitcnt lgkmcnt(5)
v_accvgpr_write_b32 a25, v241
v_accvgpr_write_b32 a26, v242
v_accvgpr_write_b32 a27, v243
v_mfma_f32_16x16x32_bf16 v[240:243], a[144:147], v[48:51], 0
v_permlane16_swap_b32 v249, v251
v_accvgpr_write_b32 a28, v248
v_accvgpr_write_b32 a30, v250
v_accvgpr_write_b32 a29, v249
v_accvgpr_write_b32 a31, v251
v_mfma_f32_16x16x32_bf16 v[248:251], a[144:147], v[52:55], 0
s_waitcnt lgkmcnt(2)
Ta 162,4,6144
Ta 164,5,4096
v_mfma_f32_16x16x32_bf16 v[244:247], a[148:151], v[48:51], 0
Ta 166,5,6144
v_mul_f32 v192, v38, v192
v_mfma_f32_16x16x32_bf16 v[252:255], a[148:151], v[52:55], 0
Ta 128,2,8192
v_mul_f32 v193, v38, v193
Mvav 224,152,56
LD 13,44,76,1024
Ta 130,2,10240
Mvav 232,152,60
s_waitcnt lgkmcnt(6)
Ta 132,3,8192
v_mul_f32 v200, v39, v200
Mvav 228,156,56
Ta 134,3,10240
v_mul_f32 v201, v39, v201
Mvav 236,156,60
s_waitcnt lgkmcnt(6)
Ta 136,4,8192
Ta 138,4,10240
Mvav 240,160,56
Ta 140,5,8192
v_mul_f32 v208, v38, v208
Mvav 248,160,60
s_waitcnt lgkmcnt(7)
Ta 142,5,10240
v_mul_f32 v209, v38, v209
Mvav 244,164,56
LD 14,44,76,2048
Ta 144,2,12288
Mvav 252,164,60
s_waitcnt lgkmcnt(7)
Ta 146,2,14336
v_mul_f32 v216, v39, v216
Mvav 224,128,64
Ta 148,3,12288
v_mul_f32 v217, v39, v217
Mvav 232,128,68
s_waitcnt lgkmcnt(7)
Ta 150,3,14336
v_mul_f32 v194, v38, v194
Mvav 228,132,64
Ta 152,4,12288
Ta 154,4,14336
Mvav 236,132,68
s_waitcnt lgkmcnt(8)
Ta 156,5,12288
v_mul_f32 v195, v38, v195
Mvav 240,136,64
Ta 158,5,14336
v_mul_f32 v202, v39, v202
Mvav 248,136,68
s_waitcnt lgkmcnt(8)
Ta 160,2,16384
v_mul_f32 v203, v39, v203
Mvav 244,140,64
LD 15,44,76,3072
Ta 162,2,18432
Mvav 252,140,68
s_waitcnt lgkmcnt(8)
s_add_u32 m0, s69, 0xd000
s_add_u32 s76, s73, 0x60000
Ta 164,3,16384
Mvav 224,144,72
Ta 166,3,18432
v_mul_f32 v210, v38, v210
Mvav 232,144,76
s_waitcnt lgkmcnt(8)
Ta 128,4,16384
v_mul_f32 v211, v38, v211
Mvav 228,148,72
Ta 130,4,18432
v_mul_f32 v218, v39, v218
Mvav 236,148,76
s_waitcnt lgkmcnt(8)
Ta 132,5,16384
v_mul_f32 v219, v39, v219
Mvav 240,152,72
LD 16,48,76,0
Ta 134,5,18432
Mvav 248,152,76
s_waitcnt lgkmcnt(8)
Ta 136,2,20480
v_mul_f32 v196, v38, v196
Mvav 244,156,72
Ta 138,2,22528
v_mul_f32 v197, v38, v197
Mvav 252,156,76
s_waitcnt lgkmcnt(8)
Ta 140,3,20480
Ta 142,3,22528
Mvav 224,160,80
Ta 144,4,20480
v_mul_f32 v198, v38, v198
Mvav 232,160,84
s_waitcnt lgkmcnt(9)
Ta 146,4,22528
v_mul_f32 v199, v38, v199
Mvav 228,164,80
LD 17,48,76,1024
Ta 148,5,20480
Mvav 236,164,84
s_waitcnt lgkmcnt(9)
Ta 150,5,22528
CV 192,192,193
Mvav 240,128,80
Ta 152,2,24576
v_mul_f32 v204, v39, v204
Mvav 248,128,84
s_waitcnt lgkmcnt(9)
Ta 154,2,26624
v_mul_f32 v205, v39, v205
Mvav 244,132,80
Ta 156,3,24576
v_mul_f32 v206, v39, v206
Mvav 252,132,84
s_waitcnt lgkmcnt(9)
Ta 158,3,26624
v_mul_f32 v207, v39, v207
Mvav 224,136,88
s_and_b32 s85, s30, 31
Ta 160,4,24576
v_and_b32 v46, 32, v1
Mvav 232,136,92
s_waitcnt lgkmcnt(8)
s_lshl_b32 s85, s85, 8
Ta 162,4,26624
v_lshl_add_u32 v46, v46, 2, s85
Mvav 228,140,88
LD 18,48,76,2048
Ta 164,5,24576
Mvav 236,140,92
s_waitcnt lgkmcnt(9)
s_getpc_b64 s[96:97]
L_ca5_0:
s_add_u32 s96, s96, L_Amain+16384-L_ca5_0
s_addc_u32 s97, s97, 0
Ta 166,5,26624
CV 200,200,201
Mvav 240,144,88
Ta 128,2,28672
v_mul_f32 v212, v38, v212
Mvav 248,144,92
s_waitcnt lgkmcnt(8)
Ta 130,2,30720
Ta 132,3,28672
Mvav 244,148,88
global_load_dword v35, v46, s[96:97]
Ta 134,3,30720
Mvav 252,148,92
s_waitcnt lgkmcnt(9)
Ta 136,4,28672
v_mul_f32 v213, v38, v213
Mvav 224,152,96
LD 19,48,76,3072
Ta 138,4,30720
Mvav 232,152,100
s_waitcnt lgkmcnt(9)
s_add_u32 m0, s69, 0x12000
Ta 140,5,28672
v_mul_f32 v214, v38, v214
Mvav 228,156,96
s_add_u32 s76, s71, 0x68000
Ta 142,5,30720
v_mul_f32 v215, v38, v215
Mvav 236,156,100
s_waitcnt lgkmcnt(9)
Ta 144,2,32768
Ta 146,2,34816
Mvav 240,160,96
Ta 148,3,32768
Ta 150,3,34816
Mvav 248,160,100
s_waitcnt lgkmcnt(10)
Ta 152,4,32768
Ta 154,4,34816
Mvav 244,164,96
Ta 156,5,32768
Ta 158,5,34816
Mvav 252,164,100
v_add_u32 v2, 0x9000, v2
v_add_u32 v3, 0x9000, v3
Mvav 224,128,104
v_add_u32 v4, 0x9000, v4
v_add_u32 v5, 0x9000, v5
Mvav 232,128,108
s_waitcnt lgkmcnt(9)
CV 208,208,209
v_mul_f32 v220, v39, v220
Mvav 228,132,104
v_mul_f32 v221, v39, v221
v_mul_f32 v222, v39, v222
v_mul_f32 v223, v39, v223
Mvav 236,132,108
CV 216,216,217
CV 193,194,195
Mvav 240,136,104
s_waitcnt vmcnt(13) lgkmcnt(0)
s_barrier
CV 201,202,203
CV 209,210,211
Mvav 248,136,108
Ta 160,2,0
CV 217,218,219
Mvav 244,140,104
Ta 162,2,2048
CV 194,196,197
Mvav 252,140,108
Ta 164,3,0
CV 195,198,199
Mvav 224,144,112
Ta 166,3,2048
CV 202,204,205
Mvav 232,144,116
Ta 128,4,0
CV 203,206,207
Mvav 228,148,112
Ta 130,4,2048
CV 210,212,213
Mvav 236,148,116
Ta 132,5,0
CV 211,214,215
Mvav 240,152,112
Ta 134,5,2048
CV 218,220,221
Mvav 248,152,116
Ta 136,2,4096
CV 219,222,223
Mvav 244,156,112
Ta 138,2,6144
Mvav 252,156,116
s_waitcnt lgkmcnt(8)
Ta 140,3,4096
Ta 142,3,6144
Mvav 224,160,120
Ta 144,4,4096
Mvav 232,160,124
s_waitcnt lgkmcnt(9)
Ta 146,4,6144
Mvav 228,164,120
LD 12,44,76,0
Ta 148,5,4096
Mvav 236,164,124
s_waitcnt lgkmcnt(9)
Ta 150,5,6144
Mvav 240,128,120
Ta 152,2,8192
Mvav 248,128,124
s_waitcnt lgkmcnt(9)
Ta 154,2,10240
Mvav 244,132,120
Ta 156,3,8192
Mvav 252,132,124
s_waitcnt lgkmcnt(9)
Ta 158,3,10240
Mvav 224,136,128
LD 13,44,76,1024
Ta 160,4,8192
Mvav 232,136,132
s_waitcnt lgkmcnt(8)
Ta 162,4,10240
Mvav 228,140,128
Ta 164,5,8192
Mvav 236,140,132
s_waitcnt lgkmcnt(9)
Ta 166,5,10240
Mvav 240,144,128
Ta 128,2,12288
Mvav 248,144,132
s_waitcnt lgkmcnt(8)
Ta 130,2,14336
Ta 132,3,12288
Mvav 244,148,128
LD 14,44,76,2048
Ta 134,3,14336
Mvav 252,148,132
s_waitcnt lgkmcnt(9)
Ta 136,4,12288
Mvav 224,152,136
Ta 138,4,14336
Mvav 232,152,140
s_waitcnt lgkmcnt(9)
Ta 140,5,12288
Mvav 228,156,136
Ta 142,5,14336
Mvav 236,156,140
s_waitcnt lgkmcnt(9)
Ta 144,2,16384
Mvav 240,160,136
Ta 146,2,18432
Mvav 248,160,140
s_waitcnt lgkmcnt(9)
Ta 148,3,16384
Mvav 244,164,136
LD 15,44,76,3072
Ta 150,3,18432
Mvav 252,164,140
s_waitcnt lgkmcnt(9)
s_add_u32 m0, s69, 0x16000
s_add_u32 s76, s73, 0x64000
Ta 152,4,16384
Mvav 224,128,144
Ta 154,4,18432
Mvav 232,128,148
s_waitcnt lgkmcnt(8)
Ta 156,5,16384
Mvav 228,132,144
Ta 158,5,18432
v_permlane32_swap_b32 v192, v194
Mvav 236,132,148
Ta 160,2,20480
Mvav 240,136,144
LD 16,48,76,0
Ta 162,2,22528
Mvav 248,136,148
s_waitcnt lgkmcnt(8)
Ta 164,3,20480
Mvav 244,140,144
Ta 166,3,22528
Mvav 252,140,148
Ta 128,4,20480
Mvav 224,144,152
Ta 130,4,22528
Mvav 232,144,156
s_waitcnt lgkmcnt(8)
Ta 132,5,20480
Mvav 228,148,152
LD 17,48,76,1024
Ta 134,5,22528
Mvav 236,148,156
Ta 136,2,24576
Mvav 240,152,152
Ta 138,2,26624
Mvav 248,152,156
s_waitcnt lgkmcnt(9)
Ta 140,3,24576
Mvav 244,156,152
Ta 142,3,26624
Mvav 252,156,156
s_waitcnt lgkmcnt(8)
Ta 144,4,24576
Ta 146,4,26624
Mvav 224,160,160
Ta 148,5,24576
L_pg9_5:
s_cbranch_execz L_ret9
Mvav 232,160,164
Ta 150,5,26624
Mvav 228,164,160
LD 18,48,76,2048
Ta 152,2,28672
Mvav 236,164,164
s_waitcnt lgkmcnt(9)
Ta 154,2,30720
Mvav 240,128,160
Ta 156,3,28672
Mvav 248,128,164
Ta 158,3,30720
Mvav 244,132,160
Ta 160,4,28672
Mvav 252,132,164
s_waitcnt lgkmcnt(9)
Ta 162,4,30720
Mvav 224,136,168
LD 19,48,76,3072
Ta 164,5,28672
Mvav 232,136,172
s_add_u32 m0, s69, 0x1b000
Ta 166,5,30720
s_add_u32 s76, s71, 0x6c000
Mvav 228,140,168
Ta 128,2,32768
Mvav 236,140,172
s_waitcnt lgkmcnt(8)
Ta 130,2,34816
Ta 132,3,32768
Mvav 240,144,168
Ta 134,3,34816
Ta 136,4,32768
Mvav 248,144,172
Ta 138,4,34816
Ta 140,5,32768
Mvav 244,148,168
Ta 142,5,34816
v_add_u32 v2, 0xfffe5000, v2
Mvav 252,148,172
s_waitcnt lgkmcnt(11)
v_permlane32_swap_b32 v193, v195
Mvav 224,152,176
v_permlane32_swap_b32 v200, v202
Mvav 232,152,180
v_permlane32_swap_b32 v201, v203
Mvav 228,156,176
v_permlane32_swap_b32 v208, v210
Mvav 236,156,180
s_waitcnt lgkmcnt(7)
v_permlane32_swap_b32 v209, v211
Mvav 240,160,176
v_permlane32_swap_b32 v216, v218
Mvav 248,160,180
s_waitcnt vmcnt(17) lgkmcnt(0)
s_barrier
v_permlane32_swap_b32 v217, v219
Mvav 244,164,176
ds_read_b128 a[144:147], v20 offset:4096
v_lshrrev_b32 v172, 3, v1
Mvav 252,164,180
ds_read_b128 a[148:151], v21 offset:4096
v_and_b32 v173, 6, v172
Mvav 224,128,184
ds_read_b128 a[152:155], v22 offset:4096
v_xor_b32 v8, v8, v173
Mvav 232,128,188
ds_read_b128 a[128:131], v20
v_mul_u32_u24 v172, 0x2400, v172
Mvav 228,132,184
ds_read_b128 a[156:159], v23 offset:4096
s_nop 0
v_mul_f32 v224, v38, v224
Mvav 236,132,188
ds_read_b128 a[132:135], v21
v_mul_f32 v225, v38, v225
Mvav 240,136,184
ds_read_b128 a[160:163], v20 offset:8192
v_mul_f32 v232, v39, v232
Mvav 248,136,188
ds_read_b128 a[136:139], v22
v_mul_f32 v233, v39, v233
Mvav 244,140,184
ds_read_b128 a[164:167], v21 offset:8192
v_mul_f32 v226, v38, v226
Mvav 252,140,188
v_mul_f32 v240, v38, v240
v_mul_f32 v241, v38, v241
v_mul_f32 v248, v39, v248
v_mul_f32 v249, v39, v249
v_mul_f32 v227, v38, v227
v_mul_f32 v234, v39, v234
v_mul_f32 v235, v39, v235
v_mul_f32 v242, v38, v242
v_mul_f32 v243, v38, v243
v_mul_f32 v250, v39, v250
v_mul_f32 v251, v39, v251
v_mul_f32 v228, v38, v228
v_mul_f32 v229, v38, v229
v_mul_f32 v230, v38, v230
v_mul_f32 v231, v38, v231
CV 224,224,225
v_mul_f32 v236, v39, v236
v_mul_f32 v237, v39, v237
v_mul_f32 v238, v39, v238
v_mul_f32 v239, v39, v239
CV 232,232,233
v_mul_f32 v244, v38, v244
v_mul_f32 v245, v38, v245
v_mul_f32 v246, v38, v246
v_mul_f32 v247, v38, v247
CV 240,240,241
v_mul_f32 v252, v39, v252
v_mul_f32 v253, v39, v253
v_mul_f32 v254, v39, v254
v_mul_f32 v255, v39, v255
CV 248,248,249
CV 225,226,227
CV 233,234,235
CV 241,242,243
CV 249,250,251
CV 226,228,229
CV 227,230,231
CV 234,236,237
CV 235,238,239
CV 242,244,245
CV 243,246,247
CV 250,252,253
CV 251,254,255
v_permlane32_swap_b32 v224, v226
v_permlane32_swap_b32 v225, v227
v_permlane32_swap_b32 v232, v234
v_permlane32_swap_b32 v233, v235
v_permlane32_swap_b32 v240, v242
v_permlane32_swap_b32 v241, v243
v_permlane32_swap_b32 v248, v250
v_permlane32_swap_b32 v249, v251
v_permlane16_swap_b32 v192, v194
v_permlane16_swap_b32 v193, v195
v_permlane16_swap_b32 v200, v202
v_permlane16_swap_b32 v201, v203
v_permlane16_swap_b32 v208, v210
v_permlane16_swap_b32 v209, v211
v_permlane16_swap_b32 v216, v218
v_permlane16_swap_b32 v217, v219
v_permlane16_swap_b32 v224, v226
v_permlane16_swap_b32 v225, v227
v_permlane16_swap_b32 v232, v234
v_permlane16_swap_b32 v233, v235
v_permlane16_swap_b32 v240, v242
v_permlane16_swap_b32 v241, v243
v_permlane16_swap_b32 v248, v250
v_permlane16_swap_b32 v249, v251
v_accvgpr_write_b32 a32, v192
v_accvgpr_write_b32 a33, v193
v_accvgpr_write_b32 a34, v194
v_accvgpr_write_b32 a35, v195
v_accvgpr_write_b32 a36, v200
v_accvgpr_write_b32 a37, v201
v_accvgpr_write_b32 a38, v202
v_accvgpr_write_b32 a39, v203
v_accvgpr_write_b32 a40, v208
v_accvgpr_write_b32 a41, v209
v_accvgpr_write_b32 a42, v210
v_accvgpr_write_b32 a43, v211
v_accvgpr_write_b32 a44, v216
v_accvgpr_write_b32 a45, v217
v_accvgpr_write_b32 a46, v218
v_accvgpr_write_b32 a47, v219
v_accvgpr_write_b32 a48, v224
v_accvgpr_write_b32 a49, v225
v_accvgpr_write_b32 a50, v226
v_accvgpr_write_b32 a51, v227
v_accvgpr_write_b32 a52, v232
v_accvgpr_write_b32 a53, v233
v_accvgpr_write_b32 a54, v234
v_accvgpr_write_b32 a55, v235
v_accvgpr_write_b32 a56, v240
v_accvgpr_write_b32 a57, v241
v_accvgpr_write_b32 a58, v242
v_accvgpr_write_b32 a59, v243
v_accvgpr_write_b32 a60, v248
v_accvgpr_write_b32 a61, v249
v_accvgpr_write_b32 a62, v250
v_accvgpr_write_b32 a63, v251
ds_read_b128 a[140:143], v23
s_nop 0
s_cmp_lg_u32 s89, 0
s_cbranch_scc1 L_max0_0
L_maxr0_0:
s_waitcnt lgkmcnt(1)
v_mfma_f32_16x16x32_bf16 v[48:51], a[128:131], a[0:3], 0
ds_read_b128 a[168:171], v22 offset:8192
v_lshl_add_u32 v8, v8, 4, v172
v_mfma_f32_16x16x32_bf16 v[56:59], a[128:131], a[4:7], 0
ds_read_b128 a[172:175], v23 offset:8192
v_add_u32 v9, 0x11c00, v8
v_mfma_f32_16x16x32_bf16 v[64:67], a[128:131], a[32:35], 0
LD 12,44,76,0
v_add_u32 v10, 0x23800, v8
v_mfma_f32_16x16x32_bf16 v[72:75], a[128:131], a[36:39], 0
ds_read_b128 a[128:131], v20 offset:12288
v_add_u32 v11, 0x35400, v8
Mvaa 48,132,8
v_add_u32 v20, 0x9000, v20
v_add_u32 v2, 0x9000, v2
Mvaa 56,132,12
v_add_u32 v3, 0xfffe5000, v3
v_add_u32 v4, 0xfffe5000, v4
Mvaa 64,132,40
LD 13,44,76,1024
v_add_u32 v3, 0x9000, v3
Mvaa 72,132,44
ds_read_b128 a[132:135], v21 offset:12288
v_add_u32 v21, 0x9000, v21
Mvaa 48,136,16
v_add_u32 v4, 0x9000, v4
v_add_u32 v5, 0xfffe5000, v5
Mvaa 56,136,20
v_add_u32 v5, 0x9000, v5
v_add_u32 v36, s9, v2
Mvaa 64,136,48
v_add_u32 v37, s9, v3
v_add_u32 v38, s9, v4
Mvaa 72,136,52
s_waitcnt lgkmcnt(2)
ds_read_b128 a[136:139], v22 offset:12288
v_add_u32 v22, 0x9000, v22
Mvaa 48,140,24
LD 14,44,76,2048
v_add_u32 v39, s9, v5
Mvaa 56,140,28
s_lshl_b32 s9, s94, 3
v_lshrrev_b32 v172, 3, v1
v_mov_b32 v174, 0
Mvaa 64,140,56
s_add_u32 s9, s9, s17
v_and_b32 v173, 6, v172
v_max3_f32 v168, v48, v49, v24
Mvaa 72,140,60
s_lshl_b32 s9, s9, 7
ds_read_b128 a[140:143], v23 offset:12288
v_max3_f32 v169, v56, v57, v25
v_mfma_f32_16x16x32_bf16 v[52:55], a[144:147], a[0:3], 0
s_add_u32 s9, s9, 0x3010024
v_max3_f32 v168, v168, v50, v51
v_max3_f32 v169, v169, v58, v59
v_mfma_f32_16x16x32_bf16 v[60:63], a[144:147], a[4:7], 0
s_add_u32 s17, s66, 3
v_max3_f32 v170, v64, v65, v26
v_max3_f32 v171, v72, v73, v27
v_mfma_f32_16x16x32_bf16 v[68:71], a[144:147], a[32:35], 0
LD 15,44,76,3072
v_max3_f32 v170, v170, v66, v67
v_mfma_f32_16x16x32_bf16 v[76:79], a[144:147], a[36:39], 0
s_add_u32 m0, s69, 0x1f000
s_add_u32 s76, s73, 0x68000
v_max3_f32 v171, v171, v74, v75
Mvaa 52,148,8
s_and_b32 s17, s17, 7
v_add_u32 v23, 0x9000, v23
v_mul_u32_u24 v172, 0x480, v172
Mvaa 60,148,12
s_mul_i32 s81, s17, 0x11000
v_and_b32 v175, 48, v1
Mvaa 68,148,40
s_waitcnt vmcnt(12) lgkmcnt(0)
s_barrier
s_add_u32 s81, s81, s13
ds_read_b128 a[144:147], v20
Mvaa 76,148,44
s_add_u32 s81, s81, 0xb000
ds_read_b128 a[148:151], v21
Mvaa 52,152,16
LD 16,48,76,0
Mvaa 60,152,20
Mvaa 68,152,48
Mvaa 76,152,52
ds_read_b128 a[152:155], v22
Mvaa 52,156,24
s_nop 0
Mvaa 60,156,28
s_nop 0
Mvaa 68,156,56
LD 17,48,76,1024
Mvaa 76,156,60
s_nop 1
v_max3_f32 v168, v168, v52, v53
s_nop 0
v_max3_f32 v169, v169, v60, v61
v_max3_f32 v168, v168, v54, v55
v_max3_f32 v169, v169, v62, v63
v_max3_f32 v170, v170, v68, v69
s_nop 0
v_permlane32_swap_b32 v168, v169
v_max3_f32 v171, v171, v76, v77
v_max3_f32 v170, v170, v70, v71
v_max_f32 v168, v168, v169
v_max3_f32 v171, v171, v78, v79
v_mov_b32 v169, v168
s_nop 0
v_permlane32_swap_b32 v170, v171
v_permlane16_swap_b32 v168, v169
v_max_f32 v170, v170, v171
ds_read_b128 a[156:159], v23
v_max_f32 v168, v168, v169
v_mov_b32 v171, v170
v_mov_b32 v169, v168
s_nop 0
v_permlane16_swap_b32 v170, v171
v_permlane32_swap_b32 v168, v169
v_max_f32 v170, v170, v171
v_sub_f32 v144, 0, v168
v_sub_f32 v145, 0, v168
v_sub_f32 v146, 0, v168
v_sub_f32 v147, 0, v168
v_mov_b32 v171, v170
v_sub_f32 v148, 0, v169
v_mfma_f32_16x16x32_bf16 v[80:83], a[160:163], a[0:3], v[144:147]
v_sub_f32 v149, 0, v169
v_sub_f32 v150, 0, v169
v_sub_f32 v151, 0, v169
v_permlane32_swap_b32 v170, v171
s_nop 0
v_mfma_f32_16x16x32_bf16 v[88:91], a[160:163], a[4:7], v[148:151]
v_sub_f32 v152, 0, v170
v_sub_f32 v153, 0, v170
v_sub_f32 v154, 0, v170
v_sub_f32 v155, 0, v170
v_sub_f32 v156, 0, v171
v_sub_f32 v157, 0, v171
v_mfma_f32_16x16x32_bf16 v[96:99], a[160:163], a[32:35], v[152:155]
v_sub_f32 v158, 0, v171
v_sub_f32 v159, 0, v171
v_sub_f32 v48, v48, v168
v_sub_f32 v49, v49, v168
v_mfma_f32_16x16x32_bf16 v[104:107], a[160:163], a[36:39], v[156:159]
ds_read_b128 a[160:163], v20 offset:4096
v_sub_f32 v50, v50, v168
Mvaa 80,164,8
LD 18,48,76,2048
v_sub_f32 v51, v51, v168
Mvaa 88,164,12
v_exp_f32 v48, v48
Mvaa 96,164,40
v_exp_f32 v49, v49
Mvaa 104,164,44
ds_read_b128 a[164:167], v21 offset:4096
v_sub_f32 v56, v56, v169
Mvaa 80,168,16
v_exp_f32 v50, v50
Mvaa 88,168,20
v_exp_f32 v51, v51
Mvaa 96,168,48
LD 19,48,76,3072
v_sub_f32 v57, v57, v169
Mvaa 104,168,52
s_add_u32 s21, s94, 54
ds_read_b128 a[168:171], v22 offset:4096
v_sub_f32 v58, v58, v169
Mvaa 80,172,24
s_min_u32 s21, s21, 0xa1
v_exp_f32 v56, v56
Mvaa 88,172,28
s_mul_i32 s22, s21, 0xe39
v_exp_f32 v57, v57
Mvaa 96,172,56
s_lshr_b32 s22, s22, 16
v_exp_f32 v58, v58
Mvaa 104,172,60
s_mul_i32 s22, s22, 0xffaf0080
s_mul_i32 s15, s21, 0x48000
s_add_u32 s22, s22, s15
v_mfma_f32_16x16x32_bf16 v[84:87], a[128:131], a[0:3], v[144:147]
s_mul_i32 s15, s66, 0x480
s_add_u32 m0, s69, 0x24000
s_add_u32 s22, s22, s15
v_mfma_f32_16x16x32_bf16 v[92:95], a[128:131], a[4:7], v[148:151]
s_mov_b32 s76, s22
ds_read_b128 a[172:175], v23 offset:4096
v_sub_f32 v59, v59, v169
v_mfma_f32_16x16x32_bf16 v[100:103], a[128:131], a[32:35], v[152:155]
s_lshl_b32 s14, s21, 12
v_exp_f32 v59, v59
v_mfma_f32_16x16x32_bf16 v[108:111], a[128:131], a[36:39], v[156:159]
s_mul_i32 s15, s66, 0xa2000
Ta 128,2,16384
CV 112,48,49
Mvaa 84,132,8
s_add_u32 s14, s14, s15
Ta 130,2,18432
CV 113,50,51
Mvaa 92,132,12
s_add_u32 s14, s14, 0x4400000
v_sub_f32 v64, v64, v170
v_sub_f32 v65, v65, v170
Mvaa 100,132,40
v_exp_f32 v64, v64
Mvaa 108,132,44
Ta 132,3,16384
v_sub_f32 v66, v66, v170
Mvaa 84,136,16
Ta 134,3,18432
v_sub_f32 v67, v67, v170
Mvaa 92,136,20
v_exp_f32 v65, v65
Mvaa 100,136,48
v_exp_f32 v66, v66
Mvaa 108,136,52
Ta 136,4,16384
CV 116,56,57
Mvaa 84,140,24
Ta 138,4,18432
CV 117,58,59
Mvaa 92,140,28
v_exp_f32 v67, v67
Mvaa 100,140,56
v_sub_f32 v72, v72, v171
v_sub_f32 v73, v73, v171
Mvaa 108,140,60
s_waitcnt lgkmcnt(4)
Ta 140,5,16384
v_sub_f32 v74, v74, v171
v_mfma_f32_16x16x32_bf16 v[48:51], a[144:147], a[0:3], v[144:147]
Ta 142,5,18432
v_sub_f32 v75, v75, v171
v_mfma_f32_16x16x32_bf16 v[56:59], a[144:147], a[4:7], v[148:151]
CV 120,64,65
CV 121,66,67
v_mfma_f32_16x16x32_bf16 v[64:67], a[144:147], a[32:35], v[152:155]
LD 8,24,76,0
LD 9,24,76,1024
LD 10,24,76,2048
LD 11,24,76,3072
s_add_u32 m0, s69, 0
s_add_u32 s76, s71, 0x70000
v_exp_f32 v72, v72
LD 12,44,76,0
v_exp_f32 v73, v73
v_exp_f32 v74, v74
v_exp_f32 v75, v75
CV 124,72,73
v_sub_f32 v52, v52, v168
CV 125,74,75
v_mfma_f32_16x16x32_bf16 v[72:75], a[144:147], a[36:39], v[156:159]
Ta 144,2,20480
v_sub_f32 v53, v53, v168
Mvaa 48,148,8
Ta 146,2,22528
v_sub_f32 v54, v54, v168
Mvaa 56,148,12
v_exp_f32 v52, v52
Mvaa 64,148,40
v_exp_f32 v53, v53
Mvaa 72,148,44
Ta 148,3,20480
v_sub_f32 v55, v55, v168
Mvaa 48,152,16
Ta 150,3,22528
v_sub_f32 v60, v60, v169
Mvaa 56,152,20
v_exp_f32 v54, v54
Mvaa 64,152,48
v_exp_f32 v55, v55
Mvaa 72,152,52
Ta 152,4,20480
v_sub_f32 v61, v61, v169
Mvaa 48,156,24
Ta 154,4,22528
v_sub_f32 v62, v62, v169
Mvaa 56,156,28
v_exp_f32 v60, v60
Mvaa 64,156,56
v_exp_f32 v61, v61
Mvaa 72,156,60
LD 13,44,76,1024
v_sub_f32 v63, v63, v169
CV 114,52,53
CV 115,54,55
v_mfma_f32_16x16x32_bf16 v[52:55], a[160:163], a[0:3], v[144:147]
v_exp_f32 v62, v62
v_exp_f32 v63, v63
v_sub_f32 v68, v68, v170
v_sub_f32 v69, v69, v170
v_sub_f32 v70, v70, v170
v_sub_f32 v71, v71, v170
CV 118,60,61
CV 119,62,63
v_mfma_f32_16x16x32_bf16 v[60:63], a[160:163], a[4:7], v[148:151]
v_exp_f32 v68, v68
v_exp_f32 v69, v69
v_exp_f32 v70, v70
v_exp_f32 v71, v71
v_sub_f32 v76, v76, v171
v_sub_f32 v77, v77, v171
v_sub_f32 v78, v78, v171
v_sub_f32 v79, v79, v171
CV 122,68,69
CV 123,70,71
v_mfma_f32_16x16x32_bf16 v[68:71], a[160:163], a[32:35], v[152:155]
v_exp_f32 v76, v76
v_exp_f32 v77, v77
v_exp_f32 v78, v78
v_exp_f32 v79, v79
CV 126,76,77
Ta 156,5,20480
CV 127,78,79
v_mfma_f32_16x16x32_bf16 v[76:79], a[160:163], a[36:39], v[156:159]
Ta 158,5,22528
Mvaa 52,164,8
ds_read_b128 a[160:163], v20 offset:8192
Mvaa 60,164,12
v_exp_f32 v80, v80
Mvaa 68,164,40
v_exp_f32 v81, v81
Mvaa 76,164,44
ds_read_b128 a[164:167], v21 offset:8192
CV 128,80,81
Mvaa 52,168,16
v_exp_f32 v82, v82
Mvaa 60,168,20
v_exp_f32 v83, v83
Mvaa 68,168,48
v_exp_f32 v88, v88
Mvaa 76,168,52
ds_read_b128 a[168:171], v22 offset:8192
CV 129,82,83
Mvaa 52,172,24
LD 14,44,76,2048
s_lshl_b32 s85, s30, 7
Mvaa 60,172,28
s_add_u32 s85, s85, 0x4000
v_exp_f32 v89, v89
Mvaa 68,172,56
s_getpc_b64 s[96:97]
v_mov_b32 v46, s85
CV 132,88,89
Mvaa 76,172,60
ds_read_b128 a[172:175], v23 offset:8192
v_mfma_f32_16x16x32_bf16 a[240:243], v[40:43], v[112:115], 0
global_load_dword v35, v46, s[96:97]
v_mfma_f32_16x16x32_bf16 a[244:247], v[40:43], v[116:119], 0
v_exp_f32 v90, v90
v_mfma_f32_16x16x32_bf16 a[248:251], v[40:43], v[120:123], 0
v_exp_f32 v91, v91
v_mfma_f32_16x16x32_bf16 a[252:255], v[40:43], v[124:127], 0
v_exp_f32 v96, v96
v_mfma_f32_16x16x32_bf16 v[176:179], a[128:131], v[112:115], 0
v_exp_f32 v97, v97
v_mfma_f32_16x16x32_bf16 v[184:187], a[128:131], v[116:119], 0
v_exp_f32 v98, v98
v_mfma_f32_16x16x32_bf16 a[176:179], a[128:131], v[120:123], 0
v_exp_f32 v99, v99
v_mfma_f32_16x16x32_bf16 a[184:187], a[128:131], v[124:127], 0
s_waitcnt lgkmcnt(1)
ds_read_b128 a[128:131], v20 offset:12288
CV 133,90,91
v_mfma_f32_16x16x32_bf16 v[180:183], a[132:135], v[112:115], 0
v_exp_f32 v104, v104
v_mfma_f32_16x16x32_bf16 v[188:191], a[132:135], v[116:119], 0
v_exp_f32 v105, v105
v_mfma_f32_16x16x32_bf16 a[180:183], a[132:135], v[120:123], 0
LD 15,44,76,3072
CV 136,96,97
v_mfma_f32_16x16x32_bf16 a[188:191], a[132:135], v[124:127], 0
s_add_u32 m0, s69, 0x4000
s_add_u32 s76, s73, 0x6c000
ds_read_b128 a[132:135], v21 offset:12288
v_mfma_f32_16x16x32_bf16 v[192:195], a[136:139], v[112:115], 0
v_exp_f32 v106, v106
v_mfma_f32_16x16x32_bf16 v[200:203], a[136:139], v[116:119], 0
v_exp_f32 v107, v107
v_mfma_f32_16x16x32_bf16 a[192:195], a[136:139], v[120:123], 0
v_exp_f32 v84, v84
v_mfma_f32_16x16x32_bf16 a[200:203], a[136:139], v[124:127], 0
ds_read_b128 a[136:139], v22 offset:12288
CV 137,98,99
v_mfma_f32_16x16x32_bf16 v[196:199], a[140:143], v[112:115], 0
v_exp_f32 v85, v85
v_mfma_f32_16x16x32_bf16 v[204:207], a[140:143], v[116:119], 0
v_exp_f32 v86, v86
v_mfma_f32_16x16x32_bf16 a[196:199], a[140:143], v[120:123], 0
v_exp_f32 v87, v87
v_mfma_f32_16x16x32_bf16 a[204:207], a[140:143], v[124:127], 0
ds_read_b128 a[140:143], v23 offset:12288
CV 140,104,105
v_mfma_f32_16x16x32_bf16 v[208:211], a[144:147], v[112:115], 0
v_exp_f32 v92, v92
v_mfma_f32_16x16x32_bf16 v[216:219], a[144:147], v[116:119], 0
v_exp_f32 v93, v93
v_mfma_f32_16x16x32_bf16 a[208:211], a[144:147], v[120:123], 0
v_exp_f32 v94, v94
v_mfma_f32_16x16x32_bf16 a[216:219], a[144:147], v[124:127], 0
Ta 144,2,24576
CV 141,106,107
v_mfma_f32_16x16x32_bf16 v[212:215], a[148:151], v[112:115], 0
LD 16,48,76,0
Ta 146,2,26624
v_mfma_f32_16x16x32_bf16 v[220:223], a[148:151], v[116:119], 0
v_exp_f32 v95, v95
v_mfma_f32_16x16x32_bf16 a[212:215], a[148:151], v[120:123], 0
v_exp_f32 v100, v100
v_mfma_f32_16x16x32_bf16 a[220:223], a[148:151], v[124:127], 0
Ta 148,3,24576
CV 130,84,85
v_mfma_f32_16x16x32_bf16 v[224:227], a[152:155], v[112:115], 0
Ta 150,3,26624
CV 131,86,87
v_mfma_f32_16x16x32_bf16 v[232:235], a[152:155], v[116:119], 0
v_exp_f32 v101, v101
v_mfma_f32_16x16x32_bf16 a[224:227], a[152:155], v[120:123], 0
v_exp_f32 v102, v102
v_mfma_f32_16x16x32_bf16 a[232:235], a[152:155], v[124:127], 0
Ta 152,4,24576
CV 134,92,93
v_mfma_f32_16x16x32_bf16 v[228:231], a[156:159], v[112:115], 0
Ta 154,4,26624
CV 135,94,95
v_mfma_f32_16x16x32_bf16 v[236:239], a[156:159], v[116:119], 0
v_exp_f32 v103, v103
v_mfma_f32_16x16x32_bf16 a[228:231], a[156:159], v[120:123], 0
v_exp_f32 v108, v108
v_mfma_f32_16x16x32_bf16 a[236:239], a[156:159], v[124:127], 0
Ta 156,5,24576
CV 138,100,101
v_mfma_f32_16x16x32_bf16 v[80:83], a[160:163], a[0:3], v[144:147]
Ta 158,5,26624
CV 139,102,103
v_mfma_f32_16x16x32_bf16 v[88:91], a[160:163], a[4:7], v[148:151]
v_exp_f32 v109, v109
v_mfma_f32_16x16x32_bf16 v[96:99], a[160:163], a[32:35], v[152:155]
LD 17,48,76,1024
L_pg9_6:
s_cbranch_execz L_ret9
CV 142,108,109
v_mfma_f32_16x16x32_bf16 v[104:107], a[160:163], a[36:39], v[156:159]
Ta 160,2,28672
v_add_u32 v20, 0x9000, v20
Mvaa 80,164,8
Ta 162,2,30720
v_add_u32 v21, 0x9000, v21
Mvaa 88,164,12
v_exp_f32 v110, v110
Mvaa 96,164,40
v_exp_f32 v111, v111
Mvaa 104,164,44
Ta 164,3,28672
CV 143,110,111
Mvaa 80,168,16
Ta 166,3,30720
v_add_u32 v22, 0x9000, v22
Mvaa 88,168,20
v_exp_f32 v48, v48
Mvaa 96,168,48
v_exp_f32 v49, v49
Mvaa 104,168,52
s_waitcnt lgkmcnt(4)
Ta 168,4,28672
CV 112,48,49
Mvaa 80,172,24
Ta 170,4,30720
v_add_u32 v23, 0x9000, v23
Mvaa 88,172,28
v_exp_f32 v50, v50
Mvaa 96,172,56
v_exp_f32 v51, v51
Mvaa 104,172,60
Ta 172,5,28672
CV 113,50,51
v_mfma_f32_16x16x32_bf16 v[84:87], a[128:131], a[0:3], v[144:147]
LD 18,48,76,2048
Ta 174,5,30720
v_mfma_f32_16x16x32_bf16 v[92:95], a[128:131], a[4:7], v[148:151]
v_exp_f32 v56, v56
v_mfma_f32_16x16x32_bf16 v[100:103], a[128:131], a[32:35], v[152:155]
v_exp_f32 v57, v57
v_mfma_f32_16x16x32_bf16 v[108:111], a[128:131], a[36:39], v[156:159]
v_exp_f32 v58, v58
Mvaa 84,132,8
v_exp_f32 v59, v59
Mvaa 92,132,12
v_exp_f32 v64, v64
Mvaa 100,132,40
v_exp_f32 v65, v65
Mvaa 108,132,44
s_waitcnt vmcnt(20) lgkmcnt(0)
s_barrier
s_waitcnt vmcnt(8)
Tv 240,36,0
CV 116,56,57
Mvaa 84,136,16
Tv 242,36,2048
CV 117,58,59
Mvaa 92,136,20
Tv 244,37,0
CV 120,64,65
Mvaa 100,136,48
Tv 246,37,2048
Tv 248,38,0
Mvaa 108,136,52
Tv 250,38,2048
Tv 252,39,0
Mvaa 84,140,24
Tv 254,39,2048
v_add_u32 v2, 0x9000, v2
Mvaa 92,140,28
ds_read_b128 a[128:131], v20
v_add_u32 v3, 0x9000, v3
Mvaa 100,140,56
LD 19,48,76,3072
ds_read_b128 a[132:135], v21
Mvaa 108,140,60
ds_read_b128 a[136:139], v22
v_add_u32 v4, 0x9000, v4
Mavv 240,40,128
ds_read_b128 a[140:143], v23
v_add_u32 v5, 0x9000, v5
Mavv 244,40,132
v_exp_f32 v66, v66
Mavv 248,40,136
s_waitcnt lgkmcnt(9)
buffer_store_dwordx4 v[240:243], v7, s[40:43], s14 offen sc1
Mavv 252,40,140
v_exp_f32 v67, v67
Mvav 176,144,128
v_exp_f32 v72, v72
Mvav 184,144,132
v_exp_f32 v73, v73
Maav 176,144,136
v_exp_f32 v74, v74
Maav 184,144,140
s_waitcnt lgkmcnt(3)
buffer_store_dwordx4 v[244:247], v7, s[40:43], s14 offen offset:1024 sc1
ds_read_b128 a[144:147], v20 offset:4096
Mvav 180,148,128
v_exp_f32 v75, v75
Mvav 188,148,132
v_exp_f32 v52, v52
Maav 180,148,136
v_exp_f32 v53, v53
Maav 188,148,140
ds_read_b128 a[148:151], v21 offset:4096
CV 121,66,67
Mvav 192,152,128
buffer_store_dwordx4 v[248:251], v7, s[40:43], s14 offen offset:2048 sc1
CV 124,72,73
Mvav 200,152,132
v_exp_f32 v54, v54
Maav 192,152,136
s_add_u32 s21, s94, 0x76
v_exp_f32 v55, v55
Maav 200,152,140
s_min_u32 s21, s21, 0xa1
ds_read_b128 a[152:155], v22 offset:4096
CV 125,74,75
Mvav 196,156,128
s_mul_i32 s22, s21, 0xe39
v_exp_f32 v60, v60
Mvav 204,156,132
buffer_store_dwordx4 v[252:255], v7, s[40:43], s14 offen offset:3072 sc1
CV 114,52,53
Maav 196,156,136
s_lshr_b32 s22, s22, 16
v_exp_f32 v61, v61
Maav 204,156,140
s_mul_i32 s22, s22, 0xffaf0080
s_mul_i32 s15, s21, 0x48000
s_add_u32 s22, s22, s15
Mvav 208,160,128
s_mul_i32 s15, s66, 0x480
s_add_u32 m0, s69, 0x24000
s_add_u32 s22, s22, s15
Mvav 216,160,132
s_mov_b32 s76, s22
ds_read_b128 a[156:159], v23 offset:4096
CV 115,54,55
Maav 208,160,136
s_lshl_b32 s14, s21, 12
v_exp_f32 v62, v62
Maav 216,160,140
s_mul_i32 s15, s66, 0xa2000
Ta 160,2,16384
CV 118,60,61
Mvav 212,164,128
s_add_u32 s14, s14, s15
Ta 162,2,18432
s_add_u32 s14, s14, 0x4400000
Mvav 220,164,132
s_and_b32 s15, s66, 3
v_exp_f32 v63, v63
Maav 212,164,136
s_lshl_b32 s20, s15, 10
v_exp_f32 v68, v68
Maav 220,164,140
s_add_u32 s20, s20, s13
Ta 164,3,16384
CV 119,62,63
Mvav 224,168,128
s_add_u32 s20, s20, 0x8000
Ta 166,3,18432
s_lshl_b32 s21, s15, 10
Mvav 232,168,132
s_add_u32 s21, s21, s13
v_exp_f32 v69, v69
Maav 224,168,136
s_add_u32 s21, s21, 0x19000
v_exp_f32 v70, v70
Maav 232,168,140
s_and_b32 s22, s66, 1
Ta 168,4,16384
CV 122,68,69
Mvav 228,172,128
s_mul_i32 s18, s22, 0x4800
Ta 170,4,18432
s_lshl_b32 s22, s22, 8
Mvav 236,172,132
v_exp_f32 v71, v71
Maav 228,172,136
v_exp_f32 v76, v76
Maav 236,172,140
Ta 172,5,16384
CV 123,70,71
v_mfma_f32_16x16x32_bf16 v[48:51], a[128:131], a[0:3], v[144:147]
Ta 174,5,18432
v_mfma_f32_16x16x32_bf16 v[56:59], a[128:131], a[4:7], v[148:151]
v_exp_f32 v77, v77
v_mfma_f32_16x16x32_bf16 v[64:67], a[128:131], a[32:35], v[152:155]
LD 8,24,76,0
CV 126,76,77
v_mfma_f32_16x16x32_bf16 v[72:75], a[128:131], a[36:39], v[156:159]
s_waitcnt lgkmcnt(4)
Ta 128,2,20480
v_and_b32 v8, 7, v1
Mvaa 48,132,8
Ta 130,2,22528
v_xor_b32 v8, v8, v173
Mvaa 56,132,12
v_exp_f32 v78, v78
Mvaa 64,132,40
LD 9,24,76,1024
v_lshl_add_u32 v8, v8, 4, v172
Mvaa 72,132,44
Ta 132,3,20480
v_mov_b32 v172, s66
Mvaa 48,136,16
Ta 134,3,22528
v_lshlrev_b32 v173, 7, s94
Mvaa 56,136,20
v_exp_f32 v79, v79
Mvaa 64,136,48
LD 10,24,76,2048
CV 127,78,79
Mvaa 72,136,52
Ta 136,4,20480
v_lshl_add_u32 v172, v172, 2, v173
Mvaa 48,140,24
Ta 138,4,22528
v_add_u32 v172, 0x3004000, v172
Mvaa 56,140,28
v_exp_f32 v80, v80
Mvaa 64,140,56
LD 11,24,76,3072
v_add_u32 v9, 0x2000, v8
Mvaa 72,140,60
s_add_u32 m0, s69, 0x9000
s_add_u32 s76, s71, 0x74000
Ta 140,5,20480
v_mfma_f32_16x16x32_bf16 v[52:55], a[144:147], a[0:3], v[144:147]
Ta 142,5,22528
v_add_u32 v10, 0x4000, v8
v_mfma_f32_16x16x32_bf16 v[60:63], a[144:147], a[4:7], v[148:151]
v_exp_f32 v81, v81
v_mfma_f32_16x16x32_bf16 v[68:71], a[144:147], a[32:35], v[152:155]
LD 12,44,76,0
CV 128,80,81
v_mfma_f32_16x16x32_bf16 v[76:79], a[144:147], a[36:39], v[156:159]
ds_read_b128 a[144:147], v20 offset:8192
v_add_u32 v11, 0x6000, v8
Mvaa 52,148,8
v_exp_f32 v82, v82
Mvaa 60,148,12
v_exp_f32 v83, v83
Mvaa 68,148,40
LD 13,44,76,1024
CV 129,82,83
Mvaa 76,148,44
ds_read_b128 a[148:151], v21 offset:8192
Mvaa 52,152,16
v_exp_f32 v88, v88
Mvaa 60,152,20
v_exp_f32 v89, v89
Mvaa 68,152,48
v_exp_f32 v90, v90
Mvaa 76,152,52
ds_read_b128 a[152:155], v22 offset:8192
CV 132,88,89
Mvaa 52,156,24
LD 14,44,76,2048
Mvaa 60,156,28
v_exp_f32 v91, v91
Mvaa 68,156,56
v_exp_f32 v96, v96
Mvaa 76,156,60
ds_read_b128 a[156:159], v23 offset:8192
CV 133,90,91
Mavv 240,40,112
v_exp_f32 v97, v97
Mavv 244,40,116
v_exp_f32 v98, v98
Mavv 248,40,120
v_exp_f32 v99, v99
Mavv 252,40,124
v_exp_f32 v104, v104
Mvav 176,160,112
v_exp_f32 v105, v105
Mvav 184,160,116
v_exp_f32 v106, v106
Maav 176,160,120
v_exp_f32 v107, v107
Maav 184,160,124
ds_read_b128 a[160:163], v20 offset:12288
CV 136,96,97
Mvav 180,164,112
v_exp_f32 v84, v84
Mvav 188,164,116
s_waitcnt lgkmcnt(1)
v_exp_f32 v85, v85
Maav 180,164,120
LD 15,44,76,3072
CV 137,98,99
Maav 188,164,124
s_add_u32 m0, s69, 0xd000
s_add_u32 s76, s73, 0x70000
ds_read_b128 a[164:167], v21 offset:12288
Mvav 192,168,112
v_exp_f32 v86, v86
Mvav 200,168,116
v_exp_f32 v87, v87
Maav 192,168,120
v_exp_f32 v92, v92
Maav 200,168,124
ds_read_b128 a[168:171], v22 offset:12288
CV 140,104,105
Mvav 196,172,112
v_exp_f32 v93, v93
Mvav 204,172,116
v_exp_f32 v94, v94
Maav 196,172,120
v_exp_f32 v95, v95
Maav 204,172,124
ds_read_b128 a[172:175], v23 offset:12288
CV 141,106,107
Mvav 208,128,112
v_exp_f32 v100, v100
Mvav 216,128,116
v_exp_f32 v101, v101
Maav 208,128,120
v_exp_f32 v102, v102
Maav 216,128,124
Ta 128,2,24576
CV 130,84,85
Mvav 212,132,112
LD 16,48,76,0
Ta 130,2,26624
Mvav 220,132,116
v_exp_f32 v103, v103
Maav 212,132,120
v_exp_f32 v108, v108
Maav 220,132,124
Ta 132,3,24576
CV 131,86,87
Mvav 224,136,112
Ta 134,3,26624
CV 134,92,93
Mvav 232,136,116
v_exp_f32 v109, v109
Maav 224,136,120
v_exp_f32 v110, v110
Maav 232,136,124
Ta 136,4,24576
CV 135,94,95
Mvav 228,140,112
Ta 138,4,26624
CV 138,100,101
Mvav 236,140,116
v_exp_f32 v111, v111
Maav 228,140,120
CV 139,102,103
CV 142,108,109
Maav 236,140,124
Ta 140,5,24576
CV 143,110,111
v_mfma_f32_16x16x32_bf16 v[80:83], a[144:147], a[0:3], v[144:147]
Ta 142,5,26624
v_add_u32 v20, 0x9000, v20
v_mfma_f32_16x16x32_bf16 v[88:91], a[144:147], a[4:7], v[148:151]
v_exp_f32 v48, v48
v_mfma_f32_16x16x32_bf16 v[96:99], a[144:147], a[32:35], v[152:155]
LD 17,48,76,1024
v_add_u32 v21, 0x9000, v21
v_mfma_f32_16x16x32_bf16 v[104:107], a[144:147], a[36:39], v[156:159]
Ta 144,2,28672
v_add_u32 v22, 0x9000, v22
Mvaa 80,148,8
Ta 146,2,30720
v_add_u32 v23, 0x9000, v23
Mvaa 88,148,12
v_exp_f32 v49, v49
Mvaa 96,148,40
v_exp_f32 v50, v50
Mvaa 104,148,44
Ta 148,3,28672
CV 112,48,49
Mvaa 80,152,16
Ta 150,3,30720
v_add_u32 v2, 0x9000, v2
Mvaa 88,152,20
v_exp_f32 v51, v51
Mvaa 96,152,48
v_exp_f32 v56, v56
Mvaa 104,152,52
Ta 152,4,28672
CV 113,50,51
Mvaa 80,156,24
Ta 154,4,30720
v_add_u32 v3, 0x9000, v3
Mvaa 88,156,28
v_exp_f32 v57, v57
Mvaa 96,156,56
v_exp_f32 v58, v58
Mvaa 104,156,60
s_waitcnt lgkmcnt(4)
s_branch L_Amain
L_hss1_0:
buffer_store_dwordx2 v[224:225], v228, s[40:43], s78 offen sc1
s_add_u32 s5, s17, 32
v_add_u32 v229, s5, v229
v_lshrrev_b32 v229, 5, v229
v_mul_u32_u24 v229, 36352, v229
v_add_u32 v229, v229, v6
s_lshl_b32 s5, s17, 5
s_add_u32 s5, s78, s5
buffer_store_dwordx2 v[226:227], v229, s[40:43], s5 offen offset:8 sc1
s_branch L_hs1_0
L_hss2_0:
buffer_store_dwordx2 v[232:233], v236, s[40:43], s79 offen sc1
s_add_u32 s6, s17, 48
v_add_u32 v237, s6, v237
v_lshrrev_b32 v237, 5, v237
v_mul_u32_u24 v237, 36352, v237
v_add_u32 v237, v237, v6
s_lshl_b32 s6, s17, 5
s_add_u32 s6, s79, s6
buffer_store_dwordx2 v[234:235], v237, s[40:43], s6 offen offset:8 sc1
s_branch L_hs2_0
L_max0_0:
s_nop 15
s_nop 15
v_and_b32 v168, 15, v1
v_and_b32 v169, 48, v1
v_lshrrev_b32 v169, 0, v169
v_lshl_add_u32 v168, v168, 8, v169
s_lshl_b32 s82, s66, 20
s_add_u32 s82, s82, 0x60000
s_mov_b32 s83, 32
L_maxl0_0:
buffer_load_dwordx4 v[144:147], v168, s[44:47], s82 offen
s_waitcnt vmcnt(0)
buffer_load_dwordx4 v[148:151], v168, s[44:47], s82 offen offset:64
buffer_load_dwordx4 v[152:155], v168, s[44:47], s82 offen offset:128
buffer_load_dwordx4 v[156:159], v168, s[44:47], s82 offen offset:192
v_mfma_f32_16x16x32_bf16 v[48:51], v[144:147], a[0:3], 0
v_mfma_f32_16x16x32_bf16 v[52:55], v[144:147], a[4:7], 0
v_mfma_f32_16x16x32_bf16 v[56:59], v[144:147], a[32:35], 0
v_mfma_f32_16x16x32_bf16 v[60:63], v[144:147], a[36:39], 0
s_waitcnt vmcnt(2)
Mvva 48,148,8
Mvva 52,148,12
Mvva 56,148,40
Mvva 60,148,44
s_waitcnt vmcnt(1)
Mvva 48,152,16
Mvva 52,152,20
Mvva 56,152,48
Mvva 60,152,52
s_waitcnt vmcnt(0)
Mvva 48,156,24
Mvva 52,156,28
Mvva 56,156,56
Mvva 60,156,60
s_nop 4
v_max3_f32 v24, v24, v48, v49
v_max3_f32 v24, v24, v50, v51
v_max3_f32 v25, v25, v52, v53
v_max3_f32 v25, v25, v54, v55
v_max3_f32 v26, v26, v56, v57
v_max3_f32 v26, v26, v58, v59
v_max3_f32 v27, v27, v60, v61
v_max3_f32 v27, v27, v62, v63
s_add_u32 s82, s82, 4096
s_sub_u32 s83, s83, 1
s_cmp_lg_u32 s83, 0
s_cbranch_scc1 L_maxl0_0
s_nop 7
s_branch L_maxr0_0
L_max0_1:
s_nop 15
s_nop 15
v_and_b32 v168, 15, v1
v_and_b32 v169, 48, v1
v_lshrrev_b32 v169, 0, v169
v_lshl_add_u32 v168, v168, 8, v169
s_lshl_b32 s82, s66, 20
s_add_u32 s82, s82, 0x60000
s_mov_b32 s83, 32
L_maxl0_1:
buffer_load_dwordx4 v[144:147], v168, s[44:47], s82 offen
s_waitcnt vmcnt(0)
buffer_load_dwordx4 v[148:151], v168, s[44:47], s82 offen offset:64
buffer_load_dwordx4 v[152:155], v168, s[44:47], s82 offen offset:128
buffer_load_dwordx4 v[156:159], v168, s[44:47], s82 offen offset:192
v_mfma_f32_16x16x32_bf16 v[48:51], v[144:147], a[0:3], 0
v_mfma_f32_16x16x32_bf16 v[52:55], v[144:147], a[4:7], 0
v_mfma_f32_16x16x32_bf16 v[56:59], v[144:147], a[32:35], 0
v_mfma_f32_16x16x32_bf16 v[60:63], v[144:147], a[36:39], 0
s_waitcnt vmcnt(2)
Mvva 48,148,8
Mvva 52,148,12
Mvva 56,148,40
Mvva 60,148,44
s_waitcnt vmcnt(1)
Mvva 48,152,16
Mvva 52,152,20
Mvva 56,152,48
Mvva 60,152,52
s_waitcnt vmcnt(0)
Mvva 48,156,24
Mvva 52,156,28
Mvva 56,156,56
Mvva 60,156,60
s_nop 4
v_max3_f32 v24, v24, v48, v49
v_max3_f32 v24, v24, v50, v51
v_max3_f32 v25, v25, v52, v53
v_max3_f32 v25, v25, v54, v55
v_max3_f32 v26, v26, v56, v57
v_max3_f32 v26, v26, v58, v59
v_max3_f32 v27, v27, v60, v61
v_max3_f32 v27, v27, v62, v63
s_add_u32 s82, s82, 4096
s_sub_u32 s83, s83, 1
s_cmp_lg_u32 s83, 0
s_cbranch_scc1 L_maxl0_1
s_nop 7
s_branch L_maxr0_1
L_spin3_2:
s_mov_b32 s91, 0x8000
L_spinl3_2:
s_sleep 2
buffer_load_dword v29, v28, s[40:43], 0 offen sc1
s_waitcnt vmcnt(0)
v_cmp_ne_u32 vcc, s98, v29
s_cbranch_vccz L_pollok3_2
s_sub_u32 s91, s91, 1
s_cmp_lg_u32 s91, 0
s_cbranch_scc1 L_spinl3_2
s_branch L_pollok3_2
L_max0_2:
s_nop 15
s_nop 15
v_and_b32 v168, 15, v1
v_and_b32 v169, 48, v1
v_lshrrev_b32 v169, 0, v169
v_lshl_add_u32 v168, v168, 8, v169
s_lshl_b32 s82, s66, 20
s_add_u32 s82, s82, 0x60000
s_mov_b32 s83, 32
L_maxl0_2:
buffer_load_dwordx4 v[144:147], v168, s[44:47], s82 offen
s_waitcnt vmcnt(0)
buffer_load_dwordx4 v[148:151], v168, s[44:47], s82 offen offset:64
buffer_load_dwordx4 v[152:155], v168, s[44:47], s82 offen offset:128
buffer_load_dwordx4 v[156:159], v168, s[44:47], s82 offen offset:192
v_mfma_f32_16x16x32_bf16 v[48:51], v[144:147], a[0:3], 0
v_mfma_f32_16x16x32_bf16 v[52:55], v[144:147], a[4:7], 0
v_mfma_f32_16x16x32_bf16 v[56:59], v[144:147], a[32:35], 0
v_mfma_f32_16x16x32_bf16 v[60:63], v[144:147], a[36:39], 0
s_waitcnt vmcnt(2)
Mvva 48,148,8
Mvva 52,148,12
Mvva 56,148,40
Mvva 60,148,44
s_waitcnt vmcnt(1)
Mvva 48,152,16
Mvva 52,152,20
Mvva 56,152,48
Mvva 60,152,52
s_waitcnt vmcnt(0)
Mvva 48,156,24
Mvva 52,156,28
Mvva 56,156,56
Mvva 60,156,60
s_nop 4
v_max3_f32 v24, v24, v48, v49
v_max3_f32 v24, v24, v50, v51
v_max3_f32 v25, v25, v52, v53
v_max3_f32 v25, v25, v54, v55
v_max3_f32 v26, v26, v56, v57
v_max3_f32 v26, v26, v58, v59
v_max3_f32 v27, v27, v60, v61
v_max3_f32 v27, v27, v62, v63
s_add_u32 s82, s82, 4096
s_sub_u32 s83, s83, 1
s_cmp_lg_u32 s83, 0
s_cbranch_scc1 L_maxl0_2
s_nop 7
s_branch L_maxr0_2
L_slow:
s_cmp_lg_u32 s89, 0
s_cbranch_scc1 L_noslow
s_waitcnt vmcnt(0) lgkmcnt(0)
s_barrier
s_mov_b32 s89, 1
v_lshl_add_u32 v7, s64, 6, v1
s_nop 15
s_branch L_restart
.p2align 12
L_A1:
s_add_u32 m0, s83, 0x2000
s_add_u32 s76, s82, 0x100
LD 192,32,76,0
LD 193,32,76,1024
LD 194,32,76,2048
LD 195,32,76,3072
s_add_u32 m0, s83, 0x3000
s_add_u32 s76, s82, 0x180
LD 192,32,76,0
LD 193,32,76,1024
LD 194,32,76,2048
LD 195,32,76,3072
s_mov_b64 exec, 0
s_cmp_eq_u32 s64, 0
s_cbranch_scc1 L_pg10_1
s_cmp_eq_u32 s64, 1
s_cbranch_scc1 L_pg10_2
s_cmp_eq_u32 s64, 2
s_cbranch_scc1 L_pg10_3
s_branch L_pg10_4
L_ret10:
s_mov_b64 exec, -1
s_mov_b64 exec, 0
s_cmp_eq_u32 s64, 0
s_cbranch_scc1 L_pg11_5
s_cmp_eq_u32 s64, 1
s_cbranch_scc1 L_pg11_6
s_cmp_eq_u32 s64, 2
s_cbranch_scc1 L_pg11_6
s_branch L_pg11_6
L_ret11:
s_mov_b64 exec, -1
s_waitcnt vmcnt(15)
ds_read_b128 v[48:51], v196
ds_read_b128 v[52:55], v196 offset:2048
ds_read_b128 v[56:59], v197
ds_read_b128 v[60:63], v197 offset:2048
s_add_u32 m0, s83, 0
s_add_u32 s76, s82, 0x200
s_waitcnt lgkmcnt(0)
LD 192,32,76,0
LD 193,32,76,1024
LD 194,32,76,2048
LD 195,32,76,3072
s_waitcnt vmcnt(15)
ds_read_b128 v[64:67], v196 offset:4096
ds_read_b128 v[68:71], v196 offset:6144
ds_read_b128 v[72:75], v197 offset:4096
ds_read_b128 v[76:79], v197 offset:6144
v_dot2_f32_bf16 v240, v48, s88, v240
v_dot2_f32_bf16 v242, v48, v48, v242
v_dot2_f32_bf16 v241, v52, s88, v241
v_dot2_f32_bf16 v243, v52, v52, v243
v_dot2_f32_bf16 v240, v49, s88, v240
v_dot2_f32_bf16 v242, v49, v49, v242
v_dot2_f32_bf16 v241, v53, s88, v241
v_dot2_f32_bf16 v243, v53, v53, v243
v_dot2_f32_bf16 v240, v50, s88, v240
v_dot2_f32_bf16 v242, v50, v50, v242
v_dot2_f32_bf16 v241, v54, s88, v241
v_dot2_f32_bf16 v243, v54, v54, v243
v_dot2_f32_bf16 v240, v51, s88, v240
v_dot2_f32_bf16 v242, v51, v51, v242
v_dot2_f32_bf16 v241, v55, s88, v241
v_dot2_f32_bf16 v243, v55, v55, v243
v_dot2_f32_bf16 v240, v56, s88, v240
v_dot2_f32_bf16 v242, v56, v56, v242
v_dot2_f32_bf16 v241, v60, s88, v241
v_dot2_f32_bf16 v243, v60, v60, v243
v_dot2_f32_bf16 v240, v57, s88, v240
v_dot2_f32_bf16 v242, v57, v57, v242
v_dot2_f32_bf16 v241, v61, s88, v241
v_dot2_f32_bf16 v243, v61, v61, v243
v_dot2_f32_bf16 v240, v58, s88, v240
v_dot2_f32_bf16 v242, v58, v58, v242
v_dot2_f32_bf16 v241, v62, s88, v241
v_dot2_f32_bf16 v243, v62, v62, v243
v_dot2_f32_bf16 v240, v59, s88, v240
v_dot2_f32_bf16 v242, v59, v59, v242
v_dot2_f32_bf16 v241, v63, s88, v241
v_dot2_f32_bf16 v243, v63, v63, v243
s_add_u32 m0, s83, 0x1000
s_add_u32 s76, s82, 0x280
s_waitcnt lgkmcnt(0)
LD 192,32,76,0
LD 193,32,76,1024
LD 194,32,76,2048
LD 195,32,76,3072
s_waitcnt vmcnt(12)
ds_read_b128 v[80:83], v196 offset:8192
ds_read_b128 v[84:87], v196 offset:10240
ds_read_b128 v[88:91], v197 offset:8192
ds_read_b128 v[92:95], v197 offset:10240
v_dot2_f32_bf16 v240, v64, s88, v240
v_dot2_f32_bf16 v242, v64, v64, v242
v_dot2_f32_bf16 v241, v68, s88, v241
v_dot2_f32_bf16 v243, v68, v68, v243
v_dot2_f32_bf16 v240, v65, s88, v240
v_dot2_f32_bf16 v242, v65, v65, v242
v_dot2_f32_bf16 v241, v69, s88, v241
v_dot2_f32_bf16 v243, v69, v69, v243
v_dot2_f32_bf16 v240, v66, s88, v240
v_dot2_f32_bf16 v242, v66, v66, v242
v_dot2_f32_bf16 v241, v70, s88, v241
v_dot2_f32_bf16 v243, v70, v70, v243
v_dot2_f32_bf16 v240, v67, s88, v240
v_dot2_f32_bf16 v242, v67, v67, v242
v_dot2_f32_bf16 v241, v71, s88, v241
v_dot2_f32_bf16 v243, v71, v71, v243
v_dot2_f32_bf16 v240, v72, s88, v240
v_dot2_f32_bf16 v242, v72, v72, v242
v_dot2_f32_bf16 v241, v76, s88, v241
v_dot2_f32_bf16 v243, v76, v76, v243
v_dot2_f32_bf16 v240, v73, s88, v240
v_dot2_f32_bf16 v242, v73, v73, v242
v_dot2_f32_bf16 v241, v77, s88, v241
v_dot2_f32_bf16 v243, v77, v77, v243
v_dot2_f32_bf16 v240, v74, s88, v240
v_dot2_f32_bf16 v242, v74, v74, v242
v_dot2_f32_bf16 v241, v78, s88, v241
v_dot2_f32_bf16 v243, v78, v78, v243
v_dot2_f32_bf16 v240, v75, s88, v240
v_dot2_f32_bf16 v242, v75, v75, v242
v_dot2_f32_bf16 v241, v79, s88, v241
v_dot2_f32_bf16 v243, v79, v79, v243
s_add_u32 m0, s83, 0x2000
s_add_u32 s76, s82, 0x300
s_waitcnt lgkmcnt(0)
LD 192,32,76,0
LD 193,32,76,1024
LD 194,32,76,2048
LD 195,32,76,3072
s_waitcnt vmcnt(12)
ds_read_b128 v[96:99], v196 offset:12288
ds_read_b128 v[100:103], v196 offset:14336
ds_read_b128 v[104:107], v197 offset:12288
ds_read_b128 v[108:111], v197 offset:14336
v_dot2_f32_bf16 v240, v80, s88, v240
v_dot2_f32_bf16 v242, v80, v80, v242
v_dot2_f32_bf16 v241, v84, s88, v241
v_dot2_f32_bf16 v243, v84, v84, v243
v_dot2_f32_bf16 v240, v81, s88, v240
v_dot2_f32_bf16 v242, v81, v81, v242
v_dot2_f32_bf16 v241, v85, s88, v241
v_dot2_f32_bf16 v243, v85, v85, v243
v_dot2_f32_bf16 v240, v82, s88, v240
v_dot2_f32_bf16 v242, v82, v82, v242
v_dot2_f32_bf16 v241, v86, s88, v241
v_dot2_f32_bf16 v243, v86, v86, v243
v_dot2_f32_bf16 v240, v83, s88, v240
v_dot2_f32_bf16 v242, v83, v83, v242
v_dot2_f32_bf16 v241, v87, s88, v241
v_dot2_f32_bf16 v243, v87, v87, v243
v_dot2_f32_bf16 v240, v88, s88, v240
v_dot2_f32_bf16 v242, v88, v88, v242
v_dot2_f32_bf16 v241, v92, s88, v241
v_dot2_f32_bf16 v243, v92, v92, v243
v_dot2_f32_bf16 v240, v89, s88, v240
v_dot2_f32_bf16 v242, v89, v89, v242
v_dot2_f32_bf16 v241, v93, s88, v241
v_dot2_f32_bf16 v243, v93, v93, v243
v_dot2_f32_bf16 v240, v90, s88, v240
v_dot2_f32_bf16 v242, v90, v90, v242
v_dot2_f32_bf16 v241, v94, s88, v241
v_dot2_f32_bf16 v243, v94, v94, v243
v_dot2_f32_bf16 v240, v91, s88, v240
v_dot2_f32_bf16 v242, v91, v91, v242
v_dot2_f32_bf16 v241, v95, s88, v241
v_dot2_f32_bf16 v243, v95, v95, v243
s_add_u32 m0, s83, 0x3000
s_add_u32 s76, s82, 0x380
s_waitcnt lgkmcnt(0)
LD 192,32,76,0
LD 193,32,76,1024
LD 194,32,76,2048
LD 195,32,76,3072
s_waitcnt vmcnt(12)
ds_read_b128 v[112:115], v196
ds_read_b128 v[116:119], v196 offset:2048
ds_read_b128 v[120:123], v197
ds_read_b128 v[124:127], v197 offset:2048
v_dot2_f32_bf16 v240, v96, s88, v240
v_dot2_f32_bf16 v242, v96, v96, v242
v_dot2_f32_bf16 v241, v100, s88, v241
v_dot2_f32_bf16 v243, v100, v100, v243
v_dot2_f32_bf16 v240, v97, s88, v240
v_dot2_f32_bf16 v242, v97, v97, v242
v_dot2_f32_bf16 v241, v101, s88, v241
v_dot2_f32_bf16 v243, v101, v101, v243
v_dot2_f32_bf16 v240, v98, s88, v240
v_dot2_f32_bf16 v242, v98, v98, v242
v_dot2_f32_bf16 v241, v102, s88, v241
v_dot2_f32_bf16 v243, v102, v102, v243
v_dot2_f32_bf16 v240, v99, s88, v240
v_dot2_f32_bf16 v242, v99, v99, v242
v_dot2_f32_bf16 v241, v103, s88, v241
v_dot2_f32_bf16 v243, v103, v103, v243
v_dot2_f32_bf16 v240, v104, s88, v240
v_dot2_f32_bf16 v242, v104, v104, v242
v_dot2_f32_bf16 v241, v108, s88, v241
v_dot2_f32_bf16 v243, v108, v108, v243
v_dot2_f32_bf16 v240, v105, s88, v240
v_dot2_f32_bf16 v242, v105, v105, v242
v_dot2_f32_bf16 v241, v109, s88, v241
v_dot2_f32_bf16 v243, v109, v109, v243
v_dot2_f32_bf16 v240, v106, s88, v240
v_dot2_f32_bf16 v242, v106, v106, v242
v_dot2_f32_bf16 v241, v110, s88, v241
v_dot2_f32_bf16 v243, v110, v110, v243
v_dot2_f32_bf16 v240, v107, s88, v240
v_dot2_f32_bf16 v242, v107, v107, v242
v_dot2_f32_bf16 v241, v111, s88, v241
v_dot2_f32_bf16 v243, v111, v111, v243
s_add_u32 m0, s83, 0
s_add_u32 s76, s82, 0x400
s_waitcnt lgkmcnt(0)
LD 192,32,76,0
LD 193,32,76,1024
LD 194,32,76,2048
LD 195,32,76,3072
s_waitcnt vmcnt(12)
ds_read_b128 v[128:131], v196 offset:4096
ds_read_b128 v[132:135], v196 offset:6144
ds_read_b128 v[136:139], v197 offset:4096
ds_read_b128 v[140:143], v197 offset:6144
v_dot2_f32_bf16 v240, v112, s88, v240
v_dot2_f32_bf16 v242, v112, v112, v242
v_dot2_f32_bf16 v241, v116, s88, v241
v_dot2_f32_bf16 v243, v116, v116, v243
v_dot2_f32_bf16 v240, v113, s88, v240
v_dot2_f32_bf16 v242, v113, v113, v242
v_dot2_f32_bf16 v241, v117, s88, v241
v_dot2_f32_bf16 v243, v117, v117, v243
v_dot2_f32_bf16 v240, v114, s88, v240
v_dot2_f32_bf16 v242, v114, v114, v242
v_dot2_f32_bf16 v241, v118, s88, v241
v_dot2_f32_bf16 v243, v118, v118, v243
v_dot2_f32_bf16 v240, v115, s88, v240
v_dot2_f32_bf16 v242, v115, v115, v242
v_dot2_f32_bf16 v241, v119, s88, v241
v_dot2_f32_bf16 v243, v119, v119, v243
v_dot2_f32_bf16 v240, v120, s88, v240
v_dot2_f32_bf16 v242, v120, v120, v242
v_dot2_f32_bf16 v241, v124, s88, v241
v_dot2_f32_bf16 v243, v124, v124, v243
v_dot2_f32_bf16 v240, v121, s88, v240
v_dot2_f32_bf16 v242, v121, v121, v242
v_dot2_f32_bf16 v241, v125, s88, v241
v_dot2_f32_bf16 v243, v125, v125, v243
v_dot2_f32_bf16 v240, v122, s88, v240
v_dot2_f32_bf16 v242, v122, v122, v242
v_dot2_f32_bf16 v241, v126, s88, v241
v_dot2_f32_bf16 v243, v126, v126, v243
v_dot2_f32_bf16 v240, v123, s88, v240
v_dot2_f32_bf16 v242, v123, v123, v242
v_dot2_f32_bf16 v241, v127, s88, v241
v_dot2_f32_bf16 v243, v127, v127, v243
s_waitcnt vmcnt(8)
ds_read_b128 v[144:147], v196 offset:8192
ds_read_b128 v[148:151], v196 offset:10240
ds_read_b128 v[152:155], v197 offset:8192
ds_read_b128 v[156:159], v197 offset:10240
s_waitcnt lgkmcnt(5)
v_dot2_f32_bf16 v240, v128, s88, v240
v_dot2_f32_bf16 v242, v128, v128, v242
v_dot2_f32_bf16 v241, v132, s88, v241
v_dot2_f32_bf16 v243, v132, v132, v243
v_dot2_f32_bf16 v240, v129, s88, v240
v_dot2_f32_bf16 v242, v129, v129, v242
v_dot2_f32_bf16 v241, v133, s88, v241
v_dot2_f32_bf16 v243, v133, v133, v243
v_dot2_f32_bf16 v240, v130, s88, v240
v_dot2_f32_bf16 v242, v130, v130, v242
v_dot2_f32_bf16 v241, v134, s88, v241
v_dot2_f32_bf16 v243, v134, v134, v243
v_dot2_f32_bf16 v240, v131, s88, v240
v_dot2_f32_bf16 v242, v131, v131, v242
v_dot2_f32_bf16 v241, v135, s88, v241
v_dot2_f32_bf16 v243, v135, v135, v243
v_dot2_f32_bf16 v240, v136, s88, v240
v_dot2_f32_bf16 v242, v136, v136, v242
s_waitcnt lgkmcnt(4)
v_dot2_f32_bf16 v241, v140, s88, v241
v_dot2_f32_bf16 v243, v140, v140, v243
v_dot2_f32_bf16 v240, v137, s88, v240
v_dot2_f32_bf16 v242, v137, v137, v242
v_dot2_f32_bf16 v241, v141, s88, v241
v_dot2_f32_bf16 v243, v141, v141, v243
v_dot2_f32_bf16 v240, v138, s88, v240
v_dot2_f32_bf16 v242, v138, v138, v242
v_dot2_f32_bf16 v241, v142, s88, v241
v_dot2_f32_bf16 v243, v142, v142, v243
v_dot2_f32_bf16 v240, v139, s88, v240
v_dot2_f32_bf16 v242, v139, v139, v242
v_dot2_f32_bf16 v241, v143, s88, v241
v_dot2_f32_bf16 v243, v143, v143, v243
s_waitcnt vmcnt(4)
ds_read_b128 v[160:163], v196 offset:12288
ds_read_b128 v[164:167], v196 offset:14336
ds_read_b128 v[168:171], v197 offset:12288
ds_read_b128 v[172:175], v197 offset:14336
s_waitcnt lgkmcnt(5)
v_dot2_f32_bf16 v240, v144, s88, v240
s_add_u32 m0, s67, 0
v_dot2_f32_bf16 v242, v144, v144, v242
v_dot2_f32_bf16 v241, v148, s88, v241
s_add_u32 s76, s95, 0
v_dot2_f32_bf16 v243, v148, v148, v243
v_dot2_f32_bf16 v240, v145, s88, v240
LD 20,36,76,0
v_dot2_f32_bf16 v242, v145, v145, v242
v_dot2_f32_bf16 v241, v149, s88, v241
LD 21,36,76,1024
v_dot2_f32_bf16 v243, v149, v149, v243
v_dot2_f32_bf16 v240, v146, s88, v240
LD 22,36,76,2048
v_dot2_f32_bf16 v242, v146, v146, v242
v_dot2_f32_bf16 v241, v150, s88, v241
LD 23,36,76,3072
v_dot2_f32_bf16 v243, v150, v150, v243
v_dot2_f32_bf16 v240, v147, s88, v240
s_add_u32 m0, s67, 0x1000
v_dot2_f32_bf16 v242, v147, v147, v242
v_dot2_f32_bf16 v241, v151, s88, v241
s_add_u32 s76, s95, 0x40000
v_dot2_f32_bf16 v243, v151, v151, v243
v_dot2_f32_bf16 v240, v152, s88, v240
LD 20,36,76,0
v_dot2_f32_bf16 v242, v152, v152, v242
s_waitcnt lgkmcnt(4)
v_dot2_f32_bf16 v241, v156, s88, v241
LD 21,36,76,1024
v_dot2_f32_bf16 v243, v156, v156, v243
v_dot2_f32_bf16 v240, v153, s88, v240
v_dot2_f32_bf16 v242, v153, v153, v242
v_dot2_f32_bf16 v241, v157, s88, v241
v_dot2_f32_bf16 v243, v157, v157, v243
v_dot2_f32_bf16 v240, v154, s88, v240
v_dot2_f32_bf16 v242, v154, v154, v242
v_dot2_f32_bf16 v241, v158, s88, v241
v_dot2_f32_bf16 v243, v158, v158, v243
v_dot2_f32_bf16 v240, v155, s88, v240
v_dot2_f32_bf16 v242, v155, v155, v242
v_dot2_f32_bf16 v241, v159, s88, v241
v_dot2_f32_bf16 v243, v159, v159, v243
s_waitcnt vmcnt(6)
ds_read_b128 v[176:179], v196
ds_read_b128 v[180:183], v196 offset:2048
ds_read_b128 v[184:187], v197
ds_read_b128 v[188:191], v197 offset:2048
s_waitcnt lgkmcnt(4)
v_dot2_f32_bf16 v240, v160, s88, v240
LD 22,36,76,2048
v_dot2_f32_bf16 v242, v160, v160, v242
v_dot2_f32_bf16 v241, v164, s88, v241
LD 23,36,76,3072
v_dot2_f32_bf16 v243, v164, v164, v243
v_dot2_f32_bf16 v240, v161, s88, v240
s_add_u32 m0, s67, 0x2000
v_dot2_f32_bf16 v242, v161, v161, v242
v_dot2_f32_bf16 v241, v165, s88, v241
s_add_u32 s76, s95, 0x80000
v_dot2_f32_bf16 v243, v165, v165, v243
v_dot2_f32_bf16 v240, v162, s88, v240
LD 20,36,76,0
v_dot2_f32_bf16 v242, v162, v162, v242
v_dot2_f32_bf16 v241, v166, s88, v241
s_add_u32 m0, s67, 0x9000
v_dot2_f32_bf16 v243, v166, v166, v243
v_dot2_f32_bf16 v240, v163, s88, v240
s_add_u32 s76, s95, 0x240000
v_dot2_f32_bf16 v242, v163, v163, v242
v_dot2_f32_bf16 v241, v167, s88, v241
LD 20,36,76,0
v_dot2_f32_bf16 v243, v167, v167, v243
v_dot2_f32_bf16 v240, v168, s88, v240
LD 21,36,76,1024
v_dot2_f32_bf16 v242, v168, v168, v242
v_dot2_f32_bf16 v241, v172, s88, v241
LD 22,36,76,2048
v_dot2_f32_bf16 v243, v172, v172, v243
v_dot2_f32_bf16 v240, v169, s88, v240
v_dot2_f32_bf16 v242, v169, v169, v242
v_dot2_f32_bf16 v241, v173, s88, v241
v_dot2_f32_bf16 v243, v173, v173, v243
v_dot2_f32_bf16 v240, v170, s88, v240
v_dot2_f32_bf16 v242, v170, v170, v242
v_dot2_f32_bf16 v241, v174, s88, v241
v_dot2_f32_bf16 v243, v174, v174, v243
v_dot2_f32_bf16 v240, v171, s88, v240
v_dot2_f32_bf16 v242, v171, v171, v242
v_dot2_f32_bf16 v241, v175, s88, v241
v_dot2_f32_bf16 v243, v175, v175, v243
s_waitcnt lgkmcnt(0)
s_barrier
v_dot2_f32_bf16 v240, v176, s88, v240
LD 23,36,76,3072
v_dot2_f32_bf16 v242, v176, v176, v242
v_dot2_f32_bf16 v241, v180, s88, v241
s_add_u32 m0, s67, 0xa000
v_dot2_f32_bf16 v243, v180, v180, v243
v_dot2_f32_bf16 v240, v177, s88, v240
s_add_u32 s76, s95, 0x280000
v_dot2_f32_bf16 v242, v177, v177, v242
v_dot2_f32_bf16 v241, v181, s88, v241
LD 20,36,76,0
v_dot2_f32_bf16 v243, v181, v181, v243
v_dot2_f32_bf16 v240, v178, s88, v240
LD 21,36,76,1024
v_dot2_f32_bf16 v242, v178, v178, v242
v_dot2_f32_bf16 v241, v182, s88, v241
LD 22,36,76,2048
v_dot2_f32_bf16 v243, v182, v182, v243
v_dot2_f32_bf16 v240, v179, s88, v240
LD 23,36,76,3072
v_dot2_f32_bf16 v242, v179, v179, v242
v_dot2_f32_bf16 v241, v183, s88, v241
s_add_u32 m0, s67, 0xb000
v_dot2_f32_bf16 v243, v183, v183, v243
v_dot2_f32_bf16 v240, v184, s88, v240
s_add_u32 s76, s95, 0x2c0000
v_dot2_f32_bf16 v242, v184, v184, v242
v_dot2_f32_bf16 v241, v188, s88, v241
LD 20,36,76,0
v_dot2_f32_bf16 v243, v188, v188, v243
v_dot2_f32_bf16 v240, v185, s88, v240
v_dot2_f32_bf16 v242, v185, v185, v242
v_dot2_f32_bf16 v241, v189, s88, v241
v_dot2_f32_bf16 v243, v189, v189, v243
v_dot2_f32_bf16 v240, v186, s88, v240
v_dot2_f32_bf16 v242, v186, v186, v242
v_dot2_f32_bf16 v241, v190, s88, v241
v_dot2_f32_bf16 v243, v190, v190, v243
v_dot2_f32_bf16 v240, v187, s88, v240
v_dot2_f32_bf16 v242, v187, v187, v242
v_dot2_f32_bf16 v241, v191, s88, v241
v_dot2_f32_bf16 v243, v191, v191, v243
s_nop 1
v_permlane32_swap_b32 v240, v241
v_add_f32 v240, v240, v241
v_permlane32_swap_b32 v242, v243
v_add_f32 v242, v242, v243
v_mov_b32 v244, v240
s_nop 1
v_permlane16_swap_b32 v240, v244
v_add_f32 v240, v240, v244
v_mov_b32 v245, v242
s_nop 1
v_permlane16_swap_b32 v242, v245
v_add_f32 v242, v242, v245
v_mul_f32 v240, 0xbae38e39, v240
v_mul_f32 v242, 0x3ae38e39, v242
v_fma_f32 v242, -v240, v240, v242
v_max_f32 v242, 0, v242
v_mov_b32 v24, v240
s_add_u32 m0, s67, 0x12000
v_mov_b32 v251, v24
v_mov_b32 v252, v24
s_add_u32 s76, s95, 0x80
s_nop 0
v_permlane32_swap_b32 v251, v252
v_readfirstlane_b32 s84, v255
v_mov_b32 v25, v242
v_mov_b32 v248, v251
v_mov_b32 v249, v251
v_mov_b32 v250, v251
v_mov_b32 v253, v252
v_mov_b32 v254, v252
v_mfma_f32_16x16x32_bf16 v[224:227], a[248:251], v[48:51], v[248:251]
LD 20,36,76,0
v_mov_b32 v255, v252
v_add_f32 v26, 0x3727c5ac, v25
v_mfma_f32_16x16x32_bf16 v[228:231], a[252:255], v[48:51], v[248:251]
s_add_u32 s9, s69, 0x1b000
v_rsq_f32 v38, v26
v_mov_b32 v25, 0xff800000
v_mfma_f32_16x16x32_bf16 v[232:235], a[248:251], v[52:55], v[252:255]
s_lshl_b32 s10, s66, 6
CV 48,224,225
CV 49,226,227
v_mul_f32 v36, v24, v38
v_mfma_f32_16x16x32_bf16 v[236:239], a[252:255], v[52:55], v[252:255]
s_add_u32 s84, s84, 0x9e3779b9
CV 50,228,229
CV 51,230,231
v_mul_f32 v38, 0x3e0293ee, v38
v_mfma_f32_16x16x32_bf16 v[240:243], a[248:251], v[56:59], v[248:251]
s_add_u32 s10, s10, s94
CV 52,232,233
CV 53,234,235
v_mov_b32 v39, v38
v_mfma_f32_16x16x32_bf16 v[244:247], a[252:255], v[56:59], v[248:251]
s_cmp_lg_u32 s89, 0
s_cselect_b32 s98, s98, s84
CV 54,236,237
CV 55,238,239
v_mov_b32 v24, 0xff800000
v_mfma_f32_16x16x32_bf16 v[224:227], a[248:251], v[60:63], v[252:255]
LD 21,36,76,1024
CV 56,240,241
CV 57,242,243
v_mfma_f32_16x16x32_bf16 v[228:231], a[252:255], v[60:63], v[252:255]
s_lshl_b32 s10, s10, 2
CV 58,244,245
CV 59,246,247
v_mov_b32 v26, 0xff800000
v_mfma_f32_16x16x32_bf16 v[232:235], a[248:251], v[64:67], v[248:251]
s_add_u32 s10, s10, 0x300c000
CV 60,224,225
CV 61,226,227
v_mov_b32 v27, 0xff800000
v_mfma_f32_16x16x32_bf16 v[236:239], a[252:255], v[64:67], v[248:251]
s_add_u32 s5, s101, 0x4000
CV 62,228,229
CV 63,230,231
v_and_b32 v8, 7, v1
v_mfma_f32_16x16x32_bf16 v[240:243], a[248:251], v[68:71], v[252:255]
s_add_u32 s6, s101, 0x5000
CV 64,232,233
CV 65,234,235
v_mov_b32 v40, s88
v_mfma_f32_16x16x32_bf16 v[244:247], a[252:255], v[68:71], v[252:255]
s_add_u32 s7, s101, 0x6000
CV 66,236,237
CV 67,238,239
v_mov_b32 v41, s88
v_mfma_f32_16x16x32_bf16 v[224:227], a[248:251], v[72:75], v[248:251]
LD 22,36,76,2048
CV 68,240,241
CV 69,242,243
v_mfma_f32_16x16x32_bf16 v[228:231], a[252:255], v[72:75], v[248:251]
s_add_u32 s4, s101, 0x7000
CV 70,244,245
CV 71,246,247
v_mov_b32 v42, s88
v_mfma_f32_16x16x32_bf16 v[232:235], a[248:251], v[76:79], v[252:255]
s_add_u32 s12, s74, 0x400
CV 72,224,225
CV 73,226,227
v_mov_b32 v43, s88
v_mfma_f32_16x16x32_bf16 v[236:239], a[252:255], v[76:79], v[252:255]
s_add_u32 s23, s66, 1
CV 74,228,229
CV 75,230,231
v_mov_b32 v37, v36
v_mfma_f32_16x16x32_bf16 v[240:243], a[248:251], v[80:83], v[248:251]
s_and_b32 s23, s23, 7
CV 76,232,233
CV 77,234,235
v_mov_b32 v47, s98
v_mfma_f32_16x16x32_bf16 v[244:247], a[252:255], v[80:83], v[248:251]
s_lshl_b32 s23, s23, 7
CV 78,236,237
CV 79,238,239
v_mov_b32 v28, 0xff800000
v_mfma_f32_16x16x32_bf16 v[224:227], a[248:251], v[84:87], v[252:255]
s_add_u32 s23, s23, s74
CV 80,240,241
CV 81,242,243
L_pg10_1:
s_cbranch_execz L_ret10
v_mov_b32 v29, 0xff800000
v_mfma_f32_16x16x32_bf16 v[228:231], a[252:255], v[84:87], v[252:255]
s_lshl_b32 s11, s64, 8
CV 82,244,245
CV 83,246,247
v_mov_b32 v30, 0xff800000
v_mfma_f32_16x16x32_bf16 v[232:235], a[248:251], v[88:91], v[248:251]
LD 23,36,76,3072
CV 84,224,225
CV 85,226,227
v_mfma_f32_16x16x32_bf16 v[236:239], a[252:255], v[88:91], v[248:251]
s_add_u32 m0, s67, 0x13000
s_add_u32 s76, s95, 0x40080
CV 86,228,229
CV 87,230,231
v_mfma_f32_16x16x32_bf16 v[240:243], a[248:251], v[92:95], v[252:255]
s_mul_i32 s77, s100, 0x12000
CV 88,232,233
CV 89,234,235
v_min_u32 v46, 8, v1
v_mfma_f32_16x16x32_bf16 v[244:247], a[252:255], v[92:95], v[252:255]
s_mul_i32 s85, s66, 0x400
CV 90,236,237
CV 91,238,239
v_mul_u32_u24 v46, 0x2000, v46
v_mfma_f32_16x16x32_bf16 v[224:227], a[248:251], v[96:99], v[248:251]
s_add_u32 s77, s77, s85
CV 92,240,241
CV 93,242,243
v_mov_b32 v31, 0xff800000
v_mfma_f32_16x16x32_bf16 v[228:231], a[252:255], v[96:99], v[248:251]
s_add_u32 s77, s77, 0x100
CV 94,244,245
CV 95,246,247
v_mfma_f32_16x16x32_bf16 v[232:235], a[248:251], v[100:103], v[252:255]
LD 20,36,76,0
CV 96,224,225
CV 97,226,227
v_mfma_f32_16x16x32_bf16 v[236:239], a[252:255], v[100:103], v[252:255]
s_add_u32 s11, s11, 0x24000
CV 98,228,229
CV 99,230,231
v_permlane32_swap_b32 v38, v39
v_mfma_f32_16x16x32_bf16 v[240:243], a[248:251], v[104:107], v[248:251]
s_add_u32 s16, s66, 0
CV 100,232,233
CV 101,234,235
v_mfma_f32_16x16x32_bf16 v[244:247], a[252:255], v[104:107], v[248:251]
s_mul_i32 s13, s94, 0x88000
CV 102,236,237
CV 103,238,239
v_permlane32_swap_b32 v36, v37
v_mfma_f32_16x16x32_bf16 v[224:227], a[248:251], v[108:111], v[252:255]
buffer_load_dword v35, v46, s[36:39], s77 offen
CV 104,240,241
CV 105,242,243
v_mfma_f32_16x16x32_bf16 v[228:231], a[252:255], v[108:111], v[252:255]
s_and_b32 s16, s16, 7
CV 106,244,245
CV 107,246,247
v_mfma_f32_16x16x32_bf16 v[232:235], a[248:251], v[112:115], v[248:251]
LD 21,36,76,1024
CV 108,224,225
CV 109,226,227
v_mfma_f32_16x16x32_bf16 v[236:239], a[252:255], v[112:115], v[248:251]
s_add_u32 s13, s13, 0x800000
CV 110,228,229
CV 111,230,231
v_mfma_f32_16x16x32_bf16 v[240:243], a[248:251], v[116:119], v[252:255]
s_mul_i32 s78, s16, 0x11000
CV 112,232,233
CV 113,234,235
v_mfma_f32_16x16x32_bf16 v[244:247], a[252:255], v[116:119], v[252:255]
s_add_u32 s78, s78, s13
s_add_u32 s17, s66, 1
CV 114,236,237
CV 115,238,239
v_mfma_f32_16x16x32_bf16 v[224:227], a[248:251], v[120:123], v[248:251]
s_add_u32 s78, s78, 0x8000
CV 116,240,241
CV 117,242,243
v_mfma_f32_16x16x32_bf16 v[228:231], a[252:255], v[120:123], v[248:251]
s_and_b32 s17, s17, 7
CV 118,244,245
CV 119,246,247
v_mfma_f32_16x16x32_bf16 v[232:235], a[248:251], v[124:127], v[252:255]
s_mul_i32 s79, s17, 0x11000
s_lshl2_add_u32 s8, s66, s99
CV 120,224,225
CV 121,226,227
v_mfma_f32_16x16x32_bf16 v[236:239], a[252:255], v[124:127], v[252:255]
s_add_u32 s79, s79, s13
CV 122,228,229
CV 123,230,231
v_mfma_f32_16x16x32_bf16 v[240:243], a[248:251], v[128:131], v[248:251]
LD 22,36,76,2048
CV 124,232,233
CV 125,234,235
v_mfma_f32_16x16x32_bf16 v[244:247], a[252:255], v[128:131], v[248:251]
s_add_u32 s79, s79, 0x9000
CV 126,236,237
CV 127,238,239
v_mfma_f32_16x16x32_bf16 v[224:227], a[248:251], v[132:135], v[252:255]
s_add_u32 s8, s8, 0x6020
CV 128,240,241
CV 129,242,243
v_mfma_f32_16x16x32_bf16 v[228:231], a[252:255], v[132:135], v[252:255]
s_add_u32 s16, s66, 2
s_mov_b64 s[56:57], s[18:19]
CV 130,244,245
CV 131,246,247
v_mfma_f32_16x16x32_bf16 v[232:235], a[248:251], v[136:139], v[248:251]
s_waitcnt vmcnt(17)
s_barrier
CV 132,224,225
CV 133,226,227
v_mfma_f32_16x16x32_bf16 v[236:239], a[252:255], v[136:139], v[248:251]
s_and_b32 s16, s16, 7
Ta 128,2,0
CV 134,228,229
CV 135,230,231
v_mfma_f32_16x16x32_bf16 v[240:243], a[248:251], v[140:143], v[252:255]
LD 23,36,76,3072
Ta 130,2,2048
s_add_u32 m0, s67, 0x14000
s_add_u32 s76, s95, 0x80080
CV 136,232,233
v_mfma_f32_16x16x32_bf16 v[244:247], a[252:255], v[140:143], v[252:255]
s_mul_i32 s80, s16, 0x11000
Ta 132,3,0
CV 137,234,235
CV 138,236,237
v_mfma_f32_16x16x32_bf16 v[224:227], a[248:251], v[144:147], v[248:251]
s_add_u32 s80, s80, s13
Ta 134,3,2048
CV 139,238,239
CV 140,240,241
v_mfma_f32_16x16x32_bf16 v[228:231], a[252:255], v[144:147], v[248:251]
s_add_u32 s80, s80, 0xa000
Ta 136,4,0
CV 141,242,243
CV 142,244,245
v_mfma_f32_16x16x32_bf16 v[232:235], a[248:251], v[148:151], v[252:255]
Ta 138,4,2048
CV 143,246,247
CV 144,224,225
v_mfma_f32_16x16x32_bf16 v[236:239], a[252:255], v[148:151], v[252:255]
Ta 140,5,0
CV 145,226,227
CV 146,228,229
v_mfma_f32_16x16x32_bf16 v[240:243], a[248:251], v[152:155], v[248:251]
LD 20,36,76,0
Ta 142,5,2048
v_mfma_f32_16x16x32_bf16 v[244:247], a[252:255], v[152:155], v[248:251]
s_add_u32 m0, s67, 0x1b000
Ta 144,2,4096
CV 147,230,231
CV 148,232,233
CV 149,234,235
v_mfma_f32_16x16x32_bf16 v[224:227], a[248:251], v[156:159], v[252:255]
s_add_u32 s76, s95, 0x240080
Ta 146,2,6144
CV 150,236,237
CV 151,238,239
v_mfma_f32_16x16x32_bf16 v[228:231], a[252:255], v[156:159], v[252:255]
Ta 148,3,4096
CV 152,240,241
CV 153,242,243
v_mfma_f32_16x16x32_bf16 v[232:235], a[248:251], v[160:163], v[248:251]
Ta 150,3,6144
CV 154,244,245
CV 155,246,247
v_mfma_f32_16x16x32_bf16 v[236:239], a[252:255], v[160:163], v[248:251]
Ta 152,4,4096
CV 156,224,225
CV 157,226,227
v_mfma_f32_16x16x32_bf16 v[240:243], a[248:251], v[164:167], v[252:255]
Ta 154,4,6144
CV 158,228,229
CV 159,230,231
v_mfma_f32_16x16x32_bf16 v[244:247], a[252:255], v[164:167], v[252:255]
Ta 156,5,4096
CV 160,232,233
CV 161,234,235
v_mfma_f32_16x16x32_bf16 v[224:227], a[248:251], v[168:171], v[248:251]
Ta 158,5,6144
CV 162,236,237
CV 163,238,239
v_mfma_f32_16x16x32_bf16 v[228:231], a[252:255], v[168:171], v[248:251]
Ta 160,2,8192
CV 164,240,241
CV 165,242,243
v_mfma_f32_16x16x32_bf16 v[232:235], a[248:251], v[172:175], v[252:255]
Ta 162,2,10240
CV 166,244,245
CV 167,246,247
v_mfma_f32_16x16x32_bf16 v[236:239], a[252:255], v[172:175], v[252:255]
Ta 164,3,8192
CV 168,224,225
CV 169,226,227
v_mfma_f32_16x16x32_bf16 v[240:243], a[248:251], v[176:179], v[248:251]
Ta 166,3,10240
CV 170,228,229
CV 171,230,231
v_mfma_f32_16x16x32_bf16 v[244:247], a[252:255], v[176:179], v[248:251]
CV 172,232,233
CV 173,234,235
CV 174,236,237
v_mfma_f32_16x16x32_bf16 v[224:227], a[248:251], v[180:183], v[252:255]
CV 175,238,239
CV 176,240,241
CV 177,242,243
v_mfma_f32_16x16x32_bf16 v[228:231], a[252:255], v[180:183], v[252:255]
CV 178,244,245
CV 179,246,247
v_mfma_f32_16x16x32_bf16 v[232:235], a[248:251], v[184:187], v[248:251]
s_nop 0
CV 180,224,225
CV 181,226,227
v_mfma_f32_16x16x32_bf16 v[236:239], a[252:255], v[184:187], v[248:251]
s_nop 0
CV 182,228,229
CV 183,230,231
v_mfma_f32_16x16x32_bf16 v[240:243], a[248:251], v[188:191], v[252:255]
s_waitcnt lgkmcnt(1)
CV 184,232,233
CV 185,234,235
v_mfma_f32_16x16x32_bf16 v[244:247], a[252:255], v[188:191], v[252:255]
s_nop 0
CV 186,236,237
CV 187,238,239
v_mfma_f32_16x16x32_bf16 v[192:195], a[128:131], v[48:51], 0
s_nop 0
CV 188,240,241
CV 189,242,243
v_mfma_f32_16x16x32_bf16 v[200:203], a[128:131], v[52:55], 0
Ta 128,4,8192
CV 190,244,245
CV 191,246,247
v_mfma_f32_16x16x32_bf16 v[196:199], a[132:135], v[48:51], 0
LD 20,36,76,0
Ta 130,4,10240
v_mfma_f32_16x16x32_bf16 v[204:207], a[132:135], v[52:55], 0
Ta 132,5,8192
v_mfma_f32_16x16x32_bf16 v[208:211], a[136:139], v[48:51], 0
Ta 134,5,10240
v_mfma_f32_16x16x32_bf16 v[216:219], a[136:139], v[52:55], 0
Ta 136,2,12288
v_mfma_f32_16x16x32_bf16 v[212:215], a[140:143], v[48:51], 0
s_mul_i32 s77, s100, 0x12000
Ta 138,2,14336
v_min_u32 v46, 8, v1
v_mfma_f32_16x16x32_bf16 v[220:223], a[140:143], v[52:55], 0
s_mul_i32 s85, s66, 0x400
Ta 140,3,12288
v_mul_u32_u24 v46, 0x2000, v46
Mvav 192,144,56
LD 21,36,76,1024
Ta 142,3,14336
Mvav 200,144,60
s_add_u32 s77, s77, s85
Ta 144,4,12288
s_add_u32 s77, s77, 0x180
Mvav 196,148,56
Ta 146,4,14336
Mvav 204,148,60
Ta 148,5,12288
Mvav 208,152,56
buffer_load_dword v35, v46, s[36:39], s77 offen
Ta 150,5,14336
Mvav 216,152,60
Ta 152,2,16384
Mvav 212,156,56
LD 22,36,76,2048
Ta 154,2,18432
Mvav 220,156,60
Ta 156,3,16384
Mvav 192,160,64
Ta 158,3,18432
Mvav 200,160,68
s_waitcnt lgkmcnt(9)
Ta 160,4,16384
Mvav 196,164,64
Ta 162,4,18432
Mvav 204,164,68
Ta 164,5,16384
Mvav 208,128,64
LD 23,36,76,3072
Ta 166,5,18432
Mvav 216,128,68
s_add_u32 m0, s67, 0x1c000
s_add_u32 s76, s95, 0x280080
Ta 128,2,20480
Mvav 212,132,64
Ta 130,2,22528
Mvav 220,132,68
Ta 132,3,20480
Mvav 192,136,72
Ta 134,3,22528
Mvav 200,136,76
s_waitcnt lgkmcnt(8)
Ta 136,4,20480
Mvav 196,140,72
LD 20,36,76,0
Ta 138,4,22528
Mvav 204,140,76
Ta 140,5,20480
Mvav 208,144,72
Ta 142,5,22528
Mvav 216,144,76
Ta 144,2,24576
Mvav 212,148,72
Ta 146,2,26624
Mvav 220,148,76
Ta 148,3,24576
Mvav 192,152,80
LD 21,36,76,1024
Ta 150,3,26624
Mvav 200,152,84
Ta 152,4,24576
Mvav 196,156,80
Ta 154,4,26624
Mvav 204,156,84
s_waitcnt lgkmcnt(9)
Ta 156,5,24576
Mvav 208,160,80
Ta 158,5,26624
Mvav 216,160,84
Ta 160,2,28672
Mvav 212,164,80
LD 22,36,76,2048
Ta 162,2,30720
Mvav 220,164,84
Ta 164,3,28672
Mvav 192,128,88
Ta 166,3,30720
Mvav 200,128,92
Ta 128,4,28672
Mvav 196,132,88
Ta 130,4,30720
Mvav 204,132,92
s_waitcnt lgkmcnt(8)
Ta 132,5,28672
Mvav 208,136,88
LD 23,36,76,3072
Ta 134,5,30720
Mvav 216,136,92
s_add_u32 m0, s67, 0x1d000
s_add_u32 s76, s95, 0x2c0080
Ta 136,2,32768
Mvav 212,140,88
Ta 138,2,34816
v_add_u32 v2, 0x9000, v2
Mvav 220,140,92
Ta 140,3,32768
Mvav 192,144,96
Ta 142,3,34816
v_add_u32 v3, 0x9000, v3
Mvav 200,144,100
Ta 144,4,32768
Mvav 196,148,96
LD 20,36,76,0
Ta 146,4,34816
Mvav 204,148,100
s_add_u32 m0, s67, 0
Ta 148,5,32768
Ta 150,5,34816
Mvav 208,152,96
s_add_u32 s76, s95, 0x100
v_add_u32 v4, 0x9000, v4
v_add_u32 v5, 0x9000, v5
Mvav 216,152,100
s_waitcnt lgkmcnt(8)
Mvav 212,156,96
Mvav 220,156,100
Mvav 192,160,104
Mvav 200,160,108
Mvav 196,164,104
s_waitcnt vmcnt(20) lgkmcnt(0)
s_barrier
Mvav 204,164,108
Ta 152,2,0
Mvav 208,128,104
Ta 154,2,2048
Mvav 216,128,108
Ta 156,3,0
Mvav 212,132,104
Ta 158,3,2048
Mvav 220,132,108
Ta 160,4,0
Mvav 192,136,112
Ta 162,4,2048
Mvav 200,136,116
Ta 164,5,0
Mvav 196,140,112
Ta 166,5,2048
Mvav 204,140,116
Ta 128,2,4096
Mvav 208,144,112
Ta 130,2,6144
Mvav 216,144,116
Ta 132,3,4096
Mvav 212,148,112
Ta 134,3,6144
Mvav 220,148,116
s_waitcnt lgkmcnt(8)
Ta 136,4,4096
Mvav 192,152,120
Ta 138,4,6144
Mvav 200,152,124
Ta 140,5,4096
Mvav 196,156,120
LD 20,36,76,0
Ta 142,5,6144
Mvav 204,156,124
s_waitcnt lgkmcnt(8)
Ta 144,2,8192
Mvav 208,160,120
Ta 146,2,10240
Mvav 216,160,124
s_waitcnt lgkmcnt(6)
Ta 148,3,8192
Mvav 212,164,120
s_mul_i32 s77, s100, 0x400
Ta 150,3,10240
v_min_u32 v46, 7, v1
Mvav 220,164,124
s_mul_i32 s85, s66, 0x100000
Ta 152,4,8192
v_mul_u32_u24 v46, 0x80, v46
Mvav 192,128,128
LD 21,36,76,1024
Ta 154,4,10240
Mvav 200,128,132
s_add_u32 s77, s77, s85
Ta 156,5,8192
s_add_u32 s77, s77, 0x60000
Mvav 196,132,128
Ta 158,5,10240
Mvav 204,132,132
s_waitcnt lgkmcnt(9)
Ta 160,2,12288
Mvav 208,136,128
buffer_load_dword v35, v46, s[44:47], s77 offen
Ta 162,2,14336
Mvav 216,136,132
s_waitcnt lgkmcnt(8)
Ta 164,3,12288
Mvav 212,140,128
LD 22,36,76,2048
Ta 166,3,14336
Mvav 220,140,132
Ta 128,4,12288
Mvav 192,144,136
Ta 130,4,14336
Mvav 200,144,140
s_waitcnt lgkmcnt(9)
Ta 132,5,12288
Mvav 196,148,136
Ta 134,5,14336
Mvav 204,148,140
s_waitcnt lgkmcnt(8)
Ta 136,2,16384
Mvav 208,152,136
LD 23,36,76,3072
Ta 138,2,18432
Mvav 216,152,140
s_add_u32 m0, s67, 0x1000
s_add_u32 s76, s95, 0x40100
Ta 140,3,16384
Mvav 212,156,136
Ta 142,3,18432
Mvav 220,156,140
s_waitcnt lgkmcnt(9)
Ta 144,4,16384
Mvav 192,160,144
Ta 146,4,18432
Mvav 200,160,148
s_waitcnt lgkmcnt(8)
Ta 148,5,16384
Mvav 196,164,144
LD 20,36,76,0
Ta 150,5,18432
Mvav 204,164,148
Ta 152,2,20480
Mvav 208,128,144
Ta 154,2,22528
Mvav 216,128,148
s_waitcnt lgkmcnt(9)
Ta 156,3,20480
Mvav 212,132,144
Ta 158,3,22528
Mvav 220,132,148
s_waitcnt lgkmcnt(8)
Ta 160,4,20480
Mvav 192,136,152
LD 21,36,76,1024
Ta 162,4,22528
Mvav 200,136,156
Ta 164,5,20480
Mvav 196,140,152
Ta 166,5,22528
Mvav 204,140,156
s_waitcnt lgkmcnt(9)
Ta 128,2,24576
Mvav 208,144,152
Ta 130,2,26624
Mvav 216,144,156
s_waitcnt lgkmcnt(8)
Ta 132,3,24576
Mvav 212,148,152
LD 22,36,76,2048
Ta 134,3,26624
Mvav 220,148,156
Ta 136,4,24576
Mvav 192,152,160
Ta 138,4,26624
Mvav 200,152,164
s_waitcnt lgkmcnt(9)
Ta 140,5,24576
Mvav 196,156,160
Ta 142,5,26624
Mvav 204,156,164
s_waitcnt lgkmcnt(8)
Ta 144,2,28672
Mvav 208,160,160
LD 23,36,76,3072
Ta 146,2,30720
Mvav 216,160,164
s_add_u32 m0, s67, 0x2000
s_add_u32 s76, s95, 0x80100
Ta 148,3,28672
Mvav 212,164,160
Ta 150,3,30720
Mvav 220,164,164
s_waitcnt lgkmcnt(9)
Ta 152,4,28672
L_pg10_2:
s_cbranch_execz L_ret10
Mvav 192,128,168
s_and_b32 s85, s30, 31
Ta 154,4,30720
v_and_b32 v46, 32, v1
Mvav 200,128,172
s_waitcnt lgkmcnt(8)
s_lshl_b32 s85, s85, 8
Ta 156,5,28672
v_lshl_add_u32 v46, v46, 2, s85
Mvav 196,132,168
LD 20,36,76,0
Ta 158,5,30720
Mvav 204,132,172
s_add_u32 m0, s67, 0x9000
Ta 160,2,32768
Ta 162,2,34816
Mvav 208,136,168
s_add_u32 s76, s95, 0x240100
Ta 164,3,32768
Ta 166,3,34816
Mvav 216,136,172
s_waitcnt lgkmcnt(10)
s_getpc_b64 s[96:97]
L_ca0_1:
s_add_u32 s96, s96, L_ca0_1+16384-L_ca0_1
s_addc_u32 s97, s97, 0
Ta 128,4,32768
Ta 130,4,34816
Mvav 212,140,168
global_load_dword v35, v46, s[96:97]
Ta 132,5,32768
Mvav 220,140,172
Ta 134,5,34816
v_add_u32 v2, 0x9000, v2
Mvav 192,144,176
v_add_u32 v3, 0x9000, v3
v_add_u32 v4, 0x9000, v4
Mvav 200,144,180
s_waitcnt lgkmcnt(10)
v_add_u32 v5, 0x9000, v5
Mvav 196,148,176
Mvav 204,148,180
Mvav 208,152,176
Mvav 216,152,180
s_waitcnt lgkmcnt(4)
Mvav 212,156,176
s_waitcnt vmcnt(21) lgkmcnt(0)
s_barrier
Mvav 220,156,180
Ta 136,2,0
Mvav 192,160,184
Ta 138,2,2048
Mvav 200,160,188
Ta 140,3,0
Mvav 196,164,184
Ta 142,3,2048
Mvav 204,164,188
Ta 144,4,0
Mvav 208,128,184
Ta 146,4,2048
v_mul_f32 v192, v38, v192
Mvav 216,128,188
Ta 148,5,0
v_mul_f32 v193, v38, v193
Mvav 212,132,184
Ta 150,5,2048
v_mul_f32 v194, v38, v194
Mvav 220,132,188
s_waitcnt lgkmcnt(6)
Ta 152,2,4096
v_mul_f32 v195, v38, v195
v_mfma_f32_16x16x32_bf16 v[224:227], a[136:139], v[48:51], 0
Ta 154,2,6144
v_mul_f32 v196, v38, v196
v_mfma_f32_16x16x32_bf16 v[232:235], a[136:139], v[52:55], 0
s_waitcnt lgkmcnt(6)
Ta 156,3,4096
v_mul_f32 v197, v38, v197
v_mfma_f32_16x16x32_bf16 v[228:231], a[140:143], v[48:51], 0
LD 20,36,76,0
Ta 158,3,6144
v_mfma_f32_16x16x32_bf16 v[236:239], a[140:143], v[52:55], 0
s_waitcnt lgkmcnt(6)
Ta 160,4,4096
v_mul_f32 v198, v38, v198
v_mfma_f32_16x16x32_bf16 v[240:243], a[144:147], v[48:51], 0
Ta 162,4,6144
v_mul_f32 v199, v38, v199
v_mfma_f32_16x16x32_bf16 v[248:251], a[144:147], v[52:55], 0
s_waitcnt lgkmcnt(6)
Ta 164,5,4096
CV 192,192,193
v_mfma_f32_16x16x32_bf16 v[244:247], a[148:151], v[48:51], 0
s_mul_i32 s77, s100, 0x400
Ta 166,5,6144
v_min_u32 v46, 7, v1
v_mfma_f32_16x16x32_bf16 v[252:255], a[148:151], v[52:55], 0
s_waitcnt lgkmcnt(6)
s_mul_i32 s85, s66, 0x100000
Ta 128,2,8192
v_mul_u32_u24 v46, 0x80, v46
Mvav 224,152,56
LD 21,36,76,1024
Ta 130,2,10240
Mvav 232,152,60
s_waitcnt lgkmcnt(6)
s_add_u32 s77, s77, s85
Ta 132,3,8192
CV 193,194,195
Mvav 228,156,56
s_add_u32 s77, s77, 0x60000
Ta 134,3,10240
CV 194,196,197
Mvav 236,156,60
s_waitcnt lgkmcnt(6)
Ta 136,4,8192
CV 195,198,199
Mvav 240,160,56
buffer_load_dword v35, v46, s[48:51], s77 offen
Ta 138,4,10240
Mvav 248,160,60
s_waitcnt lgkmcnt(6)
Ta 140,5,8192
Ta 142,5,10240
Mvav 244,164,56
LD 22,36,76,2048
Ta 144,2,12288
Mvav 252,164,60
s_waitcnt lgkmcnt(7)
Ta 146,2,14336
v_mul_f32 v200, v39, v200
Mvav 224,128,64
Ta 148,3,12288
v_mul_f32 v201, v39, v201
Mvav 232,128,68
s_waitcnt lgkmcnt(7)
Ta 150,3,14336
v_mul_f32 v202, v39, v202
Mvav 228,132,64
Ta 152,4,12288
v_mul_f32 v203, v39, v203
Mvav 236,132,68
s_waitcnt lgkmcnt(7)
Ta 154,4,14336
v_mul_f32 v204, v39, v204
Mvav 240,136,64
LD 23,36,76,3072
Ta 156,5,12288
Mvav 248,136,68
s_waitcnt lgkmcnt(7)
s_add_u32 m0, s67, 0xa000
s_add_u32 s76, s95, 0x280100
Ta 158,5,14336
Mvav 244,140,64
Ta 160,2,16384
v_mul_f32 v205, v39, v205
Mvav 252,140,68
s_waitcnt lgkmcnt(7)
Ta 162,2,18432
v_mul_f32 v206, v39, v206
Mvav 224,144,72
Ta 164,3,16384
v_mul_f32 v207, v39, v207
Mvav 232,144,76
s_waitcnt lgkmcnt(7)
Ta 166,3,18432
CV 200,200,201
Mvav 228,148,72
LD 20,36,76,0
Ta 128,4,16384
Mvav 236,148,76
s_waitcnt lgkmcnt(7)
Ta 130,4,18432
Ta 132,5,16384
Mvav 240,152,72
Ta 134,5,18432
CV 201,202,203
Mvav 248,152,76
s_waitcnt lgkmcnt(8)
Ta 136,2,20480
CV 202,204,205
Mvav 244,156,72
Ta 138,2,22528
CV 203,206,207
Mvav 252,156,76
s_waitcnt lgkmcnt(8)
Ta 140,3,20480
v_mul_f32 v208, v38, v208
Mvav 224,160,80
LD 21,36,76,1024
Ta 142,3,22528
Mvav 232,160,84
s_waitcnt lgkmcnt(8)
Ta 144,4,20480
v_mul_f32 v209, v38, v209
Mvav 228,164,80
Ta 146,4,22528
v_mul_f32 v210, v38, v210
Mvav 236,164,84
s_waitcnt lgkmcnt(8)
Ta 148,5,20480
v_mul_f32 v211, v38, v211
Mvav 240,128,80
Ta 150,5,22528
v_mul_f32 v212, v38, v212
Mvav 248,128,84
s_waitcnt lgkmcnt(8)
Ta 152,2,24576
v_mul_f32 v213, v38, v213
Mvav 244,132,80
LD 22,36,76,2048
Ta 154,2,26624
Mvav 252,132,84
s_waitcnt lgkmcnt(8)
Ta 156,3,24576
Ta 158,3,26624
Mvav 224,136,88
s_and_b32 s85, s30, 31
Ta 160,4,24576
v_and_b32 v46, 32, v1
Mvav 232,136,92
s_waitcnt lgkmcnt(9)
s_lshl_b32 s85, s85, 8
Ta 162,4,26624
v_lshl_add_u32 v46, v46, 2, s85
Mvav 228,140,88
s_getpc_b64 s[96:97]
L_ca1_1:
s_add_u32 s96, s96, L_Amain+0-L_ca1_1
s_addc_u32 s97, s97, 0
Ta 164,5,24576
v_mul_f32 v214, v38, v214
Mvav 236,140,92
s_waitcnt lgkmcnt(9)
global_load_dword v35, v46, s[96:97]
Ta 166,5,26624
Mvav 240,144,88
s_waitcnt lgkmcnt(8)
Ta 128,2,28672
v_mul_f32 v215, v38, v215
Mvav 248,144,92
LD 23,36,76,3072
Ta 130,2,30720
Mvav 244,148,88
s_add_u32 m0, s67, 0xb000
s_add_u32 s76, s95, 0x2c0100
Ta 132,3,28672
Mvav 252,148,92
s_waitcnt lgkmcnt(9)
Ta 134,3,30720
CV 208,208,209
Mvav 224,152,96
Ta 136,4,28672
CV 209,210,211
Mvav 232,152,100
s_waitcnt lgkmcnt(8)
Ta 138,4,30720
CV 210,212,213
Mvav 228,156,96
LD 20,36,76,0
Ta 140,5,28672
Mvav 236,156,100
s_waitcnt lgkmcnt(8)
s_add_u32 m0, s67, 0x12000
Ta 142,5,30720
Ta 144,2,32768
Mvav 240,160,96
s_add_u32 s76, s95, 0x180
Ta 146,2,34816
Ta 148,3,32768
Mvav 248,160,100
s_waitcnt lgkmcnt(10)
Ta 150,3,34816
Ta 152,4,32768
Mvav 244,164,96
Ta 154,4,34816
Ta 156,5,32768
Mvav 252,164,100
s_waitcnt lgkmcnt(11)
Ta 158,5,34816
v_add_u32 v2, 0x9000, v2
Mvav 224,128,104
v_add_u32 v3, 0x9000, v3
v_add_u32 v4, 0x9000, v4
Mvav 232,128,108
v_add_u32 v5, 0x9000, v5
CV 211,214,215
Mvav 228,132,104
v_permlane32_swap_b32 v192, v194
Mvav 236,132,108
s_waitcnt lgkmcnt(8)
v_permlane32_swap_b32 v193, v195
Mvav 240,136,104
v_permlane16_swap_b32 v192, v194
Mvav 248,136,108
v_permlane16_swap_b32 v193, v195
Mvav 244,140,104
s_waitcnt vmcnt(22) lgkmcnt(0)
s_barrier
v_permlane32_swap_b32 v200, v202
Mvav 252,140,108
Ta 160,2,0
v_accvgpr_write_b32 a0, v192
Mvav 224,144,112
Ta 162,2,2048
v_accvgpr_write_b32 a1, v193
Mvav 232,144,116
Ta 164,3,0
v_accvgpr_write_b32 a2, v194
Mvav 228,148,112
Ta 166,3,2048
Ta 128,4,0
Mvav 236,148,116
Ta 130,4,2048
v_accvgpr_write_b32 a3, v195
Mvav 240,152,112
Ta 132,5,0
v_mul_f32 v216, v39, v216
Mvav 248,152,116
Ta 134,5,2048
v_mul_f32 v217, v39, v217
Mvav 244,156,112
Ta 136,2,4096
v_mul_f32 v218, v39, v218
Mvav 252,156,116
s_waitcnt lgkmcnt(7)
Ta 138,2,6144
v_mul_f32 v219, v39, v219
Mvav 224,160,120
Ta 140,3,4096
v_mul_f32 v220, v39, v220
Mvav 232,160,124
s_waitcnt lgkmcnt(7)
Ta 142,3,6144
v_mul_f32 v221, v39, v221
Mvav 228,164,120
LD 20,36,76,0
Ta 144,4,4096
Mvav 236,164,124
s_waitcnt lgkmcnt(7)
Ta 146,4,6144
v_mul_f32 v222, v39, v222
Mvav 240,128,120
Ta 148,5,4096
v_mul_f32 v223, v39, v223
Mvav 248,128,124
s_waitcnt lgkmcnt(7)
Ta 150,5,6144
CV 216,216,217
Mvav 244,132,120
s_mul_i32 s77, s100, 0x400
Ta 152,2,8192
v_min_u32 v46, 7, v1
Mvav 252,132,124
s_waitcnt lgkmcnt(7)
s_mul_i32 s85, s66, 0x100000
Ta 154,2,10240
Ta 156,3,8192
Mvav 224,136,128
LD 21,36,76,1024
Ta 158,3,10240
Mvav 232,136,132
s_waitcnt lgkmcnt(8)
s_add_u32 s77, s77, s85
Ta 160,4,8192
v_mul_u32_u24 v46, 0x80, v46
Mvav 228,140,128
s_add_u32 s77, s77, 0x70000
Ta 162,4,10240
CV 217,218,219
Mvav 236,140,132
s_waitcnt lgkmcnt(8)
Ta 164,5,8192
CV 218,220,221
Mvav 240,144,128
buffer_load_dword v35, v46, s[44:47], s77 offen
Ta 166,5,10240
Mvav 248,144,132
s_waitcnt lgkmcnt(8)
Ta 128,2,12288
CV 219,222,223
Mvav 244,148,128
LD 22,36,76,2048
Ta 130,2,14336
Mvav 252,148,132
s_waitcnt lgkmcnt(8)
Ta 132,3,12288
Mvav 224,152,136
Ta 134,3,14336
Mvav 232,152,140
s_waitcnt lgkmcnt(8)
Ta 136,4,12288
Mvav 228,156,136
Ta 138,4,14336
Mvav 236,156,140
s_waitcnt lgkmcnt(8)
Ta 140,5,12288
Mvav 240,160,136
LD 23,36,76,3072
Ta 142,5,14336
Mvav 248,160,140
s_waitcnt lgkmcnt(8)
s_add_u32 m0, s67, 0x13000
s_add_u32 s76, s95, 0x40180
Ta 144,2,16384
Mvav 244,164,136
Ta 146,2,18432
Ta 148,3,16384
Mvav 252,164,140
s_waitcnt lgkmcnt(9)
Ta 150,3,18432
Mvav 224,128,144
Ta 152,4,16384
Mvav 232,128,148
s_waitcnt lgkmcnt(9)
Ta 154,4,18432
Mvav 228,132,144
LD 20,36,76,0
Ta 156,5,16384
Mvav 236,132,148
s_waitcnt lgkmcnt(9)
Ta 158,5,18432
Mvav 240,136,144
Ta 160,2,20480
Mvav 248,136,148
s_waitcnt lgkmcnt(9)
Ta 162,2,22528
Mvav 244,140,144
Ta 164,3,20480
Mvav 252,140,148
s_waitcnt lgkmcnt(8)
Ta 166,3,22528
Mvav 224,144,152
LD 21,36,76,1024
Ta 128,4,20480
Mvav 232,144,156
s_waitcnt lgkmcnt(8)
Ta 130,4,22528
Mvav 228,148,152
Ta 132,5,20480
Ta 134,5,22528
Mvav 236,148,156
s_waitcnt lgkmcnt(9)
Ta 136,2,24576
Mvav 240,152,152
Ta 138,2,26624
Mvav 248,152,156
s_waitcnt lgkmcnt(9)
Ta 140,3,24576
Mvav 244,156,152
LD 22,36,76,2048
Ta 142,3,26624
Mvav 252,156,156
s_waitcnt lgkmcnt(9)
Ta 144,4,24576
Mvav 224,160,160
Ta 146,4,26624
Mvav 232,160,164
s_waitcnt lgkmcnt(9)
Ta 148,5,24576
Mvav 228,164,160
Ta 150,5,26624
Mvav 236,164,164
s_waitcnt lgkmcnt(8)
Ta 152,2,28672
Mvav 240,128,160
LD 23,36,76,3072
Ta 154,2,30720
Mvav 248,128,164
s_add_u32 m0, s67, 0x14000
s_add_u32 s76, s95, 0x80180
Ta 156,3,28672
Mvav 244,132,160
Ta 158,3,30720
Mvav 252,132,164
s_waitcnt lgkmcnt(8)
Ta 160,4,28672
Ta 162,4,30720
Mvav 224,136,168
Ta 164,5,28672
Mvav 232,136,172
s_waitcnt lgkmcnt(7)
Ta 166,5,30720
Mvav 228,140,168
LD 20,36,76,0
Ta 128,2,32768
Mvav 236,140,172
s_add_u32 m0, s67, 0x1b000
Ta 130,2,34816
Ta 132,3,32768
Mvav 240,144,168
s_add_u32 s76, s95, 0x240180
Ta 134,3,34816
Ta 136,4,32768
Mvav 248,144,172
Ta 138,4,34816
Ta 140,5,32768
Mvav 244,148,168
Ta 142,5,34816
v_add_u32 v2, 0xfffe5000, v2
Mvav 252,148,172
s_waitcnt lgkmcnt(11)
v_permlane32_swap_b32 v201, v203
Mvav 224,152,176
v_permlane16_swap_b32 v200, v202
Mvav 232,152,180
v_permlane16_swap_b32 v201, v203
Mvav 228,156,176
v_permlane32_swap_b32 v208, v210
Mvav 236,156,180
s_waitcnt lgkmcnt(7)
v_permlane32_swap_b32 v209, v211
Mvav 240,160,176
v_permlane16_swap_b32 v208, v210
Mvav 248,160,180
s_waitcnt vmcnt(22) lgkmcnt(0)
s_barrier
v_permlane16_swap_b32 v209, v211
v_add_u32 v3, 0xfffe5000, v3
Mvav 244,164,176
Ta 144,2,0
v_add_u32 v4, 0xfffe5000, v4
Mvav 252,164,180
Ta 146,2,2048
v_add_u32 v5, 0xfffe5000, v5
Mvav 224,128,184
Ta 148,3,0
v_accvgpr_write_b32 a4, v200
Mvav 232,128,188
Ta 150,3,2048
v_accvgpr_write_b32 a5, v201
Mvav 228,132,184
Ta 152,4,0
v_accvgpr_write_b32 a6, v202
Mvav 236,132,188
Ta 154,4,2048
v_accvgpr_write_b32 a7, v203
Mvav 240,136,184
Ta 156,5,0
v_accvgpr_write_b32 a8, v208
Mvav 248,136,188
Ta 158,5,2048
v_accvgpr_write_b32 a9, v209
Mvav 244,140,184
Ta 160,2,4096
v_accvgpr_write_b32 a10, v210
Mvav 252,140,188
s_waitcnt lgkmcnt(7)
Ta 162,2,6144
v_accvgpr_write_b32 a11, v211
v_mfma_f32_16x16x32_bf16 v[192:195], a[144:147], v[48:51], 0
Ta 164,3,4096
v_mul_f32 v224, v38, v224
v_mfma_f32_16x16x32_bf16 v[200:203], a[144:147], v[52:55], 0
s_waitcnt lgkmcnt(7)
Ta 166,3,6144
v_mul_f32 v225, v38, v225
v_mfma_f32_16x16x32_bf16 v[196:199], a[148:151], v[48:51], 0
LD 20,36,76,0
Ta 128,4,4096
v_permlane32_swap_b32 v216, v218
v_mfma_f32_16x16x32_bf16 v[204:207], a[148:151], v[52:55], 0
s_waitcnt lgkmcnt(7)
Ta 130,4,6144
v_permlane32_swap_b32 v217, v219
v_mfma_f32_16x16x32_bf16 v[208:211], a[152:155], v[48:51], 0
v_permlane16_swap_b32 v216, v218
v_permlane16_swap_b32 v217, v219
v_accvgpr_write_b32 a12, v216
v_accvgpr_write_b32 a14, v218
v_accvgpr_write_b32 a13, v217
v_accvgpr_write_b32 a15, v219
v_mfma_f32_16x16x32_bf16 v[216:219], a[152:155], v[52:55], 0
s_waitcnt lgkmcnt(5)
Ta 132,5,4096
v_mul_f32 v226, v38, v226
v_mfma_f32_16x16x32_bf16 v[212:215], a[156:159], v[48:51], 0
s_mul_i32 s77, s100, 0x400
Ta 134,5,6144
v_min_u32 v46, 7, v1
v_mfma_f32_16x16x32_bf16 v[220:223], a[156:159], v[52:55], 0
s_waitcnt lgkmcnt(5)
L_pg10_3:
s_cbranch_execz L_ret10
s_mul_i32 s85, s66, 0x100000
Ta 136,2,8192
v_mul_u32_u24 v46, 0x80, v46
Mvav 192,160,56
LD 21,36,76,1024
Ta 138,2,10240
Mvav 200,160,60
s_waitcnt lgkmcnt(5)
s_add_u32 s77, s77, s85
Ta 140,3,8192
v_mul_f32 v227, v38, v227
Mvav 196,164,56
s_add_u32 s77, s77, 0x70000
Ta 142,3,10240
v_mul_f32 v228, v38, v228
Mvav 204,164,60
s_waitcnt lgkmcnt(6)
Ta 144,4,8192
v_mul_f32 v229, v38, v229
Mvav 208,128,56
buffer_load_dword v35, v46, s[48:51], s77 offen
Ta 146,4,10240
Mvav 216,128,60
s_waitcnt lgkmcnt(6)
Ta 148,5,8192
v_mul_f32 v230, v38, v230
Mvav 212,132,56
LD 22,36,76,2048
Ta 150,5,10240
Mvav 220,132,60
s_waitcnt lgkmcnt(6)
Ta 152,2,12288
Ta 154,2,14336
Mvav 192,136,64
Ta 156,3,12288
v_mul_f32 v231, v38, v231
Mvav 200,136,68
s_waitcnt lgkmcnt(7)
Ta 158,3,14336
CV 224,224,225
Mvav 196,140,64
Ta 160,4,12288
CV 225,226,227
Mvav 204,140,68
s_waitcnt lgkmcnt(7)
Ta 162,4,14336
CV 226,228,229
Mvav 208,144,64
LD 23,36,76,3072
Ta 164,5,12288
Mvav 216,144,68
s_waitcnt lgkmcnt(7)
s_add_u32 m0, s67, 0x1c000
s_add_u32 s76, s95, 0x280180
Ta 166,5,14336
Mvav 212,148,64
Ta 128,2,16384
CV 227,230,231
Mvav 220,148,68
s_waitcnt lgkmcnt(7)
Ta 130,2,18432
v_mul_f32 v232, v39, v232
Mvav 192,152,72
Ta 132,3,16384
v_mul_f32 v233, v39, v233
Mvav 200,152,76
s_waitcnt lgkmcnt(7)
Ta 134,3,18432
v_mul_f32 v234, v39, v234
Mvav 196,156,72
LD 20,36,76,0
Ta 136,4,16384
Mvav 204,156,76
s_waitcnt lgkmcnt(7)
Ta 138,4,18432
v_mul_f32 v235, v39, v235
Mvav 208,160,72
Ta 140,5,16384
v_mul_f32 v236, v39, v236
Mvav 216,160,76
s_waitcnt lgkmcnt(7)
Ta 142,5,18432
Ta 144,2,20480
Mvav 212,164,72
Ta 146,2,22528
v_mul_f32 v237, v39, v237
Mvav 220,164,76
s_waitcnt lgkmcnt(8)
Ta 148,3,20480
v_mul_f32 v238, v39, v238
Mvav 192,128,80
LD 21,36,76,1024
Ta 150,3,22528
Mvav 200,128,84
s_waitcnt lgkmcnt(8)
Ta 152,4,20480
v_mul_f32 v239, v39, v239
Mvav 196,132,80
Ta 154,4,22528
CV 232,232,233
Mvav 204,132,84
s_waitcnt lgkmcnt(8)
Ta 156,5,20480
CV 233,234,235
Mvav 208,136,80
Ta 158,5,22528
CV 234,236,237
Mvav 216,136,84
s_waitcnt lgkmcnt(8)
Ta 160,2,24576
CV 235,238,239
Mvav 212,140,80
LD 22,36,76,2048
Ta 162,2,26624
Mvav 220,140,84
s_waitcnt lgkmcnt(8)
Ta 164,3,24576
v_mul_f32 v240, v38, v240
Mvav 192,144,88
s_and_b32 s85, s30, 31
Ta 166,3,26624
v_and_b32 v46, 32, v1
Mvav 200,144,92
s_waitcnt lgkmcnt(8)
s_lshl_b32 s85, s85, 8
Ta 128,4,24576
v_lshl_add_u32 v46, v46, 2, s85
Mvav 196,148,88
s_getpc_b64 s[96:97]
L_ca2_1:
s_add_u32 s96, s96, L_Amain+8192-L_ca2_1
s_addc_u32 s97, s97, 0
Ta 130,4,26624
Ta 132,5,24576
Mvav 204,148,92
s_waitcnt lgkmcnt(9)
global_load_dword v35, v46, s[96:97]
Ta 134,5,26624
Mvav 208,152,88
s_waitcnt lgkmcnt(8)
Ta 136,2,28672
v_mul_f32 v241, v38, v241
Mvav 216,152,92
LD 23,36,76,3072
Ta 138,2,30720
Mvav 212,156,88
s_add_u32 m0, s67, 0x1d000
s_add_u32 s76, s95, 0x2c0180
Ta 140,3,28672
Mvav 220,156,92
s_waitcnt lgkmcnt(9)
Ta 142,3,30720
v_mul_f32 v242, v38, v242
Mvav 192,160,96
Ta 144,4,28672
v_mul_f32 v243, v38, v243
Mvav 200,160,100
s_waitcnt lgkmcnt(9)
Ta 146,4,30720
v_mul_f32 v244, v38, v244
Mvav 196,164,96
LD 20,36,76,0
Ta 148,5,28672
Mvav 204,164,100
s_waitcnt lgkmcnt(8)
s_add_u32 m0, s69, 0
Ta 150,5,30720
Ta 152,2,32768
Mvav 208,128,96
s_add_u32 s76, s71, 0x60000
Ta 154,2,34816
Ta 156,3,32768
Mvav 216,128,100
s_waitcnt lgkmcnt(10)
Ta 158,3,34816
Ta 160,4,32768
Mvav 212,132,96
Ta 162,4,34816
Ta 164,5,32768
Mvav 220,132,100
s_waitcnt lgkmcnt(11)
Ta 166,5,34816
v_add_u32 v2, 0x9000, v2
v_add_u32 v3, 0x9000, v3
Mvav 192,136,104
v_add_u32 v4, 0x9000, v4
v_add_u32 v5, 0x9000, v5
Mvav 200,136,108
v_permlane32_swap_b32 v224, v226
Mvav 196,140,104
v_permlane32_swap_b32 v225, v227
Mvav 204,140,108
s_waitcnt lgkmcnt(7)
v_permlane16_swap_b32 v224, v226
Mvav 208,144,104
v_permlane16_swap_b32 v225, v227
Mvav 216,144,108
s_waitcnt vmcnt(21) lgkmcnt(0)
s_barrier
v_permlane32_swap_b32 v232, v234
Mvav 212,148,104
Ta 128,2,0
v_accvgpr_write_b32 a16, v224
Mvav 220,148,108
Ta 130,2,2048
v_accvgpr_write_b32 a17, v225
Mvav 192,152,112
Ta 132,3,0
v_accvgpr_write_b32 a18, v226
Mvav 200,152,116
Ta 134,3,2048
v_accvgpr_write_b32 a19, v227
Mvav 196,156,112
Ta 136,4,0
v_mul_f32 v245, v38, v245
Mvav 204,156,116
Ta 138,4,2048
v_mul_f32 v246, v38, v246
Mvav 208,160,112
Ta 140,5,0
v_mul_f32 v247, v38, v247
Mvav 216,160,116
Ta 142,5,2048
Ta 144,2,4096
Mvav 212,164,112
Ta 146,2,6144
CV 240,240,241
Mvav 220,164,116
s_waitcnt lgkmcnt(8)
Ta 148,3,4096
CV 241,242,243
Mvav 192,128,120
Ta 150,3,6144
CV 242,244,245
Mvav 200,128,124
s_waitcnt lgkmcnt(8)
Ta 152,4,4096
CV 243,246,247
Mvav 196,132,120
LD 12,44,76,0
Ta 154,4,6144
Mvav 204,132,124
s_waitcnt lgkmcnt(8)
Ta 156,5,4096
v_mul_f32 v248, v39, v248
Mvav 208,136,120
Ta 158,5,6144
v_mul_f32 v249, v39, v249
Mvav 216,136,124
s_waitcnt lgkmcnt(8)
Ta 160,2,8192
v_mul_f32 v250, v39, v250
Mvav 212,140,120
Ta 162,2,10240
v_mul_f32 v251, v39, v251
Mvav 220,140,124
s_waitcnt lgkmcnt(8)
Ta 164,3,8192
v_mul_f32 v252, v39, v252
Mvav 192,144,128
Ta 166,3,10240
v_mul_f32 v253, v39, v253
Mvav 200,144,132
s_waitcnt lgkmcnt(8)
Ta 128,4,8192
v_mul_f32 v254, v39, v254
Mvav 196,148,128
Ta 130,4,10240
Ta 132,5,8192
Mvav 204,148,132
s_waitcnt lgkmcnt(9)
Ta 134,5,10240
v_mul_f32 v255, v39, v255
Mvav 208,152,128
Ta 136,2,12288
CV 248,248,249
Mvav 216,152,132
s_waitcnt lgkmcnt(9)
Ta 138,2,14336
CV 249,250,251
Mvav 212,156,128
LD 13,44,76,1024
Ta 140,3,12288
Mvav 220,156,132
s_waitcnt lgkmcnt(9)
Ta 142,3,14336
CV 250,252,253
Mvav 192,160,136
Ta 144,4,12288
CV 251,254,255
Mvav 200,160,140
s_waitcnt lgkmcnt(9)
Ta 146,4,14336
v_and_b32 v20, 15, v1
Mvav 196,164,136
Ta 148,5,12288
v_lshrrev_b32 v21, 4, v1
Mvav 204,164,140
s_waitcnt lgkmcnt(8)
Ta 150,5,14336
v_xor_b32 v21, v21, v20
Mvav 208,128,136
Ta 152,2,16384
v_lshlrev_b32 v20, 8, v20
Mvav 216,128,140
s_waitcnt lgkmcnt(8)
Ta 154,2,18432
v_lshl_add_u32 v20, v21, 4, v20
Mvav 212,132,136
Ta 156,3,16384
v_xor_b32 v21, 64, v20
Mvav 220,132,140
s_waitcnt lgkmcnt(8)
Ta 158,3,18432
Ta 160,4,16384
Mvav 192,136,144
Ta 162,4,18432
v_xor_b32 v22, 0x80, v20
Mvav 200,136,148
s_waitcnt lgkmcnt(9)
Ta 164,5,16384
v_xor_b32 v23, 0xc0, v20
Mvav 196,140,144
Ta 166,5,18432
Mvav 204,140,148
s_waitcnt lgkmcnt(9)
Ta 128,2,20480
Mvav 208,144,144
LD 14,44,76,2048
Ta 130,2,22528
Mvav 216,144,148
s_waitcnt lgkmcnt(9)
Ta 132,3,20480
Mvav 212,148,144
Ta 134,3,22528
Mvav 220,148,148
s_waitcnt lgkmcnt(9)
Ta 136,4,20480
Mvav 192,152,152
Ta 138,4,22528
Mvav 200,152,156
s_waitcnt lgkmcnt(8)
Ta 140,5,20480
Mvav 196,156,152
Ta 142,5,22528
Mvav 204,156,156
Ta 144,2,24576
Mvav 208,160,152
Ta 146,2,26624
Mvav 216,160,156
s_waitcnt lgkmcnt(8)
Ta 148,3,24576
Ta 150,3,26624
Mvav 212,164,152
Ta 152,4,24576
Mvav 220,164,156
Ta 154,4,26624
Mvav 192,128,160
Ta 156,5,24576
Mvav 200,128,164
s_waitcnt lgkmcnt(9)
Ta 158,5,26624
Mvav 196,132,160
LD 15,44,76,3072
Ta 160,2,28672
Mvav 204,132,164
s_add_u32 m0, s69, 0x9000
Ta 162,2,30720
s_add_u32 s76, s71, 0x64000
Mvav 208,136,160
Ta 164,3,28672
Mvav 216,136,164
s_waitcnt lgkmcnt(9)
Ta 166,3,30720
Mvav 212,140,160
Ta 128,4,28672
Mvav 220,140,164
Ta 130,4,30720
Mvav 192,144,168
Ta 132,5,28672
Mvav 200,144,172
s_waitcnt lgkmcnt(8)
Ta 134,5,30720
Mvav 196,148,168
Ta 136,2,32768
Ta 138,2,34816
Mvav 204,148,172
Ta 140,3,32768
Ta 142,3,34816
Mvav 208,152,168
Ta 144,4,32768
Ta 146,4,34816
Mvav 216,152,172
s_waitcnt lgkmcnt(10)
Ta 148,5,32768
Ta 150,5,34816
Mvav 212,156,168
v_permlane32_swap_b32 v233, v235
Mvav 220,156,172
v_permlane16_swap_b32 v232, v234
Mvav 192,160,176
v_permlane16_swap_b32 v233, v235
Mvav 200,160,180
v_permlane32_swap_b32 v240, v242
Mvav 196,164,176
v_permlane32_swap_b32 v241, v243
Mvav 204,164,180
s_waitcnt lgkmcnt(6)
v_permlane16_swap_b32 v240, v242
Mvav 208,128,176
s_waitcnt vmcnt(15) lgkmcnt(0)
s_barrier
v_permlane16_swap_b32 v241, v243
Mvav 216,128,180
v_permlane32_swap_b32 v248, v250
Mvav 212,132,176
v_permlane32_swap_b32 v249, v251
Mvav 220,132,180
v_permlane16_swap_b32 v248, v250
v_add_u32 v2, 0x9000, v2
Mvav 192,136,184
Ta 152,2,0
Ta 154,2,2048
Mvav 200,136,188
Ta 128,2,4096
v_add_u32 v3, 0x9000, v3
Mvav 196,140,184
Ta 156,3,0
Ta 158,3,2048
Mvav 204,140,188
Ta 130,2,6144
v_add_u32 v4, 0x9000, v4
Mvav 208,144,184
Ta 160,4,0
Ta 162,4,2048
Mvav 216,144,188
Ta 132,3,4096
v_add_u32 v5, 0x9000, v5
Mvav 212,148,184
Ta 164,5,0
v_accvgpr_write_b32 a20, v232
Mvav 220,148,188
s_waitcnt lgkmcnt(8)
Ta 166,5,2048
v_accvgpr_write_b32 a21, v233
v_mfma_f32_16x16x32_bf16 v[224:227], a[152:155], v[48:51], 0
v_accvgpr_write_b32 a22, v234
v_accvgpr_write_b32 a23, v235
v_mfma_f32_16x16x32_bf16 v[232:235], a[152:155], v[52:55], 0
s_waitcnt lgkmcnt(6)
Ta 134,3,6144
v_accvgpr_write_b32 a24, v240
v_mfma_f32_16x16x32_bf16 v[228:231], a[156:159], v[48:51], 0
LD 12,44,76,0
Ta 136,4,4096
v_mfma_f32_16x16x32_bf16 v[236:239], a[156:159], v[52:55], 0
s_waitcnt lgkmcnt(5)
v_accvgpr_write_b32 a25, v241
v_accvgpr_write_b32 a26, v242
v_accvgpr_write_b32 a27, v243
v_mfma_f32_16x16x32_bf16 v[240:243], a[160:163], v[48:51], 0
v_permlane16_swap_b32 v249, v251
v_accvgpr_write_b32 a28, v248
v_accvgpr_write_b32 a30, v250
v_accvgpr_write_b32 a29, v249
v_accvgpr_write_b32 a31, v251
v_mfma_f32_16x16x32_bf16 v[248:251], a[160:163], v[52:55], 0
s_waitcnt lgkmcnt(2)
Ta 138,4,6144
Ta 140,5,4096
v_mfma_f32_16x16x32_bf16 v[244:247], a[164:167], v[48:51], 0
Ta 142,5,6144
v_mul_f32 v192, v38, v192
v_mfma_f32_16x16x32_bf16 v[252:255], a[164:167], v[52:55], 0
Ta 144,2,8192
v_mul_f32 v193, v38, v193
Mvav 224,128,56
LD 13,44,76,1024
Ta 146,2,10240
Mvav 232,128,60
s_waitcnt lgkmcnt(6)
Ta 148,3,8192
v_mul_f32 v200, v39, v200
Mvav 228,132,56
Ta 150,3,10240
v_mul_f32 v201, v39, v201
Mvav 236,132,60
s_waitcnt lgkmcnt(6)
Ta 152,4,8192
Ta 154,4,10240
Mvav 240,136,56
Ta 156,5,8192
v_mul_f32 v208, v38, v208
Mvav 248,136,60
s_waitcnt lgkmcnt(7)
Ta 158,5,10240
v_mul_f32 v209, v38, v209
Mvav 244,140,56
LD 14,44,76,2048
Ta 160,2,12288
Mvav 252,140,60
s_waitcnt lgkmcnt(7)
Ta 162,2,14336
v_mul_f32 v216, v39, v216
Mvav 224,144,64
Ta 164,3,12288
v_mul_f32 v217, v39, v217
Mvav 232,144,68
s_waitcnt lgkmcnt(7)
Ta 166,3,14336
v_mul_f32 v194, v38, v194
Mvav 228,148,64
Ta 128,4,12288
Ta 130,4,14336
Mvav 236,148,68
s_waitcnt lgkmcnt(8)
Ta 132,5,12288
v_mul_f32 v195, v38, v195
Mvav 240,152,64
Ta 134,5,14336
v_mul_f32 v202, v39, v202
Mvav 248,152,68
s_waitcnt lgkmcnt(8)
Ta 136,2,16384
v_mul_f32 v203, v39, v203
Mvav 244,156,64
LD 15,44,76,3072
Ta 138,2,18432
Mvav 252,156,68
s_waitcnt lgkmcnt(8)
s_add_u32 m0, s69, 0xd000
s_add_u32 s76, s73, 0x60000
Ta 140,3,16384
Mvav 224,160,72
Ta 142,3,18432
v_mul_f32 v210, v38, v210
Mvav 232,160,76
s_waitcnt lgkmcnt(8)
Ta 144,4,16384
v_mul_f32 v211, v38, v211
Mvav 228,164,72
Ta 146,4,18432
v_mul_f32 v218, v39, v218
Mvav 236,164,76
s_waitcnt lgkmcnt(8)
Ta 148,5,16384
v_mul_f32 v219, v39, v219
Mvav 240,128,72
LD 16,48,76,0
Ta 150,5,18432
Mvav 248,128,76
s_waitcnt lgkmcnt(8)
Ta 152,2,20480
v_mul_f32 v196, v38, v196
Mvav 244,132,72
Ta 154,2,22528
v_mul_f32 v197, v38, v197
Mvav 252,132,76
s_waitcnt lgkmcnt(8)
Ta 156,3,20480
Ta 158,3,22528
Mvav 224,136,80
Ta 160,4,20480
v_mul_f32 v198, v38, v198
Mvav 232,136,84
s_waitcnt lgkmcnt(9)
Ta 162,4,22528
v_mul_f32 v199, v38, v199
Mvav 228,140,80
LD 17,48,76,1024
Ta 164,5,20480
Mvav 236,140,84
s_waitcnt lgkmcnt(9)
Ta 166,5,22528
CV 192,192,193
Mvav 240,144,80
Ta 128,2,24576
v_mul_f32 v204, v39, v204
Mvav 248,144,84
s_waitcnt lgkmcnt(9)
Ta 130,2,26624
v_mul_f32 v205, v39, v205
Mvav 244,148,80
Ta 132,3,24576
v_mul_f32 v206, v39, v206
Mvav 252,148,84
s_waitcnt lgkmcnt(9)
Ta 134,3,26624
v_mul_f32 v207, v39, v207
Mvav 224,152,88
L_pg10_4:
s_cbranch_execz L_ret10
s_and_b32 s85, s30, 31
Ta 136,4,24576
v_and_b32 v46, 32, v1
Mvav 232,152,92
s_waitcnt lgkmcnt(8)
s_lshl_b32 s85, s85, 8
Ta 138,4,26624
v_lshl_add_u32 v46, v46, 2, s85
Mvav 228,156,88
LD 18,48,76,2048
Ta 140,5,24576
Mvav 236,156,92
s_waitcnt lgkmcnt(9)
s_getpc_b64 s[96:97]
L_ca3_1:
s_add_u32 s96, s96, L_Amain+16384-L_ca3_1
s_addc_u32 s97, s97, 0
Ta 142,5,26624
CV 200,200,201
Mvav 240,160,88
Ta 144,2,28672
v_mul_f32 v212, v38, v212
Mvav 248,160,92
s_waitcnt lgkmcnt(8)
Ta 146,2,30720
Ta 148,3,28672
Mvav 244,164,88
global_load_dword v35, v46, s[96:97]
Ta 150,3,30720
Mvav 252,164,92
s_waitcnt lgkmcnt(9)
Ta 152,4,28672
v_mul_f32 v213, v38, v213
Mvav 224,128,96
LD 19,48,76,3072
Ta 154,4,30720
Mvav 232,128,100
s_waitcnt lgkmcnt(9)
s_add_u32 m0, s69, 0x12000
Ta 156,5,28672
v_mul_f32 v214, v38, v214
Mvav 228,132,96
s_add_u32 s76, s71, 0x68000
Ta 158,5,30720
v_mul_f32 v215, v38, v215
Mvav 236,132,100
s_waitcnt lgkmcnt(9)
Ta 160,2,32768
Ta 162,2,34816
Mvav 240,136,96
Ta 164,3,32768
Ta 166,3,34816
Mvav 248,136,100
s_waitcnt lgkmcnt(10)
Ta 128,4,32768
Ta 130,4,34816
Mvav 244,140,96
Ta 132,5,32768
Ta 134,5,34816
Mvav 252,140,100
v_add_u32 v2, 0x9000, v2
v_add_u32 v3, 0x9000, v3
Mvav 224,144,104
v_add_u32 v4, 0x9000, v4
v_add_u32 v5, 0x9000, v5
Mvav 232,144,108
s_waitcnt lgkmcnt(9)
CV 208,208,209
v_mul_f32 v220, v39, v220
Mvav 228,148,104
v_mul_f32 v221, v39, v221
v_mul_f32 v222, v39, v222
v_mul_f32 v223, v39, v223
Mvav 236,148,108
CV 216,216,217
CV 193,194,195
Mvav 240,152,104
s_waitcnt vmcnt(13) lgkmcnt(0)
s_barrier
CV 201,202,203
CV 209,210,211
Mvav 248,152,108
Ta 136,2,0
CV 217,218,219
Mvav 244,156,104
Ta 138,2,2048
CV 194,196,197
Mvav 252,156,108
Ta 140,3,0
CV 195,198,199
Mvav 224,160,112
Ta 142,3,2048
CV 202,204,205
Mvav 232,160,116
Ta 144,4,0
CV 203,206,207
Mvav 228,164,112
Ta 146,4,2048
CV 210,212,213
Mvav 236,164,116
Ta 148,5,0
CV 211,214,215
Mvav 240,128,112
Ta 150,5,2048
CV 218,220,221
Mvav 248,128,116
Ta 152,2,4096
CV 219,222,223
Mvav 244,132,112
Ta 154,2,6144
Mvav 252,132,116
s_waitcnt lgkmcnt(8)
Ta 156,3,4096
Ta 158,3,6144
Mvav 224,136,120
Ta 160,4,4096
Mvav 232,136,124
s_waitcnt lgkmcnt(9)
Ta 162,4,6144
Mvav 228,140,120
LD 12,44,76,0
Ta 164,5,4096
Mvav 236,140,124
s_waitcnt lgkmcnt(9)
Ta 166,5,6144
Mvav 240,144,120
Ta 128,2,8192
Mvav 248,144,124
s_waitcnt lgkmcnt(9)
Ta 130,2,10240
Mvav 244,148,120
Ta 132,3,8192
Mvav 252,148,124
s_waitcnt lgkmcnt(9)
Ta 134,3,10240
Mvav 224,152,128
LD 13,44,76,1024
Ta 136,4,8192
Mvav 232,152,132
s_waitcnt lgkmcnt(8)
Ta 138,4,10240
Mvav 228,156,128
Ta 140,5,8192
Mvav 236,156,132
s_waitcnt lgkmcnt(9)
Ta 142,5,10240
Mvav 240,160,128
Ta 144,2,12288
Mvav 248,160,132
s_waitcnt lgkmcnt(8)
Ta 146,2,14336
Ta 148,3,12288
Mvav 244,164,128
LD 14,44,76,2048
Ta 150,3,14336
Mvav 252,164,132
s_waitcnt lgkmcnt(9)
Ta 152,4,12288
Mvav 224,128,136
Ta 154,4,14336
Mvav 232,128,140
s_waitcnt lgkmcnt(9)
Ta 156,5,12288
Mvav 228,132,136
Ta 158,5,14336
Mvav 236,132,140
s_waitcnt lgkmcnt(9)
Ta 160,2,16384
Mvav 240,136,136
Ta 162,2,18432
Mvav 248,136,140
s_waitcnt lgkmcnt(9)
Ta 164,3,16384
Mvav 244,140,136
LD 15,44,76,3072
Ta 166,3,18432
Mvav 252,140,140
s_waitcnt lgkmcnt(9)
s_add_u32 m0, s69, 0x16000
s_add_u32 s76, s73, 0x64000
Ta 128,4,16384
Mvav 224,144,144
Ta 130,4,18432
Mvav 232,144,148
s_waitcnt lgkmcnt(8)
Ta 132,5,16384
Mvav 228,148,144
Ta 134,5,18432
v_permlane32_swap_b32 v192, v194
Mvav 236,148,148
Ta 136,2,20480
Mvav 240,152,144
LD 16,48,76,0
Ta 138,2,22528
Mvav 248,152,148
s_waitcnt lgkmcnt(8)
Ta 140,3,20480
Mvav 244,156,144
Ta 142,3,22528
Mvav 252,156,148
Ta 144,4,20480
Mvav 224,160,152
Ta 146,4,22528
Mvav 232,160,156
s_waitcnt lgkmcnt(8)
Ta 148,5,20480
Mvav 228,164,152
LD 17,48,76,1024
Ta 150,5,22528
Mvav 236,164,156
Ta 152,2,24576
Mvav 240,128,152
Ta 154,2,26624
Mvav 248,128,156
s_waitcnt lgkmcnt(9)
Ta 156,3,24576
Mvav 244,132,152
Ta 158,3,26624
Mvav 252,132,156
s_waitcnt lgkmcnt(8)
Ta 160,4,24576
Ta 162,4,26624
Mvav 224,136,160
Ta 164,5,24576
Mvav 232,136,164
Ta 166,5,26624
Mvav 228,140,160
LD 18,48,76,2048
Ta 128,2,28672
Mvav 236,140,164
s_waitcnt lgkmcnt(9)
Ta 130,2,30720
Mvav 240,144,160
Ta 132,3,28672
Mvav 248,144,164
Ta 134,3,30720
Mvav 244,148,160
Ta 136,4,28672
Mvav 252,148,164
s_waitcnt lgkmcnt(9)
Ta 138,4,30720
Mvav 224,152,168
LD 19,48,76,3072
Ta 140,5,28672
Mvav 232,152,172
s_add_u32 m0, s69, 0x1b000
Ta 142,5,30720
s_add_u32 s76, s71, 0x6c000
Mvav 228,156,168
Ta 144,2,32768
Mvav 236,156,172
s_waitcnt lgkmcnt(8)
Ta 146,2,34816
Ta 148,3,32768
Mvav 240,160,168
Ta 150,3,34816
Ta 152,4,32768
Mvav 248,160,172
Ta 154,4,34816
Ta 156,5,32768
Mvav 244,164,168
Ta 158,5,34816
v_add_u32 v2, 0xfffe5000, v2
Mvav 252,164,172
s_waitcnt lgkmcnt(11)
v_permlane32_swap_b32 v193, v195
Mvav 224,128,176
v_permlane32_swap_b32 v200, v202
Mvav 232,128,180
v_permlane32_swap_b32 v201, v203
Mvav 228,132,176
v_permlane32_swap_b32 v208, v210
Mvav 236,132,180
s_waitcnt lgkmcnt(7)
v_permlane32_swap_b32 v209, v211
Mvav 240,136,176
v_permlane32_swap_b32 v216, v218
Mvav 248,136,180
s_waitcnt vmcnt(17) lgkmcnt(0)
s_barrier
v_permlane32_swap_b32 v217, v219
Mvav 244,140,176
ds_read_b128 a[128:131], v20
v_lshrrev_b32 v172, 3, v1
Mvav 252,140,180
ds_read_b128 a[132:135], v21
v_and_b32 v173, 6, v172
Mvav 224,144,184
ds_read_b128 a[136:139], v22
v_xor_b32 v8, v8, v173
Mvav 232,144,188
ds_read_b128 a[140:143], v23
v_mul_u32_u24 v172, 0x2400, v172
Mvav 228,148,184
ds_read_b128 a[144:147], v20 offset:4096
s_nop 0
v_mul_f32 v224, v38, v224
Mvav 236,148,188
ds_read_b128 a[148:151], v21 offset:4096
v_mul_f32 v225, v38, v225
Mvav 240,152,184
ds_read_b128 a[160:163], v20 offset:8192
v_mul_f32 v232, v39, v232
Mvav 248,152,188
ds_read_b128 a[152:155], v22 offset:4096
v_mul_f32 v233, v39, v233
Mvav 244,156,184
ds_read_b128 a[164:167], v21 offset:8192
v_mul_f32 v226, v38, v226
Mvav 252,156,188
v_mul_f32 v240, v38, v240
v_mul_f32 v241, v38, v241
v_mul_f32 v248, v39, v248
v_mul_f32 v249, v39, v249
v_mul_f32 v227, v38, v227
v_mul_f32 v234, v39, v234
v_mul_f32 v235, v39, v235
v_mul_f32 v242, v38, v242
v_mul_f32 v243, v38, v243
v_mul_f32 v250, v39, v250
v_mul_f32 v251, v39, v251
v_mul_f32 v228, v38, v228
v_mul_f32 v229, v38, v229
v_mul_f32 v230, v38, v230
v_mul_f32 v231, v38, v231
CV 224,224,225
v_mul_f32 v236, v39, v236
v_mul_f32 v237, v39, v237
v_mul_f32 v238, v39, v238
v_mul_f32 v239, v39, v239
CV 232,232,233
v_mul_f32 v244, v38, v244
v_mul_f32 v245, v38, v245
v_mul_f32 v246, v38, v246
v_mul_f32 v247, v38, v247
CV 240,240,241
v_mul_f32 v252, v39, v252
v_mul_f32 v253, v39, v253
v_mul_f32 v254, v39, v254
v_mul_f32 v255, v39, v255
CV 248,248,249
CV 225,226,227
CV 233,234,235
CV 241,242,243
CV 249,250,251
CV 226,228,229
CV 227,230,231
CV 234,236,237
CV 235,238,239
CV 242,244,245
CV 243,246,247
CV 250,252,253
CV 251,254,255
v_permlane32_swap_b32 v224, v226
v_permlane32_swap_b32 v225, v227
v_permlane32_swap_b32 v232, v234
v_permlane32_swap_b32 v233, v235
v_permlane32_swap_b32 v240, v242
v_permlane32_swap_b32 v241, v243
v_permlane32_swap_b32 v248, v250
v_permlane32_swap_b32 v249, v251
v_permlane16_swap_b32 v192, v194
v_permlane16_swap_b32 v193, v195
v_permlane16_swap_b32 v200, v202
v_permlane16_swap_b32 v201, v203
v_permlane16_swap_b32 v208, v210
v_permlane16_swap_b32 v209, v211
v_permlane16_swap_b32 v216, v218
v_permlane16_swap_b32 v217, v219
v_permlane16_swap_b32 v224, v226
v_permlane16_swap_b32 v225, v227
v_permlane16_swap_b32 v232, v234
v_permlane16_swap_b32 v233, v235
v_permlane16_swap_b32 v240, v242
v_permlane16_swap_b32 v241, v243
v_permlane16_swap_b32 v248, v250
v_permlane16_swap_b32 v249, v251
v_accvgpr_write_b32 a32, v192
v_accvgpr_write_b32 a33, v193
v_accvgpr_write_b32 a34, v194
v_accvgpr_write_b32 a35, v195
v_accvgpr_write_b32 a36, v200
v_accvgpr_write_b32 a37, v201
v_accvgpr_write_b32 a38, v202
v_accvgpr_write_b32 a39, v203
v_accvgpr_write_b32 a40, v208
v_accvgpr_write_b32 a41, v209
v_accvgpr_write_b32 a42, v210
v_accvgpr_write_b32 a43, v211
v_accvgpr_write_b32 a44, v216
v_accvgpr_write_b32 a45, v217
v_accvgpr_write_b32 a46, v218
v_accvgpr_write_b32 a47, v219
v_accvgpr_write_b32 a48, v224
v_accvgpr_write_b32 a49, v225
v_accvgpr_write_b32 a50, v226
v_accvgpr_write_b32 a51, v227
v_accvgpr_write_b32 a52, v232
v_accvgpr_write_b32 a53, v233
v_accvgpr_write_b32 a54, v234
v_accvgpr_write_b32 a55, v235
v_accvgpr_write_b32 a56, v240
v_accvgpr_write_b32 a57, v241
v_accvgpr_write_b32 a58, v242
v_accvgpr_write_b32 a59, v243
v_accvgpr_write_b32 a60, v248
v_accvgpr_write_b32 a61, v249
v_accvgpr_write_b32 a62, v250
v_accvgpr_write_b32 a63, v251
ds_read_b128 a[156:159], v23 offset:4096
s_nop 0
s_cmp_lg_u32 s89, 0
s_cbranch_scc1 L_max0_1
L_maxr0_1:
s_waitcnt lgkmcnt(1)
v_mfma_f32_16x16x32_bf16 v[48:51], a[128:131], a[0:3], 0
ds_read_b128 a[168:171], v22 offset:8192
v_lshl_add_u32 v8, v8, 4, v172
v_mfma_f32_16x16x32_bf16 v[56:59], a[128:131], a[4:7], 0
ds_read_b128 a[172:175], v23 offset:8192
v_add_u32 v9, 0x11c00, v8
v_mfma_f32_16x16x32_bf16 v[64:67], a[128:131], a[32:35], 0
LD 12,44,76,0
v_add_u32 v10, 0x23800, v8
v_mfma_f32_16x16x32_bf16 v[72:75], a[128:131], a[36:39], 0
ds_read_b128 a[128:131], v20 offset:12288
v_add_u32 v11, 0x35400, v8
Mvaa 48,132,8
v_add_u32 v20, 0x9000, v20
v_add_u32 v2, 0x9000, v2
Mvaa 56,132,12
v_add_u32 v3, 0xfffe5000, v3
v_add_u32 v4, 0xfffe5000, v4
Mvaa 64,132,40
LD 13,44,76,1024
v_add_u32 v3, 0x9000, v3
Mvaa 72,132,44
ds_read_b128 a[132:135], v21 offset:12288
v_add_u32 v21, 0x9000, v21
Mvaa 48,136,16
v_add_u32 v4, 0x9000, v4
v_add_u32 v5, 0xfffe5000, v5
Mvaa 56,136,20
v_add_u32 v5, 0x9000, v5
v_add_u32 v36, s9, v2
Mvaa 64,136,48
v_add_u32 v37, s9, v3
v_add_u32 v38, s9, v4
Mvaa 72,136,52
ds_read_b128 a[136:139], v22 offset:12288
v_add_u32 v22, 0x9000, v22
Mvaa 48,140,24
LD 14,44,76,2048
v_add_u32 v39, s9, v5
Mvaa 56,140,28
s_lshl_b32 s9, s94, 3
v_lshrrev_b32 v172, 3, v1
v_mov_b32 v174, 0
Mvaa 64,140,56
s_add_u32 s9, s9, s17
v_and_b32 v173, 6, v172
v_max3_f32 v168, v48, v49, v24
Mvaa 72,140,60
s_lshl_b32 s9, s9, 7
ds_read_b128 a[140:143], v23 offset:12288
v_max3_f32 v169, v56, v57, v25
v_mfma_f32_16x16x32_bf16 v[52:55], a[144:147], a[0:3], 0
s_add_u32 s9, s9, 0x3010024
v_max3_f32 v168, v168, v50, v51
v_max3_f32 v169, v169, v58, v59
v_mfma_f32_16x16x32_bf16 v[60:63], a[144:147], a[4:7], 0
s_add_u32 s17, s66, 3
v_max3_f32 v170, v64, v65, v26
v_max3_f32 v171, v72, v73, v27
v_mfma_f32_16x16x32_bf16 v[68:71], a[144:147], a[32:35], 0
LD 15,44,76,3072
v_max3_f32 v170, v170, v66, v67
v_mfma_f32_16x16x32_bf16 v[76:79], a[144:147], a[36:39], 0
s_add_u32 m0, s69, 0x1f000
s_add_u32 s76, s73, 0x68000
v_max3_f32 v171, v171, v74, v75
Mvaa 52,148,8
s_and_b32 s17, s17, 7
v_add_u32 v23, 0x9000, v23
v_mul_u32_u24 v172, 0x480, v172
Mvaa 60,148,12
s_mul_i32 s81, s17, 0x11000
v_and_b32 v175, 48, v1
Mvaa 68,148,40
s_waitcnt vmcnt(12) lgkmcnt(0)
s_barrier
s_add_u32 s81, s81, s13
ds_read_b128 a[144:147], v20
Mvaa 76,148,44
s_add_u32 s81, s81, 0xb000
ds_read_b128 a[148:151], v21
Mvaa 52,152,16
LD 16,48,76,0
Mvaa 60,152,20
Mvaa 68,152,48
Mvaa 76,152,52
ds_read_b128 a[152:155], v22
Mvaa 52,156,24
s_nop 0
Mvaa 60,156,28
s_nop 0
Mvaa 68,156,56
LD 17,48,76,1024
Mvaa 76,156,60
s_nop 1
v_max3_f32 v168, v168, v52, v53
s_nop 0
v_max3_f32 v169, v169, v60, v61
v_max3_f32 v168, v168, v54, v55
v_max3_f32 v169, v169, v62, v63
v_max3_f32 v170, v170, v68, v69
s_nop 0
v_permlane32_swap_b32 v168, v169
v_max3_f32 v171, v171, v76, v77
v_max3_f32 v170, v170, v70, v71
v_max_f32 v168, v168, v169
v_max3_f32 v171, v171, v78, v79
v_mov_b32 v169, v168
s_nop 0
v_permlane32_swap_b32 v170, v171
v_permlane16_swap_b32 v168, v169
v_max_f32 v170, v170, v171
ds_read_b128 a[156:159], v23
v_max_f32 v168, v168, v169
v_mov_b32 v171, v170
v_mov_b32 v169, v168
s_nop 0
v_permlane16_swap_b32 v170, v171
v_permlane32_swap_b32 v168, v169
v_max_f32 v170, v170, v171
v_sub_f32 v144, 0, v168
v_sub_f32 v145, 0, v168
v_sub_f32 v146, 0, v168
v_sub_f32 v147, 0, v168
v_mov_b32 v171, v170
v_sub_f32 v148, 0, v169
v_mfma_f32_16x16x32_bf16 v[80:83], a[160:163], a[0:3], v[144:147]
v_sub_f32 v149, 0, v169
v_sub_f32 v150, 0, v169
v_sub_f32 v151, 0, v169
v_permlane32_swap_b32 v170, v171
s_nop 0
v_mfma_f32_16x16x32_bf16 v[88:91], a[160:163], a[4:7], v[148:151]
v_sub_f32 v152, 0, v170
v_sub_f32 v153, 0, v170
v_sub_f32 v154, 0, v170
v_sub_f32 v155, 0, v170
v_sub_f32 v156, 0, v171
v_sub_f32 v157, 0, v171
v_mfma_f32_16x16x32_bf16 v[96:99], a[160:163], a[32:35], v[152:155]
v_sub_f32 v158, 0, v171
v_sub_f32 v159, 0, v171
v_sub_f32 v48, v48, v168
v_sub_f32 v49, v49, v168
v_mfma_f32_16x16x32_bf16 v[104:107], a[160:163], a[36:39], v[156:159]
ds_read_b128 a[160:163], v20 offset:4096
v_sub_f32 v50, v50, v168
Mvaa 80,164,8
LD 18,48,76,2048
v_sub_f32 v51, v51, v168
Mvaa 88,164,12
v_exp_f32 v48, v48
Mvaa 96,164,40
v_exp_f32 v49, v49
Mvaa 104,164,44
ds_read_b128 a[164:167], v21 offset:4096
v_sub_f32 v56, v56, v169
Mvaa 80,168,16
v_exp_f32 v50, v50
Mvaa 88,168,20
v_exp_f32 v51, v51
Mvaa 96,168,48
LD 19,48,76,3072
v_sub_f32 v57, v57, v169
Mvaa 104,168,52
s_add_u32 s21, s94, 54
ds_read_b128 a[168:171], v22 offset:4096
v_sub_f32 v58, v58, v169
Mvaa 80,172,24
s_min_u32 s21, s21, 0xa1
v_exp_f32 v56, v56
Mvaa 88,172,28
s_mul_i32 s22, s21, 0xe39
v_exp_f32 v57, v57
Mvaa 96,172,56
s_lshr_b32 s22, s22, 16
v_exp_f32 v58, v58
Mvaa 104,172,60
s_mul_i32 s22, s22, 0xffaf0080
s_mul_i32 s15, s21, 0x48000
s_add_u32 s22, s22, s15
v_mfma_f32_16x16x32_bf16 v[84:87], a[128:131], a[0:3], v[144:147]
s_mul_i32 s15, s66, 0x480
s_add_u32 m0, s69, 0x24000
s_add_u32 s22, s22, s15
v_mfma_f32_16x16x32_bf16 v[92:95], a[128:131], a[4:7], v[148:151]
s_mov_b32 s76, s22
ds_read_b128 a[172:175], v23 offset:4096
v_sub_f32 v59, v59, v169
v_mfma_f32_16x16x32_bf16 v[100:103], a[128:131], a[32:35], v[152:155]
s_lshl_b32 s14, s21, 12
v_exp_f32 v59, v59
v_mfma_f32_16x16x32_bf16 v[108:111], a[128:131], a[36:39], v[156:159]
s_mul_i32 s15, s66, 0xa2000
Ta 128,2,16384
CV 112,48,49
L_pg11_5:
s_cbranch_execz L_ret11
Mvaa 84,132,8
s_add_u32 s14, s14, s15
Ta 130,2,18432
CV 113,50,51
Mvaa 92,132,12
s_add_u32 s14, s14, 0x4400000
v_sub_f32 v64, v64, v170
v_sub_f32 v65, v65, v170
Mvaa 100,132,40
v_exp_f32 v64, v64
Mvaa 108,132,44
Ta 132,3,16384
v_sub_f32 v66, v66, v170
Mvaa 84,136,16
Ta 134,3,18432
v_sub_f32 v67, v67, v170
Mvaa 92,136,20
v_exp_f32 v65, v65
Mvaa 100,136,48
v_exp_f32 v66, v66
Mvaa 108,136,52
Ta 136,4,16384
CV 116,56,57
Mvaa 84,140,24
Ta 138,4,18432
CV 117,58,59
Mvaa 92,140,28
v_exp_f32 v67, v67
Mvaa 100,140,56
v_sub_f32 v72, v72, v171
v_sub_f32 v73, v73, v171
Mvaa 108,140,60
s_waitcnt lgkmcnt(4)
Ta 140,5,16384
v_sub_f32 v74, v74, v171
v_mfma_f32_16x16x32_bf16 v[48:51], a[144:147], a[0:3], v[144:147]
Ta 142,5,18432
v_sub_f32 v75, v75, v171
v_mfma_f32_16x16x32_bf16 v[56:59], a[144:147], a[4:7], v[148:151]
CV 120,64,65
CV 121,66,67
v_mfma_f32_16x16x32_bf16 v[64:67], a[144:147], a[32:35], v[152:155]
LD 8,24,76,0
LD 9,24,76,1024
LD 10,24,76,2048
LD 11,24,76,3072
s_add_u32 m0, s69, 0
s_add_u32 s76, s71, 0x70000
v_exp_f32 v72, v72
LD 12,44,76,0
v_exp_f32 v73, v73
v_exp_f32 v74, v74
v_exp_f32 v75, v75
CV 124,72,73
v_sub_f32 v52, v52, v168
CV 125,74,75
v_mfma_f32_16x16x32_bf16 v[72:75], a[144:147], a[36:39], v[156:159]
Ta 144,2,20480
v_sub_f32 v53, v53, v168
Mvaa 48,148,8
Ta 146,2,22528
v_sub_f32 v54, v54, v168
Mvaa 56,148,12
v_exp_f32 v52, v52
Mvaa 64,148,40
v_exp_f32 v53, v53
Mvaa 72,148,44
Ta 148,3,20480
v_sub_f32 v55, v55, v168
Mvaa 48,152,16
Ta 150,3,22528
v_sub_f32 v60, v60, v169
Mvaa 56,152,20
v_exp_f32 v54, v54
Mvaa 64,152,48
v_exp_f32 v55, v55
Mvaa 72,152,52
Ta 152,4,20480
v_sub_f32 v61, v61, v169
Mvaa 48,156,24
Ta 154,4,22528
v_sub_f32 v62, v62, v169
Mvaa 56,156,28
v_exp_f32 v60, v60
Mvaa 64,156,56
v_exp_f32 v61, v61
Mvaa 72,156,60
LD 13,44,76,1024
v_sub_f32 v63, v63, v169
CV 114,52,53
CV 115,54,55
v_mfma_f32_16x16x32_bf16 v[52:55], a[160:163], a[0:3], v[144:147]
v_exp_f32 v62, v62
v_exp_f32 v63, v63
v_sub_f32 v68, v68, v170
v_sub_f32 v69, v69, v170
v_sub_f32 v70, v70, v170
v_sub_f32 v71, v71, v170
CV 118,60,61
CV 119,62,63
v_mfma_f32_16x16x32_bf16 v[60:63], a[160:163], a[4:7], v[148:151]
v_exp_f32 v68, v68
v_exp_f32 v69, v69
v_exp_f32 v70, v70
v_exp_f32 v71, v71
v_sub_f32 v76, v76, v171
v_sub_f32 v77, v77, v171
v_sub_f32 v78, v78, v171
v_sub_f32 v79, v79, v171
CV 122,68,69
CV 123,70,71
v_mfma_f32_16x16x32_bf16 v[68:71], a[160:163], a[32:35], v[152:155]
v_exp_f32 v76, v76
v_exp_f32 v77, v77
v_exp_f32 v78, v78
v_exp_f32 v79, v79
CV 126,76,77
Ta 156,5,20480
CV 127,78,79
v_mfma_f32_16x16x32_bf16 v[76:79], a[160:163], a[36:39], v[156:159]
Ta 158,5,22528
Mvaa 52,164,8
ds_read_b128 a[160:163], v20 offset:8192
Mvaa 60,164,12
v_exp_f32 v80, v80
Mvaa 68,164,40
v_exp_f32 v81, v81
Mvaa 76,164,44
ds_read_b128 a[164:167], v21 offset:8192
CV 128,80,81
Mvaa 52,168,16
v_exp_f32 v82, v82
Mvaa 60,168,20
v_exp_f32 v83, v83
Mvaa 68,168,48
v_exp_f32 v88, v88
Mvaa 76,168,52
ds_read_b128 a[168:171], v22 offset:8192
CV 129,82,83
Mvaa 52,172,24
LD 14,44,76,2048
s_lshl_b32 s85, s30, 7
Mvaa 60,172,28
s_add_u32 s85, s85, 0x4000
v_exp_f32 v89, v89
Mvaa 68,172,56
s_getpc_b64 s[96:97]
v_mov_b32 v46, s85
CV 132,88,89
Mvaa 76,172,60
ds_read_b128 a[172:175], v23 offset:8192
v_mfma_f32_16x16x32_bf16 a[240:243], v[40:43], v[112:115], 0
global_load_dword v35, v46, s[96:97]
v_mfma_f32_16x16x32_bf16 a[244:247], v[40:43], v[116:119], 0
v_exp_f32 v90, v90
v_mfma_f32_16x16x32_bf16 a[248:251], v[40:43], v[120:123], 0
v_exp_f32 v91, v91
v_mfma_f32_16x16x32_bf16 a[252:255], v[40:43], v[124:127], 0
v_exp_f32 v96, v96
v_mfma_f32_16x16x32_bf16 v[176:179], a[128:131], v[112:115], 0
v_exp_f32 v97, v97
v_mfma_f32_16x16x32_bf16 v[184:187], a[128:131], v[116:119], 0
v_exp_f32 v98, v98
v_mfma_f32_16x16x32_bf16 a[176:179], a[128:131], v[120:123], 0
v_exp_f32 v99, v99
v_mfma_f32_16x16x32_bf16 a[184:187], a[128:131], v[124:127], 0
s_waitcnt lgkmcnt(1)
ds_read_b128 a[128:131], v20 offset:12288
CV 133,90,91
v_mfma_f32_16x16x32_bf16 v[180:183], a[132:135], v[112:115], 0
v_exp_f32 v104, v104
v_mfma_f32_16x16x32_bf16 v[188:191], a[132:135], v[116:119], 0
v_exp_f32 v105, v105
v_mfma_f32_16x16x32_bf16 a[180:183], a[132:135], v[120:123], 0
LD 15,44,76,3072
CV 136,96,97
v_mfma_f32_16x16x32_bf16 a[188:191], a[132:135], v[124:127], 0
s_add_u32 m0, s69, 0x4000
s_add_u32 s76, s73, 0x6c000
ds_read_b128 a[132:135], v21 offset:12288
v_mfma_f32_16x16x32_bf16 v[192:195], a[136:139], v[112:115], 0
v_exp_f32 v106, v106
v_mfma_f32_16x16x32_bf16 v[200:203], a[136:139], v[116:119], 0
v_exp_f32 v107, v107
v_mfma_f32_16x16x32_bf16 a[192:195], a[136:139], v[120:123], 0
v_exp_f32 v84, v84
v_mfma_f32_16x16x32_bf16 a[200:203], a[136:139], v[124:127], 0
ds_read_b128 a[136:139], v22 offset:12288
CV 137,98,99
v_mfma_f32_16x16x32_bf16 v[196:199], a[140:143], v[112:115], 0
v_exp_f32 v85, v85
v_mfma_f32_16x16x32_bf16 v[204:207], a[140:143], v[116:119], 0
v_exp_f32 v86, v86
v_mfma_f32_16x16x32_bf16 a[196:199], a[140:143], v[120:123], 0
v_exp_f32 v87, v87
v_mfma_f32_16x16x32_bf16 a[204:207], a[140:143], v[124:127], 0
ds_read_b128 a[140:143], v23 offset:12288
CV 140,104,105
v_mfma_f32_16x16x32_bf16 v[208:211], a[144:147], v[112:115], 0
v_exp_f32 v92, v92
v_mfma_f32_16x16x32_bf16 v[216:219], a[144:147], v[116:119], 0
v_exp_f32 v93, v93
v_mfma_f32_16x16x32_bf16 a[208:211], a[144:147], v[120:123], 0
v_exp_f32 v94, v94
v_mfma_f32_16x16x32_bf16 a[216:219], a[144:147], v[124:127], 0
Ta 144,2,24576
CV 141,106,107
v_mfma_f32_16x16x32_bf16 v[212:215], a[148:151], v[112:115], 0
LD 16,48,76,0
Ta 146,2,26624
v_mfma_f32_16x16x32_bf16 v[220:223], a[148:151], v[116:119], 0
v_exp_f32 v95, v95
v_mfma_f32_16x16x32_bf16 a[212:215], a[148:151], v[120:123], 0
v_exp_f32 v100, v100
v_mfma_f32_16x16x32_bf16 a[220:223], a[148:151], v[124:127], 0
Ta 148,3,24576
CV 130,84,85
v_mfma_f32_16x16x32_bf16 v[224:227], a[152:155], v[112:115], 0
Ta 150,3,26624
CV 131,86,87
v_mfma_f32_16x16x32_bf16 v[232:235], a[152:155], v[116:119], 0
v_exp_f32 v101, v101
v_mfma_f32_16x16x32_bf16 a[224:227], a[152:155], v[120:123], 0
v_exp_f32 v102, v102
v_mfma_f32_16x16x32_bf16 a[232:235], a[152:155], v[124:127], 0
Ta 152,4,24576
CV 134,92,93
v_mfma_f32_16x16x32_bf16 v[228:231], a[156:159], v[112:115], 0
Ta 154,4,26624
CV 135,94,95
v_mfma_f32_16x16x32_bf16 v[236:239], a[156:159], v[116:119], 0
v_exp_f32 v103, v103
v_mfma_f32_16x16x32_bf16 a[228:231], a[156:159], v[120:123], 0
v_exp_f32 v108, v108
v_mfma_f32_16x16x32_bf16 a[236:239], a[156:159], v[124:127], 0
Ta 156,5,24576
CV 138,100,101
v_mfma_f32_16x16x32_bf16 v[80:83], a[160:163], a[0:3], v[144:147]
Ta 158,5,26624
CV 139,102,103
v_mfma_f32_16x16x32_bf16 v[88:91], a[160:163], a[4:7], v[148:151]
v_exp_f32 v109, v109
v_mfma_f32_16x16x32_bf16 v[96:99], a[160:163], a[32:35], v[152:155]
LD 17,48,76,1024
CV 142,108,109
v_mfma_f32_16x16x32_bf16 v[104:107], a[160:163], a[36:39], v[156:159]
Ta 160,2,28672
v_add_u32 v20, 0x9000, v20
Mvaa 80,164,8
Ta 162,2,30720
v_add_u32 v21, 0x9000, v21
Mvaa 88,164,12
v_exp_f32 v110, v110
Mvaa 96,164,40
v_exp_f32 v111, v111
Mvaa 104,164,44
Ta 164,3,28672
CV 143,110,111
Mvaa 80,168,16
Ta 166,3,30720
v_add_u32 v22, 0x9000, v22
Mvaa 88,168,20
v_exp_f32 v48, v48
Mvaa 96,168,48
v_exp_f32 v49, v49
Mvaa 104,168,52
s_waitcnt lgkmcnt(4)
Ta 168,4,28672
CV 112,48,49
Mvaa 80,172,24
Ta 170,4,30720
v_add_u32 v23, 0x9000, v23
Mvaa 88,172,28
v_exp_f32 v50, v50
Mvaa 96,172,56
v_exp_f32 v51, v51
Mvaa 104,172,60
Ta 172,5,28672
CV 113,50,51
v_mfma_f32_16x16x32_bf16 v[84:87], a[128:131], a[0:3], v[144:147]
LD 18,48,76,2048
Ta 174,5,30720
v_mfma_f32_16x16x32_bf16 v[92:95], a[128:131], a[4:7], v[148:151]
v_exp_f32 v56, v56
v_mfma_f32_16x16x32_bf16 v[100:103], a[128:131], a[32:35], v[152:155]
v_exp_f32 v57, v57
v_mfma_f32_16x16x32_bf16 v[108:111], a[128:131], a[36:39], v[156:159]
v_exp_f32 v58, v58
Mvaa 84,132,8
v_exp_f32 v59, v59
Mvaa 92,132,12
v_exp_f32 v64, v64
Mvaa 100,132,40
v_exp_f32 v65, v65
Mvaa 108,132,44
s_waitcnt vmcnt(20) lgkmcnt(0)
s_barrier
s_waitcnt vmcnt(8)
Tv 240,36,0
CV 116,56,57
Mvaa 84,136,16
Tv 242,36,2048
CV 117,58,59
Mvaa 92,136,20
Tv 244,37,0
CV 120,64,65
Mvaa 100,136,48
Tv 246,37,2048
Tv 248,38,0
Mvaa 108,136,52
Tv 250,38,2048
Tv 252,39,0
Mvaa 84,140,24
Tv 254,39,2048
v_add_u32 v2, 0x9000, v2
Mvaa 92,140,28
ds_read_b128 a[128:131], v20
v_add_u32 v3, 0x9000, v3
Mvaa 100,140,56
LD 19,48,76,3072
ds_read_b128 a[132:135], v21
Mvaa 108,140,60
ds_read_b128 a[136:139], v22
v_add_u32 v4, 0x9000, v4
Mavv 240,40,128
ds_read_b128 a[140:143], v23
v_add_u32 v5, 0x9000, v5
Mavv 244,40,132
v_exp_f32 v66, v66
Mavv 248,40,136
s_waitcnt lgkmcnt(9)
buffer_store_dwordx4 v[240:243], v7, s[40:43], s14 offen sc1
Mavv 252,40,140
v_exp_f32 v67, v67
Mvav 176,144,128
v_exp_f32 v72, v72
Mvav 184,144,132
v_exp_f32 v73, v73
Maav 176,144,136
v_exp_f32 v74, v74
Maav 184,144,140
s_waitcnt lgkmcnt(3)
buffer_store_dwordx4 v[244:247], v7, s[40:43], s14 offen offset:1024 sc1
ds_read_b128 a[144:147], v20 offset:4096
Mvav 180,148,128
v_exp_f32 v75, v75
Mvav 188,148,132
v_exp_f32 v52, v52
Maav 180,148,136
v_exp_f32 v53, v53
Maav 188,148,140
ds_read_b128 a[148:151], v21 offset:4096
CV 121,66,67
Mvav 192,152,128
buffer_store_dwordx4 v[248:251], v7, s[40:43], s14 offen offset:2048 sc1
CV 124,72,73
Mvav 200,152,132
v_exp_f32 v54, v54
Maav 192,152,136
s_add_u32 s21, s94, 0x76
v_exp_f32 v55, v55
Maav 200,152,140
s_min_u32 s21, s21, 0xa1
ds_read_b128 a[152:155], v22 offset:4096
CV 125,74,75
Mvav 196,156,128
s_mul_i32 s22, s21, 0xe39
v_exp_f32 v60, v60
Mvav 204,156,132
buffer_store_dwordx4 v[252:255], v7, s[40:43], s14 offen offset:3072 sc1
CV 114,52,53
Maav 196,156,136
s_lshr_b32 s22, s22, 16
v_exp_f32 v61, v61
Maav 204,156,140
s_mul_i32 s22, s22, 0xffaf0080
s_mul_i32 s15, s21, 0x48000
s_add_u32 s22, s22, s15
Mvav 208,160,128
s_mul_i32 s15, s66, 0x480
s_add_u32 m0, s69, 0x24000
s_add_u32 s22, s22, s15
Mvav 216,160,132
s_mov_b32 s76, s22
ds_read_b128 a[156:159], v23 offset:4096
CV 115,54,55
Maav 208,160,136
s_lshl_b32 s14, s21, 12
v_exp_f32 v62, v62
Maav 216,160,140
s_mul_i32 s15, s66, 0xa2000
Ta 160,2,16384
CV 118,60,61
Mvav 212,164,128
s_add_u32 s14, s14, s15
Ta 162,2,18432
s_add_u32 s14, s14, 0x4400000
Mvav 220,164,132
s_and_b32 s15, s66, 3
v_exp_f32 v63, v63
Maav 212,164,136
s_lshl_b32 s20, s15, 10
v_exp_f32 v68, v68
Maav 220,164,140
s_add_u32 s20, s20, s13
Ta 164,3,16384
CV 119,62,63
Mvav 224,168,128
s_add_u32 s20, s20, 0x8000
Ta 166,3,18432
s_lshl_b32 s21, s15, 10
Mvav 232,168,132
s_add_u32 s21, s21, s13
v_exp_f32 v69, v69
Maav 224,168,136
s_add_u32 s21, s21, 0x19000
v_exp_f32 v70, v70
Maav 232,168,140
s_and_b32 s22, s66, 1
Ta 168,4,16384
CV 122,68,69
Mvav 228,172,128
s_mul_i32 s18, s22, 0x4800
Ta 170,4,18432
s_lshl_b32 s22, s22, 8
Mvav 236,172,132
v_exp_f32 v71, v71
Maav 228,172,136
v_exp_f32 v76, v76
Maav 236,172,140
Ta 172,5,16384
CV 123,70,71
v_mfma_f32_16x16x32_bf16 v[48:51], a[128:131], a[0:3], v[144:147]
Ta 174,5,18432
v_mfma_f32_16x16x32_bf16 v[56:59], a[128:131], a[4:7], v[148:151]
v_exp_f32 v77, v77
v_mfma_f32_16x16x32_bf16 v[64:67], a[128:131], a[32:35], v[152:155]
LD 8,24,76,0
CV 126,76,77
v_mfma_f32_16x16x32_bf16 v[72:75], a[128:131], a[36:39], v[156:159]
s_waitcnt lgkmcnt(4)
Ta 128,2,20480
v_and_b32 v8, 7, v1
Mvaa 48,132,8
Ta 130,2,22528
v_xor_b32 v8, v8, v173
Mvaa 56,132,12
v_exp_f32 v78, v78
Mvaa 64,132,40
LD 9,24,76,1024
v_lshl_add_u32 v8, v8, 4, v172
Mvaa 72,132,44
Ta 132,3,20480
v_mov_b32 v172, s66
Mvaa 48,136,16
Ta 134,3,22528
v_lshlrev_b32 v173, 7, s94
Mvaa 56,136,20
v_exp_f32 v79, v79
Mvaa 64,136,48
LD 10,24,76,2048
CV 127,78,79
Mvaa 72,136,52
Ta 136,4,20480
v_lshl_add_u32 v172, v172, 2, v173
Mvaa 48,140,24
Ta 138,4,22528
v_add_u32 v172, 0x3004000, v172
Mvaa 56,140,28
v_exp_f32 v80, v80
Mvaa 64,140,56
LD 11,24,76,3072
v_add_u32 v9, 0x2000, v8
Mvaa 72,140,60
s_add_u32 m0, s69, 0x9000
s_add_u32 s76, s71, 0x74000
Ta 140,5,20480
v_mfma_f32_16x16x32_bf16 v[52:55], a[144:147], a[0:3], v[144:147]
Ta 142,5,22528
v_add_u32 v10, 0x4000, v8
v_mfma_f32_16x16x32_bf16 v[60:63], a[144:147], a[4:7], v[148:151]
v_exp_f32 v81, v81
v_mfma_f32_16x16x32_bf16 v[68:71], a[144:147], a[32:35], v[152:155]
LD 12,44,76,0
CV 128,80,81
v_mfma_f32_16x16x32_bf16 v[76:79], a[144:147], a[36:39], v[156:159]
ds_read_b128 a[144:147], v20 offset:8192
v_add_u32 v11, 0x6000, v8
Mvaa 52,148,8
v_exp_f32 v82, v82
Mvaa 60,148,12
v_exp_f32 v83, v83
Mvaa 68,148,40
LD 13,44,76,1024
CV 129,82,83
Mvaa 76,148,44
ds_read_b128 a[148:151], v21 offset:8192
Mvaa 52,152,16
v_exp_f32 v88, v88
Mvaa 60,152,20
v_exp_f32 v89, v89
Mvaa 68,152,48
v_exp_f32 v90, v90
Mvaa 76,152,52
ds_read_b128 a[152:155], v22 offset:8192
CV 132,88,89
Mvaa 52,156,24
LD 14,44,76,2048
Mvaa 60,156,28
v_exp_f32 v91, v91
Mvaa 68,156,56
v_exp_f32 v96, v96
Mvaa 76,156,60
ds_read_b128 a[156:159], v23 offset:8192
CV 133,90,91
Mavv 240,40,112
v_exp_f32 v97, v97
Mavv 244,40,116
v_exp_f32 v98, v98
Mavv 248,40,120
v_exp_f32 v99, v99
Mavv 252,40,124
v_exp_f32 v104, v104
Mvav 176,160,112
v_exp_f32 v105, v105
Mvav 184,160,116
v_exp_f32 v106, v106
Maav 176,160,120
v_exp_f32 v107, v107
Maav 184,160,124
ds_read_b128 a[160:163], v20 offset:12288
CV 136,96,97
Mvav 180,164,112
v_exp_f32 v84, v84
Mvav 188,164,116
s_waitcnt lgkmcnt(1)
v_exp_f32 v85, v85
Maav 180,164,120
LD 15,44,76,3072
CV 137,98,99
Maav 188,164,124
s_add_u32 m0, s69, 0xd000
s_add_u32 s76, s73, 0x70000
ds_read_b128 a[164:167], v21 offset:12288
Mvav 192,168,112
v_exp_f32 v86, v86
Mvav 200,168,116
v_exp_f32 v87, v87
Maav 192,168,120
v_exp_f32 v92, v92
Maav 200,168,124
ds_read_b128 a[168:171], v22 offset:12288
CV 140,104,105
Mvav 196,172,112
v_exp_f32 v93, v93
Mvav 204,172,116
v_exp_f32 v94, v94
Maav 196,172,120
v_exp_f32 v95, v95
Maav 204,172,124
ds_read_b128 a[172:175], v23 offset:12288
CV 141,106,107
Mvav 208,128,112
v_exp_f32 v100, v100
Mvav 216,128,116
v_exp_f32 v101, v101
Maav 208,128,120
v_exp_f32 v102, v102
Maav 216,128,124
Ta 128,2,24576
CV 130,84,85
Mvav 212,132,112
LD 16,48,76,0
Ta 130,2,26624
Mvav 220,132,116
v_exp_f32 v103, v103
Maav 212,132,120
v_exp_f32 v108, v108
Maav 220,132,124
Ta 132,3,24576
CV 131,86,87
Mvav 224,136,112
Ta 134,3,26624
CV 134,92,93
Mvav 232,136,116
v_exp_f32 v109, v109
Maav 224,136,120
v_exp_f32 v110, v110
Maav 232,136,124
Ta 136,4,24576
CV 135,94,95
Mvav 228,140,112
Ta 138,4,26624
CV 138,100,101
Mvav 236,140,116
v_exp_f32 v111, v111
Maav 228,140,120
CV 139,102,103
CV 142,108,109
L_pg11_6:
s_cbranch_execz L_ret11
Maav 236,140,124
Ta 140,5,24576
CV 143,110,111
v_mfma_f32_16x16x32_bf16 v[80:83], a[144:147], a[0:3], v[144:147]
Ta 142,5,26624
v_add_u32 v20, 0x9000, v20
v_mfma_f32_16x16x32_bf16 v[88:91], a[144:147], a[4:7], v[148:151]
v_exp_f32 v48, v48
v_mfma_f32_16x16x32_bf16 v[96:99], a[144:147], a[32:35], v[152:155]
LD 17,48,76,1024
v_add_u32 v21, 0x9000, v21
v_mfma_f32_16x16x32_bf16 v[104:107], a[144:147], a[36:39], v[156:159]
Ta 144,2,28672
v_add_u32 v22, 0x9000, v22
Mvaa 80,148,8
Ta 146,2,30720
v_add_u32 v23, 0x9000, v23
Mvaa 88,148,12
v_exp_f32 v49, v49
Mvaa 96,148,40
v_exp_f32 v50, v50
Mvaa 104,148,44
Ta 148,3,28672
CV 112,48,49
Mvaa 80,152,16
Ta 150,3,30720
v_add_u32 v2, 0x9000, v2
Mvaa 88,152,20
v_exp_f32 v51, v51
Mvaa 96,152,48
v_exp_f32 v56, v56
Mvaa 104,152,52
Ta 152,4,28672
CV 113,50,51
Mvaa 80,156,24
Ta 154,4,30720
v_add_u32 v3, 0x9000, v3
Mvaa 88,156,28
v_exp_f32 v57, v57
Mvaa 96,156,56
v_exp_f32 v58, v58
Mvaa 104,156,60
s_waitcnt lgkmcnt(4)
L_Amain:
Ta 156,5,28672
CV 116,56,57
v_mfma_f32_16x16x32_bf16 v[84:87], a[160:163], a[0:3], v[144:147]
s_mov_b64 exec, 0
s_cmp_eq_u32 s64, 0
s_cbranch_scc1 L_pg12_7
s_cmp_eq_u32 s64, 1
s_cbranch_scc1 L_pg12_8
s_cmp_eq_u32 s64, 2
s_cbranch_scc1 L_pg12_9
s_branch L_pg12_10
L_ret12:
s_mov_b64 exec, -1
LD 18,48,76,2048
Ta 158,5,30720
v_mfma_f32_16x16x32_bf16 v[92:95], a[160:163], a[4:7], v[148:151]
v_exp_f32 v59, v59
v_mfma_f32_16x16x32_bf16 v[100:103], a[160:163], a[32:35], v[152:155]
v_exp_f32 v64, v64
v_mfma_f32_16x16x32_bf16 v[108:111], a[160:163], a[36:39], v[156:159]
v_exp_f32 v65, v65
Mvaa 84,164,8
v_exp_f32 v66, v66
Mvaa 92,164,12
v_exp_f32 v67, v67
Mvaa 100,164,40
v_exp_f32 v72, v72
Mvaa 108,164,44
s_waitcnt lgkmcnt(0)
s_barrier
v_exp_f32 v73, v73
Mvaa 84,168,16
ds_read_b128 a[160:163], v20
CV 117,58,59
Mvaa 92,168,20
ds_read_b128 a[164:167], v21
CV 120,64,65
Mvaa 100,168,48
v_exp_f32 v74, v74
Mvaa 108,168,52
ds_read_b128 a[168:171], v22
CV 121,66,67
Mvaa 84,172,24
v_exp_f32 v75, v75
Mvaa 92,172,28
v_exp_f32 v52, v52
Mvaa 100,172,56
LD 19,48,76,3072
CV 124,72,73
Mvaa 108,172,60
s_add_u32 m0, s69, 0x12000
ds_read_b128 a[172:175], v23
CV 125,74,75
Mavv 240,40,128
s_add_u32 s76, s71, 0x78000
v_exp_f32 v53, v53
Mavv 244,40,132
v_exp_f32 v54, v54
Mavv 248,40,136
v_exp_f32 v55, v55
Mavv 252,40,140
v_exp_f32 v60, v60
Mvav 176,128,128
v_exp_f32 v61, v61
Mvav 184,128,132
v_exp_f32 v62, v62
Maav 176,128,136
v_exp_f32 v63, v63
Maav 184,128,140
ds_read_b128 a[128:131], v20 offset:4096
CV 114,52,53
Mvav 180,132,128
v_exp_f32 v68, v68
Mvav 188,132,132
v_exp_f32 v69, v69
Maav 180,132,136
v_exp_f32 v70, v70
Maav 188,132,140
ds_read_b128 a[132:135], v21 offset:4096
CV 115,54,55
Mvav 192,136,128
v_exp_f32 v71, v71
Mvav 200,136,132
v_exp_f32 v76, v76
Maav 192,136,136
s_waitcnt vmcnt(8)
Tv 240,36,0
Tv 242,36,2048
Maav 200,136,140
Tv 244,37,0
Tv 246,37,2048
Mvav 196,140,128
Tv 248,38,0
Tv 250,38,2048
Mvav 204,140,132
Tv 252,39,0
Tv 254,39,2048
Maav 196,140,136
ds_read_b128 a[136:139], v22 offset:4096
CV 118,60,61
Maav 204,140,140
ds_read_b128 a[140:143], v23 offset:4096
CV 119,62,63
Mvav 208,144,128
v_exp_f32 v77, v77
Mvav 216,144,132
s_waitcnt lgkmcnt(8)
buffer_store_dwordx4 v[240:243], v7, s[40:43], s14 offen sc1
CV 122,68,69
Maav 208,144,136
v_exp_f32 v78, v78
Maav 216,144,140
Ta 144,2,16384
CV 123,70,71
Mvav 212,148,128
Ta 146,2,18432
CV 126,76,77
Mvav 220,148,132
v_exp_f32 v79, v79
Maav 212,148,136
s_waitcnt lgkmcnt(6)
buffer_store_dwordx4 v[244:247], v7, s[40:43], s14 offen offset:1024 sc1
CV 127,78,79
Maav 220,148,140
Ta 148,3,16384
v_add_u32 v4, 0x9000, v4
Mvav 224,152,128
Ta 150,3,18432
v_add_u32 v5, 0x9000, v5
Mvav 232,152,132
v_exp_f32 v80, v80
Maav 224,152,136
v_exp_f32 v81, v81
Maav 232,152,140
buffer_store_dwordx4 v[248:251], v7, s[40:43], s14 offen offset:2048 sc1
Ta 152,4,16384
Mvav 228,156,128
Ta 154,4,18432
CV 128,80,81
Mvav 236,156,132
v_exp_f32 v82, v82
Maav 228,156,136
v_exp_f32 v83, v83
Maav 236,156,140
Ta 156,5,16384
CV 129,82,83
v_mfma_f32_16x16x32_bf16 v[48:51], a[160:163], a[0:3], v[144:147]
s_waitcnt lgkmcnt(5)
buffer_store_dwordx4 v[252:255], v7, s[40:43], s14 offen offset:3072 sc1
Ta 158,5,18432
v_mfma_f32_16x16x32_bf16 v[56:59], a[160:163], a[4:7], v[148:151]
s_lshl_b32 s14, s94, 3
v_exp_f32 v88, v88
v_mfma_f32_16x16x32_bf16 v[64:67], a[160:163], a[32:35], v[152:155]
s_add_u32 s14, s14, s66
v_exp_f32 v89, v89
v_mfma_f32_16x16x32_bf16 v[72:75], a[160:163], a[36:39], v[156:159]
s_mul_i32 s19, s14, 0x11000
Ta 160,2,20480
CV 132,88,89
Mvaa 48,164,8
s_add_u32 s19, s19, 0x800000
Ta 162,2,22528
v_and_b32 v36, 15, v1
Mvaa 56,164,12
LD 12,44,76,0
v_min_u32 v36, 7, v36
Mvaa 64,164,40
v_exp_f32 v90, v90
Mvaa 72,164,44
Ta 164,3,20480
v_lshlrev_b32 v37, 7, s94
Mvaa 48,168,16
Ta 166,3,22528
v_lshl_add_u32 v36, v36, 2, v37
Mvaa 56,168,20
v_exp_f32 v91, v91
Mvaa 64,168,48
v_exp_f32 v96, v96
Mvaa 72,168,52
Ta 168,4,20480
CV 133,90,91
Mvaa 48,172,24
Ta 170,4,22528
v_add_u32 v36, 0x3006020, v36
Mvaa 56,172,28
v_exp_f32 v97, v97
Mvaa 64,172,56
LD 13,44,76,1024
CV 136,96,97
Mvaa 72,172,60
Ta 172,5,20480
v_and_b32 v38, 15, v1
v_mfma_f32_16x16x32_bf16 v[52:55], a[128:131], a[0:3], v[144:147]
Ta 174,5,22528
v_mul_u32_u24 v38, 0x480, v38
v_mfma_f32_16x16x32_bf16 v[60:63], a[128:131], a[4:7], v[148:151]
v_exp_f32 v98, v98
v_mfma_f32_16x16x32_bf16 v[68:71], a[128:131], a[32:35], v[152:155]
v_exp_f32 v99, v99
v_mfma_f32_16x16x32_bf16 v[76:79], a[128:131], a[36:39], v[156:159]
ds_read_b128 a[128:131], v20 offset:8192
CV 137,98,99
Mvaa 52,132,8
v_exp_f32 v104, v104
Mvaa 60,132,12
v_exp_f32 v105, v105
Mvaa 68,132,40
v_exp_f32 v106, v106
Mvaa 76,132,44
ds_read_b128 a[132:135], v21 offset:8192
CV 140,104,105
Mvaa 52,136,16
v_exp_f32 v107, v107
Mvaa 60,136,20
v_exp_f32 v84, v84
Mvaa 68,136,48
v_exp_f32 v85, v85
Mvaa 76,136,52
ds_read_b128 a[136:139], v22 offset:8192
CV 141,106,107
Mvaa 52,140,24
LD 14,44,76,2048
CV 130,84,85
Mvaa 60,140,28
s_lshl_b32 s85, s30, 7
v_exp_f32 v86, v86
Mvaa 68,140,56
s_add_u32 s85, s85, 0x4000
v_exp_f32 v87, v87
Mvaa 76,140,60
s_getpc_b64 s[96:97]
ds_read_b128 a[140:143], v23 offset:8192
v_mov_b32 v46, s85
Mavv 240,40,112
global_load_dword v35, v46, s[96:97]
CV 131,86,87
Mavv 244,40,116
v_exp_f32 v92, v92
Mavv 248,40,120
v_exp_f32 v93, v93
Mavv 252,40,124
v_exp_f32 v94, v94
Mvav 176,144,112
v_exp_f32 v95, v95
Mvav 184,144,116
v_exp_f32 v100, v100
Maav 176,144,120
v_exp_f32 v101, v101
Maav 184,144,124
s_waitcnt lgkmcnt(1)
ds_read_b128 a[144:147], v20 offset:12288
CV 134,92,93
Mvav 180,148,112
v_exp_f32 v102, v102
Mvav 188,148,116
v_exp_f32 v103, v103
Maav 180,148,120
LD 15,44,76,3072
CV 135,94,95
Maav 188,148,124
s_add_u32 m0, s69, 0x16000
s_add_u32 s76, s73, 0x74000
ds_read_b128 a[148:151], v21 offset:12288
Mvav 192,152,112
v_exp_f32 v108, v108
Mvav 200,152,116
v_exp_f32 v109, v109
Maav 192,152,120
v_exp_f32 v110, v110
Maav 200,152,124
ds_read_b128 a[152:155], v22 offset:12288
CV 138,100,101
Mvav 196,156,112
v_exp_f32 v111, v111
Mvav 204,156,116
CV 139,102,103
CV 142,108,109
Maav 196,156,120
s_waitcnt vmcnt(5)
buffer_store_dword v47, off, s[40:43], s10 sc1
CV 143,110,111
Maav 204,156,124
s_lshl_b32 s10, s94, 3
ds_read_b128 a[156:159], v23 offset:12288
v_add_u32 v20, 0xfffe5000, v20
Mvav 208,160,112
s_add_u32 s10, s10, s16
v_exp_f32 v48, v48
Mvav 216,160,116
s_lshl_b32 s10, s10, 7
v_exp_f32 v49, v49
Maav 208,160,120
s_add_u32 s10, s10, 0x3010028
v_exp_f32 v50, v50
Maav 216,160,124
s_add_u32 s16, s66, 4
Ta 160,2,24576
v_add_u32 v21, 0xfffe5000, v21
Mvav 212,164,112
LD 16,48,76,0
Ta 162,2,26624
Mvav 220,164,116
s_and_b32 s16, s16, 7
v_exp_f32 v51, v51
Maav 212,164,120
v_exp_f32 v56, v56
Maav 220,164,124
Ta 164,3,24576
v_add_u32 v22, 0xfffe5000, v22
Mvav 224,168,112
Ta 166,3,26624
v_add_u32 v23, 0xfffe5000, v23
Mvav 232,168,116
v_exp_f32 v57, v57
Maav 224,168,120
v_exp_f32 v58, v58
Maav 232,168,124
Ta 168,4,24576
Mvav 228,172,112
Ta 170,4,26624
CV 112,48,49
Mvav 236,172,116
v_exp_f32 v59, v59
Maav 228,172,120
v_exp_f32 v64, v64
Maav 236,172,124
Ta 172,5,24576
CV 113,50,51
v_mfma_f32_16x16x32_bf16 v[80:83], a[128:131], a[0:3], v[144:147]
Ta 174,5,26624
CV 116,56,57
v_mfma_f32_16x16x32_bf16 v[88:91], a[128:131], a[4:7], v[148:151]
v_exp_f32 v65, v65
v_mfma_f32_16x16x32_bf16 v[96:99], a[128:131], a[32:35], v[152:155]
LD 17,48,76,1024
CV 117,58,59
v_mfma_f32_16x16x32_bf16 v[104:107], a[128:131], a[36:39], v[156:159]
Ta 128,2,28672
CV 120,64,65
Mvaa 80,132,8
Ta 130,2,30720
v_add_u32 v2, 0xfffe5000, v2
Mvaa 88,132,12
v_exp_f32 v66, v66
Mvaa 96,132,40
v_exp_f32 v67, v67
Mvaa 104,132,44
Ta 132,3,28672
CV 121,66,67
Mvaa 80,136,16
Ta 134,3,30720
v_add_u32 v3, 0xfffe5000, v3
Mvaa 88,136,20
v_exp_f32 v72, v72
Mvaa 96,136,48
v_exp_f32 v73, v73
Mvaa 104,136,52
s_waitcnt lgkmcnt(4)
Ta 136,4,28672
CV 124,72,73
Mvaa 80,140,24
Ta 138,4,30720
v_add_u32 v4, 0xfffe5000, v4
Mvaa 88,140,28
v_exp_f32 v74, v74
Mvaa 96,140,56
v_exp_f32 v75, v75
Mvaa 104,140,60
Ta 140,5,28672
CV 125,74,75
v_mfma_f32_16x16x32_bf16 v[84:87], a[144:147], a[0:3], v[144:147]
LD 18,48,76,2048
Ta 142,5,30720
v_mfma_f32_16x16x32_bf16 v[92:95], a[144:147], a[4:7], v[148:151]
v_exp_f32 v52, v52
v_mfma_f32_16x16x32_bf16 v[100:103], a[144:147], a[32:35], v[152:155]
v_exp_f32 v53, v53
v_mfma_f32_16x16x32_bf16 v[108:111], a[144:147], a[36:39], v[156:159]
v_exp_f32 v54, v54
Mvaa 84,148,8
v_exp_f32 v55, v55
Mvaa 92,148,12
v_exp_f32 v60, v60
Mvaa 100,148,40
v_exp_f32 v61, v61
Mvaa 108,148,44
s_waitcnt lgkmcnt(0)
s_barrier
v_exp_f32 v62, v62
Mvaa 84,152,16
ds_read_b128 a[144:147], v20
CV 114,52,53
Mvaa 92,152,20
ds_read_b128 a[148:151], v21
CV 115,54,55
Mvaa 100,152,48
v_exp_f32 v63, v63
Mvaa 108,152,52
ds_read_b128 a[152:155], v22
CV 118,60,61
Mvaa 84,156,24
v_exp_f32 v68, v68
Mvaa 92,156,28
v_exp_f32 v69, v69
Mvaa 100,156,56
LD 19,48,76,3072
CV 119,62,63
Mvaa 108,156,60
s_add_u32 m0, s69, 0x1b000
ds_read_b128 a[156:159], v23
CV 122,68,69
Mavv 240,40,128
s_mul_i32 s77, s100, 0x400
v_min_u32 v46, 7, v1
v_add_u32 v5, 0xfffe5000, v5
Mavv 244,40,132
s_mul_i32 s85, s66, 0x100000
v_mul_u32_u24 v46, 0x80, v46
Mavv 248,40,136
s_add_u32 s77, s77, s85
v_exp_f32 v70, v70
Mavv 252,40,140
s_add_u32 s77, s77, 0xe0000
v_exp_f32 v71, v71
Mvav 176,160,128
buffer_load_dword v35, v46, s[44:47], s77 offen
CV 123,70,71
Mvav 184,160,132
s_add_u32 s76, s71, 0x7c000
v_exp_f32 v76, v76
Maav 176,160,136
v_exp_f32 v77, v77
Maav 184,160,140
ds_read_b128 a[160:163], v20 offset:4096
CV 126,76,77
Mvav 180,164,128
v_exp_f32 v78, v78
Mvav 188,164,132
v_exp_f32 v79, v79
Maav 180,164,136
CV 127,78,79
Maav 188,164,140
ds_read_b128 a[164:167], v21 offset:4096
Mvav 192,168,128
v_exp_f32 v80, v80
Mvav 200,168,132
v_exp_f32 v81, v81
Maav 192,168,136
v_exp_f32 v82, v82
Maav 200,168,140
ds_read_b128 a[168:171], v22 offset:4096
Mvav 196,172,128
v_exp_f32 v83, v83
Mvav 204,172,132
v_exp_f32 v88, v88
Maav 196,172,136
v_exp_f32 v89, v89
Maav 204,172,140
ds_read_b128 a[172:175], v23 offset:4096
Mvav 208,128,128
v_exp_f32 v90, v90
Mvav 216,128,132
v_exp_f32 v91, v91
Maav 208,128,136
v_exp_f32 v96, v96
Maav 216,128,140
Ta 128,2,16384
Mvav 212,132,128
Ta 130,2,18432
Mvav 220,132,132
v_exp_f32 v97, v97
Maav 212,132,136
v_exp_f32 v98, v98
Maav 220,132,140
Ta 132,3,16384
Mvav 224,136,128
Ta 134,3,18432
Mvav 232,136,132
v_exp_f32 v99, v99
Maav 224,136,136
v_exp_f32 v104, v104
Maav 232,136,140
Ta 136,4,16384
Mvav 228,140,128
Ta 138,4,18432
CV 128,80,81
Mvav 236,140,132
v_exp_f32 v105, v105
Maav 228,140,136
v_exp_f32 v106, v106
Maav 236,140,140
s_waitcnt lgkmcnt(4)
Ta 140,5,16384
CV 129,82,83
v_mfma_f32_16x16x32_bf16 v[48:51], a[144:147], a[0:3], v[144:147]
Ta 142,5,18432
CV 132,88,89
v_mfma_f32_16x16x32_bf16 v[56:59], a[144:147], a[4:7], v[148:151]
v_exp_f32 v107, v107
v_mfma_f32_16x16x32_bf16 v[64:67], a[144:147], a[32:35], v[152:155]
LD 12,44,76,0
CV 133,90,91
v_mfma_f32_16x16x32_bf16 v[72:75], a[144:147], a[36:39], v[156:159]
Ta 144,2,20480
CV 136,96,97
Mvaa 48,148,8
Ta 146,2,22528
CV 137,98,99
Mvaa 56,148,12
v_exp_f32 v84, v84
Mvaa 64,148,40
v_exp_f32 v85, v85
Mvaa 72,148,44
Ta 148,3,20480
CV 140,104,105
Mvaa 48,152,16
Ta 150,3,22528
CV 141,106,107
Mvaa 56,152,20
v_exp_f32 v86, v86
Mvaa 64,152,48
v_exp_f32 v87, v87
Mvaa 72,152,52
Ta 152,4,20480
CV 130,84,85
Mvaa 48,156,24
Ta 154,4,22528
CV 131,86,87
Mvaa 56,156,28
v_exp_f32 v92, v92
Mvaa 64,156,56
LD 13,44,76,1024
Mvaa 72,156,60
Ta 156,5,20480
v_mfma_f32_16x16x32_bf16 v[52:55], a[160:163], a[0:3], v[144:147]
Ta 158,5,22528
v_mfma_f32_16x16x32_bf16 v[60:63], a[160:163], a[4:7], v[148:151]
v_exp_f32 v93, v93
v_mfma_f32_16x16x32_bf16 v[68:71], a[160:163], a[32:35], v[152:155]
v_exp_f32 v94, v94
v_mfma_f32_16x16x32_bf16 v[76:79], a[160:163], a[36:39], v[156:159]
ds_read_b128 a[160:163], v20 offset:8192
CV 134,92,93
Mvaa 52,164,8
v_exp_f32 v95, v95
Mvaa 60,164,12
v_exp_f32 v100, v100
Mvaa 68,164,40
L_pg12_7:
s_cbranch_execz L_ret12
v_exp_f32 v101, v101
Mvaa 76,164,44
ds_read_b128 a[164:167], v21 offset:8192
CV 135,94,95
Mvaa 52,168,16
v_exp_f32 v102, v102
Mvaa 60,168,20
v_exp_f32 v103, v103
Mvaa 68,168,48
v_exp_f32 v108, v108
Mvaa 76,168,52
ds_read_b128 a[168:171], v22 offset:8192
CV 138,100,101
Mvaa 52,172,24
LD 14,44,76,2048
CV 139,102,103
Mvaa 60,172,28
v_exp_f32 v109, v109
Mvaa 68,172,56
v_exp_f32 v110, v110
Mvaa 76,172,60
ds_read_b128 a[172:175], v23 offset:8192
CV 142,108,109
Mavv 240,40,112
v_exp_f32 v111, v111
Mavv 244,40,116
CV 143,110,111
Mavv 248,40,120
v_exp_f32 v48, v48
Mavv 252,40,124
v_exp_f32 v49, v49
Mvav 176,128,112
v_exp_f32 v50, v50
Mvav 184,128,116
v_exp_f32 v51, v51
Maav 176,128,120
v_exp_f32 v56, v56
Maav 184,128,124
s_waitcnt lgkmcnt(1)
ds_read_b128 a[128:131], v20 offset:12288
v_add_u32 v20, 0x9000, v20
Mvav 180,132,112
v_exp_f32 v57, v57
Mvav 188,132,116
v_exp_f32 v58, v58
Maav 180,132,120
LD 15,44,76,3072
Maav 188,132,124
s_add_u32 m0, s69, 0x1f000
s_add_u32 s76, s73, 0x78000
ds_read_b128 a[132:135], v21 offset:12288
Mvav 192,136,112
v_exp_f32 v59, v59
Mvav 200,136,116
v_exp_f32 v64, v64
Maav 192,136,120
v_exp_f32 v65, v65
Maav 200,136,124
ds_read_b128 a[136:139], v22 offset:12288
v_add_u32 v21, 0x9000, v21
Mvav 196,140,112
v_exp_f32 v66, v66
Mvav 204,140,116
v_exp_f32 v67, v67
Maav 196,140,120
v_exp_f32 v72, v72
Maav 204,140,124
ds_read_b128 a[140:143], v23 offset:12288
v_add_u32 v22, 0x9000, v22
Mvav 208,144,112
v_exp_f32 v73, v73
Mvav 216,144,116
v_exp_f32 v74, v74
Maav 208,144,120
v_exp_f32 v75, v75
Maav 216,144,124
Ta 144,2,24576
v_add_u32 v23, 0x9000, v23
Mvav 212,148,112
LD 16,48,76,0
Ta 146,2,26624
Mvav 220,148,116
v_exp_f32 v52, v52
Maav 212,148,120
v_exp_f32 v53, v53
Maav 220,148,124
Ta 148,3,24576
Mvav 224,152,112
Ta 150,3,26624
Mvav 232,152,116
v_exp_f32 v54, v54
Maav 224,152,120
v_exp_f32 v55, v55
Maav 232,152,124
Ta 152,4,24576
Mvav 228,156,112
Ta 154,4,26624
CV 112,48,49
Mvav 236,156,116
v_exp_f32 v60, v60
Maav 228,156,120
v_exp_f32 v61, v61
Maav 236,156,124
Ta 156,5,24576
CV 113,50,51
v_mfma_f32_16x16x32_bf16 v[80:83], a[160:163], a[0:3], v[144:147]
Ta 158,5,26624
CV 116,56,57
v_mfma_f32_16x16x32_bf16 v[88:91], a[160:163], a[4:7], v[148:151]
v_exp_f32 v62, v62
v_mfma_f32_16x16x32_bf16 v[96:99], a[160:163], a[32:35], v[152:155]
LD 17,48,76,1024
CV 117,58,59
v_mfma_f32_16x16x32_bf16 v[104:107], a[160:163], a[36:39], v[156:159]
Ta 160,2,28672
CV 120,64,65
Mvaa 80,164,8
Ta 162,2,30720
CV 121,66,67
Mvaa 88,164,12
v_exp_f32 v63, v63
Mvaa 96,164,40
v_exp_f32 v68, v68
Mvaa 104,164,44
Ta 164,3,28672
CV 124,72,73
Mvaa 80,168,16
Ta 166,3,30720
CV 125,74,75
Mvaa 88,168,20
v_exp_f32 v69, v69
Mvaa 96,168,48
v_exp_f32 v70, v70
Mvaa 104,168,52
s_waitcnt lgkmcnt(4)
Ta 168,4,28672
CV 114,52,53
Mvaa 80,172,24
Ta 170,4,30720
CV 115,54,55
Mvaa 88,172,28
v_exp_f32 v71, v71
Mvaa 96,172,56
v_exp_f32 v76, v76
Mvaa 104,172,60
Ta 172,5,28672
CV 118,60,61
v_mfma_f32_16x16x32_bf16 v[84:87], a[128:131], a[0:3], v[144:147]
LD 18,48,76,2048
Ta 174,5,30720
v_mfma_f32_16x16x32_bf16 v[92:95], a[128:131], a[4:7], v[148:151]
v_exp_f32 v77, v77
v_mfma_f32_16x16x32_bf16 v[100:103], a[128:131], a[32:35], v[152:155]
v_exp_f32 v78, v78
v_mfma_f32_16x16x32_bf16 v[108:111], a[128:131], a[36:39], v[156:159]
v_exp_f32 v79, v79
Mvaa 84,132,8
CV 119,62,63
CV 122,68,69
Mvaa 92,132,12
CV 123,70,71
CV 126,76,77
Mvaa 100,132,40
CV 127,78,79
v_add_u32 v2, 0x9000, v2
Mvaa 108,132,44
s_waitcnt lgkmcnt(0)
s_barrier
v_add_u32 v3, 0x9000, v3
v_add_u32 v4, 0x9000, v4
Mvaa 84,136,16
ds_read_b128 a[128:131], v20
v_add_u32 v5, 0x9000, v5
Mvaa 92,136,20
ds_read_b128 a[132:135], v21
Mvaa 100,136,48
v_exp_f32 v80, v80
Mvaa 108,136,52
ds_read_b128 a[136:139], v22
Mvaa 84,140,24
v_exp_f32 v81, v81
Mvaa 92,140,28
v_exp_f32 v82, v82
Mvaa 100,140,56
LD 19,48,76,3072
Mvaa 108,140,60
s_add_u32 m0, s69, 0
ds_read_b128 a[140:143], v23
s_add_u32 s76, s71, 0xe0000
Mavv 240,40,128
s_mul_i32 s77, s100, 0x400
v_min_u32 v46, 7, v1
Mavv 244,40,132
s_mul_i32 s85, s66, 0x100000
v_mul_u32_u24 v46, 0x80, v46
Mavv 248,40,136
s_add_u32 s77, s77, s85
v_exp_f32 v83, v83
Mavv 252,40,140
s_add_u32 s77, s77, 0xe0000
v_exp_f32 v88, v88
Mvav 176,144,128
buffer_load_dword v35, v46, s[48:51], s77 offen
Mvav 184,144,132
v_exp_f32 v89, v89
Maav 176,144,136
v_exp_f32 v90, v90
Maav 184,144,140
ds_read_b128 a[144:147], v20 offset:4096
Mvav 180,148,128
v_exp_f32 v91, v91
Mvav 188,148,132
v_exp_f32 v96, v96
Maav 180,148,136
v_exp_f32 v97, v97
Maav 188,148,140
ds_read_b128 a[148:151], v21 offset:4096
Mvav 192,152,128
v_exp_f32 v98, v98
Mvav 200,152,132
v_exp_f32 v99, v99
Maav 192,152,136
v_exp_f32 v104, v104
Maav 200,152,140
ds_read_b128 a[152:155], v22 offset:4096
Mvav 196,156,128
v_exp_f32 v105, v105
Mvav 204,156,132
v_exp_f32 v106, v106
Maav 196,156,136
v_exp_f32 v107, v107
Maav 204,156,140
ds_read_b128 a[156:159], v23 offset:4096
Mvav 208,160,128
v_exp_f32 v84, v84
Mvav 216,160,132
v_exp_f32 v85, v85
Maav 208,160,136
v_exp_f32 v86, v86
Maav 216,160,140
Ta 160,2,16384
Mvav 212,164,128
Ta 162,2,18432
Mvav 220,164,132
v_exp_f32 v87, v87
Maav 212,164,136
v_exp_f32 v92, v92
Maav 220,164,140
Ta 164,3,16384
Mvav 224,168,128
Ta 166,3,18432
Mvav 232,168,132
v_exp_f32 v93, v93
Maav 224,168,136
v_exp_f32 v94, v94
Maav 232,168,140
Ta 168,4,16384
Mvav 228,172,128
Ta 170,4,18432
CV 128,80,81
Mvav 236,172,132
v_exp_f32 v95, v95
Maav 228,172,136
v_exp_f32 v100, v100
Maav 236,172,140
s_waitcnt lgkmcnt(4)
Ta 172,5,16384
CV 129,82,83
v_mfma_f32_16x16x32_bf16 v[48:51], a[128:131], a[0:3], v[144:147]
Ta 174,5,18432
CV 132,88,89
v_mfma_f32_16x16x32_bf16 v[56:59], a[128:131], a[4:7], v[148:151]
v_exp_f32 v101, v101
v_mfma_f32_16x16x32_bf16 v[64:67], a[128:131], a[32:35], v[152:155]
LD 12,44,76,0
CV 133,90,91
v_mfma_f32_16x16x32_bf16 v[72:75], a[128:131], a[36:39], v[156:159]
Ta 128,2,20480
CV 136,96,97
Mvaa 48,132,8
Ta 130,2,22528
CV 137,98,99
Mvaa 56,132,12
v_exp_f32 v102, v102
Mvaa 64,132,40
v_exp_f32 v103, v103
Mvaa 72,132,44
Ta 132,3,20480
CV 140,104,105
Mvaa 48,136,16
Ta 134,3,22528
CV 141,106,107
Mvaa 56,136,20
v_exp_f32 v108, v108
Mvaa 64,136,48
v_exp_f32 v109, v109
Mvaa 72,136,52
Ta 136,4,20480
CV 130,84,85
Mvaa 48,140,24
Ta 138,4,22528
CV 131,86,87
Mvaa 56,140,28
v_exp_f32 v110, v110
Mvaa 64,140,56
LD 13,44,76,1024
CV 134,92,93
Mvaa 72,140,60
Ta 140,5,20480
CV 135,94,95
v_mfma_f32_16x16x32_bf16 v[52:55], a[144:147], a[0:3], v[144:147]
Ta 142,5,22528
CV 138,100,101
v_mfma_f32_16x16x32_bf16 v[60:63], a[144:147], a[4:7], v[148:151]
v_exp_f32 v111, v111
v_mfma_f32_16x16x32_bf16 v[68:71], a[144:147], a[32:35], v[152:155]
CV 139,102,103
CV 142,108,109
v_mfma_f32_16x16x32_bf16 v[76:79], a[144:147], a[36:39], v[156:159]
ds_read_b128 a[144:147], v20 offset:8192
CV 143,110,111
Mvaa 52,148,8
v_exp_f32 v48, v48
Mvaa 60,148,12
v_exp_f32 v49, v49
Mvaa 68,148,40
v_exp_f32 v50, v50
Mvaa 76,148,44
ds_read_b128 a[148:151], v21 offset:8192
Mvaa 52,152,16
v_exp_f32 v51, v51
Mvaa 60,152,20
v_exp_f32 v56, v56
Mvaa 68,152,48
v_exp_f32 v57, v57
Mvaa 76,152,52
ds_read_b128 a[152:155], v22 offset:8192
Mvaa 52,156,24
LD 14,44,76,2048
s_lshl_b32 s85, s30, 7
Mvaa 60,156,28
s_add_u32 s85, s85, 0x4000
v_exp_f32 v58, v58
Mvaa 68,156,56
s_getpc_b64 s[96:97]
v_mov_b32 v46, s85
Mvaa 76,156,60
ds_read_b128 a[156:159], v23 offset:8192
Mavv 240,40,112
global_load_dword v35, v46, s[96:97]
Mavv 244,40,116
v_exp_f32 v59, v59
Mavv 248,40,120
v_exp_f32 v64, v64
Mavv 252,40,124
v_exp_f32 v65, v65
Mvav 176,160,112
v_exp_f32 v66, v66
Mvav 184,160,116
v_exp_f32 v67, v67
Maav 176,160,120
v_exp_f32 v72, v72
Maav 184,160,124
s_waitcnt lgkmcnt(1)
ds_read_b128 a[160:163], v20 offset:12288
v_add_u32 v20, 0x9000, v20
Mvav 180,164,112
v_exp_f32 v73, v73
Mvav 188,164,116
v_exp_f32 v74, v74
Maav 180,164,120
LD 15,44,76,3072
Maav 188,164,124
s_add_u32 m0, s69, 0x4000
s_add_u32 s76, s73, 0x7c000
ds_read_b128 a[164:167], v21 offset:12288
Mvav 192,168,112
v_exp_f32 v75, v75
Mvav 200,168,116
v_exp_f32 v52, v52
Maav 192,168,120
v_exp_f32 v53, v53
Maav 200,168,124
ds_read_b128 a[168:171], v22 offset:12288
v_add_u32 v21, 0x9000, v21
Mvav 196,172,112
v_exp_f32 v54, v54
Mvav 204,172,116
v_exp_f32 v55, v55
Maav 196,172,120
v_exp_f32 v60, v60
Maav 204,172,124
ds_read_b128 a[172:175], v23 offset:12288
v_add_u32 v22, 0x9000, v22
Mvav 208,128,112
v_exp_f32 v61, v61
Mvav 216,128,116
v_exp_f32 v62, v62
Maav 208,128,120
v_exp_f32 v63, v63
Maav 216,128,124
Ta 128,2,24576
v_add_u32 v23, 0x9000, v23
Mvav 212,132,112
LD 16,48,76,0
Ta 130,2,26624
Mvav 220,132,116
v_exp_f32 v68, v68
Maav 212,132,120
v_exp_f32 v69, v69
Maav 220,132,124
Ta 132,3,24576
Mvav 224,136,112
Ta 134,3,26624
Mvav 232,136,116
v_exp_f32 v70, v70
Maav 224,136,120
v_exp_f32 v71, v71
Maav 232,136,124
Ta 136,4,24576
Mvav 228,140,112
Ta 138,4,26624
CV 112,48,49
Mvav 236,140,116
v_exp_f32 v76, v76
Maav 228,140,120
v_exp_f32 v77, v77
Maav 236,140,124
Ta 140,5,24576
CV 113,50,51
v_mfma_f32_16x16x32_bf16 v[80:83], a[144:147], a[0:3], v[144:147]
Ta 142,5,26624
CV 116,56,57
v_mfma_f32_16x16x32_bf16 v[88:91], a[144:147], a[4:7], v[148:151]
v_exp_f32 v78, v78
v_mfma_f32_16x16x32_bf16 v[96:99], a[144:147], a[32:35], v[152:155]
LD 17,48,76,1024
CV 117,58,59
v_mfma_f32_16x16x32_bf16 v[104:107], a[144:147], a[36:39], v[156:159]
Ta 144,2,28672
CV 120,64,65
Mvaa 80,148,8
Ta 146,2,30720
CV 121,66,67
Mvaa 88,148,12
v_exp_f32 v79, v79
Mvaa 96,148,40
CV 124,72,73
CV 125,74,75
Mvaa 104,148,44
Ta 148,3,28672
CV 114,52,53
Mvaa 80,152,16
Ta 150,3,30720
CV 115,54,55
Mvaa 88,152,20
CV 118,60,61
CV 119,62,63
Mvaa 96,152,48
CV 122,68,69
CV 123,70,71
Mvaa 104,152,52
s_waitcnt lgkmcnt(4)
Ta 152,4,28672
CV 126,76,77
Mvaa 80,156,24
s_mul_i32 s77, s100, 0x400
Ta 154,4,30720
v_min_u32 v46, 7, v1
Mvaa 88,156,28
s_mul_i32 s85, s66, 0x90000
v_mul_u32_u24 v46, 0x80, v46
CV 127,78,79
Mvaa 96,156,56
s_add_u32 s77, s77, s85
v_add_u32 v2, 0x9000, v2
v_add_u32 v3, 0x9000, v3
Mvaa 104,156,60
buffer_load_dword v35, v46, s[52:55], s77 offen
Ta 156,5,28672
v_mfma_f32_16x16x32_bf16 v[84:87], a[160:163], a[0:3], v[144:147]
Ta 158,5,30720
v_add_u32 v4, 0x9000, v4
v_mfma_f32_16x16x32_bf16 v[92:95], a[160:163], a[4:7], v[148:151]
LD 18,48,76,2048
v_add_u32 v5, 0x9000, v5
v_mfma_f32_16x16x32_bf16 v[100:103], a[160:163], a[32:35], v[152:155]
v_exp_f32 v80, v80
v_mfma_f32_16x16x32_bf16 v[108:111], a[160:163], a[36:39], v[156:159]
v_exp_f32 v81, v81
Mvaa 84,164,8
v_exp_f32 v82, v82
Mvaa 92,164,12
v_exp_f32 v83, v83
Mvaa 100,164,40
v_exp_f32 v88, v88
Mvaa 108,164,44
s_waitcnt vmcnt(19) lgkmcnt(0)
s_barrier
v_exp_f32 v89, v89
Mvaa 84,168,16
ds_read_b128 a[160:163], v20
Mvaa 92,168,20
ds_read_b128 a[164:167], v21
Mvaa 100,168,48
v_exp_f32 v90, v90
Mvaa 108,168,52
ds_read_b128 a[168:171], v22
Mvaa 84,172,24
v_exp_f32 v91, v91
Mvaa 92,172,28
v_exp_f32 v96, v96
Mvaa 100,172,56
LD 19,48,76,3072
Mvaa 108,172,60
s_add_u32 m0, s69, 0x9000
ds_read_b128 a[172:175], v23
s_add_u32 s76, s71, 0xe4000
Mavv 240,40,128
v_exp_f32 v97, v97
Mavv 244,40,132
v_exp_f32 v98, v98
Mavv 248,40,136
v_exp_f32 v99, v99
Mavv 252,40,140
v_exp_f32 v104, v104
Mvav 176,128,128
v_exp_f32 v105, v105
Mvav 184,128,132
v_exp_f32 v106, v106
Maav 176,128,136
v_exp_f32 v107, v107
Maav 184,128,140
ds_read_b128 a[128:131], v20 offset:4096
Mvav 180,132,128
v_exp_f32 v84, v84
Mvav 188,132,132
v_exp_f32 v85, v85
Maav 180,132,136
v_exp_f32 v86, v86
Maav 188,132,140
ds_read_b128 a[132:135], v21 offset:4096
Mvav 192,136,128
v_exp_f32 v87, v87
Mvav 200,136,132
v_exp_f32 v92, v92
Maav 192,136,136
v_exp_f32 v93, v93
Maav 200,136,140
ds_read_b128 a[136:139], v22 offset:4096
Mvav 196,140,128
v_exp_f32 v94, v94
Mvav 204,140,132
v_exp_f32 v95, v95
Maav 196,140,136
v_exp_f32 v100, v100
Maav 204,140,140
ds_read_b128 a[140:143], v23 offset:4096
Mvav 208,144,128
v_exp_f32 v101, v101
Mvav 216,144,132
v_exp_f32 v102, v102
Maav 208,144,136
v_exp_f32 v103, v103
Maav 216,144,140
Ta 144,2,16384
Mvav 212,148,128
Ta 146,2,18432
Mvav 220,148,132
v_exp_f32 v108, v108
Maav 212,148,136
v_exp_f32 v109, v109
Maav 220,148,140
Ta 148,3,16384
Mvav 224,152,128
Ta 150,3,18432
Mvav 232,152,132
v_exp_f32 v110, v110
Maav 224,152,136
v_exp_f32 v111, v111
Maav 232,152,140
Ta 152,4,16384
Mvav 228,156,128
Ta 154,4,18432
CV 128,80,81
Mvav 236,156,132
CV 129,82,83
L_pg12_8:
s_cbranch_execz L_ret12
CV 132,88,89
Maav 228,156,136
CV 133,90,91
CV 136,96,97
Maav 236,156,140
s_waitcnt lgkmcnt(4)
Ta 156,5,16384
CV 137,98,99
v_mfma_f32_16x16x32_bf16 v[48:51], a[160:163], a[0:3], v[144:147]
Ta 158,5,18432
CV 140,104,105
v_mfma_f32_16x16x32_bf16 v[56:59], a[160:163], a[4:7], v[148:151]
CV 141,106,107
CV 130,84,85
v_mfma_f32_16x16x32_bf16 v[64:67], a[160:163], a[32:35], v[152:155]
LD 12,44,76,0
CV 131,86,87
v_mfma_f32_16x16x32_bf16 v[72:75], a[160:163], a[36:39], v[156:159]
Ta 160,2,20480
CV 134,92,93
Mvaa 48,164,8
Ta 162,2,22528
CV 135,94,95
Mvaa 56,164,12
CV 138,100,101
CV 139,102,103
Mvaa 64,164,40
CV 142,108,109
CV 143,110,111
Mvaa 72,164,44
Ta 164,3,20480
Mvaa 48,168,16
Ta 166,3,22528
Mvaa 56,168,20
Mvaa 64,168,48
Mvaa 72,168,52
Ta 168,4,20480
Mvaa 48,172,24
Ta 170,4,22528
Mvaa 56,172,28
s_nop 0
Mvaa 64,172,56
LD 13,44,76,1024
Mvaa 72,172,60
Ta 172,5,20480
v_mfma_f32_16x16x32_bf16 v[52:55], a[128:131], a[0:3], v[144:147]
Ta 174,5,22528
v_mfma_f32_16x16x32_bf16 v[60:63], a[128:131], a[4:7], v[148:151]
v_exp_f32 v48, v48
v_mfma_f32_16x16x32_bf16 v[68:71], a[128:131], a[32:35], v[152:155]
v_exp_f32 v49, v49
v_mfma_f32_16x16x32_bf16 v[76:79], a[128:131], a[36:39], v[156:159]
ds_read_b128 a[128:131], v20 offset:8192
Mvaa 52,132,8
v_exp_f32 v50, v50
Mvaa 60,132,12
v_exp_f32 v51, v51
Mvaa 68,132,40
v_exp_f32 v56, v56
Mvaa 76,132,44
ds_read_b128 a[132:135], v21 offset:8192
Mvaa 52,136,16
v_exp_f32 v57, v57
Mvaa 60,136,20
v_exp_f32 v58, v58
Mvaa 68,136,48
v_exp_f32 v59, v59
Mvaa 76,136,52
ds_read_b128 a[136:139], v22 offset:8192
Mvaa 52,140,24
LD 14,44,76,2048
Mvaa 60,140,28
v_exp_f32 v64, v64
Mvaa 68,140,56
v_exp_f32 v65, v65
Mvaa 76,140,60
ds_read_b128 a[140:143], v23 offset:8192
Mavv 240,40,112
v_exp_f32 v66, v66
Mavv 244,40,116
v_exp_f32 v67, v67
Mavv 248,40,120
v_exp_f32 v72, v72
Mavv 252,40,124
v_exp_f32 v73, v73
Mvav 176,144,112
v_exp_f32 v74, v74
Mvav 184,144,116
v_exp_f32 v75, v75
Maav 176,144,120
v_exp_f32 v52, v52
Maav 184,144,124
s_waitcnt lgkmcnt(1)
ds_read_b128 a[144:147], v20 offset:12288
v_add_u32 v20, 0x9000, v20
Mvav 180,148,112
v_exp_f32 v53, v53
Mvav 188,148,116
v_exp_f32 v54, v54
Maav 180,148,120
LD 15,44,76,3072
Maav 188,148,124
s_add_u32 m0, s69, 0xd000
s_add_u32 s76, s73, 0xe0000
ds_read_b128 a[148:151], v21 offset:12288
Mvav 192,152,112
v_exp_f32 v55, v55
Mvav 200,152,116
v_add_u32 v21, 0x9000, v21
Maav 192,152,120
v_exp_f32 v60, v60
Maav 200,152,124
ds_read_b128 a[152:155], v22 offset:12288
v_add_u32 v22, 0x9000, v22
Mvav 196,156,112
v_exp_f32 v61, v61
Mvav 204,156,116
v_exp_f32 v62, v62
Maav 196,156,120
v_exp_f32 v63, v63
Maav 204,156,124
ds_read_b128 a[156:159], v23 offset:12288
v_add_u32 v23, 0x9000, v23
Mvav 208,160,112
v_exp_f32 v68, v68
Mvav 216,160,116
v_exp_f32 v69, v69
Maav 208,160,120
v_exp_f32 v70, v70
Maav 216,160,124
Ta 160,2,24576
Mvav 212,164,112
LD 16,48,76,0
Ta 162,2,26624
Mvav 220,164,116
v_exp_f32 v71, v71
Maav 212,164,120
v_exp_f32 v76, v76
Maav 220,164,124
Ta 164,3,24576
Mvav 224,168,112
Ta 166,3,26624
Mvav 232,168,116
v_exp_f32 v77, v77
Maav 224,168,120
v_exp_f32 v78, v78
Maav 232,168,124
Ta 168,4,24576
Mvav 228,172,112
Ta 170,4,26624
CV 112,48,49
Mvav 236,172,116
v_exp_f32 v79, v79
Maav 228,172,120
CV 113,50,51
CV 116,56,57
Maav 236,172,124
Ta 172,5,24576
CV 117,58,59
v_mfma_f32_16x16x32_bf16 v[80:83], a[128:131], a[0:3], v[144:147]
Ta 174,5,26624
CV 120,64,65
v_mfma_f32_16x16x32_bf16 v[88:91], a[128:131], a[4:7], v[148:151]
CV 121,66,67
CV 124,72,73
v_mfma_f32_16x16x32_bf16 v[96:99], a[128:131], a[32:35], v[152:155]
LD 17,48,76,1024
CV 125,74,75
v_mfma_f32_16x16x32_bf16 v[104:107], a[128:131], a[36:39], v[156:159]
Ta 128,2,28672
CV 114,52,53
Mvaa 80,132,8
Ta 130,2,30720
CV 115,54,55
Mvaa 88,132,12
CV 118,60,61
CV 119,62,63
Mvaa 96,132,40
CV 122,68,69
CV 123,70,71
Mvaa 104,132,44
Ta 132,3,28672
CV 126,76,77
Mvaa 80,136,16
Ta 134,3,30720
CV 127,78,79
Mvaa 88,136,20
v_add_u32 v2, 0x9000, v2
v_add_u32 v3, 0x9000, v3
Mvaa 96,136,48
Mvaa 104,136,52
s_waitcnt lgkmcnt(4)
Ta 136,4,28672
Mvaa 80,140,24
s_mul_i32 s77, s100, 0x400
Ta 138,4,30720
v_min_u32 v46, 7, v1
Mvaa 88,140,28
s_mul_i32 s85, s66, 0x90000
v_mul_u32_u24 v46, 0x80, v46
v_add_u32 v4, 0x9000, v4
Mvaa 96,140,56
s_add_u32 s77, s77, s85
Mvaa 104,140,60
s_add_u32 s77, s77, 0x10000
Ta 140,5,28672
v_mfma_f32_16x16x32_bf16 v[84:87], a[144:147], a[0:3], v[144:147]
LD 18,48,76,2048
Ta 142,5,30720
v_mfma_f32_16x16x32_bf16 v[92:95], a[144:147], a[4:7], v[148:151]
v_add_u32 v5, 0x9000, v5
v_mfma_f32_16x16x32_bf16 v[100:103], a[144:147], a[32:35], v[152:155]
v_exp_f32 v80, v80
v_mfma_f32_16x16x32_bf16 v[108:111], a[144:147], a[36:39], v[156:159]
v_exp_f32 v81, v81
Mvaa 84,148,8
buffer_load_dword v35, v46, s[52:55], s77 offen
Mvaa 92,148,12
v_exp_f32 v82, v82
Mvaa 100,148,40
v_exp_f32 v83, v83
Mvaa 108,148,44
s_waitcnt vmcnt(19) lgkmcnt(0)
s_barrier
v_exp_f32 v88, v88
Mvaa 84,152,16
ds_read_b128 a[144:147], v20
Mvaa 92,152,20
ds_read_b128 a[148:151], v21
Mvaa 100,152,48
v_exp_f32 v89, v89
Mvaa 108,152,52
ds_read_b128 a[152:155], v22
Mvaa 84,156,24
v_exp_f32 v90, v90
Mvaa 92,156,28
v_exp_f32 v91, v91
Mvaa 100,156,56
LD 19,48,76,3072
Mvaa 108,156,60
s_add_u32 m0, s69, 0x12000
ds_read_b128 a[156:159], v23
s_add_u32 s76, s71, 0xe8000
Mavv 240,40,128
v_exp_f32 v96, v96
Mavv 244,40,132
v_exp_f32 v97, v97
Mavv 248,40,136
v_exp_f32 v98, v98
Mavv 252,40,140
v_exp_f32 v99, v99
Mvav 176,160,128
v_exp_f32 v104, v104
Mvav 184,160,132
v_exp_f32 v105, v105
Maav 176,160,136
v_exp_f32 v106, v106
Maav 184,160,140
ds_read_b128 a[160:163], v20 offset:4096
Mvav 180,164,128
v_exp_f32 v107, v107
Mvav 188,164,132
v_exp_f32 v84, v84
Maav 180,164,136
v_exp_f32 v85, v85
Maav 188,164,140
ds_read_b128 a[164:167], v21 offset:4096
Mvav 192,168,128
v_exp_f32 v86, v86
Mvav 200,168,132
v_exp_f32 v87, v87
Maav 192,168,136
v_exp_f32 v92, v92
Maav 200,168,140
ds_read_b128 a[168:171], v22 offset:4096
Mvav 196,172,128
buffer_load_dword v173, v172, s[40:43], 0 offen sc1
Mvav 204,172,132
v_exp_f32 v93, v93
Maav 196,172,136
v_exp_f32 v94, v94
Maav 204,172,140
ds_read_b128 a[172:175], v23 offset:4096
Mvav 208,128,128
v_exp_f32 v95, v95
Mvav 216,128,132
v_exp_f32 v100, v100
Maav 208,128,136
v_exp_f32 v101, v101
Maav 216,128,140
Ta 128,2,16384
Mvav 212,132,128
Ta 130,2,18432
Mvav 220,132,132
v_exp_f32 v102, v102
Maav 212,132,136
v_exp_f32 v103, v103
Maav 220,132,140
Ta 132,3,16384
Mvav 224,136,128
Ta 134,3,18432
Mvav 232,136,132
v_exp_f32 v108, v108
Maav 224,136,136
v_exp_f32 v109, v109
Maav 232,136,140
Ta 136,4,16384
Mvav 228,140,128
Ta 138,4,18432
CV 128,80,81
Mvav 236,140,132
v_exp_f32 v110, v110
Maav 228,140,136
v_exp_f32 v111, v111
Maav 236,140,140
s_waitcnt lgkmcnt(4)
Ta 140,5,16384
CV 129,82,83
v_mfma_f32_16x16x32_bf16 v[48:51], a[144:147], a[0:3], v[144:147]
Ta 142,5,18432
CV 132,88,89
v_mfma_f32_16x16x32_bf16 v[56:59], a[144:147], a[4:7], v[148:151]
CV 133,90,91
CV 136,96,97
v_mfma_f32_16x16x32_bf16 v[64:67], a[144:147], a[32:35], v[152:155]
LD 12,44,76,0
CV 137,98,99
v_mfma_f32_16x16x32_bf16 v[72:75], a[144:147], a[36:39], v[156:159]
Ta 144,2,20480
CV 140,104,105
Mvaa 48,148,8
Ta 146,2,22528
CV 141,106,107
Mvaa 56,148,12
CV 130,84,85
CV 131,86,87
Mvaa 64,148,40
CV 134,92,93
CV 135,94,95
Mvaa 72,148,44
Ta 148,3,20480
CV 138,100,101
Mvaa 48,152,16
Ta 150,3,22528
CV 139,102,103
Mvaa 56,152,20
CV 142,108,109
CV 143,110,111
Mvaa 64,152,48
Mvaa 72,152,52
Ta 152,4,20480
Mvaa 48,156,24
Ta 154,4,22528
Mvaa 56,156,28
s_nop 0
Mvaa 64,156,56
LD 13,44,76,1024
Mvaa 72,156,60
Ta 156,5,20480
v_mfma_f32_16x16x32_bf16 v[52:55], a[160:163], a[0:3], v[144:147]
Ta 158,5,22528
v_mfma_f32_16x16x32_bf16 v[60:63], a[160:163], a[4:7], v[148:151]
v_exp_f32 v48, v48
v_mfma_f32_16x16x32_bf16 v[68:71], a[160:163], a[32:35], v[152:155]
v_exp_f32 v49, v49
v_mfma_f32_16x16x32_bf16 v[76:79], a[160:163], a[36:39], v[156:159]
ds_read_b128 a[160:163], v20 offset:8192
Mvaa 52,164,8
v_exp_f32 v56, v56
Mvaa 60,164,12
v_exp_f32 v57, v57
Mvaa 68,164,40
v_exp_f32 v50, v50
Mvaa 76,164,44
ds_read_b128 a[164:167], v21 offset:8192
Mvaa 52,168,16
v_exp_f32 v51, v51
Mvaa 60,168,20
v_exp_f32 v58, v58
Mvaa 68,168,48
v_exp_f32 v59, v59
Mvaa 76,168,52
ds_read_b128 a[168:171], v22 offset:8192
Mvaa 52,172,24
LD 14,44,76,2048
s_lshl_b32 s85, s30, 7
Mvaa 60,172,28
s_add_u32 s85, s85, 0x4000
v_exp_f32 v64, v64
Mvaa 68,172,56
s_getpc_b64 s[96:97]
s_waitcnt vmcnt(3)
v_cmp_ne_u32 vcc, s98, v173
s_cbranch_vccnz L_spin10
L_pollok10:
Mvaa 76,172,60
ds_read_b128 a[172:175], v23 offset:8192
v_mov_b32 v46, s85
Mavv 240,40,112
buffer_load_dwordx4 a[64:67], v7, s[40:43], s5 offen sc1
v_lshl_add_u32 v172, v1, 2, s11
Mavv 244,40,116
s_lshl_b32 s11, s94, 3
v_exp_f32 v52, v52
Mavv 248,40,120
s_add_u32 s11, s11, s17
v_exp_f32 v53, v53
Mavv 252,40,124
s_lshl_b32 s11, s11, 7
v_exp_f32 v60, v60
Mvav 176,128,112
buffer_load_dwordx4 a[68:71], v7, s[40:43], s5 offen offset:1024 sc1
s_add_u32 s11, s11, 0x301002c
Mvav 184,128,116
s_add_u32 s17, s66, 5
v_exp_f32 v61, v61
Maav 176,128,120
s_and_b32 s17, s17, 7
v_exp_f32 v54, v54
Maav 184,128,124
s_waitcnt lgkmcnt(1)
ds_read_b128 a[128:131], v20 offset:12288
v_add_u32 v20, 0xfffe5000, v20
Mvav 180,132,112
buffer_load_dwordx4 a[72:75], v7, s[40:43], s5 offen offset:2048 sc1
Mvav 188,132,116
v_exp_f32 v55, v55
Maav 180,132,120
v_exp_f32 v62, v62
Maav 188,132,124
ds_read_b128 a[132:135], v21 offset:12288
v_add_u32 v21, 0xfffe5000, v21
Mvav 192,136,112
LD 15,44,76,3072
Mvav 200,136,116
s_add_u32 m0, s69, 0x16000
s_add_u32 s76, s73, 0xe4000
Maav 192,136,120
v_exp_f32 v63, v63
Maav 200,136,124
ds_read_b128 a[136:139], v22 offset:12288
v_add_u32 v22, 0xfffe5000, v22
Mvav 196,140,112
buffer_load_dwordx4 a[76:79], v7, s[40:43], s5 offen offset:3072 sc1
Mvav 204,140,116
s_and_b32 s5, s66, 4
v_exp_f32 v65, v65
Maav 196,140,120
s_lshl_b32 s5, s5, 28
v_exp_f32 v66, v66
Maav 204,140,124
ds_read_b128 a[140:143], v23 offset:12288
v_add_u32 v23, 0xfffe5000, v23
Mvav 208,144,112
buffer_load_dwordx4 a[80:83], v7, s[40:43], s6 offen sc1
v_or_b32 v39, s5, v7
Mvav 216,144,116
v_exp_f32 v67, v67
Maav 208,144,120
v_exp_f32 v72, v72
Maav 216,144,124
Ta 144,2,24576
Mvav 212,148,112
global_load_dword v35, v46, s[96:97]
Ta 146,2,26624
Mvav 220,148,116
v_exp_f32 v73, v73
Maav 212,148,120
LD 16,48,76,0
Maav 220,148,124
Ta 148,3,24576
Mvav 224,152,112
Ta 150,3,26624
Mvav 232,152,116
v_exp_f32 v74, v74
Maav 224,152,120
buffer_load_dwordx4 a[84:87], v7, s[40:43], s6 offen offset:1024 sc1
Maav 232,152,124
Ta 152,4,24576
Mvav 228,156,112
Ta 154,4,26624
CV 112,48,49
Mvav 236,156,116
v_exp_f32 v75, v75
Maav 228,156,120
buffer_load_dwordx4 a[88:91], v7, s[40:43], s6 offen offset:2048 sc1
CV 116,56,57
Maav 236,156,124
Ta 156,5,24576
CV 113,50,51
v_mfma_f32_16x16x32_bf16 v[80:83], a[160:163], a[0:3], v[144:147]
Ta 158,5,26624
CV 117,58,59
v_mfma_f32_16x16x32_bf16 v[88:91], a[160:163], a[4:7], v[148:151]
v_exp_f32 v68, v68
v_mfma_f32_16x16x32_bf16 v[96:99], a[160:163], a[32:35], v[152:155]
buffer_load_dwordx4 a[92:95], v7, s[40:43], s6 offen offset:3072 sc1
CV 114,52,53
v_mfma_f32_16x16x32_bf16 v[104:107], a[160:163], a[36:39], v[156:159]
s_mul_i32 s6, s94, 0x9000
Ta 160,2,28672
CV 118,60,61
Mvaa 80,164,8
Ta 162,2,30720
CV 115,54,55
Mvaa 88,164,12
v_exp_f32 v69, v69
Mvaa 96,164,40
buffer_load_dwordx4 a[96:99], v7, s[40:43], s7 offen sc1
CV 119,62,63
Mvaa 104,164,44
Ta 164,3,28672
CV 120,64,65
Mvaa 80,168,16
Ta 166,3,30720
CV 121,66,67
Mvaa 88,168,20
v_exp_f32 v70, v70
Mvaa 96,168,48
LD 17,48,76,1024
CV 124,72,73
Mvaa 104,168,52
s_waitcnt lgkmcnt(4)
Ta 168,4,28672
CV 125,74,75
Mvaa 80,172,24
Ta 170,4,30720
CV 122,68,69
Mvaa 88,172,28
v_exp_f32 v71, v71
Mvaa 96,172,56
buffer_load_dwordx4 a[100:103], v7, s[40:43], s7 offen offset:1024 sc1
CV 123,70,71
Mvaa 104,172,60
Ta 172,5,28672
v_add_u32 v2, 0xfffe5000, v2
v_mfma_f32_16x16x32_bf16 v[84:87], a[128:131], a[0:3], v[144:147]
Ta 174,5,30720
v_add_u32 v3, 0xfffe5000, v3
v_mfma_f32_16x16x32_bf16 v[92:95], a[128:131], a[4:7], v[148:151]
v_exp_f32 v76, v76
v_mfma_f32_16x16x32_bf16 v[100:103], a[128:131], a[32:35], v[152:155]
buffer_load_dwordx4 a[104:107], v7, s[40:43], s7 offen offset:2048 sc1
v_add_u32 v4, 0xfffe5000, v4
v_mfma_f32_16x16x32_bf16 v[108:111], a[128:131], a[36:39], v[156:159]
v_exp_f32 v77, v77
Mvaa 84,132,8
v_exp_f32 v78, v78
Mvaa 92,132,12
v_exp_f32 v79, v79
Mvaa 100,132,40
buffer_load_dwordx4 a[108:111], v7, s[40:43], s7 offen offset:3072 sc1
s_waitcnt lgkmcnt(0)
s_barrier
Mvaa 108,132,44
s_add_u32 s7, s19, 0x9000
ds_read_b128 a[128:131], v20
CV 126,76,77
Mvaa 84,136,16
ds_read_b128 a[132:135], v21
CV 127,78,79
Mvaa 92,136,20
v_add_u32 v5, 0xfffe5000, v5
v_add3_u32 v38, v38, v175, s6
Mvaa 100,136,48
LD 18,48,76,2048
v_or_b32 v38, s5, v38
Mvaa 108,136,52
s_add_u32 s6, s19, 0xb000
ds_read_b128 a[136:139], v22
Mvaa 84,140,24
v_exp_f32 v80, v80
Mvaa 92,140,28
v_exp_f32 v81, v81
Mvaa 100,140,56
buffer_load_dwordx4 a[112:115], v7, s[40:43], s4 offen sc1
L_pg12_9:
s_cbranch_execz L_ret12
Mvaa 108,140,60
ds_read_b128 a[140:143], v23
Mavv 240,40,128
s_mul_i32 s77, s100, 0x400
s_mul_i32 s85, s66, 0x100000
s_add_u32 s77, s77, s85
Mavv 244,40,132
s_add_u32 s77, s77, 0xf0000
s_mul_i32 s85, s66, 0x90000
v_min_u32 v46, 7, v1
Mavv 248,40,136
buffer_load_dwordx4 a[116:119], v7, s[40:43], s4 offen offset:1024 sc1
v_mul_u32_u24 v46, 0x80, v46
Mavv 252,40,140
v_exp_f32 v82, v82
Mvav 176,144,128
v_exp_f32 v83, v83
Mvav 184,144,132
v_exp_f32 v88, v88
Maav 176,144,136
buffer_load_dwordx4 a[120:123], v7, s[40:43], s4 offen offset:2048 sc1
Maav 184,144,140
ds_read_b128 a[144:147], v20 offset:4096
Mvav 180,148,128
v_exp_f32 v89, v89
Mvav 188,148,132
v_exp_f32 v90, v90
Maav 180,148,136
buffer_load_dwordx4 a[124:127], v7, s[40:43], s4 offen offset:3072 sc1
Maav 188,148,140
s_add_u32 s4, s19, 0xa000
ds_read_b128 a[148:151], v21 offset:4096
Mvav 192,152,128
v_exp_f32 v91, v91
Mvav 200,152,132
v_exp_f32 v96, v96
Maav 192,152,136
LD 19,48,76,3072
Maav 200,152,140
s_add_u32 m0, s69, 0x1b000
ds_read_b128 a[152:155], v22 offset:4096
s_add_u32 s76, s71, 0xec000
Mvav 196,156,128
v_exp_f32 v97, v97
Mvav 204,156,132
v_exp_f32 v98, v98
Maav 196,156,136
buffer_load_dword v35, v46, s[44:47], s77 offen
Maav 204,156,140
s_mul_i32 s77, s100, 0x400
ds_read_b128 a[156:159], v23 offset:4096
s_add_u32 s77, s77, s85
Mvav 208,160,128
s_add_u32 s77, s77, 0x20000
v_min_u32 v46, 7, v1
Mvav 216,160,132
v_mul_u32_u24 v46, 0x80, v46
Maav 208,160,136
buffer_load_dword v35, v46, s[52:55], s77 offen
Maav 216,160,140
Ta 160,2,16384
Mvav 212,164,128
Ta 162,2,18432
Mvav 220,164,132
v_exp_f32 v99, v99
Maav 212,164,136
v_exp_f32 v104, v104
Maav 220,164,140
Ta 164,3,16384
Mvav 224,168,128
Ta 166,3,18432
Mvav 232,168,132
v_exp_f32 v105, v105
Maav 224,168,136
v_exp_f32 v106, v106
Maav 232,168,140
Ta 168,4,16384
Mvav 228,172,128
Ta 170,4,18432
CV 128,80,81
Mvav 236,172,132
v_exp_f32 v107, v107
Maav 228,172,136
v_exp_f32 v84, v84
Maav 236,172,140
Ta 172,5,16384
Ta 174,5,18432
CV 129,82,83
CV 132,88,89
CV 133,90,91
CV 136,96,97
CV 137,98,99
CV 140,104,105
CV 141,106,107
v_exp_f32 v85, v85
v_exp_f32 v86, v86
v_exp_f32 v87, v87
CV 130,84,85
v_exp_f32 v92, v92
CV 131,86,87
v_exp_f32 v93, v93
v_exp_f32 v94, v94
v_exp_f32 v95, v95
CV 134,92,93
v_exp_f32 v100, v100
CV 135,94,95
v_exp_f32 v101, v101
v_exp_f32 v102, v102
v_exp_f32 v103, v103
CV 138,100,101
v_exp_f32 v108, v108
CV 139,102,103
v_exp_f32 v109, v109
v_exp_f32 v110, v110
v_exp_f32 v111, v111
CV 142,108,109
CV 143,110,111
s_waitcnt vmcnt(3)
s_cmp_lg_u32 s89, 0
s_cbranch_scc1 L_max1
L_maxr1:
s_waitcnt lgkmcnt(0)
v_mfma_f32_16x16x32_bf16 v[48:51], a[128:131], a[64:67], 0
v_mfma_f32_16x16x32_bf16 v[56:59], a[128:131], a[68:71], 0
v_mfma_f32_16x16x32_bf16 v[64:67], a[128:131], a[96:99], 0
LD 12,44,76,0
v_mfma_f32_16x16x32_bf16 v[72:75], a[128:131], a[100:103], 0
Ta 128,2,20480
Mvaa 48,132,72
Ta 130,2,22528
Mvaa 56,132,76
Mvaa 64,132,104
Mvaa 72,132,108
Ta 132,3,20480
Mvaa 48,136,80
Ta 134,3,22528
Mvaa 56,136,84
Mvaa 64,136,112
Mvaa 72,136,116
Ta 136,4,20480
Mvaa 48,140,88
Ta 138,4,22528
Mvaa 56,140,92
s_nop 0
Mvaa 64,140,120
LD 13,44,76,1024
Mvaa 72,140,124
Ta 140,5,20480
v_mfma_f32_16x16x32_bf16 v[52:55], a[144:147], a[64:67], 0
Ta 142,5,22528
v_max3_f32 v168, v48, v49, v28
v_mfma_f32_16x16x32_bf16 v[60:63], a[144:147], a[68:71], 0
s_nop 0
v_max3_f32 v170, v64, v65, v30
v_mfma_f32_16x16x32_bf16 v[68:71], a[144:147], a[96:99], 0
v_max3_f32 v169, v56, v57, v29
v_max3_f32 v168, v168, v50, v51
v_mfma_f32_16x16x32_bf16 v[76:79], a[144:147], a[100:103], 0
ds_read_b128 a[144:147], v20 offset:8192
v_max3_f32 v169, v169, v58, v59
Mvaa 52,148,72
v_max3_f32 v171, v72, v73, v31
v_max3_f32 v170, v170, v66, v67
Mvaa 60,148,76
v_max3_f32 v171, v171, v74, v75
Mvaa 68,148,104
Mvaa 76,148,108
ds_read_b128 a[148:151], v21 offset:8192
Mvaa 52,152,80
Mvaa 60,152,84
Mvaa 68,152,112
Mvaa 76,152,116
ds_read_b128 a[152:155], v22 offset:8192
Mvaa 52,156,88
LD 14,44,76,2048
Mvaa 60,156,92
s_nop 0
Mvaa 68,156,120
s_nop 0
Mvaa 76,156,124
ds_read_b128 a[156:159], v23 offset:8192
Mavv 240,40,112
v_max3_f32 v168, v168, v52, v53
Mavv 244,40,116
v_max3_f32 v169, v169, v60, v61
v_max3_f32 v168, v168, v54, v55
Mavv 248,40,120
s_nop 0
v_max3_f32 v171, v171, v76, v77
Mavv 252,40,124
v_max3_f32 v169, v169, v62, v63
v_max3_f32 v170, v170, v68, v69
Mvav 176,160,112
v_permlane32_swap_b32 v168, v169
Mvav 184,160,116
v_max_f32 v168, v168, v169
v_max3_f32 v170, v170, v70, v71
Maav 176,160,120
v_mov_b32 v169, v168
v_max3_f32 v171, v171, v78, v79
Maav 184,160,124
ds_read_b128 a[160:163], v20 offset:12288
v_add_u32 v20, 0x9000, v20
Mvav 180,164,112
v_permlane16_swap_b32 v168, v169
Mvav 188,164,116
v_permlane32_swap_b32 v170, v171
Maav 180,164,120
LD 15,44,76,3072
v_max_f32 v168, v168, v169
Maav 188,164,124
s_add_u32 m0, s69, 0x1f000
s_add_u32 s76, s73, 0xe8000
ds_read_b128 a[164:167], v21 offset:12288
Mvav 192,168,112
v_max_f32 v170, v170, v171
v_mov_b32 v169, v168
Mvav 200,168,116
s_nop 0
v_permlane32_swap_b32 v168, v169
Maav 192,168,120
v_mov_b32 v171, v170
v_sub_f32 v144, 0, v168
Maav 200,168,124
ds_read_b128 a[168:171], v22 offset:12288
v_sub_f32 v145, 0, v168
Mvav 196,172,112
v_permlane16_swap_b32 v170, v171
Mvav 204,172,116
v_sub_f32 v146, 0, v168
v_sub_f32 v147, 0, v168
Maav 196,172,120
v_max_f32 v170, v170, v171
v_sub_f32 v148, 0, v169
Maav 204,172,124
s_waitcnt lgkmcnt(2)
ds_read_b128 a[172:175], v23 offset:12288
v_mov_b32 v171, v170
Mvav 208,128,112
s_nop 0
v_permlane32_swap_b32 v170, v171
Mvav 216,128,116
v_sub_f32 v149, 0, v169
v_sub_f32 v150, 0, v169
Maav 208,128,120
v_sub_f32 v151, 0, v169
v_sub_f32 v152, 0, v170
Maav 216,128,124
Ta 128,2,24576
v_sub_f32 v153, 0, v170
Mvav 212,132,112
LD 16,48,76,0
Ta 130,2,26624
Mvav 220,132,116
v_sub_f32 v154, 0, v170
v_sub_f32 v155, 0, v170
Maav 212,132,120
v_sub_f32 v156, 0, v171
v_sub_f32 v157, 0, v171
Maav 220,132,124
Ta 132,3,24576
v_sub_f32 v158, 0, v171
Mvav 224,136,112
Ta 134,3,26624
v_sub_f32 v159, 0, v171
Mvav 232,136,116
v_add_u32 v21, 0x9000, v21
v_sub_f32 v48, v48, v168
Maav 224,136,120
v_exp_f32 v48, v48
Maav 232,136,124
Ta 136,4,24576
v_sub_f32 v49, v49, v168
Mvav 228,140,112
Ta 138,4,26624
v_sub_f32 v50, v50, v168
Mvav 236,140,116
v_exp_f32 v49, v49
Maav 228,140,120
v_exp_f32 v50, v50
Maav 236,140,124
Ta 140,5,24576
v_sub_f32 v51, v51, v168
v_mfma_f32_16x16x32_bf16 v[80:83], a[144:147], a[64:67], v[144:147]
Ta 142,5,26624
v_sub_f32 v56, v56, v169
v_mfma_f32_16x16x32_bf16 v[88:91], a[144:147], a[68:71], v[148:151]
v_exp_f32 v51, v51
v_mfma_f32_16x16x32_bf16 v[96:99], a[144:147], a[96:99], v[152:155]
LD 17,48,76,1024
v_sub_f32 v57, v57, v169
v_mfma_f32_16x16x32_bf16 v[104:107], a[144:147], a[100:103], v[156:159]
Ta 144,2,28672
v_sub_f32 v58, v58, v169
Mvaa 80,148,72
Ta 146,2,30720
v_sub_f32 v59, v59, v169
Mvaa 88,148,76
v_exp_f32 v56, v56
Mvaa 96,148,104
v_exp_f32 v57, v57
Mvaa 104,148,108
Ta 148,3,28672
CV 112,48,49
Mvaa 80,152,80
Ta 150,3,30720
CV 113,50,51
Mvaa 88,152,84
v_exp_f32 v58, v58
Mvaa 96,152,112
v_exp_f32 v59, v59
Mvaa 104,152,116
Ta 152,4,28672
v_sub_f32 v64, v64, v170
Mvaa 80,156,88
Ta 154,4,30720
v_sub_f32 v65, v65, v170
Mvaa 88,156,92
v_exp_f32 v64, v64
Mvaa 96,156,120
v_exp_f32 v65, v65
Mvaa 104,156,124
Ta 156,5,28672
v_sub_f32 v66, v66, v170
v_mfma_f32_16x16x32_bf16 v[84:87], a[160:163], a[64:67], v[144:147]
LD 18,48,76,2048
Ta 158,5,30720
v_mfma_f32_16x16x32_bf16 v[92:95], a[160:163], a[68:71], v[148:151]
v_exp_f32 v66, v66
v_mfma_f32_16x16x32_bf16 v[100:103], a[160:163], a[96:99], v[152:155]
v_sub_f32 v67, v67, v170
v_add_u32 v22, 0x9000, v22
v_mfma_f32_16x16x32_bf16 v[108:111], a[160:163], a[100:103], v[156:159]
s_waitcnt lgkmcnt(4)
v_exp_f32 v67, v67
Mvaa 84,164,72
CV 116,56,57
CV 117,58,59
Mvaa 92,164,76
v_sub_f32 v72, v72, v171
v_sub_f32 v73, v73, v171
Mvaa 100,164,104
v_exp_f32 v72, v72
Mvaa 108,164,108
s_waitcnt lgkmcnt(0)
s_barrier
v_exp_f32 v73, v73
Mvaa 84,168,80
ds_read_b128 a[160:163], v20
v_sub_f32 v74, v74, v171
Mvaa 92,168,84
ds_read_b128 a[164:167], v21
v_sub_f32 v75, v75, v171
Mvaa 100,168,112
v_exp_f32 v74, v74
Mvaa 108,168,116
ds_read_b128 a[168:171], v22
CV 120,64,65
Mvaa 84,172,88
v_exp_f32 v75, v75
Mvaa 92,172,92
CV 121,66,67
CV 124,72,73
Mvaa 100,172,120
LD 19,48,76,3072
CV 125,74,75
Mvaa 108,172,124
s_add_u32 m0, s69, 0
v_add_u32 v23, 0x9000, v23
v_sub_f32 v52, v52, v168
Mavv 240,40,128
s_mul_i32 s77, s100, 0x400
s_mul_i32 s85, s66, 0x100000
s_add_u32 s77, s77, s85
Mavv 244,40,132
s_add_u32 s77, s77, 0xf0000
s_mul_i32 s85, s66, 0x90000
ds_read_b128 a[172:175], v23
Mavv 248,40,136
s_add_u32 s76, s71, 0xf0000
v_min_u32 v46, 7, v1
v_sub_f32 v53, v53, v168
Mavv 252,40,140
v_mul_u32_u24 v46, 0x80, v46
v_sub_f32 v54, v54, v168
Mvav 176,128,128
buffer_load_dword v35, v46, s[48:51], s77 offen
v_sub_f32 v55, v55, v168
Mvav 184,128,132
s_mul_i32 s77, s100, 0x400
v_min_u32 v46, 7, v1
v_sub_f32 v60, v60, v169
Maav 176,128,136
s_add_u32 s77, s77, s85
v_mul_u32_u24 v46, 0x80, v46
v_sub_f32 v61, v61, v169
Maav 184,128,140
s_add_u32 s77, s77, 0x30000
ds_read_b128 a[128:131], v20 offset:4096
v_sub_f32 v62, v62, v169
Mvav 180,132,128
buffer_load_dword v35, v46, s[52:55], s77 offen
v_sub_f32 v63, v63, v169
Mvav 188,132,132
v_exp_f32 v52, v52
Maav 180,132,136
v_exp_f32 v53, v53
Maav 188,132,140
ds_read_b128 a[132:135], v21 offset:4096
CV 114,52,53
Mvav 192,136,128
v_exp_f32 v54, v54
Mvav 200,136,132
v_exp_f32 v55, v55
Maav 192,136,136
v_exp_f32 v60, v60
Maav 200,136,140
ds_read_b128 a[136:139], v22 offset:4096
CV 115,54,55
Mvav 196,140,128
v_exp_f32 v61, v61
Mvav 204,140,132
v_exp_f32 v62, v62
Maav 196,140,136
v_exp_f32 v63, v63
Maav 204,140,140
ds_read_b128 a[140:143], v23 offset:4096
v_sub_f32 v68, v68, v170
Mvav 208,144,128
v_exp_f32 v68, v68
Mvav 216,144,132
v_sub_f32 v69, v69, v170
v_sub_f32 v70, v70, v170
Maav 208,144,136
v_exp_f32 v69, v69
Maav 216,144,140
v_exp_f32 v70, v70
Mvav 212,148,128
v_sub_f32 v71, v71, v170
CV 118,60,61
Mvav 220,148,132
v_exp_f32 v71, v71
Maav 212,148,136
CV 119,62,63
v_sub_f32 v76, v76, v171
Maav 220,148,140
v_exp_f32 v76, v76
Mvav 224,152,128
v_sub_f32 v77, v77, v171
v_sub_f32 v78, v78, v171
Mvav 232,152,132
v_exp_f32 v77, v77
Maav 224,152,136
v_exp_f32 v78, v78
Maav 232,152,140
v_sub_f32 v79, v79, v171
CV 122,68,69
Mvav 228,156,128
v_exp_f32 v79, v79
Mvav 236,156,132
CV 123,70,71
CV 126,76,77
Maav 228,156,136
CV 127,78,79
v_add_u32 v2, 0x9000, v2
Maav 236,156,140
s_waitcnt lgkmcnt(0)
Ta 144,2,16384
v_accvgpr_read_b32 v160, a240
v_mfma_f32_16x16x32_bf16 v[48:51], a[160:163], a[64:67], v[144:147]
Ta 146,2,18432
v_add_u32 v3, 0x9000, v3
v_mfma_f32_16x16x32_bf16 v[56:59], a[160:163], a[68:71], v[148:151]
Ta 148,3,16384
v_accvgpr_read_b32 v161, a244
v_mfma_f32_16x16x32_bf16 v[64:67], a[160:163], a[96:99], v[152:155]
LD 12,44,76,0
Ta 150,3,18432
v_mfma_f32_16x16x32_bf16 v[72:75], a[160:163], a[100:103], v[156:159]
Ta 160,2,20480
v_max_f32 v174, v174, v160
Mvaa 48,164,72
Ta 162,2,22528
v_accvgpr_read_b32 v162, a248
Mvaa 56,164,76
v_rcp_f32 v160, v160
Mvaa 64,164,104
v_max_f32 v174, v174, v161
v_accvgpr_read_b32 v163, a252
Mvaa 72,164,108
Ta 164,3,20480
v_mul_f32 v176, v160, v176
Mvaa 48,168,80
Ta 166,3,22528
v_mul_f32 v177, v160, v177
Mvaa 56,168,84
v_rcp_f32 v161, v161
Mvaa 64,168,112
v_mul_f32 v178, v160, v178
v_mul_f32 v179, v160, v179
Mvaa 72,168,116
CV 176,176,177
CV 178,178,179
Mvaa 48,172,88
v_accvgpr_write_b32 a0, v176
v_accvgpr_write_b32 a1, v178
Mvaa 56,172,92
v_mul_f32 v184, v161, v184
v_mul_f32 v185, v161, v185
Mvaa 64,172,120
LD 13,44,76,1024
v_mul_f32 v186, v161, v186
Mvaa 72,172,124
v_mul_f32 v187, v161, v187
CV 184,184,185
v_mfma_f32_16x16x32_bf16 v[52:55], a[128:131], a[64:67], v[144:147]
CV 186,186,187
v_add_u32 v4, 0x9000, v4
v_mfma_f32_16x16x32_bf16 v[60:63], a[128:131], a[68:71], v[148:151]
Ta 152,4,16384
v_accvgpr_write_b32 a4, v184
v_mfma_f32_16x16x32_bf16 v[68:71], a[128:131], a[96:99], v[152:155]
Ta 154,4,18432
v_accvgpr_write_b32 a5, v186
v_mfma_f32_16x16x32_bf16 v[76:79], a[128:131], a[100:103], v[156:159]
Ta 168,4,20480
v_accvgpr_read_b32 v240, a176
Mvaa 52,132,72
Ta 170,4,22528
v_accvgpr_read_b32 v241, a177
Mvaa 60,132,76
v_accvgpr_read_b32 v242, a178
v_accvgpr_read_b32 v243, a179
Mvaa 68,132,104
v_mul_f32 v180, v160, v180
v_mul_f32 v181, v160, v181
Mvaa 76,132,108
v_mul_f32 v182, v160, v182
v_mul_f32 v183, v160, v183
Mvaa 52,136,80
v_accvgpr_read_b32 v248, a184
v_accvgpr_read_b32 v249, a185
Mvaa 60,136,84
ds_read_b128 a[128:131], v20 offset:8192
v_accvgpr_read_b32 v250, a186
Mvaa 68,136,112
v_accvgpr_read_b32 v251, a187
CV 180,180,181
Mvaa 76,136,116
CV 182,182,183
v_accvgpr_write_b32 a2, v180
Mvaa 52,140,88
LD 14,44,76,2048
v_accvgpr_write_b32 a3, v182
Mvaa 60,140,92
s_lshl_b32 s85, s30, 7
v_mul_f32 v188, v161, v188
v_mul_f32 v189, v161, v189
Mvaa 68,140,120
s_add_u32 s85, s85, 0x4000
v_mul_f32 v190, v161, v190
v_mov_b32 v46, s85
Mvaa 76,140,124
s_getpc_b64 s[96:97]
ds_read_b128 a[132:135], v21 offset:8192
v_mul_f32 v191, v161, v191
v_mfma_f32_16x16x32_bf16 a[240:243], v[40:43], v[112:115], 0
global_load_dword v35, v46, s[96:97]
CV 188,188,189
v_mfma_f32_16x16x32_bf16 a[244:247], v[40:43], v[116:119], 0
CV 190,190,191
v_add_u32 v5, 0x9000, v5
v_mfma_f32_16x16x32_bf16 a[248:251], v[40:43], v[120:123], 0
Ta 156,5,16384
v_accvgpr_write_b32 a6, v188
v_mfma_f32_16x16x32_bf16 a[252:255], v[40:43], v[124:127], 0
s_waitcnt lgkmcnt(2)
Ta 158,5,18432
v_accvgpr_write_b32 a7, v190
v_mfma_f32_16x16x32_bf16 v[176:179], a[144:147], v[112:115], 0
Ta 172,5,20480
v_accvgpr_read_b32 v244, a180
v_mfma_f32_16x16x32_bf16 v[184:187], a[144:147], v[116:119], 0
Ta 174,5,22528
v_accvgpr_read_b32 v245, a181
v_mfma_f32_16x16x32_bf16 a[176:179], a[144:147], v[120:123], 0
v_accvgpr_read_b32 v246, a182
v_accvgpr_read_b32 v247, a183
v_mfma_f32_16x16x32_bf16 a[184:187], a[144:147], v[124:127], 0
v_accvgpr_read_b32 v252, a188
v_accvgpr_read_b32 v253, a189
v_mfma_f32_16x16x32_bf16 v[180:183], a[148:151], v[112:115], 0
v_accvgpr_read_b32 v254, a190
v_accvgpr_read_b32 v255, a191
v_mfma_f32_16x16x32_bf16 v[188:191], a[148:151], v[116:119], 0
ds_read_b128 a[136:139], v22 offset:8192
v_mul_f32 v192, v160, v192
v_mfma_f32_16x16x32_bf16 a[180:183], a[148:151], v[120:123], 0
LD 15,44,76,3072
v_mul_f32 v193, v160, v193
L_pg12_10:
s_cbranch_execz L_ret12
v_mfma_f32_16x16x32_bf16 a[188:191], a[148:151], v[124:127], 0
s_add_u32 m0, s69, 0x4000
s_add_u32 s76, s73, 0xec000
v_mul_f32 v194, v160, v194
v_mul_f32 v195, v160, v195
CV 192,192,193
CV 194,194,195
v_max_f32 v174, v174, v162
v_rcp_f32 v162, v162
v_accvgpr_write_b32 a8, v192
v_accvgpr_write_b32 a9, v194
v_mfma_f32_16x16x32_bf16 v[192:195], a[152:155], v[112:115], 0
v_mul_f32 v200, v161, v200
v_mul_f32 v201, v161, v201
v_mul_f32 v202, v161, v202
v_mul_f32 v203, v161, v203
CV 200,200,201
CV 202,202,203
v_max_f32 v174, v174, v163
v_mul_f32 v240, v162, v240
v_mul_f32 v241, v162, v241
v_mul_f32 v242, v162, v242
v_mul_f32 v243, v162, v243
v_rcp_f32 v163, v163
v_accvgpr_write_b32 a12, v200
v_accvgpr_write_b32 a13, v202
v_mfma_f32_16x16x32_bf16 v[200:203], a[152:155], v[116:119], 0
CV 240,240,241
CV 242,242,243
v_accvgpr_write_b32 a32, v240
v_accvgpr_write_b32 a33, v242
v_mul_f32 v248, v163, v248
v_mul_f32 v249, v163, v249
v_mul_f32 v250, v163, v250
v_mul_f32 v251, v163, v251
v_accvgpr_read_b32 v240, a192
v_accvgpr_read_b32 v241, a193
v_accvgpr_read_b32 v242, a194
v_accvgpr_read_b32 v243, a195
v_mfma_f32_16x16x32_bf16 a[192:195], a[152:155], v[120:123], 0
CV 248,248,249
CV 250,250,251
v_accvgpr_write_b32 a36, v248
v_accvgpr_write_b32 a37, v250
v_mul_f32 v196, v160, v196
v_mul_f32 v197, v160, v197
v_mul_f32 v198, v160, v198
v_mul_f32 v199, v160, v199
v_accvgpr_read_b32 v248, a200
v_accvgpr_read_b32 v249, a201
v_accvgpr_read_b32 v250, a202
v_accvgpr_read_b32 v251, a203
v_mfma_f32_16x16x32_bf16 a[200:203], a[152:155], v[124:127], 0
s_waitcnt lgkmcnt(0)
CV 196,196,197
CV 198,198,199
v_accvgpr_write_b32 a10, v196
v_accvgpr_write_b32 a11, v198
v_mfma_f32_16x16x32_bf16 v[196:199], a[156:159], v[112:115], 0
v_mul_f32 v204, v161, v204
v_mul_f32 v205, v161, v205
v_mul_f32 v206, v161, v206
v_mul_f32 v207, v161, v207
CV 204,204,205
CV 206,206,207
v_mul_f32 v244, v162, v244
v_mul_f32 v245, v162, v245
v_mul_f32 v246, v162, v246
v_mul_f32 v247, v162, v247
v_accvgpr_write_b32 a14, v204
v_accvgpr_write_b32 a15, v206
v_mfma_f32_16x16x32_bf16 v[204:207], a[156:159], v[116:119], 0
CV 244,244,245
CV 246,246,247
v_accvgpr_write_b32 a34, v244
v_accvgpr_write_b32 a35, v246
v_mul_f32 v252, v163, v252
v_mul_f32 v253, v163, v253
v_mul_f32 v254, v163, v254
v_mul_f32 v255, v163, v255
v_accvgpr_read_b32 v244, a196
v_accvgpr_read_b32 v245, a197
v_accvgpr_read_b32 v246, a198
v_accvgpr_read_b32 v247, a199
v_mfma_f32_16x16x32_bf16 a[196:199], a[156:159], v[120:123], 0
s_mov_b64 exec, 0
s_cmp_eq_u32 s64, 0
s_cbranch_scc1 L_pg13_11
s_cmp_eq_u32 s64, 1
s_cbranch_scc1 L_pg13_12
s_cmp_eq_u32 s64, 2
s_cbranch_scc1 L_pg13_13
s_branch L_pg13_14
L_ret13:
s_mov_b64 exec, -1
CV 252,252,253
CV 254,254,255
v_accvgpr_write_b32 a38, v252
v_accvgpr_write_b32 a39, v254
v_accvgpr_read_b32 v252, a204
v_accvgpr_read_b32 v253, a205
v_accvgpr_read_b32 v254, a206
v_accvgpr_read_b32 v255, a207
v_mfma_f32_16x16x32_bf16 a[204:207], a[156:159], v[124:127], 0
v_mul_f32 v208, v160, v208
v_mul_f32 v209, v160, v209
v_mul_f32 v210, v160, v210
v_mul_f32 v211, v160, v211
CV 208,208,209
CV 210,210,211
v_accvgpr_write_b32 a16, v208
v_accvgpr_write_b32 a17, v210
v_mfma_f32_16x16x32_bf16 v[208:211], a[160:163], v[112:115], 0
v_mul_f32 v216, v161, v216
v_mul_f32 v217, v161, v217
v_mul_f32 v218, v161, v218
v_mul_f32 v219, v161, v219
CV 216,216,217
CV 218,218,219
v_mul_f32 v240, v162, v240
v_mul_f32 v241, v162, v241
v_mul_f32 v242, v162, v242
v_mul_f32 v243, v162, v243
v_accvgpr_write_b32 a20, v216
v_accvgpr_write_b32 a21, v218
v_mfma_f32_16x16x32_bf16 v[216:219], a[160:163], v[116:119], 0
CV 240,240,241
CV 242,242,243
v_accvgpr_write_b32 a40, v240
v_accvgpr_write_b32 a41, v242
v_mul_f32 v248, v163, v248
v_mul_f32 v249, v163, v249
v_mul_f32 v250, v163, v250
v_mul_f32 v251, v163, v251
v_accvgpr_read_b32 v240, a208
v_accvgpr_read_b32 v241, a209
v_accvgpr_read_b32 v242, a210
v_accvgpr_read_b32 v243, a211
v_mfma_f32_16x16x32_bf16 a[208:211], a[160:163], v[120:123], 0
CV 248,248,249
CV 250,250,251
v_accvgpr_write_b32 a44, v248
v_accvgpr_write_b32 a45, v250
v_mul_f32 v212, v160, v212
v_mul_f32 v213, v160, v213
v_mul_f32 v214, v160, v214
v_mul_f32 v215, v160, v215
v_accvgpr_read_b32 v248, a216
v_accvgpr_read_b32 v249, a217
v_accvgpr_read_b32 v250, a218
v_accvgpr_read_b32 v251, a219
v_mfma_f32_16x16x32_bf16 a[216:219], a[160:163], v[124:127], 0
CV 212,212,213
CV 214,214,215
v_accvgpr_write_b32 a18, v212
v_accvgpr_write_b32 a19, v214
v_mfma_f32_16x16x32_bf16 v[212:215], a[164:167], v[112:115], 0
LD 16,48,76,0
v_mul_f32 v220, v161, v220
v_mul_f32 v221, v161, v221
v_mul_f32 v222, v161, v222
v_mul_f32 v223, v161, v223
CV 220,220,221
CV 222,222,223
v_mul_f32 v244, v162, v244
v_mul_f32 v245, v162, v245
v_mul_f32 v246, v162, v246
v_mul_f32 v247, v162, v247
v_accvgpr_write_b32 a22, v220
v_accvgpr_write_b32 a23, v222
v_mfma_f32_16x16x32_bf16 v[220:223], a[164:167], v[116:119], 0
CV 244,244,245
CV 246,246,247
v_accvgpr_write_b32 a42, v244
v_accvgpr_write_b32 a43, v246
v_mul_f32 v252, v163, v252
v_mul_f32 v253, v163, v253
v_mul_f32 v254, v163, v254
v_mul_f32 v255, v163, v255
v_accvgpr_read_b32 v244, a212
v_accvgpr_read_b32 v245, a213
v_accvgpr_read_b32 v246, a214
v_accvgpr_read_b32 v247, a215
v_mfma_f32_16x16x32_bf16 a[212:215], a[164:167], v[120:123], 0
CV 252,252,253
CV 254,254,255
v_accvgpr_write_b32 a46, v252
v_accvgpr_write_b32 a47, v254
v_accvgpr_read_b32 v252, a220
v_accvgpr_read_b32 v253, a221
v_accvgpr_read_b32 v254, a222
v_accvgpr_read_b32 v255, a223
v_mfma_f32_16x16x32_bf16 a[220:223], a[164:167], v[124:127], 0
v_mul_f32 v224, v160, v224
v_mul_f32 v225, v160, v225
v_mul_f32 v226, v160, v226
v_mul_f32 v227, v160, v227
CV 224,224,225
CV 226,226,227
v_accvgpr_write_b32 a24, v224
v_accvgpr_write_b32 a25, v226
v_mfma_f32_16x16x32_bf16 v[224:227], a[168:171], v[112:115], 0
v_mul_f32 v232, v161, v232
v_mul_f32 v233, v161, v233
v_mul_f32 v234, v161, v234
v_mul_f32 v235, v161, v235
CV 232,232,233
CV 234,234,235
v_mul_f32 v240, v162, v240
v_mul_f32 v241, v162, v241
v_mul_f32 v242, v162, v242
v_mul_f32 v243, v162, v243
v_accvgpr_write_b32 a28, v232
v_accvgpr_write_b32 a29, v234
v_mfma_f32_16x16x32_bf16 v[232:235], a[168:171], v[116:119], 0
CV 240,240,241
CV 242,242,243
v_accvgpr_write_b32 a48, v240
v_accvgpr_write_b32 a49, v242
v_mul_f32 v248, v163, v248
v_mul_f32 v249, v163, v249
v_mul_f32 v250, v163, v250
v_mul_f32 v251, v163, v251
v_accvgpr_read_b32 v240, a224
v_accvgpr_read_b32 v241, a225
v_accvgpr_read_b32 v242, a226
v_accvgpr_read_b32 v243, a227
v_mfma_f32_16x16x32_bf16 a[224:227], a[168:171], v[120:123], 0
CV 248,248,249
CV 250,250,251
v_accvgpr_write_b32 a52, v248
v_accvgpr_write_b32 a53, v250
v_mul_f32 v228, v160, v228
v_mul_f32 v229, v160, v229
v_mul_f32 v230, v160, v230
v_mul_f32 v231, v160, v231
v_accvgpr_read_b32 v248, a232
v_accvgpr_read_b32 v249, a233
v_accvgpr_read_b32 v250, a234
v_accvgpr_read_b32 v251, a235
v_mfma_f32_16x16x32_bf16 a[232:235], a[168:171], v[124:127], 0
CV 228,228,229
CV 230,230,231
v_accvgpr_write_b32 a26, v228
v_accvgpr_write_b32 a27, v230
v_mfma_f32_16x16x32_bf16 v[228:231], a[172:175], v[112:115], 0
v_mul_f32 v236, v161, v236
v_mul_f32 v237, v161, v237
v_mul_f32 v238, v161, v238
v_mul_f32 v239, v161, v239
CV 236,236,237
CV 238,238,239
v_mul_f32 v244, v162, v244
v_mul_f32 v245, v162, v245
v_mul_f32 v246, v162, v246
v_mul_f32 v247, v162, v247
v_accvgpr_write_b32 a30, v236
v_accvgpr_write_b32 a31, v238
v_mfma_f32_16x16x32_bf16 v[236:239], a[172:175], v[116:119], 0
CV 244,244,245
CV 246,246,247
v_accvgpr_write_b32 a50, v244
v_accvgpr_write_b32 a51, v246
v_mul_f32 v252, v163, v252
v_mul_f32 v253, v163, v253
v_mul_f32 v254, v163, v254
v_mul_f32 v255, v163, v255
v_accvgpr_read_b32 v244, a228
v_accvgpr_read_b32 v245, a229
v_accvgpr_read_b32 v246, a230
v_accvgpr_read_b32 v247, a231
v_mfma_f32_16x16x32_bf16 a[228:231], a[172:175], v[120:123], 0
CV 252,252,253
CV 254,254,255
v_accvgpr_write_b32 a54, v252
v_accvgpr_write_b32 a55, v254
v_accvgpr_read_b32 v252, a236
v_accvgpr_read_b32 v253, a237
v_accvgpr_read_b32 v254, a238
v_accvgpr_read_b32 v255, a239
v_mfma_f32_16x16x32_bf16 a[236:239], a[172:175], v[124:127], 0
v_exp_f32 v80, v80
v_exp_f32 v81, v81
v_exp_f32 v82, v82
v_exp_f32 v83, v83
CV 128,80,81
v_exp_f32 v88, v88
CV 129,82,83
v_mfma_f32_16x16x32_bf16 v[80:83], a[128:131], a[64:67], v[144:147]
v_exp_f32 v89, v89
v_exp_f32 v90, v90
v_exp_f32 v91, v91
CV 132,88,89
v_exp_f32 v96, v96
CV 133,90,91
v_mfma_f32_16x16x32_bf16 v[88:91], a[128:131], a[68:71], v[148:151]
v_exp_f32 v97, v97
v_exp_f32 v98, v98
v_exp_f32 v99, v99
CV 136,96,97
v_exp_f32 v104, v104
CV 137,98,99
v_mfma_f32_16x16x32_bf16 v[96:99], a[128:131], a[96:99], v[152:155]
LD 17,48,76,1024
v_exp_f32 v105, v105
v_exp_f32 v106, v106
v_exp_f32 v107, v107
CV 140,104,105
ds_read_b128 a[140:143], v23 offset:8192
CV 141,106,107
v_mfma_f32_16x16x32_bf16 v[104:107], a[128:131], a[100:103], v[156:159]
ds_read_b128 a[144:147], v20 offset:12288
v_add_u32 v20, 0x9000, v20
Mvaa 80,132,72
ds_read_b128 a[148:151], v21 offset:12288
v_add_u32 v21, 0x9000, v21
Mvaa 88,132,76
ds_read_b128 a[152:155], v22 offset:12288
v_add_u32 v22, 0x9000, v22
Mvaa 96,132,104
ds_read_b128 a[156:159], v23 offset:12288
v_add_u32 v23, 0x9000, v23
Mvaa 104,132,108
Ta 160,2,24576
Mvaa 80,136,80
Ta 162,2,26624
Mvaa 88,136,84
Ta 164,3,24576
v_mul_f32 v240, v162, v240
Mvaa 96,136,112
Ta 166,3,26624
v_mul_f32 v241, v162, v241
Mvaa 104,136,116
s_waitcnt lgkmcnt(8)
Ta 168,4,24576
v_mul_f32 v242, v162, v242
Mvaa 80,140,88
s_mul_i32 s77, s100, 0x400
Ta 170,4,26624
v_min_u32 v46, 7, v1
Mvaa 88,140,92
s_mul_i32 s85, s66, 0x90000
Ta 172,5,24576
v_mul_u32_u24 v46, 0x80, v46
Mvaa 96,140,120
s_add_u32 s77, s77, s85
Ta 174,5,26624
v_exp_f32 v84, v84
Mvaa 104,140,124
s_waitcnt lgkmcnt(6)
v_exp_f32 v85, v85
v_exp_f32 v86, v86
v_exp_f32 v87, v87
CV 130,84,85
v_exp_f32 v92, v92
CV 131,86,87
v_mfma_f32_16x16x32_bf16 v[84:87], a[144:147], a[64:67], v[144:147]
LD 18,48,76,2048
v_exp_f32 v93, v93
v_exp_f32 v94, v94
v_exp_f32 v95, v95
CV 134,92,93
v_exp_f32 v100, v100
CV 135,94,95
v_mfma_f32_16x16x32_bf16 v[92:95], a[144:147], a[68:71], v[148:151]
v_exp_f32 v101, v101
v_exp_f32 v102, v102
v_exp_f32 v103, v103
CV 138,100,101
v_exp_f32 v108, v108
CV 139,102,103
v_mfma_f32_16x16x32_bf16 v[100:103], a[144:147], a[96:99], v[152:155]
v_exp_f32 v109, v109
v_exp_f32 v110, v110
v_exp_f32 v111, v111
CV 142,108,109
s_add_u32 s77, s77, 0x40000
CV 143,110,111
v_mfma_f32_16x16x32_bf16 v[108:111], a[144:147], a[100:103], v[156:159]
buffer_load_dword v35, v46, s[52:55], s77 offen
Ta 128,2,28672
Mvaa 84,148,72
Ta 130,2,30720
v_add_u32 v2, 0x9000, v2
Mvaa 92,148,76
Ta 132,3,28672
v_mul_f32 v243, v162, v243
Mvaa 100,148,104
Ta 134,3,30720
v_add_u32 v3, 0x9000, v3
Mvaa 108,148,108
Ta 136,4,28672
v_mul_f32 v244, v162, v244
Mvaa 84,152,80
Ta 138,4,30720
v_add_u32 v4, 0x9000, v4
Mvaa 92,152,84
Ta 140,5,28672
v_mul_f32 v245, v162, v245
Mvaa 100,152,112
Ta 142,5,30720
v_add_u32 v5, 0x9000, v5
Mvaa 108,152,116
v_exp_f32 v48, v48
Mvaa 84,156,88
v_exp_f32 v49, v49
Mvaa 92,156,92
v_exp_f32 v50, v50
Mvaa 100,156,120
LD 19,48,76,3072
CV 112,48,49
Mvaa 108,156,124
s_add_u32 m0, s69, 0x9000
v_exp_f32 v51, v51
Mavv 240,40,128
s_add_u32 s76, s71, 0xf4000
v_exp_f32 v56, v56
Mavv 244,40,132
s_waitcnt vmcnt(22) lgkmcnt(0)
s_barrier
v_exp_f32 v57, v57
Mavv 248,40,136
ds_read_b128 a[144:147], v20
CV 113,50,51
Mavv 252,40,140
ds_read_b128 a[148:151], v21
CV 116,56,57
Mvav 176,160,128
ds_read_b128 a[152:155], v22
Mvav 184,160,132
ds_read_b128 a[156:159], v23
Maav 176,160,136
v_exp_f32 v58, v58
Maav 184,160,140
ds_read_b128 a[160:163], v20 offset:4096
Mvav 180,164,128
v_exp_f32 v59, v59
Mvav 188,164,132
v_exp_f32 v64, v64
Maav 180,164,136
v_exp_f32 v65, v65
Maav 188,164,140
ds_read_b128 a[164:167], v21 offset:4096
CV 117,58,59
Mvav 192,168,128
v_exp_f32 v66, v66
Mvav 200,168,132
v_exp_f32 v67, v67
Maav 192,168,136
v_exp_f32 v72, v72
Maav 200,168,140
ds_read_b128 a[168:171], v22 offset:4096
CV 120,64,65
Mvav 196,172,128
v_exp_f32 v73, v73
Mvav 204,172,132
v_exp_f32 v74, v74
Maav 196,172,136
v_exp_f32 v75, v75
Maav 204,172,140
ds_read_b128 a[172:175], v23 offset:4096
CV 121,66,67
Mvav 208,128,128
v_exp_f32 v52, v52
Mvav 216,128,132
v_exp_f32 v53, v53
Maav 208,128,136
v_exp_f32 v54, v54
Maav 216,128,140
Ta 128,2,16384
CV 124,72,73
Mvav 212,132,128
Ta 130,2,18432
CV 125,74,75
Mvav 220,132,132
v_exp_f32 v55, v55
Maav 212,132,136
v_exp_f32 v60, v60
Maav 220,132,140
Ta 132,3,16384
CV 114,52,53
Mvav 224,136,128
Ta 134,3,18432
CV 115,54,55
Mvav 232,136,132
v_exp_f32 v61, v61
Maav 224,136,136
v_exp_f32 v62, v62
Maav 232,136,140
Ta 136,4,16384
CV 118,60,61
Mvav 228,140,128
Ta 138,4,18432
v_mul_f32 v246, v162, v246
Mvav 236,140,132
v_exp_f32 v63, v63
Maav 228,140,136
v_exp_f32 v68, v68
Maav 236,140,140
s_waitcnt lgkmcnt(4)
Ta 140,5,16384
CV 119,62,63
v_mfma_f32_16x16x32_bf16 v[48:51], a[144:147], a[64:67], v[144:147]
Ta 142,5,18432
v_mul_f32 v247, v162, v247
v_mfma_f32_16x16x32_bf16 v[56:59], a[144:147], a[68:71], v[148:151]
v_exp_f32 v69, v69
v_mfma_f32_16x16x32_bf16 v[64:67], a[144:147], a[96:99], v[152:155]
LD 12,44,76,0
CV 122,68,69
v_mfma_f32_16x16x32_bf16 v[72:75], a[144:147], a[100:103], v[156:159]
Ta 144,2,20480
CV 240,240,241
Mvaa 48,148,72
Ta 146,2,22528
CV 242,242,243
Mvaa 56,148,76
v_exp_f32 v70, v70
Mvaa 64,148,104
v_exp_f32 v71, v71
Mvaa 72,148,108
Ta 148,3,20480
CV 123,70,71
Mvaa 48,152,80
Ta 150,3,22528
CV 244,244,245
Mvaa 56,152,84
v_exp_f32 v76, v76
Mvaa 64,152,112
v_exp_f32 v77, v77
Mvaa 72,152,116
Ta 152,4,20480
CV 126,76,77
Mvaa 48,156,88
Ta 154,4,22528
CV 246,246,247
Mvaa 56,156,92
v_exp_f32 v78, v78
Mvaa 64,156,120
LD 13,44,76,1024
v_accvgpr_write_b32 a56, v240
Mvaa 72,156,124
Ta 156,5,20480
v_accvgpr_write_b32 a57, v242
v_mfma_f32_16x16x32_bf16 v[52:55], a[160:163], a[64:67], v[144:147]
Ta 158,5,22528
v_accvgpr_write_b32 a58, v244
v_mfma_f32_16x16x32_bf16 v[60:63], a[160:163], a[68:71], v[148:151]
v_exp_f32 v79, v79
v_mfma_f32_16x16x32_bf16 v[68:71], a[160:163], a[96:99], v[152:155]
CV 127,78,79
v_accvgpr_write_b32 a59, v246
v_mfma_f32_16x16x32_bf16 v[76:79], a[160:163], a[100:103], v[156:159]
ds_read_b128 a[160:163], v20 offset:8192
v_mul_f32 v248, v163, v248
Mvaa 52,164,72
v_exp_f32 v80, v80
Mvaa 60,164,76
v_exp_f32 v81, v81
Mvaa 68,164,104
v_exp_f32 v82, v82
Mvaa 76,164,108
ds_read_b128 a[164:167], v21 offset:8192
CV 128,80,81
Mvaa 52,168,80
v_exp_f32 v83, v83
Mvaa 60,168,84
v_exp_f32 v88, v88
Mvaa 68,168,112
v_exp_f32 v89, v89
Mvaa 76,168,116
ds_read_b128 a[168:171], v22 offset:8192
CV 129,82,83
Mvaa 52,172,88
LD 14,44,76,2048
CV 132,88,89
Mvaa 60,172,92
v_exp_f32 v90, v90
Mvaa 68,172,120
v_exp_f32 v91, v91
Mvaa 76,172,124
ds_read_b128 a[172:175], v23 offset:8192
CV 133,90,91
Mavv 240,40,112
v_exp_f32 v96, v96
Mavv 244,40,116
v_exp_f32 v97, v97
Mavv 248,40,120
v_exp_f32 v98, v98
Mavv 252,40,124
v_exp_f32 v99, v99
Mvav 176,128,112
v_exp_f32 v104, v104
Mvav 184,128,116
v_exp_f32 v105, v105
Maav 176,128,120
v_exp_f32 v106, v106
Maav 184,128,124
s_waitcnt lgkmcnt(1)
ds_read_b128 a[128:131], v20 offset:12288
CV 136,96,97
Mvav 180,132,112
v_exp_f32 v107, v107
Mvav 188,132,116
v_exp_f32 v84, v84
Maav 180,132,120
LD 15,44,76,3072
CV 137,98,99
Maav 188,132,124
s_add_u32 m0, s69, 0xd000
s_add_u32 s76, s73, 0xf0000
ds_read_b128 a[132:135], v21 offset:12288
Mvav 192,136,112
v_exp_f32 v85, v85
Mvav 200,136,116
v_exp_f32 v86, v86
Maav 192,136,120
L_pg13_11:
s_cbranch_execz L_ret13
v_exp_f32 v87, v87
Maav 200,136,124
ds_read_b128 a[136:139], v22 offset:12288
CV 140,104,105
Mvav 196,140,112
v_exp_f32 v92, v92
Mvav 204,140,116
v_exp_f32 v93, v93
Maav 196,140,120
v_exp_f32 v94, v94
Maav 204,140,124
ds_read_b128 a[140:143], v23 offset:12288
CV 141,106,107
Mvav 208,144,112
v_exp_f32 v95, v95
Mvav 216,144,116
v_exp_f32 v100, v100
Maav 208,144,120
v_exp_f32 v101, v101
Maav 216,144,124
Ta 144,2,24576
CV 130,84,85
Mvav 212,148,112
LD 16,48,76,0
Ta 146,2,26624
Mvav 220,148,116
v_exp_f32 v102, v102
Maav 212,148,120
v_exp_f32 v103, v103
Maav 220,148,124
Ta 148,3,24576
CV 131,86,87
Mvav 224,152,112
Ta 150,3,26624
CV 134,92,93
Mvav 232,152,116
v_exp_f32 v108, v108
Maav 224,152,120
v_exp_f32 v109, v109
Maav 232,152,124
Ta 152,4,24576
CV 135,94,95
Mvav 228,156,112
Ta 154,4,26624
CV 138,100,101
Mvav 236,156,116
v_exp_f32 v110, v110
Maav 228,156,120
v_exp_f32 v111, v111
Maav 236,156,124
Ta 156,5,24576
CV 139,102,103
v_mfma_f32_16x16x32_bf16 v[80:83], a[160:163], a[64:67], v[144:147]
Ta 158,5,26624
CV 142,108,109
v_mfma_f32_16x16x32_bf16 v[88:91], a[160:163], a[68:71], v[148:151]
CV 143,110,111
v_add_u32 v20, 0x9000, v20
v_mfma_f32_16x16x32_bf16 v[96:99], a[160:163], a[96:99], v[152:155]
LD 17,48,76,1024
v_add_u32 v21, 0x9000, v21
v_mfma_f32_16x16x32_bf16 v[104:107], a[160:163], a[100:103], v[156:159]
Ta 160,2,28672
v_add_u32 v22, 0x9000, v22
Mvaa 80,164,72
Ta 162,2,30720
v_add_u32 v23, 0x9000, v23
Mvaa 88,164,76
v_exp_f32 v48, v48
Mvaa 96,164,104
v_exp_f32 v49, v49
Mvaa 104,164,108
Ta 164,3,28672
CV 112,48,49
Mvaa 80,168,80
Ta 166,3,30720
v_add_u32 v2, 0x9000, v2
Mvaa 88,168,84
v_exp_f32 v50, v50
Mvaa 96,168,112
v_exp_f32 v51, v51
Mvaa 104,168,116
s_waitcnt lgkmcnt(4)
Ta 168,4,28672
CV 113,50,51
Mvaa 80,172,88
s_mul_i32 s77, s100, 0x400
Ta 170,4,30720
v_min_u32 v46, 7, v1
Mvaa 88,172,92
s_mul_i32 s85, s66, 0x90000
v_mul_u32_u24 v46, 0x80, v46
v_add_u32 v3, 0x9000, v3
Mvaa 96,172,120
s_add_u32 s77, s77, s85
v_exp_f32 v56, v56
Mvaa 104,172,124
s_add_u32 s77, s77, 0x50000
Ta 172,5,28672
v_add_u32 v4, 0x9000, v4
v_mfma_f32_16x16x32_bf16 v[84:87], a[128:131], a[64:67], v[144:147]
LD 18,48,76,2048
Ta 174,5,30720
v_mfma_f32_16x16x32_bf16 v[92:95], a[128:131], a[68:71], v[148:151]
v_exp_f32 v57, v57
v_mfma_f32_16x16x32_bf16 v[100:103], a[128:131], a[96:99], v[152:155]
v_exp_f32 v58, v58
v_mfma_f32_16x16x32_bf16 v[108:111], a[128:131], a[100:103], v[156:159]
v_exp_f32 v59, v59
Mvaa 84,132,72
buffer_load_dword v35, v46, s[52:55], s77 offen
CV 116,56,57
Mvaa 92,132,76
v_exp_f32 v64, v64
Mvaa 100,132,104
v_exp_f32 v65, v65
Mvaa 108,132,108
s_waitcnt vmcnt(20) lgkmcnt(0)
s_barrier
v_exp_f32 v66, v66
Mvaa 84,136,80
ds_read_b128 a[128:131], v20
CV 117,58,59
Mvaa 92,136,84
ds_read_b128 a[132:135], v21
CV 120,64,65
Mvaa 100,136,112
v_exp_f32 v67, v67
Mvaa 108,136,116
ds_read_b128 a[136:139], v22
CV 121,66,67
Mvaa 84,140,88
v_exp_f32 v72, v72
Mvaa 92,140,92
v_exp_f32 v73, v73
Mvaa 100,140,120
LD 19,48,76,3072
CV 124,72,73
Mvaa 108,140,124
s_add_u32 m0, s69, 0x12000
ds_read_b128 a[140:143], v23
v_add_u32 v5, 0x9000, v5
Mavv 240,40,128
s_add_u32 s76, s71, 0xf8000
v_exp_f32 v74, v74
Mavv 244,40,132
v_exp_f32 v75, v75
Mavv 248,40,136
v_exp_f32 v52, v52
Mavv 252,40,140
v_exp_f32 v53, v53
Mvav 176,144,128
v_exp_f32 v54, v54
Mvav 184,144,132
v_exp_f32 v55, v55
Maav 176,144,136
v_exp_f32 v60, v60
Maav 184,144,140
ds_read_b128 a[144:147], v20 offset:4096
CV 125,74,75
Mvav 180,148,128
v_exp_f32 v61, v61
Mvav 188,148,132
v_exp_f32 v62, v62
Maav 180,148,136
v_exp_f32 v63, v63
Maav 188,148,140
ds_read_b128 a[148:151], v21 offset:4096
CV 114,52,53
Mvav 192,152,128
v_exp_f32 v68, v68
Mvav 200,152,132
v_exp_f32 v69, v69
Maav 192,152,136
v_exp_f32 v70, v70
Maav 200,152,140
ds_read_b128 a[152:155], v22 offset:4096
CV 115,54,55
Mvav 196,156,128
v_exp_f32 v71, v71
Mvav 204,156,132
v_exp_f32 v76, v76
Maav 196,156,136
v_exp_f32 v77, v77
Maav 204,156,140
ds_read_b128 a[156:159], v23 offset:4096
CV 118,60,61
Mvav 208,160,128
v_exp_f32 v78, v78
Mvav 216,160,132
v_exp_f32 v79, v79
Maav 208,160,136
CV 119,62,63
CV 122,68,69
Maav 216,160,140
Ta 160,2,16384
CV 123,70,71
Mvav 212,164,128
Ta 162,2,18432
CV 126,76,77
Mvav 220,164,132
CV 127,78,79
v_mul_f32 v249, v163, v249
Maav 212,164,136
v_exp_f32 v80, v80
Maav 220,164,140
Ta 164,3,16384
v_mul_f32 v250, v163, v250
Mvav 224,168,128
Ta 166,3,18432
v_mul_f32 v251, v163, v251
Mvav 232,168,132
v_exp_f32 v81, v81
Maav 224,168,136
v_exp_f32 v82, v82
Maav 232,168,140
Ta 168,4,16384
v_mul_f32 v252, v163, v252
Mvav 228,172,128
Ta 170,4,18432
CV 128,80,81
Mvav 236,172,132
v_exp_f32 v83, v83
Maav 228,172,136
v_exp_f32 v88, v88
Maav 236,172,140
s_waitcnt lgkmcnt(4)
Ta 172,5,16384
CV 129,82,83
v_mfma_f32_16x16x32_bf16 v[48:51], a[128:131], a[64:67], v[144:147]
Ta 174,5,18432
v_mul_f32 v253, v163, v253
v_mfma_f32_16x16x32_bf16 v[56:59], a[128:131], a[68:71], v[148:151]
v_exp_f32 v89, v89
v_mfma_f32_16x16x32_bf16 v[64:67], a[128:131], a[96:99], v[152:155]
LD 12,44,76,0
CV 132,88,89
v_mfma_f32_16x16x32_bf16 v[72:75], a[128:131], a[100:103], v[156:159]
Ta 128,2,20480
v_mul_f32 v254, v163, v254
Mvaa 48,132,72
Ta 130,2,22528
v_mul_f32 v255, v163, v255
Mvaa 56,132,76
v_exp_f32 v90, v90
Mvaa 64,132,104
v_exp_f32 v91, v91
Mvaa 72,132,108
Ta 132,3,20480
CV 133,90,91
Mvaa 48,136,80
Ta 134,3,22528
CV 248,248,249
Mvaa 56,136,84
v_exp_f32 v96, v96
Mvaa 64,136,112
v_exp_f32 v97, v97
Mvaa 72,136,116
Ta 136,4,20480
CV 136,96,97
Mvaa 48,140,88
Ta 138,4,22528
CV 250,250,251
Mvaa 56,140,92
v_exp_f32 v98, v98
Mvaa 64,140,120
LD 13,44,76,1024
CV 252,252,253
Mvaa 72,140,124
Ta 140,5,20480
CV 254,254,255
v_mfma_f32_16x16x32_bf16 v[52:55], a[144:147], a[64:67], v[144:147]
Ta 142,5,22528
v_accvgpr_write_b32 a60, v248
v_mfma_f32_16x16x32_bf16 v[60:63], a[144:147], a[68:71], v[148:151]
v_exp_f32 v99, v99
v_mfma_f32_16x16x32_bf16 v[68:71], a[144:147], a[96:99], v[152:155]
v_exp_f32 v104, v104
v_mfma_f32_16x16x32_bf16 v[76:79], a[144:147], a[100:103], v[156:159]
ds_read_b128 a[144:147], v20 offset:8192
CV 137,98,99
Mvaa 52,148,72
v_exp_f32 v105, v105
Mvaa 60,148,76
v_exp_f32 v106, v106
Mvaa 68,148,104
v_exp_f32 v107, v107
Mvaa 76,148,108
ds_read_b128 a[148:151], v21 offset:8192
CV 140,104,105
Mvaa 52,152,80
v_exp_f32 v84, v84
Mvaa 60,152,84
v_exp_f32 v85, v85
Mvaa 68,152,112
v_exp_f32 v86, v86
Mvaa 76,152,116
ds_read_b128 a[152:155], v22 offset:8192
CV 141,106,107
Mvaa 52,156,88
LD 14,44,76,2048
CV 130,84,85
Mvaa 60,156,92
s_lshl_b32 s85, s30, 7
v_exp_f32 v87, v87
Mvaa 68,156,120
s_add_u32 s85, s85, 0x4000
v_exp_f32 v92, v92
Mvaa 76,156,124
s_getpc_b64 s[96:97]
ds_read_b128 a[156:159], v23 offset:8192
v_mov_b32 v46, s85
Mavv 240,40,112
global_load_dword v35, v46, s[96:97]
CV 131,86,87
Mavv 244,40,116
v_exp_f32 v93, v93
Mavv 248,40,120
v_exp_f32 v94, v94
Mavv 252,40,124
v_exp_f32 v95, v95
Mvav 176,160,112
v_exp_f32 v100, v100
Mvav 184,160,116
v_exp_f32 v101, v101
Maav 176,160,120
v_exp_f32 v102, v102
Maav 184,160,124
s_waitcnt lgkmcnt(1)
ds_read_b128 a[160:163], v20 offset:12288
CV 134,92,93
Mvav 180,164,112
v_exp_f32 v103, v103
Mvav 188,164,116
v_exp_f32 v108, v108
Maav 180,164,120
LD 15,44,76,3072
CV 135,94,95
Maav 188,164,124
s_add_u32 m0, s69, 0x16000
s_add_u32 s76, s73, 0xf4000
ds_read_b128 a[164:167], v21 offset:12288
Mvav 192,168,112
v_exp_f32 v109, v109
Mvav 200,168,116
v_exp_f32 v110, v110
Maav 192,168,120
v_exp_f32 v111, v111
Maav 200,168,124
ds_read_b128 a[168:171], v22 offset:12288
CV 138,100,101
Mvav 196,172,112
CV 139,102,103
CV 142,108,109
Mvav 204,172,116
CV 143,110,111
v_add_u32 v20, 0xfffe5000, v20
Maav 196,172,120
v_exp_f32 v48, v48
Maav 204,172,124
ds_read_b128 a[172:175], v23 offset:12288
v_add_u32 v21, 0xfffe5000, v21
Mvav 208,128,112
v_exp_f32 v49, v49
Mvav 216,128,116
v_exp_f32 v50, v50
Maav 208,128,120
v_exp_f32 v51, v51
Maav 216,128,124
Ta 128,2,24576
v_add_u32 v22, 0xfffe5000, v22
Mvav 212,132,112
LD 16,48,76,0
Ta 130,2,26624
Mvav 220,132,116
v_exp_f32 v56, v56
Maav 212,132,120
v_exp_f32 v57, v57
Maav 220,132,124
Ta 132,3,24576
v_add_u32 v23, 0xfffe5000, v23
Mvav 224,136,112
Ta 134,3,26624
v_accvgpr_write_b32 a61, v250
Mvav 232,136,116
v_exp_f32 v58, v58
Maav 224,136,120
v_exp_f32 v59, v59
Maav 232,136,124
Ta 136,4,24576
v_accvgpr_write_b32 a62, v252
Mvav 228,140,112
Ta 138,4,26624
CV 112,48,49
Mvav 236,140,116
v_exp_f32 v64, v64
Maav 228,140,120
v_exp_f32 v65, v65
Maav 236,140,124
Ta 140,5,24576
CV 113,50,51
v_mfma_f32_16x16x32_bf16 v[80:83], a[144:147], a[64:67], v[144:147]
Ta 142,5,26624
CV 116,56,57
v_mfma_f32_16x16x32_bf16 v[88:91], a[144:147], a[68:71], v[148:151]
v_exp_f32 v66, v66
v_mfma_f32_16x16x32_bf16 v[96:99], a[144:147], a[96:99], v[152:155]
LD 17,48,76,1024
CV 117,58,59
v_mfma_f32_16x16x32_bf16 v[104:107], a[144:147], a[100:103], v[156:159]
Ta 144,2,28672
CV 120,64,65
Mvaa 80,148,72
Ta 146,2,30720
v_add_u32 v2, 0xfffe5000, v2
Mvaa 88,148,76
v_exp_f32 v67, v67
Mvaa 96,148,104
v_exp_f32 v72, v72
Mvaa 104,148,108
Ta 148,3,28672
CV 121,66,67
Mvaa 80,152,80
Ta 150,3,30720
v_add_u32 v3, 0xfffe5000, v3
Mvaa 88,152,84
v_exp_f32 v73, v73
Mvaa 96,152,112
v_exp_f32 v74, v74
Mvaa 104,152,116
s_waitcnt lgkmcnt(4)
Ta 152,4,28672
CV 124,72,73
Mvaa 80,156,88
s_mul_i32 s77, s100, 0x400
Ta 154,4,30720
v_min_u32 v46, 7, v1
Mvaa 88,156,92
s_mul_i32 s85, s66, 0x90000
v_mul_u32_u24 v46, 0x80, v46
v_add_u32 v4, 0xfffe5000, v4
Mvaa 96,156,120
s_add_u32 s77, s77, s85
v_exp_f32 v75, v75
Mvaa 104,156,124
s_add_u32 s77, s77, 0x60000
Ta 156,5,28672
CV 125,74,75
v_mfma_f32_16x16x32_bf16 v[84:87], a[160:163], a[64:67], v[144:147]
LD 18,48,76,2048
Ta 158,5,30720
v_mfma_f32_16x16x32_bf16 v[92:95], a[160:163], a[68:71], v[148:151]
v_exp_f32 v52, v52
v_mfma_f32_16x16x32_bf16 v[100:103], a[160:163], a[96:99], v[152:155]
v_exp_f32 v53, v53
v_mfma_f32_16x16x32_bf16 v[108:111], a[160:163], a[100:103], v[156:159]
v_exp_f32 v54, v54
Mvaa 84,164,72
buffer_load_dword v35, v46, s[52:55], s77 offen
CV 114,52,53
Mvaa 92,164,76
v_exp_f32 v55, v55
Mvaa 100,164,104
v_exp_f32 v60, v60
Mvaa 108,164,108
s_waitcnt vmcnt(18) lgkmcnt(0)
s_barrier
v_exp_f32 v61, v61
Mvaa 84,168,80
ds_read_b128 a[160:163], v20
CV 115,54,55
Mvaa 92,168,84
ds_read_b128 a[164:167], v21
CV 118,60,61
Mvaa 100,168,112
v_exp_f32 v62, v62
Mvaa 108,168,116
ds_read_b128 a[168:171], v22
v_add_u32 v5, 0xfffe5000, v5
Mvaa 84,172,88
v_exp_f32 v63, v63
Mvaa 92,172,92
v_exp_f32 v68, v68
Mvaa 100,172,120
LD 19,48,76,3072
CV 119,62,63
Mvaa 108,172,124
s_add_u32 m0, s69, 0x1b000
ds_read_b128 a[172:175], v23
v_accvgpr_write_b32 a63, v254
Mavv 240,40,128
s_add_u32 s76, s71, 0xfc000
v_exp_f32 v69, v69
Mavv 244,40,132
v_exp_f32 v70, v70
Mavv 248,40,136
v_exp_f32 v71, v71
Mavv 252,40,140
v_exp_f32 v76, v76
Mvav 176,128,128
v_exp_f32 v77, v77
Mvav 184,128,132
v_exp_f32 v78, v78
Maav 176,128,136
v_exp_f32 v79, v79
Maav 184,128,140
ds_read_b128 a[128:131], v20 offset:4096
CV 122,68,69
Mvav 180,132,128
CV 123,70,71
CV 126,76,77
Mvav 188,132,132
CV 127,78,79
v_lshrrev_b32 v170, 4, v1
Maav 180,132,136
v_exp_f32 v80, v80
Maav 188,132,140
ds_read_b128 a[132:135], v21 offset:4096
v_and_b32 v168, 15, v1
Mvav 192,136,128
v_exp_f32 v81, v81
Mvav 200,136,132
v_exp_f32 v82, v82
Maav 192,136,136
v_exp_f32 v83, v83
Maav 200,136,140
ds_read_b128 a[136:139], v22 offset:4096
v_lshlrev_b32 v170, 2, v170
Mvav 196,140,128
v_exp_f32 v88, v88
Mvav 204,140,132
v_exp_f32 v89, v89
Maav 196,140,136
v_exp_f32 v90, v90
Maav 204,140,140
ds_read_b128 a[140:143], v23 offset:4096
v_sub_u32 v168, v168, v170
Mvav 208,144,128
v_exp_f32 v91, v91
Mvav 216,144,132
v_exp_f32 v96, v96
Maav 208,144,136
v_exp_f32 v97, v97
Maav 216,144,140
Ta 144,2,16384
v_and_b32 v170, 1, v168
Mvav 212,148,128
Ta 146,2,18432
v_lshlrev_b32 v170, 4, v170
Mvav 220,148,132
v_exp_f32 v98, v98
Maav 212,148,136
v_exp_f32 v99, v99
Maav 220,148,140
Ta 148,3,16384
v_ashrrev_i32 v168, 1, v168
Mvav 224,152,128
Ta 150,3,18432
v_lshlrev_b32 v169, v170, s86
Mvav 232,152,132
v_exp_f32 v104, v104
Maav 224,152,136
v_exp_f32 v105, v105
Maav 232,152,140
Ta 152,4,16384
v_mov_b32 v160, 0
Mvav 228,156,128
Ta 154,4,18432
CV 128,80,81
Mvav 236,156,132
v_exp_f32 v106, v106
Maav 228,156,136
v_exp_f32 v107, v107
Maav 236,156,140
s_waitcnt lgkmcnt(4)
Ta 156,5,16384
CV 129,82,83
v_mfma_f32_16x16x32_bf16 v[48:51], a[160:163], a[64:67], v[144:147]
Ta 158,5,18432
CV 132,88,89
v_mfma_f32_16x16x32_bf16 v[56:59], a[160:163], a[68:71], v[148:151]
v_exp_f32 v84, v84
v_mfma_f32_16x16x32_bf16 v[64:67], a[160:163], a[96:99], v[152:155]
LD 12,44,76,0
CV 133,90,91
v_mfma_f32_16x16x32_bf16 v[72:75], a[160:163], a[100:103], v[156:159]
Ta 160,2,20480
CV 136,96,97
Mvaa 48,164,72
Ta 162,2,22528
L_pg13_12:
s_cbranch_execz L_ret13
CV 137,98,99
Mvaa 56,164,76
v_exp_f32 v85, v85
Mvaa 64,164,104
v_exp_f32 v86, v86
Mvaa 72,164,108
Ta 164,3,20480
CV 140,104,105
Mvaa 48,168,80
Ta 166,3,22528
CV 141,106,107
Mvaa 56,168,84
v_exp_f32 v87, v87
Mvaa 64,168,112
v_exp_f32 v92, v92
Mvaa 72,168,116
Ta 168,4,20480
CV 130,84,85
Mvaa 48,172,88
Ta 170,4,22528
CV 131,86,87
Mvaa 56,172,92
v_exp_f32 v93, v93
Mvaa 64,172,120
LD 13,44,76,1024
CV 134,92,93
Mvaa 72,172,124
Ta 172,5,20480
v_mov_b32 v161, 0
v_mfma_f32_16x16x32_bf16 v[52:55], a[128:131], a[64:67], v[144:147]
Ta 174,5,22528
v_mfma_f32_16x16x32_bf16 v[60:63], a[128:131], a[68:71], v[148:151]
v_exp_f32 v94, v94
v_mfma_f32_16x16x32_bf16 v[68:71], a[128:131], a[96:99], v[152:155]
v_exp_f32 v95, v95
v_mfma_f32_16x16x32_bf16 v[76:79], a[128:131], a[100:103], v[156:159]
ds_read_b128 a[128:131], v20 offset:8192
CV 135,94,95
Mvaa 52,132,72
v_exp_f32 v100, v100
Mvaa 60,132,76
v_exp_f32 v101, v101
Mvaa 68,132,104
v_exp_f32 v102, v102
Mvaa 76,132,108
ds_read_b128 a[132:135], v21 offset:8192
CV 138,100,101
Mvaa 52,136,80
v_exp_f32 v103, v103
Mvaa 60,136,84
v_exp_f32 v108, v108
Mvaa 68,136,112
v_exp_f32 v109, v109
Mvaa 76,136,116
ds_read_b128 a[136:139], v22 offset:8192
CV 139,102,103
Mvaa 52,140,88
LD 14,44,76,2048
CV 142,108,109
Mvaa 60,140,92
v_exp_f32 v110, v110
Mvaa 68,140,120
v_exp_f32 v111, v111
Mvaa 76,140,124
ds_read_b128 a[140:143], v23 offset:8192
CV 143,110,111
Mavv 240,40,112
v_exp_f32 v48, v48
Mavv 244,40,116
v_exp_f32 v49, v49
Mavv 248,40,120
v_exp_f32 v50, v50
Mavv 252,40,124
v_exp_f32 v51, v51
Mvav 176,144,112
v_exp_f32 v56, v56
Mvav 184,144,116
v_exp_f32 v57, v57
Maav 176,144,120
v_exp_f32 v58, v58
Maav 184,144,124
s_waitcnt lgkmcnt(1)
ds_read_b128 a[144:147], v20 offset:12288
v_add_u32 v20, 0x9000, v20
Mvav 180,148,112
v_exp_f32 v59, v59
Mvav 188,148,116
v_exp_f32 v64, v64
Maav 180,148,120
LD 15,44,76,3072
Maav 188,148,124
s_add_u32 m0, s69, 0x1f000
s_add_u32 s76, s73, 0xf8000
ds_read_b128 a[148:151], v21 offset:12288
Mvav 192,152,112
v_exp_f32 v65, v65
Mvav 200,152,116
v_exp_f32 v66, v66
Maav 192,152,120
v_exp_f32 v67, v67
Maav 200,152,124
ds_read_b128 a[152:155], v22 offset:12288
v_add_u32 v21, 0x9000, v21
Mvav 196,156,112
v_exp_f32 v72, v72
Mvav 204,156,116
v_exp_f32 v73, v73
Maav 196,156,120
v_exp_f32 v74, v74
Maav 204,156,124
ds_read_b128 a[156:159], v23 offset:12288
v_add_u32 v22, 0x9000, v22
Mvav 208,160,112
v_exp_f32 v75, v75
Mvav 216,160,116
v_exp_f32 v52, v52
Maav 208,160,120
v_exp_f32 v53, v53
Maav 216,160,124
Ta 160,2,24576
v_add_u32 v23, 0x9000, v23
Mvav 212,164,112
LD 16,48,76,0
Ta 162,2,26624
Mvav 220,164,116
v_exp_f32 v54, v54
Maav 212,164,120
v_exp_f32 v55, v55
Maav 220,164,124
Ta 164,3,24576
Mvav 224,168,112
Ta 166,3,26624
Mvav 232,168,116
v_exp_f32 v60, v60
Maav 224,168,120
v_exp_f32 v61, v61
Maav 232,168,124
Ta 168,4,24576
Mvav 228,172,112
Ta 170,4,26624
CV 112,48,49
Mvav 236,172,116
v_exp_f32 v62, v62
Maav 228,172,120
v_exp_f32 v63, v63
Maav 236,172,124
Ta 172,5,24576
CV 113,50,51
v_mfma_f32_16x16x32_bf16 v[80:83], a[128:131], a[64:67], v[144:147]
Ta 174,5,26624
CV 116,56,57
v_mfma_f32_16x16x32_bf16 v[88:91], a[128:131], a[68:71], v[148:151]
v_exp_f32 v68, v68
v_mfma_f32_16x16x32_bf16 v[96:99], a[128:131], a[96:99], v[152:155]
LD 17,48,76,1024
CV 117,58,59
v_mfma_f32_16x16x32_bf16 v[104:107], a[128:131], a[100:103], v[156:159]
Ta 128,2,28672
CV 120,64,65
Mvaa 80,132,72
Ta 130,2,30720
CV 121,66,67
Mvaa 88,132,76
v_exp_f32 v69, v69
Mvaa 96,132,104
v_exp_f32 v70, v70
Mvaa 104,132,108
Ta 132,3,28672
CV 124,72,73
Mvaa 80,136,80
Ta 134,3,30720
CV 125,74,75
Mvaa 88,136,84
v_exp_f32 v71, v71
Mvaa 96,136,112
v_exp_f32 v76, v76
Mvaa 104,136,116
s_waitcnt lgkmcnt(4)
Ta 136,4,28672
CV 114,52,53
Mvaa 80,140,88
s_mul_i32 s77, s100, 0x400
Ta 138,4,30720
v_min_u32 v46, 7, v1
Mvaa 88,140,92
s_mul_i32 s85, s66, 0x90000
v_mul_u32_u24 v46, 0x80, v46
CV 115,54,55
Mvaa 96,140,120
s_add_u32 s77, s77, s85
v_exp_f32 v77, v77
Mvaa 104,140,124
s_add_u32 s77, s77, 0x70000
Ta 140,5,28672
CV 118,60,61
v_mfma_f32_16x16x32_bf16 v[84:87], a[144:147], a[64:67], v[144:147]
LD 18,48,76,2048
Ta 142,5,30720
v_mfma_f32_16x16x32_bf16 v[92:95], a[144:147], a[68:71], v[148:151]
v_exp_f32 v78, v78
v_mfma_f32_16x16x32_bf16 v[100:103], a[144:147], a[96:99], v[152:155]
v_exp_f32 v79, v79
v_mfma_f32_16x16x32_bf16 v[108:111], a[144:147], a[100:103], v[156:159]
CV 119,62,63
CV 122,68,69
Mvaa 84,148,72
buffer_load_dword v35, v46, s[52:55], s77 offen
CV 123,70,71
Mvaa 92,148,76
CV 126,76,77
CV 127,78,79
Mvaa 100,148,104
v_add_u32 v2, 0x9000, v2
v_add_u32 v3, 0x9000, v3
Mvaa 108,148,108
s_waitcnt vmcnt(18) lgkmcnt(0)
s_barrier
v_add_u32 v4, 0x9000, v4
v_add_u32 v5, 0x9000, v5
Mvaa 84,152,80
ds_read_b128 a[144:147], v20
Mvaa 92,152,84
ds_read_b128 a[148:151], v21
Mvaa 100,152,112
v_exp_f32 v80, v80
Mvaa 108,152,116
ds_read_b128 a[152:155], v22
Mvaa 84,156,88
v_exp_f32 v81, v81
Mvaa 92,156,92
v_exp_f32 v82, v82
Mvaa 100,156,120
LD 19,48,76,3072
Mvaa 108,156,124
s_add_u32 m0, s69, 0x4000
ds_read_b128 a[156:159], v23
s_add_u32 s76, s73, 0xfc000
Mavv 240,40,128
v_exp_f32 v83, v83
Mavv 244,40,132
v_exp_f32 v88, v88
Mavv 248,40,136
v_exp_f32 v89, v89
Mavv 252,40,140
v_exp_f32 v90, v90
Mvav 176,160,128
v_exp_f32 v91, v91
Mvav 184,160,132
v_exp_f32 v96, v96
Maav 176,160,136
v_exp_f32 v97, v97
Maav 184,160,140
ds_read_b128 a[160:163], v20 offset:4096
Mvav 180,164,128
v_exp_f32 v98, v98
Mvav 188,164,132
v_exp_f32 v99, v99
Maav 180,164,136
v_exp_f32 v104, v104
Maav 188,164,140
ds_read_b128 a[164:167], v21 offset:4096
Mvav 192,168,128
v_exp_f32 v105, v105
Mvav 200,168,132
v_exp_f32 v106, v106
Maav 192,168,136
v_exp_f32 v107, v107
Maav 200,168,140
ds_read_b128 a[168:171], v22 offset:4096
Mvav 196,172,128
v_exp_f32 v84, v84
Mvav 204,172,132
v_exp_f32 v85, v85
Maav 196,172,136
v_exp_f32 v86, v86
Maav 204,172,140
ds_read_b128 a[172:175], v23 offset:4096
Mvav 208,128,128
v_exp_f32 v87, v87
Mvav 216,128,132
v_exp_f32 v92, v92
Maav 208,128,136
v_exp_f32 v93, v93
Maav 216,128,140
Ta 128,2,16384
Mvav 212,132,128
Ta 130,2,18432
Mvav 220,132,132
v_exp_f32 v94, v94
Maav 212,132,136
v_exp_f32 v95, v95
Maav 220,132,140
Ta 132,3,16384
Mvav 224,136,128
Ta 134,3,18432
Mvav 232,136,132
v_exp_f32 v100, v100
Maav 224,136,136
v_exp_f32 v101, v101
Maav 232,136,140
Ta 136,4,16384
Mvav 228,140,128
Ta 138,4,18432
CV 128,80,81
Mvav 236,140,132
v_exp_f32 v102, v102
Maav 228,140,136
v_exp_f32 v103, v103
Maav 236,140,140
s_waitcnt lgkmcnt(4)
Ta 140,5,16384
CV 129,82,83
v_mfma_f32_16x16x32_bf16 v[48:51], a[144:147], a[64:67], v[144:147]
Ta 142,5,18432
CV 132,88,89
v_mfma_f32_16x16x32_bf16 v[56:59], a[144:147], a[68:71], v[148:151]
v_exp_f32 v108, v108
v_mfma_f32_16x16x32_bf16 v[64:67], a[144:147], a[96:99], v[152:155]
LD 16,48,76,0
CV 133,90,91
v_mfma_f32_16x16x32_bf16 v[72:75], a[144:147], a[100:103], v[156:159]
Ta 144,2,20480
CV 136,96,97
Mvaa 48,148,72
Ta 146,2,22528
CV 137,98,99
Mvaa 56,148,76
v_exp_f32 v109, v109
Mvaa 64,148,104
v_exp_f32 v110, v110
Mvaa 72,148,108
Ta 148,3,20480
CV 140,104,105
Mvaa 48,152,80
Ta 150,3,22528
CV 141,106,107
Mvaa 56,152,84
v_exp_f32 v111, v111
Mvaa 64,152,112
CV 130,84,85
CV 131,86,87
Mvaa 72,152,116
Ta 152,4,20480
CV 134,92,93
Mvaa 48,156,88
Ta 154,4,22528
CV 135,94,95
Mvaa 56,156,92
CV 138,100,101
CV 139,102,103
Mvaa 64,156,120
CV 142,108,109
CV 143,110,111
Mvaa 72,156,124
Ta 156,5,20480
v_mfma_f32_16x16x32_bf16 v[52:55], a[160:163], a[64:67], v[144:147]
Ta 158,5,22528
v_mfma_f32_16x16x32_bf16 v[60:63], a[160:163], a[68:71], v[148:151]
v_exp_f32 v48, v48
v_mfma_f32_16x16x32_bf16 v[68:71], a[160:163], a[96:99], v[152:155]
v_exp_f32 v49, v49
v_mfma_f32_16x16x32_bf16 v[76:79], a[160:163], a[100:103], v[156:159]
ds_read_b128 a[160:163], v20 offset:8192
Mvaa 52,164,72
v_exp_f32 v50, v50
Mvaa 60,164,76
v_exp_f32 v51, v51
Mvaa 68,164,104
v_exp_f32 v56, v56
Mvaa 76,164,108
ds_read_b128 a[164:167], v21 offset:8192
Mvaa 52,168,80
v_exp_f32 v57, v57
Mvaa 60,168,84
v_exp_f32 v58, v58
Mvaa 68,168,112
v_exp_f32 v59, v59
Mvaa 76,168,116
ds_read_b128 a[168:171], v22 offset:8192
Mvaa 52,172,88
LD 17,48,76,1024
s_lshl_b32 s85, s30, 7
Mvaa 60,172,92
s_add_u32 s85, s85, 0x4000
v_exp_f32 v64, v64
Mvaa 68,172,120
s_getpc_b64 s[96:97]
v_mov_b32 v46, s85
Mvaa 76,172,124
ds_read_b128 a[172:175], v23 offset:8192
Mavv 240,40,112
global_load_dword v35, v46, s[96:97]
Mavv 244,40,116
v_exp_f32 v65, v65
Mavv 248,40,120
v_exp_f32 v66, v66
Mavv 252,40,124
v_exp_f32 v67, v67
Mvav 176,128,112
v_exp_f32 v72, v72
Mvav 184,128,116
v_exp_f32 v73, v73
Maav 176,128,120
v_exp_f32 v74, v74
Maav 184,128,124
s_waitcnt lgkmcnt(1)
ds_read_b128 a[128:131], v20 offset:12288
v_add_u32 v20, 0x9000, v20
Mvav 180,132,112
v_exp_f32 v75, v75
Mvav 188,132,116
v_exp_f32 v52, v52
Maav 180,132,120
v_exp_f32 v53, v53
Maav 188,132,124
ds_read_b128 a[132:135], v21 offset:12288
v_add_u32 v21, 0x9000, v21
Mvav 192,136,112
v_exp_f32 v54, v54
Mvav 200,136,116
v_exp_f32 v55, v55
Maav 192,136,120
v_exp_f32 v60, v60
Maav 200,136,124
ds_read_b128 a[136:139], v22 offset:12288
v_add_u32 v22, 0x9000, v22
Mvav 196,140,112
v_exp_f32 v61, v61
Mvav 204,140,116
v_exp_f32 v62, v62
Maav 196,140,120
v_exp_f32 v63, v63
Maav 204,140,124
ds_read_b128 a[140:143], v23 offset:12288
v_add_u32 v23, 0x9000, v23
Mvav 208,144,112
v_exp_f32 v68, v68
Mvav 216,144,116
v_exp_f32 v69, v69
Maav 208,144,120
v_exp_f32 v70, v70
Maav 216,144,124
Ta 144,2,24576
Mvav 212,148,112
LD 18,48,76,2048
Ta 146,2,26624
Mvav 220,148,116
v_exp_f32 v71, v71
Maav 212,148,120
v_exp_f32 v76, v76
Maav 220,148,124
Ta 148,3,24576
Mvav 224,152,112
Ta 150,3,26624
Mvav 232,152,116
v_exp_f32 v77, v77
Maav 224,152,120
v_exp_f32 v78, v78
Maav 232,152,124
Ta 152,4,24576
Mvav 228,156,112
Ta 154,4,26624
CV 112,48,49
Mvav 236,156,116
v_exp_f32 v79, v79
Maav 228,156,120
CV 113,50,51
CV 116,56,57
Maav 236,156,124
Ta 156,5,24576
CV 117,58,59
v_mfma_f32_16x16x32_bf16 v[80:83], a[160:163], a[64:67], v[144:147]
Ta 158,5,26624
CV 120,64,65
v_mfma_f32_16x16x32_bf16 v[88:91], a[160:163], a[68:71], v[148:151]
CV 121,66,67
CV 124,72,73
v_mfma_f32_16x16x32_bf16 v[96:99], a[160:163], a[96:99], v[152:155]
CV 125,74,75
CV 114,52,53
v_mfma_f32_16x16x32_bf16 v[104:107], a[160:163], a[100:103], v[156:159]
Ta 160,2,28672
CV 115,54,55
Mvaa 80,164,72
Ta 162,2,30720
CV 118,60,61
Mvaa 88,164,76
CV 119,62,63
CV 122,68,69
Mvaa 96,164,104
CV 123,70,71
CV 126,76,77
Mvaa 104,164,108
Ta 164,3,28672
CV 127,78,79
Mvaa 80,168,80
Ta 166,3,30720
v_add_u32 v2, 0x9000, v2
Mvaa 88,168,84
v_add_u32 v3, 0x9000, v3
Mvaa 96,168,112
Mvaa 104,168,116
s_waitcnt lgkmcnt(4)
Ta 168,4,28672
Mvaa 80,172,88
s_mul_i32 s77, s100, 0x400
Ta 170,4,30720
v_min_u32 v46, 7, v1
Mvaa 88,172,92
s_mul_i32 s85, s66, 0x90000
v_mul_u32_u24 v46, 0x80, v46
v_add_u32 v4, 0x9000, v4
Mvaa 96,172,120
s_add_u32 s77, s77, s85
Mvaa 104,172,124
s_add_u32 s77, s77, 0x80000
Ta 172,5,28672
v_mfma_f32_16x16x32_bf16 v[84:87], a[128:131], a[64:67], v[144:147]
LD 19,48,76,3072
Ta 174,5,30720
v_mfma_f32_16x16x32_bf16 v[92:95], a[128:131], a[68:71], v[148:151]
s_add_u32 m0, s68, 0x9000
v_add_u32 v5, 0x9000, v5
v_mfma_f32_16x16x32_bf16 v[100:103], a[128:131], a[96:99], v[152:155]
s_add_u32 s76, s12, 0
v_exp_f32 v80, v80
v_mfma_f32_16x16x32_bf16 v[108:111], a[128:131], a[100:103], v[156:159]
v_exp_f32 v81, v81
Mvaa 84,132,72
buffer_load_dword v35, v46, s[52:55], s77 offen
Mvaa 92,132,76
v_exp_f32 v82, v82
Mvaa 100,132,104
v_exp_f32 v83, v83
Mvaa 108,132,108
s_waitcnt vmcnt(15) lgkmcnt(0)
s_barrier
v_exp_f32 v88, v88
Mvaa 84,136,80
ds_read_b128 a[128:131], v20
Mvaa 92,136,84
ds_read_b128 a[132:135], v21
Mvaa 100,136,112
v_exp_f32 v89, v89
Mvaa 108,136,116
ds_read_b128 a[136:139], v22
Mvaa 84,140,88
v_exp_f32 v90, v90
Mvaa 92,140,92
v_exp_f32 v91, v91
Mvaa 100,140,120
v_exp_f32 v96, v96
Mvaa 108,140,124
ds_read_b128 a[140:143], v23
Mavv 240,40,128
v_exp_f32 v97, v97
Mavv 244,40,132
v_exp_f32 v98, v98
Mavv 248,40,136
v_exp_f32 v99, v99
Mavv 252,40,140
v_exp_f32 v104, v104
Mvav 176,144,128
v_exp_f32 v105, v105
Mvav 184,144,132
v_exp_f32 v106, v106
Maav 176,144,136
v_exp_f32 v107, v107
Maav 184,144,140
ds_read_b128 a[144:147], v20 offset:4096
Mvav 180,148,128
v_exp_f32 v84, v84
Mvav 188,148,132
v_exp_f32 v85, v85
Maav 180,148,136
v_exp_f32 v86, v86
Maav 188,148,140
ds_read_b128 a[148:151], v21 offset:4096
Mvav 192,152,128
v_exp_f32 v87, v87
Mvav 200,152,132
v_exp_f32 v92, v92
Maav 192,152,136
v_exp_f32 v93, v93
Maav 200,152,140
ds_read_b128 a[152:155], v22 offset:4096
Mvav 196,156,128
L_pg13_13:
s_cbranch_execz L_ret13
v_exp_f32 v94, v94
Mvav 204,156,132
v_exp_f32 v95, v95
Maav 196,156,136
v_exp_f32 v100, v100
Maav 204,156,140
ds_read_b128 a[156:159], v23 offset:4096
Mvav 208,160,128
v_exp_f32 v101, v101
Mvav 216,160,132
v_exp_f32 v102, v102
Maav 208,160,136
v_exp_f32 v103, v103
Maav 216,160,140
Ta 160,2,16384
Mvav 212,164,128
Ta 162,2,18432
Mvav 220,164,132
v_exp_f32 v108, v108
Maav 212,164,136
v_exp_f32 v109, v109
Maav 220,164,140
Ta 164,3,16384
Mvav 224,168,128
Ta 166,3,18432
Mvav 232,168,132
v_exp_f32 v110, v110
Maav 224,168,136
v_exp_f32 v111, v111
Maav 232,168,140
Ta 168,4,16384
Mvav 228,172,128
Ta 170,4,18432
CV 128,80,81
Mvav 236,172,132
CV 129,82,83
CV 132,88,89
Maav 228,172,136
CV 133,90,91
CV 136,96,97
Maav 236,172,140
s_waitcnt lgkmcnt(4)
Ta 172,5,16384
CV 137,98,99
v_mfma_f32_16x16x32_bf16 v[48:51], a[128:131], a[64:67], v[144:147]
Ta 174,5,18432
CV 140,104,105
v_mfma_f32_16x16x32_bf16 v[56:59], a[128:131], a[68:71], v[148:151]
CV 141,106,107
CV 130,84,85
v_mfma_f32_16x16x32_bf16 v[64:67], a[128:131], a[96:99], v[152:155]
LD 8,52,76,0
CV 131,86,87
v_mfma_f32_16x16x32_bf16 v[72:75], a[128:131], a[100:103], v[156:159]
Ta 128,2,20480
CV 134,92,93
Mvaa 48,132,72
Ta 130,2,22528
CV 135,94,95
Mvaa 56,132,76
CV 138,100,101
CV 139,102,103
Mvaa 64,132,104
CV 142,108,109
CV 143,110,111
Mvaa 72,132,108
Ta 132,3,20480
Mvaa 48,136,80
Ta 134,3,22528
Mvaa 56,136,84
Mvaa 64,136,112
Mvaa 72,136,116
Ta 136,4,20480
Mvaa 48,140,88
Ta 138,4,22528
Mvaa 56,140,92
s_nop 0
Mvaa 64,140,120
LD 9,52,76,1024
Mvaa 72,140,124
Ta 140,5,20480
v_mfma_f32_16x16x32_bf16 v[52:55], a[144:147], a[64:67], v[144:147]
Ta 142,5,22528
v_mfma_f32_16x16x32_bf16 v[60:63], a[144:147], a[68:71], v[148:151]
v_exp_f32 v48, v48
v_mfma_f32_16x16x32_bf16 v[68:71], a[144:147], a[96:99], v[152:155]
v_exp_f32 v49, v49
v_mfma_f32_16x16x32_bf16 v[76:79], a[144:147], a[100:103], v[156:159]
ds_read_b128 a[144:147], v20 offset:8192
Mvaa 52,148,72
v_exp_f32 v50, v50
Mvaa 60,148,76
v_exp_f32 v51, v51
Mvaa 68,148,104
v_exp_f32 v56, v56
Mvaa 76,148,108
ds_read_b128 a[148:151], v21 offset:8192
Mvaa 52,152,80
v_exp_f32 v57, v57
Mvaa 60,152,84
v_exp_f32 v58, v58
Mvaa 68,152,112
v_exp_f32 v59, v59
Mvaa 76,152,116
ds_read_b128 a[152:155], v22 offset:8192
Mvaa 52,156,88
LD 10,52,76,2048
Mvaa 60,156,92
v_exp_f32 v64, v64
Mvaa 68,156,120
v_exp_f32 v65, v65
Mvaa 76,156,124
ds_read_b128 a[156:159], v23 offset:8192
Mavv 240,40,112
v_exp_f32 v66, v66
Mavv 244,40,116
v_exp_f32 v67, v67
Mavv 248,40,120
v_exp_f32 v72, v72
Mavv 252,40,124
v_exp_f32 v73, v73
Mvav 176,160,112
v_exp_f32 v74, v74
Mvav 184,160,116
v_exp_f32 v75, v75
Maav 176,160,120
v_exp_f32 v52, v52
Maav 184,160,124
s_waitcnt lgkmcnt(1)
ds_read_b128 a[160:163], v20 offset:12288
v_add_u32 v20, 0x9000, v20
Mvav 180,164,112
v_exp_f32 v53, v53
Mvav 188,164,116
v_exp_f32 v54, v54
Maav 180,164,120
LD 11,52,76,3072
Maav 188,164,124
s_add_u32 m0, s68, 0xa000
s_add_u32 s76, s12, 0x9000
ds_read_b128 a[164:167], v21 offset:12288
Mvav 192,168,112
v_exp_f32 v55, v55
Mvav 200,168,116
v_add_u32 v21, 0x9000, v21
Maav 192,168,120
v_exp_f32 v60, v60
Maav 200,168,124
ds_read_b128 a[168:171], v22 offset:12288
v_add_u32 v22, 0x9000, v22
Mvav 196,172,112
v_exp_f32 v61, v61
Mvav 204,172,116
v_exp_f32 v62, v62
Maav 196,172,120
v_exp_f32 v63, v63
Maav 204,172,124
ds_read_b128 a[172:175], v23 offset:12288
v_add_u32 v23, 0x9000, v23
Mvav 208,128,112
v_exp_f32 v68, v68
Mvav 216,128,116
v_exp_f32 v69, v69
Maav 208,128,120
v_exp_f32 v70, v70
Maav 216,128,124
Ta 128,2,24576
Mvav 212,132,112
LD 8,52,76,0
Ta 130,2,26624
Mvav 220,132,116
v_exp_f32 v71, v71
Maav 212,132,120
v_exp_f32 v76, v76
Maav 220,132,124
Ta 132,3,24576
Mvav 224,136,112
Ta 134,3,26624
Mvav 232,136,116
v_exp_f32 v77, v77
Maav 224,136,120
v_exp_f32 v78, v78
Maav 232,136,124
Ta 136,4,24576
Mvav 228,140,112
Ta 138,4,26624
CV 112,48,49
Mvav 236,140,116
v_exp_f32 v79, v79
Maav 228,140,120
CV 113,50,51
CV 116,56,57
Maav 236,140,124
Ta 140,5,24576
CV 117,58,59
v_mfma_f32_16x16x32_bf16 v[80:83], a[144:147], a[64:67], v[144:147]
Ta 142,5,26624
CV 120,64,65
v_mfma_f32_16x16x32_bf16 v[88:91], a[144:147], a[68:71], v[148:151]
CV 121,66,67
CV 124,72,73
v_mfma_f32_16x16x32_bf16 v[96:99], a[144:147], a[96:99], v[152:155]
LD 9,52,76,1024
CV 125,74,75
v_mfma_f32_16x16x32_bf16 v[104:107], a[144:147], a[100:103], v[156:159]
Ta 144,2,28672
CV 114,52,53
Mvaa 80,148,72
Ta 146,2,30720
CV 115,54,55
Mvaa 88,148,76
CV 118,60,61
CV 119,62,63
Mvaa 96,148,104
CV 122,68,69
CV 123,70,71
Mvaa 104,148,108
Ta 148,3,28672
CV 126,76,77
Mvaa 80,152,80
Ta 150,3,30720
CV 127,78,79
Mvaa 88,152,84
v_add_u32 v2, 0x9000, v2
v_add_u32 v3, 0x9000, v3
Mvaa 96,152,112
Mvaa 104,152,116
s_waitcnt lgkmcnt(4)
Ta 152,4,28672
Mvaa 80,156,88
Ta 154,4,30720
v_add_u32 v4, 0x9000, v4
Mvaa 88,156,92
s_nop 0
Mvaa 96,156,120
s_nop 0
Mvaa 104,156,124
Ta 156,5,28672
v_mfma_f32_16x16x32_bf16 v[84:87], a[160:163], a[64:67], v[144:147]
LD 10,52,76,2048
Ta 158,5,30720
v_mfma_f32_16x16x32_bf16 v[92:95], a[160:163], a[68:71], v[148:151]
v_add_u32 v5, 0x9000, v5
v_mfma_f32_16x16x32_bf16 v[100:103], a[160:163], a[96:99], v[152:155]
v_exp_f32 v80, v80
v_mfma_f32_16x16x32_bf16 v[108:111], a[160:163], a[100:103], v[156:159]
v_exp_f32 v81, v81
Mvaa 84,164,72
v_exp_f32 v82, v82
Mvaa 92,164,76
v_exp_f32 v83, v83
Mvaa 100,164,104
v_exp_f32 v88, v88
Mvaa 108,164,108
s_waitcnt vmcnt(13) lgkmcnt(0)
s_barrier
v_exp_f32 v89, v89
Mvaa 84,168,80
ds_read_b128 a[160:163], v20
Mvaa 92,168,84
ds_read_b128 a[164:167], v21
Mvaa 100,168,112
v_exp_f32 v90, v90
Mvaa 108,168,116
ds_read_b128 a[168:171], v22
Mvaa 84,172,88
v_exp_f32 v91, v91
Mvaa 92,172,92
v_exp_f32 v96, v96
Mvaa 100,172,120
LD 11,52,76,3072
Mvaa 108,172,124
s_add_u32 m0, s68, 0x12000
ds_read_b128 a[172:175], v23
s_add_u32 s76, s23, 0
Mavv 240,40,128
v_exp_f32 v97, v97
Mavv 244,40,132
v_exp_f32 v98, v98
Mavv 248,40,136
v_exp_f32 v99, v99
Mavv 252,40,140
v_exp_f32 v104, v104
Mvav 176,128,128
v_exp_f32 v105, v105
Mvav 184,128,132
v_exp_f32 v106, v106
Maav 176,128,136
v_exp_f32 v107, v107
Maav 184,128,140
ds_read_b128 a[128:131], v20 offset:4096
Mvav 180,132,128
v_exp_f32 v84, v84
Mvav 188,132,132
v_exp_f32 v85, v85
Maav 180,132,136
v_exp_f32 v86, v86
Maav 188,132,140
ds_read_b128 a[132:135], v21 offset:4096
Mvav 192,136,128
v_exp_f32 v87, v87
Mvav 200,136,132
v_exp_f32 v92, v92
Maav 192,136,136
v_exp_f32 v93, v93
Maav 200,136,140
ds_read_b128 a[136:139], v22 offset:4096
Mvav 196,140,128
v_exp_f32 v94, v94
Mvav 204,140,132
v_exp_f32 v95, v95
Maav 196,140,136
v_exp_f32 v100, v100
Maav 204,140,140
ds_read_b128 a[140:143], v23 offset:4096
Mvav 208,144,128
v_exp_f32 v101, v101
Mvav 216,144,132
v_exp_f32 v102, v102
Maav 208,144,136
v_exp_f32 v103, v103
Maav 216,144,140
Ta 144,2,16384
Mvav 212,148,128
Ta 146,2,18432
Mvav 220,148,132
v_exp_f32 v108, v108
Maav 212,148,136
v_exp_f32 v109, v109
Maav 220,148,140
Ta 148,3,16384
Mvav 224,152,128
Ta 150,3,18432
Mvav 232,152,132
v_exp_f32 v110, v110
Maav 224,152,136
v_exp_f32 v111, v111
Maav 232,152,140
Ta 152,4,16384
Mvav 228,156,128
Ta 154,4,18432
CV 128,80,81
Mvav 236,156,132
CV 129,82,83
CV 132,88,89
Maav 228,156,136
CV 133,90,91
CV 136,96,97
Maav 236,156,140
s_waitcnt lgkmcnt(4)
Ta 156,5,16384
CV 137,98,99
v_mfma_f32_16x16x32_bf16 v[48:51], a[160:163], a[64:67], v[144:147]
Ta 158,5,18432
CV 140,104,105
v_mfma_f32_16x16x32_bf16 v[56:59], a[160:163], a[68:71], v[148:151]
CV 141,106,107
CV 130,84,85
v_mfma_f32_16x16x32_bf16 v[64:67], a[160:163], a[96:99], v[152:155]
LD 8,52,76,0
CV 131,86,87
v_mfma_f32_16x16x32_bf16 v[72:75], a[160:163], a[100:103], v[156:159]
Ta 160,2,20480
CV 134,92,93
Mvaa 48,164,72
Ta 162,2,22528
CV 135,94,95
Mvaa 56,164,76
CV 138,100,101
CV 139,102,103
Mvaa 64,164,104
CV 142,108,109
CV 143,110,111
Mvaa 72,164,108
Ta 164,3,20480
Mvaa 48,168,80
Ta 166,3,22528
Mvaa 56,168,84
Mvaa 64,168,112
Mvaa 72,168,116
Ta 168,4,20480
Mvaa 48,172,88
Ta 170,4,22528
Mvaa 56,172,92
s_nop 0
Mvaa 64,172,120
LD 9,52,76,1024
Mvaa 72,172,124
Ta 172,5,20480
v_mfma_f32_16x16x32_bf16 v[52:55], a[128:131], a[64:67], v[144:147]
Ta 174,5,22528
v_mfma_f32_16x16x32_bf16 v[60:63], a[128:131], a[68:71], v[148:151]
v_exp_f32 v48, v48
v_mfma_f32_16x16x32_bf16 v[68:71], a[128:131], a[96:99], v[152:155]
v_exp_f32 v49, v49
v_mfma_f32_16x16x32_bf16 v[76:79], a[128:131], a[100:103], v[156:159]
ds_read_b128 a[128:131], v20 offset:8192
Mvaa 52,132,72
v_exp_f32 v50, v50
Mvaa 60,132,76
v_exp_f32 v51, v51
Mvaa 68,132,104
v_exp_f32 v56, v56
Mvaa 76,132,108
ds_read_b128 a[132:135], v21 offset:8192
Mvaa 52,136,80
v_exp_f32 v57, v57
Mvaa 60,136,84
v_exp_f32 v58, v58
Mvaa 68,136,112
v_exp_f32 v59, v59
Mvaa 76,136,116
ds_read_b128 a[136:139], v22 offset:8192
Mvaa 52,140,88
LD 10,52,76,2048
s_lshl_b32 s85, s30, 7
Mvaa 60,140,92
s_add_u32 s85, s85, 0x4000
v_exp_f32 v64, v64
Mvaa 68,140,120
s_getpc_b64 s[96:97]
v_mov_b32 v46, s85
Mvaa 76,140,124
ds_read_b128 a[140:143], v23 offset:8192
Mavv 240,40,112
global_load_dword v35, v46, s[96:97]
Mavv 244,40,116
v_exp_f32 v52, v52
Mavv 248,40,120
v_exp_f32 v53, v53
Mavv 252,40,124
v_exp_f32 v54, v54
Mvav 176,144,112
v_exp_f32 v55, v55
Mvav 184,144,116
v_exp_f32 v60, v60
Maav 176,144,120
v_exp_f32 v61, v61
Maav 184,144,124
s_waitcnt lgkmcnt(1)
ds_read_b128 a[144:147], v20 offset:12288
Mvav 180,148,112
v_exp_f32 v62, v62
Mvav 188,148,116
v_exp_f32 v63, v63
Maav 180,148,120
LD 11,52,76,3072
Maav 188,148,124
s_add_u32 m0, s68, 0x13000
s_add_u32 s76, s23, 0x9000
ds_read_b128 a[148:151], v21 offset:12288
Mvav 192,152,112
v_exp_f32 v65, v65
Mvav 200,152,116
v_exp_f32 v66, v66
Maav 192,152,120
v_exp_f32 v67, v67
Maav 200,152,124
ds_read_b128 a[152:155], v22 offset:12288
Mvav 196,156,112
v_exp_f32 v68, v68
Mvav 204,156,116
v_exp_f32 v69, v69
Maav 196,156,120
v_exp_f32 v70, v70
Maav 204,156,124
ds_read_b128 a[156:159], v23 offset:12288
Mvav 208,160,112
v_exp_f32 v71, v71
Mvav 216,160,116
v_exp_f32 v72, v72
Maav 208,160,120
v_exp_f32 v73, v73
Maav 216,160,124
Ta 160,2,24576
Mvav 212,164,112
LD 8,52,76,0
Ta 162,2,26624
Mvav 220,164,116
v_exp_f32 v74, v74
Maav 212,164,120
v_exp_f32 v75, v75
Maav 220,164,124
Ta 164,3,24576
Mvav 224,168,112
Ta 166,3,26624
Mvav 232,168,116
v_exp_f32 v76, v76
Maav 224,168,120
v_exp_f32 v77, v77
Maav 232,168,124
Ta 168,4,24576
Mvav 228,172,112
Ta 170,4,26624
CV 112,48,49
Mvav 236,172,116
v_exp_f32 v78, v78
Maav 228,172,120
v_exp_f32 v79, v79
Maav 236,172,124
Ta 172,5,24576
CV 113,50,51
v_mfma_f32_16x16x32_bf16 v[80:83], a[128:131], a[64:67], v[144:147]
Ta 174,5,26624
CV 114,52,53
v_mfma_f32_16x16x32_bf16 v[88:91], a[128:131], a[68:71], v[148:151]
CV 115,54,55
CV 116,56,57
v_mfma_f32_16x16x32_bf16 v[96:99], a[128:131], a[96:99], v[152:155]
LD 9,52,76,1024
CV 117,58,59
v_mfma_f32_16x16x32_bf16 v[104:107], a[128:131], a[100:103], v[156:159]
Ta 128,2,28672
CV 118,60,61
Mvaa 80,132,72
Ta 130,2,30720
v_add_u32 v2, 0xfffe5000, v2
Mvaa 88,132,76
CV 119,62,63
CV 120,64,65
Mvaa 96,132,104
CV 121,66,67
CV 122,68,69
Mvaa 104,132,108
Ta 132,3,28672
CV 123,70,71
Mvaa 80,136,80
Ta 134,3,30720
v_add_u32 v3, 0xfffe5000, v3
Mvaa 88,136,84
CV 124,72,73
CV 125,74,75
Mvaa 96,136,112
CV 126,76,77
CV 127,78,79
Mvaa 104,136,116
s_waitcnt lgkmcnt(4)
Ta 136,4,28672
Mvaa 80,140,88
Ta 138,4,30720
v_add_u32 v4, 0xfffe5000, v4
Mvaa 88,140,92
s_nop 0
Mvaa 96,140,120
s_nop 0
Mvaa 104,140,124
Ta 140,5,28672
v_mfma_f32_16x16x32_bf16 v[84:87], a[144:147], a[64:67], v[144:147]
LD 10,52,76,2048
Ta 142,5,30720
v_mfma_f32_16x16x32_bf16 v[92:95], a[144:147], a[68:71], v[148:151]
v_add_u32 v5, 0xfffe5000, v5
v_mfma_f32_16x16x32_bf16 v[100:103], a[144:147], a[96:99], v[152:155]
v_exp_f32 v80, v80
v_mfma_f32_16x16x32_bf16 v[108:111], a[144:147], a[100:103], v[156:159]
v_exp_f32 v81, v81
Mvaa 84,148,72
v_exp_f32 v82, v82
Mvaa 92,148,76
v_exp_f32 v83, v83
Mvaa 100,148,104
v_exp_f32 v88, v88
Mvaa 108,148,108
s_waitcnt vmcnt(17) lgkmcnt(0)
s_barrier
v_exp_f32 v89, v89
Mvaa 84,152,80
Ta 144,2,16384
Mvaa 92,152,84
Ta 146,2,18432
Mvaa 100,152,112
Ta 148,3,16384
Mvaa 108,152,116
Ta 150,3,18432
Mvaa 84,156,88
Ta 152,4,16384
Mvaa 92,156,92
L_pg13_14:
s_cbranch_execz L_ret13
Ta 154,4,18432
Mvaa 100,156,120
LD 11,52,76,3072
Mvaa 108,156,124
s_add_u32 m0, s68, 0x1b000
Ta 156,5,16384
s_add_u32 s76, s12, 0x48000
Mavv 240,40,128
Ta 158,5,18432
Mavv 244,40,132
v_exp_f32 v84, v84
Mavv 248,40,136
v_exp_f32 v85, v85
Mavv 252,40,140
v_exp_f32 v86, v86
Mvav 176,160,128
v_exp_f32 v87, v87
Mvav 184,160,132
v_exp_f32 v90, v90
Maav 176,160,136
v_exp_f32 v91, v91
Maav 184,160,140
Ta 160,2,20480
Mvav 180,164,128
Ta 162,2,22528
Mvav 188,164,132
v_exp_f32 v92, v92
Maav 180,164,136
v_exp_f32 v93, v93
Maav 188,164,140
Ta 164,3,20480
Mvav 192,168,128
Ta 166,3,22528
Mvav 200,168,132
v_exp_f32 v94, v94
Maav 192,168,136
v_exp_f32 v95, v95
Maav 200,168,140
Ta 168,4,20480
Mvav 196,172,128
Ta 170,4,22528
Mvav 204,172,132
v_exp_f32 v96, v96
Maav 196,172,136
v_exp_f32 v97, v97
Maav 204,172,140
Ta 172,5,20480
Mvav 208,128,128
Ta 174,5,22528
Mvav 216,128,132
v_exp_f32 v98, v98
Maav 208,128,136
v_exp_f32 v99, v99
Maav 216,128,140
Ta 128,2,24576
Mvav 212,132,128
Ta 130,2,26624
Mvav 220,132,132
v_exp_f32 v100, v100
Maav 212,132,136
v_exp_f32 v101, v101
Maav 220,132,140
Ta 132,3,24576
Mvav 224,136,128
Ta 134,3,26624
Mvav 232,136,132
v_exp_f32 v102, v102
Maav 224,136,136
v_exp_f32 v103, v103
Maav 232,136,140
Ta 136,4,24576
Mvav 228,140,128
Ta 138,4,26624
CV 128,80,81
Mvav 236,140,132
s_mov_b64 exec, 0
s_cmp_eq_u32 s64, 0
s_cbranch_scc1 L_pg14_15
s_cmp_eq_u32 s64, 1
s_cbranch_scc1 L_pg14_16
s_cmp_eq_u32 s64, 2
s_cbranch_scc1 L_pg14_17
s_branch L_pg14_18
L_ret14:
s_mov_b64 exec, -1
v_exp_f32 v104, v104
Maav 228,140,136
v_exp_f32 v105, v105
Maav 236,140,140
Ta 140,5,24576
CV 129,82,83
Mavv 240,40,112
Ta 142,5,26624
CV 130,84,85
Mavv 244,40,116
v_exp_f32 v106, v106
Mavv 248,40,120
LD 8,52,76,0
CV 131,86,87
Mavv 252,40,124
s_waitcnt lgkmcnt(4)
v_exp_f32 v107, v107
Mvav 176,144,112
v_exp_f32 v108, v108
Mvav 184,144,116
v_exp_f32 v109, v109
Maav 176,144,120
LD 9,52,76,1024
CV 132,88,89
Maav 184,144,124
Ta 144,2,28672
CV 133,90,91
Mvav 180,148,112
Ta 146,2,30720
CV 134,92,93
Mvav 188,148,116
v_exp_f32 v110, v110
Maav 180,148,120
v_exp_f32 v111, v111
Maav 188,148,124
Ta 148,3,28672
CV 135,94,95
Mvav 192,152,112
LD 10,52,76,2048
Ta 150,3,30720
Mvav 200,152,116
CV 136,96,97
CV 137,98,99
Maav 192,152,120
CV 138,100,101
CV 139,102,103
Maav 200,152,124
Ta 152,4,28672
CV 140,104,105
Mvav 196,156,112
Ta 154,4,30720
CV 141,106,107
Mvav 204,156,116
CV 142,108,109
CV 143,110,111
Maav 196,156,120
LD 11,52,76,3072
v_add_u32 v2, 0x9000, v2
Maav 204,156,124
s_add_u32 m0, s68, 0x1c000
s_add_u32 s76, s12, 0x51000
Ta 156,5,28672
Mvav 208,160,112
s_add_u32 s12, s66, 2
Ta 158,5,30720
v_add_u32 v3, 0x9000, v3
Mvav 216,160,116
s_and_b32 s12, s12, 7
v_add_u32 v4, 0x9000, v4
v_add_u32 v5, 0x9000, v5
Maav 208,160,120
s_lshl_b32 s12, s12, 7
Maav 216,160,124
s_add_u32 s12, s12, s74
Mvav 212,164,112
LD 8,52,76,0
Mvav 220,164,116
Maav 212,164,120
Maav 220,164,124
s_waitcnt vmcnt(14) lgkmcnt(0)
s_barrier
Mvav 224,168,112
Ta 160,2,0
Mvav 232,168,116
Ta 162,2,2048
Maav 224,168,120
LD 9,52,76,1024
Ta 164,3,0
Maav 232,168,124
Ta 166,3,2048
Mvav 228,172,112
Ta 168,4,0
Mvav 236,172,116
Ta 170,4,2048
Maav 228,172,120
Maav 236,172,124
Ta 172,5,0
Mavv 240,40,128
LD 10,52,76,2048
Ta 174,5,2048
Mavv 244,40,132
s_nop 0
Mavv 248,40,136
s_nop 0
Mavv 252,40,140
s_nop 0
v_accvgpr_read_b32 v164, a240
Mvav 176,128,128
s_nop 0
v_accvgpr_read_b32 v165, a244
Mvav 184,128,132
v_max_f32 v174, v174, v164
v_accvgpr_read_b32 v166, a248
Maav 176,128,136
LD 11,52,76,3072
v_max_f32 v174, v174, v165
Maav 184,128,140
s_add_u32 m0, s68, 0
Ta 128,2,4096
v_max_f32 v174, v174, v166
Mvav 180,132,128
s_add_u32 s76, s23, 0x48000
Ta 130,2,6144
v_accvgpr_read_b32 v167, a252
Mvav 188,132,132
v_max_f32 v174, v174, v167
v_accvgpr_read_b32 v240, a176
Maav 180,132,136
v_cmp_lt_f32 vcc, 0x53800000, v174
v_accvgpr_read_b32 v241, a177
Maav 188,132,140
Ta 132,3,4096
v_cndmask_b32 v173, 0, 1, vcc
Mvav 192,136,128
ds_write_b32 v172, v173
Mvav 200,136,132
Ta 134,3,6144
v_accvgpr_read_b32 v242, a178
Maav 192,136,136
v_rcp_f32 v164, v164
Maav 200,136,140
Ta 136,4,4096
v_mul_f32 v176, v164, v176
Mvav 196,140,128
Ta 138,4,6144
v_mul_f32 v177, v164, v177
Mvav 204,140,132
v_rcp_f32 v165, v165
Maav 196,140,136
v_mul_f32 v178, v164, v178
v_mul_f32 v179, v164, v179
Maav 204,140,140
Ta 140,5,4096
CV 176,176,177
Mvav 208,144,128
Ta 142,5,6144
v_mul_f32 v180, v164, v180
Mvav 216,144,132
v_mul_f32 v181, v164, v181
v_mul_f32 v182, v164, v182
Maav 208,144,136
v_mul_f32 v183, v164, v183
CV 177,178,179
Maav 216,144,140
Ta 144,2,8192
CV 178,180,181
Mvav 212,148,128
Ta 146,2,10240
CV 179,182,183
Mvav 220,148,132
v_mul_f32 v184, v165, v184
v_mul_f32 v185, v165, v185
Maav 212,148,136
v_mul_f32 v186, v165, v186
v_mul_f32 v187, v165, v187
Maav 220,148,140
Ta 148,3,8192
v_mul_f32 v188, v165, v188
Mvav 224,152,128
Ta 150,3,10240
v_mul_f32 v189, v165, v189
Mvav 232,152,132
v_mul_f32 v190, v165, v190
v_mul_f32 v191, v165, v191
Maav 224,152,136
CV 180,184,185
CV 181,186,187
Maav 232,152,140
Ta 152,4,8192
CV 182,188,189
Mvav 228,156,128
Ta 154,4,10240
CV 183,190,191
Mvav 236,156,132
v_mul_f32 v192, v164, v192
v_mul_f32 v193, v164, v193
Maav 228,156,136
v_mul_f32 v194, v164, v194
v_mul_f32 v195, v164, v195
Maav 236,156,140
s_waitcnt lgkmcnt(4)
Ta 156,5,8192
v_mul_f32 v196, v164, v196
v_mfma_f32_16x16x32_bf16 v[48:51], a[160:163], a[0:3], 0
Ta 158,5,10240
v_mul_f32 v197, v164, v197
v_mul_f32 v198, v164, v198
v_mfma_f32_16x16x32_bf16 v[56:59], a[160:163], a[4:7], 0
Ta 160,2,12288
v_mul_f32 v199, v164, v199
CV 184,192,193
CV 185,194,195
v_mfma_f32_16x16x32_bf16 v[52:55], a[164:167], a[0:3], 0
LD 8,52,76,0
Ta 162,2,14336
v_mfma_f32_16x16x32_bf16 v[60:63], a[164:167], a[4:7], 0
Ta 164,3,12288
CV 186,196,197
CV 187,198,199
v_mul_f32 v200, v165, v200
v_mul_f32 v201, v165, v201
v_mfma_f32_16x16x32_bf16 v[64:67], a[168:171], a[0:3], 0
Ta 166,3,14336
v_mul_f32 v202, v165, v202
v_mul_f32 v203, v165, v203
v_mul_f32 v204, v165, v204
v_mfma_f32_16x16x32_bf16 v[72:75], a[168:171], a[4:7], 0
Ta 168,4,12288
v_mul_f32 v205, v165, v205
v_mul_f32 v206, v165, v206
v_mfma_f32_16x16x32_bf16 v[68:71], a[172:175], a[0:3], 0
LD 9,52,76,1024
Ta 170,4,14336
v_mul_f32 v207, v165, v207
v_mfma_f32_16x16x32_bf16 v[76:79], a[172:175], a[4:7], 0
Ta 172,5,12288
CV 188,200,201
CV 189,202,203
CV 190,204,205
Mvaa 48,128,8
Ta 174,5,14336
CV 191,206,207
v_mul_f32 v208, v164, v208
Mvaa 56,128,12
Ta 128,2,16384
v_mul_f32 v209, v164, v209
v_mul_f32 v210, v164, v210
v_mul_f32 v211, v164, v211
Mvaa 52,132,8
Ta 130,2,18432
v_mul_f32 v212, v164, v212
v_mul_f32 v213, v164, v213
Mvaa 60,132,12
Ta 132,3,16384
v_mul_f32 v214, v164, v214
v_mul_f32 v215, v164, v215
CV 192,208,209
Mvaa 64,136,8
LD 10,52,76,2048
Ta 134,3,18432
CV 193,210,211
Mvaa 72,136,12
Ta 136,4,16384
CV 194,212,213
CV 195,214,215
Mvaa 68,140,8
Ta 138,4,18432
v_mul_f32 v216, v165, v216
v_mul_f32 v217, v165, v217
v_mul_f32 v218, v165, v218
Mvaa 76,140,12
Ta 140,5,16384
v_mul_f32 v219, v165, v219
v_mul_f32 v220, v165, v220
v_mul_f32 v221, v165, v221
Mvaa 48,144,16
Ta 142,5,18432
v_mul_f32 v222, v165, v222
v_mul_f32 v223, v165, v223
Mvaa 56,144,20
s_waitcnt lgkmcnt(5)
Ta 144,2,20480
CV 196,216,217
CV 197,218,219
CV 198,220,221
Mvaa 52,148,16
LD 11,52,76,3072
Ta 146,2,22528
s_add_u32 m0, s68, 0x1000
Mvaa 60,148,20
s_add_u32 s76, s23, 0x51000
Ta 148,3,20480
CV 199,222,223
v_mul_f32 v224, v164, v224
v_mul_f32 v225, v164, v225
Mvaa 64,152,16
s_add_u32 s23, s66, 3
Ta 150,3,22528
v_mul_f32 v226, v164, v226
v_mul_f32 v227, v164, v227
v_mul_f32 v228, v164, v228
Mvaa 72,152,20
s_and_b32 s23, s23, 7
Ta 152,4,20480
v_mul_f32 v229, v164, v229
v_mul_f32 v230, v164, v230
Mvaa 68,156,16
s_lshl_b32 s23, s23, 7
Ta 154,4,22528
v_mul_f32 v231, v164, v231
CV 200,224,225
CV 201,226,227
Mvaa 76,156,20
s_add_u32 s23, s23, s74
Ta 156,5,20480
CV 202,228,229
CV 203,230,231
v_mul_f32 v232, v165, v232
Mvaa 48,160,24
LD 8,52,76,0
Ta 158,5,22528
Mvaa 56,160,28
Ta 160,2,24576
v_mul_f32 v233, v165, v233
v_mul_f32 v234, v165, v234
v_mul_f32 v235, v165, v235
v_mul_f32 v236, v165, v236
Mvaa 52,164,24
Ta 162,2,26624
v_mul_f32 v237, v165, v237
v_mul_f32 v238, v165, v238
Mvaa 60,164,28
Ta 164,3,24576
v_mul_f32 v239, v165, v239
CV 204,232,233
CV 205,234,235
Mvaa 64,168,24
s_lshl_b32 s85, s30, 7
Ta 166,3,26624
CV 206,236,237
CV 207,238,239
v_accvgpr_read_b32 v243, a179
Mvaa 72,168,28
s_add_u32 s85, s85, 0x4000
Ta 168,4,24576
v_mov_b32 v46, s85
v_accvgpr_read_b32 v244, a180
Mvaa 68,172,24
LD 9,52,76,1024
Ta 170,4,26624
v_accvgpr_read_b32 v245, a181
Mvaa 76,172,28
s_getpc_b64 s[96:97]
Ta 172,5,24576
v_accvgpr_read_b32 v246, a182
v_rcp_f32 v166, v166
Mvaa 48,128,32
s_waitcnt lgkmcnt(4)
Ta 174,5,26624
v_accvgpr_read_b32 v247, a183
v_mul_f32 v240, v166, v240
Mvaa 56,128,36
global_load_dword v35, v46, s[96:97]
Ta 128,2,28672
v_mul_f32 v241, v166, v241
Mvaa 52,132,32
Ta 130,2,30720
v_add_u32 v2, 0x9000, v2
v_mul_f32 v242, v166, v242
Mvaa 60,132,36
Ta 132,3,28672
v_mul_f32 v243, v166, v243
v_mul_f32 v244, v166, v244
v_mul_f32 v245, v166, v245
Mvaa 64,136,32
LD 10,52,76,2048
Ta 134,3,30720
v_add_u32 v3, 0x9000, v3
Mvaa 72,136,36
Ta 136,4,28672
v_mul_f32 v246, v166, v246
v_mul_f32 v247, v166, v247
Mvaa 68,140,32
Ta 138,4,30720
v_add_u32 v4, 0x9000, v4
v_rcp_f32 v167, v167
Mvaa 76,140,36
Ta 140,5,28672
CV 208,240,241
CV 209,242,243
CV 210,244,245
Mvaa 48,144,40
Ta 142,5,30720
v_add_u32 v5, 0x9000, v5
CV 211,246,247
Mvaa 56,144,44
v_accvgpr_read_b32 v248, a184
v_accvgpr_read_b32 v249, a185
v_accvgpr_read_b32 v250, a186
v_accvgpr_read_b32 v251, a187
Mvaa 52,148,40
LD 11,52,76,3072
v_accvgpr_read_b32 v252, a188
v_accvgpr_read_b32 v253, a189
Mvaa 60,148,44
s_add_u32 m0, s68, 0x9000
v_accvgpr_read_b32 v254, a190
v_accvgpr_read_b32 v255, a191
v_mul_f32 v248, v167, v248
v_mul_f32 v249, v167, v249
Mvaa 64,152,40
s_add_u32 s76, s12, 0
v_mul_f32 v250, v167, v250
v_mul_f32 v251, v167, v251
v_mul_f32 v252, v167, v252
v_mul_f32 v253, v167, v253
Mvaa 72,152,44
s_waitcnt vmcnt(17) lgkmcnt(0)
s_barrier
v_mul_f32 v254, v167, v254
v_mul_f32 v255, v167, v255
CV 212,248,249
Mvaa 68,156,40
Ta 144,2,0
CV 213,250,251
CV 214,252,253
CV 215,254,255
Mvaa 76,156,44
Ta 146,2,2048
v_accvgpr_read_b32 v240, a192
v_accvgpr_read_b32 v241, a193
v_accvgpr_read_b32 v242, a194
Mvaa 48,160,48
Ta 148,3,0
v_accvgpr_read_b32 v243, a195
v_accvgpr_read_b32 v244, a196
Mvaa 56,160,52
Ta 150,3,2048
v_accvgpr_read_b32 v245, a197
v_accvgpr_read_b32 v246, a198
v_accvgpr_read_b32 v247, a199
Mvaa 52,164,48
Ta 152,4,0
v_mul_f32 v240, v166, v240
v_mul_f32 v241, v166, v241
Mvaa 60,164,52
Ta 154,4,2048
v_mul_f32 v242, v166, v242
v_mul_f32 v243, v166, v243
v_mul_f32 v244, v166, v244
Mvaa 64,168,48
Ta 156,5,0
v_mul_f32 v245, v166, v245
v_mul_f32 v246, v166, v246
v_mul_f32 v247, v166, v247
Mvaa 72,168,52
Ta 158,5,2048
CV 216,240,241
CV 217,242,243
Mvaa 68,172,48
Ta 160,2,4096
CV 218,244,245
CV 219,246,247
v_accvgpr_read_b32 v248, a200
Mvaa 76,172,52
Ta 162,2,6144
v_accvgpr_read_b32 v249, a201
v_accvgpr_read_b32 v250, a202
v_accvgpr_read_b32 v251, a203
Mvaa 48,128,56
Ta 164,3,4096
v_accvgpr_read_b32 v252, a204
v_accvgpr_read_b32 v253, a205
Mvaa 56,128,60
Ta 166,3,6144
v_accvgpr_read_b32 v254, a206
v_accvgpr_read_b32 v255, a207
v_mul_f32 v248, v167, v248
Mvaa 52,132,56
Ta 168,4,4096
v_mul_f32 v249, v167, v249
v_mul_f32 v250, v167, v250
Mvaa 60,132,60
Ta 170,4,6144
v_mul_f32 v251, v167, v251
v_mul_f32 v252, v167, v252
v_mul_f32 v253, v167, v253
Mvaa 64,136,56
Ta 172,5,4096
v_mul_f32 v254, v167, v254
v_mul_f32 v255, v167, v255
CV 220,248,249
Mvaa 72,136,60
Ta 174,5,6144
CV 221,250,251
CV 222,252,253
Mvaa 68,140,56
Ta 128,2,8192
CV 223,254,255
v_accvgpr_read_b32 v240, a208
v_accvgpr_read_b32 v241, a209
Mvaa 76,140,60
s_waitcnt lgkmcnt(5)
Ta 130,2,10240
v_accvgpr_read_b32 v242, a210
v_accvgpr_read_b32 v243, a211
v_accvgpr_read_b32 v244, a212
v_mfma_f32_16x16x32_bf16 v[80:83], a[144:147], a[0:3], 0
Ta 132,3,8192
v_accvgpr_read_b32 v245, a213
L_pg14_15:
s_cbranch_execz L_ret14
v_accvgpr_read_b32 v246, a214
v_mfma_f32_16x16x32_bf16 v[88:91], a[144:147], a[4:7], 0
Ta 134,3,10240
v_accvgpr_read_b32 v247, a215
v_mul_f32 v240, v166, v240
v_mul_f32 v241, v166, v241
v_mfma_f32_16x16x32_bf16 v[84:87], a[148:151], a[0:3], 0
LD 8,52,76,0
Ta 136,4,8192
v_mfma_f32_16x16x32_bf16 v[92:95], a[148:151], a[4:7], 0
Ta 138,4,10240
v_mul_f32 v242, v166, v242
v_mul_f32 v243, v166, v243
v_mul_f32 v244, v166, v244
v_mul_f32 v245, v166, v245
v_mfma_f32_16x16x32_bf16 v[96:99], a[152:155], a[0:3], 0
Ta 140,5,8192
v_mul_f32 v246, v166, v246
v_mul_f32 v247, v166, v247
CV 224,240,241
v_mfma_f32_16x16x32_bf16 v[104:107], a[152:155], a[4:7], 0
Ta 142,5,10240
CV 225,242,243
CV 226,244,245
v_mfma_f32_16x16x32_bf16 v[100:103], a[156:159], a[0:3], 0
LD 9,52,76,1024
Ta 144,2,12288
CV 227,246,247
v_mfma_f32_16x16x32_bf16 v[108:111], a[156:159], a[4:7], 0
Ta 146,2,14336
v_accvgpr_read_b32 v248, a216
v_accvgpr_read_b32 v249, a217
v_accvgpr_read_b32 v250, a218
Mvaa 80,160,8
Ta 148,3,12288
v_accvgpr_read_b32 v251, a219
v_accvgpr_read_b32 v252, a220
Mvaa 88,160,12
Ta 150,3,14336
v_accvgpr_read_b32 v253, a221
v_accvgpr_read_b32 v254, a222
v_accvgpr_read_b32 v255, a223
Mvaa 84,164,8
Ta 152,4,12288
v_mul_f32 v248, v167, v248
v_mul_f32 v249, v167, v249
Mvaa 92,164,12
s_waitcnt lgkmcnt(6)
Ta 154,4,14336
v_mul_f32 v250, v167, v250
v_mul_f32 v251, v167, v251
v_mul_f32 v252, v167, v252
Mvaa 96,168,8
LD 10,52,76,2048
Ta 156,5,12288
v_mul_f32 v253, v167, v253
Mvaa 104,168,12
Ta 158,5,14336
v_mul_f32 v254, v167, v254
v_mul_f32 v255, v167, v255
Mvaa 100,172,8
Ta 160,2,16384
CV 228,248,249
CV 229,250,251
CV 230,252,253
Mvaa 108,172,12
Ta 162,2,18432
CV 231,254,255
v_accvgpr_read_b32 v240, a224
v_accvgpr_read_b32 v241, a225
Mvaa 80,128,16
Ta 164,3,16384
v_accvgpr_read_b32 v242, a226
v_accvgpr_read_b32 v243, a227
Mvaa 88,128,20
Ta 166,3,18432
v_accvgpr_read_b32 v244, a228
v_accvgpr_read_b32 v245, a229
v_accvgpr_read_b32 v246, a230
Mvaa 84,132,16
LD 11,52,76,3072
Ta 168,4,16384
s_add_u32 m0, s68, 0xa000
Mvaa 92,132,20
s_add_u32 s76, s12, 0x9000
Ta 170,4,18432
v_accvgpr_read_b32 v247, a231
v_mul_f32 v240, v166, v240
v_mul_f32 v241, v166, v241
Mvaa 96,136,16
Ta 172,5,16384
v_mul_f32 v242, v166, v242
v_mul_f32 v243, v166, v243
v_mul_f32 v244, v166, v244
Mvaa 104,136,20
s_waitcnt lgkmcnt(6)
Ta 174,5,18432
v_mul_f32 v245, v166, v245
v_mul_f32 v246, v166, v246
Mvaa 100,140,16
Ta 128,2,20480
v_mul_f32 v247, v166, v247
CV 232,240,241
CV 233,242,243
Mvaa 108,140,20
Ta 130,2,22528
CV 234,244,245
CV 235,246,247
v_accvgpr_read_b32 v248, a232
Mvaa 80,144,24
LD 8,52,76,0
Ta 132,3,20480
Mvaa 88,144,28
Ta 134,3,22528
v_accvgpr_read_b32 v249, a233
v_accvgpr_read_b32 v250, a234
v_accvgpr_read_b32 v251, a235
v_accvgpr_read_b32 v252, a236
Mvaa 84,148,24
Ta 136,4,20480
v_accvgpr_read_b32 v253, a237
v_accvgpr_read_b32 v254, a238
Mvaa 92,148,28
Ta 138,4,22528
v_accvgpr_read_b32 v255, a239
v_mul_f32 v248, v167, v248
v_mul_f32 v249, v167, v249
Mvaa 96,152,24
Ta 140,5,20480
v_mul_f32 v250, v167, v250
v_mul_f32 v251, v167, v251
v_mul_f32 v252, v167, v252
Mvaa 104,152,28
Ta 142,5,22528
v_mul_f32 v253, v167, v253
v_mul_f32 v254, v167, v254
Mvaa 100,156,24
LD 9,52,76,1024
Ta 144,2,24576
v_mul_f32 v255, v167, v255
Mvaa 108,156,28
s_waitcnt lgkmcnt(5)
Ta 146,2,26624
CV 236,248,249
CV 237,250,251
CV 238,252,253
Mvaa 80,160,32
Ta 148,3,24576
CV 239,254,255
v_add_u32 v172, 0x24000, v7
Mvaa 88,160,36
Ta 150,3,26624
v_lshlrev_b32 v173, 7, s14
v_or_b32 v40, s5, v6
v_mov_b32 v166, 0
Mvaa 84,164,32
s_and_b32 s5, s66, 2
Ta 152,4,24576
v_mov_b32 v167, 0
Mvaa 92,164,36
s_lshl_b32 s5, s5, 5
Ta 154,4,26624
s_add_u32 s18, s18, s5
Mvaa 96,168,32
LD 10,52,76,2048
Ta 156,5,24576
Mvaa 104,168,36
s_lshl_b32 s5, s5, 5
Ta 158,5,26624
s_add_u32 s22, s22, s5
Mvaa 100,172,32
s_add_u32 s22, s22, 0x248000
Ta 160,2,28672
Mvaa 108,172,36
Ta 162,2,30720
v_add_u32 v2, 0x9000, v2
Mvaa 80,128,40
Ta 164,3,28672
Mvaa 88,128,44
s_waitcnt lgkmcnt(5)
Ta 166,3,30720
Ta 168,4,28672
v_add_u32 v3, 0x9000, v3
Mvaa 84,132,40
LD 11,52,76,3072
Ta 170,4,30720
Ta 172,5,28672
v_add_u32 v4, 0x9000, v4
Mvaa 92,132,44
s_add_u32 m0, s68, 0x12000
Ta 174,5,30720
v_add_u32 v5, 0x9000, v5
Mvaa 96,136,40
s_add_u32 s76, s12, 0x48000
ds_read_b128 v[144:147], v172
v_mov_b32 v172, 0
Mvaa 104,136,44
v_lshl_add_u32 v172, v172, 2, v173
Mvaa 100,140,40
v_add_u32 v172, 0x3010024, v172
Mvaa 108,140,44
Mvaa 80,144,48
Mvaa 88,144,52
Mvaa 84,148,48
s_waitcnt vmcnt(17) lgkmcnt(1)
s_barrier
Mvaa 92,148,52
Ta 128,2,0
s_waitcnt lgkmcnt(1)
v_or3_b32 v144, v144, v145, v146
Mvaa 96,152,48
Ta 130,2,2048
v_or_b32 v144, v144, v147
Mvaa 104,152,52
Ta 132,3,0
v_cmp_ne_u32 vcc, 0, v144
s_cbranch_vccnz L_slow
L_noslow:
v_cmp_eq_u32 vcc, 0, v168
Mvaa 100,156,48
Ta 134,3,2048
v_cndmask_b32 v162, 0, v169, vcc
v_cmp_eq_u32 vcc, 1, v168
Mvaa 108,156,52
Ta 136,4,0
v_cndmask_b32 v163, 0, v169, vcc
v_cmp_eq_u32 vcc, 0, v168
Mvaa 80,160,56
Ta 138,4,2048
v_cndmask_b32 v164, 0, v169, vcc
v_cmp_eq_u32 vcc, 1, v168
Mvaa 88,160,60
Ta 140,5,0
v_cndmask_b32 v165, 0, v169, vcc
Mvaa 84,164,56
Ta 142,5,2048
Mvaa 92,164,60
Ta 144,2,4096
Mvaa 96,168,56
Ta 146,2,6144
Mvaa 104,168,60
Ta 148,3,4096
Mvaa 100,172,56
Ta 150,3,6144
Mvaa 108,172,60
s_waitcnt lgkmcnt(8)
Ta 152,4,4096
Mvav 48,128,176
Ta 154,4,6144
Mvav 56,128,180
Ta 156,5,4096
Mvav 52,132,176
LD 8,52,76,0
Ta 158,5,6144
Mvav 60,132,180
s_waitcnt lgkmcnt(8)
Ta 160,2,8192
Mvav 64,136,176
Ta 162,2,10240
Mvav 72,136,180
Ta 164,3,8192
Mvav 68,140,176
LD 9,52,76,1024
Ta 166,3,10240
Mvav 76,140,180
s_waitcnt lgkmcnt(8)
Ta 168,4,8192
Mvav 48,144,184
Ta 170,4,10240
Mvav 56,144,188
Ta 172,5,8192
Mvav 52,148,184
Ta 174,5,10240
Mvav 60,148,188
s_waitcnt lgkmcnt(9)
Ta 128,2,12288
Mvav 64,152,184
LD 10,52,76,2048
Ta 130,2,14336
Mvav 72,152,188
s_waitcnt lgkmcnt(8)
Ta 132,3,12288
Mvav 68,156,184
Ta 134,3,14336
Mvav 76,156,188
Ta 136,4,12288
Mvav 48,160,192
Ta 138,4,14336
Mvav 56,160,196
s_waitcnt lgkmcnt(8)
Ta 140,5,12288
Mvav 52,164,192
LD 11,52,76,3072
Ta 142,5,14336
s_add_u32 m0, s68, 0x13000
s_add_u32 s76, s12, 0x51000
Mvav 60,164,196
s_add_u32 s12, s66, 4
Ta 144,2,16384
s_and_b32 s12, s12, 7
Mvav 64,168,192
s_lshl_b32 s12, s12, 7
Ta 146,2,18432
s_add_u32 s12, s12, s74
Mvav 72,168,196
s_waitcnt lgkmcnt(8)
Ta 148,3,16384
Mvav 68,172,192
Ta 150,3,18432
Mvav 76,172,196
Ta 152,4,16384
Mvav 48,128,200
LD 8,52,76,0
Ta 154,4,18432
Mvav 56,128,204
s_waitcnt lgkmcnt(8)
Ta 156,5,16384
Mvav 52,132,200
Ta 158,5,18432
Mvav 60,132,204
Ta 160,2,20480
Mvav 64,136,200
Ta 162,2,22528
Mvav 72,136,204
s_waitcnt lgkmcnt(8)
Ta 164,3,20480
Mvav 68,140,200
LD 9,52,76,1024
Ta 166,3,22528
Mvav 76,140,204
Ta 168,4,20480
Mvav 48,144,208
Ta 170,4,22528
Mvav 56,144,212
s_waitcnt lgkmcnt(9)
Ta 172,5,20480
Mvav 52,148,208
Ta 174,5,22528
Mvav 60,148,212
s_waitcnt lgkmcnt(8)
Ta 128,2,24576
Mvav 64,152,208
LD 10,52,76,2048
Ta 130,2,26624
Mvav 72,152,212
Ta 132,3,24576
Mvav 68,156,208
Ta 134,3,26624
Mvav 76,156,212
s_waitcnt lgkmcnt(9)
Ta 136,4,24576
Mvav 48,160,216
Ta 138,4,26624
Mvav 56,160,220
s_waitcnt lgkmcnt(8)
Ta 140,5,24576
Ta 142,5,26624
Mvav 52,164,216
LD 11,52,76,3072
Ta 144,2,28672
Ta 146,2,30720
v_add_u32 v2, 0xfffe5000, v2
Mvav 60,164,220
s_add_u32 m0, s68, 0x1b000
Ta 148,3,28672
Ta 150,3,30720
v_add_u32 v3, 0xfffe5000, v3
Mvav 64,168,216
s_add_u32 s76, s23, 0
Ta 152,4,28672
Ta 154,4,30720
v_add_u32 v4, 0xfffe5000, v4
Mvav 72,168,220
s_waitcnt lgkmcnt(10)
Ta 156,5,28672
Ta 158,5,30720
Mvav 68,172,216
v_add_u32 v5, 0xfffe5000, v5
Mvav 76,172,220
Mvav 48,128,224
Mvav 56,128,228
Mvav 52,132,224
Mvav 60,132,228
s_waitcnt lgkmcnt(4)
Mvav 64,136,224
s_waitcnt vmcnt(16) lgkmcnt(0)
s_barrier
Mvav 72,136,228
Ta 160,2,0
Mvav 68,140,224
Ta 162,2,2048
Mvav 76,140,228
Ta 164,3,0
Mvav 48,144,232
Ta 166,3,2048
Mvav 56,144,236
Ta 168,4,0
Ta 170,4,2048
Mvav 52,148,232
Ta 172,5,0
s_nop 1
CV 48,48,49
CV 49,50,51
CV 56,56,57
Mvav 60,148,236
Ta 174,5,2048
CV 50,52,53
CV 51,54,55
CV 57,58,59
Mvav 64,152,232
buffer_store_dwordx4 v[48:51], v7, s[40:43], s78 offen sc1
Ta 128,2,4096
Ta 130,2,6144
Mvav 72,152,236
Ta 132,3,4096
Ta 134,3,6144
Mvav 68,156,232
Ta 136,4,4096
CV 58,60,61
CV 59,62,63
CV 64,64,65
Mvav 76,156,236
s_waitcnt lgkmcnt(7)
Ta 138,4,6144
CV 65,66,67
CV 72,72,73
CV 66,68,69
Mvav 80,160,176
buffer_store_dwordx4 v[56:59], v7, s[40:43], s78 offen offset:1024 sc1
Ta 140,5,4096
Mvav 88,160,180
Ta 142,5,6144
CV 67,70,71
Mvav 84,164,176
Ta 144,2,8192
CV 73,74,75
Mvav 92,164,180
Ta 146,2,10240
CV 74,76,77
Mvav 96,168,176
s_waitcnt lgkmcnt(6)
Ta 148,3,8192
CV 75,78,79
Mvav 104,168,180
buffer_store_dwordx4 v[64:67], v7, s[40:43], s78 offen offset:2048 sc1
Ta 150,3,10240
Mvav 100,172,176
Ta 152,4,8192
Mvav 108,172,180
Ta 154,4,10240
Mvav 80,128,184
Ta 156,5,8192
Mvav 88,128,188
s_waitcnt lgkmcnt(6)
Ta 158,5,10240
Mvav 84,132,184
buffer_store_dwordx4 v[72:75], v7, s[40:43], s78 offen offset:3072 sc1
Ta 160,2,12288
Mvav 92,132,188
s_mul_i32 s78, s16, 0x11000
Ta 162,2,14336
s_add_u32 s78, s78, s13
Mvav 96,136,184
s_add_u32 s78, s78, 0xc000
Ta 164,3,12288
Mvav 104,136,188
Ta 166,3,14336
Mvav 100,140,184
s_waitcnt lgkmcnt(7)
Ta 168,4,12288
Mvav 108,140,188
LD 8,52,76,0
Ta 170,4,14336
Mvav 80,144,192
Ta 172,5,12288
Mvav 88,144,196
Ta 174,5,14336
Mvav 84,148,192
s_waitcnt lgkmcnt(8)
Ta 128,2,16384
Mvav 92,148,196
LD 9,52,76,1024
Ta 130,2,18432
Mvav 96,152,192
Ta 132,3,16384
Mvav 104,152,196
Ta 134,3,18432
Mvav 100,156,192
s_waitcnt lgkmcnt(7)
Ta 136,4,16384
Mvav 108,156,196
LD 10,52,76,2048
Ta 138,4,18432
Mvav 80,160,200
Ta 140,5,16384
Mvav 88,160,204
Ta 142,5,18432
Mvav 84,164,200
s_waitcnt lgkmcnt(7)
Ta 144,2,20480
Mvav 92,164,204
LD 11,52,76,3072
Ta 146,2,22528
Mvav 96,168,200
s_add_u32 m0, s68, 0x1c000
s_add_u32 s76, s23, 0x9000
Ta 148,3,20480
Mvav 104,168,204
Ta 150,3,22528
Mvav 100,172,200
s_waitcnt lgkmcnt(7)
Ta 152,4,20480
Mvav 108,172,204
LD 8,52,76,0
Ta 154,4,22528
Mvav 80,128,208
Ta 156,5,20480
Mvav 88,128,212
Ta 158,5,22528
Mvav 84,132,208
s_waitcnt lgkmcnt(7)
Ta 160,2,24576
Mvav 92,132,212
LD 9,52,76,1024
Ta 162,2,26624
Mvav 96,136,208
Ta 164,3,24576
Mvav 104,136,212
Ta 166,3,26624
Mvav 100,140,208
s_waitcnt lgkmcnt(7)
Ta 168,4,24576
Mvav 108,140,212
LD 10,52,76,2048
Ta 170,4,26624
Mvav 80,144,216
Ta 172,5,24576
Ta 174,5,26624
Mvav 88,144,220
Ta 128,2,28672
Mvav 84,148,216
s_waitcnt lgkmcnt(8)
Ta 130,2,30720
v_add_u32 v2, 0x9000, v2
Mvav 92,148,220
LD 11,52,76,3072
Ta 132,3,28672
Mvav 96,152,216
s_add_u32 m0, s68, 0
Ta 134,3,30720
Ta 136,4,28672
Mvav 104,152,220
s_add_u32 s76, s23, 0x48000
Ta 138,4,30720
Ta 140,5,28672
Mvav 100,156,216
Ta 142,5,30720
v_add_u32 v3, 0x9000, v3
Mvav 108,156,220
s_waitcnt lgkmcnt(11)
v_add_u32 v4, 0x9000, v4
L_pg14_16:
s_cbranch_execz L_ret14
v_add_u32 v5, 0x9000, v5
Mvav 80,160,224
Mvav 88,160,228
Mvav 84,164,224
Mvav 92,164,228
s_waitcnt lgkmcnt(6)
Mvav 96,168,224
Mvav 104,168,228
s_waitcnt vmcnt(20) lgkmcnt(0)
s_barrier
Mvav 100,172,224
Ta 144,2,0
Mvav 108,172,228
Ta 146,2,2048
Mvav 80,128,232
Ta 148,3,0
Mvav 88,128,236
Ta 150,3,2048
Mvav 84,132,232
Ta 152,4,0
Mvav 92,132,236
Ta 154,4,2048
Mvav 96,136,232
Ta 156,5,0
Mvav 104,136,236
Ta 158,5,2048
Mvav 100,140,232
Ta 160,2,4096
CV 84,84,85
Mvav 108,140,236
s_waitcnt lgkmcnt(7)
Ta 162,2,6144
CV 85,86,87
v_mfma_f32_16x16x32_bf16 v[48:51], a[144:147], a[0:3], 0
Ta 164,3,4096
CV 86,80,81
v_mfma_f32_16x16x32_bf16 v[56:59], a[144:147], a[4:7], 0
s_waitcnt lgkmcnt(7)
Ta 166,3,6144
CV 87,82,83
v_mfma_f32_16x16x32_bf16 v[52:55], a[148:151], a[0:3], 0
s_waitcnt vmcnt(8)
buffer_store_dword v47, off, s[40:43], s8 sc1
Ta 168,4,4096
v_mfma_f32_16x16x32_bf16 v[60:63], a[148:151], a[4:7], 0
s_waitcnt lgkmcnt(7)
s_lshl_b32 s8, s94, 3
Ta 170,4,6144
CV 92,92,93
v_mfma_f32_16x16x32_bf16 v[64:67], a[152:155], a[0:3], 0
buffer_store_dwordx4 v[84:87], v7, s[40:43], s79 offen sc1
Ta 172,5,4096
v_mfma_f32_16x16x32_bf16 v[72:75], a[152:155], a[4:7], 0
s_waitcnt lgkmcnt(7)
s_add_u32 s8, s8, s16
Ta 174,5,6144
CV 93,94,95
v_mfma_f32_16x16x32_bf16 v[68:71], a[156:159], a[0:3], 0
s_lshl_b32 s8, s8, 7
Ta 128,2,8192
CV 94,88,89
v_mfma_f32_16x16x32_bf16 v[76:79], a[156:159], a[4:7], 0
s_waitcnt lgkmcnt(7)
s_add_u32 s8, s8, 0x3010030
Ta 130,2,10240
CV 95,90,91
Mvaa 48,160,8
s_add_u32 s16, s66, 6
Ta 132,3,8192
CV 100,100,101
Mvaa 56,160,12
s_waitcnt lgkmcnt(7)
buffer_store_dwordx4 v[92:95], v7, s[40:43], s79 offen offset:1024 sc1
Ta 134,3,10240
Mvaa 52,164,8
s_and_b32 s16, s16, 7
Ta 136,4,8192
CV 101,102,103
Mvaa 60,164,12
s_waitcnt lgkmcnt(7)
Ta 138,4,10240
CV 102,96,97
Mvaa 64,168,8
Ta 140,5,8192
CV 103,98,99
Mvaa 72,168,12
s_waitcnt lgkmcnt(7)
Ta 142,5,10240
CV 108,108,109
Mvaa 68,172,8
buffer_store_dwordx4 v[100:103], v7, s[40:43], s79 offen offset:2048 sc1
Ta 144,2,12288
Mvaa 76,172,12
s_waitcnt lgkmcnt(7)
Ta 146,2,14336
CV 109,110,111
Mvaa 48,128,16
Ta 148,3,12288
Ta 150,3,14336
Mvaa 56,128,20
s_waitcnt lgkmcnt(8)
Ta 152,4,12288
CV 110,104,105
Mvaa 52,132,16
s_waitcnt lgkmcnt(7)
Ta 154,4,14336
CV 111,106,107
Mvaa 60,132,20
buffer_store_dwordx4 v[108:111], v7, s[40:43], s79 offen offset:3072 sc1
Ta 156,5,12288
Mvaa 64,136,16
s_mul_i32 s79, s17, 0x11000
Ta 158,5,14336
s_add_u32 s79, s79, s13
Mvaa 72,136,20
s_waitcnt lgkmcnt(8)
s_add_u32 s79, s79, 0xd000
Ta 160,2,16384
Mvaa 68,140,16
Ta 162,2,18432
Mvaa 76,140,20
s_waitcnt lgkmcnt(8)
Ta 164,3,16384
Mvaa 48,144,24
LD 8,52,76,0
Ta 166,3,18432
Mvaa 56,144,28
s_waitcnt lgkmcnt(8)
Ta 168,4,16384
Mvaa 52,148,24
Ta 170,4,18432
Mvaa 60,148,28
s_waitcnt lgkmcnt(8)
Ta 172,5,16384
Mvaa 64,152,24
LD 9,52,76,1024
Ta 174,5,18432
Mvaa 72,152,28
s_waitcnt lgkmcnt(8)
s_lshl_b32 s85, s30, 7
Ta 128,2,20480
s_add_u32 s85, s85, 0x4000
Mvaa 68,156,24
s_getpc_b64 s[96:97]
Ta 130,2,22528
v_mov_b32 v46, s85
Mvaa 76,156,28
s_waitcnt lgkmcnt(8)
Ta 132,3,20480
Mvaa 48,160,32
LD 10,52,76,2048
Ta 134,3,22528
Mvaa 56,160,36
s_waitcnt lgkmcnt(8)
Ta 136,4,20480
Mvaa 52,164,32
Ta 138,4,22528
Mvaa 60,164,36
s_waitcnt lgkmcnt(8)
Ta 140,5,20480
Mvaa 64,168,32
LD 11,52,76,3072
Ta 142,5,22528
Mvaa 72,168,36
s_waitcnt lgkmcnt(8)
s_add_u32 m0, s68, 0x1000
s_add_u32 s76, s23, 0x51000
Ta 144,2,24576
Mvaa 68,172,32
s_add_u32 s23, s66, 5
Ta 146,2,26624
s_and_b32 s23, s23, 7
Mvaa 76,172,36
s_waitcnt lgkmcnt(8)
s_lshl_b32 s23, s23, 7
Ta 148,3,24576
s_add_u32 s23, s23, s74
Mvaa 48,128,40
LD 8,52,76,0
Ta 150,3,26624
Mvaa 56,128,44
s_waitcnt lgkmcnt(8)
Ta 152,4,24576
Mvaa 52,132,40
Ta 154,4,26624
Mvaa 60,132,44
s_waitcnt lgkmcnt(8)
Ta 156,5,24576
Ta 158,5,26624
Mvaa 64,136,40
LD 9,52,76,1024
Ta 160,2,28672
Mvaa 72,136,44
s_waitcnt lgkmcnt(9)
Ta 162,2,30720
Ta 164,3,28672
Mvaa 68,140,40
Ta 166,3,30720
Ta 168,4,28672
Mvaa 76,140,44
s_waitcnt lgkmcnt(10)
Ta 170,4,30720
Ta 172,5,28672
Mvaa 48,144,48
LD 10,52,76,2048
Ta 174,5,30720
Mvaa 56,144,52
s_waitcnt lgkmcnt(11)
v_add_u32 v2, 0x9000, v2
v_add_u32 v3, 0x9000, v3
Mvaa 52,148,48
v_add_u32 v4, 0x9000, v4
v_add_u32 v5, 0x9000, v5
Mvaa 60,148,52
s_waitcnt lgkmcnt(9)
Mvaa 64,152,48
LD 11,52,76,3072
Mvaa 72,152,52
s_waitcnt lgkmcnt(7)
s_add_u32 m0, s68, 0x9000
s_add_u32 s76, s12, 0
Mvaa 68,156,48
Mvaa 76,156,52
s_waitcnt lgkmcnt(0)
s_barrier
Mvaa 48,160,56
global_load_dword v35, v46, s[96:97]
Ta 128,2,0
Ta 130,2,2048
Mvaa 56,160,60
Ta 132,3,0
Mvaa 52,164,56
Ta 134,3,2048
Mvaa 60,164,60
Ta 136,4,0
Mvaa 64,168,56
Ta 138,4,2048
Mvaa 72,168,60
Ta 140,5,0
Mvaa 68,172,56
Ta 142,5,2048
Mvaa 76,172,60
s_waitcnt lgkmcnt(6)
Ta 144,2,4096
Mvav 48,128,176
Ta 146,2,6144
Mvav 56,128,180
s_waitcnt lgkmcnt(6)
Ta 148,3,4096
Mvav 52,132,176
LD 8,52,76,0
Ta 150,3,6144
Mvav 60,132,180
s_waitcnt lgkmcnt(6)
Ta 152,4,4096
Mvav 64,136,176
Ta 154,4,6144
Mvav 72,136,180
s_waitcnt lgkmcnt(6)
Ta 156,5,4096
Mvav 68,140,176
LD 9,52,76,1024
Ta 158,5,6144
Mvav 76,140,180
s_waitcnt lgkmcnt(6)
Ta 160,2,8192
Mvav 48,144,184
Ta 162,2,10240
Mvav 56,144,188
s_waitcnt lgkmcnt(6)
Ta 164,3,8192
Mvav 52,148,184
s_waitcnt vmcnt(11)
buffer_store_dword v47, off, s[40:43], s9 sc1
Ta 166,3,10240
Mvav 60,148,188
s_waitcnt lgkmcnt(6)
s_lshl_b32 s9, s94, 3
Ta 168,4,8192
s_add_u32 s9, s9, s17
Mvav 64,152,184
LD 10,52,76,2048
Ta 170,4,10240
Mvav 72,152,188
s_waitcnt lgkmcnt(6)
s_lshl_b32 s9, s9, 7
Ta 172,5,8192
s_add_u32 s9, s9, 0x3010034
Mvav 68,156,184
s_add_u32 s17, s66, 7
Ta 174,5,10240
s_and_b32 s17, s17, 7
Mvav 76,156,188
s_waitcnt lgkmcnt(6)
Ta 128,2,12288
Mvav 48,160,192
Ta 130,2,14336
Mvav 56,160,196
s_waitcnt lgkmcnt(6)
Ta 132,3,12288
Mvav 52,164,192
LD 11,52,76,3072
Ta 134,3,14336
Mvav 60,164,196
s_waitcnt lgkmcnt(6)
s_add_u32 m0, s68, 0xa000
s_add_u32 s76, s12, 0x9000
Ta 136,4,12288
Mvav 64,168,192
Ta 138,4,14336
Mvav 72,168,196
s_waitcnt lgkmcnt(6)
Ta 140,5,12288
Mvav 68,172,192
Ta 142,5,14336
Mvav 76,172,196
s_waitcnt lgkmcnt(6)
Ta 144,2,16384
Mvav 48,128,200
LD 8,52,76,0
Ta 146,2,18432
Mvav 56,128,204
s_waitcnt lgkmcnt(6)
Ta 148,3,16384
Mvav 52,132,200
Ta 150,3,18432
Mvav 60,132,204
s_waitcnt lgkmcnt(6)
Ta 152,4,16384
Mvav 64,136,200
Ta 154,4,18432
Mvav 72,136,204
s_waitcnt lgkmcnt(6)
Ta 156,5,16384
Mvav 68,140,200
LD 9,52,76,1024
Ta 158,5,18432
Mvav 76,140,204
s_waitcnt lgkmcnt(6)
Ta 160,2,20480
Mvav 48,144,208
Ta 162,2,22528
Ta 164,3,20480
Mvav 56,144,212
s_waitcnt lgkmcnt(7)
Ta 166,3,22528
Mvav 52,148,208
Ta 168,4,20480
Mvav 60,148,212
s_waitcnt lgkmcnt(7)
Ta 170,4,22528
Mvav 64,152,208
LD 10,52,76,2048
Ta 172,5,20480
Mvav 72,152,212
s_waitcnt lgkmcnt(7)
Ta 174,5,22528
Mvav 68,156,208
Ta 128,2,24576
Mvav 76,156,212
s_waitcnt lgkmcnt(7)
Ta 130,2,26624
Mvav 48,160,216
Ta 132,3,24576
Mvav 56,160,220
s_waitcnt lgkmcnt(7)
Ta 134,3,26624
Mvav 52,164,216
LD 11,52,76,3072
Ta 136,4,24576
Mvav 60,164,220
s_waitcnt lgkmcnt(7)
s_add_u32 m0, s68, 0x12000
Ta 138,4,26624
Ta 140,5,24576
Mvav 64,168,216
s_add_u32 s76, s12, 0x48000
Ta 142,5,26624
Ta 144,2,28672
Mvav 72,168,220
s_waitcnt lgkmcnt(9)
Ta 146,2,30720
Ta 148,3,28672
Mvav 68,172,216
Ta 150,3,30720
Ta 152,4,28672
Mvav 76,172,220
s_waitcnt lgkmcnt(11)
Ta 154,4,30720
Ta 156,5,28672
Mvav 48,128,224
Ta 158,5,30720
v_add_u32 v2, 0x9000, v2
Mvav 56,128,228
s_waitcnt lgkmcnt(12)
v_add_u32 v3, 0x9000, v3
v_add_u32 v4, 0x9000, v4
Mvav 52,132,224
v_add_u32 v5, 0x9000, v5
Mvav 60,132,228
s_waitcnt lgkmcnt(9)
Mvav 64,136,224
Mvav 72,136,228
s_waitcnt lgkmcnt(7)
Mvav 68,140,224
Mvav 76,140,228
s_waitcnt lgkmcnt(0)
s_barrier
Mvav 48,144,232
Ta 160,2,0
Ta 162,2,2048
Mvav 56,144,236
Ta 164,3,0
Mvav 52,148,232
Ta 166,3,2048
Mvav 60,148,236
Ta 168,4,0
CV 48,48,49
Mvav 64,152,232
Ta 170,4,2048
CV 49,50,51
Mvav 72,152,236
Ta 172,5,0
CV 50,52,53
Mvav 68,156,232
s_waitcnt lgkmcnt(5)
Ta 174,5,2048
CV 51,54,55
Mvav 76,156,236
buffer_store_dwordx4 v[48:51], v7, s[40:43], s80 offen sc1
Ta 128,2,4096
v_mfma_f32_16x16x32_bf16 v[80:83], a[160:163], a[0:3], 0
Ta 130,2,6144
CV 56,56,57
v_mfma_f32_16x16x32_bf16 v[88:91], a[160:163], a[4:7], 0
s_waitcnt lgkmcnt(6)
Ta 132,3,4096
CV 57,58,59
v_mfma_f32_16x16x32_bf16 v[84:87], a[164:167], a[0:3], 0
Ta 134,3,6144
CV 58,60,61
v_mfma_f32_16x16x32_bf16 v[92:95], a[164:167], a[4:7], 0
s_waitcnt lgkmcnt(6)
Ta 136,4,4096
CV 59,62,63
v_mfma_f32_16x16x32_bf16 v[96:99], a[168:171], a[0:3], 0
buffer_store_dwordx4 v[56:59], v7, s[40:43], s80 offen offset:1024 sc1
Ta 138,4,6144
v_mfma_f32_16x16x32_bf16 v[104:107], a[168:171], a[4:7], 0
s_waitcnt lgkmcnt(6)
Ta 140,5,4096
CV 64,64,65
v_mfma_f32_16x16x32_bf16 v[100:103], a[172:175], a[0:3], 0
Ta 142,5,6144
CV 65,66,67
v_mfma_f32_16x16x32_bf16 v[108:111], a[172:175], a[4:7], 0
s_waitcnt lgkmcnt(6)
Ta 144,2,8192
CV 66,68,69
Mvaa 80,128,8
s_waitcnt lgkmcnt(5)
Ta 146,2,10240
Ta 148,3,8192
Mvaa 88,128,12
LD 8,52,76,0
Ta 150,3,10240
Mvaa 84,132,8
Ta 152,4,8192
CV 67,70,71
Mvaa 92,132,12
s_waitcnt lgkmcnt(7)
Ta 154,4,10240
CV 72,72,73
Mvaa 96,136,8
s_waitcnt lgkmcnt(6)
Ta 156,5,8192
CV 73,74,75
Mvaa 104,136,12
buffer_store_dwordx4 v[64:67], v7, s[40:43], s80 offen offset:2048 sc1
Ta 158,5,10240
Mvaa 100,140,8
Ta 160,2,12288
CV 74,76,77
Mvaa 108,140,12
s_waitcnt lgkmcnt(7)
Ta 162,2,14336
CV 75,78,79
Mvaa 80,144,16
Ta 164,3,12288
Mvaa 88,144,20
s_waitcnt lgkmcnt(7)
Ta 166,3,14336
Mvaa 84,148,16
buffer_store_dwordx4 v[72:75], v7, s[40:43], s80 offen offset:3072 sc1
Ta 168,4,12288
Mvaa 92,148,20
s_waitcnt lgkmcnt(7)
s_mul_i32 s80, s16, 0x11000
Ta 170,4,14336
s_add_u32 s80, s80, s13
Mvaa 96,152,16
s_add_u32 s80, s80, 0xe000
Ta 172,5,12288
Mvaa 104,152,20
s_waitcnt lgkmcnt(7)
Ta 174,5,14336
Mvaa 100,156,16
s_waitcnt lgkmcnt(6)
Ta 128,2,16384
Mvaa 108,156,20
LD 9,52,76,1024
Ta 130,2,18432
Mvaa 80,160,24
Ta 132,3,16384
Mvaa 88,160,28
s_waitcnt lgkmcnt(7)
Ta 134,3,18432
Mvaa 84,164,24
s_waitcnt lgkmcnt(6)
Ta 136,4,16384
Mvaa 92,164,28
buffer_load_dword v37, v36, s[40:43], 0 offen sc1
Ta 138,4,18432
Mvaa 96,168,24
s_waitcnt lgkmcnt(6)
Ta 140,5,16384
Mvaa 104,168,28
LD 10,52,76,2048
Ta 142,5,18432
Mvaa 100,172,24
Ta 144,2,20480
Mvaa 108,172,28
s_waitcnt lgkmcnt(7)
Ta 146,2,22528
Mvaa 80,128,32
s_waitcnt lgkmcnt(6)
Ta 148,3,20480
Mvaa 88,128,36
LD 11,52,76,3072
Ta 150,3,22528
Mvaa 84,132,32
s_add_u32 m0, s68, 0x13000
s_add_u32 s76, s12, 0x51000
Ta 152,4,20480
Mvaa 92,132,36
s_waitcnt lgkmcnt(7)
s_add_u32 s12, s66, 6
Ta 154,4,22528
s_and_b32 s12, s12, 7
Mvaa 96,136,32
s_lshl_b32 s12, s12, 7
Ta 156,5,20480
s_add_u32 s12, s12, s74
Mvaa 104,136,36
s_waitcnt lgkmcnt(7)
LD 8,52,76,0
Ta 158,5,22528
Mvaa 100,140,32
Ta 160,2,24576
Mvaa 108,140,36
s_waitcnt lgkmcnt(7)
Ta 162,2,26624
Mvaa 80,144,40
s_waitcnt lgkmcnt(6)
Ta 164,3,24576
Mvaa 88,144,44
LD 9,52,76,1024
L_pg14_17:
s_cbranch_execz L_ret14
Ta 166,3,26624
Mvaa 84,148,40
Ta 168,4,24576
Mvaa 92,148,44
s_waitcnt lgkmcnt(7)
Ta 170,4,26624
Ta 172,5,24576
Mvaa 96,152,40
s_waitcnt lgkmcnt(7)
Ta 174,5,26624
Ta 128,2,28672
Mvaa 104,152,44
LD 10,52,76,2048
Ta 130,2,30720
Mvaa 100,156,40
Ta 132,3,28672
Ta 134,3,30720
Mvaa 108,156,44
s_waitcnt lgkmcnt(10)
Ta 136,4,28672
Ta 138,4,30720
Mvaa 80,160,48
s_waitcnt lgkmcnt(10)
Ta 140,5,28672
Ta 142,5,30720
Mvaa 88,160,52
LD 11,52,76,3072
v_add_u32 v2, 0xfffe5000, v2
Mvaa 84,164,48
s_add_u32 m0, s68, 0x1b000
s_add_u32 s76, s23, 0
v_add_u32 v3, 0xfffe5000, v3
Mvaa 92,164,52
s_waitcnt lgkmcnt(9)
v_add_u32 v4, 0xfffe5000, v4
v_add_u32 v5, 0xfffe5000, v5
Mvaa 96,168,48
Mvaa 104,168,52
s_waitcnt lgkmcnt(7)
Mvaa 100,172,48
Mvaa 108,172,52
s_waitcnt vmcnt(23) lgkmcnt(0)
s_barrier
Mvaa 80,128,56
Ta 144,2,0
Ta 146,2,2048
Mvaa 88,128,60
Ta 148,3,0
Mvaa 84,132,56
Ta 150,3,2048
Mvaa 92,132,60
Ta 152,4,0
Mvaa 96,136,56
Ta 154,4,2048
Mvaa 104,136,60
Ta 156,5,0
Mvaa 100,140,56
Ta 158,5,2048
Mvaa 108,140,60
s_waitcnt lgkmcnt(6)
Ta 160,2,4096
Mvav 80,144,176
Ta 162,2,6144
Mvav 88,144,180
s_waitcnt lgkmcnt(6)
Ta 164,3,4096
Mvav 84,148,176
LD 8,52,76,0
Ta 166,3,6144
Mvav 92,148,180
s_waitcnt lgkmcnt(6)
Ta 168,4,4096
Mvav 96,152,176
Ta 170,4,6144
Mvav 104,152,180
s_waitcnt lgkmcnt(6)
Ta 172,5,4096
Mvav 100,156,176
LD 9,52,76,1024
Ta 174,5,6144
Mvav 108,156,180
s_waitcnt lgkmcnt(6)
Ta 128,2,8192
Mvav 80,160,184
Ta 130,2,10240
Mvav 88,160,188
s_waitcnt lgkmcnt(6)
Ta 132,3,8192
Mvav 84,164,184
s_waitcnt vmcnt(10)
buffer_store_dword v47, off, s[40:43], s10 sc1
Ta 134,3,10240
Mvav 92,164,188
s_waitcnt lgkmcnt(6)
s_lshl_b32 s10, s94, 3
Ta 136,4,8192
s_add_u32 s10, s10, s16
Mvav 96,168,184
LD 10,52,76,2048
Ta 138,4,10240
Mvav 104,168,188
s_lshl_b32 s10, s10, 7
Ta 140,5,8192
s_waitcnt vmcnt(10)
v_cmp_ne_u32 vcc, s98, v37
s_cbranch_vccnz L_spin11
L_pollok11:
s_waitcnt lgkmcnt(7)
Mvav 100,172,184
s_add_u32 s10, s10, 0x3010038
Ta 142,5,10240
v_and_b32 v36, 15, v1
Mvav 108,172,188
s_waitcnt lgkmcnt(6)
s_add_u32 s16, s66, 8
Ta 144,2,12288
v_min_u32 v36, 7, v36
Mvav 80,128,192
buffer_load_dwordx4 v[128:131], v39, s[40:43], s20 offen sc1
Ta 146,2,14336
Mvav 88,128,196
s_waitcnt lgkmcnt(6)
s_lshl_b32 s20, s15, 10
Ta 148,3,12288
s_add_u32 s20, s20, s13
Mvav 84,132,192
s_add_u32 s20, s20, 0x2a000
Ta 150,3,14336
v_lshlrev_b32 v37, 7, s94
Mvav 92,132,196
s_waitcnt lgkmcnt(6)
s_and_b32 s16, s16, 7
Ta 152,4,12288
v_lshl_add_u32 v36, v36, 2, v37
Mvav 96,136,192
buffer_load_dwordx4 v[132:135], v39, s[40:43], s21 offen sc1
Ta 154,4,14336
Mvav 104,136,196
s_waitcnt lgkmcnt(6)
s_lshl_b32 s21, s15, 10
Ta 156,5,12288
s_add_u32 s21, s21, s13
Mvav 100,140,192
s_add_u32 s21, s21, 0x3b000
Ta 158,5,14336
v_add_u32 v36, 0x3006000, v36
Mvav 108,140,196
s_waitcnt lgkmcnt(6)
Ta 160,2,16384
Mvav 80,144,200
buffer_load_dwordx4 v[136:139], v39, s[40:43], s20 offen sc1
Ta 162,2,18432
s_lshl_b32 s20, s15, 10
Mvav 88,144,204
s_waitcnt lgkmcnt(6)
s_add_u32 s20, s20, s13
Ta 164,3,16384
s_add_u32 s20, s20, 0x4c000
Mvav 84,148,200
Ta 166,3,18432
Mvav 92,148,204
s_waitcnt lgkmcnt(6)
Ta 168,4,16384
Mvav 96,152,200
buffer_load_dwordx4 v[140:143], v39, s[40:43], s21 offen sc1
Ta 170,4,18432
Mvav 104,152,204
s_waitcnt lgkmcnt(6)
s_lshl_b32 s21, s15, 10
Ta 172,5,16384
s_add_u32 s21, s21, s13
Mvav 100,156,200
s_add_u32 s21, s21, 0x5d000
Ta 174,5,18432
Mvav 108,156,204
s_waitcnt lgkmcnt(6)
Ta 128,2,20480
Mvav 80,160,208
buffer_load_dwordx4 v[144:147], v39, s[40:43], s20 offen sc1
Ta 130,2,22528
Mvav 88,160,212
s_waitcnt lgkmcnt(6)
s_lshl_b32 s20, s15, 10
Ta 132,3,20480
s_add_u32 s20, s20, s13
Mvav 84,164,208
s_add_u32 s20, s20, 0x6e000
Ta 134,3,22528
Mvav 92,164,212
s_waitcnt lgkmcnt(6)
Ta 136,4,20480
Mvav 96,168,208
buffer_load_dwordx4 v[148:151], v39, s[40:43], s21 offen sc1
Ta 138,4,22528
Mvav 104,168,212
s_waitcnt lgkmcnt(6)
s_lshl_b32 s21, s15, 10
Ta 140,5,20480
s_add_u32 s21, s21, s13
Mvav 100,172,208
s_add_u32 s21, s21, 0x7f000
Ta 142,5,22528
Mvav 108,172,212
s_waitcnt lgkmcnt(6)
Ta 144,2,24576
Mvav 80,128,216
buffer_load_dwordx4 v[152:155], v39, s[40:43], s20 offen sc1
Ta 146,2,26624
Mvav 88,128,220
s_waitcnt lgkmcnt(6)
s_lshl_b32 s20, s15, 10
Ta 148,3,24576
s_add_u32 s20, s20, s13
Mvav 84,132,216
s_add_u32 s20, s20, 0
Ta 150,3,26624
Mvav 92,132,220
s_waitcnt lgkmcnt(6)
Ta 152,4,24576
Ta 154,4,26624
Mvav 96,136,216
buffer_load_dwordx4 v[156:159], v39, s[40:43], s21 offen sc1
Ta 156,5,24576
Mvav 104,136,220
s_waitcnt lgkmcnt(7)
s_lshl_b32 s21, s15, 10
Ta 158,5,26624
Ta 160,2,28672
Mvav 100,140,216
s_add_u32 s21, s21, s13
Ta 162,2,30720
Ta 164,3,28672
Mvav 108,140,220
s_waitcnt lgkmcnt(9)
s_add_u32 s21, s21, 0x11000
Ta 166,3,30720
Ta 168,4,28672
Mvav 80,144,224
LD 11,52,76,3072
Ta 170,4,30720
Mvav 88,144,228
s_waitcnt lgkmcnt(10)
s_add_u32 m0, s68, 0x1c000
s_add_u32 s76, s23, 0x9000
Ta 172,5,28672
Mvav 84,148,224
Ta 174,5,30720
v_add_u32 v2, 0x9000, v2
Mvav 92,148,228
s_waitcnt lgkmcnt(10)
v_add_u32 v3, 0x9000, v3
v_add_u32 v4, 0x9000, v4
Mvav 96,152,224
LD 8,52,76,0
v_add_u32 v5, 0x9000, v5
Mvav 104,152,228
s_waitcnt lgkmcnt(8)
Mvav 100,156,224
Mvav 108,156,228
s_waitcnt lgkmcnt(5)
Mvav 80,160,232
LD 9,52,76,1024
s_waitcnt lgkmcnt(0)
s_barrier
Mvav 88,160,236
Ta 128,2,0
Ta 130,2,2048
Mvav 84,164,232
Ta 132,3,0
Mvav 92,164,236
Ta 134,3,2048
Mvav 96,168,232
LD 10,52,76,2048
Ta 136,4,0
Mvav 104,168,236
Ta 138,4,2048
CV 84,84,85
Mvav 100,172,232
Ta 140,5,0
CV 85,86,87
Mvav 108,172,236
s_waitcnt lgkmcnt(5)
Ta 142,5,2048
Ta 144,2,4096
CV 86,80,81
v_mfma_f32_16x16x32_bf16 v[48:51], a[128:131], a[0:3], 0
buffer_load_dword v173, v172, s[40:43], 0 offen sc1
Ta 146,2,6144
v_mfma_f32_16x16x32_bf16 v[56:59], a[128:131], a[4:7], 0
s_waitcnt lgkmcnt(6)
Ta 148,3,4096
Ta 150,3,6144
v_mfma_f32_16x16x32_bf16 v[52:55], a[132:135], a[0:3], 0
LD 11,52,76,3072
Ta 152,4,4096
v_mfma_f32_16x16x32_bf16 v[60:63], a[132:135], a[4:7], 0
s_waitcnt lgkmcnt(7)
s_add_u32 m0, s68, 0
s_add_u32 s76, s23, 0x48000
Ta 154,4,6144
v_mfma_f32_16x16x32_bf16 v[64:67], a[136:139], a[0:3], 0
Ta 156,5,4096
CV 87,82,83
v_mfma_f32_16x16x32_bf16 v[72:75], a[136:139], a[4:7], 0
s_waitcnt lgkmcnt(7)
Ta 158,5,6144
CV 92,92,93
v_mfma_f32_16x16x32_bf16 v[68:71], a[140:143], a[0:3], 0
buffer_store_dwordx4 v[84:87], v7, s[40:43], s81 offen sc1
Ta 160,2,8192
v_mfma_f32_16x16x32_bf16 v[76:79], a[140:143], a[4:7], 0
s_waitcnt lgkmcnt(7)
Ta 162,2,10240
CV 93,94,95
Mvaa 48,144,8
Ta 164,3,8192
CV 94,88,89
Mvaa 56,144,12
s_waitcnt lgkmcnt(7)
Ta 166,3,10240
CV 95,90,91
Mvaa 52,148,8
s_waitcnt lgkmcnt(6)
Ta 168,4,8192
CV 100,100,101
Mvaa 60,148,12
buffer_store_dwordx4 v[92:95], v7, s[40:43], s81 offen offset:1024 sc1
Ta 170,4,10240
Mvaa 64,152,8
Ta 172,5,8192
CV 101,102,103
Mvaa 72,152,12
s_waitcnt lgkmcnt(7)
Ta 174,5,10240
CV 102,96,97
Mvaa 68,156,8
Ta 128,2,12288
CV 103,98,99
Mvaa 76,156,12
s_waitcnt lgkmcnt(7)
Ta 130,2,14336
CV 108,108,109
Mvaa 48,160,16
buffer_store_dwordx4 v[100:103], v7, s[40:43], s81 offen offset:2048 sc1
Ta 132,3,12288
Mvaa 56,160,20
s_waitcnt lgkmcnt(7)
Ta 134,3,14336
CV 109,110,111
Mvaa 52,164,16
Ta 136,4,12288
CV 110,104,105
Mvaa 60,164,20
s_waitcnt lgkmcnt(7)
Ta 138,4,14336
CV 111,106,107
Mvaa 64,168,16
Ta 140,5,12288
s_waitcnt vmcnt(16)
v_lshlrev_b32 v112, 16, v128
Mvaa 72,168,20
s_waitcnt lgkmcnt(7)
buffer_store_dwordx4 v[108:111], v7, s[40:43], s81 offen offset:3072 sc1
Ta 142,5,14336
Mvaa 68,172,16
s_mul_i32 s81, s17, 0x11000
Ta 144,2,16384
v_and_b32 v113, s90, v128
Mvaa 76,172,20
s_waitcnt lgkmcnt(7)
s_add_u32 s81, s81, s13
Ta 146,2,18432
v_lshlrev_b32 v114, 16, v129
Mvaa 48,128,24
s_add_u32 s81, s81, 0xf000
Ta 148,3,16384
v_and_b32 v115, s90, v129
Mvaa 56,128,28
s_waitcnt lgkmcnt(7)
Ta 150,3,18432
v_lshlrev_b32 v116, 16, v130
Mvaa 52,132,24
LD 8,52,76,0
Ta 152,4,16384
Mvaa 60,132,28
s_waitcnt lgkmcnt(7)
Ta 154,4,18432
v_and_b32 v117, s90, v130
Mvaa 64,136,24
s_lshl_b32 s85, s30, 7
Ta 156,5,16384
v_lshlrev_b32 v118, 16, v131
Mvaa 72,136,28
s_waitcnt lgkmcnt(7)
s_add_u32 s85, s85, 0x4000
Ta 158,5,18432
v_mov_b32 v46, s85
Mvaa 68,140,24
LD 9,52,76,1024
Ta 160,2,20480
Mvaa 76,140,28
s_waitcnt lgkmcnt(7)
s_getpc_b64 s[96:97]
Ta 162,2,22528
v_and_b32 v119, s90, v131
Mvaa 48,144,32
Ta 164,3,20480
s_waitcnt vmcnt(18)
v_lshlrev_b32 v175, 16, v132
Mvaa 56,144,36
s_waitcnt lgkmcnt(7)
Ta 166,3,22528
v_add_f32 v112, v112, v175
Mvaa 52,148,32
LD 10,52,76,2048
Ta 168,4,20480
Mvaa 60,148,36
s_waitcnt lgkmcnt(7)
Ta 170,4,22528
v_lshlrev_b32 v175, 16, v133
Mvaa 64,152,32
Ta 172,5,20480
v_add_f32 v114, v114, v175
Mvaa 72,152,36
s_waitcnt lgkmcnt(7)
Ta 174,5,22528
v_lshlrev_b32 v175, 16, v134
Mvaa 68,156,32
LD 11,52,76,3072
Ta 128,2,24576
Mvaa 76,156,36
s_waitcnt lgkmcnt(7)
s_add_u32 m0, s68, 0x1000
s_add_u32 s76, s23, 0x51000
Ta 130,2,26624
Mvaa 48,160,40
s_add_u32 s23, s66, 7
Ta 132,3,24576
Ta 134,3,26624
Mvaa 56,160,44
s_waitcnt lgkmcnt(8)
s_and_b32 s23, s23, 7
Ta 136,4,24576
v_add_f32 v116, v116, v175
Mvaa 52,164,40
LD 8,52,76,0
Ta 138,4,26624
Mvaa 60,164,44
s_waitcnt lgkmcnt(8)
s_lshl_b32 s23, s23, 7
Ta 140,5,24576
Ta 142,5,26624
Mvaa 64,168,40
s_add_u32 s23, s23, s74
Ta 144,2,28672
Ta 146,2,30720
Mvaa 72,168,44
s_waitcnt lgkmcnt(10)
Ta 148,3,28672
Ta 150,3,30720
Mvaa 68,172,40
LD 9,52,76,1024
Ta 152,4,28672
Mvaa 76,172,44
s_waitcnt lgkmcnt(11)
Ta 154,4,30720
Ta 156,5,28672
Mvaa 48,128,48
Ta 158,5,30720
v_add_u32 v2, 0x9000, v2
Mvaa 56,128,52
s_waitcnt vmcnt(11)
v_cmp_ne_u32 vcc, s98, v173
s_cbranch_vccnz L_spin12
L_pollok12:
s_waitcnt lgkmcnt(11)
Mvaa 52,132,48
buffer_load_dwordx4 a[176:179], v7, s[40:43], s7 offen sc1
v_mov_b32 v172, 0
Mvaa 60,132,52
s_waitcnt lgkmcnt(9)
v_lshlrev_b32 v173, 7, s14
v_add_u32 v3, 0x9000, v3
Mvaa 64,136,48
v_lshl_add_u32 v172, v172, 2, v173
v_add_u32 v4, 0x9000, v4
Mvaa 72,136,52
s_waitcnt lgkmcnt(6)
v_add_u32 v172, 0x3010028, v172
v_add_u32 v5, 0x9000, v5
Mvaa 68,140,48
buffer_load_dwordx4 a[196:199], v7, s[40:43], s7 offen offset:1024 sc1
s_waitcnt lgkmcnt(0)
s_barrier
Mvaa 76,140,52
Ta 160,2,0
v_lshlrev_b32 v175, 16, v135
Mvaa 48,144,56
Ta 162,2,2048
v_and_b32 v132, s90, v132
Mvaa 56,144,60
Ta 164,3,0
v_and_b32 v133, s90, v133
Mvaa 52,148,56
buffer_load_dwordx4 a[216:219], v7, s[40:43], s7 offen offset:2048 sc1
Ta 166,3,2048
Mvaa 60,148,60
Ta 168,4,0
v_and_b32 v134, s90, v134
Mvaa 64,152,56
Ta 170,4,2048
v_and_b32 v135, s90, v135
Mvaa 72,152,60
s_waitcnt lgkmcnt(4)
Ta 172,5,0
v_add_f32 v113, v113, v132
Mvaa 68,156,56
buffer_load_dwordx4 a[236:239], v7, s[40:43], s7 offen offset:3072 sc1
Ta 174,5,2048
Mvaa 76,156,60
s_add_u32 s7, s19, 0xc000
Ta 128,2,4096
v_add_f32 v115, v115, v133
Mvav 48,160,176
Ta 130,2,6144
v_add_f32 v117, v117, v134
Mvav 56,160,180
s_waitcnt lgkmcnt(6)
Ta 132,3,4096
v_add_f32 v119, v119, v135
Mvav 52,164,176
buffer_load_dword v173, v172, s[40:43], 0 offen sc1
Ta 134,3,6144
Mvav 60,164,180
s_waitcnt lgkmcnt(6)
Ta 136,4,4096
v_add_f32 v118, v118, v175
Mvav 64,168,176
LD 10,52,76,2048
Ta 138,4,6144
Mvav 72,168,180
s_waitcnt lgkmcnt(6)
Ta 140,5,4096
v_lshlrev_b32 v175, 16, v136
Mvav 68,172,176
Ta 142,5,6144
v_add_f32 v112, v112, v175
Mvav 76,172,180
s_waitcnt lgkmcnt(6)
Ta 144,2,8192
v_lshlrev_b32 v175, 16, v137
Mvav 48,128,184
LD 11,52,76,3072
Ta 146,2,10240
Mvav 56,128,188
s_waitcnt lgkmcnt(6)
s_add_u32 m0, s68, 0x9000
s_add_u32 s76, s12, 0
Ta 148,3,8192
Mvav 52,132,184
Ta 150,3,10240
v_add_f32 v114, v114, v175
Mvav 60,132,188
s_waitcnt lgkmcnt(6)
Ta 152,4,8192
v_lshlrev_b32 v175, 16, v138
Mvav 64,136,184
s_waitcnt vmcnt(13)
buffer_store_dword v47, off, s[40:43], s11 sc1
Ta 154,4,10240
Mvav 72,136,188
s_waitcnt lgkmcnt(6)
s_lshl_b32 s11, s94, 3
Ta 156,5,8192
v_add_f32 v116, v116, v175
Mvav 68,140,184
global_load_dword v35, v46, s[96:97]
Ta 158,5,10240
Mvav 76,140,188
s_waitcnt lgkmcnt(6)
s_add_u32 s11, s11, s17
Ta 160,2,12288
v_lshlrev_b32 v175, 16, v139
Mvav 48,144,192
LD 8,52,76,0
Ta 162,2,14336
Mvav 56,144,196
s_waitcnt lgkmcnt(6)
s_lshl_b32 s11, s11, 7
Ta 164,3,12288
Ta 166,3,14336
Mvav 52,148,192
s_add_u32 s11, s11, 0x301003c
L_pg14_18:
s_cbranch_execz L_ret14
Ta 168,4,12288
v_and_b32 v136, s90, v136
Mvav 60,148,196
s_waitcnt lgkmcnt(7)
Ta 170,4,14336
v_and_b32 v137, s90, v137
Mvav 64,152,192
LD 9,52,76,1024
Ta 172,5,12288
Mvav 72,152,196
s_waitcnt lgkmcnt(7)
Ta 174,5,14336
v_and_b32 v138, s90, v138
Mvav 68,156,192
Ta 128,2,16384
v_and_b32 v139, s90, v139
Mvav 76,156,196
s_waitcnt lgkmcnt(7)
Ta 130,2,18432
v_add_f32 v113, v113, v136
Mvav 48,160,200
LD 10,52,76,2048
Ta 132,3,16384
Mvav 56,160,204
s_waitcnt lgkmcnt(7)
Ta 134,3,18432
v_add_f32 v115, v115, v137
Mvav 52,164,200
Ta 136,4,16384
v_add_f32 v117, v117, v138
Mvav 60,164,204
s_waitcnt lgkmcnt(7)
Ta 138,4,18432
v_add_f32 v119, v119, v139
Mvav 64,168,200
LD 11,52,76,3072
Ta 140,5,16384
Mvav 72,168,204
s_waitcnt lgkmcnt(7)
s_add_u32 m0, s68, 0xa000
s_add_u32 s76, s12, 0x9000
Ta 142,5,18432
Mvav 68,172,200
Ta 144,2,20480
v_add_f32 v118, v118, v175
Mvav 76,172,204
s_waitcnt lgkmcnt(7)
Ta 146,2,22528
v_lshlrev_b32 v175, 16, v140
Mvav 48,128,208
LD 8,52,76,0
Ta 148,3,20480
Mvav 56,128,212
s_waitcnt lgkmcnt(7)
Ta 150,3,22528
v_add_f32 v112, v112, v175
Mvav 52,132,208
Ta 152,4,20480
v_lshlrev_b32 v175, 16, v141
Mvav 60,132,212
s_waitcnt lgkmcnt(7)
Ta 154,4,22528
v_add_f32 v114, v114, v175
Mvav 64,136,208
LD 9,52,76,1024
Ta 156,5,20480
Mvav 72,136,212
s_waitcnt lgkmcnt(7)
Ta 158,5,22528
v_lshlrev_b32 v175, 16, v142
Mvav 68,140,208
Ta 160,2,24576
v_add_f32 v116, v116, v175
Mvav 76,140,212
s_waitcnt lgkmcnt(7)
Ta 162,2,26624
v_lshlrev_b32 v175, 16, v143
Mvav 48,144,216
s_mov_b64 exec, 0
s_cmp_eq_u32 s64, 0
s_cbranch_scc1 L_pg15_19
s_cmp_eq_u32 s64, 1
s_cbranch_scc1 L_pg15_20
s_cmp_eq_u32 s64, 2
s_cbranch_scc1 L_pg15_21
s_branch L_ret15
L_ret15:
s_mov_b64 exec, -1
LD 10,52,76,2048
Ta 164,3,24576
Mvav 56,144,220
s_waitcnt lgkmcnt(7)
Ta 166,3,26624
v_and_b32 v140, s90, v140
Mvav 52,148,216
Ta 168,4,24576
v_and_b32 v141, s90, v141
Mvav 60,148,220
s_waitcnt lgkmcnt(7)
Ta 170,4,26624
Ta 172,5,24576
Mvav 64,152,216
LD 11,52,76,3072
Ta 174,5,26624
Mvav 72,152,220
s_waitcnt lgkmcnt(8)
s_add_u32 m0, s68, 0x12000
Ta 128,2,28672
Ta 130,2,30720
Mvav 68,156,216
s_add_u32 s76, s12, 0x48000
Ta 132,3,28672
Ta 134,3,30720
Mvav 76,156,220
s_waitcnt lgkmcnt(10)
Ta 136,4,28672
Ta 138,4,30720
Mvav 48,160,224
Ta 140,5,28672
Ta 142,5,30720
Mvav 56,160,228
s_waitcnt lgkmcnt(12)
v_add_u32 v2, 0x9000, v2
v_add_u32 v3, 0x9000, v3
Mvav 52,164,224
v_add_u32 v4, 0x9000, v4
v_add_u32 v5, 0x9000, v5
Mvav 60,164,228
s_waitcnt vmcnt(12)
v_cmp_ne_u32 vcc, s98, v173
s_cbranch_vccnz L_spin13
L_pollok13:
s_waitcnt lgkmcnt(9)
Mvav 64,168,224
buffer_load_dwordx4 a[180:183], v7, s[40:43], s4 offen sc1
v_and_b32 v142, s90, v142
Mvav 72,168,228
s_waitcnt lgkmcnt(7)
v_and_b32 v143, s90, v143
v_add_f32 v113, v113, v140
Mvav 68,172,224
v_add_f32 v115, v115, v141
v_add_f32 v117, v117, v142
Mvav 76,172,228
s_waitcnt lgkmcnt(0)
s_barrier
v_add_f32 v119, v119, v143
v_add_f32 v118, v118, v175
Mvav 48,128,232
buffer_load_dwordx4 a[200:203], v7, s[40:43], s4 offen offset:1024 sc1
Ta 144,2,0
Ta 146,2,2048
Mvav 56,128,236
Ta 148,3,0
v_lshlrev_b32 v175, 16, v144
Mvav 52,132,232
Ta 150,3,2048
CV 48,48,49
Mvav 60,132,236
Ta 152,4,0
CV 49,50,51
Mvav 64,136,232
buffer_load_dwordx4 a[220:223], v7, s[40:43], s4 offen offset:2048 sc1
Ta 154,4,2048
Mvav 72,136,236
Ta 156,5,0
CV 50,52,53
Mvav 68,140,232
Ta 158,5,2048
CV 51,54,55
Mvav 76,140,236
s_waitcnt lgkmcnt(6)
Ta 160,2,4096
CV 56,56,57
v_mfma_f32_16x16x32_bf16 v[80:83], a[144:147], a[0:3], 0
buffer_store_dwordx4 v[48:51], v7, s[40:43], s78 offen sc1
Ta 162,2,6144
v_mfma_f32_16x16x32_bf16 v[88:91], a[144:147], a[4:7], 0
s_waitcnt lgkmcnt(6)
Ta 164,3,4096
CV 57,58,59
v_mfma_f32_16x16x32_bf16 v[84:87], a[148:151], a[0:3], 0
Ta 166,3,6144
CV 58,60,61
v_mfma_f32_16x16x32_bf16 v[92:95], a[148:151], a[4:7], 0
s_waitcnt lgkmcnt(6)
Ta 168,4,4096
CV 59,62,63
v_mfma_f32_16x16x32_bf16 v[96:99], a[152:155], a[0:3], 0
s_waitcnt lgkmcnt(5)
Ta 170,4,6144
CV 64,64,65
v_mfma_f32_16x16x32_bf16 v[104:107], a[152:155], a[4:7], 0
buffer_store_dwordx4 v[56:59], v7, s[40:43], s78 offen offset:1024 sc1
Ta 172,5,4096
v_mfma_f32_16x16x32_bf16 v[100:103], a[156:159], a[0:3], 0
Ta 174,5,6144
CV 65,66,67
v_mfma_f32_16x16x32_bf16 v[108:111], a[156:159], a[4:7], 0
s_waitcnt lgkmcnt(6)
Ta 128,2,8192
CV 66,68,69
Mvaa 80,160,8
Ta 130,2,10240
CV 67,70,71
Mvaa 88,160,12
s_waitcnt lgkmcnt(6)
Ta 132,3,8192
CV 72,72,73
Mvaa 84,164,8
buffer_store_dwordx4 v[64:67], v7, s[40:43], s78 offen offset:2048 sc1
Ta 134,3,10240
Mvaa 92,164,12
s_waitcnt lgkmcnt(6)
Ta 136,4,8192
CV 73,74,75
Mvaa 96,168,8
Ta 138,4,10240
CV 74,76,77
Mvaa 104,168,12
s_waitcnt lgkmcnt(6)
Ta 140,5,8192
CV 75,78,79
Mvaa 100,172,8
s_waitcnt lgkmcnt(5)
Ta 142,5,10240
v_add_f32 v112, v112, v175
Mvaa 108,172,12
buffer_store_dwordx4 v[72:75], v7, s[40:43], s78 offen offset:3072 sc1
Ta 144,2,12288
Mvaa 80,128,16
s_mul_i32 s78, s16, 0x11000
Ta 146,2,14336
v_lshlrev_b32 v175, 16, v145
Mvaa 88,128,20
s_waitcnt lgkmcnt(6)
s_add_u32 s78, s78, s13
Ta 148,3,12288
v_add_f32 v114, v114, v175
Mvaa 84,132,16
s_add_u32 s78, s78, 0x10000
Ta 150,3,14336
v_lshlrev_b32 v175, 16, v146
Mvaa 92,132,20
s_waitcnt lgkmcnt(6)
Ta 152,4,12288
v_add_f32 v116, v116, v175
Mvaa 96,136,16
buffer_load_dwordx4 a[240:243], v7, s[40:43], s4 offen offset:3072 sc1
Ta 154,4,14336
Mvaa 104,136,20
s_waitcnt lgkmcnt(6)
s_add_u32 s4, s19, 0xd000
Ta 156,5,12288
v_lshlrev_b32 v175, 16, v147
Mvaa 100,140,16
Ta 158,5,14336
v_and_b32 v144, s90, v144
Mvaa 108,140,20
s_waitcnt lgkmcnt(6)
Ta 160,2,16384
v_and_b32 v145, s90, v145
Mvaa 80,144,24
buffer_load_dword v37, v36, s[40:43], 0 offen sc1
Ta 162,2,18432
Mvaa 88,144,28
s_waitcnt lgkmcnt(6)
Ta 164,3,16384
v_and_b32 v146, s90, v146
Mvaa 84,148,24
LD 8,52,76,0
Ta 166,3,18432
Mvaa 92,148,28
s_waitcnt lgkmcnt(6)
Ta 168,4,16384
v_and_b32 v147, s90, v147
Mvaa 96,152,24
Ta 170,4,18432
v_add_f32 v113, v113, v144
Mvaa 104,152,28
s_waitcnt lgkmcnt(6)
Ta 172,5,16384
v_add_f32 v115, v115, v145
Mvaa 100,156,24
LD 9,52,76,1024
Ta 174,5,18432
Mvaa 108,156,28
s_waitcnt lgkmcnt(6)
Ta 128,2,20480
v_add_f32 v117, v117, v146
Mvaa 80,160,32
Ta 130,2,22528
Ta 132,3,20480
Mvaa 88,160,36
s_waitcnt lgkmcnt(7)
Ta 134,3,22528
v_add_f32 v119, v119, v147
Mvaa 84,164,32
LD 10,52,76,2048
Ta 136,4,20480
Mvaa 92,164,36
s_waitcnt lgkmcnt(7)
Ta 138,4,22528
v_add_f32 v118, v118, v175
Mvaa 96,168,32
Ta 140,5,20480
v_lshlrev_b32 v175, 16, v148
Mvaa 104,168,36
s_waitcnt lgkmcnt(7)
Ta 142,5,22528
v_add_f32 v112, v112, v175
Mvaa 100,172,32
LD 11,52,76,3072
Ta 144,2,24576
Mvaa 108,172,36
s_waitcnt lgkmcnt(7)
s_add_u32 m0, s68, 0x13000
s_add_u32 s76, s12, 0x51000
Ta 146,2,26624
Mvaa 80,128,40
s_add_u32 s12, s66, 8
Ta 148,3,24576
v_lshlrev_b32 v175, 16, v149
Mvaa 88,128,44
s_waitcnt lgkmcnt(7)
s_and_b32 s12, s12, 7
Ta 150,3,26624
v_add_f32 v114, v114, v175
Mvaa 84,132,40
LD 8,52,76,0
Ta 152,4,24576
Mvaa 92,132,44
s_waitcnt lgkmcnt(7)
s_lshl_b32 s12, s12, 7
Ta 154,4,26624
Ta 156,5,24576
Mvaa 96,136,40
s_add_u32 s12, s12, s74
Ta 158,5,26624
Ta 160,2,28672
Mvaa 104,136,44
s_waitcnt lgkmcnt(9)
Ta 162,2,30720
Ta 164,3,28672
Mvaa 100,140,40
LD 9,52,76,1024
Ta 166,3,30720
Mvaa 108,140,44
s_waitcnt lgkmcnt(10)
Ta 168,4,28672
Ta 170,4,30720
Mvaa 80,144,48
Ta 172,5,28672
Ta 174,5,30720
Mvaa 88,144,52
s_waitcnt lgkmcnt(12)
v_add_u32 v2, 0xfffe5000, v2
v_add_u32 v3, 0xfffe5000, v3
Mvaa 84,148,48
LD 10,52,76,2048
v_add_u32 v4, 0xfffe5000, v4
Mvaa 92,148,52
s_waitcnt lgkmcnt(9)
v_add_u32 v5, 0xfffe5000, v5
v_lshlrev_b32 v175, 16, v150
Mvaa 96,152,48
v_add_f32 v116, v116, v175
v_lshlrev_b32 v175, 16, v151
Mvaa 104,152,52
s_waitcnt lgkmcnt(7)
v_and_b32 v148, s90, v148
v_and_b32 v149, s90, v149
Mvaa 100,156,48
LD 11,52,76,3072
s_waitcnt vmcnt(27) lgkmcnt(0)
s_barrier
Mvaa 108,156,52
s_add_u32 m0, s68, 0x1b000
s_add_u32 s76, s23, 0
Ta 128,2,0
Mvaa 80,160,56
Ta 130,2,2048
v_and_b32 v150, s90, v150
Mvaa 88,160,60
Ta 132,3,0
v_and_b32 v151, s90, v151
Mvaa 84,164,56
Ta 134,3,2048
v_add_f32 v113, v113, v148
Mvaa 92,164,60
Ta 136,4,0
v_add_f32 v115, v115, v149
Mvaa 96,168,56
Ta 138,4,2048
v_add_f32 v117, v117, v150
Mvaa 104,168,60
Ta 140,5,0
v_add_f32 v119, v119, v151
Mvaa 100,172,56
Ta 142,5,2048
v_add_f32 v118, v118, v175
Mvaa 108,172,60
s_waitcnt lgkmcnt(6)
Ta 144,2,4096
v_lshlrev_b32 v175, 16, v152
Mvav 80,128,176
Ta 146,2,6144
v_add_f32 v112, v112, v175
Mvav 88,128,180
s_waitcnt lgkmcnt(6)
Ta 148,3,4096
v_lshlrev_b32 v175, 16, v153
Mvav 84,132,176
LD 8,52,76,0
Ta 150,3,6144
Mvav 92,132,180
s_waitcnt lgkmcnt(6)
Ta 152,4,4096
v_add_f32 v114, v114, v175
Mvav 96,136,176
Ta 154,4,6144
v_lshlrev_b32 v175, 16, v154
Mvav 104,136,180
s_waitcnt lgkmcnt(6)
Ta 156,5,4096
v_add_f32 v116, v116, v175
Mvav 100,140,176
s_waitcnt vmcnt(11)
buffer_store_dword v47, off, s[40:43], s8 sc1
Ta 158,5,6144
Mvav 108,140,180
s_waitcnt lgkmcnt(6)
s_lshl_b32 s8, s94, 3
Ta 160,2,8192
v_lshlrev_b32 v175, 16, v155
Mvav 80,144,184
LD 9,52,76,1024
Ta 162,2,10240
s_waitcnt vmcnt(11)
v_cmp_ne_u32 vcc, s98, v37
s_cbranch_vccnz L_spin14
L_pollok14:
Mvav 88,144,188
s_waitcnt lgkmcnt(6)
s_add_u32 s8, s8, s16
Ta 164,3,8192
v_and_b32 v152, s90, v152
Mvav 84,148,184
s_lshl_b32 s8, s8, 7
Ta 166,3,10240
v_and_b32 v153, s90, v153
Mvav 92,148,188
s_waitcnt lgkmcnt(6)
s_add_u32 s8, s8, 0x3010040
Ta 168,4,8192
buffer_load_dwordx4 v[128:131], v39, s[40:43], s20 offen sc1
Mvav 96,152,184
s_lshl_b32 s20, s15, 10
Ta 170,4,10240
s_add_u32 s20, s20, s13
Mvav 104,152,188
s_waitcnt lgkmcnt(6)
s_add_u32 s20, s20, 0x22000
Ta 172,5,8192
v_and_b32 v154, s90, v154
Mvav 100,156,184
s_waitcnt lgkmcnt(5)
Ta 174,5,10240
v_and_b32 v155, s90, v155
Mvav 108,156,188
buffer_load_dwordx4 v[132:135], v39, s[40:43], s21 offen sc1
Ta 128,2,12288
Mvav 80,160,192
s_lshl_b32 s21, s15, 10
Ta 130,2,14336
s_add_u32 s21, s21, s13
Mvav 88,160,196
s_waitcnt lgkmcnt(6)
s_add_u32 s21, s21, 0x33000
Ta 132,3,12288
v_add_f32 v113, v113, v152
Mvav 84,164,192
s_waitcnt lgkmcnt(5)
Ta 134,3,14336
v_add_f32 v115, v115, v153
Mvav 92,164,196
buffer_load_dwordx4 v[136:139], v39, s[40:43], s20 offen sc1
Ta 136,4,12288
Mvav 96,168,192
s_lshl_b32 s20, s15, 10
Ta 138,4,14336
s_add_u32 s20, s20, s13
Mvav 104,168,196
s_waitcnt lgkmcnt(6)
s_add_u32 s20, s20, 0x44000
Ta 140,5,12288
v_add_f32 v117, v117, v154
Mvav 100,172,192
s_waitcnt lgkmcnt(5)
Ta 142,5,14336
v_add_f32 v119, v119, v155
Mvav 108,172,196
buffer_load_dwordx4 v[140:143], v39, s[40:43], s21 offen sc1
Ta 144,2,16384
Mvav 80,128,200
s_lshl_b32 s21, s15, 10
Ta 146,2,18432
s_add_u32 s21, s21, s13
Mvav 88,128,204
s_waitcnt lgkmcnt(6)
s_add_u32 s21, s21, 0x55000
Ta 148,3,16384
v_add_f32 v118, v118, v175
Mvav 84,132,200
s_waitcnt lgkmcnt(5)
Ta 150,3,18432
v_lshlrev_b32 v175, 16, v156
Mvav 92,132,204
buffer_load_dwordx4 v[144:147], v39, s[40:43], s20 offen sc1
Ta 152,4,16384
Mvav 96,136,200
s_lshl_b32 s20, s15, 10
Ta 154,4,18432
s_add_u32 s20, s20, s13
Mvav 104,136,204
s_waitcnt lgkmcnt(6)
s_add_u32 s20, s20, 0x66000
Ta 156,5,16384
v_add_f32 v112, v112, v175
Mvav 100,140,200
s_waitcnt lgkmcnt(5)
Ta 158,5,18432
v_lshlrev_b32 v175, 16, v157
Mvav 108,140,204
buffer_load_dwordx4 v[148:151], v39, s[40:43], s21 offen sc1
Ta 160,2,20480
Mvav 80,144,208
s_lshl_b32 s21, s15, 10
Ta 162,2,22528
s_add_u32 s21, s21, s13
Mvav 88,144,212
s_waitcnt lgkmcnt(6)
s_add_u32 s21, s21, 0x77000
Ta 164,3,20480
v_add_f32 v114, v114, v175
Mvav 84,148,208
s_waitcnt lgkmcnt(5)
Ta 166,3,22528
v_lshlrev_b32 v175, 16, v158
Mvav 92,148,212
buffer_load_dwordx4 v[152:155], v39, s[40:43], s20 offen sc1
Ta 168,4,20480
Mvav 96,152,208
Ta 170,4,22528
v_add_f32 v116, v116, v175
Mvav 104,152,212
s_waitcnt lgkmcnt(6)
Ta 172,5,20480
v_lshlrev_b32 v175, 16, v159
Mvav 100,156,208
s_waitcnt lgkmcnt(5)
Ta 174,5,22528
v_and_b32 v156, s90, v156
Mvav 108,156,212
LD 10,52,76,2048
Ta 128,2,24576
Mvav 80,160,216
Ta 130,2,26624
v_and_b32 v157, s90, v157
Mvav 88,160,220
s_waitcnt lgkmcnt(6)
Ta 132,3,24576
v_and_b32 v158, s90, v158
Mvav 84,164,216
s_waitcnt lgkmcnt(5)
Ta 134,3,26624
v_and_b32 v159, s90, v159
Mvav 92,164,220
LD 11,52,76,3072
Ta 136,4,24576
Mvav 96,168,216
s_add_u32 m0, s68, 0x1c000
s_add_u32 s76, s23, 0x9000
Ta 138,4,26624
Mvav 104,168,220
s_waitcnt lgkmcnt(6)
Ta 140,5,24576
Ta 142,5,26624
Mvav 100,172,216
s_waitcnt lgkmcnt(6)
Ta 144,2,28672
Ta 146,2,30720
Mvav 108,172,220
LD 8,52,76,0
Ta 148,3,28672
Mvav 80,128,224
Ta 150,3,30720
Ta 152,4,28672
Mvav 88,128,228
s_waitcnt lgkmcnt(9)
Ta 154,4,30720
Ta 156,5,28672
Mvav 84,132,224
s_waitcnt lgkmcnt(9)
Ta 158,5,30720
v_add_f32 v113, v113, v156
Mvav 92,132,228
LD 9,52,76,1024
v_add_f32 v115, v115, v157
Mvav 96,136,224
v_add_f32 v117, v117, v158
v_add_f32 v119, v119, v159
Mvav 104,136,228
s_waitcnt lgkmcnt(8)
v_mov_b32 v172, 0
v_lshlrev_b32 v173, 7, s14
L_pg15_19:
s_cbranch_execz L_ret15
Mvav 100,140,224
s_waitcnt lgkmcnt(6)
v_lshl_add_u32 v172, v172, 2, v173
v_add_u32 v2, 0x9000, v2
Mvav 108,140,228
buffer_load_dwordx4 v[156:159], v39, s[40:43], s21 offen sc1
v_add_u32 v172, 0x301002c, v172
Mvav 80,144,232
v_add_u32 v3, 0x9000, v3
v_add_u32 v4, 0x9000, v4
Mvav 88,144,236
s_waitcnt lgkmcnt(0)
s_barrier
v_add_u32 v5, 0x9000, v5
v_add_f32 v118, v118, v175
Mvav 84,148,232
Ta 160,2,0
Ta 162,2,2048
Mvav 92,148,236
LD 10,52,76,2048
Ta 164,3,0
Mvav 96,152,232
Ta 166,3,2048
Ta 168,4,0
Mvav 104,152,236
Ta 170,4,2048
CV 84,84,85
Mvav 100,156,232
s_waitcnt lgkmcnt(4)
Ta 172,5,0
Ta 174,5,2048
Mvav 108,156,236
LD 11,52,76,3072
Ta 128,2,4096
s_add_u32 m0, s68, 0
s_add_u32 s76, s23, 0x48000
Ta 130,2,6144
v_mfma_f32_16x16x32_bf16 v[48:51], a[160:163], a[0:3], 0
Ta 132,3,4096
CV 85,86,87
v_mfma_f32_16x16x32_bf16 v[56:59], a[160:163], a[4:7], 0
s_waitcnt lgkmcnt(7)
Ta 134,3,6144
CV 86,80,81
v_mfma_f32_16x16x32_bf16 v[52:55], a[164:167], a[0:3], 0
buffer_load_dword v173, v172, s[40:43], 0 offen sc1
Ta 136,4,4096
v_mfma_f32_16x16x32_bf16 v[60:63], a[164:167], a[4:7], 0
s_waitcnt lgkmcnt(7)
Ta 138,4,6144
CV 87,82,83
v_mfma_f32_16x16x32_bf16 v[64:67], a[168:171], a[0:3], 0
buffer_store_dwordx4 v[84:87], v7, s[40:43], s79 offen sc1
Ta 140,5,4096
v_mfma_f32_16x16x32_bf16 v[72:75], a[168:171], a[4:7], 0
s_waitcnt lgkmcnt(7)
Ta 142,5,6144
CV 92,92,93
v_mfma_f32_16x16x32_bf16 v[68:71], a[172:175], a[0:3], 0
Ta 144,2,8192
CV 93,94,95
v_mfma_f32_16x16x32_bf16 v[76:79], a[172:175], a[4:7], 0
s_waitcnt lgkmcnt(7)
Ta 146,2,10240
CV 94,88,89
Mvaa 48,128,8
s_waitcnt lgkmcnt(6)
Ta 148,3,8192
CV 95,90,91
Mvaa 56,128,12
buffer_store_dwordx4 v[92:95], v7, s[40:43], s79 offen offset:1024 sc1
Ta 150,3,10240
Mvaa 52,132,8
Ta 152,4,8192
CV 100,100,101
Mvaa 60,132,12
s_waitcnt lgkmcnt(7)
Ta 154,4,10240
CV 101,102,103
Mvaa 64,136,8
Ta 156,5,8192
CV 102,96,97
Mvaa 72,136,12
s_waitcnt lgkmcnt(7)
Ta 158,5,10240
CV 103,98,99
Mvaa 68,140,8
buffer_store_dwordx4 v[100:103], v7, s[40:43], s79 offen offset:2048 sc1
Ta 160,2,12288
Mvaa 76,140,12
s_waitcnt lgkmcnt(7)
Ta 162,2,14336
CV 108,108,109
Mvaa 48,144,16
Ta 164,3,12288
CV 109,110,111
Mvaa 56,144,20
s_waitcnt lgkmcnt(7)
Ta 166,3,14336
CV 110,104,105
Mvaa 52,148,16
s_waitcnt lgkmcnt(6)
Ta 168,4,12288
CV 111,106,107
Mvaa 60,148,20
buffer_store_dwordx4 v[108:111], v7, s[40:43], s79 offen offset:3072 sc1
Ta 170,4,14336
Mvaa 64,152,16
Ta 172,5,12288
s_waitcnt vmcnt(18)
v_lshlrev_b32 v120, 16, v128
Mvaa 72,152,20
s_waitcnt lgkmcnt(7)
Ta 174,5,14336
v_and_b32 v121, s90, v128
Mvaa 68,156,16
Ta 128,2,16384
v_lshlrev_b32 v122, 16, v129
Mvaa 76,156,20
s_waitcnt lgkmcnt(7)
Ta 130,2,18432
v_and_b32 v123, s90, v129
Mvaa 48,160,24
LD 8,52,76,0
Ta 132,3,16384
Mvaa 56,160,28
s_waitcnt lgkmcnt(7)
Ta 134,3,18432
Ta 136,4,16384
Mvaa 52,164,24
Ta 138,4,18432
v_lshlrev_b32 v124, 16, v130
Mvaa 60,164,28
s_waitcnt lgkmcnt(8)
Ta 140,5,16384
v_and_b32 v125, s90, v130
Mvaa 64,168,24
LD 9,52,76,1024
Ta 142,5,18432
Mvaa 72,168,28
s_waitcnt lgkmcnt(8)
s_lshl_b32 s85, s30, 7
Ta 144,2,20480
v_lshlrev_b32 v126, 16, v131
Mvaa 68,172,24
s_add_u32 s85, s85, 0x4000
Ta 146,2,22528
v_mov_b32 v46, s85
Mvaa 76,172,28
s_waitcnt lgkmcnt(8)
s_getpc_b64 s[96:97]
Ta 148,3,20480
v_and_b32 v127, s90, v131
Mvaa 48,128,32
LD 10,52,76,2048
Ta 150,3,22528
Mvaa 56,128,36
Ta 152,4,20480
s_waitcnt vmcnt(20)
s_waitcnt lgkmcnt(9)
v_lshlrev_b32 v175, 16, v132
Mvaa 52,132,32
Ta 154,4,22528
v_add_f32 v120, v120, v175
Mvaa 60,132,36
s_waitcnt lgkmcnt(8)
Ta 156,5,20480
v_lshlrev_b32 v175, 16, v133
Mvaa 64,136,32
LD 11,52,76,3072
Ta 158,5,22528
Mvaa 72,136,36
s_waitcnt lgkmcnt(8)
s_add_u32 m0, s68, 0x1000
s_add_u32 s76, s23, 0x51000
Ta 160,2,24576
Mvaa 68,140,32
Ta 162,2,26624
v_add_f32 v122, v122, v175
Mvaa 76,140,36
s_waitcnt lgkmcnt(8)
Ta 164,3,24576
v_lshlrev_b32 v175, 16, v134
Mvaa 48,144,40
LD 8,52,76,0
Ta 166,3,26624
Mvaa 56,144,44
s_waitcnt lgkmcnt(8)
Ta 168,4,24576
v_add_f32 v124, v124, v175
Mvaa 52,148,40
Ta 170,4,26624
v_lshlrev_b32 v175, 16, v135
Mvaa 60,148,44
s_waitcnt lgkmcnt(8)
Ta 172,5,24576
Ta 174,5,26624
Mvaa 64,152,40
LD 9,52,76,1024
Ta 128,2,28672
Mvaa 72,152,44
s_waitcnt lgkmcnt(9)
Ta 130,2,30720
Ta 132,3,28672
Mvaa 68,156,40
Ta 134,3,30720
Ta 136,4,28672
Mvaa 76,156,44
s_waitcnt lgkmcnt(10)
Ta 138,4,30720
Ta 140,5,28672
Mvaa 48,160,48
LD 10,52,76,2048
Ta 142,5,30720
Mvaa 56,160,52
s_waitcnt lgkmcnt(11)
v_add_u32 v2, 0x9000, v2
v_add_u32 v3, 0x9000, v3
Mvaa 52,164,48
v_add_u32 v4, 0x9000, v4
v_add_u32 v5, 0x9000, v5
Mvaa 60,164,52
s_waitcnt vmcnt(11)
v_cmp_ne_u32 vcc, s98, v173
s_cbranch_vccnz L_spin15
L_pollok15:
s_waitcnt lgkmcnt(9)
Mvaa 64,168,48
buffer_load_dwordx4 a[184:187], v7, s[40:43], s6 offen sc1
v_mov_b32 v172, 0
Mvaa 72,168,52
s_waitcnt lgkmcnt(7)
v_lshlrev_b32 v173, 7, s14
v_add_f32 v126, v126, v175
Mvaa 68,172,48
v_lshl_add_u32 v172, v172, 2, v173
v_lshlrev_b32 v175, 16, v136
Mvaa 76,172,52
s_waitcnt lgkmcnt(0)
s_barrier
v_add_u32 v172, 0x3010030, v172
v_add_f32 v120, v120, v175
Mvaa 48,128,56
buffer_load_dwordx4 a[204:207], v7, s[40:43], s6 offen offset:1024 sc1
Ta 144,2,0
Mvaa 56,128,60
Ta 146,2,2048
v_lshlrev_b32 v175, 16, v137
Mvaa 52,132,56
Ta 148,3,0
v_add_f32 v122, v122, v175
Mvaa 60,132,60
Ta 150,3,2048
v_lshlrev_b32 v175, 16, v138
Mvaa 64,136,56
buffer_load_dwordx4 a[224:227], v7, s[40:43], s6 offen offset:2048 sc1
Ta 152,4,0
Mvaa 72,136,60
Ta 154,4,2048
v_add_f32 v124, v124, v175
Mvaa 68,140,56
Ta 156,5,0
v_lshlrev_b32 v175, 16, v139
Mvaa 76,140,60
s_waitcnt lgkmcnt(5)
Ta 158,5,2048
Ta 160,2,4096
v_add_f32 v126, v126, v175
Mvav 48,144,176
buffer_load_dwordx4 a[244:247], v7, s[40:43], s6 offen offset:3072 sc1
Ta 162,2,6144
Mvav 56,144,180
s_waitcnt lgkmcnt(6)
Ta 164,3,4096
Ta 166,3,6144
Mvav 52,148,176
Ta 168,4,4096
v_lshlrev_b32 v175, 16, v140
Mvav 60,148,180
s_waitcnt lgkmcnt(7)
Ta 170,4,6144
v_add_f32 v120, v120, v175
Mvav 64,152,176
buffer_load_dword v173, v172, s[40:43], 0 offen sc1
Ta 172,5,4096
Mvav 72,152,180
s_waitcnt lgkmcnt(7)
Ta 174,5,6144
v_lshlrev_b32 v175, 16, v141
Mvav 68,156,176
LD 11,52,76,3072
Ta 128,2,8192
Mvav 76,156,180
s_waitcnt lgkmcnt(7)
s_add_u32 m0, s68, 0x9000
s_add_u32 s76, s12, 0
Ta 130,2,10240
Mvav 48,160,184
Ta 132,3,8192
v_add_f32 v122, v122, v175
Mvav 56,160,188
s_waitcnt lgkmcnt(7)
Ta 134,3,10240
v_lshlrev_b32 v175, 16, v142
Mvav 52,164,184
s_waitcnt vmcnt(13)
buffer_store_dword v47, off, s[40:43], s9 sc1
Ta 136,4,8192
Mvav 60,164,188
s_waitcnt lgkmcnt(7)
Ta 138,4,10240
v_add_f32 v124, v124, v175
Mvav 64,168,184
global_load_dword v35, v46, s[96:97]
Ta 140,5,8192
Mvav 72,168,188
s_waitcnt lgkmcnt(7)
Ta 142,5,10240
v_lshlrev_b32 v175, 16, v143
Mvav 68,172,184
LD 8,52,76,0
Ta 144,2,12288
Mvav 76,172,188
s_waitcnt lgkmcnt(7)
Ta 146,2,14336
v_add_f32 v126, v126, v175
Mvav 48,128,192
Ta 148,3,12288
v_lshlrev_b32 v175, 16, v144
Mvav 56,128,196
s_waitcnt lgkmcnt(7)
Ta 150,3,14336
v_add_f32 v120, v120, v175
Mvav 52,132,192
LD 9,52,76,1024
Ta 152,4,12288
Mvav 60,132,196
s_waitcnt lgkmcnt(7)
Ta 154,4,14336
v_lshlrev_b32 v175, 16, v145
Mvav 64,136,192
Ta 156,5,12288
v_add_f32 v122, v122, v175
Mvav 72,136,196
s_waitcnt lgkmcnt(7)
Ta 158,5,14336
v_lshlrev_b32 v175, 16, v146
Mvav 68,140,192
LD 10,52,76,2048
Ta 160,2,16384
Mvav 76,140,196
s_waitcnt lgkmcnt(7)
Ta 162,2,18432
v_add_f32 v124, v124, v175
Mvav 48,144,200
Ta 164,3,16384
v_lshlrev_b32 v175, 16, v147
Mvav 56,144,204
s_waitcnt lgkmcnt(7)
Ta 166,3,18432
v_add_f32 v126, v126, v175
Mvav 52,148,200
LD 11,52,76,3072
Ta 168,4,16384
Mvav 60,148,204
s_waitcnt lgkmcnt(7)
s_add_u32 m0, s68, 0xa000
s_add_u32 s76, s12, 0x9000
Ta 170,4,18432
Mvav 64,152,200
Ta 172,5,16384
v_lshlrev_b32 v175, 16, v148
Mvav 72,152,204
s_waitcnt lgkmcnt(7)
Ta 174,5,18432
v_add_f32 v120, v120, v175
Mvav 68,156,200
LD 8,52,76,0
Ta 128,2,20480
Mvav 76,156,204
s_waitcnt lgkmcnt(7)
Ta 130,2,22528
v_lshlrev_b32 v175, 16, v149
Mvav 48,160,208
Ta 132,3,20480
v_add_f32 v122, v122, v175
Mvav 56,160,212
s_waitcnt lgkmcnt(7)
Ta 134,3,22528
v_lshlrev_b32 v175, 16, v150
Mvav 52,164,208
LD 9,52,76,1024
Ta 136,4,20480
Mvav 60,164,212
s_waitcnt lgkmcnt(7)
Ta 138,4,22528
v_add_f32 v124, v124, v175
Mvav 64,168,208
Ta 140,5,20480
v_lshlrev_b32 v175, 16, v151
Mvav 72,168,212
s_waitcnt lgkmcnt(7)
Ta 142,5,22528
v_add_f32 v126, v126, v175
Mvav 68,172,208
LD 10,52,76,2048
Ta 144,2,24576
Mvav 76,172,212
s_waitcnt lgkmcnt(7)
Ta 146,2,26624
v_lshlrev_b32 v175, 16, v152
Mvav 48,128,216
Ta 148,3,24576
Ta 150,3,26624
Mvav 56,128,220
s_waitcnt lgkmcnt(8)
Ta 152,4,24576
v_add_f32 v120, v120, v175
Mvav 52,132,216
LD 11,52,76,3072
Ta 154,4,26624
Mvav 60,132,220
s_waitcnt lgkmcnt(8)
s_add_u32 m0, s68, 0x12000
Ta 156,5,24576
Ta 158,5,26624
Mvav 64,136,216
s_add_u32 s76, s12, 0x48000
Ta 160,2,28672
Ta 162,2,30720
Mvav 72,136,220
s_waitcnt lgkmcnt(10)
Ta 164,3,28672
Ta 166,3,30720
Mvav 68,140,216
buffer_load_dwordx4 v[128:131], v40, s[40:43], s22 offen sc1
Ta 168,4,28672
Mvav 76,140,220
s_waitcnt lgkmcnt(11)
Ta 170,4,30720
Ta 172,5,28672
Mvav 48,144,224
Ta 174,5,30720
v_add_u32 v2, 0x9000, v2
Mvav 56,144,228
s_waitcnt lgkmcnt(11)
v_add_u32 v3, 0x9000, v3
v_add_u32 v4, 0x9000, v4
Mvav 52,148,224
v_add_u32 v5, 0x9000, v5
v_lshlrev_b32 v175, 16, v153
Mvav 60,148,228
s_waitcnt lgkmcnt(9)
v_add_f32 v122, v122, v175
v_lshlrev_b32 v175, 16, v154
Mvav 64,152,224
v_add_f32 v124, v124, v175
v_lshlrev_b32 v175, 16, v155
Mvav 72,152,228
s_waitcnt vmcnt(12)
v_cmp_ne_u32 vcc, s98, v173
s_cbranch_vccnz L_spin16
L_pollok16:
s_waitcnt lgkmcnt(6)
Mvav 68,156,224
buffer_load_dwordx4 a[188:191], v7, s[40:43], s7 offen sc1
s_waitcnt lgkmcnt(0)
s_barrier
Mvav 76,156,228
Ta 128,2,0
v_mov_b32 v172, 0
Mvav 48,160,232
Ta 130,2,2048
v_lshlrev_b32 v173, 7, s14
Mvav 56,160,236
Ta 132,3,0
v_lshl_add_u32 v172, v172, 2, v173
Mvav 52,164,232
buffer_load_dwordx4 a[208:211], v7, s[40:43], s7 offen offset:1024 sc1
Ta 134,3,2048
Mvav 60,164,236
Ta 136,4,0
CV 48,48,49
Mvav 64,168,232
Ta 138,4,2048
CV 49,50,51
Mvav 72,168,236
Ta 140,5,0
CV 50,52,53
Mvav 68,172,232
buffer_load_dwordx4 a[228:231], v7, s[40:43], s7 offen offset:2048 sc1
Ta 142,5,2048
Mvav 76,172,236
s_waitcnt lgkmcnt(6)
Ta 144,2,4096
CV 51,54,55
v_mfma_f32_16x16x32_bf16 v[80:83], a[128:131], a[0:3], 0
Ta 146,2,6144
CV 56,56,57
v_mfma_f32_16x16x32_bf16 v[88:91], a[128:131], a[4:7], 0
s_waitcnt lgkmcnt(6)
Ta 148,3,4096
CV 57,58,59
v_mfma_f32_16x16x32_bf16 v[84:87], a[132:135], a[0:3], 0
buffer_store_dwordx4 v[48:51], v7, s[40:43], s80 offen sc1
Ta 150,3,6144
v_mfma_f32_16x16x32_bf16 v[92:95], a[132:135], a[4:7], 0
s_waitcnt lgkmcnt(6)
Ta 152,4,4096
CV 58,60,61
v_mfma_f32_16x16x32_bf16 v[96:99], a[136:139], a[0:3], 0
Ta 154,4,6144
CV 59,62,63
v_mfma_f32_16x16x32_bf16 v[104:107], a[136:139], a[4:7], 0
s_waitcnt lgkmcnt(6)
Ta 156,5,4096
CV 64,64,65
v_mfma_f32_16x16x32_bf16 v[100:103], a[140:143], a[0:3], 0
s_waitcnt lgkmcnt(5)
Ta 158,5,6144
CV 65,66,67
v_mfma_f32_16x16x32_bf16 v[108:111], a[140:143], a[4:7], 0
buffer_store_dwordx4 v[56:59], v7, s[40:43], s80 offen offset:1024 sc1
Ta 160,2,8192
Mvaa 80,144,8
Ta 162,2,10240
CV 66,68,69
Mvaa 88,144,12
s_waitcnt lgkmcnt(6)
Ta 164,3,8192
CV 67,70,71
Mvaa 84,148,8
Ta 166,3,10240
CV 72,72,73
Mvaa 92,148,12
s_waitcnt lgkmcnt(6)
Ta 168,4,8192
CV 73,74,75
Mvaa 96,152,8
buffer_store_dwordx4 v[64:67], v7, s[40:43], s80 offen offset:2048 sc1
Ta 170,4,10240
Mvaa 104,152,12
s_waitcnt lgkmcnt(6)
Ta 172,5,8192
CV 74,76,77
Mvaa 100,156,8
Ta 174,5,10240
CV 75,78,79
Mvaa 108,156,12
s_waitcnt lgkmcnt(6)
Ta 128,2,12288
v_add_u32 v172, 0x3010034, v172
Mvaa 80,160,16
s_waitcnt lgkmcnt(5)
Ta 130,2,14336
Ta 132,3,12288
Mvaa 88,160,20
buffer_store_dwordx4 v[72:75], v7, s[40:43], s80 offen offset:3072 sc1
Ta 134,3,14336
Mvaa 84,164,16
Ta 136,4,12288
v_add_f32 v126, v126, v175
Mvaa 92,164,20
s_waitcnt lgkmcnt(7)
Ta 138,4,14336
v_lshlrev_b32 v175, 16, v156
Mvaa 96,168,16
Ta 140,5,12288
v_add_f32 v120, v120, v175
Mvaa 104,168,20
s_waitcnt lgkmcnt(7)
Ta 142,5,14336
v_lshlrev_b32 v175, 16, v157
Mvaa 100,172,16
buffer_load_dwordx4 a[248:251], v7, s[40:43], s7 offen offset:3072 sc1
Ta 144,2,16384
Mvaa 108,172,20
s_waitcnt lgkmcnt(7)
Ta 146,2,18432
v_add_f32 v122, v122, v175
Mvaa 80,128,24
Ta 148,3,16384
v_lshlrev_b32 v175, 16, v158
Mvaa 88,128,28
s_waitcnt lgkmcnt(7)
Ta 150,3,18432
v_and_b32 v132, s90, v132
Mvaa 84,132,24
LD 8,52,76,0
Ta 152,4,16384
Mvaa 92,132,28
s_waitcnt lgkmcnt(7)
L_pg15_20:
s_cbranch_execz L_ret15
Ta 154,4,18432
v_and_b32 v133, s90, v133
Mvaa 96,136,24
Ta 156,5,16384
v_and_b32 v134, s90, v134
Mvaa 104,136,28
s_waitcnt lgkmcnt(7)
Ta 158,5,18432
v_and_b32 v135, s90, v135
Mvaa 100,140,24
LD 9,52,76,1024
Ta 160,2,20480
Mvaa 108,140,28
s_waitcnt lgkmcnt(7)
Ta 162,2,22528
v_add_f32 v124, v124, v175
Mvaa 80,144,32
Ta 164,3,20480
v_add_f32 v121, v121, v132
Mvaa 88,144,36
s_waitcnt lgkmcnt(7)
Ta 166,3,22528
v_add_f32 v123, v123, v133
Mvaa 84,148,32
LD 10,52,76,2048
Ta 168,4,20480
Mvaa 92,148,36
s_waitcnt lgkmcnt(7)
Ta 170,4,22528
v_and_b32 v136, s90, v136
Mvaa 96,152,32
Ta 172,5,20480
v_and_b32 v137, s90, v137
Mvaa 104,152,36
s_waitcnt lgkmcnt(7)
Ta 174,5,22528
v_lshlrev_b32 v175, 16, v159
Mvaa 100,156,32
LD 11,52,76,3072
Ta 128,2,24576
Mvaa 108,156,36
s_waitcnt lgkmcnt(7)
s_add_u32 m0, s68, 0x13000
s_add_u32 s76, s12, 0x51000
Ta 130,2,26624
Mvaa 80,160,40
Ta 132,3,24576
v_add_f32 v125, v125, v134
Mvaa 88,160,44
s_waitcnt lgkmcnt(7)
Ta 134,3,26624
v_add_f32 v127, v127, v135
Mvaa 84,164,40
LD 8,52,76,0
Ta 136,4,24576
Mvaa 92,164,44
s_waitcnt lgkmcnt(7)
Ta 138,4,26624
v_and_b32 v138, s90, v138
Mvaa 96,168,40
Ta 140,5,24576
v_and_b32 v139, s90, v139
Mvaa 104,168,44
s_waitcnt lgkmcnt(7)
Ta 142,5,26624
v_add_f32 v121, v121, v136
Mvaa 100,172,40
LD 9,52,76,1024
Ta 144,2,28672
Mvaa 108,172,44
s_waitcnt lgkmcnt(7)
Ta 146,2,30720
v_add_u32 v2, 0xfffe5000, v2
Mvaa 80,128,48
Ta 148,3,28672
v_add_f32 v123, v123, v137
Mvaa 88,128,52
s_waitcnt lgkmcnt(7)
Ta 150,3,30720
v_add_u32 v3, 0xfffe5000, v3
Mvaa 84,132,48
LD 10,52,76,2048
Ta 152,4,28672
Mvaa 92,132,52
s_waitcnt lgkmcnt(7)
Ta 154,4,30720
Ta 156,5,28672
Mvaa 96,136,48
Ta 158,5,30720
v_add_u32 v4, 0xfffe5000, v4
Mvaa 104,136,52
s_waitcnt lgkmcnt(8)
v_add_u32 v5, 0xfffe5000, v5
v_and_b32 v140, s90, v140
Mvaa 100,140,48
LD 11,52,76,3072
v_and_b32 v141, s90, v141
Mvaa 108,140,52
s_waitcnt lgkmcnt(6)
v_add_f32 v126, v126, v175
v_add_f32 v125, v125, v138
Mvaa 80,144,56
v_add_f32 v127, v127, v139
v_and_b32 v142, s90, v142
v_and_b32 v143, s90, v143
Mvaa 88,144,60
s_waitcnt vmcnt(16)
s_waitcnt lgkmcnt(4)
v_lshlrev_b32 v175, 16, v128
v_add_f32 v121, v121, v140
Mvaa 84,148,56
s_waitcnt lgkmcnt(0)
s_barrier
v_add_f32 v123, v123, v141
v_and_b32 v144, s90, v144
Mvaa 92,148,60
Ta 160,2,0
Ta 162,2,2048
Mvaa 96,152,56
Ta 164,3,0
Ta 166,3,2048
Mvaa 104,152,60
Ta 168,4,0
Ta 170,4,2048
Mvaa 100,156,56
Ta 172,5,0
Ta 174,5,2048
Mvaa 108,156,60
s_waitcnt lgkmcnt(6)
Ta 128,2,4096
Ta 130,2,6144
v_and_b32 v145, s90, v145
v_add_f32 v125, v125, v142
v_add_f32 v127, v127, v143
v_and_b32 v146, s90, v146
v_and_b32 v147, s90, v147
v_add_f32 v120, v120, v175
Mvav 80,160,176
buffer_load_dword v173, v172, s[40:43], 0 offen sc1
Ta 132,3,4096
Mvav 88,160,180
s_waitcnt lgkmcnt(7)
Ta 134,3,6144
v_add_f32 v121, v121, v144
Mvav 84,164,176
Ta 136,4,4096
v_add_f32 v123, v123, v145
Mvav 92,164,180
s_waitcnt lgkmcnt(7)
Ta 138,4,6144
v_and_b32 v148, s90, v148
Mvav 96,168,176
Ta 140,5,4096
v_and_b32 v149, s90, v149
Mvav 104,168,180
s_waitcnt lgkmcnt(7)
Ta 142,5,6144
v_lshlrev_b32 v175, 16, v129
Mvav 100,172,176
s_waitcnt vmcnt(10)
buffer_store_dword v47, off, s[40:43], s10 sc1
Ta 144,2,8192
Mvav 108,172,180
s_waitcnt lgkmcnt(7)
Ta 146,2,10240
v_add_f32 v125, v125, v146
Mvav 80,128,184
Ta 148,3,8192
v_add_f32 v127, v127, v147
Mvav 88,128,188
s_waitcnt lgkmcnt(7)
Ta 150,3,10240
v_and_b32 v150, s90, v150
Mvav 84,132,184
Ta 152,4,8192
v_and_b32 v151, s90, v151
Mvav 92,132,188
s_waitcnt lgkmcnt(7)
Ta 154,4,10240
v_add_f32 v121, v121, v148
Mvav 96,136,184
Ta 156,5,8192
v_add_f32 v123, v123, v149
Mvav 104,136,188
s_waitcnt lgkmcnt(7)
Ta 158,5,10240
v_and_b32 v152, s90, v152
Mvav 100,140,184
Ta 160,2,12288
v_and_b32 v153, s90, v153
Mvav 108,140,188
s_waitcnt lgkmcnt(7)
Ta 162,2,14336
v_add_f32 v122, v122, v175
Mvav 80,144,192
Ta 164,3,12288
v_add_f32 v125, v125, v150
Mvav 88,144,196
s_waitcnt lgkmcnt(7)
Ta 166,3,14336
v_add_f32 v127, v127, v151
Mvav 84,148,192
Ta 168,4,12288
v_and_b32 v154, s90, v154
Mvav 92,148,196
s_waitcnt lgkmcnt(7)
Ta 170,4,14336
v_and_b32 v155, s90, v155
Mvav 96,152,192
Ta 172,5,12288
v_lshlrev_b32 v175, 16, v130
Mvav 104,152,196
s_waitcnt lgkmcnt(7)
Ta 174,5,14336
v_add_f32 v121, v121, v152
Mvav 100,156,192
Ta 128,2,16384
v_add_f32 v123, v123, v153
Mvav 108,156,196
s_waitcnt lgkmcnt(7)
Ta 130,2,18432
v_and_b32 v156, s90, v156
Mvav 80,160,200
Ta 132,3,16384
v_and_b32 v157, s90, v157
Mvav 88,160,204
s_waitcnt lgkmcnt(7)
Ta 134,3,18432
v_add_f32 v125, v125, v154
Mvav 84,164,200
Ta 136,4,16384
v_add_f32 v127, v127, v155
Mvav 92,164,204
s_waitcnt lgkmcnt(7)
Ta 138,4,18432
v_and_b32 v158, s90, v158
Mvav 96,168,200
Ta 140,5,16384
v_and_b32 v159, s90, v159
Mvav 104,168,204
s_waitcnt lgkmcnt(7)
Ta 142,5,18432
v_add_f32 v124, v124, v175
Mvav 100,172,200
Ta 144,2,20480
v_add_f32 v121, v121, v156
Mvav 108,172,204
s_waitcnt lgkmcnt(7)
Ta 146,2,22528
v_add_f32 v123, v123, v157
Mvav 80,128,208
Ta 148,3,20480
Ta 150,3,22528
Mvav 88,128,212
s_waitcnt lgkmcnt(8)
Ta 152,4,20480
v_and_b32 v128, s90, v128
Mvav 84,132,208
Ta 154,4,22528
v_and_b32 v129, s90, v129
Mvav 92,132,212
s_waitcnt lgkmcnt(8)
Ta 156,5,20480
v_lshlrev_b32 v175, 16, v131
Mvav 96,136,208
Ta 158,5,22528
v_add_f32 v125, v125, v158
Mvav 104,136,212
s_waitcnt lgkmcnt(8)
Ta 160,2,24576
v_add_f32 v127, v127, v159
Mvav 100,140,208
Ta 162,2,26624
v_and_b32 v130, s90, v130
Mvav 108,140,212
s_waitcnt lgkmcnt(8)
Ta 164,3,24576
v_and_b32 v131, s90, v131
Mvav 80,144,216
Ta 166,3,26624
v_add_f32 v121, v121, v128
Mvav 88,144,220
s_waitcnt lgkmcnt(8)
Ta 168,4,24576
v_add_f32 v123, v123, v129
Mvav 84,148,216
Ta 170,4,26624
v_add_f32 v125, v125, v130
Mvav 92,148,220
s_waitcnt lgkmcnt(8)
Ta 172,5,24576
v_add_f32 v127, v127, v131
Mvav 96,152,216
Ta 174,5,26624
v_mul_f32 v128, 0xbfb8aa3b, v120
Mvav 104,152,220
s_waitcnt lgkmcnt(8)
Ta 128,2,28672
v_mul_f32 v129, 0xbfb8aa3b, v121
Mvav 100,156,216
Ta 130,2,30720
v_add_u32 v2, 0x9000, v2
Mvav 108,156,220
s_waitcnt lgkmcnt(8)
Ta 132,3,28672
v_mul_f32 v130, 0xbfb8aa3b, v122
Mvav 80,160,224
Ta 134,3,30720
v_add_u32 v3, 0x9000, v3
Mvav 88,160,228
s_waitcnt lgkmcnt(8)
Ta 136,4,28672
v_mul_f32 v131, 0xbfb8aa3b, v123
Mvav 84,164,224
Ta 138,4,30720
Ta 140,5,28672
Mvav 92,164,228
Ta 142,5,30720
s_waitcnt vmcnt(1)
v_cmp_ne_u32 vcc, s98, v173
s_cbranch_vccnz L_spin17
L_pollok17:
s_waitcnt lgkmcnt(10)
Mvav 96,168,224
buffer_load_dwordx4 a[192:195], v7, s[40:43], s4 offen sc1
v_add_u32 v4, 0x9000, v4
Mvav 104,168,228
s_waitcnt lgkmcnt(8)
v_add_u32 v5, 0x9000, v5
v_add_f32 v126, v126, v175
Mvav 100,172,224
v_exp_f32 v128, v128
Mvav 108,172,228
s_waitcnt lgkmcnt(6)
v_exp_f32 v129, v129
Mvav 80,128,232
buffer_load_dwordx4 a[212:215], v7, s[40:43], s4 offen offset:1024 sc1
v_add_f32 v128, 1.0, v128
Mvav 88,128,236
s_waitcnt lgkmcnt(0)
s_barrier
v_exp_f32 v130, v130
Mvav 84,132,232
Ta 144,2,0
Ta 146,2,2048
Mvav 92,132,236
Ta 148,3,0
Ta 150,3,2048
Mvav 96,136,232
buffer_load_dwordx4 a[232:235], v7, s[40:43], s4 offen offset:2048 sc1
Ta 152,4,0
Mvav 104,136,236
Ta 154,4,2048
CV 84,84,85
Mvav 100,140,232
Ta 156,5,0
Ta 158,5,2048
Mvav 108,140,236
s_waitcnt lgkmcnt(6)
Ta 160,2,4096
Ta 162,2,6144
buffer_load_dwordx4 a[252:255], v7, s[40:43], s4 offen offset:3072 sc1
v_mfma_f32_16x16x32_bf16 v[48:51], a[144:147], a[0:3], 0
Ta 164,3,4096
CV 85,86,87
v_mfma_f32_16x16x32_bf16 v[56:59], a[144:147], a[4:7], 0
s_waitcnt lgkmcnt(7)
Ta 166,3,6144
CV 86,80,81
v_mfma_f32_16x16x32_bf16 v[52:55], a[148:151], a[0:3], 0
s_waitcnt lgkmcnt(6)
Ta 168,4,4096
CV 87,82,83
v_mfma_f32_16x16x32_bf16 v[60:63], a[148:151], a[4:7], 0
buffer_store_dwordx4 v[84:87], v7, s[40:43], s81 offen sc1
Ta 170,4,6144
v_mfma_f32_16x16x32_bf16 v[64:67], a[152:155], a[0:3], 0
Ta 172,5,4096
CV 92,92,93
v_mfma_f32_16x16x32_bf16 v[72:75], a[152:155], a[4:7], 0
s_waitcnt lgkmcnt(7)
Ta 174,5,6144
CV 93,94,95
v_mfma_f32_16x16x32_bf16 v[68:71], a[156:159], a[0:3], 0
Ta 128,2,8192
CV 94,88,89
v_mfma_f32_16x16x32_bf16 v[76:79], a[156:159], a[4:7], 0
s_waitcnt lgkmcnt(7)
Ta 130,2,10240
CV 95,90,91
Mvaa 48,160,8
buffer_store_dwordx4 v[92:95], v7, s[40:43], s81 offen offset:1024 sc1
Ta 132,3,8192
Mvaa 56,160,12
s_waitcnt lgkmcnt(7)
Ta 134,3,10240
Ta 136,4,8192
Mvaa 52,164,8
Ta 138,4,10240
CV 100,100,101
Mvaa 60,164,12
s_waitcnt lgkmcnt(8)
Ta 140,5,8192
CV 101,102,103
Mvaa 64,168,8
Ta 142,5,10240
CV 102,96,97
Mvaa 72,168,12
s_waitcnt lgkmcnt(8)
Ta 144,2,12288
CV 103,98,99
Mvaa 68,172,8
buffer_store_dwordx4 v[100:103], v7, s[40:43], s81 offen offset:2048 sc1
Ta 146,2,14336
Mvaa 76,172,12
s_waitcnt lgkmcnt(8)
Ta 148,3,12288
CV 108,108,109
Mvaa 48,128,16
Ta 150,3,14336
CV 109,110,111
Mvaa 56,128,20
s_waitcnt lgkmcnt(8)
Ta 152,4,12288
CV 110,104,105
Mvaa 52,132,16
s_waitcnt lgkmcnt(7)
Ta 154,4,14336
CV 111,106,107
Mvaa 60,132,20
buffer_store_dwordx4 v[108:111], v7, s[40:43], s81 offen offset:3072 sc1
Ta 156,5,12288
Mvaa 64,136,16
Ta 158,5,14336
v_add_f32 v129, 1.0, v129
Mvaa 72,136,20
s_waitcnt lgkmcnt(8)
Ta 160,2,16384
v_add_f32 v130, 1.0, v130
Mvaa 68,140,16
Ta 162,2,18432
v_mul_f32 v132, 0xbfb8aa3b, v124
Mvaa 76,140,20
s_waitcnt lgkmcnt(8)
Ta 164,3,16384
v_mul_f32 v133, 0xbfb8aa3b, v125
Mvaa 48,144,24
Ta 166,3,18432
v_mul_f32 v134, 0xbfb8aa3b, v126
Mvaa 56,144,28
s_waitcnt lgkmcnt(8)
Ta 168,4,16384
v_mul_f32 v135, 0xbfb8aa3b, v127
Mvaa 52,148,24
Ta 170,4,18432
Mvaa 60,148,28
s_waitcnt lgkmcnt(8)
Ta 172,5,16384
Mvaa 64,152,24
Ta 174,5,18432
Mvaa 72,152,28
s_waitcnt lgkmcnt(8)
Ta 128,2,20480
Mvaa 68,156,24
Ta 130,2,22528
Mvaa 76,156,28
s_waitcnt lgkmcnt(8)
Ta 132,3,20480
Mvaa 48,160,32
Ta 134,3,22528
Mvaa 56,160,36
s_waitcnt lgkmcnt(8)
Ta 136,4,20480
Mvaa 52,164,32
Ta 138,4,22528
Mvaa 60,164,36
s_waitcnt lgkmcnt(8)
Ta 140,5,20480
Mvaa 64,168,32
Ta 142,5,22528
Mvaa 72,168,36
s_waitcnt lgkmcnt(8)
Ta 144,2,24576
Mvaa 68,172,32
Ta 146,2,26624
Mvaa 76,172,36
s_waitcnt lgkmcnt(8)
Ta 148,3,24576
Mvaa 48,128,40
Ta 150,3,26624
Mvaa 56,128,44
s_waitcnt lgkmcnt(8)
Ta 152,4,24576
Mvaa 52,132,40
Ta 154,4,26624
Mvaa 60,132,44
s_waitcnt lgkmcnt(8)
Ta 156,5,24576
Mvaa 64,136,40
Ta 158,5,26624
Mvaa 72,136,44
s_waitcnt lgkmcnt(8)
Ta 160,2,28672
Mvaa 68,140,40
Ta 162,2,30720
v_add_u32 v2, 0x9000, v2
Mvaa 76,140,44
s_waitcnt lgkmcnt(8)
Ta 164,3,28672
Mvaa 48,144,48
Ta 166,3,30720
Ta 168,4,28672
Mvaa 56,144,52
s_waitcnt lgkmcnt(9)
Ta 170,4,30720
v_add_u32 v3, 0x9000, v3
Mvaa 52,148,48
Ta 172,5,28672
Ta 174,5,30720
Mvaa 60,148,52
s_waitcnt lgkmcnt(10)
v_add_u32 v4, 0x9000, v4
v_add_u32 v5, 0x9000, v5
Mvaa 64,152,48
v_exp_f32 v131, v131
Mvaa 72,152,52
s_waitcnt lgkmcnt(8)
v_rcp_f32 v128, v128
Mvaa 68,156,48
v_rcp_f32 v129, v129
Mvaa 76,156,52
s_waitcnt lgkmcnt(6)
v_rcp_f32 v130, v130
Mvaa 48,160,56
v_add_f32 v131, 1.0, v131
v_mul_f32 v120, v120, v128
Mvaa 56,160,60
s_waitcnt lgkmcnt(0)
s_barrier
v_rcp_f32 v131, v131
Mvaa 52,164,56
Ta 128,2,0
Ta 130,2,2048
Mvaa 60,164,60
Ta 132,3,0
Ta 134,3,2048
Mvaa 64,168,56
Ta 136,4,0
Ta 138,4,2048
Mvaa 72,168,60
Ta 140,5,0
v_mul_f32 v121, v121, v129
Mvaa 68,172,56
Ta 142,5,2048
v_mul_f32 v122, v122, v130
Mvaa 76,172,60
s_waitcnt lgkmcnt(6)
Ta 144,2,4096
Ta 146,2,6144
v_mul_f32 v123, v123, v131
v_exp_f32 v132, v132
Mvav 48,128,176
buffer_load_dwordx4 v[128:131], v38, s[32:35], s18 offen offset:1024
Ta 148,3,4096
Mvav 56,128,180
s_waitcnt lgkmcnt(7)
Ta 150,3,6144
v_add_f32 v132, 1.0, v132
Mvav 52,132,176
Ta 152,4,4096
Mvav 60,132,180
s_waitcnt lgkmcnt(7)
Ta 154,4,6144
Mvav 64,136,176
Ta 156,5,4096
Mvav 72,136,180
s_waitcnt lgkmcnt(7)
Ta 158,5,6144
Mvav 68,140,176
Ta 160,2,8192
Mvav 76,140,180
s_waitcnt lgkmcnt(7)
Ta 162,2,10240
Mvav 48,144,184
Ta 164,3,8192
Mvav 56,144,188
s_waitcnt vmcnt(1)
s_waitcnt lgkmcnt(7)
buffer_store_dword v47, off, s[40:43], s11 sc1
Ta 166,3,10240
Mvav 52,148,184
Ta 168,4,8192
Mvav 60,148,188
s_waitcnt lgkmcnt(7)
Ta 170,4,10240
Mvav 64,152,184
Ta 172,5,8192
Mvav 72,152,188
s_waitcnt lgkmcnt(7)
Ta 174,5,10240
Mvav 68,156,184
Ta 128,2,12288
Mvav 76,156,188
Ta 130,2,14336
Mvva 52,164,176
L_pg15_21:
s_cbranch_execz L_ret15
Ta 132,3,12288
Mvva 60,164,196
Ta 134,3,14336
Mvva 68,164,216
Ta 136,4,12288
Mvva 76,164,236
s_waitcnt lgkmcnt(8)
Ta 138,4,14336
Mvav 48,160,192
Ta 140,5,12288
Mvav 56,160,196
Ta 142,5,14336
Mvav 52,164,192
Ta 144,2,16384
Mvav 60,164,196
s_waitcnt lgkmcnt(8)
Ta 146,2,18432
Mvav 64,168,192
Ta 148,3,16384
Mvav 72,168,196
Ta 150,3,18432
Mvav 68,172,192
Ta 152,4,16384
Mvav 76,172,196
Ta 154,4,18432
Mvva 48,162,178
Ta 156,5,16384
Mvva 56,162,198
Ta 158,5,18432
Mvva 64,162,218
Ta 160,2,20480
Mvva 72,162,238
s_waitcnt lgkmcnt(8)
Ta 162,2,22528
Mvav 48,128,200
Ta 164,3,20480
v_exp_f32 v133, v133
Mvav 56,128,204
Ta 166,3,22528
v_add_f32 v133, 1.0, v133
Mvav 52,132,200
Ta 168,4,20480
Mvav 60,132,204
Ta 170,4,22528
Mvav 64,136,200
Ta 172,5,20480
Mvav 72,136,204
Ta 174,5,22528
Mvav 68,140,200
Ta 128,2,24576
Mvav 76,140,204
Ta 130,2,26624
Mvva 52,162,182
Ta 132,3,24576
Mvva 60,162,202
Ta 134,3,26624
Mvva 68,162,222
Ta 136,4,24576
Mvva 76,162,242
s_waitcnt lgkmcnt(8)
Ta 138,4,26624
Mvav 48,144,208
Ta 140,5,24576
Mvav 56,144,212
Ta 142,5,26624
Mvav 52,148,208
Ta 144,2,28672
Mvav 60,148,212
Ta 146,2,30720
Mvav 64,152,208
Ta 148,3,28672
Mvav 72,152,212
Ta 150,3,30720
Mvav 68,156,208
Ta 152,4,28672
Mvav 76,156,212
Ta 154,4,30720
Mvva 48,162,186
Ta 156,5,28672
Mvva 56,162,206
Ta 158,5,30720
Mvva 64,162,226
v_exp_f32 v134, v134
Mvva 72,162,246
v_exp_f32 v135, v135
Mvav 48,160,216
v_rcp_f32 v132, v132
Mvav 56,160,220
v_rcp_f32 v133, v133
Mvav 52,164,216
v_add_f32 v134, 1.0, v134
v_add_f32 v135, 1.0, v135
Mvav 60,164,220
s_waitcnt lgkmcnt(3)
v_rcp_f32 v134, v134
Mvav 64,168,216
v_rcp_f32 v135, v135
Mvav 72,168,220
v_mul_f32 v124, v124, v132
v_mul_f32 v125, v125, v133
Mvav 68,172,216
v_mul_f32 v126, v126, v134
v_mul_f32 v127, v127, v135
Mvav 76,172,220
Mvva 52,162,190
Mvva 60,162,210
Mvva 68,162,230
Mvva 76,162,250
Mvav 48,128,224
Mvav 56,128,228
Mvav 52,132,224
Mvav 60,132,228
Mvav 64,136,224
Mvav 72,136,228
Mvav 68,140,224
Mvav 76,140,228
s_waitcnt vmcnt(1)
v_permlane16_swap_b32 v128, v130
Mvva 48,160,192
v_permlane16_swap_b32 v129, v131
Mvva 56,160,212
v_permlane32_swap_b32 v128, v130
Mvva 64,160,232
v_permlane32_swap_b32 v129, v131
Mvva 72,160,252
v_lshlrev_b32 v132, 16, v128
v_and_b32 v133, s90, v128
Mvav 48,144,232
v_lshlrev_b32 v134, 16, v129
v_and_b32 v135, s90, v129
Mvav 56,144,236
v_fma_f32 v112, v112, v120, v132
v_fma_f32 v113, v113, v121, v133
Mvav 52,148,232
v_fma_f32 v114, v114, v122, v134
v_fma_f32 v115, v115, v123, v135
Mvav 60,148,236
s_waitcnt lgkmcnt(0)
CV 48,48,49
CV 49,50,51
Mvav 64,152,232
CV 56,56,57
CV 57,58,59
Mvav 72,152,236
CV 50,52,53
CV 51,54,55
Mvav 68,156,232
buffer_store_dwordx4 v[48:51], v7, s[40:43], s78 offen sc1
CV 58,60,61
Mvav 76,156,236
CV 64,64,65
s_nop 0
CV 72,72,73
CV 65,66,67
CV 73,74,75
CV 59,62,63
CV 66,68,69
buffer_store_dwordx4 v[56:59], v7, s[40:43], s78 offen offset:1024 sc1
CV 67,70,71
CV 74,76,77
buffer_store_dwordx4 v[64:67], v7, s[40:43], s78 offen offset:2048 sc1
CV 75,78,79
v_lshlrev_b32 v132, 16, v130
buffer_store_dwordx4 v[72:75], v7, s[40:43], s78 offen offset:3072 sc1
s_waitcnt vmcnt(0)
buffer_store_dword v47, off, s[40:43], s8 sc1
v_and_b32 v133, s90, v130
v_lshlrev_b32 v134, 16, v131
v_and_b32 v135, s90, v131
v_fma_f32 v116, v116, v124, v132
v_fma_f32 v117, v117, v125, v133
v_fma_f32 v118, v118, v126, v134
v_fma_f32 v119, v119, v127, v135
CV 112,112,113
CV 113,114,115
CV 114,116,117
CV 115,118,119
s_nop 0
v_permlane32_swap_b32 v112, v114
v_permlane32_swap_b32 v113, v115
s_nop 0
v_permlane16_swap_b32 v112, v114
v_permlane16_swap_b32 v113, v115
buffer_store_dwordx4 v[112:115], v38, s[60:63], s18 offen offset:1024 sc1
s_endpgm
L_endA:
L_spin10:
s_mov_b32 s91, 0x8000
L_spinl10:
s_sleep 2
buffer_load_dword v173, v172, s[40:43], 0 offen sc1
s_waitcnt vmcnt(0)
v_cmp_ne_u32 vcc, s98, v173
s_cbranch_vccz L_pollok10
s_sub_u32 s91, s91, 1
s_cmp_lg_u32 s91, 0
s_cbranch_scc1 L_spinl10
s_branch L_pollok10
L_max1:
s_nop 15
s_nop 15
v_and_b32 v168, 15, v1
v_and_b32 v169, 48, v1
v_lshrrev_b32 v169, 0, v169
v_lshl_add_u32 v168, v168, 8, v169
s_lshl_b32 s82, s66, 20
s_add_u32 s82, s82, 0xe0000
s_mov_b32 s83, 32
L_maxl1:
buffer_load_dwordx4 v[144:147], v168, s[44:47], s82 offen
s_waitcnt vmcnt(0)
buffer_load_dwordx4 v[148:151], v168, s[44:47], s82 offen offset:64
buffer_load_dwordx4 v[152:155], v168, s[44:47], s82 offen offset:128
buffer_load_dwordx4 v[156:159], v168, s[44:47], s82 offen offset:192
v_mfma_f32_16x16x32_bf16 v[48:51], v[144:147], a[64:67], 0
v_mfma_f32_16x16x32_bf16 v[52:55], v[144:147], a[68:71], 0
v_mfma_f32_16x16x32_bf16 v[56:59], v[144:147], a[96:99], 0
v_mfma_f32_16x16x32_bf16 v[60:63], v[144:147], a[100:103], 0
s_waitcnt vmcnt(2)
Mvva 48,148,72
Mvva 52,148,76
Mvva 56,148,104
Mvva 60,148,108
s_waitcnt vmcnt(1)
Mvva 48,152,80
Mvva 52,152,84
Mvva 56,152,112
Mvva 60,152,116
s_waitcnt vmcnt(0)
Mvva 48,156,88
Mvva 52,156,92
Mvva 56,156,120
Mvva 60,156,124
s_nop 4
v_max3_f32 v28, v28, v48, v49
v_max3_f32 v28, v28, v50, v51
v_max3_f32 v29, v29, v52, v53
v_max3_f32 v29, v29, v54, v55
v_max3_f32 v30, v30, v56, v57
v_max3_f32 v30, v30, v58, v59
v_max3_f32 v31, v31, v60, v61
v_max3_f32 v31, v31, v62, v63
s_add_u32 s82, s82, 4096
s_sub_u32 s83, s83, 1
s_cmp_lg_u32 s83, 0
s_cbranch_scc1 L_maxl1
s_nop 7
s_branch L_maxr1
L_spin11:
s_mov_b32 s91, 0x8000
L_spinl11:
s_sleep 2
buffer_load_dword v37, v36, s[40:43], 0 offen sc1
s_waitcnt vmcnt(0)
v_cmp_ne_u32 vcc, s98, v37
s_cbranch_vccz L_pollok11
s_sub_u32 s91, s91, 1
s_cmp_lg_u32 s91, 0
s_cbranch_scc1 L_spinl11
s_branch L_pollok11
L_spin12:
s_mov_b32 s91, 0x8000
L_spinl12:
s_sleep 2
buffer_load_dword v173, v172, s[40:43], 0 offen sc1
s_waitcnt vmcnt(0)
v_cmp_ne_u32 vcc, s98, v173
s_cbranch_vccz L_pollok12
s_sub_u32 s91, s91, 1
s_cmp_lg_u32 s91, 0
s_cbranch_scc1 L_spinl12
s_branch L_pollok12
L_spin13:
s_mov_b32 s91, 0x8000
L_spinl13:
s_sleep 2
buffer_load_dword v173, v172, s[40:43], 0 offen sc1
s_waitcnt vmcnt(0)
v_cmp_ne_u32 vcc, s98, v173
s_cbranch_vccz L_pollok13
s_sub_u32 s91, s91, 1
s_cmp_lg_u32 s91, 0
s_cbranch_scc1 L_spinl13
s_branch L_pollok13
L_spin14:
s_mov_b32 s91, 0x8000
L_spinl14:
s_sleep 2
buffer_load_dword v37, v36, s[40:43], 0 offen sc1
s_waitcnt vmcnt(0)
v_cmp_ne_u32 vcc, s98, v37
s_cbranch_vccz L_pollok14
s_sub_u32 s91, s91, 1
s_cmp_lg_u32 s91, 0
s_cbranch_scc1 L_spinl14
s_branch L_pollok14
L_spin15:
s_mov_b32 s91, 0x8000
L_spinl15:
s_sleep 2
buffer_load_dword v173, v172, s[40:43], 0 offen sc1
s_waitcnt vmcnt(0)
v_cmp_ne_u32 vcc, s98, v173
s_cbranch_vccz L_pollok15
s_sub_u32 s91, s91, 1
s_cmp_lg_u32 s91, 0
s_cbranch_scc1 L_spinl15
s_branch L_pollok15
L_spin16:
s_mov_b32 s91, 0x8000
L_spinl16:
s_sleep 2
buffer_load_dword v173, v172, s[40:43], 0 offen sc1
s_waitcnt vmcnt(0)
v_cmp_ne_u32 vcc, s98, v173
s_cbranch_vccz L_pollok16
s_sub_u32 s91, s91, 1
s_cmp_lg_u32 s91, 0
s_cbranch_scc1 L_spinl16
s_branch L_pollok16
L_spin17:
s_mov_b32 s91, 0x8000
L_spinl17:
s_sleep 2
buffer_load_dword v173, v172, s[40:43], 0 offen sc1
s_waitcnt vmcnt(0)
v_cmp_ne_u32 vcc, s98, v173
s_cbranch_vccz L_pollok17
s_sub_u32 s91, s91, 1
s_cmp_lg_u32 s91, 0
s_cbranch_scc1 L_spinl17
s_branch L_pollok17
.fill 16384, 4, 0xbf810000
.section .rodata,"a"
.p2align 6
.amdhsa_kernel recurrent_scan__sliding_block_cached__mixer_s_mlp__prompt_kernel
  .amdhsa_next_free_vgpr 512
  .amdhsa_next_free_sgpr 102
  .amdhsa_accum_offset 256
  .amdhsa_group_segment_fixed_size 0
  .amdhsa_kernarg_size 104
  .amdhsa_user_sgpr_count 2
  .amdhsa_user_sgpr_kernarg_segment_ptr 1
  .amdhsa_system_sgpr_workgroup_id_x 1
.end_amdhsa_kernel
```
